```python
import torch

def _softmax(x, axis=-1):
    return torch.softmax(x, dim=axis)
def _gelu(x):
    return torch.nn.functional.gelu(x, approximate="tanh")
def _silu(x):
    return torch.nn.functional.silu(x)
def _sigmoid(x):
    return torch.sigmoid(x)
def _layernorm(x, axis=-1, eps=1e-5):
    m = x.mean(dim=axis, keepdim=True)
    v = x.var(dim=axis, keepdim=True, unbiased=False)
    return (x - m) / torch.sqrt(v + eps)
def _scatter_add(tgt, idx, src, axis=0):
    return tgt.clone().index_add_(axis, idx, src)
def _segment_sum(src, seg, n):
    out = torch.zeros((n,) + src.shape[1:], dtype=src.dtype)
    return out.index_add_(0, seg, src)
def _pad(x, pw):
    flat = tuple(v for pair in reversed(pw) for v in pair)
    return torch.nn.functional.pad(x, flat)

kernel_name = 'parallel_sum__compressed_kv_cla__glu_gated_geglu__prompt'

def setup_inputs():

    _w = (lambda a: (lambda t: t.to(torch.bfloat16) if t.is_floating_point() else t)(torch.as_tensor(a)))
    def _A_setup():
        B, H, Sq, Sk, D, M = 1, 32, 2048, 2048, 128, 576
        Dc = 4 * D
        return {
            "x": _w((lambda *s: torch.randn(*s, dtype=torch.bfloat16) * 0.05)(B, Sq, M)),
            "c_kv": _w((lambda *s: torch.randn(*s, dtype=torch.bfloat16) * 0.4)(B, Sk, Dc)),
            "w_q": _w((lambda *s: torch.randn(*s, dtype=torch.bfloat16) * 3.2)(M, H, D) * (M ** -0.5)),
            "w_uk": _w((lambda *s: torch.randn(*s, dtype=torch.bfloat16) * 3.2)(Dc, H, D) * (Dc ** -0.5)),
            "w_uv": _w((lambda *s: torch.randn(*s, dtype=torch.bfloat16) * 0.4)(Dc, H, D) * (Dc ** -0.5)),
            "w_o": _w((lambda *s: torch.randn(*s, dtype=torch.bfloat16) * 0.4)(H, D, M) * ((H * D) ** -0.5)),
        }
    _A_in = _A_setup()

    def _B_setup():
        B, S, Dm, Df = 1, 2048, 576, 4608
        return {
            "x": _w((lambda *s: torch.randn(*s, dtype=torch.bfloat16) * 0.05)(B, S, Dm)),
            "w_gate": _w((lambda *s: torch.randn(*s, dtype=torch.bfloat16) * 0.4)(Dm, Df) * (Dm ** -0.5)),
            "w_up": _w((lambda *s: torch.randn(*s, dtype=torch.bfloat16) * 0.4)(Dm, Df) * (Dm ** -0.5)),
            "w_down": _w((lambda *s: torch.randn(*s, dtype=torch.bfloat16) * 0.4)(Df, Dm) * (Df ** -0.5)),
        }
    _B_in = _B_setup()

    return {
        "A_x": _A_in["x"],
        "A_c_kv": _A_in["c_kv"],
        "A_w_q": _A_in["w_q"],
        "A_w_uk": _A_in["w_uk"],
        "A_w_uv": _A_in["w_uv"],
        "A_w_o": _A_in["w_o"],
        "B_x": _B_in["x"],
        "B_w_gate": _B_in["w_gate"],
        "B_w_up": _B_in["w_up"],
        "B_w_down": _B_in["w_down"],
    }

def reference(A_x, A_c_kv, A_w_q, A_w_uk, A_w_uv, A_w_o, B_x, B_w_gate, B_w_up, B_w_down):
    def _A_ref(x, c_kv, w_q, w_uk, w_uv, w_o):
        B, Sq, M = x.shape[0], x.shape[1], x.shape[2]
        Sk = c_kv.shape[1]
        H, D = w_q.shape[1], w_q.shape[2]
        q = torch.einsum("bqm,mhd->bhqd", x, w_q)
        k = torch.einsum("bkc,chd->bhkd", c_kv, w_uk)
        v = torch.einsum("bkc,chd->bhkd", c_kv, w_uv)
        scores = torch.einsum("bhqd,bhkd->bhqk", q, k) * (D ** -0.5)
        off = Sk - Sq
        qi = torch.arange(Sq)[:, None]
        kj = torch.arange(Sk)[None, :]
        cmask = kj <= (qi + off)
        scores = torch.where(cmask[None, None], scores, -1e9)
        p = _softmax(scores, axis=-1)
        ctx = torch.einsum("bhqk,bhkd->bhqd", p, v)
        return torch.einsum("bhqd,hdm->bqm", ctx, w_o)

    def _B_ref(x, w_gate, w_up, w_down):
        g = torch.einsum("bsd,df->bsf", x, w_gate)
        u = torch.einsum("bsd,df->bsf", x, w_up)
        h = _gelu(g) * u
        return torch.einsum("bsf,fd->bsd", h, w_down)

    x = A_x
    xn = _layernorm(x, axis=-1)
    return x + _A_ref(xn, A_c_kv, A_w_q, A_w_uk, A_w_uv, A_w_o) + _B_ref(xn, B_w_gate, B_w_up, B_w_down)
```

```asm
; @launch kernel=p1_kernel grid=(256,1,1) block=(256,1,1) lds=147456
; @launch kernel=ap_kernel grid=(256,1,1) block=(256,1,1) lds=147456
.amdgcn_target "amdgcn-amd-amdhsa--gfx950"
.text
.globl p1_kernel
.p2align 8
.type p1_kernel,@function
p1_kernel:
s_cmp_ge_u32 s2, 256
s_cbranch_scc1 L_p1_end
s_load_dwordx4 s[4:7], s[0:1], 0
s_load_dwordx2 s[68:69], s[0:1], 96
s_load_dwordx2 s[88:89], s[0:1], 88
v_lshrrev_b32 v1, 6, v0
s_nop 0
v_readfirstlane_b32 s20, v1
s_and_b32 s35, s2, 1
s_lshl_b32 s35, s35, 2
s_lshr_b32 s37, s2, 3
s_and_b32 s37, s37, 3
s_add_u32 s35, s35, s37
s_and_b32 s36, s2, 6
s_lshl_b32 s36, s36, 2
s_lshr_b32 s37, s2, 5
s_add_u32 s36, s36, s37
s_lshl_b32 s26, s35, 4
s_nop 1
s_lshl_b32 s37, s20, 2
s_add_u32 s26, s26, s37
s_mov_b32 s23, 0
s_mov_b32 s78, 0
s_mov_b32 s25, 1
s_mov_b32 s42, s36
s_mov_b32 s43, 0
s_waitcnt lgkmcnt(0)
s_cmp_lg_u32 s2, 0
s_cbranch_scc1 L_p1_nz
s_add_u32 s8, s68, 0x6d00000
s_addc_u32 s9, s69, 0
s_mov_b32 s10, 0x3000
s_mov_b32 s11, 0x20000
v_lshlrev_b32 v10, 7, v0
v_mov_b32 v11, 0
buffer_store_dword v11, v10, s[8:11], 0 offen sc1
L_p1_nz:
s_cmp_lg_u32 s20, 3
s_cbranch_scc1 L_p1_nmb
s_add_u32 s8, s68, 0x6d10000
s_addc_u32 s9, s69, 0
s_mov_b32 s10, 0x8000
s_mov_b32 s11, 0x20000
s_lshr_b32 s12, s26, 4
s_lshl_b32 s12, s12, 5
s_add_u32 s12, s12, s42
s_lshl_b32 s12, s12, 7
v_mov_b32 v10, s12
v_mov_b32 v11, 0
s_mov_b64 exec, 1
buffer_store_dword v11, v10, s[8:11], 0 offen sc1
s_mov_b64 exec, -1
L_p1_nmb:
L_p1_taskC:
v_and_b32 v97, 63, v0
v_lshrrev_b32 v99, 4, v97
v_and_b32 v100, 15, v97
s_lshr_b32 s80, s26, 4
s_lshl_b32 s80, s80, 8
s_lshl_b32 s81, s42, 3
s_add_u32 s80, s80, s81
s_and_b32 s81, s20, 1
s_lshl_b32 s81, s81, 2
s_add_u32 s80, s80, s81
v_add_u32 v101, s80, v99
v_lshrrev_b32 v102, 3, v100
v_lshlrev_b32 v102, 10, v102
v_and_b32 v103, 3, v100
v_lshlrev_b32 v103, 4, v103
v_and_b32 v104, 15, v101
v_add_u32 v103, v103, v104
v_lshlrev_b32 v103, 4, v103
v_add_u32 v102, v102, v103
v_lshrrev_b32 v103, 2, v100
v_and_b32 v103, 1, v103
v_lshlrev_b32 v103, 3, v103
v_add_u32 v102, v102, v103
v_lshrrev_b32 v105, 4, v101
s_cmp_ge_u32 s20, 2
s_cbranch_scc1 L_p1_cklC
s_mov_b32 s8, s4
s_mov_b32 s9, s5
s_mov_b32 s10, 0x240000
s_mov_b32 s11, 0x20000
s_mov_b32 s16, s68
s_mov_b32 s17, s69
s_mov_b32 s18, 0x240000
s_mov_b32 s19, 0x20000
s_movk_i32 s80, 1152
v_mul_lo_u32 v106, v101, s80
v_lshl_add_u32 v106, v100, 3, v106
buffer_load_dwordx2 v[108:109], v106, s[8:11], 0 offen
buffer_load_dwordx2 v[110:111], v106, s[8:11], 0 offen offset:128
buffer_load_dwordx2 v[112:113], v106, s[8:11], 0 offen offset:256
buffer_load_dwordx2 v[114:115], v106, s[8:11], 0 offen offset:384
buffer_load_dwordx2 v[116:117], v106, s[8:11], 0 offen offset:512
buffer_load_dwordx2 v[118:119], v106, s[8:11], 0 offen offset:640
buffer_load_dwordx2 v[120:121], v106, s[8:11], 0 offen offset:768
buffer_load_dwordx2 v[122:123], v106, s[8:11], 0 offen offset:896
buffer_load_dwordx2 v[124:125], v106, s[8:11], 0 offen offset:1024
s_movk_i32 s80, 18432
v_mul_lo_u32 v105, v105, s80
v_add_u32 v102, v102, v105
s_branch L_p1_tkjC
L_p1_cklC:
s_mov_b32 s8, s6
s_mov_b32 s9, s7
s_mov_b32 s10, 0x200000
s_mov_b32 s11, 0x20000
s_add_u32 s16, s68, 0x400000
s_addc_u32 s17, s69, 0
s_mov_b32 s18, 0x200000
s_mov_b32 s19, 0x20000
v_lshlrev_b32 v106, 10, v101
v_lshl_add_u32 v106, v100, 3, v106
buffer_load_dwordx2 v[108:109], v106, s[8:11], 0 offen
buffer_load_dwordx2 v[110:111], v106, s[8:11], 0 offen offset:128
buffer_load_dwordx2 v[112:113], v106, s[8:11], 0 offen offset:256
buffer_load_dwordx2 v[114:115], v106, s[8:11], 0 offen offset:384
buffer_load_dwordx2 v[116:117], v106, s[8:11], 0 offen offset:512
buffer_load_dwordx2 v[118:119], v106, s[8:11], 0 offen offset:640
buffer_load_dwordx2 v[120:121], v106, s[8:11], 0 offen offset:768
buffer_load_dwordx2 v[122:123], v106, s[8:11], 0 offen offset:896
v_mov_b32 v107, 0x7fffffff
buffer_load_dwordx2 v[124:125], v107, s[8:11], 0 offen
v_lshlrev_b32 v105, 14, v105
v_add_u32 v102, v102, v105
L_p1_tkjC:
s_mov_b32 s36, s42
s_cmp_lt_u32 s36, 7
s_cbranch_scc1 L_p1_roleQ
s_cmp_lt_u32 s36, 21
s_cbranch_scc1 L_p1_roleG
s_cmp_lt_u32 s36, 27
s_cbranch_scc1 L_p1_roleK
s_sub_u32 s21, s36, 27
s_mul_i32 s21, s21, 12
s_mov_b32 s22, 12
s_branch L_p1_segV
L_p1_roleQ:
s_mul_i32 s21, s36, 10
s_cmp_eq_u32 s36, 6
s_cselect_b32 s22, 4, 10
s_cselect_b32 s23, 1, 0
s_branch L_p1_segQ
L_p1_roleG:
s_sub_u32 s21, s36, 7
s_mul_i32 s21, s21, 10
s_mov_b32 s22, 10
s_branch L_p1_segG
L_p1_roleK:
s_sub_u32 s21, s36, 21
s_cmp_eq_u32 s21, 5
s_mul_i32 s21, s21, 12
s_cselect_b32 s22, 4, 12
s_cselect_b32 s23, 1, 0
s_branch L_p1_segK
L_p1_segQ:
s_load_dwordx2 s[64:65], s[0:1], 16
s_load_dwordx2 s[68:69], s[0:1], 96
v_and_b32 v10, 63, v0
v_lshlrev_b32 v2, 4, v10
v_lshrrev_b32 v11, 3, v10
v_mul_u32_u24 v11, 8192, v11
v_lshrrev_b32 v12, 4, v10
v_lshlrev_b32 v12, 1, v12
v_and_b32 v13, 7, v10
v_xor_b32 v12, v12, v13
v_lshl_add_u32 v9, v12, 4, v11
v_lshrrev_b32 v11, 2, v10
v_and_b32 v12, 3, v10
v_lshlrev_b32 v12, 3, v12
v_lshl_add_u32 v12, v11, 7, v12
v_lshrrev_b32 v13, 1, v11
v_and_b32 v13, 3, v13
v_xor_b32 v14, 0, v13
v_lshl_add_u32 v3, v14, 5, v12
v_xor_b32 v14, 1, v13
v_lshl_add_u32 v4, v14, 5, v12
v_xor_b32 v14, 2, v13
v_lshl_add_u32 v5, v14, 5, v12
v_xor_b32 v14, 3, v13
v_lshl_add_u32 v6, v14, 5, v12
s_waitcnt lgkmcnt(0)
s_mov_b32 s44, s64
s_mov_b32 s45, s65
s_mov_b32 s46, 0x480000
s_mov_b32 s47, 0x20000
s_add_u32 s52, s68, 0x800000
s_addc_u32 s53, s69, 0
s_mov_b32 s54, 0x1000000
s_mov_b32 s55, 0x20000
s_add_u32 s56, s68, 0x800000
s_addc_u32 s57, s69, 0
s_mov_b32 s58, 0x0
s_mov_b32 s59, 0x20000
s_mul_i32 s32, s21, 128
s_mul_i32 s35, s20, 65536
s_add_u32 s32, s32, s35
s_lshl_b32 s30, s20, 10
s_mov_b32 s27, 0
s_mov_b32 s28, 36864
s_mov_b32 s29, 73728
s_lshl_b32 s33, s26, 17
s_lshl_b32 s35, s21, 11
s_add_u32 s33, s33, s35
s_mov_b32 s34, s33
s_mov_b32 s41, 0x3e0293ee
s_lshr_b32 s35, s26, 4
s_mul_i32 s35, s35, 589824
s_add_u32 s36, s21, 4
s_mul_i32 s36, s36, 128
s_add_u32 s76, s35, s36
v_lshrrev_b32 v10, 1, v0
v_and_b32 v11, 1, v0
v_mul_u32_u24 v216, 8192, v10
v_lshl_add_u32 v216, v11, 7, v216
s_mov_b32 s72, s44
s_mov_b32 s73, s45
s_mov_b32 s74, s46
s_mov_b32 s75, s47
v_mov_b32 v12, 0x7fffffff
v_cmp_gt_u32 vcc, 72, v10
s_nop 1
v_cndmask_b32 v216, v12, v216, vcc
s_mov_b32 s77, s74
s_getpc_b64 s[90:91]
L_ct_p1Q:
s_add_u32 s90, s90, L_p1_tkjQ-L_ct_p1Q
s_addc_u32 s91, s91, 0
s_lshr_b32 s35, s2, 3
s_and_b32 s35, s35, 3
s_mul_i32 s35, s35, 8192
v_min_u32 v238, 63, v0
v_lshlrev_b32 v238, 7, v238
v_add_u32 v238, s35, v238
global_load_dword v239, v238, s[90:91]
s_branch L_p1_tkjQ
L_p1_taskQ:
v_and_b32 v97, 63, v0
v_lshrrev_b32 v99, 4, v97
v_and_b32 v100, 15, v97
s_lshr_b32 s80, s26, 4
s_lshl_b32 s80, s80, 8
s_lshl_b32 s81, s42, 3
s_add_u32 s80, s80, s81
s_and_b32 s81, s20, 1
s_lshl_b32 s81, s81, 2
s_add_u32 s80, s80, s81
v_add_u32 v101, s80, v99
v_lshrrev_b32 v102, 3, v100
v_lshlrev_b32 v102, 10, v102
v_and_b32 v103, 3, v100
v_lshlrev_b32 v103, 4, v103
v_and_b32 v104, 15, v101
v_add_u32 v103, v103, v104
v_lshlrev_b32 v103, 4, v103
v_add_u32 v102, v102, v103
v_lshrrev_b32 v103, 2, v100
v_and_b32 v103, 1, v103
v_lshlrev_b32 v103, 3, v103
v_add_u32 v102, v102, v103
v_lshrrev_b32 v105, 4, v101
s_cmp_ge_u32 s20, 2
s_cbranch_scc1 L_p1_cklQ
s_mov_b32 s8, s4
s_mov_b32 s9, s5
s_mov_b32 s10, 0x240000
s_mov_b32 s11, 0x20000
s_mov_b32 s16, s68
s_mov_b32 s17, s69
s_mov_b32 s18, 0x240000
s_mov_b32 s19, 0x20000
s_movk_i32 s80, 1152
v_mul_lo_u32 v106, v101, s80
v_lshl_add_u32 v106, v100, 3, v106
buffer_load_dwordx2 v[108:109], v106, s[8:11], 0 offen
buffer_load_dwordx2 v[110:111], v106, s[8:11], 0 offen offset:128
buffer_load_dwordx2 v[112:113], v106, s[8:11], 0 offen offset:256
buffer_load_dwordx2 v[114:115], v106, s[8:11], 0 offen offset:384
buffer_load_dwordx2 v[116:117], v106, s[8:11], 0 offen offset:512
buffer_load_dwordx2 v[118:119], v106, s[8:11], 0 offen offset:640
buffer_load_dwordx2 v[120:121], v106, s[8:11], 0 offen offset:768
buffer_load_dwordx2 v[122:123], v106, s[8:11], 0 offen offset:896
buffer_load_dwordx2 v[124:125], v106, s[8:11], 0 offen offset:1024
s_movk_i32 s80, 18432
v_mul_lo_u32 v105, v105, s80
v_add_u32 v102, v102, v105
s_branch L_p1_tkjQ
L_p1_cklQ:
s_mov_b32 s8, s6
s_mov_b32 s9, s7
s_mov_b32 s10, 0x200000
s_mov_b32 s11, 0x20000
s_add_u32 s16, s68, 0x400000
s_addc_u32 s17, s69, 0
s_mov_b32 s18, 0x200000
s_mov_b32 s19, 0x20000
v_lshlrev_b32 v106, 10, v101
v_lshl_add_u32 v106, v100, 3, v106
buffer_load_dwordx2 v[108:109], v106, s[8:11], 0 offen
buffer_load_dwordx2 v[110:111], v106, s[8:11], 0 offen offset:128
buffer_load_dwordx2 v[112:113], v106, s[8:11], 0 offen offset:256
buffer_load_dwordx2 v[114:115], v106, s[8:11], 0 offen offset:384
buffer_load_dwordx2 v[116:117], v106, s[8:11], 0 offen offset:512
buffer_load_dwordx2 v[118:119], v106, s[8:11], 0 offen offset:640
buffer_load_dwordx2 v[120:121], v106, s[8:11], 0 offen offset:768
buffer_load_dwordx2 v[122:123], v106, s[8:11], 0 offen offset:896
v_mov_b32 v107, 0x7fffffff
buffer_load_dwordx2 v[124:125], v107, s[8:11], 0 offen
v_lshlrev_b32 v105, 14, v105
v_add_u32 v102, v102, v105
L_p1_tkjQ:
s_cmp_lg_u32 s43, 0
s_cbranch_scc1 L_p1_tkwQ
s_branch L_p1_tkcQ
L_p1_tkwQ:
s_waitcnt vmcnt(0)
L_p1_tkcQ:
s_cmp_ge_u32 s20, 2
s_cbranch_scc1 L_p1_ckcQ
s_waitcnt vmcnt(9)
v_lshlrev_b32 v128, 16, v108
v_and_b32 v129, 0xffff0000, v108
v_lshlrev_b32 v130, 16, v109
v_and_b32 v131, 0xffff0000, v109
s_waitcnt vmcnt(8)
v_lshlrev_b32 v132, 16, v110
v_and_b32 v133, 0xffff0000, v110
v_lshlrev_b32 v134, 16, v111
v_and_b32 v135, 0xffff0000, v111
s_waitcnt vmcnt(7)
v_lshlrev_b32 v136, 16, v112
v_and_b32 v137, 0xffff0000, v112
v_lshlrev_b32 v138, 16, v113
v_and_b32 v139, 0xffff0000, v113
s_waitcnt vmcnt(6)
v_lshlrev_b32 v140, 16, v114
v_and_b32 v141, 0xffff0000, v114
v_lshlrev_b32 v142, 16, v115
v_and_b32 v143, 0xffff0000, v115
s_waitcnt vmcnt(5)
v_lshlrev_b32 v144, 16, v116
v_and_b32 v145, 0xffff0000, v116
v_lshlrev_b32 v146, 16, v117
v_and_b32 v147, 0xffff0000, v117
s_waitcnt vmcnt(4)
v_lshlrev_b32 v148, 16, v118
v_and_b32 v149, 0xffff0000, v118
v_lshlrev_b32 v150, 16, v119
v_and_b32 v151, 0xffff0000, v119
s_waitcnt vmcnt(3)
v_lshlrev_b32 v152, 16, v120
v_and_b32 v153, 0xffff0000, v120
v_lshlrev_b32 v154, 16, v121
v_and_b32 v155, 0xffff0000, v121
s_waitcnt vmcnt(2)
v_lshlrev_b32 v156, 16, v122
v_and_b32 v157, 0xffff0000, v122
v_lshlrev_b32 v158, 16, v123
v_and_b32 v159, 0xffff0000, v123
s_waitcnt vmcnt(1)
v_lshlrev_b32 v160, 16, v124
v_and_b32 v161, 0xffff0000, v124
v_lshlrev_b32 v162, 16, v125
v_and_b32 v163, 0xffff0000, v125
v_add_f32 v166, v128, v129
v_add_f32 v167, v130, v131
v_add_f32 v168, v132, v133
v_add_f32 v169, v134, v135
v_add_f32 v166, v166, v136
v_add_f32 v167, v167, v137
v_add_f32 v168, v168, v138
v_add_f32 v169, v169, v139
v_add_f32 v166, v166, v140
v_add_f32 v167, v167, v141
v_add_f32 v168, v168, v142
v_add_f32 v169, v169, v143
v_add_f32 v166, v166, v144
v_add_f32 v167, v167, v145
v_add_f32 v168, v168, v146
v_add_f32 v169, v169, v147
v_add_f32 v166, v166, v148
v_add_f32 v167, v167, v149
v_add_f32 v168, v168, v150
v_add_f32 v169, v169, v151
v_add_f32 v166, v166, v152
v_add_f32 v167, v167, v153
v_add_f32 v168, v168, v154
v_add_f32 v169, v169, v155
v_add_f32 v166, v166, v156
v_add_f32 v167, v167, v157
v_add_f32 v168, v168, v158
v_add_f32 v169, v169, v159
v_add_f32 v166, v166, v160
v_add_f32 v167, v167, v161
v_add_f32 v168, v168, v162
v_add_f32 v169, v169, v163
v_add_f32 v166, v166, v167
v_add_f32 v168, v168, v169
s_nop 0
v_add_f32 v166, v166, v168
s_nop 1
v_add_f32_dpp v166, v166, v166 row_ror:8 row_mask:0xf bank_mask:0xf
s_nop 1
v_add_f32_dpp v166, v166, v166 row_ror:4 row_mask:0xf bank_mask:0xf
s_nop 1
v_add_f32_dpp v166, v166, v166 row_ror:2 row_mask:0xf bank_mask:0xf
s_nop 1
v_add_f32_dpp v166, v166, v166 row_ror:1 row_mask:0xf bank_mask:0xf
s_mov_b32 s80, 0x3ae38e39
v_mul_f32 v166, s80, v166
v_sub_f32 v170, v128, v166
v_mul_f32 v172, v170, v170
v_sub_f32 v170, v129, v166
v_mul_f32 v173, v170, v170
v_sub_f32 v170, v130, v166
v_mul_f32 v174, v170, v170
v_sub_f32 v170, v131, v166
v_mul_f32 v175, v170, v170
v_sub_f32 v170, v132, v166
v_fmac_f32 v172, v170, v170
v_sub_f32 v170, v133, v166
v_fmac_f32 v173, v170, v170
v_sub_f32 v170, v134, v166
v_fmac_f32 v174, v170, v170
v_sub_f32 v170, v135, v166
v_fmac_f32 v175, v170, v170
v_sub_f32 v170, v136, v166
v_fmac_f32 v172, v170, v170
v_sub_f32 v170, v137, v166
v_fmac_f32 v173, v170, v170
v_sub_f32 v170, v138, v166
v_fmac_f32 v174, v170, v170
v_sub_f32 v170, v139, v166
v_fmac_f32 v175, v170, v170
v_sub_f32 v170, v140, v166
v_fmac_f32 v172, v170, v170
v_sub_f32 v170, v141, v166
v_fmac_f32 v173, v170, v170
v_sub_f32 v170, v142, v166
v_fmac_f32 v174, v170, v170
v_sub_f32 v170, v143, v166
v_fmac_f32 v175, v170, v170
v_sub_f32 v170, v144, v166
v_fmac_f32 v172, v170, v170
v_sub_f32 v170, v145, v166
v_fmac_f32 v173, v170, v170
v_sub_f32 v170, v146, v166
v_fmac_f32 v174, v170, v170
v_sub_f32 v170, v147, v166
v_fmac_f32 v175, v170, v170
v_sub_f32 v170, v148, v166
v_fmac_f32 v172, v170, v170
v_sub_f32 v170, v149, v166
v_fmac_f32 v173, v170, v170
v_sub_f32 v170, v150, v166
v_fmac_f32 v174, v170, v170
v_sub_f32 v170, v151, v166
v_fmac_f32 v175, v170, v170
v_sub_f32 v170, v152, v166
v_fmac_f32 v172, v170, v170
v_sub_f32 v170, v153, v166
v_fmac_f32 v173, v170, v170
v_sub_f32 v170, v154, v166
v_fmac_f32 v174, v170, v170
v_sub_f32 v170, v155, v166
v_fmac_f32 v175, v170, v170
v_sub_f32 v170, v156, v166
v_fmac_f32 v172, v170, v170
v_sub_f32 v170, v157, v166
v_fmac_f32 v173, v170, v170
v_sub_f32 v170, v158, v166
v_fmac_f32 v174, v170, v170
v_sub_f32 v170, v159, v166
v_fmac_f32 v175, v170, v170
v_sub_f32 v170, v160, v166
v_fmac_f32 v172, v170, v170
v_sub_f32 v170, v161, v166
v_fmac_f32 v173, v170, v170
v_sub_f32 v170, v162, v166
v_fmac_f32 v174, v170, v170
v_sub_f32 v170, v163, v166
v_fmac_f32 v175, v170, v170
v_add_f32 v172, v172, v173
v_add_f32 v174, v174, v175
s_nop 0
v_add_f32 v172, v172, v174
s_nop 1
v_add_f32_dpp v172, v172, v172 row_ror:8 row_mask:0xf bank_mask:0xf
s_nop 1
v_add_f32_dpp v172, v172, v172 row_ror:4 row_mask:0xf bank_mask:0xf
s_nop 1
v_add_f32_dpp v172, v172, v172 row_ror:2 row_mask:0xf bank_mask:0xf
s_nop 1
v_add_f32_dpp v172, v172, v172 row_ror:1 row_mask:0xf bank_mask:0xf
v_mul_f32 v172, s80, v172
v_cvt_pk_bf16_f32 v166, v166, v172
v_and_b32 v172, 0xffff0000, v166
v_lshlrev_b32 v166, 16, v166
v_add_f32 v172, 0x3727c5ac, v172
v_cvt_pk_bf16_f32 v172, v172, v172
v_lshlrev_b32 v172, 16, v172
v_sqrt_f32 v172, v172
s_nop 0
v_cvt_pk_bf16_f32 v172, v172, v172
v_lshlrev_b32 v172, 16, v172
v_rcp_f32 v173, v172
s_nop 0
v_sub_f32 v128, v128, v166
v_sub_f32 v129, v129, v166
v_cvt_pk_bf16_f32 v176, v128, v129
v_lshlrev_b32 v177, 16, v176
v_and_b32 v178, 0xffff0000, v176
v_mul_f32 v179, v177, v173
v_mul_f32 v180, v178, v173
v_cvt_pk_bf16_f32 v108, v179, v180
v_sub_f32 v130, v130, v166
v_sub_f32 v131, v131, v166
v_cvt_pk_bf16_f32 v176, v130, v131
v_lshlrev_b32 v177, 16, v176
v_and_b32 v178, 0xffff0000, v176
v_mul_f32 v179, v177, v173
v_mul_f32 v180, v178, v173
v_cvt_pk_bf16_f32 v109, v179, v180
v_sub_f32 v132, v132, v166
v_sub_f32 v133, v133, v166
v_cvt_pk_bf16_f32 v176, v132, v133
v_lshlrev_b32 v177, 16, v176
v_and_b32 v178, 0xffff0000, v176
v_mul_f32 v179, v177, v173
v_mul_f32 v180, v178, v173
v_cvt_pk_bf16_f32 v110, v179, v180
v_sub_f32 v134, v134, v166
v_sub_f32 v135, v135, v166
v_cvt_pk_bf16_f32 v176, v134, v135
v_lshlrev_b32 v177, 16, v176
v_and_b32 v178, 0xffff0000, v176
v_mul_f32 v179, v177, v173
v_mul_f32 v180, v178, v173
v_cvt_pk_bf16_f32 v111, v179, v180
v_sub_f32 v136, v136, v166
v_sub_f32 v137, v137, v166
v_cvt_pk_bf16_f32 v176, v136, v137
v_lshlrev_b32 v177, 16, v176
v_and_b32 v178, 0xffff0000, v176
v_mul_f32 v179, v177, v173
v_mul_f32 v180, v178, v173
v_cvt_pk_bf16_f32 v112, v179, v180
v_sub_f32 v138, v138, v166
v_sub_f32 v139, v139, v166
v_cvt_pk_bf16_f32 v176, v138, v139
v_lshlrev_b32 v177, 16, v176
v_and_b32 v178, 0xffff0000, v176
v_mul_f32 v179, v177, v173
v_mul_f32 v180, v178, v173
v_cvt_pk_bf16_f32 v113, v179, v180
v_sub_f32 v140, v140, v166
v_sub_f32 v141, v141, v166
v_cvt_pk_bf16_f32 v176, v140, v141
v_lshlrev_b32 v177, 16, v176
v_and_b32 v178, 0xffff0000, v176
v_mul_f32 v179, v177, v173
v_mul_f32 v180, v178, v173
v_cvt_pk_bf16_f32 v114, v179, v180
v_sub_f32 v142, v142, v166
v_sub_f32 v143, v143, v166
v_cvt_pk_bf16_f32 v176, v142, v143
v_lshlrev_b32 v177, 16, v176
v_and_b32 v178, 0xffff0000, v176
v_mul_f32 v179, v177, v173
v_mul_f32 v180, v178, v173
v_cvt_pk_bf16_f32 v115, v179, v180
v_sub_f32 v144, v144, v166
v_sub_f32 v145, v145, v166
v_cvt_pk_bf16_f32 v176, v144, v145
v_lshlrev_b32 v177, 16, v176
v_and_b32 v178, 0xffff0000, v176
v_mul_f32 v179, v177, v173
v_mul_f32 v180, v178, v173
v_cvt_pk_bf16_f32 v116, v179, v180
v_sub_f32 v146, v146, v166
v_sub_f32 v147, v147, v166
v_cvt_pk_bf16_f32 v176, v146, v147
v_lshlrev_b32 v177, 16, v176
v_and_b32 v178, 0xffff0000, v176
v_mul_f32 v179, v177, v173
v_mul_f32 v180, v178, v173
v_cvt_pk_bf16_f32 v117, v179, v180
v_sub_f32 v148, v148, v166
v_sub_f32 v149, v149, v166
v_cvt_pk_bf16_f32 v176, v148, v149
v_lshlrev_b32 v177, 16, v176
v_and_b32 v178, 0xffff0000, v176
v_mul_f32 v179, v177, v173
v_mul_f32 v180, v178, v173
v_cvt_pk_bf16_f32 v118, v179, v180
v_sub_f32 v150, v150, v166
v_sub_f32 v151, v151, v166
v_cvt_pk_bf16_f32 v176, v150, v151
v_lshlrev_b32 v177, 16, v176
v_and_b32 v178, 0xffff0000, v176
v_mul_f32 v179, v177, v173
v_mul_f32 v180, v178, v173
v_cvt_pk_bf16_f32 v119, v179, v180
v_sub_f32 v152, v152, v166
v_sub_f32 v153, v153, v166
v_cvt_pk_bf16_f32 v176, v152, v153
v_lshlrev_b32 v177, 16, v176
v_and_b32 v178, 0xffff0000, v176
v_mul_f32 v179, v177, v173
v_mul_f32 v180, v178, v173
v_cvt_pk_bf16_f32 v120, v179, v180
v_sub_f32 v154, v154, v166
v_sub_f32 v155, v155, v166
v_cvt_pk_bf16_f32 v176, v154, v155
v_lshlrev_b32 v177, 16, v176
v_and_b32 v178, 0xffff0000, v176
v_mul_f32 v179, v177, v173
v_mul_f32 v180, v178, v173
v_cvt_pk_bf16_f32 v121, v179, v180
v_sub_f32 v156, v156, v166
v_sub_f32 v157, v157, v166
v_cvt_pk_bf16_f32 v176, v156, v157
v_lshlrev_b32 v177, 16, v176
v_and_b32 v178, 0xffff0000, v176
v_mul_f32 v179, v177, v173
v_mul_f32 v180, v178, v173
v_cvt_pk_bf16_f32 v122, v179, v180
v_sub_f32 v158, v158, v166
v_sub_f32 v159, v159, v166
v_cvt_pk_bf16_f32 v176, v158, v159
v_lshlrev_b32 v177, 16, v176
v_and_b32 v178, 0xffff0000, v176
v_mul_f32 v179, v177, v173
v_mul_f32 v180, v178, v173
v_cvt_pk_bf16_f32 v123, v179, v180
v_sub_f32 v160, v160, v166
v_sub_f32 v161, v161, v166
v_cvt_pk_bf16_f32 v176, v160, v161
v_lshlrev_b32 v177, 16, v176
v_and_b32 v178, 0xffff0000, v176
v_mul_f32 v179, v177, v173
v_mul_f32 v180, v178, v173
v_cvt_pk_bf16_f32 v124, v179, v180
v_sub_f32 v162, v162, v166
v_sub_f32 v163, v163, v166
v_cvt_pk_bf16_f32 v176, v162, v163
v_lshlrev_b32 v177, 16, v176
v_and_b32 v178, 0xffff0000, v176
v_mul_f32 v179, v177, v173
v_mul_f32 v180, v178, v173
v_cvt_pk_bf16_f32 v125, v179, v180
s_movk_i32 s80, 0
buffer_store_dwordx2 v[108:109], v102, s[16:19], s80 offen sc1
s_movk_i32 s80, 2048
buffer_store_dwordx2 v[110:111], v102, s[16:19], s80 offen sc1
s_movk_i32 s80, 4096
buffer_store_dwordx2 v[112:113], v102, s[16:19], s80 offen sc1
s_movk_i32 s80, 6144
buffer_store_dwordx2 v[114:115], v102, s[16:19], s80 offen sc1
s_movk_i32 s80, 8192
buffer_store_dwordx2 v[116:117], v102, s[16:19], s80 offen sc1
s_movk_i32 s80, 10240
buffer_store_dwordx2 v[118:119], v102, s[16:19], s80 offen sc1
s_movk_i32 s80, 12288
buffer_store_dwordx2 v[120:121], v102, s[16:19], s80 offen sc1
s_movk_i32 s80, 14336
buffer_store_dwordx2 v[122:123], v102, s[16:19], s80 offen sc1
s_movk_i32 s80, 16384
buffer_store_dwordx2 v[124:125], v102, s[16:19], s80 offen sc1
s_branch L_p1_tkdQ
L_p1_ckcQ:
s_movk_i32 s80, 0
s_waitcnt vmcnt(9)
buffer_store_dwordx2 v[108:109], v102, s[16:19], s80 offen sc1
s_movk_i32 s80, 2048
s_waitcnt vmcnt(9)
buffer_store_dwordx2 v[110:111], v102, s[16:19], s80 offen sc1
s_movk_i32 s80, 4096
s_waitcnt vmcnt(9)
buffer_store_dwordx2 v[112:113], v102, s[16:19], s80 offen sc1
s_movk_i32 s80, 6144
s_waitcnt vmcnt(9)
buffer_store_dwordx2 v[114:115], v102, s[16:19], s80 offen sc1
s_movk_i32 s80, 8192
s_waitcnt vmcnt(9)
buffer_store_dwordx2 v[116:117], v102, s[16:19], s80 offen sc1
s_movk_i32 s80, 10240
s_waitcnt vmcnt(9)
buffer_store_dwordx2 v[118:119], v102, s[16:19], s80 offen sc1
s_movk_i32 s80, 12288
s_waitcnt vmcnt(9)
buffer_store_dwordx2 v[120:121], v102, s[16:19], s80 offen sc1
s_movk_i32 s80, 14336
s_waitcnt vmcnt(9)
buffer_store_dwordx2 v[122:123], v102, s[16:19], s80 offen sc1
L_p1_tkdQ:
s_waitcnt vmcnt(0)
s_barrier
s_cmp_lg_u32 s43, 0
s_cbranch_scc1 L_p1_fbnQ
s_cmp_lg_u32 s20, 3
s_cbranch_scc1 L_p1_tkw1Q
s_mov_b32 s92, s88
s_mov_b32 s93, s89
s_movk_i32 s94, 256
s_mov_b32 s95, 0x20000
s_lshr_b32 s80, s26, 4
s_lshl_b32 s84, s80, 5
v_mov_b32 v97, s84
v_mov_b32 v98, 1
s_mov_b64 exec, 1
buffer_atomic_add v98, v97, s[92:95], 0 offen sc0
s_lshl_b32 s85, s80, 12
s_waitcnt vmcnt(0)
v_readfirstlane_b32 s82, v98
s_add_u32 s92, s68, 0x6d10000
s_addc_u32 s93, s69, 0
s_mov_b32 s94, 0x8000
s_mov_b32 s95, 0x20000
s_cmp_lg_u32 s82, 31
s_cbranch_scc1 L_p1_notlastQ
s_mov_b32 exec_lo, -1
s_mov_b32 exec_hi, 0
v_and_b32 v99, 63, v0
v_lshlrev_b32 v99, 7, v99
v_mov_b32 v100, 1
buffer_store_dword v100, v99, s[92:95], s85 offen sc1
s_mov_b64 exec, 1
s_mov_b32 s83, 1
s_branch L_p1_pubQ
L_p1_notlastQ:
s_lshl_b32 s84, s42, 7
s_add_u32 s84, s84, s85
v_mov_b32 v97, s84
s_mov_b32 s81, 0
L_p1_pollQ:
buffer_load_dword v99, v97, s[92:95], 0 offen sc1
s_waitcnt vmcnt(0)
v_readfirstlane_b32 s82, v99
s_nop 3
s_cmp_eq_u32 s82, 1
s_cselect_b32 s83, 1, 0
s_cbranch_scc1 L_p1_pubQ
s_sleep 4
s_add_u32 s81, s81, 1
s_cmp_lt_u32 s81, 4000
s_cbranch_scc1 L_p1_pollQ
L_p1_pubQ:
v_mov_b32 v97, 147452
v_mov_b32 v98, s83
ds_write_b32 v97, v98
s_mov_b64 exec, -1
s_add_u32 m0, s30, 0
s_add_u32 s31, s32, 0
buffer_load_dwordx4 v9, s[44:47], s31 offen lds
s_add_u32 m0, s30, 4096
s_add_u32 s31, s32, 262144
buffer_load_dwordx4 v9, s[44:47], s31 offen lds
s_add_u32 m0, s30, 8192
s_add_u32 s31, s32, 524288
buffer_load_dwordx4 v9, s[44:47], s31 offen lds
s_add_u32 m0, s30, 12288
s_add_u32 s31, s32, 786432
buffer_load_dwordx4 v9, s[44:47], s31 offen lds
s_add_u32 m0, s30, 16384
s_add_u32 s31, s32, 1048576
buffer_load_dwordx4 v9, s[44:47], s31 offen lds
s_add_u32 m0, s30, 20480
s_add_u32 s31, s32, 1310720
buffer_load_dwordx4 v9, s[44:47], s31 offen lds
s_add_u32 m0, s30, 24576
s_add_u32 s31, s32, 1572864
buffer_load_dwordx4 v9, s[44:47], s31 offen lds
s_add_u32 m0, s30, 28672
s_add_u32 s31, s32, 1835008
buffer_load_dwordx4 v9, s[44:47], s31 offen lds
s_add_u32 m0, s30, 32768
s_add_u32 s31, s32, 2097152
buffer_load_dwordx4 v9, s[44:47], s31 offen lds
s_add_u32 m0, s30, 36864
s_add_u32 s31, s32, 2359296
buffer_load_dwordx4 v9, s[44:47], s31 offen lds
s_add_u32 m0, s30, 40960
s_add_u32 s31, s32, 2621440
buffer_load_dwordx4 v9, s[44:47], s31 offen lds
s_add_u32 m0, s30, 45056
s_add_u32 s31, s32, 2883584
buffer_load_dwordx4 v9, s[44:47], s31 offen lds
s_waitcnt lgkmcnt(0)
L_p1_tkmQ:
s_barrier
v_mov_b32 v97, 147452
ds_read_b32 v98, v97
s_waitcnt lgkmcnt(0)
v_readfirstlane_b32 s83, v98
s_nop 3
s_cmp_lg_u32 s83, 0
s_cbranch_scc1 L_p1_goQ
s_mov_b32 s43, 1
s_mov_b32 s42, 0
s_barrier
s_branch L_p1_taskQ
L_p1_tkw1Q:
s_add_u32 m0, s30, 0
s_add_u32 s31, s32, 0
buffer_load_dwordx4 v9, s[44:47], s31 offen lds
s_add_u32 m0, s30, 4096
s_add_u32 s31, s32, 262144
buffer_load_dwordx4 v9, s[44:47], s31 offen lds
s_add_u32 m0, s30, 8192
s_add_u32 s31, s32, 524288
buffer_load_dwordx4 v9, s[44:47], s31 offen lds
s_add_u32 m0, s30, 12288
s_add_u32 s31, s32, 786432
buffer_load_dwordx4 v9, s[44:47], s31 offen lds
s_add_u32 m0, s30, 16384
s_add_u32 s31, s32, 1048576
buffer_load_dwordx4 v9, s[44:47], s31 offen lds
s_add_u32 m0, s30, 20480
s_add_u32 s31, s32, 1310720
buffer_load_dwordx4 v9, s[44:47], s31 offen lds
s_add_u32 m0, s30, 24576
s_add_u32 s31, s32, 1572864
buffer_load_dwordx4 v9, s[44:47], s31 offen lds
s_add_u32 m0, s30, 28672
s_add_u32 s31, s32, 1835008
buffer_load_dwordx4 v9, s[44:47], s31 offen lds
s_add_u32 m0, s30, 32768
s_add_u32 s31, s32, 2097152
buffer_load_dwordx4 v9, s[44:47], s31 offen lds
s_add_u32 m0, s30, 36864
s_add_u32 s31, s32, 2359296
buffer_load_dwordx4 v9, s[44:47], s31 offen lds
s_add_u32 m0, s30, 40960
s_add_u32 s31, s32, 2621440
buffer_load_dwordx4 v9, s[44:47], s31 offen lds
s_add_u32 m0, s30, 45056
s_add_u32 s31, s32, 2883584
buffer_load_dwordx4 v9, s[44:47], s31 offen lds
s_sub_u32 s35, s76, 512
buffer_load_dword v237, v216, s[72:75], s35 offen
s_branch L_p1_tkmQ
L_p1_fbnQ:
s_add_u32 s42, s42, 1
s_cmp_lt_u32 s42, 32
s_cbranch_scc1 L_p1_taskQ
L_p1_goQ:
s_mov_b32 s60, s68
s_mov_b32 s61, s69
s_mov_b32 s62, 0x240000
s_mov_b32 s63, 0x20000
s_mul_i32 s12, s26, 18432
s_add_u32 s13, s12, 18432
s_add_u32 s14, s12, 36864
s_add_u32 s15, s12, 55296
buffer_load_dwordx4 a[0:3], v2, s[60:63], s12 offen sc1
buffer_load_dwordx4 a[72:75], v2, s[60:63], s13 offen sc1
buffer_load_dwordx4 a[144:147], v2, s[60:63], s14 offen sc1
buffer_load_dwordx4 a[216:219], v2, s[60:63], s15 offen sc1
buffer_load_dwordx4 a[4:7], v2, s[60:63], s12 offen offset:1024 sc1
buffer_load_dwordx4 a[76:79], v2, s[60:63], s13 offen offset:1024 sc1
buffer_load_dwordx4 a[148:151], v2, s[60:63], s14 offen offset:1024 sc1
buffer_load_dwordx4 a[220:223], v2, s[60:63], s15 offen offset:1024 sc1
buffer_load_dwordx4 a[8:11], v2, s[60:63], s12 offen offset:2048 sc1
buffer_load_dwordx4 a[80:83], v2, s[60:63], s13 offen offset:2048 sc1
buffer_load_dwordx4 a[152:155], v2, s[60:63], s14 offen offset:2048 sc1
buffer_load_dwordx4 a[224:227], v2, s[60:63], s15 offen offset:2048 sc1
buffer_load_dwordx4 a[12:15], v2, s[60:63], s12 offen offset:3072 sc1
buffer_load_dwordx4 a[84:87], v2, s[60:63], s13 offen offset:3072 sc1
buffer_load_dwordx4 a[156:159], v2, s[60:63], s14 offen offset:3072 sc1
buffer_load_dwordx4 a[228:231], v2, s[60:63], s15 offen offset:3072 sc1
s_add_u32 s12, s12, 4096
s_add_u32 s13, s13, 4096
s_add_u32 s14, s14, 4096
s_add_u32 s15, s15, 4096
buffer_load_dwordx4 a[16:19], v2, s[60:63], s12 offen sc1
buffer_load_dwordx4 a[88:91], v2, s[60:63], s13 offen sc1
buffer_load_dwordx4 a[160:163], v2, s[60:63], s14 offen sc1
buffer_load_dwordx4 a[232:235], v2, s[60:63], s15 offen sc1
buffer_load_dwordx4 a[20:23], v2, s[60:63], s12 offen offset:1024 sc1
buffer_load_dwordx4 a[92:95], v2, s[60:63], s13 offen offset:1024 sc1
buffer_load_dwordx4 a[164:167], v2, s[60:63], s14 offen offset:1024 sc1
buffer_load_dwordx4 a[236:239], v2, s[60:63], s15 offen offset:1024 sc1
buffer_load_dwordx4 a[24:27], v2, s[60:63], s12 offen offset:2048 sc1
buffer_load_dwordx4 a[96:99], v2, s[60:63], s13 offen offset:2048 sc1
buffer_load_dwordx4 a[168:171], v2, s[60:63], s14 offen offset:2048 sc1
buffer_load_dwordx4 a[240:243], v2, s[60:63], s15 offen offset:2048 sc1
buffer_load_dwordx4 a[28:31], v2, s[60:63], s12 offen offset:3072 sc1
buffer_load_dwordx4 a[100:103], v2, s[60:63], s13 offen offset:3072 sc1
buffer_load_dwordx4 a[172:175], v2, s[60:63], s14 offen offset:3072 sc1
buffer_load_dwordx4 a[244:247], v2, s[60:63], s15 offen offset:3072 sc1
s_add_u32 s12, s12, 4096
s_add_u32 s13, s13, 4096
s_add_u32 s14, s14, 4096
s_add_u32 s15, s15, 4096
buffer_load_dwordx4 a[32:35], v2, s[60:63], s12 offen sc1
buffer_load_dwordx4 a[104:107], v2, s[60:63], s13 offen sc1
buffer_load_dwordx4 a[176:179], v2, s[60:63], s14 offen sc1
buffer_load_dwordx4 a[248:251], v2, s[60:63], s15 offen sc1
buffer_load_dwordx4 a[36:39], v2, s[60:63], s12 offen offset:1024 sc1
buffer_load_dwordx4 a[108:111], v2, s[60:63], s13 offen offset:1024 sc1
buffer_load_dwordx4 a[180:183], v2, s[60:63], s14 offen offset:1024 sc1
buffer_load_dwordx4 a[252:255], v2, s[60:63], s15 offen offset:1024 sc1
buffer_load_dwordx4 a[40:43], v2, s[60:63], s12 offen offset:2048 sc1
buffer_load_dwordx4 a[112:115], v2, s[60:63], s13 offen offset:2048 sc1
buffer_load_dwordx4 a[184:187], v2, s[60:63], s14 offen offset:2048 sc1
buffer_load_dwordx4 v[168:171], v2, s[60:63], s15 offen offset:2048 sc1
buffer_load_dwordx4 a[44:47], v2, s[60:63], s12 offen offset:3072 sc1
buffer_load_dwordx4 a[116:119], v2, s[60:63], s13 offen offset:3072 sc1
buffer_load_dwordx4 a[188:191], v2, s[60:63], s14 offen offset:3072 sc1
buffer_load_dwordx4 v[172:175], v2, s[60:63], s15 offen offset:3072 sc1
s_add_u32 s12, s12, 4096
s_add_u32 s13, s13, 4096
s_add_u32 s14, s14, 4096
s_add_u32 s15, s15, 4096
v_add_u32 v200, s27, v3
v_add_u32 v201, s28, v3
v_add_u32 v202, s27, v4
v_add_u32 v203, s28, v4
v_add_u32 v204, s27, v5
v_add_u32 v205, s28, v5
v_add_u32 v206, s27, v6
v_add_u32 v207, s28, v6
s_lshr_b32 s35, s26, 4
s_cmp_eq_u32 s23, 0
s_load_dwordx4 s[88:91], s[0:1], 56
s_cselect_b32 s38, 0, 5308416
s_mul_i32 s35, s35, 663552
s_add_u32 s35, s35, 8960
v_lshrrev_b32 v10, 1, v0
v_and_b32 v11, 1, v0
v_mul_u32_u24 v12, 9216, v10
v_lshl_add_u32 v12, v11, 7, v12
v_mov_b32 v13, 0x7fffffff
v_cmp_gt_u32 vcc, 72, v10
s_nop 1
v_cndmask_b32 v12, v13, v12, vcc
s_waitcnt lgkmcnt(0)
s_mov_b32 s92, s88
s_mov_b32 s93, s89
s_mov_b32 s94, s38
s_mov_b32 s95, 0x20000
buffer_load_dword v233, v12, s[92:95], s35 offen
s_mov_b32 s92, s90
s_mov_b32 s93, s91
s_mov_b32 s94, s38
s_mov_b32 s95, 0x20000
buffer_load_dword v234, v12, s[92:95], s35 offen
s_sub_u32 s35, s76, 256
buffer_load_dword v235, v216, s[72:75], s35 offen
s_waitcnt vmcnt(57)
s_barrier
ds_read_b64_tr_b16 v[116:117], v200
ds_read_b64_tr_b16 v[118:119], v200 offset:2048
ds_read_b64_tr_b16 v[120:121], v202
ds_read_b64_tr_b16 v[122:123], v202 offset:2048
ds_read_b64_tr_b16 v[124:125], v204
ds_read_b64_tr_b16 v[126:127], v204 offset:2048
ds_read_b64_tr_b16 v[128:129], v206
ds_read_b64_tr_b16 v[130:131], v206 offset:2048
ds_read_b64_tr_b16 v[132:133], v200 offset:4096
ds_read_b64_tr_b16 v[134:135], v200 offset:6144
ds_read_b64_tr_b16 v[136:137], v202 offset:4096
ds_read_b64_tr_b16 v[138:139], v202 offset:6144
ds_read_b64_tr_b16 v[140:141], v204 offset:4096
ds_read_b64_tr_b16 v[142:143], v204 offset:6144
s_waitcnt vmcnt(50) lgkmcnt(12)
v_mfma_f32_16x16x32_bf16 v[16:19], v[116:119], a[0:3], 0
s_waitcnt vmcnt(49)
ds_read_b64_tr_b16 v[144:145], v206 offset:4096
v_mfma_f32_16x16x32_bf16 v[20:23], v[116:119], a[72:75], 0
s_waitcnt vmcnt(48)
s_add_u32 m0, s30, 49152
s_add_u32 s31, s32, 3145728
buffer_load_dwordx4 v9, s[44:47], s31 offen lds
v_mfma_f32_16x16x32_bf16 v[24:27], v[116:119], a[144:147], 0
s_waitcnt vmcnt(48)
ds_read_b64_tr_b16 v[146:147], v206 offset:6144
v_mfma_f32_16x16x32_bf16 v[28:31], v[116:119], a[216:219], 0
s_waitcnt lgkmcnt(12)
v_mfma_f32_16x16x32_bf16 v[32:35], v[120:123], a[0:3], 0
ds_read_b64_tr_b16 v[148:149], v200 offset:8192
v_mfma_f32_16x16x32_bf16 v[36:39], v[120:123], a[72:75], 0
s_add_u32 m0, s30, 53248
s_add_u32 s31, s32, 3407872
buffer_load_dwordx4 v9, s[44:47], s31 offen lds
v_mfma_f32_16x16x32_bf16 v[40:43], v[120:123], a[144:147], 0
ds_read_b64_tr_b16 v[150:151], v200 offset:10240
v_mfma_f32_16x16x32_bf16 v[44:47], v[120:123], a[216:219], 0
s_waitcnt lgkmcnt(12)
s_add_u32 m0, s30, 57344
s_add_u32 s31, s32, 3670016
buffer_load_dwordx4 v9, s[44:47], s31 offen lds
v_mfma_f32_16x16x32_bf16 v[48:51], v[124:127], a[0:3], 0
ds_read_b64_tr_b16 v[116:117], v202 offset:8192
v_mfma_f32_16x16x32_bf16 v[52:55], v[124:127], a[72:75], 0
v_mfma_f32_16x16x32_bf16 v[56:59], v[124:127], a[144:147], 0
ds_read_b64_tr_b16 v[118:119], v202 offset:10240
v_mfma_f32_16x16x32_bf16 v[60:63], v[124:127], a[216:219], 0
s_waitcnt lgkmcnt(12)
s_add_u32 m0, s30, 61440
s_add_u32 s31, s32, 3932160
buffer_load_dwordx4 v9, s[44:47], s31 offen lds
v_mfma_f32_16x16x32_bf16 v[64:67], v[128:131], a[0:3], 0
ds_read_b64_tr_b16 v[120:121], v204 offset:8192
v_mfma_f32_16x16x32_bf16 v[68:71], v[128:131], a[72:75], 0
s_add_u32 m0, s30, 65536
s_add_u32 s31, s32, 4194304
buffer_load_dwordx4 v9, s[44:47], s31 offen lds
v_mfma_f32_16x16x32_bf16 v[72:75], v[128:131], a[144:147], 0
ds_read_b64_tr_b16 v[122:123], v204 offset:10240
v_mfma_f32_16x16x32_bf16 v[76:79], v[128:131], a[216:219], 0
s_waitcnt vmcnt(51) lgkmcnt(12)
v_mfma_f32_16x16x32_bf16 v[16:19], v[132:135], a[4:7], v[16:19]
s_waitcnt vmcnt(50)
ds_read_b64_tr_b16 v[124:125], v206 offset:8192
v_mfma_f32_16x16x32_bf16 v[20:23], v[132:135], a[76:79], v[20:23]
s_waitcnt vmcnt(49)
s_add_u32 m0, s30, 69632
s_add_u32 s31, s32, 4456448
buffer_load_dwordx4 v9, s[44:47], s31 offen lds
v_mfma_f32_16x16x32_bf16 v[24:27], v[132:135], a[148:151], v[24:27]
s_waitcnt vmcnt(49)
ds_read_b64_tr_b16 v[126:127], v206 offset:10240
v_mfma_f32_16x16x32_bf16 v[28:31], v[132:135], a[220:223], v[28:31]
s_waitcnt lgkmcnt(12)
v_mfma_f32_16x16x32_bf16 v[32:35], v[136:139], a[4:7], v[32:35]
ds_read_b64_tr_b16 v[128:129], v200 offset:12288
v_mfma_f32_16x16x32_bf16 v[36:39], v[136:139], a[76:79], v[36:39]
buffer_load_dwordx4 a[48:51], v2, s[60:63], s12 offen sc1
v_mfma_f32_16x16x32_bf16 v[40:43], v[136:139], a[148:151], v[40:43]
ds_read_b64_tr_b16 v[130:131], v200 offset:14336
v_mfma_f32_16x16x32_bf16 v[44:47], v[136:139], a[220:223], v[44:47]
s_waitcnt lgkmcnt(12)
buffer_load_dwordx4 a[120:123], v2, s[60:63], s13 offen sc1
v_mfma_f32_16x16x32_bf16 v[48:51], v[140:143], a[4:7], v[48:51]
ds_read_b64_tr_b16 v[132:133], v202 offset:12288
v_mfma_f32_16x16x32_bf16 v[52:55], v[140:143], a[76:79], v[52:55]
v_mfma_f32_16x16x32_bf16 v[56:59], v[140:143], a[148:151], v[56:59]
ds_read_b64_tr_b16 v[134:135], v202 offset:14336
v_mfma_f32_16x16x32_bf16 v[60:63], v[140:143], a[220:223], v[60:63]
s_waitcnt lgkmcnt(12)
buffer_load_dwordx4 a[192:195], v2, s[60:63], s14 offen sc1
v_mfma_f32_16x16x32_bf16 v[64:67], v[144:147], a[4:7], v[64:67]
ds_read_b64_tr_b16 v[136:137], v204 offset:12288
v_mfma_f32_16x16x32_bf16 v[68:71], v[144:147], a[76:79], v[68:71]
buffer_load_dwordx4 v[176:179], v2, s[60:63], s15 offen sc1
v_mfma_f32_16x16x32_bf16 v[72:75], v[144:147], a[148:151], v[72:75]
ds_read_b64_tr_b16 v[138:139], v204 offset:14336
v_mfma_f32_16x16x32_bf16 v[76:79], v[144:147], a[220:223], v[76:79]
s_waitcnt vmcnt(52) lgkmcnt(12)
v_mfma_f32_16x16x32_bf16 v[16:19], v[148:151], a[8:11], v[16:19]
s_waitcnt vmcnt(51)
ds_read_b64_tr_b16 v[140:141], v206 offset:12288
v_mfma_f32_16x16x32_bf16 v[20:23], v[148:151], a[80:83], v[20:23]
s_waitcnt vmcnt(50)
buffer_load_dwordx4 a[52:55], v2, s[60:63], s12 offen offset:1024 sc1
v_mfma_f32_16x16x32_bf16 v[24:27], v[148:151], a[152:155], v[24:27]
s_waitcnt vmcnt(50)
ds_read_b64_tr_b16 v[142:143], v206 offset:14336
v_mfma_f32_16x16x32_bf16 v[28:31], v[148:151], a[224:227], v[28:31]
s_waitcnt lgkmcnt(12)
buffer_load_dwordx4 a[124:127], v2, s[60:63], s13 offen offset:1024 sc1
v_mfma_f32_16x16x32_bf16 v[32:35], v[116:119], a[8:11], v[32:35]
ds_read_b64_tr_b16 v[144:145], v200 offset:16384
v_mfma_f32_16x16x32_bf16 v[36:39], v[116:119], a[80:83], v[36:39]
v_mfma_f32_16x16x32_bf16 v[40:43], v[116:119], a[152:155], v[40:43]
ds_read_b64_tr_b16 v[146:147], v200 offset:18432
v_mfma_f32_16x16x32_bf16 v[44:47], v[116:119], a[224:227], v[44:47]
s_waitcnt lgkmcnt(12)
buffer_load_dwordx4 a[196:199], v2, s[60:63], s14 offen offset:1024 sc1
v_mfma_f32_16x16x32_bf16 v[48:51], v[120:123], a[8:11], v[48:51]
ds_read_b64_tr_b16 v[148:149], v202 offset:16384
v_mfma_f32_16x16x32_bf16 v[52:55], v[120:123], a[80:83], v[52:55]
v_mfma_f32_16x16x32_bf16 v[56:59], v[120:123], a[152:155], v[56:59]
ds_read_b64_tr_b16 v[150:151], v202 offset:18432
v_mfma_f32_16x16x32_bf16 v[60:63], v[120:123], a[224:227], v[60:63]
s_waitcnt lgkmcnt(12)
buffer_load_dwordx4 v[180:183], v2, s[60:63], s15 offen offset:1024 sc1
v_mfma_f32_16x16x32_bf16 v[64:67], v[124:127], a[8:11], v[64:67]
ds_read_b64_tr_b16 v[116:117], v204 offset:16384
v_mfma_f32_16x16x32_bf16 v[68:71], v[124:127], a[80:83], v[68:71]
buffer_load_dwordx4 a[56:59], v2, s[60:63], s12 offen offset:2048 sc1
v_mfma_f32_16x16x32_bf16 v[72:75], v[124:127], a[152:155], v[72:75]
ds_read_b64_tr_b16 v[118:119], v204 offset:18432
v_mfma_f32_16x16x32_bf16 v[76:79], v[124:127], a[224:227], v[76:79]
s_waitcnt vmcnt(53) lgkmcnt(12)
v_mfma_f32_16x16x32_bf16 v[16:19], v[128:131], a[12:15], v[16:19]
s_waitcnt vmcnt(52)
ds_read_b64_tr_b16 v[120:121], v206 offset:16384
v_mfma_f32_16x16x32_bf16 v[20:23], v[128:131], a[84:87], v[20:23]
s_waitcnt vmcnt(51)
buffer_load_dwordx4 a[128:131], v2, s[60:63], s13 offen offset:2048 sc1
v_mfma_f32_16x16x32_bf16 v[24:27], v[128:131], a[156:159], v[24:27]
s_waitcnt vmcnt(51)
ds_read_b64_tr_b16 v[122:123], v206 offset:18432
v_mfma_f32_16x16x32_bf16 v[28:31], v[128:131], a[228:231], v[28:31]
s_waitcnt lgkmcnt(12)
buffer_load_dwordx4 a[200:203], v2, s[60:63], s14 offen offset:2048 sc1
v_mfma_f32_16x16x32_bf16 v[32:35], v[132:135], a[12:15], v[32:35]
ds_read_b64_tr_b16 v[124:125], v200 offset:20480
v_mfma_f32_16x16x32_bf16 v[36:39], v[132:135], a[84:87], v[36:39]
v_mfma_f32_16x16x32_bf16 v[40:43], v[132:135], a[156:159], v[40:43]
ds_read_b64_tr_b16 v[126:127], v200 offset:22528
v_mfma_f32_16x16x32_bf16 v[44:47], v[132:135], a[228:231], v[44:47]
s_waitcnt lgkmcnt(12)
buffer_load_dwordx4 v[184:187], v2, s[60:63], s15 offen offset:2048 sc1
v_mfma_f32_16x16x32_bf16 v[48:51], v[136:139], a[12:15], v[48:51]
ds_read_b64_tr_b16 v[128:129], v202 offset:20480
v_mfma_f32_16x16x32_bf16 v[52:55], v[136:139], a[84:87], v[52:55]
v_mfma_f32_16x16x32_bf16 v[56:59], v[136:139], a[156:159], v[56:59]
ds_read_b64_tr_b16 v[130:131], v202 offset:22528
v_mfma_f32_16x16x32_bf16 v[60:63], v[136:139], a[228:231], v[60:63]
s_waitcnt lgkmcnt(12)
buffer_load_dwordx4 a[60:63], v2, s[60:63], s12 offen offset:3072 sc1
v_mfma_f32_16x16x32_bf16 v[64:67], v[140:143], a[12:15], v[64:67]
ds_read_b64_tr_b16 v[132:133], v204 offset:20480
v_mfma_f32_16x16x32_bf16 v[68:71], v[140:143], a[84:87], v[68:71]
buffer_load_dwordx4 a[132:135], v2, s[60:63], s13 offen offset:3072 sc1
v_mfma_f32_16x16x32_bf16 v[72:75], v[140:143], a[156:159], v[72:75]
ds_read_b64_tr_b16 v[134:135], v204 offset:22528
v_mfma_f32_16x16x32_bf16 v[76:79], v[140:143], a[228:231], v[76:79]
s_waitcnt vmcnt(54) lgkmcnt(12)
v_mfma_f32_16x16x32_bf16 v[16:19], v[144:147], a[16:19], v[16:19]
s_waitcnt vmcnt(53)
ds_read_b64_tr_b16 v[136:137], v206 offset:20480
v_mfma_f32_16x16x32_bf16 v[20:23], v[144:147], a[88:91], v[20:23]
s_waitcnt vmcnt(52)
buffer_load_dwordx4 a[204:207], v2, s[60:63], s14 offen offset:3072 sc1
v_mfma_f32_16x16x32_bf16 v[24:27], v[144:147], a[160:163], v[24:27]
s_waitcnt vmcnt(52)
ds_read_b64_tr_b16 v[138:139], v206 offset:22528
v_mfma_f32_16x16x32_bf16 v[28:31], v[144:147], a[232:235], v[28:31]
s_barrier
buffer_load_dwordx4 v[188:191], v2, s[60:63], s15 offen offset:3072 sc1
s_waitcnt lgkmcnt(12)
v_mfma_f32_16x16x32_bf16 v[32:35], v[148:151], a[16:19], v[32:35]
s_add_u32 s12, s12, 4096
s_add_u32 s13, s13, 4096
s_add_u32 s14, s14, 4096
s_add_u32 s15, s15, 4096
ds_read_b64_tr_b16 v[140:141], v200 offset:24576
v_mfma_f32_16x16x32_bf16 v[36:39], v[148:151], a[88:91], v[36:39]
v_mfma_f32_16x16x32_bf16 v[40:43], v[148:151], a[160:163], v[40:43]
ds_read_b64_tr_b16 v[142:143], v200 offset:26624
v_mfma_f32_16x16x32_bf16 v[44:47], v[148:151], a[232:235], v[44:47]
s_waitcnt lgkmcnt(12)
buffer_load_dwordx4 a[64:67], v2, s[60:63], s12 offen sc1
v_mfma_f32_16x16x32_bf16 v[48:51], v[116:119], a[16:19], v[48:51]
ds_read_b64_tr_b16 v[144:145], v202 offset:24576
v_mfma_f32_16x16x32_bf16 v[52:55], v[116:119], a[88:91], v[52:55]
buffer_load_dwordx4 a[136:139], v2, s[60:63], s13 offen sc1
v_mfma_f32_16x16x32_bf16 v[56:59], v[116:119], a[160:163], v[56:59]
ds_read_b64_tr_b16 v[146:147], v202 offset:26624
v_mfma_f32_16x16x32_bf16 v[60:63], v[116:119], a[232:235], v[60:63]
s_waitcnt lgkmcnt(12)
v_mfma_f32_16x16x32_bf16 v[64:67], v[120:123], a[16:19], v[64:67]
ds_read_b64_tr_b16 v[148:149], v204 offset:24576
v_mfma_f32_16x16x32_bf16 v[68:71], v[120:123], a[88:91], v[68:71]
buffer_load_dwordx4 a[208:211], v2, s[60:63], s14 offen sc1
v_mfma_f32_16x16x32_bf16 v[72:75], v[120:123], a[160:163], v[72:75]
ds_read_b64_tr_b16 v[150:151], v204 offset:26624
v_mfma_f32_16x16x32_bf16 v[76:79], v[120:123], a[232:235], v[76:79]
s_waitcnt vmcnt(55) lgkmcnt(12)
v_mfma_f32_16x16x32_bf16 v[16:19], v[124:127], a[20:23], v[16:19]
s_waitcnt vmcnt(54)
ds_read_b64_tr_b16 v[116:117], v206 offset:24576
v_mfma_f32_16x16x32_bf16 v[20:23], v[124:127], a[92:95], v[20:23]
s_waitcnt vmcnt(53)
buffer_load_dwordx4 v[192:195], v2, s[60:63], s15 offen sc1
v_mfma_f32_16x16x32_bf16 v[24:27], v[124:127], a[164:167], v[24:27]
s_waitcnt vmcnt(53)
ds_read_b64_tr_b16 v[118:119], v206 offset:26624
v_mfma_f32_16x16x32_bf16 v[28:31], v[124:127], a[236:239], v[28:31]
s_waitcnt lgkmcnt(12)
buffer_load_dwordx4 a[68:71], v2, s[60:63], s12 offen offset:1024 sc1
v_mfma_f32_16x16x32_bf16 v[32:35], v[128:131], a[20:23], v[32:35]
ds_read_b64_tr_b16 v[120:121], v200 offset:28672
v_mfma_f32_16x16x32_bf16 v[36:39], v[128:131], a[92:95], v[36:39]
v_mfma_f32_16x16x32_bf16 v[40:43], v[128:131], a[164:167], v[40:43]
ds_read_b64_tr_b16 v[122:123], v200 offset:30720
v_mfma_f32_16x16x32_bf16 v[44:47], v[128:131], a[236:239], v[44:47]
s_waitcnt lgkmcnt(12)
buffer_load_dwordx4 a[140:143], v2, s[60:63], s13 offen offset:1024 sc1
v_mfma_f32_16x16x32_bf16 v[48:51], v[132:135], a[20:23], v[48:51]
ds_read_b64_tr_b16 v[124:125], v202 offset:28672
v_mfma_f32_16x16x32_bf16 v[52:55], v[132:135], a[92:95], v[52:55]
buffer_load_dwordx4 a[212:215], v2, s[60:63], s14 offen offset:1024 sc1
v_mfma_f32_16x16x32_bf16 v[56:59], v[132:135], a[164:167], v[56:59]
ds_read_b64_tr_b16 v[126:127], v202 offset:30720
v_mfma_f32_16x16x32_bf16 v[60:63], v[132:135], a[236:239], v[60:63]
s_waitcnt lgkmcnt(12)
v_mfma_f32_16x16x32_bf16 v[64:67], v[136:139], a[20:23], v[64:67]
ds_read_b64_tr_b16 v[128:129], v204 offset:28672
v_mfma_f32_16x16x32_bf16 v[68:71], v[136:139], a[92:95], v[68:71]
buffer_load_dwordx4 v[196:199], v2, s[60:63], s15 offen offset:1024 sc1
v_mfma_f32_16x16x32_bf16 v[72:75], v[136:139], a[164:167], v[72:75]
ds_read_b64_tr_b16 v[130:131], v204 offset:30720
v_mfma_f32_16x16x32_bf16 v[76:79], v[136:139], a[236:239], v[76:79]
s_waitcnt vmcnt(56) lgkmcnt(12)
v_mfma_f32_16x16x32_bf16 v[16:19], v[140:143], a[24:27], v[16:19]
s_waitcnt vmcnt(55)
ds_read_b64_tr_b16 v[132:133], v206 offset:28672
v_mfma_f32_16x16x32_bf16 v[20:23], v[140:143], a[96:99], v[20:23]
s_waitcnt vmcnt(54)
v_mfma_f32_16x16x32_bf16 v[24:27], v[140:143], a[168:171], v[24:27]
s_waitcnt vmcnt(53)
ds_read_b64_tr_b16 v[134:135], v206 offset:30720
v_mfma_f32_16x16x32_bf16 v[28:31], v[140:143], a[240:243], v[28:31]
s_waitcnt lgkmcnt(12)
v_mfma_f32_16x16x32_bf16 v[32:35], v[144:147], a[24:27], v[32:35]
ds_read_b64_tr_b16 v[136:137], v200 offset:32768
v_mfma_f32_16x16x32_bf16 v[36:39], v[144:147], a[96:99], v[36:39]
v_mfma_f32_16x16x32_bf16 v[40:43], v[144:147], a[168:171], v[40:43]
ds_read_b64_tr_b16 v[138:139], v200 offset:34816
v_mfma_f32_16x16x32_bf16 v[44:47], v[144:147], a[240:243], v[44:47]
s_waitcnt lgkmcnt(12)
s_add_u32 s32, s32, 128
s_xor_b32 s30, s30, 73728
v_mfma_f32_16x16x32_bf16 v[48:51], v[148:151], a[24:27], v[48:51]
s_cmp_eq_u32 s22, 1
s_cselect_b32 s46, 0, s46
ds_read_b64_tr_b16 v[140:141], v202 offset:32768
v_mfma_f32_16x16x32_bf16 v[52:55], v[148:151], a[96:99], v[52:55]
s_mov_b32 m0, s30
s_mov_b32 s31, s32
buffer_load_dwordx4 v9, s[44:47], s31 offen lds
v_mfma_f32_16x16x32_bf16 v[56:59], v[148:151], a[168:171], v[56:59]
ds_read_b64_tr_b16 v[142:143], v202 offset:34816
v_mfma_f32_16x16x32_bf16 v[60:63], v[148:151], a[240:243], v[60:63]
s_waitcnt lgkmcnt(12)
v_mfma_f32_16x16x32_bf16 v[64:67], v[116:119], a[24:27], v[64:67]
ds_read_b64_tr_b16 v[144:145], v204 offset:32768
v_mfma_f32_16x16x32_bf16 v[68:71], v[116:119], a[96:99], v[68:71]
s_add_u32 m0, m0, 4096
s_add_u32 s31, s31, 262144
buffer_load_dwordx4 v9, s[44:47], s31 offen lds
v_mfma_f32_16x16x32_bf16 v[72:75], v[116:119], a[168:171], v[72:75]
ds_read_b64_tr_b16 v[146:147], v204 offset:34816
v_mfma_f32_16x16x32_bf16 v[76:79], v[116:119], a[240:243], v[76:79]
s_waitcnt vmcnt(54) lgkmcnt(12)
v_mfma_f32_16x16x32_bf16 v[16:19], v[120:123], a[28:31], v[16:19]
s_waitcnt vmcnt(53)
ds_read_b64_tr_b16 v[148:149], v206 offset:32768
v_mfma_f32_16x16x32_bf16 v[20:23], v[120:123], a[100:103], v[20:23]
s_waitcnt vmcnt(52)
v_mfma_f32_16x16x32_bf16 v[24:27], v[120:123], a[172:175], v[24:27]
s_waitcnt vmcnt(51)
ds_read_b64_tr_b16 v[150:151], v206 offset:34816
v_mfma_f32_16x16x32_bf16 v[28:31], v[120:123], a[244:247], v[28:31]
s_waitcnt lgkmcnt(12)
s_add_u32 m0, m0, 4096
s_add_u32 s31, s31, 262144
buffer_load_dwordx4 v9, s[44:47], s31 offen lds
v_mfma_f32_16x16x32_bf16 v[32:35], v[124:127], a[28:31], v[32:35]
ds_read_b64_tr_b16 v[116:117], v201
v_mfma_f32_16x16x32_bf16 v[36:39], v[124:127], a[100:103], v[36:39]
v_mfma_f32_16x16x32_bf16 v[40:43], v[124:127], a[172:175], v[40:43]
ds_read_b64_tr_b16 v[118:119], v201 offset:2048
v_mfma_f32_16x16x32_bf16 v[44:47], v[124:127], a[244:247], v[44:47]
s_waitcnt lgkmcnt(12)
v_mfma_f32_16x16x32_bf16 v[48:51], v[128:131], a[28:31], v[48:51]
ds_read_b64_tr_b16 v[120:121], v203
v_mfma_f32_16x16x32_bf16 v[52:55], v[128:131], a[100:103], v[52:55]
s_add_u32 m0, m0, 4096
s_add_u32 s31, s31, 262144
buffer_load_dwordx4 v9, s[44:47], s31 offen lds
v_mfma_f32_16x16x32_bf16 v[56:59], v[128:131], a[172:175], v[56:59]
ds_read_b64_tr_b16 v[122:123], v203 offset:2048
v_mfma_f32_16x16x32_bf16 v[60:63], v[128:131], a[244:247], v[60:63]
s_waitcnt lgkmcnt(12)
v_mfma_f32_16x16x32_bf16 v[64:67], v[132:135], a[28:31], v[64:67]
ds_read_b64_tr_b16 v[124:125], v205
v_mfma_f32_16x16x32_bf16 v[68:71], v[132:135], a[100:103], v[68:71]
s_add_u32 m0, m0, 4096
s_add_u32 s31, s31, 262144
buffer_load_dwordx4 v9, s[44:47], s31 offen lds
v_mfma_f32_16x16x32_bf16 v[72:75], v[132:135], a[172:175], v[72:75]
ds_read_b64_tr_b16 v[126:127], v205 offset:2048
v_mfma_f32_16x16x32_bf16 v[76:79], v[132:135], a[244:247], v[76:79]
s_waitcnt vmcnt(53) lgkmcnt(12)
v_mfma_f32_16x16x32_bf16 v[16:19], v[136:139], a[32:35], v[16:19]
s_waitcnt vmcnt(52)
ds_read_b64_tr_b16 v[128:129], v207
v_mfma_f32_16x16x32_bf16 v[20:23], v[136:139], a[104:107], v[20:23]
s_waitcnt vmcnt(51)
v_mfma_f32_16x16x32_bf16 v[24:27], v[136:139], a[176:179], v[24:27]
s_waitcnt vmcnt(50)
ds_read_b64_tr_b16 v[130:131], v207 offset:2048
v_mfma_f32_16x16x32_bf16 v[28:31], v[136:139], a[248:251], v[28:31]
s_waitcnt lgkmcnt(12)
s_add_u32 m0, m0, 4096
s_add_u32 s31, s31, 262144
buffer_load_dwordx4 v9, s[44:47], s31 offen lds
v_mfma_f32_16x16x32_bf16 v[32:35], v[140:143], a[32:35], v[32:35]
ds_read_b64_tr_b16 v[132:133], v201 offset:4096
v_mfma_f32_16x16x32_bf16 v[36:39], v[140:143], a[104:107], v[36:39]
v_mfma_f32_16x16x32_bf16 v[40:43], v[140:143], a[176:179], v[40:43]
ds_read_b64_tr_b16 v[134:135], v201 offset:6144
v_mfma_f32_16x16x32_bf16 v[44:47], v[140:143], a[248:251], v[44:47]
s_waitcnt lgkmcnt(12)
v_mfma_f32_16x16x32_bf16 v[48:51], v[144:147], a[32:35], v[48:51]
ds_read_b64_tr_b16 v[136:137], v203 offset:4096
v_mfma_f32_16x16x32_bf16 v[52:55], v[144:147], a[104:107], v[52:55]
s_add_u32 m0, m0, 4096
s_add_u32 s31, s31, 262144
buffer_load_dwordx4 v9, s[44:47], s31 offen lds
v_mfma_f32_16x16x32_bf16 v[56:59], v[144:147], a[176:179], v[56:59]
ds_read_b64_tr_b16 v[138:139], v203 offset:6144
v_mfma_f32_16x16x32_bf16 v[60:63], v[144:147], a[248:251], v[60:63]
s_waitcnt lgkmcnt(12)
v_mfma_f32_16x16x32_bf16 v[64:67], v[148:151], a[32:35], v[64:67]
ds_read_b64_tr_b16 v[140:141], v205 offset:4096
v_mfma_f32_16x16x32_bf16 v[68:71], v[148:151], a[104:107], v[68:71]
v_mfma_f32_16x16x32_bf16 v[72:75], v[148:151], a[176:179], v[72:75]
ds_read_b64_tr_b16 v[142:143], v205 offset:6144
v_mfma_f32_16x16x32_bf16 v[76:79], v[148:151], a[248:251], v[76:79]
s_waitcnt vmcnt(51) lgkmcnt(12)
s_add_u32 m0, m0, 4096
s_add_u32 s31, s31, 262144
buffer_load_dwordx4 v9, s[44:47], s31 offen lds
v_mfma_f32_16x16x32_bf16 v[16:19], v[116:119], a[36:39], v[16:19]
s_waitcnt vmcnt(51)
ds_read_b64_tr_b16 v[144:145], v207 offset:4096
v_mfma_f32_16x16x32_bf16 v[20:23], v[116:119], a[108:111], v[20:23]
s_waitcnt vmcnt(50)
v_mfma_f32_16x16x32_bf16 v[24:27], v[116:119], a[180:183], v[24:27]
s_waitcnt vmcnt(49)
ds_read_b64_tr_b16 v[146:147], v207 offset:6144
v_mfma_f32_16x16x32_bf16 v[28:31], v[116:119], a[252:255], v[28:31]
s_waitcnt lgkmcnt(12)
v_mfma_f32_16x16x32_bf16 v[32:35], v[120:123], a[36:39], v[32:35]
ds_read_b64_tr_b16 v[148:149], v201 offset:8192
v_mfma_f32_16x16x32_bf16 v[36:39], v[120:123], a[108:111], v[36:39]
s_add_u32 m0, m0, 4096
s_add_u32 s31, s31, 262144
buffer_load_dwordx4 v9, s[44:47], s31 offen lds
v_mfma_f32_16x16x32_bf16 v[40:43], v[120:123], a[180:183], v[40:43]
ds_read_b64_tr_b16 v[150:151], v201 offset:10240
v_mfma_f32_16x16x32_bf16 v[44:47], v[120:123], a[252:255], v[44:47]
s_waitcnt lgkmcnt(12)
v_mfma_f32_16x16x32_bf16 v[48:51], v[124:127], a[36:39], v[48:51]
ds_read_b64_tr_b16 v[116:117], v203 offset:8192
v_mfma_f32_16x16x32_bf16 v[52:55], v[124:127], a[108:111], v[52:55]
v_mfma_f32_16x16x32_bf16 v[56:59], v[124:127], a[180:183], v[56:59]
ds_read_b64_tr_b16 v[118:119], v203 offset:10240
v_mfma_f32_16x16x32_bf16 v[60:63], v[124:127], a[252:255], v[60:63]
s_waitcnt lgkmcnt(12)
s_add_u32 m0, m0, 4096
s_add_u32 s31, s31, 262144
buffer_load_dwordx4 v9, s[44:47], s31 offen lds
v_mfma_f32_16x16x32_bf16 v[64:67], v[128:131], a[36:39], v[64:67]
ds_read_b64_tr_b16 v[120:121], v205 offset:8192
v_mfma_f32_16x16x32_bf16 v[68:71], v[128:131], a[108:111], v[68:71]
v_mfma_f32_16x16x32_bf16 v[72:75], v[128:131], a[180:183], v[72:75]
ds_read_b64_tr_b16 v[122:123], v205 offset:10240
v_mfma_f32_16x16x32_bf16 v[76:79], v[128:131], a[252:255], v[76:79]
s_waitcnt vmcnt(50) lgkmcnt(12)
s_add_u32 m0, m0, 4096
s_add_u32 s31, s31, 262144
buffer_load_dwordx4 v9, s[44:47], s31 offen lds
v_mfma_f32_16x16x32_bf16 v[16:19], v[132:135], a[40:43], v[16:19]
s_waitcnt vmcnt(50)
ds_read_b64_tr_b16 v[124:125], v207 offset:8192
v_mfma_f32_16x16x32_bf16 v[20:23], v[132:135], a[112:115], v[20:23]
s_waitcnt vmcnt(49)
v_mfma_f32_16x16x32_bf16 v[24:27], v[132:135], a[184:187], v[24:27]
s_waitcnt vmcnt(48)
ds_read_b64_tr_b16 v[126:127], v207 offset:10240
v_mfma_f32_16x16x32_bf16 v[28:31], v[132:135], v[168:171], v[28:31]
s_waitcnt vmcnt(35)
s_barrier
s_waitcnt lgkmcnt(12)
v_mfma_f32_16x16x32_bf16 v[32:35], v[136:139], a[40:43], v[32:35]
ds_read_b64_tr_b16 v[128:129], v201 offset:12288
v_mfma_f32_16x16x32_bf16 v[36:39], v[136:139], a[112:115], v[36:39]
s_add_u32 m0, m0, 4096
s_add_u32 s31, s31, 262144
buffer_load_dwordx4 v9, s[44:47], s31 offen lds
v_mfma_f32_16x16x32_bf16 v[40:43], v[136:139], a[184:187], v[40:43]
ds_read_b64_tr_b16 v[130:131], v201 offset:14336
v_mfma_f32_16x16x32_bf16 v[44:47], v[136:139], v[168:171], v[44:47]
s_waitcnt lgkmcnt(12)
v_mfma_f32_16x16x32_bf16 v[48:51], v[140:143], a[40:43], v[48:51]
ds_read_b64_tr_b16 v[132:133], v203 offset:12288
v_mfma_f32_16x16x32_bf16 v[52:55], v[140:143], a[112:115], v[52:55]
v_mfma_f32_16x16x32_bf16 v[56:59], v[140:143], a[184:187], v[56:59]
ds_read_b64_tr_b16 v[134:135], v203 offset:14336
v_mfma_f32_16x16x32_bf16 v[60:63], v[140:143], v[168:171], v[60:63]
s_waitcnt lgkmcnt(12)
s_add_u32 m0, m0, 4096
s_add_u32 s31, s31, 262144
buffer_load_dwordx4 v9, s[44:47], s31 offen lds
v_mfma_f32_16x16x32_bf16 v[64:67], v[144:147], a[40:43], v[64:67]
ds_read_b64_tr_b16 v[136:137], v205 offset:12288
v_mfma_f32_16x16x32_bf16 v[68:71], v[144:147], a[112:115], v[68:71]
v_mfma_f32_16x16x32_bf16 v[72:75], v[144:147], a[184:187], v[72:75]
ds_read_b64_tr_b16 v[138:139], v205 offset:14336
v_mfma_f32_16x16x32_bf16 v[76:79], v[144:147], v[168:171], v[76:79]
s_waitcnt lgkmcnt(12)
v_mfma_f32_16x16x32_bf16 v[16:19], v[148:151], a[44:47], v[16:19]
ds_read_b64_tr_b16 v[140:141], v207 offset:12288
v_mfma_f32_16x16x32_bf16 v[20:23], v[148:151], a[116:119], v[20:23]
s_add_u32 m0, m0, 4096
s_add_u32 s31, s31, 262144
buffer_load_dwordx4 v9, s[44:47], s31 offen lds
v_mfma_f32_16x16x32_bf16 v[24:27], v[148:151], a[188:191], v[24:27]
ds_read_b64_tr_b16 v[142:143], v207 offset:14336
v_mfma_f32_16x16x32_bf16 v[28:31], v[148:151], v[172:175], v[28:31]
s_waitcnt lgkmcnt(12)
v_mfma_f32_16x16x32_bf16 v[32:35], v[116:119], a[44:47], v[32:35]
ds_read_b64_tr_b16 v[144:145], v201 offset:16384
v_mfma_f32_16x16x32_bf16 v[36:39], v[116:119], a[116:119], v[36:39]
v_mfma_f32_16x16x32_bf16 v[40:43], v[116:119], a[188:191], v[40:43]
ds_read_b64_tr_b16 v[146:147], v201 offset:18432
v_mfma_f32_16x16x32_bf16 v[44:47], v[116:119], v[172:175], v[44:47]
s_waitcnt lgkmcnt(12)
s_add_u32 m0, m0, 4096
s_add_u32 s31, s31, 262144
buffer_load_dwordx4 v9, s[44:47], s31 offen lds
v_mfma_f32_16x16x32_bf16 v[48:51], v[120:123], a[44:47], v[48:51]
ds_read_b64_tr_b16 v[148:149], v203 offset:16384
v_mfma_f32_16x16x32_bf16 v[52:55], v[120:123], a[116:119], v[52:55]
v_mfma_f32_16x16x32_bf16 v[56:59], v[120:123], a[188:191], v[56:59]
ds_read_b64_tr_b16 v[150:151], v203 offset:18432
v_mfma_f32_16x16x32_bf16 v[60:63], v[120:123], v[172:175], v[60:63]
s_waitcnt lgkmcnt(12)
v_mfma_f32_16x16x32_bf16 v[64:67], v[124:127], a[44:47], v[64:67]
ds_read_b64_tr_b16 v[116:117], v205 offset:16384
v_mfma_f32_16x16x32_bf16 v[68:71], v[124:127], a[116:119], v[68:71]
s_add_u32 m0, m0, 4096
s_add_u32 s31, s31, 262144
buffer_load_dwordx4 v9, s[44:47], s31 offen lds
v_mfma_f32_16x16x32_bf16 v[72:75], v[124:127], a[188:191], v[72:75]
ds_read_b64_tr_b16 v[118:119], v205 offset:18432
v_mfma_f32_16x16x32_bf16 v[76:79], v[124:127], v[172:175], v[76:79]
s_waitcnt vmcnt(39) lgkmcnt(12)
v_mfma_f32_16x16x32_bf16 v[16:19], v[128:131], a[48:51], v[16:19]
s_waitcnt vmcnt(38)
ds_read_b64_tr_b16 v[120:121], v207 offset:16384
v_mfma_f32_16x16x32_bf16 v[20:23], v[128:131], a[120:123], v[20:23]
s_waitcnt vmcnt(37)
s_add_u32 m0, m0, 4096
s_add_u32 s31, s31, 262144
buffer_load_dwordx4 v9, s[44:47], s31 offen lds
v_mfma_f32_16x16x32_bf16 v[24:27], v[128:131], a[192:195], v[24:27]
s_waitcnt vmcnt(37)
ds_read_b64_tr_b16 v[122:123], v207 offset:18432
v_mfma_f32_16x16x32_bf16 v[28:31], v[128:131], v[176:179], v[28:31]
s_waitcnt lgkmcnt(12)
v_mfma_f32_16x16x32_bf16 v[32:35], v[132:135], a[48:51], v[32:35]
ds_read_b64_tr_b16 v[124:125], v201 offset:20480
v_mfma_f32_16x16x32_bf16 v[36:39], v[132:135], a[120:123], v[36:39]
v_mfma_f32_16x16x32_bf16 v[40:43], v[132:135], a[192:195], v[40:43]
ds_read_b64_tr_b16 v[126:127], v201 offset:22528
v_mfma_f32_16x16x32_bf16 v[44:47], v[132:135], v[176:179], v[44:47]
s_waitcnt lgkmcnt(12)
s_add_u32 m0, m0, 4096
s_add_u32 s31, s31, 262144
buffer_load_dwordx4 v9, s[44:47], s31 offen lds
v_mfma_f32_16x16x32_bf16 v[48:51], v[136:139], a[48:51], v[48:51]
ds_read_b64_tr_b16 v[128:129], v203 offset:20480
v_mfma_f32_16x16x32_bf16 v[52:55], v[136:139], a[120:123], v[52:55]
v_mfma_f32_16x16x32_bf16 v[56:59], v[136:139], a[192:195], v[56:59]
ds_read_b64_tr_b16 v[130:131], v203 offset:22528
v_mfma_f32_16x16x32_bf16 v[60:63], v[136:139], v[176:179], v[60:63]
s_waitcnt lgkmcnt(12)
v_mfma_f32_16x16x32_bf16 v[64:67], v[140:143], a[48:51], v[64:67]
ds_read_b64_tr_b16 v[132:133], v205 offset:20480
v_mfma_f32_16x16x32_bf16 v[68:71], v[140:143], a[120:123], v[68:71]
v_mfma_f32_16x16x32_bf16 v[72:75], v[140:143], a[192:195], v[72:75]
ds_read_b64_tr_b16 v[134:135], v205 offset:22528
v_mfma_f32_16x16x32_bf16 v[76:79], v[140:143], v[176:179], v[76:79]
s_waitcnt vmcnt(37) lgkmcnt(12)
v_mfma_f32_16x16x32_bf16 v[16:19], v[144:147], a[52:55], v[16:19]
s_waitcnt vmcnt(36)
ds_read_b64_tr_b16 v[136:137], v207 offset:20480
v_mfma_f32_16x16x32_bf16 v[20:23], v[144:147], a[124:127], v[20:23]
s_waitcnt vmcnt(35)
v_mfma_f32_16x16x32_bf16 v[24:27], v[144:147], a[196:199], v[24:27]
s_waitcnt vmcnt(34)
ds_read_b64_tr_b16 v[138:139], v207 offset:22528
v_mfma_f32_16x16x32_bf16 v[28:31], v[144:147], v[180:183], v[28:31]
s_waitcnt lgkmcnt(12)
v_mfma_f32_16x16x32_bf16 v[32:35], v[148:151], a[52:55], v[32:35]
ds_read_b64_tr_b16 v[140:141], v201 offset:24576
v_mfma_f32_16x16x32_bf16 v[36:39], v[148:151], a[124:127], v[36:39]
v_mfma_f32_16x16x32_bf16 v[40:43], v[148:151], a[196:199], v[40:43]
ds_read_b64_tr_b16 v[142:143], v201 offset:26624
v_mfma_f32_16x16x32_bf16 v[44:47], v[148:151], v[180:183], v[44:47]
s_waitcnt lgkmcnt(12)
v_mfma_f32_16x16x32_bf16 v[48:51], v[116:119], a[52:55], v[48:51]
ds_read_b64_tr_b16 v[144:145], v203 offset:24576
v_mfma_f32_16x16x32_bf16 v[52:55], v[116:119], a[124:127], v[52:55]
v_mfma_f32_16x16x32_bf16 v[56:59], v[116:119], a[196:199], v[56:59]
s_cmp_gt_u32 s22, 4
s_cselect_b32 s74, s77, 0
s_bitcmp1_b32 s78, 0
s_cselect_b32 s74, 0, s74
ds_read_b64_tr_b16 v[146:147], v203 offset:26624
v_mfma_f32_16x16x32_bf16 v[60:63], v[116:119], v[180:183], v[60:63]
s_waitcnt lgkmcnt(12)
buffer_load_dword v232, v216, s[72:75], s76 offen
v_mfma_f32_16x16x32_bf16 v[64:67], v[120:123], a[52:55], v[64:67]
s_add_u32 s76, s76, 128
ds_read_b64_tr_b16 v[148:149], v205 offset:24576
v_mfma_f32_16x16x32_bf16 v[68:71], v[120:123], a[124:127], v[68:71]
v_mfma_f32_16x16x32_bf16 v[72:75], v[120:123], a[196:199], v[72:75]
s_add_u32 s78, s78, 1
ds_read_b64_tr_b16 v[150:151], v205 offset:26624
v_mfma_f32_16x16x32_bf16 v[76:79], v[120:123], v[180:183], v[76:79]
s_waitcnt vmcnt(34) lgkmcnt(12)
v_mfma_f32_16x16x32_bf16 v[16:19], v[124:127], a[56:59], v[16:19]
s_waitcnt vmcnt(33)
ds_read_b64_tr_b16 v[116:117], v207 offset:24576
v_mfma_f32_16x16x32_bf16 v[20:23], v[124:127], a[128:131], v[20:23]
s_waitcnt vmcnt(32)
v_mfma_f32_16x16x32_bf16 v[24:27], v[124:127], a[200:203], v[24:27]
s_waitcnt vmcnt(31)
ds_read_b64_tr_b16 v[118:119], v207 offset:26624
v_mfma_f32_16x16x32_bf16 v[28:31], v[124:127], v[184:187], v[28:31]
s_waitcnt lgkmcnt(12)
v_mfma_f32_16x16x32_bf16 v[32:35], v[128:131], a[56:59], v[32:35]
ds_read_b64_tr_b16 v[120:121], v201 offset:28672
v_mfma_f32_16x16x32_bf16 v[36:39], v[128:131], a[128:131], v[36:39]
v_mfma_f32_16x16x32_bf16 v[40:43], v[128:131], a[200:203], v[40:43]
ds_read_b64_tr_b16 v[122:123], v201 offset:30720
v_mfma_f32_16x16x32_bf16 v[44:47], v[128:131], v[184:187], v[44:47]
s_waitcnt lgkmcnt(12)
v_mfma_f32_16x16x32_bf16 v[48:51], v[132:135], a[56:59], v[48:51]
ds_read_b64_tr_b16 v[124:125], v203 offset:28672
v_mfma_f32_16x16x32_bf16 v[52:55], v[132:135], a[128:131], v[52:55]
v_mfma_f32_16x16x32_bf16 v[56:59], v[132:135], a[200:203], v[56:59]
ds_read_b64_tr_b16 v[126:127], v203 offset:30720
v_mfma_f32_16x16x32_bf16 v[60:63], v[132:135], v[184:187], v[60:63]
s_waitcnt lgkmcnt(12)
v_mfma_f32_16x16x32_bf16 v[64:67], v[136:139], a[56:59], v[64:67]
ds_read_b64_tr_b16 v[128:129], v205 offset:28672
v_mfma_f32_16x16x32_bf16 v[68:71], v[136:139], a[128:131], v[68:71]
v_mfma_f32_16x16x32_bf16 v[72:75], v[136:139], a[200:203], v[72:75]
ds_read_b64_tr_b16 v[130:131], v205 offset:30720
v_mfma_f32_16x16x32_bf16 v[76:79], v[136:139], v[184:187], v[76:79]
s_waitcnt vmcnt(30) lgkmcnt(12)
v_mfma_f32_16x16x32_bf16 v[16:19], v[140:143], a[60:63], v[16:19]
s_waitcnt vmcnt(29)
ds_read_b64_tr_b16 v[132:133], v207 offset:28672
v_mfma_f32_16x16x32_bf16 v[20:23], v[140:143], a[132:135], v[20:23]
s_waitcnt vmcnt(28)
v_mfma_f32_16x16x32_bf16 v[24:27], v[140:143], a[204:207], v[24:27]
s_waitcnt vmcnt(27)
ds_read_b64_tr_b16 v[134:135], v207 offset:30720
v_mfma_f32_16x16x32_bf16 v[28:31], v[140:143], v[188:191], v[28:31]
s_waitcnt lgkmcnt(12)
v_mfma_f32_16x16x32_bf16 v[32:35], v[144:147], a[60:63], v[32:35]
ds_read_b64_tr_b16 v[136:137], v201 offset:32768
v_mfma_f32_16x16x32_bf16 v[36:39], v[144:147], a[132:135], v[36:39]
v_mfma_f32_16x16x32_bf16 v[40:43], v[144:147], a[204:207], v[40:43]
ds_read_b64_tr_b16 v[138:139], v201 offset:34816
v_mfma_f32_16x16x32_bf16 v[44:47], v[144:147], v[188:191], v[44:47]
s_waitcnt lgkmcnt(12)
v_mfma_f32_16x16x32_bf16 v[48:51], v[148:151], a[60:63], v[48:51]
ds_read_b64_tr_b16 v[140:141], v203 offset:32768
v_mfma_f32_16x16x32_bf16 v[52:55], v[148:151], a[132:135], v[52:55]
v_mfma_f32_16x16x32_bf16 v[56:59], v[148:151], a[204:207], v[56:59]
ds_read_b64_tr_b16 v[142:143], v203 offset:34816
v_mfma_f32_16x16x32_bf16 v[60:63], v[148:151], v[188:191], v[60:63]
s_waitcnt lgkmcnt(12)
v_mfma_f32_16x16x32_bf16 v[64:67], v[116:119], a[60:63], v[64:67]
ds_read_b64_tr_b16 v[144:145], v205 offset:32768
v_mfma_f32_16x16x32_bf16 v[68:71], v[116:119], a[132:135], v[68:71]
v_mfma_f32_16x16x32_bf16 v[72:75], v[116:119], a[204:207], v[72:75]
ds_read_b64_tr_b16 v[146:147], v205 offset:34816
v_mfma_f32_16x16x32_bf16 v[76:79], v[116:119], v[188:191], v[76:79]
s_waitcnt vmcnt(26) lgkmcnt(12)
v_mfma_f32_16x16x32_bf16 v[16:19], v[120:123], a[64:67], v[16:19]
s_waitcnt vmcnt(25)
ds_read_b64_tr_b16 v[148:149], v207 offset:32768
v_mfma_f32_16x16x32_bf16 v[20:23], v[120:123], a[136:139], v[20:23]
s_waitcnt vmcnt(24)
v_mfma_f32_16x16x32_bf16 v[24:27], v[120:123], a[208:211], v[24:27]
s_waitcnt vmcnt(23)
ds_read_b64_tr_b16 v[150:151], v207 offset:34816
v_add_u32 v7, s29, v3
v_mfma_f32_16x16x32_bf16 v[28:31], v[120:123], v[192:195], v[28:31]
s_waitcnt lgkmcnt(12)
v_mfma_f32_16x16x32_bf16 v[32:35], v[124:127], a[64:67], v[32:35]
s_waitcnt vmcnt(1) lgkmcnt(0)
s_barrier
v_mfma_f32_16x16x32_bf16 v[36:39], v[124:127], a[136:139], v[36:39]
ds_read_b64_tr_b16 v[80:81], v7
v_mfma_f32_16x16x32_bf16 v[40:43], v[124:127], a[208:211], v[40:43]
ds_read_b64_tr_b16 v[82:83], v7 offset:2048
v_mfma_f32_16x16x32_bf16 v[44:47], v[124:127], v[192:195], v[44:47]
ds_read_b64_tr_b16 v[84:85], v7 offset:4096
v_mfma_f32_16x16x32_bf16 v[48:51], v[128:131], a[64:67], v[48:51]
ds_read_b64_tr_b16 v[86:87], v7 offset:6144
v_mfma_f32_16x16x32_bf16 v[52:55], v[128:131], a[136:139], v[52:55]
v_mfma_f32_16x16x32_bf16 v[56:59], v[128:131], a[208:211], v[56:59]
ds_read_b64_tr_b16 v[88:89], v7 offset:8192
v_mfma_f32_16x16x32_bf16 v[60:63], v[128:131], v[192:195], v[60:63]
ds_read_b64_tr_b16 v[90:91], v7 offset:10240
v_mfma_f32_16x16x32_bf16 v[64:67], v[132:135], a[64:67], v[64:67]
ds_read_b64_tr_b16 v[92:93], v7 offset:12288
v_mfma_f32_16x16x32_bf16 v[68:71], v[132:135], a[136:139], v[68:71]
ds_read_b64_tr_b16 v[94:95], v7 offset:14336
v_mfma_f32_16x16x32_bf16 v[72:75], v[132:135], a[208:211], v[72:75]
v_mfma_f32_16x16x32_bf16 v[76:79], v[132:135], v[192:195], v[76:79]
ds_read_b64_tr_b16 v[96:97], v7 offset:16384
v_mfma_f32_16x16x32_bf16 v[16:19], v[136:139], a[68:71], v[16:19]
ds_read_b64_tr_b16 v[98:99], v7 offset:18432
v_mfma_f32_16x16x32_bf16 v[20:23], v[136:139], a[140:143], v[20:23]
ds_read_b64_tr_b16 v[100:101], v7 offset:20480
v_mfma_f32_16x16x32_bf16 v[24:27], v[136:139], a[212:215], v[24:27]
v_mfma_f32_16x16x32_bf16 v[28:31], v[136:139], v[196:199], v[28:31]
ds_read_b64_tr_b16 v[102:103], v7 offset:22528
v_mfma_f32_16x16x32_bf16 v[32:35], v[140:143], a[68:71], v[32:35]
ds_read_b64_tr_b16 v[104:105], v7 offset:24576
v_mfma_f32_16x16x32_bf16 v[36:39], v[140:143], a[140:143], v[36:39]
ds_read_b64_tr_b16 v[106:107], v7 offset:26624
v_mfma_f32_16x16x32_bf16 v[40:43], v[140:143], a[212:215], v[40:43]
ds_read_b64_tr_b16 v[108:109], v7 offset:28672
v_mfma_f32_16x16x32_bf16 v[44:47], v[140:143], v[196:199], v[44:47]
v_mfma_f32_16x16x32_bf16 v[48:51], v[144:147], a[68:71], v[48:51]
ds_read_b64_tr_b16 v[110:111], v7 offset:30720
v_mfma_f32_16x16x32_bf16 v[52:55], v[144:147], a[140:143], v[52:55]
ds_read_b64_tr_b16 v[112:113], v7 offset:32768
v_mfma_f32_16x16x32_bf16 v[56:59], v[144:147], a[212:215], v[56:59]
ds_read_b64_tr_b16 v[114:115], v7 offset:34816
v_mfma_f32_16x16x32_bf16 v[60:63], v[144:147], v[196:199], v[60:63]
v_mfma_f32_16x16x32_bf16 v[64:67], v[148:151], a[68:71], v[64:67]
v_mfma_f32_16x16x32_bf16 v[68:71], v[148:151], a[140:143], v[68:71]
v_mfma_f32_16x16x32_bf16 v[72:75], v[148:151], a[212:215], v[72:75]
v_mfma_f32_16x16x32_bf16 v[76:79], v[148:151], v[196:199], v[76:79]
s_nop 7
v_mul_f32 v16, s41, v16
v_mul_f32 v17, s41, v17
v_mul_f32 v18, s41, v18
v_mul_f32 v19, s41, v19
v_mul_f32 v32, s41, v32
v_mul_f32 v33, s41, v33
v_mul_f32 v34, s41, v34
v_mul_f32 v35, s41, v35
v_cvt_pk_bf16_f32 v152, v16, v17
v_cvt_pk_bf16_f32 v153, v18, v19
v_cvt_pk_bf16_f32 v154, v32, v33
v_cvt_pk_bf16_f32 v155, v34, v35
buffer_store_dwordx4 v[152:155], v2, s[52:55], s33 offen sc1
v_mul_f32 v20, s41, v20
v_mul_f32 v21, s41, v21
v_mul_f32 v22, s41, v22
v_mul_f32 v23, s41, v23
v_mul_f32 v36, s41, v36
v_mul_f32 v37, s41, v37
v_mul_f32 v38, s41, v38
v_mul_f32 v39, s41, v39
v_cvt_pk_bf16_f32 v156, v20, v21
v_cvt_pk_bf16_f32 v157, v22, v23
v_cvt_pk_bf16_f32 v158, v36, v37
v_cvt_pk_bf16_f32 v159, v38, v39
s_add_u32 s35, s33, 131072
buffer_store_dwordx4 v[156:159], v2, s[52:55], s35 offen sc1
v_mul_f32 v24, s41, v24
v_mul_f32 v25, s41, v25
v_mul_f32 v26, s41, v26
v_mul_f32 v27, s41, v27
v_mul_f32 v40, s41, v40
v_mul_f32 v41, s41, v41
v_mul_f32 v42, s41, v42
v_mul_f32 v43, s41, v43
v_cvt_pk_bf16_f32 v160, v24, v25
v_cvt_pk_bf16_f32 v161, v26, v27
v_cvt_pk_bf16_f32 v162, v40, v41
v_cvt_pk_bf16_f32 v163, v42, v43
s_add_u32 s35, s33, 262144
buffer_store_dwordx4 v[160:163], v2, s[52:55], s35 offen sc1
v_mul_f32 v28, s41, v28
v_mul_f32 v29, s41, v29
v_mul_f32 v30, s41, v30
v_mul_f32 v31, s41, v31
v_mul_f32 v44, s41, v44
v_mul_f32 v45, s41, v45
v_mul_f32 v46, s41, v46
v_mul_f32 v47, s41, v47
v_cvt_pk_bf16_f32 v164, v28, v29
v_cvt_pk_bf16_f32 v165, v30, v31
v_cvt_pk_bf16_f32 v166, v44, v45
v_cvt_pk_bf16_f32 v167, v46, v47
s_add_u32 s35, s33, 393216
buffer_store_dwordx4 v[164:167], v2, s[52:55], s35 offen sc1
s_getpc_b64 s[90:91]
L_ct_apQ:
s_add_u32 s90, s90, ap_kernel-L_ct_apQ
s_addc_u32 s91, s91, 0
s_lshr_b32 s38, s2, 3
s_and_b32 s38, s38, 31
s_mul_i32 s38, s38, 2176
v_min_u32 v238, 16, v0
v_lshlrev_b32 v238, 7, v238
v_add_u32 v238, s38, v238
global_load_dword v240, v238, s[90:91]
s_mov_b32 s34, s33
s_mov_b32 s58, s54
s_add_u32 s33, s33, 2048
s_xor_b32 s27, s27, 73728
s_xor_b32 s29, s29, 73728
s_add_u32 s28, s27, 36864
s_sub_u32 s22, s22, 1
s_cmp_lg_u32 s22, 0
s_branch L_p1_loopQ

L_p1_loopQ:
s_waitcnt lgkmcnt(12)
v_mfma_f32_16x16x32_bf16 v[16:19], v[80:83], a[0:3], 0
s_add_u32 s32, s32, 128
v_add_u32 v8, s28, v3
v_mfma_f32_16x16x32_bf16 v[16:19], v[84:87], a[4:7], v[16:19]
s_xor_b32 s30, s30, 73728
ds_read_b64_tr_b16 v[116:117], v8
v_mfma_f32_16x16x32_bf16 v[16:19], v[88:91], a[8:11], v[16:19]
s_waitcnt lgkmcnt(7)
s_cmp_eq_u32 s22, 1
s_cselect_b32 s46, 0, s46
s_mov_b32 m0, s30
ds_read_b64_tr_b16 v[118:119], v8 offset:2048
v_mfma_f32_16x16x32_bf16 v[16:19], v[92:95], a[12:15], v[16:19]
s_mov_b32 s31, s32
ds_read_b64_tr_b16 v[120:121], v8 offset:4096
v_mfma_f32_16x16x32_bf16 v[16:19], v[96:99], a[16:19], v[16:19]
buffer_load_dwordx4 v9, s[44:47], s31 offen lds
v_mfma_f32_16x16x32_bf16 v[16:19], v[100:103], a[20:23], v[16:19]
s_waitcnt lgkmcnt(3)
ds_read_b64_tr_b16 v[122:123], v8 offset:6144
v_mfma_f32_16x16x32_bf16 v[16:19], v[104:107], a[24:27], v[16:19]
v_mfma_f32_16x16x32_bf16 v[16:19], v[108:111], a[28:31], v[16:19]
s_add_u32 m0, m0, 4096
ds_read_b64_tr_b16 v[124:125], v8 offset:8192
v_mfma_f32_16x16x32_bf16 v[16:19], v[112:115], a[32:35], v[16:19]
s_add_u32 s31, s31, 262144
v_mfma_f32_16x16x32_bf16 v[20:23], v[80:83], a[72:75], 0
ds_read_b64_tr_b16 v[126:127], v8 offset:10240
v_mul_f32 v48, s41, v48
v_mfma_f32_16x16x32_bf16 v[20:23], v[84:87], a[76:79], v[20:23]
buffer_load_dwordx4 v9, s[44:47], s31 offen lds
v_mul_f32 v49, s41, v49
v_mfma_f32_16x16x32_bf16 v[20:23], v[88:91], a[80:83], v[20:23]
ds_read_b64_tr_b16 v[128:129], v8 offset:12288
v_mfma_f32_16x16x32_bf16 v[20:23], v[92:95], a[84:87], v[20:23]
v_mul_f32 v50, s41, v50
v_mfma_f32_16x16x32_bf16 v[20:23], v[96:99], a[88:91], v[20:23]
ds_read_b64_tr_b16 v[130:131], v8 offset:14336
v_mfma_f32_16x16x32_bf16 v[20:23], v[100:103], a[92:95], v[20:23]
v_mul_f32 v51, s41, v51
v_mfma_f32_16x16x32_bf16 v[20:23], v[104:107], a[96:99], v[20:23]
s_add_u32 m0, m0, 4096
ds_read_b64_tr_b16 v[132:133], v8 offset:16384
v_mfma_f32_16x16x32_bf16 v[20:23], v[108:111], a[100:103], v[20:23]
s_add_u32 s31, s31, 262144
v_mfma_f32_16x16x32_bf16 v[20:23], v[112:115], a[104:107], v[20:23]
ds_read_b64_tr_b16 v[134:135], v8 offset:18432
v_mul_f32 v64, s41, v64
v_mfma_f32_16x16x32_bf16 v[24:27], v[80:83], a[144:147], 0
ds_read_b64_tr_b16 v[136:137], v8 offset:20480
v_mfma_f32_16x16x32_bf16 v[24:27], v[84:87], a[148:151], v[24:27]
buffer_load_dwordx4 v9, s[44:47], s31 offen lds
v_mul_f32 v65, s41, v65
v_mfma_f32_16x16x32_bf16 v[24:27], v[88:91], a[152:155], v[24:27]
ds_read_b64_tr_b16 v[138:139], v8 offset:22528
v_mfma_f32_16x16x32_bf16 v[24:27], v[92:95], a[156:159], v[24:27]
v_mfma_f32_16x16x32_bf16 v[24:27], v[96:99], a[160:163], v[24:27]
ds_read_b64_tr_b16 v[140:141], v8 offset:24576
v_mul_f32 v66, s41, v66
v_mfma_f32_16x16x32_bf16 v[24:27], v[100:103], a[164:167], v[24:27]
s_add_u32 m0, m0, 4096
v_mfma_f32_16x16x32_bf16 v[24:27], v[104:107], a[168:171], v[24:27]
s_add_u32 s31, s31, 262144
ds_read_b64_tr_b16 v[142:143], v8 offset:26624
v_mul_f32 v67, s41, v67
v_mfma_f32_16x16x32_bf16 v[24:27], v[108:111], a[172:175], v[24:27]
v_mfma_f32_16x16x32_bf16 v[24:27], v[112:115], a[176:179], v[24:27]
ds_read_b64_tr_b16 v[144:145], v8 offset:28672
v_mfma_f32_16x16x32_bf16 v[28:31], v[80:83], a[216:219], 0
buffer_load_dwordx4 v9, s[44:47], s31 offen lds
v_cvt_pk_bf16_f32 v152, v48, v49
v_mfma_f32_16x16x32_bf16 v[28:31], v[84:87], a[220:223], v[28:31]
ds_read_b64_tr_b16 v[146:147], v8 offset:30720
v_mfma_f32_16x16x32_bf16 v[28:31], v[88:91], a[224:227], v[28:31]
v_cvt_pk_bf16_f32 v153, v50, v51
v_mfma_f32_16x16x32_bf16 v[28:31], v[92:95], a[228:231], v[28:31]
ds_read_b64_tr_b16 v[148:149], v8 offset:32768
v_mfma_f32_16x16x32_bf16 v[28:31], v[96:99], a[232:235], v[28:31]
s_add_u32 m0, m0, 4096
v_mfma_f32_16x16x32_bf16 v[28:31], v[100:103], a[236:239], v[28:31]
s_add_u32 s31, s31, 262144
ds_read_b64_tr_b16 v[150:151], v8 offset:34816
v_cvt_pk_bf16_f32 v154, v64, v65
v_mfma_f32_16x16x32_bf16 v[28:31], v[104:107], a[240:243], v[28:31]
v_mfma_f32_16x16x32_bf16 v[28:31], v[108:111], a[244:247], v[28:31]
buffer_load_dwordx4 v9, s[44:47], s31 offen lds
v_add_u32 v7, s27, v4
v_mfma_f32_16x16x32_bf16 v[28:31], v[112:115], a[248:251], v[28:31]
s_waitcnt lgkmcnt(12)
v_cvt_pk_bf16_f32 v155, v66, v67
v_mfma_f32_16x16x32_bf16 v[16:19], v[116:119], a[36:39], v[16:19]
ds_read_b64_tr_b16 v[80:81], v7
v_mfma_f32_16x16x32_bf16 v[16:19], v[120:123], a[40:43], v[16:19]
ds_read_b64_tr_b16 v[82:83], v7 offset:2048
v_mfma_f32_16x16x32_bf16 v[16:19], v[124:127], a[44:47], v[16:19]
s_waitcnt lgkmcnt(8)
buffer_store_dwordx4 v[152:155], v2, s[56:59], s34 offen offset:1024 sc1
v_mfma_f32_16x16x32_bf16 v[16:19], v[128:131], a[48:51], v[16:19]
s_add_u32 m0, m0, 4096
ds_read_b64_tr_b16 v[84:85], v7 offset:4096
v_mul_f32 v52, s41, v52
v_mfma_f32_16x16x32_bf16 v[16:19], v[132:135], a[52:55], v[16:19]
s_add_u32 s31, s31, 262144
v_mfma_f32_16x16x32_bf16 v[16:19], v[136:139], a[56:59], v[16:19]
s_waitcnt lgkmcnt(3)
ds_read_b64_tr_b16 v[86:87], v7 offset:6144
v_mfma_f32_16x16x32_bf16 v[16:19], v[140:143], a[60:63], v[16:19]
buffer_load_dwordx4 v9, s[44:47], s31 offen lds
v_mul_f32 v53, s41, v53
v_mfma_f32_16x16x32_bf16 v[16:19], v[144:147], a[64:67], v[16:19]
ds_read_b64_tr_b16 v[88:89], v7 offset:8192
v_mfma_f32_16x16x32_bf16 v[16:19], v[148:151], a[68:71], v[16:19]
v_mul_f32 v54, s41, v54
v_mfma_f32_16x16x32_bf16 v[20:23], v[116:119], a[108:111], v[20:23]
ds_read_b64_tr_b16 v[90:91], v7 offset:10240
v_mfma_f32_16x16x32_bf16 v[20:23], v[120:123], a[112:115], v[20:23]
v_mfma_f32_16x16x32_bf16 v[20:23], v[124:127], a[116:119], v[20:23]
s_add_u32 m0, m0, 4096
ds_read_b64_tr_b16 v[92:93], v7 offset:12288
v_mul_f32 v55, s41, v55
v_mfma_f32_16x16x32_bf16 v[20:23], v[128:131], a[120:123], v[20:23]
s_add_u32 s31, s31, 262144
v_mfma_f32_16x16x32_bf16 v[20:23], v[132:135], a[124:127], v[20:23]
ds_read_b64_tr_b16 v[94:95], v7 offset:14336
v_mul_f32 v68, s41, v68
v_mfma_f32_16x16x32_bf16 v[20:23], v[136:139], a[128:131], v[20:23]
buffer_load_dwordx4 v9, s[44:47], s31 offen lds
v_mfma_f32_16x16x32_bf16 v[20:23], v[140:143], a[132:135], v[20:23]
ds_read_b64_tr_b16 v[96:97], v7 offset:16384
v_mfma_f32_16x16x32_bf16 v[20:23], v[144:147], a[136:139], v[20:23]
v_mul_f32 v69, s41, v69
v_mfma_f32_16x16x32_bf16 v[20:23], v[148:151], a[140:143], v[20:23]
ds_read_b64_tr_b16 v[98:99], v7 offset:18432
v_mfma_f32_16x16x32_bf16 v[24:27], v[116:119], a[180:183], v[24:27]
s_add_u32 m0, m0, 4096
ds_read_b64_tr_b16 v[100:101], v7 offset:20480
v_mul_f32 v70, s41, v70
v_mfma_f32_16x16x32_bf16 v[24:27], v[120:123], a[184:187], v[24:27]
s_add_u32 s31, s31, 262144
v_mfma_f32_16x16x32_bf16 v[24:27], v[124:127], a[188:191], v[24:27]
ds_read_b64_tr_b16 v[102:103], v7 offset:22528
v_mfma_f32_16x16x32_bf16 v[24:27], v[128:131], a[192:195], v[24:27]
buffer_load_dwordx4 v9, s[44:47], s31 offen lds
v_mul_f32 v71, s41, v71
v_mfma_f32_16x16x32_bf16 v[24:27], v[132:135], a[196:199], v[24:27]
ds_read_b64_tr_b16 v[104:105], v7 offset:24576
v_mfma_f32_16x16x32_bf16 v[24:27], v[136:139], a[200:203], v[24:27]
v_cvt_pk_bf16_f32 v156, v52, v53
v_mfma_f32_16x16x32_bf16 v[24:27], v[140:143], a[204:207], v[24:27]
ds_read_b64_tr_b16 v[106:107], v7 offset:26624
v_mfma_f32_16x16x32_bf16 v[24:27], v[144:147], a[208:211], v[24:27]
v_mfma_f32_16x16x32_bf16 v[24:27], v[148:151], a[212:215], v[24:27]
s_add_u32 m0, m0, 4096
ds_read_b64_tr_b16 v[108:109], v7 offset:28672
v_cvt_pk_bf16_f32 v157, v54, v55
v_mfma_f32_16x16x32_bf16 v[28:31], v[116:119], a[252:255], v[28:31]
s_add_u32 s31, s31, 262144
v_mfma_f32_16x16x32_bf16 v[28:31], v[120:123], v[168:171], v[28:31]
ds_read_b64_tr_b16 v[110:111], v7 offset:30720
v_cvt_pk_bf16_f32 v158, v68, v69
v_mfma_f32_16x16x32_bf16 v[28:31], v[124:127], v[172:175], v[28:31]
buffer_load_dwordx4 v9, s[44:47], s31 offen lds
v_mfma_f32_16x16x32_bf16 v[28:31], v[128:131], v[176:179], v[28:31]
ds_read_b64_tr_b16 v[112:113], v7 offset:32768
v_mfma_f32_16x16x32_bf16 v[28:31], v[132:135], v[180:183], v[28:31]
v_cvt_pk_bf16_f32 v159, v70, v71
v_mfma_f32_16x16x32_bf16 v[28:31], v[136:139], v[184:187], v[28:31]
ds_read_b64_tr_b16 v[114:115], v7 offset:34816
v_mfma_f32_16x16x32_bf16 v[28:31], v[140:143], v[188:191], v[28:31]
s_add_u32 s35, s34, 131072
buffer_store_dwordx4 v[156:159], v2, s[56:59], s35 offen offset:1024 sc1
v_mfma_f32_16x16x32_bf16 v[28:31], v[144:147], v[192:195], v[28:31]
s_add_u32 m0, m0, 4096
v_add_u32 v8, s28, v4
v_mfma_f32_16x16x32_bf16 v[28:31], v[148:151], v[196:199], v[28:31]
s_waitcnt lgkmcnt(12)
s_add_u32 s31, s31, 262144
v_mfma_f32_16x16x32_bf16 v[32:35], v[80:83], a[0:3], 0
ds_read_b64_tr_b16 v[116:117], v8
v_mul_f32 v56, s41, v56
v_mfma_f32_16x16x32_bf16 v[32:35], v[84:87], a[4:7], v[32:35]
ds_read_b64_tr_b16 v[118:119], v8 offset:2048
v_mfma_f32_16x16x32_bf16 v[32:35], v[88:91], a[8:11], v[32:35]
s_waitcnt lgkmcnt(8)
buffer_load_dwordx4 v9, s[44:47], s31 offen lds
v_mfma_f32_16x16x32_bf16 v[32:35], v[92:95], a[12:15], v[32:35]
ds_read_b64_tr_b16 v[120:121], v8 offset:4096
v_mul_f32 v57, s41, v57
v_mfma_f32_16x16x32_bf16 v[32:35], v[96:99], a[16:19], v[32:35]
v_mfma_f32_16x16x32_bf16 v[32:35], v[100:103], a[20:23], v[32:35]
s_waitcnt lgkmcnt(3)
ds_read_b64_tr_b16 v[122:123], v8 offset:6144
v_mul_f32 v58, s41, v58
v_mfma_f32_16x16x32_bf16 v[32:35], v[104:107], a[24:27], v[32:35]
s_add_u32 m0, m0, 4096
v_mfma_f32_16x16x32_bf16 v[32:35], v[108:111], a[28:31], v[32:35]
s_add_u32 s31, s31, 262144
ds_read_b64_tr_b16 v[124:125], v8 offset:8192
v_mfma_f32_16x16x32_bf16 v[32:35], v[112:115], a[32:35], v[32:35]
v_mul_f32 v59, s41, v59
v_mfma_f32_16x16x32_bf16 v[36:39], v[80:83], a[72:75], 0
ds_read_b64_tr_b16 v[126:127], v8 offset:10240
v_mfma_f32_16x16x32_bf16 v[36:39], v[84:87], a[76:79], v[36:39]
buffer_load_dwordx4 v9, s[44:47], s31 offen lds
v_mul_f32 v72, s41, v72
v_mfma_f32_16x16x32_bf16 v[36:39], v[88:91], a[80:83], v[36:39]
ds_read_b64_tr_b16 v[128:129], v8 offset:12288
v_mfma_f32_16x16x32_bf16 v[36:39], v[92:95], a[84:87], v[36:39]
v_mfma_f32_16x16x32_bf16 v[36:39], v[96:99], a[88:91], v[36:39]
ds_read_b64_tr_b16 v[130:131], v8 offset:14336
v_mul_f32 v73, s41, v73
v_mfma_f32_16x16x32_bf16 v[36:39], v[100:103], a[92:95], v[36:39]
s_add_u32 m0, m0, 4096
v_mfma_f32_16x16x32_bf16 v[36:39], v[104:107], a[96:99], v[36:39]
s_add_u32 s31, s31, 262144
ds_read_b64_tr_b16 v[132:133], v8 offset:16384
v_mul_f32 v74, s41, v74
v_mfma_f32_16x16x32_bf16 v[36:39], v[108:111], a[100:103], v[36:39]
v_mfma_f32_16x16x32_bf16 v[36:39], v[112:115], a[104:107], v[36:39]
ds_read_b64_tr_b16 v[134:135], v8 offset:18432
v_mfma_f32_16x16x32_bf16 v[40:43], v[80:83], a[144:147], 0
ds_read_b64_tr_b16 v[136:137], v8 offset:20480
v_mul_f32 v75, s41, v75
v_mfma_f32_16x16x32_bf16 v[40:43], v[84:87], a[148:151], v[40:43]
buffer_load_dwordx4 v9, s[44:47], s31 offen lds
v_mfma_f32_16x16x32_bf16 v[40:43], v[88:91], a[152:155], v[40:43]
ds_read_b64_tr_b16 v[138:139], v8 offset:22528
v_cvt_pk_bf16_f32 v160, v56, v57
v_mfma_f32_16x16x32_bf16 v[40:43], v[92:95], a[156:159], v[40:43]
v_mfma_f32_16x16x32_bf16 v[40:43], v[96:99], a[160:163], v[40:43]
s_add_u32 m0, m0, 4096
ds_read_b64_tr_b16 v[140:141], v8 offset:24576
v_mfma_f32_16x16x32_bf16 v[40:43], v[100:103], a[164:167], v[40:43]
s_add_u32 s31, s31, 262144
v_cvt_pk_bf16_f32 v161, v58, v59
v_mfma_f32_16x16x32_bf16 v[40:43], v[104:107], a[168:171], v[40:43]
ds_read_b64_tr_b16 v[142:143], v8 offset:26624
v_mfma_f32_16x16x32_bf16 v[40:43], v[108:111], a[172:175], v[40:43]
buffer_load_dwordx4 v9, s[44:47], s31 offen lds
v_cvt_pk_bf16_f32 v162, v72, v73
v_mfma_f32_16x16x32_bf16 v[40:43], v[112:115], a[176:179], v[40:43]
ds_read_b64_tr_b16 v[144:145], v8 offset:28672
v_mfma_f32_16x16x32_bf16 v[44:47], v[80:83], a[216:219], 0
v_mfma_f32_16x16x32_bf16 v[44:47], v[84:87], a[220:223], v[44:47]
ds_read_b64_tr_b16 v[146:147], v8 offset:30720
v_cvt_pk_bf16_f32 v163, v74, v75
v_mfma_f32_16x16x32_bf16 v[44:47], v[88:91], a[224:227], v[44:47]
s_add_u32 m0, m0, 4096
v_mfma_f32_16x16x32_bf16 v[44:47], v[92:95], a[228:231], v[44:47]
s_add_u32 s31, s31, 262144
ds_read_b64_tr_b16 v[148:149], v8 offset:32768
v_mfma_f32_16x16x32_bf16 v[44:47], v[96:99], a[232:235], v[44:47]
s_add_u32 s35, s34, 262144
buffer_store_dwordx4 v[160:163], v2, s[56:59], s35 offen offset:1024 sc1
v_mfma_f32_16x16x32_bf16 v[44:47], v[100:103], a[236:239], v[44:47]
ds_read_b64_tr_b16 v[150:151], v8 offset:34816
v_mfma_f32_16x16x32_bf16 v[44:47], v[104:107], a[240:243], v[44:47]
buffer_load_dwordx4 v9, s[44:47], s31 offen lds
v_mul_f32 v60, s41, v60
v_mfma_f32_16x16x32_bf16 v[44:47], v[108:111], a[244:247], v[44:47]
v_add_u32 v7, s27, v5
v_mfma_f32_16x16x32_bf16 v[44:47], v[112:115], a[248:251], v[44:47]
s_waitcnt lgkmcnt(12)
v_mul_f32 v61, s41, v61
v_mfma_f32_16x16x32_bf16 v[32:35], v[116:119], a[36:39], v[32:35]
ds_read_b64_tr_b16 v[80:81], v7
v_mfma_f32_16x16x32_bf16 v[32:35], v[120:123], a[40:43], v[32:35]
s_add_u32 m0, m0, 4096
ds_read_b64_tr_b16 v[82:83], v7 offset:2048
v_mfma_f32_16x16x32_bf16 v[32:35], v[124:127], a[44:47], v[32:35]
s_waitcnt lgkmcnt(8)
s_add_u32 s31, s31, 262144
v_mul_f32 v62, s41, v62
v_mfma_f32_16x16x32_bf16 v[32:35], v[128:131], a[48:51], v[32:35]
ds_read_b64_tr_b16 v[84:85], v7 offset:4096
v_mfma_f32_16x16x32_bf16 v[32:35], v[132:135], a[52:55], v[32:35]
buffer_load_dwordx4 v9, s[44:47], s31 offen lds
v_mul_f32 v63, s41, v63
v_mfma_f32_16x16x32_bf16 v[32:35], v[136:139], a[56:59], v[32:35]
s_waitcnt lgkmcnt(3)
ds_read_b64_tr_b16 v[86:87], v7 offset:6144
v_mfma_f32_16x16x32_bf16 v[32:35], v[140:143], a[60:63], v[32:35]
v_mfma_f32_16x16x32_bf16 v[32:35], v[144:147], a[64:67], v[32:35]
ds_read_b64_tr_b16 v[88:89], v7 offset:8192
v_mul_f32 v76, s41, v76
v_mfma_f32_16x16x32_bf16 v[32:35], v[148:151], a[68:71], v[32:35]
v_mfma_f32_16x16x32_bf16 v[36:39], v[116:119], a[108:111], v[36:39]
s_add_u32 m0, m0, 4096
ds_read_b64_tr_b16 v[90:91], v7 offset:10240
v_mul_f32 v77, s41, v77
v_mfma_f32_16x16x32_bf16 v[36:39], v[120:123], a[112:115], v[36:39]
s_add_u32 s31, s31, 262144
v_mfma_f32_16x16x32_bf16 v[36:39], v[124:127], a[116:119], v[36:39]
ds_read_b64_tr_b16 v[92:93], v7 offset:12288
v_mfma_f32_16x16x32_bf16 v[36:39], v[128:131], a[120:123], v[36:39]
buffer_load_dwordx4 v9, s[44:47], s31 offen lds
v_mul_f32 v78, s41, v78
v_mfma_f32_16x16x32_bf16 v[36:39], v[132:135], a[124:127], v[36:39]
ds_read_b64_tr_b16 v[94:95], v7 offset:14336
v_mfma_f32_16x16x32_bf16 v[36:39], v[136:139], a[128:131], v[36:39]
v_mul_f32 v79, s41, v79
v_mfma_f32_16x16x32_bf16 v[36:39], v[140:143], a[132:135], v[36:39]
ds_read_b64_tr_b16 v[96:97], v7 offset:16384
v_mfma_f32_16x16x32_bf16 v[36:39], v[144:147], a[136:139], v[36:39]
v_mfma_f32_16x16x32_bf16 v[36:39], v[148:151], a[140:143], v[36:39]
s_add_u32 m0, m0, 4096
ds_read_b64_tr_b16 v[98:99], v7 offset:18432
v_cvt_pk_bf16_f32 v164, v60, v61
v_mfma_f32_16x16x32_bf16 v[40:43], v[116:119], a[180:183], v[40:43]
s_add_u32 s31, s31, 262144
ds_read_b64_tr_b16 v[100:101], v7 offset:20480
v_mfma_f32_16x16x32_bf16 v[40:43], v[120:123], a[184:187], v[40:43]
v_cvt_pk_bf16_f32 v165, v62, v63
v_mfma_f32_16x16x32_bf16 v[40:43], v[124:127], a[188:191], v[40:43]
ds_read_b64_tr_b16 v[102:103], v7 offset:22528
v_mfma_f32_16x16x32_bf16 v[40:43], v[128:131], a[192:195], v[40:43]
buffer_load_dwordx4 v9, s[44:47], s31 offen lds
v_mfma_f32_16x16x32_bf16 v[40:43], v[132:135], a[196:199], v[40:43]
ds_read_b64_tr_b16 v[104:105], v7 offset:24576
v_cvt_pk_bf16_f32 v166, v76, v77
v_mfma_f32_16x16x32_bf16 v[40:43], v[136:139], a[200:203], v[40:43]
v_mfma_f32_16x16x32_bf16 v[40:43], v[140:143], a[204:207], v[40:43]
ds_read_b64_tr_b16 v[106:107], v7 offset:26624
v_cvt_pk_bf16_f32 v167, v78, v79
v_mfma_f32_16x16x32_bf16 v[40:43], v[144:147], a[208:211], v[40:43]
s_add_u32 m0, m0, 4096
v_mfma_f32_16x16x32_bf16 v[40:43], v[148:151], a[212:215], v[40:43]
s_add_u32 s31, s31, 262144
ds_read_b64_tr_b16 v[108:109], v7 offset:28672
v_mfma_f32_16x16x32_bf16 v[44:47], v[116:119], a[252:255], v[44:47]
s_add_u32 s35, s34, 393216
buffer_store_dwordx4 v[164:167], v2, s[56:59], s35 offen offset:1024 sc1
v_mfma_f32_16x16x32_bf16 v[44:47], v[120:123], v[168:171], v[44:47]
ds_read_b64_tr_b16 v[110:111], v7 offset:30720
v_mfma_f32_16x16x32_bf16 v[44:47], v[124:127], v[172:175], v[44:47]
buffer_load_dwordx4 v9, s[44:47], s31 offen lds
v_mfma_f32_16x16x32_bf16 v[44:47], v[128:131], v[176:179], v[44:47]
ds_read_b64_tr_b16 v[112:113], v7 offset:32768
v_mfma_f32_16x16x32_bf16 v[44:47], v[132:135], v[180:183], v[44:47]
v_mfma_f32_16x16x32_bf16 v[44:47], v[136:139], v[184:187], v[44:47]
ds_read_b64_tr_b16 v[114:115], v7 offset:34816
v_mfma_f32_16x16x32_bf16 v[44:47], v[140:143], v[188:191], v[44:47]
v_mfma_f32_16x16x32_bf16 v[44:47], v[144:147], v[192:195], v[44:47]
v_add_u32 v8, s28, v5
v_mfma_f32_16x16x32_bf16 v[44:47], v[148:151], v[196:199], v[44:47]
s_waitcnt lgkmcnt(12)
v_mfma_f32_16x16x32_bf16 v[48:51], v[80:83], a[0:3], 0
ds_read_b64_tr_b16 v[116:117], v8
v_mfma_f32_16x16x32_bf16 v[48:51], v[84:87], a[4:7], v[48:51]
ds_read_b64_tr_b16 v[118:119], v8 offset:2048
v_mfma_f32_16x16x32_bf16 v[48:51], v[88:91], a[8:11], v[48:51]
s_waitcnt lgkmcnt(8)
v_mfma_f32_16x16x32_bf16 v[48:51], v[92:95], a[12:15], v[48:51]
ds_read_b64_tr_b16 v[120:121], v8 offset:4096
v_mfma_f32_16x16x32_bf16 v[48:51], v[96:99], a[16:19], v[48:51]
v_mfma_f32_16x16x32_bf16 v[48:51], v[100:103], a[20:23], v[48:51]
s_waitcnt lgkmcnt(3)
ds_read_b64_tr_b16 v[122:123], v8 offset:6144
v_mfma_f32_16x16x32_bf16 v[48:51], v[104:107], a[24:27], v[48:51]
v_mfma_f32_16x16x32_bf16 v[48:51], v[108:111], a[28:31], v[48:51]
ds_read_b64_tr_b16 v[124:125], v8 offset:8192
v_mfma_f32_16x16x32_bf16 v[48:51], v[112:115], a[32:35], v[48:51]
v_mfma_f32_16x16x32_bf16 v[52:55], v[80:83], a[72:75], 0
ds_read_b64_tr_b16 v[126:127], v8 offset:10240
v_mul_f32 v16, s41, v16
v_mfma_f32_16x16x32_bf16 v[52:55], v[84:87], a[76:79], v[52:55]
v_mul_f32 v17, s41, v17
v_mfma_f32_16x16x32_bf16 v[52:55], v[88:91], a[80:83], v[52:55]
ds_read_b64_tr_b16 v[128:129], v8 offset:12288
v_mfma_f32_16x16x32_bf16 v[52:55], v[92:95], a[84:87], v[52:55]
v_mul_f32 v18, s41, v18
v_mfma_f32_16x16x32_bf16 v[52:55], v[96:99], a[88:91], v[52:55]
ds_read_b64_tr_b16 v[130:131], v8 offset:14336
v_mfma_f32_16x16x32_bf16 v[52:55], v[100:103], a[92:95], v[52:55]
v_mul_f32 v19, s41, v19
v_mfma_f32_16x16x32_bf16 v[52:55], v[104:107], a[96:99], v[52:55]
ds_read_b64_tr_b16 v[132:133], v8 offset:16384
v_mfma_f32_16x16x32_bf16 v[52:55], v[108:111], a[100:103], v[52:55]
v_mfma_f32_16x16x32_bf16 v[52:55], v[112:115], a[104:107], v[52:55]
s_cmp_gt_u32 s22, 4
s_cselect_b32 s74, s77, 0
s_bitcmp1_b32 s78, 0
s_cselect_b32 s74, 0, s74
ds_read_b64_tr_b16 v[134:135], v8 offset:18432
v_mul_f32 v32, s41, v32
v_mfma_f32_16x16x32_bf16 v[56:59], v[80:83], a[144:147], 0
ds_read_b64_tr_b16 v[136:137], v8 offset:20480
v_mfma_f32_16x16x32_bf16 v[56:59], v[84:87], a[148:151], v[56:59]
s_waitcnt vmcnt(26)
buffer_load_dword v232, v216, s[72:75], s76 offen
s_add_u32 s76, s76, 128
v_mul_f32 v33, s41, v33
v_mfma_f32_16x16x32_bf16 v[56:59], v[88:91], a[152:155], v[56:59]
ds_read_b64_tr_b16 v[138:139], v8 offset:22528
v_mfma_f32_16x16x32_bf16 v[56:59], v[92:95], a[156:159], v[56:59]
s_add_u32 s78, s78, 1
v_mfma_f32_16x16x32_bf16 v[56:59], v[96:99], a[160:163], v[56:59]
ds_read_b64_tr_b16 v[140:141], v8 offset:24576
v_mul_f32 v34, s41, v34
v_mfma_f32_16x16x32_bf16 v[56:59], v[100:103], a[164:167], v[56:59]
v_mfma_f32_16x16x32_bf16 v[56:59], v[104:107], a[168:171], v[56:59]
ds_read_b64_tr_b16 v[142:143], v8 offset:26624
v_mul_f32 v35, s41, v35
v_mfma_f32_16x16x32_bf16 v[56:59], v[108:111], a[172:175], v[56:59]
v_mfma_f32_16x16x32_bf16 v[56:59], v[112:115], a[176:179], v[56:59]
ds_read_b64_tr_b16 v[144:145], v8 offset:28672
v_mfma_f32_16x16x32_bf16 v[60:63], v[80:83], a[216:219], 0
v_cvt_pk_bf16_f32 v152, v16, v17
v_mfma_f32_16x16x32_bf16 v[60:63], v[84:87], a[220:223], v[60:63]
ds_read_b64_tr_b16 v[146:147], v8 offset:30720
v_mfma_f32_16x16x32_bf16 v[60:63], v[88:91], a[224:227], v[60:63]
v_cvt_pk_bf16_f32 v153, v18, v19
v_mfma_f32_16x16x32_bf16 v[60:63], v[92:95], a[228:231], v[60:63]
ds_read_b64_tr_b16 v[148:149], v8 offset:32768
v_mfma_f32_16x16x32_bf16 v[60:63], v[96:99], a[232:235], v[60:63]
v_mfma_f32_16x16x32_bf16 v[60:63], v[100:103], a[236:239], v[60:63]
ds_read_b64_tr_b16 v[150:151], v8 offset:34816
v_cvt_pk_bf16_f32 v154, v32, v33
v_mfma_f32_16x16x32_bf16 v[60:63], v[104:107], a[240:243], v[60:63]
v_mfma_f32_16x16x32_bf16 v[60:63], v[108:111], a[244:247], v[60:63]
v_add_u32 v7, s27, v6
v_cvt_pk_bf16_f32 v155, v34, v35
v_mfma_f32_16x16x32_bf16 v[60:63], v[112:115], a[248:251], v[60:63]
s_waitcnt lgkmcnt(12)
v_mfma_f32_16x16x32_bf16 v[48:51], v[116:119], a[36:39], v[48:51]
ds_read_b64_tr_b16 v[80:81], v7
v_mfma_f32_16x16x32_bf16 v[48:51], v[120:123], a[40:43], v[48:51]
ds_read_b64_tr_b16 v[82:83], v7 offset:2048
v_mfma_f32_16x16x32_bf16 v[48:51], v[124:127], a[44:47], v[48:51]
s_waitcnt lgkmcnt(8)
buffer_store_dwordx4 v[152:155], v2, s[52:55], s33 offen sc1
v_mfma_f32_16x16x32_bf16 v[48:51], v[128:131], a[48:51], v[48:51]
ds_read_b64_tr_b16 v[84:85], v7 offset:4096
v_mul_f32 v20, s41, v20
v_mfma_f32_16x16x32_bf16 v[48:51], v[132:135], a[52:55], v[48:51]
v_mfma_f32_16x16x32_bf16 v[48:51], v[136:139], a[56:59], v[48:51]
s_waitcnt lgkmcnt(3)
ds_read_b64_tr_b16 v[86:87], v7 offset:6144
v_mfma_f32_16x16x32_bf16 v[48:51], v[140:143], a[60:63], v[48:51]
v_mul_f32 v21, s41, v21
v_mfma_f32_16x16x32_bf16 v[48:51], v[144:147], a[64:67], v[48:51]
ds_read_b64_tr_b16 v[88:89], v7 offset:8192
v_mfma_f32_16x16x32_bf16 v[48:51], v[148:151], a[68:71], v[48:51]
v_mul_f32 v22, s41, v22
v_mfma_f32_16x16x32_bf16 v[52:55], v[116:119], a[108:111], v[52:55]
ds_read_b64_tr_b16 v[90:91], v7 offset:10240
v_mfma_f32_16x16x32_bf16 v[52:55], v[120:123], a[112:115], v[52:55]
v_mfma_f32_16x16x32_bf16 v[52:55], v[124:127], a[116:119], v[52:55]
ds_read_b64_tr_b16 v[92:93], v7 offset:12288
v_mul_f32 v23, s41, v23
v_mfma_f32_16x16x32_bf16 v[52:55], v[128:131], a[120:123], v[52:55]
v_mfma_f32_16x16x32_bf16 v[52:55], v[132:135], a[124:127], v[52:55]
ds_read_b64_tr_b16 v[94:95], v7 offset:14336
v_mul_f32 v36, s41, v36
v_mfma_f32_16x16x32_bf16 v[52:55], v[136:139], a[128:131], v[52:55]
v_mfma_f32_16x16x32_bf16 v[52:55], v[140:143], a[132:135], v[52:55]
ds_read_b64_tr_b16 v[96:97], v7 offset:16384
v_mfma_f32_16x16x32_bf16 v[52:55], v[144:147], a[136:139], v[52:55]
v_mul_f32 v37, s41, v37
v_mfma_f32_16x16x32_bf16 v[52:55], v[148:151], a[140:143], v[52:55]
ds_read_b64_tr_b16 v[98:99], v7 offset:18432
v_mfma_f32_16x16x32_bf16 v[56:59], v[116:119], a[180:183], v[56:59]
ds_read_b64_tr_b16 v[100:101], v7 offset:20480
v_mul_f32 v38, s41, v38
v_mfma_f32_16x16x32_bf16 v[56:59], v[120:123], a[184:187], v[56:59]
v_mfma_f32_16x16x32_bf16 v[56:59], v[124:127], a[188:191], v[56:59]
ds_read_b64_tr_b16 v[102:103], v7 offset:22528
v_mfma_f32_16x16x32_bf16 v[56:59], v[128:131], a[192:195], v[56:59]
v_mul_f32 v39, s41, v39
v_mfma_f32_16x16x32_bf16 v[56:59], v[132:135], a[196:199], v[56:59]
ds_read_b64_tr_b16 v[104:105], v7 offset:24576
v_mfma_f32_16x16x32_bf16 v[56:59], v[136:139], a[200:203], v[56:59]
v_cvt_pk_bf16_f32 v156, v20, v21
v_mfma_f32_16x16x32_bf16 v[56:59], v[140:143], a[204:207], v[56:59]
ds_read_b64_tr_b16 v[106:107], v7 offset:26624
v_mfma_f32_16x16x32_bf16 v[56:59], v[144:147], a[208:211], v[56:59]
v_mfma_f32_16x16x32_bf16 v[56:59], v[148:151], a[212:215], v[56:59]
ds_read_b64_tr_b16 v[108:109], v7 offset:28672
v_cvt_pk_bf16_f32 v157, v22, v23
v_mfma_f32_16x16x32_bf16 v[60:63], v[116:119], a[252:255], v[60:63]
v_mfma_f32_16x16x32_bf16 v[60:63], v[120:123], v[168:171], v[60:63]
ds_read_b64_tr_b16 v[110:111], v7 offset:30720
v_cvt_pk_bf16_f32 v158, v36, v37
v_mfma_f32_16x16x32_bf16 v[60:63], v[124:127], v[172:175], v[60:63]
v_mfma_f32_16x16x32_bf16 v[60:63], v[128:131], v[176:179], v[60:63]
ds_read_b64_tr_b16 v[112:113], v7 offset:32768
v_mfma_f32_16x16x32_bf16 v[60:63], v[132:135], v[180:183], v[60:63]
v_cvt_pk_bf16_f32 v159, v38, v39
v_mfma_f32_16x16x32_bf16 v[60:63], v[136:139], v[184:187], v[60:63]
ds_read_b64_tr_b16 v[114:115], v7 offset:34816
v_mfma_f32_16x16x32_bf16 v[60:63], v[140:143], v[188:191], v[60:63]
s_add_u32 s35, s33, 131072
buffer_store_dwordx4 v[156:159], v2, s[52:55], s35 offen sc1
v_mfma_f32_16x16x32_bf16 v[60:63], v[144:147], v[192:195], v[60:63]
v_add_u32 v8, s28, v6
v_mfma_f32_16x16x32_bf16 v[60:63], v[148:151], v[196:199], v[60:63]
s_waitcnt lgkmcnt(12)
v_mfma_f32_16x16x32_bf16 v[64:67], v[80:83], a[0:3], 0
ds_read_b64_tr_b16 v[116:117], v8
v_mul_f32 v24, s41, v24
v_mfma_f32_16x16x32_bf16 v[64:67], v[84:87], a[4:7], v[64:67]
ds_read_b64_tr_b16 v[118:119], v8 offset:2048
v_mfma_f32_16x16x32_bf16 v[64:67], v[88:91], a[8:11], v[64:67]
s_waitcnt lgkmcnt(8)
v_mfma_f32_16x16x32_bf16 v[64:67], v[92:95], a[12:15], v[64:67]
ds_read_b64_tr_b16 v[120:121], v8 offset:4096
v_mul_f32 v25, s41, v25
v_mfma_f32_16x16x32_bf16 v[64:67], v[96:99], a[16:19], v[64:67]
v_mfma_f32_16x16x32_bf16 v[64:67], v[100:103], a[20:23], v[64:67]
s_waitcnt lgkmcnt(3)
ds_read_b64_tr_b16 v[122:123], v8 offset:6144
v_mul_f32 v26, s41, v26
v_mfma_f32_16x16x32_bf16 v[64:67], v[104:107], a[24:27], v[64:67]
v_mfma_f32_16x16x32_bf16 v[64:67], v[108:111], a[28:31], v[64:67]
ds_read_b64_tr_b16 v[124:125], v8 offset:8192
v_mfma_f32_16x16x32_bf16 v[64:67], v[112:115], a[32:35], v[64:67]
v_mul_f32 v27, s41, v27
v_mfma_f32_16x16x32_bf16 v[68:71], v[80:83], a[72:75], 0
ds_read_b64_tr_b16 v[126:127], v8 offset:10240
v_mfma_f32_16x16x32_bf16 v[68:71], v[84:87], a[76:79], v[68:71]
v_mul_f32 v40, s41, v40
v_mfma_f32_16x16x32_bf16 v[68:71], v[88:91], a[80:83], v[68:71]
ds_read_b64_tr_b16 v[128:129], v8 offset:12288
v_mfma_f32_16x16x32_bf16 v[68:71], v[92:95], a[84:87], v[68:71]
v_mfma_f32_16x16x32_bf16 v[68:71], v[96:99], a[88:91], v[68:71]
ds_read_b64_tr_b16 v[130:131], v8 offset:14336
v_mul_f32 v41, s41, v41
v_mfma_f32_16x16x32_bf16 v[68:71], v[100:103], a[92:95], v[68:71]
v_mfma_f32_16x16x32_bf16 v[68:71], v[104:107], a[96:99], v[68:71]
ds_read_b64_tr_b16 v[132:133], v8 offset:16384
v_mul_f32 v42, s41, v42
v_mfma_f32_16x16x32_bf16 v[68:71], v[108:111], a[100:103], v[68:71]
v_mfma_f32_16x16x32_bf16 v[68:71], v[112:115], a[104:107], v[68:71]
ds_read_b64_tr_b16 v[134:135], v8 offset:18432
v_mfma_f32_16x16x32_bf16 v[72:75], v[80:83], a[144:147], 0
ds_read_b64_tr_b16 v[136:137], v8 offset:20480
v_mul_f32 v43, s41, v43
v_mfma_f32_16x16x32_bf16 v[72:75], v[84:87], a[148:151], v[72:75]
v_mfma_f32_16x16x32_bf16 v[72:75], v[88:91], a[152:155], v[72:75]
ds_read_b64_tr_b16 v[138:139], v8 offset:22528
v_cvt_pk_bf16_f32 v160, v24, v25
v_mfma_f32_16x16x32_bf16 v[72:75], v[92:95], a[156:159], v[72:75]
v_mfma_f32_16x16x32_bf16 v[72:75], v[96:99], a[160:163], v[72:75]
ds_read_b64_tr_b16 v[140:141], v8 offset:24576
v_mfma_f32_16x16x32_bf16 v[72:75], v[100:103], a[164:167], v[72:75]
v_cvt_pk_bf16_f32 v161, v26, v27
v_mfma_f32_16x16x32_bf16 v[72:75], v[104:107], a[168:171], v[72:75]
ds_read_b64_tr_b16 v[142:143], v8 offset:26624
v_mfma_f32_16x16x32_bf16 v[72:75], v[108:111], a[172:175], v[72:75]
v_cvt_pk_bf16_f32 v162, v40, v41
v_mfma_f32_16x16x32_bf16 v[72:75], v[112:115], a[176:179], v[72:75]
ds_read_b64_tr_b16 v[144:145], v8 offset:28672
v_mfma_f32_16x16x32_bf16 v[76:79], v[80:83], a[216:219], 0
v_mfma_f32_16x16x32_bf16 v[76:79], v[84:87], a[220:223], v[76:79]
ds_read_b64_tr_b16 v[146:147], v8 offset:30720
v_cvt_pk_bf16_f32 v163, v42, v43
v_mfma_f32_16x16x32_bf16 v[76:79], v[88:91], a[224:227], v[76:79]
v_mfma_f32_16x16x32_bf16 v[76:79], v[92:95], a[228:231], v[76:79]
ds_read_b64_tr_b16 v[148:149], v8 offset:32768
v_mfma_f32_16x16x32_bf16 v[76:79], v[96:99], a[232:235], v[76:79]
s_add_u32 s35, s33, 262144
buffer_store_dwordx4 v[160:163], v2, s[52:55], s35 offen sc1
v_mfma_f32_16x16x32_bf16 v[76:79], v[100:103], a[236:239], v[76:79]
ds_read_b64_tr_b16 v[150:151], v8 offset:34816
v_mfma_f32_16x16x32_bf16 v[76:79], v[104:107], a[240:243], v[76:79]
v_mul_f32 v28, s41, v28
v_mfma_f32_16x16x32_bf16 v[76:79], v[108:111], a[244:247], v[76:79]
v_mfma_f32_16x16x32_bf16 v[76:79], v[112:115], a[248:251], v[76:79]
s_waitcnt lgkmcnt(12)
v_mul_f32 v29, s41, v29
v_mfma_f32_16x16x32_bf16 v[64:67], v[116:119], a[36:39], v[64:67]
v_mfma_f32_16x16x32_bf16 v[64:67], v[120:123], a[40:43], v[64:67]
v_mfma_f32_16x16x32_bf16 v[64:67], v[124:127], a[44:47], v[64:67]
s_waitcnt lgkmcnt(6)
v_mul_f32 v30, s41, v30
v_mfma_f32_16x16x32_bf16 v[64:67], v[128:131], a[48:51], v[64:67]
v_mfma_f32_16x16x32_bf16 v[64:67], v[132:135], a[52:55], v[64:67]
v_mul_f32 v31, s41, v31
v_mfma_f32_16x16x32_bf16 v[64:67], v[136:139], a[56:59], v[64:67]
s_waitcnt lgkmcnt(0)
v_mfma_f32_16x16x32_bf16 v[64:67], v[140:143], a[60:63], v[64:67]
v_mfma_f32_16x16x32_bf16 v[64:67], v[144:147], a[64:67], v[64:67]
v_mul_f32 v44, s41, v44
v_mfma_f32_16x16x32_bf16 v[64:67], v[148:151], a[68:71], v[64:67]
v_add_u32 v7, s29, v3
v_mfma_f32_16x16x32_bf16 v[68:71], v[116:119], a[108:111], v[68:71]
s_waitcnt vmcnt(4)
s_barrier
v_mul_f32 v45, s41, v45
v_mfma_f32_16x16x32_bf16 v[68:71], v[120:123], a[112:115], v[68:71]
ds_read_b64_tr_b16 v[80:81], v7
v_mfma_f32_16x16x32_bf16 v[68:71], v[124:127], a[116:119], v[68:71]
s_xor_b32 s27, s27, 73728
ds_read_b64_tr_b16 v[82:83], v7 offset:2048
v_mfma_f32_16x16x32_bf16 v[68:71], v[128:131], a[120:123], v[68:71]
ds_read_b64_tr_b16 v[84:85], v7 offset:4096
v_mul_f32 v46, s41, v46
v_mfma_f32_16x16x32_bf16 v[68:71], v[132:135], a[124:127], v[68:71]
s_xor_b32 s29, s29, 73728
ds_read_b64_tr_b16 v[86:87], v7 offset:6144
v_mfma_f32_16x16x32_bf16 v[68:71], v[136:139], a[128:131], v[68:71]
ds_read_b64_tr_b16 v[88:89], v7 offset:8192
v_mul_f32 v47, s41, v47
v_mfma_f32_16x16x32_bf16 v[68:71], v[140:143], a[132:135], v[68:71]
s_add_u32 s28, s27, 36864
ds_read_b64_tr_b16 v[90:91], v7 offset:10240
v_mfma_f32_16x16x32_bf16 v[68:71], v[144:147], a[136:139], v[68:71]
v_mfma_f32_16x16x32_bf16 v[68:71], v[148:151], a[140:143], v[68:71]
s_sub_u32 s22, s22, 1
ds_read_b64_tr_b16 v[92:93], v7 offset:12288
v_cvt_pk_bf16_f32 v164, v28, v29
v_mfma_f32_16x16x32_bf16 v[72:75], v[116:119], a[180:183], v[72:75]
ds_read_b64_tr_b16 v[94:95], v7 offset:14336
v_mfma_f32_16x16x32_bf16 v[72:75], v[120:123], a[184:187], v[72:75]
ds_read_b64_tr_b16 v[96:97], v7 offset:16384
v_cvt_pk_bf16_f32 v165, v30, v31
v_mfma_f32_16x16x32_bf16 v[72:75], v[124:127], a[188:191], v[72:75]
ds_read_b64_tr_b16 v[98:99], v7 offset:18432
v_mfma_f32_16x16x32_bf16 v[72:75], v[128:131], a[192:195], v[72:75]
ds_read_b64_tr_b16 v[100:101], v7 offset:20480
v_mfma_f32_16x16x32_bf16 v[72:75], v[132:135], a[196:199], v[72:75]
ds_read_b64_tr_b16 v[102:103], v7 offset:22528
v_cvt_pk_bf16_f32 v166, v44, v45
v_mfma_f32_16x16x32_bf16 v[72:75], v[136:139], a[200:203], v[72:75]
v_mfma_f32_16x16x32_bf16 v[72:75], v[140:143], a[204:207], v[72:75]
ds_read_b64_tr_b16 v[104:105], v7 offset:24576
v_cvt_pk_bf16_f32 v167, v46, v47
v_mfma_f32_16x16x32_bf16 v[72:75], v[144:147], a[208:211], v[72:75]
ds_read_b64_tr_b16 v[106:107], v7 offset:26624
v_mfma_f32_16x16x32_bf16 v[72:75], v[148:151], a[212:215], v[72:75]
ds_read_b64_tr_b16 v[108:109], v7 offset:28672
v_mfma_f32_16x16x32_bf16 v[76:79], v[116:119], a[252:255], v[76:79]
ds_read_b64_tr_b16 v[110:111], v7 offset:30720
v_mfma_f32_16x16x32_bf16 v[76:79], v[120:123], v[168:171], v[76:79]
ds_read_b64_tr_b16 v[112:113], v7 offset:32768
v_mfma_f32_16x16x32_bf16 v[76:79], v[124:127], v[172:175], v[76:79]
ds_read_b64_tr_b16 v[114:115], v7 offset:34816
v_mfma_f32_16x16x32_bf16 v[76:79], v[128:131], v[176:179], v[76:79]
s_add_u32 s35, s33, 393216
buffer_store_dwordx4 v[164:167], v2, s[52:55], s35 offen sc1
v_mfma_f32_16x16x32_bf16 v[76:79], v[132:135], v[180:183], v[76:79]
v_mfma_f32_16x16x32_bf16 v[76:79], v[136:139], v[184:187], v[76:79]
v_mfma_f32_16x16x32_bf16 v[76:79], v[140:143], v[188:191], v[76:79]
v_mfma_f32_16x16x32_bf16 v[76:79], v[144:147], v[192:195], v[76:79]
v_mfma_f32_16x16x32_bf16 v[76:79], v[148:151], v[196:199], v[76:79]
s_mov_b32 s34, s33
s_mov_b32 s58, s54
s_add_u32 s33, s33, 2048
s_cmp_lg_u32 s22, 0
s_cbranch_scc1 L_p1_loopQ
s_nop 7
v_mul_f32 v48, s41, v48
v_mul_f32 v49, s41, v49
v_mul_f32 v50, s41, v50
v_mul_f32 v51, s41, v51
v_mul_f32 v64, s41, v64
v_mul_f32 v65, s41, v65
v_mul_f32 v66, s41, v66
v_mul_f32 v67, s41, v67
v_cvt_pk_bf16_f32 v152, v48, v49
v_cvt_pk_bf16_f32 v153, v50, v51
v_cvt_pk_bf16_f32 v154, v64, v65
v_cvt_pk_bf16_f32 v155, v66, v67
buffer_store_dwordx4 v[152:155], v2, s[56:59], s34 offen offset:1024 sc1
v_mul_f32 v52, s41, v52
v_mul_f32 v53, s41, v53
v_mul_f32 v54, s41, v54
v_mul_f32 v55, s41, v55
v_mul_f32 v68, s41, v68
v_mul_f32 v69, s41, v69
v_mul_f32 v70, s41, v70
v_mul_f32 v71, s41, v71
v_cvt_pk_bf16_f32 v156, v52, v53
v_cvt_pk_bf16_f32 v157, v54, v55
v_cvt_pk_bf16_f32 v158, v68, v69
v_cvt_pk_bf16_f32 v159, v70, v71
s_add_u32 s35, s34, 131072
buffer_store_dwordx4 v[156:159], v2, s[56:59], s35 offen offset:1024 sc1
v_mul_f32 v56, s41, v56
v_mul_f32 v57, s41, v57
v_mul_f32 v58, s41, v58
v_mul_f32 v59, s41, v59
v_mul_f32 v72, s41, v72
v_mul_f32 v73, s41, v73
v_mul_f32 v74, s41, v74
v_mul_f32 v75, s41, v75
v_cvt_pk_bf16_f32 v160, v56, v57
v_cvt_pk_bf16_f32 v161, v58, v59
v_cvt_pk_bf16_f32 v162, v72, v73
v_cvt_pk_bf16_f32 v163, v74, v75
s_add_u32 s35, s34, 262144
buffer_store_dwordx4 v[160:163], v2, s[56:59], s35 offen offset:1024 sc1
v_mul_f32 v60, s41, v60
v_mul_f32 v61, s41, v61
v_mul_f32 v62, s41, v62
v_mul_f32 v63, s41, v63
v_mul_f32 v76, s41, v76
v_mul_f32 v77, s41, v77
v_mul_f32 v78, s41, v78
v_mul_f32 v79, s41, v79
v_cvt_pk_bf16_f32 v164, v60, v61
v_cvt_pk_bf16_f32 v165, v62, v63
v_cvt_pk_bf16_f32 v166, v76, v77
v_cvt_pk_bf16_f32 v167, v78, v79
s_add_u32 s35, s34, 393216
buffer_store_dwordx4 v[164:167], v2, s[56:59], s35 offen offset:1024 sc1
s_cmp_eq_u32 s23, 0
s_cbranch_scc1 L_p1_fin
s_mov_b32 s25, 0
s_mov_b32 s22, 4
s_mov_b32 s23, 0
s_mov_b32 s21, 140
s_waitcnt vmcnt(0) lgkmcnt(0)
s_barrier
s_branch L_p1_segG
L_p1_segG:
s_load_dwordx2 s[64:65], s[0:1], 56
s_load_dwordx2 s[66:67], s[0:1], 64
s_load_dwordx2 s[68:69], s[0:1], 96
v_and_b32 v10, 63, v0
v_lshlrev_b32 v2, 4, v10
v_lshrrev_b32 v11, 2, v10
v_mul_u32_u24 v11, 9216, v11
v_lshrrev_b32 v12, 4, v10
v_and_b32 v12, 1, v12
v_lshlrev_b32 v12, 1, v12
v_and_b32 v13, 3, v10
v_xor_b32 v12, v12, v13
v_lshl_add_u32 v9, v12, 4, v11
v_lshrrev_b32 v11, 2, v10
v_and_b32 v12, 3, v10
v_lshlrev_b32 v12, 3, v12
v_lshl_add_u32 v12, v11, 6, v12
v_lshrrev_b32 v13, 2, v11
v_and_b32 v13, 1, v13
v_xor_b32 v14, 0, v13
v_lshl_add_u32 v3, v14, 5, v12
v_add_u32 v5, 36864, v3
v_xor_b32 v14, 1, v13
v_lshl_add_u32 v4, v14, 5, v12
v_add_u32 v6, 36864, v4
v_mov_b32 v15, 0xc0135761
s_waitcnt lgkmcnt(0)
s_mov_b32 s44, s64
s_mov_b32 s45, s65
s_mov_b32 s46, 0x510000
s_mov_b32 s47, 0x20000
s_mov_b32 s48, s66
s_mov_b32 s49, s67
s_mov_b32 s50, 0x510000
s_mov_b32 s51, 0x20000
s_add_u32 s52, s68, 0x3800000
s_addc_u32 s53, s69, 0
s_mov_b32 s54, 0x1200000
s_mov_b32 s55, 0x20000
s_add_u32 s56, s68, 0x3800000
s_addc_u32 s57, s69, 0
s_mov_b32 s58, 0x0
s_mov_b32 s59, 0x20000
s_mul_i32 s32, s21, 64
s_mul_i32 s35, s20, 147456
s_add_u32 s32, s32, s35
s_lshl_b32 s30, s20, 10
s_mov_b32 s27, 0
s_mov_b32 s28, 18432
s_mov_b32 s29, 73728
s_mul_i32 s33, s26, 147456
s_lshl_b32 s35, s21, 10
s_add_u32 s33, s33, s35
s_mov_b32 s34, s33
s_lshr_b32 s35, s26, 4
s_mul_i32 s35, s35, 663552
s_add_u32 s36, s21, 4
s_mul_i32 s36, s36, 64
s_add_u32 s76, s35, s36
v_and_b32 v10, 127, v0
v_mul_u32_u24 v216, 9216, v10
s_cmp_lt_u32 s20, 2
s_cselect_b32 s72, s44, s48
s_cselect_b32 s73, s45, s49
s_cselect_b32 s74, s46, s50
s_cselect_b32 s75, s47, s51
s_mov_b32 s75, 0x20000
v_mov_b32 v12, 0x7fffffff
v_cmp_gt_u32 vcc, 72, v10
s_nop 1
v_cndmask_b32 v216, v12, v216, vcc
s_mov_b32 s77, s74
s_cmp_eq_u32 s25, 0
s_cbranch_scc1 L_p1_oldG
s_getpc_b64 s[90:91]
L_ct_p1G:
s_add_u32 s90, s90, L_p1_tkjG-L_ct_p1G
s_addc_u32 s91, s91, 0
s_lshr_b32 s35, s2, 3
s_and_b32 s35, s35, 3
s_mul_i32 s35, s35, 8192
v_min_u32 v238, 63, v0
v_lshlrev_b32 v238, 7, v238
v_add_u32 v238, s35, v238
global_load_dword v239, v238, s[90:91]
s_branch L_p1_tkjG
L_p1_taskG:
v_and_b32 v97, 63, v0
v_lshrrev_b32 v99, 4, v97
v_and_b32 v100, 15, v97
s_lshr_b32 s80, s26, 4
s_lshl_b32 s80, s80, 8
s_lshl_b32 s81, s42, 3
s_add_u32 s80, s80, s81
s_and_b32 s81, s20, 1
s_lshl_b32 s81, s81, 2
s_add_u32 s80, s80, s81
v_add_u32 v101, s80, v99
v_lshrrev_b32 v102, 3, v100
v_lshlrev_b32 v102, 10, v102
v_and_b32 v103, 3, v100
v_lshlrev_b32 v103, 4, v103
v_and_b32 v104, 15, v101
v_add_u32 v103, v103, v104
v_lshlrev_b32 v103, 4, v103
v_add_u32 v102, v102, v103
v_lshrrev_b32 v103, 2, v100
v_and_b32 v103, 1, v103
v_lshlrev_b32 v103, 3, v103
v_add_u32 v102, v102, v103
v_lshrrev_b32 v105, 4, v101
s_cmp_ge_u32 s20, 2
s_cbranch_scc1 L_p1_cklG
s_mov_b32 s8, s4
s_mov_b32 s9, s5
s_mov_b32 s10, 0x240000
s_mov_b32 s11, 0x20000
s_mov_b32 s16, s68
s_mov_b32 s17, s69
s_mov_b32 s18, 0x240000
s_mov_b32 s19, 0x20000
s_movk_i32 s80, 1152
v_mul_lo_u32 v106, v101, s80
v_lshl_add_u32 v106, v100, 3, v106
buffer_load_dwordx2 v[108:109], v106, s[8:11], 0 offen
buffer_load_dwordx2 v[110:111], v106, s[8:11], 0 offen offset:128
buffer_load_dwordx2 v[112:113], v106, s[8:11], 0 offen offset:256
buffer_load_dwordx2 v[114:115], v106, s[8:11], 0 offen offset:384
buffer_load_dwordx2 v[116:117], v106, s[8:11], 0 offen offset:512
buffer_load_dwordx2 v[118:119], v106, s[8:11], 0 offen offset:640
buffer_load_dwordx2 v[120:121], v106, s[8:11], 0 offen offset:768
buffer_load_dwordx2 v[122:123], v106, s[8:11], 0 offen offset:896
buffer_load_dwordx2 v[124:125], v106, s[8:11], 0 offen offset:1024
s_movk_i32 s80, 18432
v_mul_lo_u32 v105, v105, s80
v_add_u32 v102, v102, v105
s_branch L_p1_tkjG
L_p1_cklG:
s_mov_b32 s8, s6
s_mov_b32 s9, s7
s_mov_b32 s10, 0x200000
s_mov_b32 s11, 0x20000
s_add_u32 s16, s68, 0x400000
s_addc_u32 s17, s69, 0
s_mov_b32 s18, 0x200000
s_mov_b32 s19, 0x20000
v_lshlrev_b32 v106, 10, v101
v_lshl_add_u32 v106, v100, 3, v106
buffer_load_dwordx2 v[108:109], v106, s[8:11], 0 offen
buffer_load_dwordx2 v[110:111], v106, s[8:11], 0 offen offset:128
buffer_load_dwordx2 v[112:113], v106, s[8:11], 0 offen offset:256
buffer_load_dwordx2 v[114:115], v106, s[8:11], 0 offen offset:384
buffer_load_dwordx2 v[116:117], v106, s[8:11], 0 offen offset:512
buffer_load_dwordx2 v[118:119], v106, s[8:11], 0 offen offset:640
buffer_load_dwordx2 v[120:121], v106, s[8:11], 0 offen offset:768
buffer_load_dwordx2 v[122:123], v106, s[8:11], 0 offen offset:896
v_mov_b32 v107, 0x7fffffff
buffer_load_dwordx2 v[124:125], v107, s[8:11], 0 offen
v_lshlrev_b32 v105, 14, v105
v_add_u32 v102, v102, v105
L_p1_tkjG:
s_cmp_lg_u32 s43, 0
s_cbranch_scc1 L_p1_tkwG
s_branch L_p1_tkcG
L_p1_tkwG:
s_waitcnt vmcnt(0)
L_p1_tkcG:
s_cmp_ge_u32 s20, 2
s_cbranch_scc1 L_p1_ckcG
s_waitcnt vmcnt(9)
v_lshlrev_b32 v128, 16, v108
v_and_b32 v129, 0xffff0000, v108
v_lshlrev_b32 v130, 16, v109
v_and_b32 v131, 0xffff0000, v109
s_waitcnt vmcnt(8)
v_lshlrev_b32 v132, 16, v110
v_and_b32 v133, 0xffff0000, v110
v_lshlrev_b32 v134, 16, v111
v_and_b32 v135, 0xffff0000, v111
s_waitcnt vmcnt(7)
v_lshlrev_b32 v136, 16, v112
v_and_b32 v137, 0xffff0000, v112
v_lshlrev_b32 v138, 16, v113
v_and_b32 v139, 0xffff0000, v113
s_waitcnt vmcnt(6)
v_lshlrev_b32 v140, 16, v114
v_and_b32 v141, 0xffff0000, v114
v_lshlrev_b32 v142, 16, v115
v_and_b32 v143, 0xffff0000, v115
s_waitcnt vmcnt(5)
v_lshlrev_b32 v144, 16, v116
v_and_b32 v145, 0xffff0000, v116
v_lshlrev_b32 v146, 16, v117
v_and_b32 v147, 0xffff0000, v117
s_waitcnt vmcnt(4)
v_lshlrev_b32 v148, 16, v118
v_and_b32 v149, 0xffff0000, v118
v_lshlrev_b32 v150, 16, v119
v_and_b32 v151, 0xffff0000, v119
s_waitcnt vmcnt(3)
v_lshlrev_b32 v152, 16, v120
v_and_b32 v153, 0xffff0000, v120
v_lshlrev_b32 v154, 16, v121
v_and_b32 v155, 0xffff0000, v121
s_waitcnt vmcnt(2)
v_lshlrev_b32 v156, 16, v122
v_and_b32 v157, 0xffff0000, v122
v_lshlrev_b32 v158, 16, v123
v_and_b32 v159, 0xffff0000, v123
s_waitcnt vmcnt(1)
v_lshlrev_b32 v160, 16, v124
v_and_b32 v161, 0xffff0000, v124
v_lshlrev_b32 v162, 16, v125
v_and_b32 v163, 0xffff0000, v125
v_add_f32 v166, v128, v129
v_add_f32 v167, v130, v131
v_add_f32 v168, v132, v133
v_add_f32 v169, v134, v135
v_add_f32 v166, v166, v136
v_add_f32 v167, v167, v137
v_add_f32 v168, v168, v138
v_add_f32 v169, v169, v139
v_add_f32 v166, v166, v140
v_add_f32 v167, v167, v141
v_add_f32 v168, v168, v142
v_add_f32 v169, v169, v143
v_add_f32 v166, v166, v144
v_add_f32 v167, v167, v145
v_add_f32 v168, v168, v146
v_add_f32 v169, v169, v147
v_add_f32 v166, v166, v148
v_add_f32 v167, v167, v149
v_add_f32 v168, v168, v150
v_add_f32 v169, v169, v151
v_add_f32 v166, v166, v152
v_add_f32 v167, v167, v153
v_add_f32 v168, v168, v154
v_add_f32 v169, v169, v155
v_add_f32 v166, v166, v156
v_add_f32 v167, v167, v157
v_add_f32 v168, v168, v158
v_add_f32 v169, v169, v159
v_add_f32 v166, v166, v160
v_add_f32 v167, v167, v161
v_add_f32 v168, v168, v162
v_add_f32 v169, v169, v163
v_add_f32 v166, v166, v167
v_add_f32 v168, v168, v169
s_nop 0
v_add_f32 v166, v166, v168
s_nop 1
v_add_f32_dpp v166, v166, v166 row_ror:8 row_mask:0xf bank_mask:0xf
s_nop 1
v_add_f32_dpp v166, v166, v166 row_ror:4 row_mask:0xf bank_mask:0xf
s_nop 1
v_add_f32_dpp v166, v166, v166 row_ror:2 row_mask:0xf bank_mask:0xf
s_nop 1
v_add_f32_dpp v166, v166, v166 row_ror:1 row_mask:0xf bank_mask:0xf
s_mov_b32 s80, 0x3ae38e39
v_mul_f32 v166, s80, v166
v_sub_f32 v170, v128, v166
v_mul_f32 v172, v170, v170
v_sub_f32 v170, v129, v166
v_mul_f32 v173, v170, v170
v_sub_f32 v170, v130, v166
v_mul_f32 v174, v170, v170
v_sub_f32 v170, v131, v166
v_mul_f32 v175, v170, v170
v_sub_f32 v170, v132, v166
v_fmac_f32 v172, v170, v170
v_sub_f32 v170, v133, v166
v_fmac_f32 v173, v170, v170
v_sub_f32 v170, v134, v166
v_fmac_f32 v174, v170, v170
v_sub_f32 v170, v135, v166
v_fmac_f32 v175, v170, v170
v_sub_f32 v170, v136, v166
v_fmac_f32 v172, v170, v170
v_sub_f32 v170, v137, v166
v_fmac_f32 v173, v170, v170
v_sub_f32 v170, v138, v166
v_fmac_f32 v174, v170, v170
v_sub_f32 v170, v139, v166
v_fmac_f32 v175, v170, v170
v_sub_f32 v170, v140, v166
v_fmac_f32 v172, v170, v170
v_sub_f32 v170, v141, v166
v_fmac_f32 v173, v170, v170
v_sub_f32 v170, v142, v166
v_fmac_f32 v174, v170, v170
v_sub_f32 v170, v143, v166
v_fmac_f32 v175, v170, v170
v_sub_f32 v170, v144, v166
v_fmac_f32 v172, v170, v170
v_sub_f32 v170, v145, v166
v_fmac_f32 v173, v170, v170
v_sub_f32 v170, v146, v166
v_fmac_f32 v174, v170, v170
v_sub_f32 v170, v147, v166
v_fmac_f32 v175, v170, v170
v_sub_f32 v170, v148, v166
v_fmac_f32 v172, v170, v170
v_sub_f32 v170, v149, v166
v_fmac_f32 v173, v170, v170
v_sub_f32 v170, v150, v166
v_fmac_f32 v174, v170, v170
v_sub_f32 v170, v151, v166
v_fmac_f32 v175, v170, v170
v_sub_f32 v170, v152, v166
v_fmac_f32 v172, v170, v170
v_sub_f32 v170, v153, v166
v_fmac_f32 v173, v170, v170
v_sub_f32 v170, v154, v166
v_fmac_f32 v174, v170, v170
v_sub_f32 v170, v155, v166
v_fmac_f32 v175, v170, v170
v_sub_f32 v170, v156, v166
v_fmac_f32 v172, v170, v170
v_sub_f32 v170, v157, v166
v_fmac_f32 v173, v170, v170
v_sub_f32 v170, v158, v166
v_fmac_f32 v174, v170, v170
v_sub_f32 v170, v159, v166
v_fmac_f32 v175, v170, v170
v_sub_f32 v170, v160, v166
v_fmac_f32 v172, v170, v170
v_sub_f32 v170, v161, v166
v_fmac_f32 v173, v170, v170
v_sub_f32 v170, v162, v166
v_fmac_f32 v174, v170, v170
v_sub_f32 v170, v163, v166
v_fmac_f32 v175, v170, v170
v_add_f32 v172, v172, v173
v_add_f32 v174, v174, v175
s_nop 0
v_add_f32 v172, v172, v174
s_nop 1
v_add_f32_dpp v172, v172, v172 row_ror:8 row_mask:0xf bank_mask:0xf
s_nop 1
v_add_f32_dpp v172, v172, v172 row_ror:4 row_mask:0xf bank_mask:0xf
s_nop 1
v_add_f32_dpp v172, v172, v172 row_ror:2 row_mask:0xf bank_mask:0xf
s_nop 1
v_add_f32_dpp v172, v172, v172 row_ror:1 row_mask:0xf bank_mask:0xf
v_mul_f32 v172, s80, v172
v_cvt_pk_bf16_f32 v166, v166, v172
v_and_b32 v172, 0xffff0000, v166
v_lshlrev_b32 v166, 16, v166
v_add_f32 v172, 0x3727c5ac, v172
v_cvt_pk_bf16_f32 v172, v172, v172
v_lshlrev_b32 v172, 16, v172
v_sqrt_f32 v172, v172
s_nop 0
v_cvt_pk_bf16_f32 v172, v172, v172
v_lshlrev_b32 v172, 16, v172
v_rcp_f32 v173, v172
s_nop 0
v_sub_f32 v128, v128, v166
v_sub_f32 v129, v129, v166
v_cvt_pk_bf16_f32 v176, v128, v129
v_lshlrev_b32 v177, 16, v176
v_and_b32 v178, 0xffff0000, v176
v_mul_f32 v179, v177, v173
v_mul_f32 v180, v178, v173
v_cvt_pk_bf16_f32 v108, v179, v180
v_sub_f32 v130, v130, v166
v_sub_f32 v131, v131, v166
v_cvt_pk_bf16_f32 v176, v130, v131
v_lshlrev_b32 v177, 16, v176
v_and_b32 v178, 0xffff0000, v176
v_mul_f32 v179, v177, v173
v_mul_f32 v180, v178, v173
v_cvt_pk_bf16_f32 v109, v179, v180
v_sub_f32 v132, v132, v166
v_sub_f32 v133, v133, v166
v_cvt_pk_bf16_f32 v176, v132, v133
v_lshlrev_b32 v177, 16, v176
v_and_b32 v178, 0xffff0000, v176
v_mul_f32 v179, v177, v173
v_mul_f32 v180, v178, v173
v_cvt_pk_bf16_f32 v110, v179, v180
v_sub_f32 v134, v134, v166
v_sub_f32 v135, v135, v166
v_cvt_pk_bf16_f32 v176, v134, v135
v_lshlrev_b32 v177, 16, v176
v_and_b32 v178, 0xffff0000, v176
v_mul_f32 v179, v177, v173
v_mul_f32 v180, v178, v173
v_cvt_pk_bf16_f32 v111, v179, v180
v_sub_f32 v136, v136, v166
v_sub_f32 v137, v137, v166
v_cvt_pk_bf16_f32 v176, v136, v137
v_lshlrev_b32 v177, 16, v176
v_and_b32 v178, 0xffff0000, v176
v_mul_f32 v179, v177, v173
v_mul_f32 v180, v178, v173
v_cvt_pk_bf16_f32 v112, v179, v180
v_sub_f32 v138, v138, v166
v_sub_f32 v139, v139, v166
v_cvt_pk_bf16_f32 v176, v138, v139
v_lshlrev_b32 v177, 16, v176
v_and_b32 v178, 0xffff0000, v176
v_mul_f32 v179, v177, v173
v_mul_f32 v180, v178, v173
v_cvt_pk_bf16_f32 v113, v179, v180
v_sub_f32 v140, v140, v166
v_sub_f32 v141, v141, v166
v_cvt_pk_bf16_f32 v176, v140, v141
v_lshlrev_b32 v177, 16, v176
v_and_b32 v178, 0xffff0000, v176
v_mul_f32 v179, v177, v173
v_mul_f32 v180, v178, v173
v_cvt_pk_bf16_f32 v114, v179, v180
v_sub_f32 v142, v142, v166
v_sub_f32 v143, v143, v166
v_cvt_pk_bf16_f32 v176, v142, v143
v_lshlrev_b32 v177, 16, v176
v_and_b32 v178, 0xffff0000, v176
v_mul_f32 v179, v177, v173
v_mul_f32 v180, v178, v173
v_cvt_pk_bf16_f32 v115, v179, v180
v_sub_f32 v144, v144, v166
v_sub_f32 v145, v145, v166
v_cvt_pk_bf16_f32 v176, v144, v145
v_lshlrev_b32 v177, 16, v176
v_and_b32 v178, 0xffff0000, v176
v_mul_f32 v179, v177, v173
v_mul_f32 v180, v178, v173
v_cvt_pk_bf16_f32 v116, v179, v180
v_sub_f32 v146, v146, v166
v_sub_f32 v147, v147, v166
v_cvt_pk_bf16_f32 v176, v146, v147
v_lshlrev_b32 v177, 16, v176
v_and_b32 v178, 0xffff0000, v176
v_mul_f32 v179, v177, v173
v_mul_f32 v180, v178, v173
v_cvt_pk_bf16_f32 v117, v179, v180
v_sub_f32 v148, v148, v166
v_sub_f32 v149, v149, v166
v_cvt_pk_bf16_f32 v176, v148, v149
v_lshlrev_b32 v177, 16, v176
v_and_b32 v178, 0xffff0000, v176
v_mul_f32 v179, v177, v173
v_mul_f32 v180, v178, v173
v_cvt_pk_bf16_f32 v118, v179, v180
v_sub_f32 v150, v150, v166
v_sub_f32 v151, v151, v166
v_cvt_pk_bf16_f32 v176, v150, v151
v_lshlrev_b32 v177, 16, v176
v_and_b32 v178, 0xffff0000, v176
v_mul_f32 v179, v177, v173
v_mul_f32 v180, v178, v173
v_cvt_pk_bf16_f32 v119, v179, v180
v_sub_f32 v152, v152, v166
v_sub_f32 v153, v153, v166
v_cvt_pk_bf16_f32 v176, v152, v153
v_lshlrev_b32 v177, 16, v176
v_and_b32 v178, 0xffff0000, v176
v_mul_f32 v179, v177, v173
v_mul_f32 v180, v178, v173
v_cvt_pk_bf16_f32 v120, v179, v180
v_sub_f32 v154, v154, v166
v_sub_f32 v155, v155, v166
v_cvt_pk_bf16_f32 v176, v154, v155
v_lshlrev_b32 v177, 16, v176
v_and_b32 v178, 0xffff0000, v176
v_mul_f32 v179, v177, v173
v_mul_f32 v180, v178, v173
v_cvt_pk_bf16_f32 v121, v179, v180
v_sub_f32 v156, v156, v166
v_sub_f32 v157, v157, v166
v_cvt_pk_bf16_f32 v176, v156, v157
v_lshlrev_b32 v177, 16, v176
v_and_b32 v178, 0xffff0000, v176
v_mul_f32 v179, v177, v173
v_mul_f32 v180, v178, v173
v_cvt_pk_bf16_f32 v122, v179, v180
v_sub_f32 v158, v158, v166
v_sub_f32 v159, v159, v166
v_cvt_pk_bf16_f32 v176, v158, v159
v_lshlrev_b32 v177, 16, v176
v_and_b32 v178, 0xffff0000, v176
v_mul_f32 v179, v177, v173
v_mul_f32 v180, v178, v173
v_cvt_pk_bf16_f32 v123, v179, v180
v_sub_f32 v160, v160, v166
v_sub_f32 v161, v161, v166
v_cvt_pk_bf16_f32 v176, v160, v161
v_lshlrev_b32 v177, 16, v176
v_and_b32 v178, 0xffff0000, v176
v_mul_f32 v179, v177, v173
v_mul_f32 v180, v178, v173
v_cvt_pk_bf16_f32 v124, v179, v180
v_sub_f32 v162, v162, v166
v_sub_f32 v163, v163, v166
v_cvt_pk_bf16_f32 v176, v162, v163
v_lshlrev_b32 v177, 16, v176
v_and_b32 v178, 0xffff0000, v176
v_mul_f32 v179, v177, v173
v_mul_f32 v180, v178, v173
v_cvt_pk_bf16_f32 v125, v179, v180
s_movk_i32 s80, 0
buffer_store_dwordx2 v[108:109], v102, s[16:19], s80 offen sc1
s_movk_i32 s80, 2048
buffer_store_dwordx2 v[110:111], v102, s[16:19], s80 offen sc1
s_movk_i32 s80, 4096
buffer_store_dwordx2 v[112:113], v102, s[16:19], s80 offen sc1
s_movk_i32 s80, 6144
buffer_store_dwordx2 v[114:115], v102, s[16:19], s80 offen sc1
s_movk_i32 s80, 8192
buffer_store_dwordx2 v[116:117], v102, s[16:19], s80 offen sc1
s_movk_i32 s80, 10240
buffer_store_dwordx2 v[118:119], v102, s[16:19], s80 offen sc1
s_movk_i32 s80, 12288
buffer_store_dwordx2 v[120:121], v102, s[16:19], s80 offen sc1
s_movk_i32 s80, 14336
buffer_store_dwordx2 v[122:123], v102, s[16:19], s80 offen sc1
s_movk_i32 s80, 16384
buffer_store_dwordx2 v[124:125], v102, s[16:19], s80 offen sc1
s_branch L_p1_tkdG
L_p1_ckcG:
s_movk_i32 s80, 0
s_waitcnt vmcnt(9)
buffer_store_dwordx2 v[108:109], v102, s[16:19], s80 offen sc1
s_movk_i32 s80, 2048
s_waitcnt vmcnt(9)
buffer_store_dwordx2 v[110:111], v102, s[16:19], s80 offen sc1
s_movk_i32 s80, 4096
s_waitcnt vmcnt(9)
buffer_store_dwordx2 v[112:113], v102, s[16:19], s80 offen sc1
s_movk_i32 s80, 6144
s_waitcnt vmcnt(9)
buffer_store_dwordx2 v[114:115], v102, s[16:19], s80 offen sc1
s_movk_i32 s80, 8192
s_waitcnt vmcnt(9)
buffer_store_dwordx2 v[116:117], v102, s[16:19], s80 offen sc1
s_movk_i32 s80, 10240
s_waitcnt vmcnt(9)
buffer_store_dwordx2 v[118:119], v102, s[16:19], s80 offen sc1
s_movk_i32 s80, 12288
s_waitcnt vmcnt(9)
buffer_store_dwordx2 v[120:121], v102, s[16:19], s80 offen sc1
s_movk_i32 s80, 14336
s_waitcnt vmcnt(9)
buffer_store_dwordx2 v[122:123], v102, s[16:19], s80 offen sc1
L_p1_tkdG:
s_waitcnt vmcnt(0)
s_barrier
s_cmp_lg_u32 s43, 0
s_cbranch_scc1 L_p1_fbnG
s_cmp_lg_u32 s20, 3
s_cbranch_scc1 L_p1_tkw1G
s_mov_b32 s92, s88
s_mov_b32 s93, s89
s_movk_i32 s94, 256
s_mov_b32 s95, 0x20000
s_lshr_b32 s80, s26, 4
s_lshl_b32 s84, s80, 5
v_mov_b32 v97, s84
v_mov_b32 v98, 1
s_mov_b64 exec, 1
buffer_atomic_add v98, v97, s[92:95], 0 offen sc0
s_lshl_b32 s85, s80, 12
s_waitcnt vmcnt(0)
v_readfirstlane_b32 s82, v98
s_add_u32 s92, s68, 0x6d10000
s_addc_u32 s93, s69, 0
s_mov_b32 s94, 0x8000
s_mov_b32 s95, 0x20000
s_cmp_lg_u32 s82, 31
s_cbranch_scc1 L_p1_notlastG
s_mov_b32 exec_lo, -1
s_mov_b32 exec_hi, 0
v_and_b32 v99, 63, v0
v_lshlrev_b32 v99, 7, v99
v_mov_b32 v100, 1
buffer_store_dword v100, v99, s[92:95], s85 offen sc1
s_mov_b64 exec, 1
s_mov_b32 s83, 1
s_branch L_p1_pubG
L_p1_notlastG:
s_lshl_b32 s84, s42, 7
s_add_u32 s84, s84, s85
v_mov_b32 v97, s84
s_mov_b32 s81, 0
L_p1_pollG:
buffer_load_dword v99, v97, s[92:95], 0 offen sc1
s_waitcnt vmcnt(0)
v_readfirstlane_b32 s82, v99
s_nop 3
s_cmp_eq_u32 s82, 1
s_cselect_b32 s83, 1, 0
s_cbranch_scc1 L_p1_pubG
s_sleep 4
s_add_u32 s81, s81, 1
s_cmp_lt_u32 s81, 4000
s_cbranch_scc1 L_p1_pollG
L_p1_pubG:
v_mov_b32 v97, 147452
v_mov_b32 v98, s83
ds_write_b32 v97, v98
s_mov_b64 exec, -1
s_add_u32 m0, s30, 0
s_add_u32 s31, s32, 0
buffer_load_dwordx4 v9, s[44:47], s31 offen lds
s_add_u32 m0, s30, 73728
s_add_u32 s31, s32, 64
buffer_load_dwordx4 v9, s[44:47], s31 offen lds
s_add_u32 m0, s30, 36864
s_add_u32 s31, s32, 0
buffer_load_dwordx4 v9, s[48:51], s31 offen lds
s_add_u32 m0, s30, 110592
s_add_u32 s31, s32, 64
buffer_load_dwordx4 v9, s[48:51], s31 offen lds
s_add_u32 m0, s30, 4096
s_add_u32 s31, s32, 589824
buffer_load_dwordx4 v9, s[44:47], s31 offen lds
s_add_u32 m0, s30, 77824
s_add_u32 s31, s32, 589888
buffer_load_dwordx4 v9, s[44:47], s31 offen lds
s_add_u32 m0, s30, 40960
s_add_u32 s31, s32, 589824
buffer_load_dwordx4 v9, s[48:51], s31 offen lds
s_add_u32 m0, s30, 114688
s_add_u32 s31, s32, 589888
buffer_load_dwordx4 v9, s[48:51], s31 offen lds
s_add_u32 m0, s30, 8192
s_add_u32 s31, s32, 1179648
buffer_load_dwordx4 v9, s[44:47], s31 offen lds
s_add_u32 m0, s30, 81920
s_add_u32 s31, s32, 1179712
buffer_load_dwordx4 v9, s[44:47], s31 offen lds
s_add_u32 m0, s30, 45056
s_add_u32 s31, s32, 1179648
buffer_load_dwordx4 v9, s[48:51], s31 offen lds
s_add_u32 m0, s30, 118784
s_add_u32 s31, s32, 1179712
buffer_load_dwordx4 v9, s[48:51], s31 offen lds
s_add_u32 m0, s30, 12288
s_add_u32 s31, s32, 1769472
buffer_load_dwordx4 v9, s[44:47], s31 offen lds
s_add_u32 m0, s30, 86016
s_add_u32 s31, s32, 1769536
buffer_load_dwordx4 v9, s[44:47], s31 offen lds
s_add_u32 m0, s30, 49152
s_add_u32 s31, s32, 1769472
buffer_load_dwordx4 v9, s[48:51], s31 offen lds
s_add_u32 m0, s30, 122880
s_add_u32 s31, s32, 1769536
buffer_load_dwordx4 v9, s[48:51], s31 offen lds
s_add_u32 m0, s30, 16384
s_add_u32 s31, s32, 2359296
buffer_load_dwordx4 v9, s[44:47], s31 offen lds
s_add_u32 m0, s30, 90112
s_add_u32 s31, s32, 2359360
buffer_load_dwordx4 v9, s[44:47], s31 offen lds
s_add_u32 m0, s30, 53248
s_add_u32 s31, s32, 2359296
buffer_load_dwordx4 v9, s[48:51], s31 offen lds
s_add_u32 m0, s30, 126976
s_add_u32 s31, s32, 2359360
buffer_load_dwordx4 v9, s[48:51], s31 offen lds
s_add_u32 m0, s30, 20480
s_add_u32 s31, s32, 2949120
buffer_load_dwordx4 v9, s[44:47], s31 offen lds
s_add_u32 m0, s30, 94208
s_add_u32 s31, s32, 2949184
buffer_load_dwordx4 v9, s[44:47], s31 offen lds
s_add_u32 m0, s30, 57344
s_add_u32 s31, s32, 2949120
buffer_load_dwordx4 v9, s[48:51], s31 offen lds
s_add_u32 m0, s30, 131072
s_add_u32 s31, s32, 2949184
buffer_load_dwordx4 v9, s[48:51], s31 offen lds
s_waitcnt lgkmcnt(0)
L_p1_tkmG:
s_barrier
v_mov_b32 v97, 147452
ds_read_b32 v98, v97
s_waitcnt lgkmcnt(0)
v_readfirstlane_b32 s83, v98
s_nop 3
s_cmp_lg_u32 s83, 0
s_cbranch_scc1 L_p1_goG
s_mov_b32 s43, 1
s_mov_b32 s42, 0
s_barrier
s_branch L_p1_taskG
L_p1_tkw1G:
s_add_u32 m0, s30, 0
s_add_u32 s31, s32, 0
buffer_load_dwordx4 v9, s[44:47], s31 offen lds
s_add_u32 m0, s30, 73728
s_add_u32 s31, s32, 64
buffer_load_dwordx4 v9, s[44:47], s31 offen lds
s_add_u32 m0, s30, 36864
s_add_u32 s31, s32, 0
buffer_load_dwordx4 v9, s[48:51], s31 offen lds
s_add_u32 m0, s30, 110592
s_add_u32 s31, s32, 64
buffer_load_dwordx4 v9, s[48:51], s31 offen lds
s_add_u32 m0, s30, 4096
s_add_u32 s31, s32, 589824
buffer_load_dwordx4 v9, s[44:47], s31 offen lds
s_add_u32 m0, s30, 77824
s_add_u32 s31, s32, 589888
buffer_load_dwordx4 v9, s[44:47], s31 offen lds
s_add_u32 m0, s30, 40960
s_add_u32 s31, s32, 589824
buffer_load_dwordx4 v9, s[48:51], s31 offen lds
s_add_u32 m0, s30, 114688
s_add_u32 s31, s32, 589888
buffer_load_dwordx4 v9, s[48:51], s31 offen lds
s_add_u32 m0, s30, 8192
s_add_u32 s31, s32, 1179648
buffer_load_dwordx4 v9, s[44:47], s31 offen lds
s_add_u32 m0, s30, 81920
s_add_u32 s31, s32, 1179712
buffer_load_dwordx4 v9, s[44:47], s31 offen lds
s_add_u32 m0, s30, 45056
s_add_u32 s31, s32, 1179648
buffer_load_dwordx4 v9, s[48:51], s31 offen lds
s_add_u32 m0, s30, 118784
s_add_u32 s31, s32, 1179712
buffer_load_dwordx4 v9, s[48:51], s31 offen lds
s_add_u32 m0, s30, 12288
s_add_u32 s31, s32, 1769472
buffer_load_dwordx4 v9, s[44:47], s31 offen lds
s_add_u32 m0, s30, 86016
s_add_u32 s31, s32, 1769536
buffer_load_dwordx4 v9, s[44:47], s31 offen lds
s_add_u32 m0, s30, 49152
s_add_u32 s31, s32, 1769472
buffer_load_dwordx4 v9, s[48:51], s31 offen lds
s_add_u32 m0, s30, 122880
s_add_u32 s31, s32, 1769536
buffer_load_dwordx4 v9, s[48:51], s31 offen lds
s_add_u32 m0, s30, 16384
s_add_u32 s31, s32, 2359296
buffer_load_dwordx4 v9, s[44:47], s31 offen lds
s_add_u32 m0, s30, 90112
s_add_u32 s31, s32, 2359360
buffer_load_dwordx4 v9, s[44:47], s31 offen lds
s_add_u32 m0, s30, 53248
s_add_u32 s31, s32, 2359296
buffer_load_dwordx4 v9, s[48:51], s31 offen lds
s_add_u32 m0, s30, 126976
s_add_u32 s31, s32, 2359360
buffer_load_dwordx4 v9, s[48:51], s31 offen lds
s_add_u32 m0, s30, 20480
s_add_u32 s31, s32, 2949120
buffer_load_dwordx4 v9, s[44:47], s31 offen lds
s_add_u32 m0, s30, 94208
s_add_u32 s31, s32, 2949184
buffer_load_dwordx4 v9, s[44:47], s31 offen lds
s_add_u32 m0, s30, 57344
s_add_u32 s31, s32, 2949120
buffer_load_dwordx4 v9, s[48:51], s31 offen lds
s_add_u32 m0, s30, 131072
s_add_u32 s31, s32, 2949184
buffer_load_dwordx4 v9, s[48:51], s31 offen lds
s_sub_u32 s35, s76, 256
buffer_load_dword v237, v216, s[72:75], s35 offen
s_branch L_p1_tkmG
L_p1_fbnG:
s_add_u32 s42, s42, 1
s_cmp_lt_u32 s42, 32
s_cbranch_scc1 L_p1_taskG
L_p1_goG:
s_mov_b32 s60, s68
s_mov_b32 s61, s69
s_mov_b32 s62, 0x240000
s_mov_b32 s63, 0x20000
s_mul_i32 s12, s26, 18432
s_add_u32 s13, s12, 18432
s_add_u32 s14, s12, 36864
s_add_u32 s15, s12, 55296
buffer_load_dwordx4 a[0:3], v2, s[60:63], s12 offen sc1
buffer_load_dwordx4 a[72:75], v2, s[60:63], s13 offen sc1
buffer_load_dwordx4 a[144:147], v2, s[60:63], s14 offen sc1
buffer_load_dwordx4 a[216:219], v2, s[60:63], s15 offen sc1
buffer_load_dwordx4 a[4:7], v2, s[60:63], s12 offen offset:1024 sc1
buffer_load_dwordx4 a[76:79], v2, s[60:63], s13 offen offset:1024 sc1
buffer_load_dwordx4 a[148:151], v2, s[60:63], s14 offen offset:1024 sc1
buffer_load_dwordx4 a[220:223], v2, s[60:63], s15 offen offset:1024 sc1
buffer_load_dwordx4 a[8:11], v2, s[60:63], s12 offen offset:2048 sc1
buffer_load_dwordx4 a[80:83], v2, s[60:63], s13 offen offset:2048 sc1
buffer_load_dwordx4 a[152:155], v2, s[60:63], s14 offen offset:2048 sc1
buffer_load_dwordx4 a[224:227], v2, s[60:63], s15 offen offset:2048 sc1
buffer_load_dwordx4 a[12:15], v2, s[60:63], s12 offen offset:3072 sc1
buffer_load_dwordx4 a[84:87], v2, s[60:63], s13 offen offset:3072 sc1
buffer_load_dwordx4 a[156:159], v2, s[60:63], s14 offen offset:3072 sc1
buffer_load_dwordx4 a[228:231], v2, s[60:63], s15 offen offset:3072 sc1
s_add_u32 s12, s12, 4096
s_add_u32 s13, s13, 4096
s_add_u32 s14, s14, 4096
s_add_u32 s15, s15, 4096
buffer_load_dwordx4 a[16:19], v2, s[60:63], s12 offen sc1
buffer_load_dwordx4 a[88:91], v2, s[60:63], s13 offen sc1
buffer_load_dwordx4 a[160:163], v2, s[60:63], s14 offen sc1
buffer_load_dwordx4 a[232:235], v2, s[60:63], s15 offen sc1
buffer_load_dwordx4 a[20:23], v2, s[60:63], s12 offen offset:1024 sc1
buffer_load_dwordx4 a[92:95], v2, s[60:63], s13 offen offset:1024 sc1
buffer_load_dwordx4 a[164:167], v2, s[60:63], s14 offen offset:1024 sc1
buffer_load_dwordx4 a[236:239], v2, s[60:63], s15 offen offset:1024 sc1
buffer_load_dwordx4 a[24:27], v2, s[60:63], s12 offen offset:2048 sc1
buffer_load_dwordx4 a[96:99], v2, s[60:63], s13 offen offset:2048 sc1
buffer_load_dwordx4 a[168:171], v2, s[60:63], s14 offen offset:2048 sc1
buffer_load_dwordx4 a[240:243], v2, s[60:63], s15 offen offset:2048 sc1
buffer_load_dwordx4 a[28:31], v2, s[60:63], s12 offen offset:3072 sc1
buffer_load_dwordx4 a[100:103], v2, s[60:63], s13 offen offset:3072 sc1
buffer_load_dwordx4 a[172:175], v2, s[60:63], s14 offen offset:3072 sc1
buffer_load_dwordx4 a[244:247], v2, s[60:63], s15 offen offset:3072 sc1
s_add_u32 s12, s12, 4096
s_add_u32 s13, s13, 4096
s_add_u32 s14, s14, 4096
s_add_u32 s15, s15, 4096
buffer_load_dwordx4 a[32:35], v2, s[60:63], s12 offen sc1
buffer_load_dwordx4 a[104:107], v2, s[60:63], s13 offen sc1
buffer_load_dwordx4 a[176:179], v2, s[60:63], s14 offen sc1
buffer_load_dwordx4 a[248:251], v2, s[60:63], s15 offen sc1
buffer_load_dwordx4 a[36:39], v2, s[60:63], s12 offen offset:1024 sc1
buffer_load_dwordx4 a[108:111], v2, s[60:63], s13 offen offset:1024 sc1
buffer_load_dwordx4 a[180:183], v2, s[60:63], s14 offen offset:1024 sc1
buffer_load_dwordx4 a[252:255], v2, s[60:63], s15 offen offset:1024 sc1
buffer_load_dwordx4 a[40:43], v2, s[60:63], s12 offen offset:2048 sc1
buffer_load_dwordx4 a[112:115], v2, s[60:63], s13 offen offset:2048 sc1
buffer_load_dwordx4 a[184:187], v2, s[60:63], s14 offen offset:2048 sc1
buffer_load_dwordx4 v[168:171], v2, s[60:63], s15 offen offset:2048 sc1
buffer_load_dwordx4 a[44:47], v2, s[60:63], s12 offen offset:3072 sc1
buffer_load_dwordx4 a[116:119], v2, s[60:63], s13 offen offset:3072 sc1
buffer_load_dwordx4 a[188:191], v2, s[60:63], s14 offen offset:3072 sc1
buffer_load_dwordx4 v[172:175], v2, s[60:63], s15 offen offset:3072 sc1
s_add_u32 s12, s12, 4096
s_add_u32 s13, s13, 4096
s_add_u32 s14, s14, 4096
s_add_u32 s15, s15, 4096
v_add_u32 v200, s27, v3
v_add_u32 v201, s28, v3
v_add_u32 v202, s27, v5
v_add_u32 v203, s28, v5
v_add_u32 v204, s27, v4
v_add_u32 v205, s28, v4
v_add_u32 v206, s27, v6
v_add_u32 v207, s28, v6
s_sub_u32 s35, s76, 128
buffer_load_dword v235, v216, s[72:75], s35 offen
s_waitcnt vmcnt(62)
s_barrier
ds_read_b64_tr_b16 v[116:117], v200
ds_read_b64_tr_b16 v[118:119], v200 offset:1024
ds_read_b64_tr_b16 v[120:121], v202
ds_read_b64_tr_b16 v[122:123], v202 offset:1024
ds_read_b64_tr_b16 v[124:125], v204
ds_read_b64_tr_b16 v[126:127], v204 offset:1024
ds_read_b64_tr_b16 v[128:129], v206
ds_read_b64_tr_b16 v[130:131], v206 offset:1024
ds_read_b64_tr_b16 v[132:133], v200 offset:2048
ds_read_b64_tr_b16 v[134:135], v200 offset:3072
ds_read_b64_tr_b16 v[136:137], v202 offset:2048
ds_read_b64_tr_b16 v[138:139], v202 offset:3072
ds_read_b64_tr_b16 v[140:141], v204 offset:2048
ds_read_b64_tr_b16 v[142:143], v204 offset:3072
s_waitcnt vmcnt(48) lgkmcnt(12)
v_mfma_f32_16x16x32_bf16 v[16:19], v[116:119], a[0:3], 0
s_waitcnt vmcnt(47)
ds_read_b64_tr_b16 v[144:145], v206 offset:2048
v_mfma_f32_16x16x32_bf16 v[20:23], v[116:119], a[72:75], 0
s_waitcnt vmcnt(46)
s_add_u32 m0, s30, 24576
s_add_u32 s31, s32, 3538944
buffer_load_dwordx4 v9, s[44:47], s31 offen lds
v_mfma_f32_16x16x32_bf16 v[24:27], v[116:119], a[144:147], 0
s_waitcnt vmcnt(46)
ds_read_b64_tr_b16 v[146:147], v206 offset:3072
v_mfma_f32_16x16x32_bf16 v[28:31], v[116:119], a[216:219], 0
s_waitcnt lgkmcnt(12)
s_add_u32 m0, s30, 98304
s_add_u32 s31, s32, 3539008
buffer_load_dwordx4 v9, s[44:47], s31 offen lds
v_mfma_f32_16x16x32_bf16 v[32:35], v[120:123], a[0:3], 0
ds_read_b64_tr_b16 v[148:149], v200 offset:4096
v_mfma_f32_16x16x32_bf16 v[36:39], v[120:123], a[72:75], 0
v_mfma_f32_16x16x32_bf16 v[40:43], v[120:123], a[144:147], 0
ds_read_b64_tr_b16 v[150:151], v200 offset:5120
v_mfma_f32_16x16x32_bf16 v[44:47], v[120:123], a[216:219], 0
s_waitcnt lgkmcnt(12)
s_add_u32 m0, s30, 61440
s_add_u32 s31, s32, 3538944
buffer_load_dwordx4 v9, s[48:51], s31 offen lds
v_mfma_f32_16x16x32_bf16 v[48:51], v[124:127], a[0:3], 0
ds_read_b64_tr_b16 v[116:117], v202 offset:4096
v_mfma_f32_16x16x32_bf16 v[52:55], v[124:127], a[72:75], 0
s_add_u32 m0, s30, 135168
s_add_u32 s31, s32, 3539008
buffer_load_dwordx4 v9, s[48:51], s31 offen lds
v_mfma_f32_16x16x32_bf16 v[56:59], v[124:127], a[144:147], 0
ds_read_b64_tr_b16 v[118:119], v202 offset:5120
v_mfma_f32_16x16x32_bf16 v[60:63], v[124:127], a[216:219], 0
s_waitcnt lgkmcnt(12)
s_add_u32 m0, s30, 28672
s_add_u32 s31, s32, 4128768
buffer_load_dwordx4 v9, s[44:47], s31 offen lds
v_mfma_f32_16x16x32_bf16 v[64:67], v[128:131], a[0:3], 0
ds_read_b64_tr_b16 v[120:121], v204 offset:4096
v_mfma_f32_16x16x32_bf16 v[68:71], v[128:131], a[72:75], 0
v_mfma_f32_16x16x32_bf16 v[72:75], v[128:131], a[144:147], 0
ds_read_b64_tr_b16 v[122:123], v204 offset:5120
v_mfma_f32_16x16x32_bf16 v[76:79], v[128:131], a[216:219], 0
s_waitcnt vmcnt(49) lgkmcnt(12)
s_add_u32 m0, s30, 102400
s_add_u32 s31, s32, 4128832
buffer_load_dwordx4 v9, s[44:47], s31 offen lds
v_mfma_f32_16x16x32_bf16 v[16:19], v[132:135], a[4:7], v[16:19]
s_waitcnt vmcnt(49)
ds_read_b64_tr_b16 v[124:125], v206 offset:4096
v_mfma_f32_16x16x32_bf16 v[20:23], v[132:135], a[76:79], v[20:23]
s_waitcnt vmcnt(48)
s_add_u32 m0, s30, 65536
s_add_u32 s31, s32, 4128768
buffer_load_dwordx4 v9, s[48:51], s31 offen lds
v_mfma_f32_16x16x32_bf16 v[24:27], v[132:135], a[148:151], v[24:27]
s_waitcnt vmcnt(48)
ds_read_b64_tr_b16 v[126:127], v206 offset:5120
v_mfma_f32_16x16x32_bf16 v[28:31], v[132:135], a[220:223], v[28:31]
s_waitcnt lgkmcnt(12)
s_add_u32 m0, s30, 139264
s_add_u32 s31, s32, 4128832
buffer_load_dwordx4 v9, s[48:51], s31 offen lds
v_mfma_f32_16x16x32_bf16 v[32:35], v[136:139], a[4:7], v[32:35]
ds_read_b64_tr_b16 v[128:129], v200 offset:6144
v_mfma_f32_16x16x32_bf16 v[36:39], v[136:139], a[76:79], v[36:39]
v_mfma_f32_16x16x32_bf16 v[40:43], v[136:139], a[148:151], v[40:43]
ds_read_b64_tr_b16 v[130:131], v200 offset:7168
v_mfma_f32_16x16x32_bf16 v[44:47], v[136:139], a[220:223], v[44:47]
s_waitcnt lgkmcnt(12)
s_add_u32 m0, s30, 32768
s_add_u32 s31, s32, 4718592
buffer_load_dwordx4 v9, s[44:47], s31 offen lds
v_mfma_f32_16x16x32_bf16 v[48:51], v[140:143], a[4:7], v[48:51]
ds_read_b64_tr_b16 v[132:133], v202 offset:6144
v_mfma_f32_16x16x32_bf16 v[52:55], v[140:143], a[76:79], v[52:55]
s_add_u32 m0, s30, 106496
s_add_u32 s31, s32, 4718656
buffer_load_dwordx4 v9, s[44:47], s31 offen lds
v_mfma_f32_16x16x32_bf16 v[56:59], v[140:143], a[148:151], v[56:59]
ds_read_b64_tr_b16 v[134:135], v202 offset:7168
v_mfma_f32_16x16x32_bf16 v[60:63], v[140:143], a[220:223], v[60:63]
s_waitcnt lgkmcnt(12)
s_add_u32 m0, s30, 69632
s_add_u32 s31, s32, 4718592
buffer_load_dwordx4 v9, s[48:51], s31 offen lds
v_mfma_f32_16x16x32_bf16 v[64:67], v[144:147], a[4:7], v[64:67]
ds_read_b64_tr_b16 v[136:137], v204 offset:6144
v_mfma_f32_16x16x32_bf16 v[68:71], v[144:147], a[76:79], v[68:71]
v_mfma_f32_16x16x32_bf16 v[72:75], v[144:147], a[148:151], v[72:75]
ds_read_b64_tr_b16 v[138:139], v204 offset:7168
v_mfma_f32_16x16x32_bf16 v[76:79], v[144:147], a[220:223], v[76:79]
s_waitcnt vmcnt(51) lgkmcnt(12)
s_add_u32 m0, s30, 143360
s_add_u32 s31, s32, 4718656
buffer_load_dwordx4 v9, s[48:51], s31 offen lds
v_mfma_f32_16x16x32_bf16 v[16:19], v[148:151], a[8:11], v[16:19]
s_waitcnt vmcnt(51)
ds_read_b64_tr_b16 v[140:141], v206 offset:6144
v_mfma_f32_16x16x32_bf16 v[20:23], v[148:151], a[80:83], v[20:23]
s_waitcnt vmcnt(50)
buffer_load_dwordx4 a[48:51], v2, s[60:63], s12 offen sc1
v_mfma_f32_16x16x32_bf16 v[24:27], v[148:151], a[152:155], v[24:27]
s_waitcnt vmcnt(50)
ds_read_b64_tr_b16 v[142:143], v206 offset:7168
v_mfma_f32_16x16x32_bf16 v[28:31], v[148:151], a[224:227], v[28:31]
s_waitcnt lgkmcnt(12)
buffer_load_dwordx4 a[120:123], v2, s[60:63], s13 offen sc1
v_mfma_f32_16x16x32_bf16 v[32:35], v[116:119], a[8:11], v[32:35]
ds_read_b64_tr_b16 v[144:145], v200 offset:8192
v_mfma_f32_16x16x32_bf16 v[36:39], v[116:119], a[80:83], v[36:39]
buffer_load_dwordx4 a[192:195], v2, s[60:63], s14 offen sc1
v_mfma_f32_16x16x32_bf16 v[40:43], v[116:119], a[152:155], v[40:43]
ds_read_b64_tr_b16 v[146:147], v200 offset:9216
v_mfma_f32_16x16x32_bf16 v[44:47], v[116:119], a[224:227], v[44:47]
s_waitcnt lgkmcnt(12)
v_mfma_f32_16x16x32_bf16 v[48:51], v[120:123], a[8:11], v[48:51]
ds_read_b64_tr_b16 v[148:149], v202 offset:8192
v_mfma_f32_16x16x32_bf16 v[52:55], v[120:123], a[80:83], v[52:55]
buffer_load_dwordx4 v[176:179], v2, s[60:63], s15 offen sc1
v_mfma_f32_16x16x32_bf16 v[56:59], v[120:123], a[152:155], v[56:59]
ds_read_b64_tr_b16 v[150:151], v202 offset:9216
v_mfma_f32_16x16x32_bf16 v[60:63], v[120:123], a[224:227], v[60:63]
s_waitcnt lgkmcnt(12)
buffer_load_dwordx4 a[52:55], v2, s[60:63], s12 offen offset:1024 sc1
v_mfma_f32_16x16x32_bf16 v[64:67], v[124:127], a[8:11], v[64:67]
ds_read_b64_tr_b16 v[116:117], v204 offset:8192
v_mfma_f32_16x16x32_bf16 v[68:71], v[124:127], a[80:83], v[68:71]
buffer_load_dwordx4 a[124:127], v2, s[60:63], s13 offen offset:1024 sc1
v_mfma_f32_16x16x32_bf16 v[72:75], v[124:127], a[152:155], v[72:75]
ds_read_b64_tr_b16 v[118:119], v204 offset:9216
v_mfma_f32_16x16x32_bf16 v[76:79], v[124:127], a[224:227], v[76:79]
s_waitcnt vmcnt(54) lgkmcnt(12)
v_mfma_f32_16x16x32_bf16 v[16:19], v[128:131], a[12:15], v[16:19]
s_waitcnt vmcnt(53)
ds_read_b64_tr_b16 v[120:121], v206 offset:8192
v_mfma_f32_16x16x32_bf16 v[20:23], v[128:131], a[84:87], v[20:23]
s_waitcnt vmcnt(52)
buffer_load_dwordx4 a[196:199], v2, s[60:63], s14 offen offset:1024 sc1
v_mfma_f32_16x16x32_bf16 v[24:27], v[128:131], a[156:159], v[24:27]
s_waitcnt vmcnt(52)
ds_read_b64_tr_b16 v[122:123], v206 offset:9216
v_mfma_f32_16x16x32_bf16 v[28:31], v[128:131], a[228:231], v[28:31]
s_waitcnt lgkmcnt(12)
buffer_load_dwordx4 v[180:183], v2, s[60:63], s15 offen offset:1024 sc1
v_mfma_f32_16x16x32_bf16 v[32:35], v[132:135], a[12:15], v[32:35]
ds_read_b64_tr_b16 v[124:125], v200 offset:10240
v_mfma_f32_16x16x32_bf16 v[36:39], v[132:135], a[84:87], v[36:39]
buffer_load_dwordx4 a[56:59], v2, s[60:63], s12 offen offset:2048 sc1
v_mfma_f32_16x16x32_bf16 v[40:43], v[132:135], a[156:159], v[40:43]
ds_read_b64_tr_b16 v[126:127], v200 offset:11264
v_mfma_f32_16x16x32_bf16 v[44:47], v[132:135], a[228:231], v[44:47]
s_waitcnt lgkmcnt(12)
v_mfma_f32_16x16x32_bf16 v[48:51], v[136:139], a[12:15], v[48:51]
ds_read_b64_tr_b16 v[128:129], v202 offset:10240
v_mfma_f32_16x16x32_bf16 v[52:55], v[136:139], a[84:87], v[52:55]
buffer_load_dwordx4 a[128:131], v2, s[60:63], s13 offen offset:2048 sc1
v_mfma_f32_16x16x32_bf16 v[56:59], v[136:139], a[156:159], v[56:59]
ds_read_b64_tr_b16 v[130:131], v202 offset:11264
v_mfma_f32_16x16x32_bf16 v[60:63], v[136:139], a[228:231], v[60:63]
s_waitcnt lgkmcnt(12)
buffer_load_dwordx4 a[200:203], v2, s[60:63], s14 offen offset:2048 sc1
v_mfma_f32_16x16x32_bf16 v[64:67], v[140:143], a[12:15], v[64:67]
ds_read_b64_tr_b16 v[132:133], v204 offset:10240
v_mfma_f32_16x16x32_bf16 v[68:71], v[140:143], a[84:87], v[68:71]
buffer_load_dwordx4 v[184:187], v2, s[60:63], s15 offen offset:2048 sc1
v_mfma_f32_16x16x32_bf16 v[72:75], v[140:143], a[156:159], v[72:75]
ds_read_b64_tr_b16 v[134:135], v204 offset:11264
v_mfma_f32_16x16x32_bf16 v[76:79], v[140:143], a[228:231], v[76:79]
s_waitcnt vmcnt(56) lgkmcnt(12)
v_mfma_f32_16x16x32_bf16 v[16:19], v[144:147], a[16:19], v[16:19]
s_waitcnt vmcnt(55)
ds_read_b64_tr_b16 v[136:137], v206 offset:10240
v_mfma_f32_16x16x32_bf16 v[20:23], v[144:147], a[88:91], v[20:23]
s_waitcnt vmcnt(54)
buffer_load_dwordx4 a[60:63], v2, s[60:63], s12 offen offset:3072 sc1
v_mfma_f32_16x16x32_bf16 v[24:27], v[144:147], a[160:163], v[24:27]
s_waitcnt vmcnt(54)
ds_read_b64_tr_b16 v[138:139], v206 offset:11264
v_mfma_f32_16x16x32_bf16 v[28:31], v[144:147], a[232:235], v[28:31]
s_barrier
buffer_load_dwordx4 a[132:135], v2, s[60:63], s13 offen offset:3072 sc1
s_waitcnt lgkmcnt(12)
v_mfma_f32_16x16x32_bf16 v[32:35], v[148:151], a[16:19], v[32:35]
ds_read_b64_tr_b16 v[140:141], v200 offset:12288
v_mfma_f32_16x16x32_bf16 v[36:39], v[148:151], a[88:91], v[36:39]
buffer_load_dwordx4 a[204:207], v2, s[60:63], s14 offen offset:3072 sc1
v_mfma_f32_16x16x32_bf16 v[40:43], v[148:151], a[160:163], v[40:43]
ds_read_b64_tr_b16 v[142:143], v200 offset:13312
v_mfma_f32_16x16x32_bf16 v[44:47], v[148:151], a[232:235], v[44:47]
s_waitcnt lgkmcnt(12)
v_mfma_f32_16x16x32_bf16 v[48:51], v[116:119], a[16:19], v[48:51]
ds_read_b64_tr_b16 v[144:145], v202 offset:12288
v_mfma_f32_16x16x32_bf16 v[52:55], v[116:119], a[88:91], v[52:55]
buffer_load_dwordx4 v[188:191], v2, s[60:63], s15 offen offset:3072 sc1
s_add_u32 s12, s12, 4096
s_add_u32 s13, s13, 4096
s_add_u32 s14, s14, 4096
s_add_u32 s15, s15, 4096
v_mfma_f32_16x16x32_bf16 v[56:59], v[116:119], a[160:163], v[56:59]
ds_read_b64_tr_b16 v[146:147], v202 offset:13312
v_mfma_f32_16x16x32_bf16 v[60:63], v[116:119], a[232:235], v[60:63]
s_waitcnt lgkmcnt(12)
buffer_load_dwordx4 a[64:67], v2, s[60:63], s12 offen sc1
v_mfma_f32_16x16x32_bf16 v[64:67], v[120:123], a[16:19], v[64:67]
ds_read_b64_tr_b16 v[148:149], v204 offset:12288
v_mfma_f32_16x16x32_bf16 v[68:71], v[120:123], a[88:91], v[68:71]
buffer_load_dwordx4 a[136:139], v2, s[60:63], s13 offen sc1
v_mfma_f32_16x16x32_bf16 v[72:75], v[120:123], a[160:163], v[72:75]
ds_read_b64_tr_b16 v[150:151], v204 offset:13312
v_mfma_f32_16x16x32_bf16 v[76:79], v[120:123], a[232:235], v[76:79]
s_waitcnt vmcnt(58) lgkmcnt(12)
v_mfma_f32_16x16x32_bf16 v[16:19], v[124:127], a[20:23], v[16:19]
s_waitcnt vmcnt(57)
ds_read_b64_tr_b16 v[116:117], v206 offset:12288
v_mfma_f32_16x16x32_bf16 v[20:23], v[124:127], a[92:95], v[20:23]
s_waitcnt vmcnt(56)
buffer_load_dwordx4 a[208:211], v2, s[60:63], s14 offen sc1
v_mfma_f32_16x16x32_bf16 v[24:27], v[124:127], a[164:167], v[24:27]
s_waitcnt vmcnt(56)
ds_read_b64_tr_b16 v[118:119], v206 offset:13312
v_mfma_f32_16x16x32_bf16 v[28:31], v[124:127], a[236:239], v[28:31]
s_waitcnt lgkmcnt(12)
buffer_load_dwordx4 v[192:195], v2, s[60:63], s15 offen sc1
v_mfma_f32_16x16x32_bf16 v[32:35], v[128:131], a[20:23], v[32:35]
ds_read_b64_tr_b16 v[120:121], v200 offset:14336
v_mfma_f32_16x16x32_bf16 v[36:39], v[128:131], a[92:95], v[36:39]
buffer_load_dwordx4 a[68:71], v2, s[60:63], s12 offen offset:1024 sc1
v_mfma_f32_16x16x32_bf16 v[40:43], v[128:131], a[164:167], v[40:43]
ds_read_b64_tr_b16 v[122:123], v200 offset:15360
v_mfma_f32_16x16x32_bf16 v[44:47], v[128:131], a[236:239], v[44:47]
s_waitcnt lgkmcnt(12)
v_mfma_f32_16x16x32_bf16 v[48:51], v[132:135], a[20:23], v[48:51]
ds_read_b64_tr_b16 v[124:125], v202 offset:14336
v_mfma_f32_16x16x32_bf16 v[52:55], v[132:135], a[92:95], v[52:55]
buffer_load_dwordx4 a[140:143], v2, s[60:63], s13 offen offset:1024 sc1
v_mfma_f32_16x16x32_bf16 v[56:59], v[132:135], a[164:167], v[56:59]
ds_read_b64_tr_b16 v[126:127], v202 offset:15360
v_mfma_f32_16x16x32_bf16 v[60:63], v[132:135], a[236:239], v[60:63]
s_waitcnt lgkmcnt(12)
buffer_load_dwordx4 a[212:215], v2, s[60:63], s14 offen offset:1024 sc1
v_mfma_f32_16x16x32_bf16 v[64:67], v[136:139], a[20:23], v[64:67]
ds_read_b64_tr_b16 v[128:129], v204 offset:14336
v_mfma_f32_16x16x32_bf16 v[68:71], v[136:139], a[92:95], v[68:71]
buffer_load_dwordx4 v[196:199], v2, s[60:63], s15 offen offset:1024 sc1
v_mfma_f32_16x16x32_bf16 v[72:75], v[136:139], a[164:167], v[72:75]
ds_read_b64_tr_b16 v[130:131], v204 offset:15360
v_mfma_f32_16x16x32_bf16 v[76:79], v[136:139], a[236:239], v[76:79]
s_waitcnt vmcnt(60) lgkmcnt(12)
v_mfma_f32_16x16x32_bf16 v[16:19], v[140:143], a[24:27], v[16:19]
s_waitcnt vmcnt(59)
ds_read_b64_tr_b16 v[132:133], v206 offset:14336
v_mfma_f32_16x16x32_bf16 v[20:23], v[140:143], a[96:99], v[20:23]
s_waitcnt vmcnt(58)
v_mfma_f32_16x16x32_bf16 v[24:27], v[140:143], a[168:171], v[24:27]
s_waitcnt vmcnt(57)
ds_read_b64_tr_b16 v[134:135], v206 offset:15360
v_mfma_f32_16x16x32_bf16 v[28:31], v[140:143], a[240:243], v[28:31]
s_waitcnt lgkmcnt(12)
v_mfma_f32_16x16x32_bf16 v[32:35], v[144:147], a[24:27], v[32:35]
ds_read_b64_tr_b16 v[136:137], v200 offset:16384
v_mfma_f32_16x16x32_bf16 v[36:39], v[144:147], a[96:99], v[36:39]
v_mfma_f32_16x16x32_bf16 v[40:43], v[144:147], a[168:171], v[40:43]
ds_read_b64_tr_b16 v[138:139], v200 offset:17408
v_mfma_f32_16x16x32_bf16 v[44:47], v[144:147], a[240:243], v[44:47]
s_waitcnt lgkmcnt(12)
s_add_u32 s32, s32, 64
s_xor_b32 s30, s30, 73728
v_mfma_f32_16x16x32_bf16 v[48:51], v[148:151], a[24:27], v[48:51]
s_cmp_eq_u32 s22, 1
s_cselect_b32 s46, 0, s46
s_cselect_b32 s50, 0, s50
ds_read_b64_tr_b16 v[140:141], v202 offset:16384
v_mfma_f32_16x16x32_bf16 v[52:55], v[148:151], a[96:99], v[52:55]
v_mfma_f32_16x16x32_bf16 v[56:59], v[148:151], a[168:171], v[56:59]
ds_read_b64_tr_b16 v[142:143], v202 offset:17408
v_mfma_f32_16x16x32_bf16 v[60:63], v[148:151], a[240:243], v[60:63]
s_waitcnt lgkmcnt(12)
v_mfma_f32_16x16x32_bf16 v[64:67], v[116:119], a[24:27], v[64:67]
ds_read_b64_tr_b16 v[144:145], v204 offset:16384
v_mfma_f32_16x16x32_bf16 v[68:71], v[116:119], a[96:99], v[68:71]
v_mfma_f32_16x16x32_bf16 v[72:75], v[116:119], a[168:171], v[72:75]
ds_read_b64_tr_b16 v[146:147], v204 offset:17408
v_mfma_f32_16x16x32_bf16 v[76:79], v[116:119], a[240:243], v[76:79]
s_waitcnt vmcnt(56) lgkmcnt(12)
v_mfma_f32_16x16x32_bf16 v[16:19], v[120:123], a[28:31], v[16:19]
s_waitcnt vmcnt(55)
ds_read_b64_tr_b16 v[148:149], v206 offset:16384
v_mfma_f32_16x16x32_bf16 v[20:23], v[120:123], a[100:103], v[20:23]
s_waitcnt vmcnt(54)
v_mfma_f32_16x16x32_bf16 v[24:27], v[120:123], a[172:175], v[24:27]
s_waitcnt vmcnt(53)
ds_read_b64_tr_b16 v[150:151], v206 offset:17408
v_mfma_f32_16x16x32_bf16 v[28:31], v[120:123], a[244:247], v[28:31]
s_waitcnt lgkmcnt(12)
v_mfma_f32_16x16x32_bf16 v[32:35], v[124:127], a[28:31], v[32:35]
ds_read_b64_tr_b16 v[116:117], v201
v_mfma_f32_16x16x32_bf16 v[36:39], v[124:127], a[100:103], v[36:39]
v_mfma_f32_16x16x32_bf16 v[40:43], v[124:127], a[172:175], v[40:43]
ds_read_b64_tr_b16 v[118:119], v201 offset:1024
v_mfma_f32_16x16x32_bf16 v[44:47], v[124:127], a[244:247], v[44:47]
s_waitcnt lgkmcnt(12)
v_mfma_f32_16x16x32_bf16 v[48:51], v[128:131], a[28:31], v[48:51]
ds_read_b64_tr_b16 v[120:121], v203
v_mfma_f32_16x16x32_bf16 v[52:55], v[128:131], a[100:103], v[52:55]
v_mfma_f32_16x16x32_bf16 v[56:59], v[128:131], a[172:175], v[56:59]
ds_read_b64_tr_b16 v[122:123], v203 offset:1024
v_mfma_f32_16x16x32_bf16 v[60:63], v[128:131], a[244:247], v[60:63]
s_waitcnt lgkmcnt(12)
v_mfma_f32_16x16x32_bf16 v[64:67], v[132:135], a[28:31], v[64:67]
ds_read_b64_tr_b16 v[124:125], v205
v_mfma_f32_16x16x32_bf16 v[68:71], v[132:135], a[100:103], v[68:71]
v_mfma_f32_16x16x32_bf16 v[72:75], v[132:135], a[172:175], v[72:75]
ds_read_b64_tr_b16 v[126:127], v205 offset:1024
v_mfma_f32_16x16x32_bf16 v[76:79], v[132:135], a[244:247], v[76:79]
s_waitcnt vmcnt(52) lgkmcnt(12)
v_mfma_f32_16x16x32_bf16 v[16:19], v[136:139], a[32:35], v[16:19]
s_waitcnt vmcnt(51)
ds_read_b64_tr_b16 v[128:129], v207
v_mfma_f32_16x16x32_bf16 v[20:23], v[136:139], a[104:107], v[20:23]
s_waitcnt vmcnt(50)
v_mfma_f32_16x16x32_bf16 v[24:27], v[136:139], a[176:179], v[24:27]
s_waitcnt vmcnt(49)
ds_read_b64_tr_b16 v[130:131], v207 offset:1024
v_mfma_f32_16x16x32_bf16 v[28:31], v[136:139], a[248:251], v[28:31]
s_waitcnt lgkmcnt(12)
v_mfma_f32_16x16x32_bf16 v[32:35], v[140:143], a[32:35], v[32:35]
ds_read_b64_tr_b16 v[132:133], v201 offset:2048
v_mfma_f32_16x16x32_bf16 v[36:39], v[140:143], a[104:107], v[36:39]
v_mfma_f32_16x16x32_bf16 v[40:43], v[140:143], a[176:179], v[40:43]
ds_read_b64_tr_b16 v[134:135], v201 offset:3072
v_mfma_f32_16x16x32_bf16 v[44:47], v[140:143], a[248:251], v[44:47]
s_waitcnt lgkmcnt(12)
v_mfma_f32_16x16x32_bf16 v[48:51], v[144:147], a[32:35], v[48:51]
ds_read_b64_tr_b16 v[136:137], v203 offset:2048
v_mfma_f32_16x16x32_bf16 v[52:55], v[144:147], a[104:107], v[52:55]
v_mfma_f32_16x16x32_bf16 v[56:59], v[144:147], a[176:179], v[56:59]
ds_read_b64_tr_b16 v[138:139], v203 offset:3072
v_mfma_f32_16x16x32_bf16 v[60:63], v[144:147], a[248:251], v[60:63]
s_waitcnt lgkmcnt(12)
v_mfma_f32_16x16x32_bf16 v[64:67], v[148:151], a[32:35], v[64:67]
ds_read_b64_tr_b16 v[140:141], v205 offset:2048
v_mfma_f32_16x16x32_bf16 v[68:71], v[148:151], a[104:107], v[68:71]
v_mfma_f32_16x16x32_bf16 v[72:75], v[148:151], a[176:179], v[72:75]
ds_read_b64_tr_b16 v[142:143], v205 offset:3072
v_mfma_f32_16x16x32_bf16 v[76:79], v[148:151], a[248:251], v[76:79]
s_waitcnt vmcnt(48) lgkmcnt(12)
v_mfma_f32_16x16x32_bf16 v[16:19], v[116:119], a[36:39], v[16:19]
s_waitcnt vmcnt(47)
ds_read_b64_tr_b16 v[144:145], v207 offset:2048
v_mfma_f32_16x16x32_bf16 v[20:23], v[116:119], a[108:111], v[20:23]
s_waitcnt vmcnt(46)
v_mfma_f32_16x16x32_bf16 v[24:27], v[116:119], a[180:183], v[24:27]
s_waitcnt vmcnt(45)
ds_read_b64_tr_b16 v[146:147], v207 offset:3072
v_mfma_f32_16x16x32_bf16 v[28:31], v[116:119], a[252:255], v[28:31]
s_waitcnt lgkmcnt(12)
v_mfma_f32_16x16x32_bf16 v[32:35], v[120:123], a[36:39], v[32:35]
ds_read_b64_tr_b16 v[148:149], v201 offset:4096
v_mfma_f32_16x16x32_bf16 v[36:39], v[120:123], a[108:111], v[36:39]
v_mfma_f32_16x16x32_bf16 v[40:43], v[120:123], a[180:183], v[40:43]
ds_read_b64_tr_b16 v[150:151], v201 offset:5120
v_mfma_f32_16x16x32_bf16 v[44:47], v[120:123], a[252:255], v[44:47]
s_waitcnt lgkmcnt(12)
v_mfma_f32_16x16x32_bf16 v[48:51], v[124:127], a[36:39], v[48:51]
ds_read_b64_tr_b16 v[116:117], v203 offset:4096
v_mfma_f32_16x16x32_bf16 v[52:55], v[124:127], a[108:111], v[52:55]
v_mfma_f32_16x16x32_bf16 v[56:59], v[124:127], a[180:183], v[56:59]
ds_read_b64_tr_b16 v[118:119], v203 offset:5120
v_mfma_f32_16x16x32_bf16 v[60:63], v[124:127], a[252:255], v[60:63]
s_waitcnt lgkmcnt(12)
v_mfma_f32_16x16x32_bf16 v[64:67], v[128:131], a[36:39], v[64:67]
ds_read_b64_tr_b16 v[120:121], v205 offset:4096
v_mfma_f32_16x16x32_bf16 v[68:71], v[128:131], a[108:111], v[68:71]
v_mfma_f32_16x16x32_bf16 v[72:75], v[128:131], a[180:183], v[72:75]
ds_read_b64_tr_b16 v[122:123], v205 offset:5120
v_mfma_f32_16x16x32_bf16 v[76:79], v[128:131], a[252:255], v[76:79]
s_waitcnt vmcnt(44) lgkmcnt(12)
v_mfma_f32_16x16x32_bf16 v[16:19], v[132:135], a[40:43], v[16:19]
s_waitcnt vmcnt(43)
ds_read_b64_tr_b16 v[124:125], v207 offset:4096
v_mfma_f32_16x16x32_bf16 v[20:23], v[132:135], a[112:115], v[20:23]
s_waitcnt vmcnt(42)
v_mfma_f32_16x16x32_bf16 v[24:27], v[132:135], a[184:187], v[24:27]
s_waitcnt vmcnt(41)
ds_read_b64_tr_b16 v[126:127], v207 offset:5120
v_mfma_f32_16x16x32_bf16 v[28:31], v[132:135], v[168:171], v[28:31]
s_waitcnt vmcnt(25)
s_barrier
s_waitcnt lgkmcnt(12)
v_mfma_f32_16x16x32_bf16 v[32:35], v[136:139], a[40:43], v[32:35]
ds_read_b64_tr_b16 v[128:129], v201 offset:6144
v_mfma_f32_16x16x32_bf16 v[36:39], v[136:139], a[112:115], v[36:39]
v_mfma_f32_16x16x32_bf16 v[40:43], v[136:139], a[184:187], v[40:43]
ds_read_b64_tr_b16 v[130:131], v201 offset:7168
v_mfma_f32_16x16x32_bf16 v[44:47], v[136:139], v[168:171], v[44:47]
s_waitcnt lgkmcnt(12)
v_mfma_f32_16x16x32_bf16 v[48:51], v[140:143], a[40:43], v[48:51]
ds_read_b64_tr_b16 v[132:133], v203 offset:6144
v_mfma_f32_16x16x32_bf16 v[52:55], v[140:143], a[112:115], v[52:55]
v_mfma_f32_16x16x32_bf16 v[56:59], v[140:143], a[184:187], v[56:59]
ds_read_b64_tr_b16 v[134:135], v203 offset:7168
v_mfma_f32_16x16x32_bf16 v[60:63], v[140:143], v[168:171], v[60:63]
s_waitcnt lgkmcnt(12)
v_mfma_f32_16x16x32_bf16 v[64:67], v[144:147], a[40:43], v[64:67]
ds_read_b64_tr_b16 v[136:137], v205 offset:6144
v_mfma_f32_16x16x32_bf16 v[68:71], v[144:147], a[112:115], v[68:71]
v_mfma_f32_16x16x32_bf16 v[72:75], v[144:147], a[184:187], v[72:75]
ds_read_b64_tr_b16 v[138:139], v205 offset:7168
v_mfma_f32_16x16x32_bf16 v[76:79], v[144:147], v[168:171], v[76:79]
s_waitcnt lgkmcnt(12)
v_mfma_f32_16x16x32_bf16 v[16:19], v[148:151], a[44:47], v[16:19]
ds_read_b64_tr_b16 v[140:141], v207 offset:6144
v_mfma_f32_16x16x32_bf16 v[20:23], v[148:151], a[116:119], v[20:23]
v_mfma_f32_16x16x32_bf16 v[24:27], v[148:151], a[188:191], v[24:27]
ds_read_b64_tr_b16 v[142:143], v207 offset:7168
v_mfma_f32_16x16x32_bf16 v[28:31], v[148:151], v[172:175], v[28:31]
s_waitcnt lgkmcnt(12)
v_mfma_f32_16x16x32_bf16 v[32:35], v[116:119], a[44:47], v[32:35]
ds_read_b64_tr_b16 v[144:145], v201 offset:8192
v_mfma_f32_16x16x32_bf16 v[36:39], v[116:119], a[116:119], v[36:39]
v_mfma_f32_16x16x32_bf16 v[40:43], v[116:119], a[188:191], v[40:43]
ds_read_b64_tr_b16 v[146:147], v201 offset:9216
v_mfma_f32_16x16x32_bf16 v[44:47], v[116:119], v[172:175], v[44:47]
s_waitcnt lgkmcnt(12)
v_mfma_f32_16x16x32_bf16 v[48:51], v[120:123], a[44:47], v[48:51]
ds_read_b64_tr_b16 v[148:149], v203 offset:8192
v_mfma_f32_16x16x32_bf16 v[52:55], v[120:123], a[116:119], v[52:55]
v_mfma_f32_16x16x32_bf16 v[56:59], v[120:123], a[188:191], v[56:59]
ds_read_b64_tr_b16 v[150:151], v203 offset:9216
v_mfma_f32_16x16x32_bf16 v[60:63], v[120:123], v[172:175], v[60:63]
s_waitcnt lgkmcnt(12)
v_mfma_f32_16x16x32_bf16 v[64:67], v[124:127], a[44:47], v[64:67]
ds_read_b64_tr_b16 v[116:117], v205 offset:8192
v_mfma_f32_16x16x32_bf16 v[68:71], v[124:127], a[116:119], v[68:71]
v_mfma_f32_16x16x32_bf16 v[72:75], v[124:127], a[188:191], v[72:75]
ds_read_b64_tr_b16 v[118:119], v205 offset:9216
v_mfma_f32_16x16x32_bf16 v[76:79], v[124:127], v[172:175], v[76:79]
s_waitcnt vmcnt(23) lgkmcnt(12)
v_mfma_f32_16x16x32_bf16 v[16:19], v[128:131], a[48:51], v[16:19]
s_waitcnt vmcnt(22)
ds_read_b64_tr_b16 v[120:121], v207 offset:8192
v_mfma_f32_16x16x32_bf16 v[20:23], v[128:131], a[120:123], v[20:23]
s_waitcnt vmcnt(21)
v_mfma_f32_16x16x32_bf16 v[24:27], v[128:131], a[192:195], v[24:27]
s_waitcnt vmcnt(20)
ds_read_b64_tr_b16 v[122:123], v207 offset:9216
v_mfma_f32_16x16x32_bf16 v[28:31], v[128:131], v[176:179], v[28:31]
s_waitcnt lgkmcnt(12)
v_mfma_f32_16x16x32_bf16 v[32:35], v[132:135], a[48:51], v[32:35]
ds_read_b64_tr_b16 v[124:125], v201 offset:10240
v_mfma_f32_16x16x32_bf16 v[36:39], v[132:135], a[120:123], v[36:39]
v_mfma_f32_16x16x32_bf16 v[40:43], v[132:135], a[192:195], v[40:43]
ds_read_b64_tr_b16 v[126:127], v201 offset:11264
v_mfma_f32_16x16x32_bf16 v[44:47], v[132:135], v[176:179], v[44:47]
s_waitcnt lgkmcnt(12)
v_mfma_f32_16x16x32_bf16 v[48:51], v[136:139], a[48:51], v[48:51]
ds_read_b64_tr_b16 v[128:129], v203 offset:10240
v_mfma_f32_16x16x32_bf16 v[52:55], v[136:139], a[120:123], v[52:55]
v_mfma_f32_16x16x32_bf16 v[56:59], v[136:139], a[192:195], v[56:59]
ds_read_b64_tr_b16 v[130:131], v203 offset:11264
v_mfma_f32_16x16x32_bf16 v[60:63], v[136:139], v[176:179], v[60:63]
s_waitcnt lgkmcnt(12)
v_mfma_f32_16x16x32_bf16 v[64:67], v[140:143], a[48:51], v[64:67]
ds_read_b64_tr_b16 v[132:133], v205 offset:10240
v_mfma_f32_16x16x32_bf16 v[68:71], v[140:143], a[120:123], v[68:71]
v_mfma_f32_16x16x32_bf16 v[72:75], v[140:143], a[192:195], v[72:75]
ds_read_b64_tr_b16 v[134:135], v205 offset:11264
v_mfma_f32_16x16x32_bf16 v[76:79], v[140:143], v[176:179], v[76:79]
s_waitcnt vmcnt(19) lgkmcnt(12)
v_mfma_f32_16x16x32_bf16 v[16:19], v[144:147], a[52:55], v[16:19]
s_waitcnt vmcnt(18)
ds_read_b64_tr_b16 v[136:137], v207 offset:10240
v_mfma_f32_16x16x32_bf16 v[20:23], v[144:147], a[124:127], v[20:23]
s_waitcnt vmcnt(17)
v_mfma_f32_16x16x32_bf16 v[24:27], v[144:147], a[196:199], v[24:27]
s_waitcnt vmcnt(16)
ds_read_b64_tr_b16 v[138:139], v207 offset:11264
v_mfma_f32_16x16x32_bf16 v[28:31], v[144:147], v[180:183], v[28:31]
s_waitcnt lgkmcnt(12)
v_mfma_f32_16x16x32_bf16 v[32:35], v[148:151], a[52:55], v[32:35]
ds_read_b64_tr_b16 v[140:141], v201 offset:12288
v_mfma_f32_16x16x32_bf16 v[36:39], v[148:151], a[124:127], v[36:39]
v_mfma_f32_16x16x32_bf16 v[40:43], v[148:151], a[196:199], v[40:43]
ds_read_b64_tr_b16 v[142:143], v201 offset:13312
v_mfma_f32_16x16x32_bf16 v[44:47], v[148:151], v[180:183], v[44:47]
s_waitcnt lgkmcnt(12)
v_mfma_f32_16x16x32_bf16 v[48:51], v[116:119], a[52:55], v[48:51]
ds_read_b64_tr_b16 v[144:145], v203 offset:12288
v_mfma_f32_16x16x32_bf16 v[52:55], v[116:119], a[124:127], v[52:55]
v_mfma_f32_16x16x32_bf16 v[56:59], v[116:119], a[196:199], v[56:59]
s_cmp_gt_u32 s22, 4
s_cselect_b32 s74, s77, 0
s_bitcmp1_b32 s78, 0
s_cselect_b32 s74, 0, s74
ds_read_b64_tr_b16 v[146:147], v203 offset:13312
v_mfma_f32_16x16x32_bf16 v[60:63], v[116:119], v[180:183], v[60:63]
s_waitcnt lgkmcnt(12)
buffer_load_dword v232, v216, s[72:75], s76 offen
v_mfma_f32_16x16x32_bf16 v[64:67], v[120:123], a[52:55], v[64:67]
s_add_u32 s76, s76, 64
ds_read_b64_tr_b16 v[148:149], v205 offset:12288
v_mfma_f32_16x16x32_bf16 v[68:71], v[120:123], a[124:127], v[68:71]
v_mfma_f32_16x16x32_bf16 v[72:75], v[120:123], a[196:199], v[72:75]
s_add_u32 s78, s78, 1
ds_read_b64_tr_b16 v[150:151], v205 offset:13312
v_mfma_f32_16x16x32_bf16 v[76:79], v[120:123], v[180:183], v[76:79]
s_waitcnt vmcnt(16) lgkmcnt(12)
v_mfma_f32_16x16x32_bf16 v[16:19], v[124:127], a[56:59], v[16:19]
s_waitcnt vmcnt(15)
ds_read_b64_tr_b16 v[116:117], v207 offset:12288
v_mfma_f32_16x16x32_bf16 v[20:23], v[124:127], a[128:131], v[20:23]
s_waitcnt vmcnt(14)
v_mfma_f32_16x16x32_bf16 v[24:27], v[124:127], a[200:203], v[24:27]
s_waitcnt vmcnt(13)
ds_read_b64_tr_b16 v[118:119], v207 offset:13312
v_mfma_f32_16x16x32_bf16 v[28:31], v[124:127], v[184:187], v[28:31]
s_waitcnt lgkmcnt(12)
v_mfma_f32_16x16x32_bf16 v[32:35], v[128:131], a[56:59], v[32:35]
ds_read_b64_tr_b16 v[120:121], v201 offset:14336
v_mfma_f32_16x16x32_bf16 v[36:39], v[128:131], a[128:131], v[36:39]
v_mfma_f32_16x16x32_bf16 v[40:43], v[128:131], a[200:203], v[40:43]
ds_read_b64_tr_b16 v[122:123], v201 offset:15360
v_mfma_f32_16x16x32_bf16 v[44:47], v[128:131], v[184:187], v[44:47]
s_waitcnt lgkmcnt(12)
v_mfma_f32_16x16x32_bf16 v[48:51], v[132:135], a[56:59], v[48:51]
ds_read_b64_tr_b16 v[124:125], v203 offset:14336
v_mfma_f32_16x16x32_bf16 v[52:55], v[132:135], a[128:131], v[52:55]
v_mfma_f32_16x16x32_bf16 v[56:59], v[132:135], a[200:203], v[56:59]
ds_read_b64_tr_b16 v[126:127], v203 offset:15360
v_mfma_f32_16x16x32_bf16 v[60:63], v[132:135], v[184:187], v[60:63]
s_waitcnt lgkmcnt(12)
v_mfma_f32_16x16x32_bf16 v[64:67], v[136:139], a[56:59], v[64:67]
ds_read_b64_tr_b16 v[128:129], v205 offset:14336
v_mfma_f32_16x16x32_bf16 v[68:71], v[136:139], a[128:131], v[68:71]
v_mfma_f32_16x16x32_bf16 v[72:75], v[136:139], a[200:203], v[72:75]
ds_read_b64_tr_b16 v[130:131], v205 offset:15360
v_mfma_f32_16x16x32_bf16 v[76:79], v[136:139], v[184:187], v[76:79]
s_waitcnt vmcnt(12) lgkmcnt(12)
v_mfma_f32_16x16x32_bf16 v[16:19], v[140:143], a[60:63], v[16:19]
s_waitcnt vmcnt(11)
ds_read_b64_tr_b16 v[132:133], v207 offset:14336
v_mfma_f32_16x16x32_bf16 v[20:23], v[140:143], a[132:135], v[20:23]
s_waitcnt vmcnt(10)
v_mfma_f32_16x16x32_bf16 v[24:27], v[140:143], a[204:207], v[24:27]
s_waitcnt vmcnt(9)
ds_read_b64_tr_b16 v[134:135], v207 offset:15360
v_mfma_f32_16x16x32_bf16 v[28:31], v[140:143], v[188:191], v[28:31]
s_waitcnt lgkmcnt(12)
v_mfma_f32_16x16x32_bf16 v[32:35], v[144:147], a[60:63], v[32:35]
ds_read_b64_tr_b16 v[136:137], v201 offset:16384
v_mfma_f32_16x16x32_bf16 v[36:39], v[144:147], a[132:135], v[36:39]
v_mfma_f32_16x16x32_bf16 v[40:43], v[144:147], a[204:207], v[40:43]
ds_read_b64_tr_b16 v[138:139], v201 offset:17408
v_mfma_f32_16x16x32_bf16 v[44:47], v[144:147], v[188:191], v[44:47]
s_waitcnt lgkmcnt(12)
v_mfma_f32_16x16x32_bf16 v[48:51], v[148:151], a[60:63], v[48:51]
ds_read_b64_tr_b16 v[140:141], v203 offset:16384
v_mfma_f32_16x16x32_bf16 v[52:55], v[148:151], a[132:135], v[52:55]
v_mfma_f32_16x16x32_bf16 v[56:59], v[148:151], a[204:207], v[56:59]
ds_read_b64_tr_b16 v[142:143], v203 offset:17408
v_mfma_f32_16x16x32_bf16 v[60:63], v[148:151], v[188:191], v[60:63]
s_waitcnt lgkmcnt(12)
v_mfma_f32_16x16x32_bf16 v[64:67], v[116:119], a[60:63], v[64:67]
ds_read_b64_tr_b16 v[144:145], v205 offset:16384
v_mfma_f32_16x16x32_bf16 v[68:71], v[116:119], a[132:135], v[68:71]
v_mfma_f32_16x16x32_bf16 v[72:75], v[116:119], a[204:207], v[72:75]
ds_read_b64_tr_b16 v[146:147], v205 offset:17408
v_mfma_f32_16x16x32_bf16 v[76:79], v[116:119], v[188:191], v[76:79]
s_waitcnt vmcnt(8) lgkmcnt(12)
v_mfma_f32_16x16x32_bf16 v[16:19], v[120:123], a[64:67], v[16:19]
s_waitcnt vmcnt(7)
ds_read_b64_tr_b16 v[148:149], v207 offset:16384
v_mfma_f32_16x16x32_bf16 v[20:23], v[120:123], a[136:139], v[20:23]
s_waitcnt vmcnt(6)
v_mfma_f32_16x16x32_bf16 v[24:27], v[120:123], a[208:211], v[24:27]
s_waitcnt vmcnt(5)
ds_read_b64_tr_b16 v[150:151], v207 offset:17408
v_add_u32 v7, s29, v3
v_mfma_f32_16x16x32_bf16 v[28:31], v[120:123], v[192:195], v[28:31]
s_waitcnt lgkmcnt(12)
v_mfma_f32_16x16x32_bf16 v[32:35], v[124:127], a[64:67], v[32:35]
s_waitcnt lgkmcnt(0)
s_barrier
v_mfma_f32_16x16x32_bf16 v[36:39], v[124:127], a[136:139], v[36:39]
ds_read_b64_tr_b16 v[80:81], v7
v_mfma_f32_16x16x32_bf16 v[40:43], v[124:127], a[208:211], v[40:43]
ds_read_b64_tr_b16 v[82:83], v7 offset:1024
v_mfma_f32_16x16x32_bf16 v[44:47], v[124:127], v[192:195], v[44:47]
ds_read_b64_tr_b16 v[84:85], v7 offset:2048
v_mfma_f32_16x16x32_bf16 v[48:51], v[128:131], a[64:67], v[48:51]
ds_read_b64_tr_b16 v[86:87], v7 offset:3072
v_mfma_f32_16x16x32_bf16 v[52:55], v[128:131], a[136:139], v[52:55]
v_mfma_f32_16x16x32_bf16 v[56:59], v[128:131], a[208:211], v[56:59]
ds_read_b64_tr_b16 v[88:89], v7 offset:4096
v_mfma_f32_16x16x32_bf16 v[60:63], v[128:131], v[192:195], v[60:63]
ds_read_b64_tr_b16 v[90:91], v7 offset:5120
v_mfma_f32_16x16x32_bf16 v[64:67], v[132:135], a[64:67], v[64:67]
ds_read_b64_tr_b16 v[92:93], v7 offset:6144
v_mfma_f32_16x16x32_bf16 v[68:71], v[132:135], a[136:139], v[68:71]
ds_read_b64_tr_b16 v[94:95], v7 offset:7168
v_mfma_f32_16x16x32_bf16 v[72:75], v[132:135], a[208:211], v[72:75]
v_mfma_f32_16x16x32_bf16 v[76:79], v[132:135], v[192:195], v[76:79]
s_waitcnt vmcnt(4)
ds_read_b64_tr_b16 v[96:97], v7 offset:8192
v_mfma_f32_16x16x32_bf16 v[16:19], v[136:139], a[68:71], v[16:19]
s_waitcnt vmcnt(3)
ds_read_b64_tr_b16 v[98:99], v7 offset:9216
v_mfma_f32_16x16x32_bf16 v[20:23], v[136:139], a[140:143], v[20:23]
s_waitcnt vmcnt(2)
ds_read_b64_tr_b16 v[100:101], v7 offset:10240
v_mfma_f32_16x16x32_bf16 v[24:27], v[136:139], a[212:215], v[24:27]
s_waitcnt vmcnt(1)
v_mfma_f32_16x16x32_bf16 v[28:31], v[136:139], v[196:199], v[28:31]
ds_read_b64_tr_b16 v[102:103], v7 offset:11264
v_mfma_f32_16x16x32_bf16 v[32:35], v[140:143], a[68:71], v[32:35]
ds_read_b64_tr_b16 v[104:105], v7 offset:12288
v_mfma_f32_16x16x32_bf16 v[36:39], v[140:143], a[140:143], v[36:39]
ds_read_b64_tr_b16 v[106:107], v7 offset:13312
v_mfma_f32_16x16x32_bf16 v[40:43], v[140:143], a[212:215], v[40:43]
ds_read_b64_tr_b16 v[108:109], v7 offset:14336
v_mfma_f32_16x16x32_bf16 v[44:47], v[140:143], v[196:199], v[44:47]
v_mfma_f32_16x16x32_bf16 v[48:51], v[144:147], a[68:71], v[48:51]
ds_read_b64_tr_b16 v[110:111], v7 offset:15360
v_mfma_f32_16x16x32_bf16 v[52:55], v[144:147], a[140:143], v[52:55]
ds_read_b64_tr_b16 v[112:113], v7 offset:16384
v_mfma_f32_16x16x32_bf16 v[56:59], v[144:147], a[212:215], v[56:59]
ds_read_b64_tr_b16 v[114:115], v7 offset:17408
v_mfma_f32_16x16x32_bf16 v[60:63], v[144:147], v[196:199], v[60:63]
v_mfma_f32_16x16x32_bf16 v[64:67], v[148:151], a[68:71], v[64:67]
v_mfma_f32_16x16x32_bf16 v[68:71], v[148:151], a[140:143], v[68:71]
v_mfma_f32_16x16x32_bf16 v[72:75], v[148:151], a[212:215], v[72:75]
v_mfma_f32_16x16x32_bf16 v[76:79], v[148:151], v[196:199], v[76:79]
s_nop 7
v_mul_f32 v200, v16, v16
v_mul_f32 v201, v17, v17
v_mul_f32 v202, v18, v18
v_mul_f32 v203, v19, v19
v_fmamk_f32 v200, v200, 0xbdd2d3e8, v15
v_fmamk_f32 v201, v201, 0xbdd2d3e8, v15
v_fmamk_f32 v202, v202, 0xbdd2d3e8, v15
v_fmamk_f32 v203, v203, 0xbdd2d3e8, v15
v_mul_f32 v200, v16, v200
v_mul_f32 v201, v17, v201
v_mul_f32 v202, v18, v202
v_mul_f32 v203, v19, v203
v_exp_f32 v200, v200
v_mul_f32 v204, v16, v32
v_exp_f32 v201, v201
v_mul_f32 v205, v17, v33
v_exp_f32 v202, v202
v_mul_f32 v206, v18, v34
v_exp_f32 v203, v203
v_mul_f32 v207, v19, v35
v_add_f32 v200, 1.0, v200
v_add_f32 v201, 1.0, v201
v_rcp_f32 v200, v200
v_add_f32 v202, 1.0, v202
v_rcp_f32 v201, v201
v_add_f32 v203, 1.0, v203
v_rcp_f32 v202, v202
v_mul_f32 v204, v204, v200
v_rcp_f32 v203, v203
v_mul_f32 v205, v205, v201
v_mul_f32 v206, v206, v202
v_mul_f32 v207, v207, v203
v_cvt_pk_bf16_f32 v152, v204, v205
v_cvt_pk_bf16_f32 v153, v206, v207
v_mul_f32 v208, v20, v20
v_mul_f32 v209, v21, v21
v_mul_f32 v210, v22, v22
v_mul_f32 v211, v23, v23
v_fmamk_f32 v208, v208, 0xbdd2d3e8, v15
v_fmamk_f32 v209, v209, 0xbdd2d3e8, v15
v_fmamk_f32 v210, v210, 0xbdd2d3e8, v15
v_fmamk_f32 v211, v211, 0xbdd2d3e8, v15
v_mul_f32 v208, v20, v208
v_mul_f32 v209, v21, v209
v_mul_f32 v210, v22, v210
v_mul_f32 v211, v23, v211
v_exp_f32 v208, v208
v_mul_f32 v212, v20, v36
v_exp_f32 v209, v209
v_mul_f32 v213, v21, v37
v_exp_f32 v210, v210
v_mul_f32 v214, v22, v38
v_exp_f32 v211, v211
v_mul_f32 v215, v23, v39
v_add_f32 v208, 1.0, v208
v_add_f32 v209, 1.0, v209
v_rcp_f32 v208, v208
v_add_f32 v210, 1.0, v210
v_rcp_f32 v209, v209
v_add_f32 v211, 1.0, v211
v_rcp_f32 v210, v210
v_mul_f32 v212, v212, v208
v_rcp_f32 v211, v211
v_mul_f32 v213, v213, v209
v_mul_f32 v214, v214, v210
v_mul_f32 v215, v215, v211
v_cvt_pk_bf16_f32 v156, v212, v213
v_cvt_pk_bf16_f32 v157, v214, v215
v_mul_f32 v200, v24, v24
v_mul_f32 v201, v25, v25
v_mul_f32 v202, v26, v26
v_mul_f32 v203, v27, v27
v_fmamk_f32 v200, v200, 0xbdd2d3e8, v15
v_fmamk_f32 v201, v201, 0xbdd2d3e8, v15
v_fmamk_f32 v202, v202, 0xbdd2d3e8, v15
v_fmamk_f32 v203, v203, 0xbdd2d3e8, v15
v_mul_f32 v200, v24, v200
v_mul_f32 v201, v25, v201
v_mul_f32 v202, v26, v202
v_mul_f32 v203, v27, v203
v_exp_f32 v200, v200
v_mul_f32 v204, v24, v40
v_exp_f32 v201, v201
v_mul_f32 v205, v25, v41
v_exp_f32 v202, v202
v_mul_f32 v206, v26, v42
v_exp_f32 v203, v203
v_mul_f32 v207, v27, v43
v_add_f32 v200, 1.0, v200
v_add_f32 v201, 1.0, v201
v_rcp_f32 v200, v200
v_add_f32 v202, 1.0, v202
v_rcp_f32 v201, v201
v_add_f32 v203, 1.0, v203
v_rcp_f32 v202, v202
v_mul_f32 v204, v204, v200
v_rcp_f32 v203, v203
v_mul_f32 v205, v205, v201
v_mul_f32 v206, v206, v202
v_mul_f32 v207, v207, v203
v_cvt_pk_bf16_f32 v160, v204, v205
v_cvt_pk_bf16_f32 v161, v206, v207
v_mul_f32 v208, v28, v28
v_mul_f32 v209, v29, v29
v_mul_f32 v210, v30, v30
v_mul_f32 v211, v31, v31
v_fmamk_f32 v208, v208, 0xbdd2d3e8, v15
v_fmamk_f32 v209, v209, 0xbdd2d3e8, v15
v_fmamk_f32 v210, v210, 0xbdd2d3e8, v15
v_fmamk_f32 v211, v211, 0xbdd2d3e8, v15
v_mul_f32 v208, v28, v208
v_mul_f32 v209, v29, v209
v_mul_f32 v210, v30, v210
v_mul_f32 v211, v31, v211
v_exp_f32 v208, v208
v_mul_f32 v212, v28, v44
v_exp_f32 v209, v209
v_mul_f32 v213, v29, v45
v_exp_f32 v210, v210
v_mul_f32 v214, v30, v46
v_exp_f32 v211, v211
v_mul_f32 v215, v31, v47
v_add_f32 v208, 1.0, v208
v_add_f32 v209, 1.0, v209
v_rcp_f32 v208, v208
v_add_f32 v210, 1.0, v210
v_rcp_f32 v209, v209
v_add_f32 v211, 1.0, v211
v_rcp_f32 v210, v210
v_mul_f32 v212, v212, v208
v_rcp_f32 v211, v211
v_mul_f32 v213, v213, v209
v_mul_f32 v214, v214, v210
v_mul_f32 v215, v215, v211
v_cvt_pk_bf16_f32 v164, v212, v213
v_cvt_pk_bf16_f32 v165, v214, v215
s_getpc_b64 s[90:91]
L_ct_apG:
s_add_u32 s90, s90, ap_kernel-L_ct_apG
s_addc_u32 s91, s91, 0
s_lshr_b32 s38, s2, 3
s_and_b32 s38, s38, 31
s_mul_i32 s38, s38, 2176
v_min_u32 v238, 16, v0
v_lshlrev_b32 v238, 7, v238
v_add_u32 v238, s38, v238
global_load_dword v240, v238, s[90:91]
s_mov_b32 s34, s33
s_mov_b32 s58, s54
s_add_u32 s33, s33, 1024
s_xor_b32 s27, s27, 73728
s_xor_b32 s29, s29, 73728
s_add_u32 s28, s27, 18432
s_sub_u32 s22, s22, 1
s_cmp_lg_u32 s22, 0
s_branch L_p1_loopG
L_p1_oldG:
s_mov_b32 m0, s30
s_mov_b32 s31, s32
buffer_load_dwordx4 v9, s[44:47], s31 offen lds
s_add_u32 m0, m0, 4096
s_add_u32 s31, s31, 589824
buffer_load_dwordx4 v9, s[44:47], s31 offen lds
s_add_u32 m0, m0, 4096
s_add_u32 s31, s31, 589824
buffer_load_dwordx4 v9, s[44:47], s31 offen lds
s_add_u32 m0, m0, 4096
s_add_u32 s31, s31, 589824
buffer_load_dwordx4 v9, s[44:47], s31 offen lds
s_add_u32 m0, m0, 4096
s_add_u32 s31, s31, 589824
buffer_load_dwordx4 v9, s[44:47], s31 offen lds
s_add_u32 m0, m0, 4096
s_add_u32 s31, s31, 589824
buffer_load_dwordx4 v9, s[44:47], s31 offen lds
s_add_u32 m0, m0, 4096
s_add_u32 s31, s31, 589824
buffer_load_dwordx4 v9, s[44:47], s31 offen lds
s_add_u32 m0, m0, 4096
s_add_u32 s31, s31, 589824
buffer_load_dwordx4 v9, s[44:47], s31 offen lds
s_add_u32 m0, m0, 4096
s_add_u32 s31, s31, 589824
buffer_load_dwordx4 v9, s[44:47], s31 offen lds
s_add_u32 m0, s30, 36864
s_mov_b32 s31, s32
buffer_load_dwordx4 v9, s[48:51], s31 offen lds
s_add_u32 m0, m0, 4096
s_add_u32 s31, s31, 589824
buffer_load_dwordx4 v9, s[48:51], s31 offen lds
s_add_u32 m0, m0, 4096
s_add_u32 s31, s31, 589824
buffer_load_dwordx4 v9, s[48:51], s31 offen lds
s_add_u32 m0, m0, 4096
s_add_u32 s31, s31, 589824
buffer_load_dwordx4 v9, s[48:51], s31 offen lds
s_add_u32 m0, m0, 4096
s_add_u32 s31, s31, 589824
buffer_load_dwordx4 v9, s[48:51], s31 offen lds
s_add_u32 m0, m0, 4096
s_add_u32 s31, s31, 589824
buffer_load_dwordx4 v9, s[48:51], s31 offen lds
s_add_u32 m0, m0, 4096
s_add_u32 s31, s31, 589824
buffer_load_dwordx4 v9, s[48:51], s31 offen lds
s_add_u32 m0, m0, 4096
s_add_u32 s31, s31, 589824
buffer_load_dwordx4 v9, s[48:51], s31 offen lds
s_add_u32 m0, m0, 4096
s_add_u32 s31, s31, 589824
buffer_load_dwordx4 v9, s[48:51], s31 offen lds
s_waitcnt vmcnt(0)
s_barrier
v_add_u32 v7, s27, v3
s_nop 0
ds_read_b64_tr_b16 v[80:81], v7
ds_read_b64_tr_b16 v[82:83], v7 offset:1024
ds_read_b64_tr_b16 v[84:85], v7 offset:2048
ds_read_b64_tr_b16 v[86:87], v7 offset:3072
ds_read_b64_tr_b16 v[88:89], v7 offset:4096
ds_read_b64_tr_b16 v[90:91], v7 offset:5120
ds_read_b64_tr_b16 v[92:93], v7 offset:6144
ds_read_b64_tr_b16 v[94:95], v7 offset:7168
ds_read_b64_tr_b16 v[96:97], v7 offset:8192
ds_read_b64_tr_b16 v[98:99], v7 offset:9216
ds_read_b64_tr_b16 v[100:101], v7 offset:10240
ds_read_b64_tr_b16 v[102:103], v7 offset:11264
ds_read_b64_tr_b16 v[104:105], v7 offset:12288
ds_read_b64_tr_b16 v[106:107], v7 offset:13312
ds_read_b64_tr_b16 v[108:109], v7 offset:14336
ds_read_b64_tr_b16 v[110:111], v7 offset:15360
ds_read_b64_tr_b16 v[112:113], v7 offset:16384
ds_read_b64_tr_b16 v[114:115], v7 offset:17408
L_p1_loopG:
s_waitcnt lgkmcnt(12)
v_mfma_f32_16x16x32_bf16 v[16:19], v[80:83], a[0:3], 0
s_add_u32 s32, s32, 64
v_add_u32 v8, s28, v3
v_mfma_f32_16x16x32_bf16 v[16:19], v[84:87], a[4:7], v[16:19]
s_xor_b32 s30, s30, 73728
ds_read_b64_tr_b16 v[116:117], v8
v_mfma_f32_16x16x32_bf16 v[16:19], v[88:91], a[8:11], v[16:19]
s_waitcnt lgkmcnt(7)
s_cmp_eq_u32 s22, 1
s_cselect_b32 s46, 0, s46
s_cselect_b32 s50, 0, s50
s_mov_b32 m0, s30
ds_read_b64_tr_b16 v[118:119], v8 offset:1024
v_mfma_f32_16x16x32_bf16 v[16:19], v[92:95], a[12:15], v[16:19]
s_mov_b32 s31, s32
ds_read_b64_tr_b16 v[120:121], v8 offset:2048
v_mfma_f32_16x16x32_bf16 v[16:19], v[96:99], a[16:19], v[16:19]
buffer_load_dwordx4 v9, s[44:47], s31 offen lds
v_mfma_f32_16x16x32_bf16 v[16:19], v[100:103], a[20:23], v[16:19]
s_waitcnt lgkmcnt(3)
ds_read_b64_tr_b16 v[122:123], v8 offset:3072
v_mfma_f32_16x16x32_bf16 v[16:19], v[104:107], a[24:27], v[16:19]
v_mfma_f32_16x16x32_bf16 v[16:19], v[108:111], a[28:31], v[16:19]
s_add_u32 m0, m0, 4096
ds_read_b64_tr_b16 v[124:125], v8 offset:4096
v_mfma_f32_16x16x32_bf16 v[16:19], v[112:115], a[32:35], v[16:19]
s_add_u32 s31, s31, 589824
v_mfma_f32_16x16x32_bf16 v[20:23], v[80:83], a[72:75], 0
ds_read_b64_tr_b16 v[126:127], v8 offset:5120
v_mul_f32 v200, v48, v48
v_mfma_f32_16x16x32_bf16 v[20:23], v[84:87], a[76:79], v[20:23]
buffer_load_dwordx4 v9, s[44:47], s31 offen lds
v_mul_f32 v201, v49, v49
v_mfma_f32_16x16x32_bf16 v[20:23], v[88:91], a[80:83], v[20:23]
ds_read_b64_tr_b16 v[128:129], v8 offset:6144
v_mul_f32 v202, v50, v50
v_mfma_f32_16x16x32_bf16 v[20:23], v[92:95], a[84:87], v[20:23]
v_mul_f32 v203, v51, v51
v_fmamk_f32 v200, v200, 0xbdd2d3e8, v15
v_mfma_f32_16x16x32_bf16 v[20:23], v[96:99], a[88:91], v[20:23]
ds_read_b64_tr_b16 v[130:131], v8 offset:7168
v_fmamk_f32 v201, v201, 0xbdd2d3e8, v15
v_mfma_f32_16x16x32_bf16 v[20:23], v[100:103], a[92:95], v[20:23]
v_fmamk_f32 v202, v202, 0xbdd2d3e8, v15
v_fmamk_f32 v203, v203, 0xbdd2d3e8, v15
v_mfma_f32_16x16x32_bf16 v[20:23], v[104:107], a[96:99], v[20:23]
s_add_u32 m0, m0, 4096
ds_read_b64_tr_b16 v[132:133], v8 offset:8192
v_mul_f32 v200, v48, v200
v_mfma_f32_16x16x32_bf16 v[20:23], v[108:111], a[100:103], v[20:23]
s_add_u32 s31, s31, 589824
v_mul_f32 v201, v49, v201
v_mul_f32 v202, v50, v202
v_mfma_f32_16x16x32_bf16 v[20:23], v[112:115], a[104:107], v[20:23]
ds_read_b64_tr_b16 v[134:135], v8 offset:9216
v_mul_f32 v203, v51, v203
v_mfma_f32_16x16x32_bf16 v[24:27], v[80:83], a[144:147], 0
ds_read_b64_tr_b16 v[136:137], v8 offset:10240
v_mfma_f32_16x16x32_bf16 v[24:27], v[84:87], a[148:151], v[24:27]
buffer_load_dwordx4 v9, s[44:47], s31 offen lds
v_mfma_f32_16x16x32_bf16 v[24:27], v[88:91], a[152:155], v[24:27]
ds_read_b64_tr_b16 v[138:139], v8 offset:11264
v_mfma_f32_16x16x32_bf16 v[24:27], v[92:95], a[156:159], v[24:27]
v_exp_f32 v200, v200
v_mfma_f32_16x16x32_bf16 v[24:27], v[96:99], a[160:163], v[24:27]
ds_read_b64_tr_b16 v[140:141], v8 offset:12288
v_mul_f32 v204, v48, v64
v_mfma_f32_16x16x32_bf16 v[24:27], v[100:103], a[164:167], v[24:27]
s_add_u32 m0, m0, 4096
v_exp_f32 v201, v201
v_mfma_f32_16x16x32_bf16 v[24:27], v[104:107], a[168:171], v[24:27]
s_add_u32 s31, s31, 589824
ds_read_b64_tr_b16 v[142:143], v8 offset:13312
v_mul_f32 v205, v49, v65
v_mfma_f32_16x16x32_bf16 v[24:27], v[108:111], a[172:175], v[24:27]
v_exp_f32 v202, v202
v_mfma_f32_16x16x32_bf16 v[24:27], v[112:115], a[176:179], v[24:27]
ds_read_b64_tr_b16 v[144:145], v8 offset:14336
v_mul_f32 v206, v50, v66
v_mfma_f32_16x16x32_bf16 v[28:31], v[80:83], a[216:219], 0
buffer_load_dwordx4 v9, s[44:47], s31 offen lds
v_mfma_f32_16x16x32_bf16 v[28:31], v[84:87], a[220:223], v[28:31]
ds_read_b64_tr_b16 v[146:147], v8 offset:15360
v_mfma_f32_16x16x32_bf16 v[28:31], v[88:91], a[224:227], v[28:31]
v_exp_f32 v203, v203
v_mfma_f32_16x16x32_bf16 v[28:31], v[92:95], a[228:231], v[28:31]
ds_read_b64_tr_b16 v[148:149], v8 offset:16384
v_mul_f32 v207, v51, v67
v_mfma_f32_16x16x32_bf16 v[28:31], v[96:99], a[232:235], v[28:31]
s_add_u32 m0, m0, 4096
v_add_f32 v200, 1.0, v200
v_add_f32 v201, 1.0, v201
v_mfma_f32_16x16x32_bf16 v[28:31], v[100:103], a[236:239], v[28:31]
s_add_u32 s31, s31, 589824
ds_read_b64_tr_b16 v[150:151], v8 offset:17408
v_mfma_f32_16x16x32_bf16 v[28:31], v[104:107], a[240:243], v[28:31]
v_rcp_f32 v200, v200
v_mfma_f32_16x16x32_bf16 v[28:31], v[108:111], a[244:247], v[28:31]
buffer_load_dwordx4 v9, s[44:47], s31 offen lds
v_add_u32 v7, s27, v5
v_mfma_f32_16x16x32_bf16 v[28:31], v[112:115], a[248:251], v[28:31]
s_waitcnt lgkmcnt(12)
v_add_f32 v202, 1.0, v202
v_mfma_f32_16x16x32_bf16 v[16:19], v[116:119], a[36:39], v[16:19]
ds_read_b64_tr_b16 v[80:81], v7
v_rcp_f32 v201, v201
v_mfma_f32_16x16x32_bf16 v[16:19], v[120:123], a[40:43], v[16:19]
ds_read_b64_tr_b16 v[82:83], v7 offset:1024
v_add_f32 v203, 1.0, v203
v_mfma_f32_16x16x32_bf16 v[16:19], v[124:127], a[44:47], v[16:19]
s_waitcnt lgkmcnt(8)
v_rcp_f32 v202, v202
v_mfma_f32_16x16x32_bf16 v[16:19], v[128:131], a[48:51], v[16:19]
s_add_u32 m0, m0, 4096
ds_read_b64_tr_b16 v[84:85], v7 offset:2048
v_mul_f32 v204, v204, v200
v_mfma_f32_16x16x32_bf16 v[16:19], v[132:135], a[52:55], v[16:19]
s_add_u32 s31, s31, 589824
v_rcp_f32 v203, v203
v_mfma_f32_16x16x32_bf16 v[16:19], v[136:139], a[56:59], v[16:19]
s_waitcnt lgkmcnt(3)
ds_read_b64_tr_b16 v[86:87], v7 offset:3072
v_mul_f32 v205, v205, v201
v_mfma_f32_16x16x32_bf16 v[16:19], v[140:143], a[60:63], v[16:19]
buffer_load_dwordx4 v9, s[44:47], s31 offen lds
v_mul_f32 v206, v206, v202
v_mfma_f32_16x16x32_bf16 v[16:19], v[144:147], a[64:67], v[16:19]
ds_read_b64_tr_b16 v[88:89], v7 offset:4096
v_mul_f32 v207, v207, v203
v_mfma_f32_16x16x32_bf16 v[16:19], v[148:151], a[68:71], v[16:19]
v_cvt_pk_bf16_f32 v154, v204, v205
v_cvt_pk_bf16_f32 v155, v206, v207
v_mfma_f32_16x16x32_bf16 v[20:23], v[116:119], a[108:111], v[20:23]
ds_read_b64_tr_b16 v[90:91], v7 offset:5120
v_mfma_f32_16x16x32_bf16 v[20:23], v[120:123], a[112:115], v[20:23]
buffer_store_dwordx4 v[152:155], v2, s[56:59], s34 offen sc1
v_mul_f32 v208, v52, v52
v_mfma_f32_16x16x32_bf16 v[20:23], v[124:127], a[116:119], v[20:23]
s_add_u32 m0, m0, 4096
ds_read_b64_tr_b16 v[92:93], v7 offset:6144
v_mul_f32 v209, v53, v53
v_mfma_f32_16x16x32_bf16 v[20:23], v[128:131], a[120:123], v[20:23]
s_add_u32 s31, s31, 589824
v_mul_f32 v210, v54, v54
v_mul_f32 v211, v55, v55
v_mfma_f32_16x16x32_bf16 v[20:23], v[132:135], a[124:127], v[20:23]
ds_read_b64_tr_b16 v[94:95], v7 offset:7168
v_fmamk_f32 v208, v208, 0xbdd2d3e8, v15
v_mfma_f32_16x16x32_bf16 v[20:23], v[136:139], a[128:131], v[20:23]
buffer_load_dwordx4 v9, s[44:47], s31 offen lds
v_fmamk_f32 v209, v209, 0xbdd2d3e8, v15
v_mfma_f32_16x16x32_bf16 v[20:23], v[140:143], a[132:135], v[20:23]
ds_read_b64_tr_b16 v[96:97], v7 offset:8192
v_fmamk_f32 v210, v210, 0xbdd2d3e8, v15
v_mfma_f32_16x16x32_bf16 v[20:23], v[144:147], a[136:139], v[20:23]
v_fmamk_f32 v211, v211, 0xbdd2d3e8, v15
v_mul_f32 v208, v52, v208
v_mfma_f32_16x16x32_bf16 v[20:23], v[148:151], a[140:143], v[20:23]
ds_read_b64_tr_b16 v[98:99], v7 offset:9216
v_mul_f32 v209, v53, v209
v_mfma_f32_16x16x32_bf16 v[24:27], v[116:119], a[180:183], v[24:27]
s_add_u32 m0, m0, 4096
ds_read_b64_tr_b16 v[100:101], v7 offset:10240
v_mul_f32 v210, v54, v210
v_mfma_f32_16x16x32_bf16 v[24:27], v[120:123], a[184:187], v[24:27]
s_add_u32 s31, s31, 589824
v_mul_f32 v211, v55, v211
v_exp_f32 v208, v208
v_mfma_f32_16x16x32_bf16 v[24:27], v[124:127], a[188:191], v[24:27]
ds_read_b64_tr_b16 v[102:103], v7 offset:11264
v_mul_f32 v212, v52, v68
v_mfma_f32_16x16x32_bf16 v[24:27], v[128:131], a[192:195], v[24:27]
buffer_load_dwordx4 v9, s[44:47], s31 offen lds
v_mfma_f32_16x16x32_bf16 v[24:27], v[132:135], a[196:199], v[24:27]
ds_read_b64_tr_b16 v[104:105], v7 offset:12288
v_exp_f32 v209, v209
v_mfma_f32_16x16x32_bf16 v[24:27], v[136:139], a[200:203], v[24:27]
v_mul_f32 v213, v53, v69
v_mfma_f32_16x16x32_bf16 v[24:27], v[140:143], a[204:207], v[24:27]
ds_read_b64_tr_b16 v[106:107], v7 offset:13312
v_exp_f32 v210, v210
v_mfma_f32_16x16x32_bf16 v[24:27], v[144:147], a[208:211], v[24:27]
v_mul_f32 v214, v54, v70
v_mfma_f32_16x16x32_bf16 v[24:27], v[148:151], a[212:215], v[24:27]
s_add_u32 m0, m0, 4096
ds_read_b64_tr_b16 v[108:109], v7 offset:14336
v_exp_f32 v211, v211
v_mfma_f32_16x16x32_bf16 v[28:31], v[116:119], a[252:255], v[28:31]
s_add_u32 s31, s31, 589824
v_mul_f32 v215, v55, v71
v_add_f32 v208, 1.0, v208
v_mfma_f32_16x16x32_bf16 v[28:31], v[120:123], v[168:171], v[28:31]
ds_read_b64_tr_b16 v[110:111], v7 offset:15360
v_add_f32 v209, 1.0, v209
v_mfma_f32_16x16x32_bf16 v[28:31], v[124:127], v[172:175], v[28:31]
buffer_load_dwordx4 v9, s[44:47], s31 offen lds
v_mfma_f32_16x16x32_bf16 v[28:31], v[128:131], v[176:179], v[28:31]
ds_read_b64_tr_b16 v[112:113], v7 offset:16384
v_rcp_f32 v208, v208
v_mfma_f32_16x16x32_bf16 v[28:31], v[132:135], v[180:183], v[28:31]
v_add_f32 v210, 1.0, v210
v_mfma_f32_16x16x32_bf16 v[28:31], v[136:139], v[184:187], v[28:31]
ds_read_b64_tr_b16 v[114:115], v7 offset:17408
v_rcp_f32 v209, v209
v_mfma_f32_16x16x32_bf16 v[28:31], v[140:143], v[188:191], v[28:31]
v_add_f32 v211, 1.0, v211
v_mfma_f32_16x16x32_bf16 v[28:31], v[144:147], v[192:195], v[28:31]
s_add_u32 m0, s30, 36864
v_add_u32 v8, s28, v5
v_mfma_f32_16x16x32_bf16 v[28:31], v[148:151], v[196:199], v[28:31]
s_waitcnt lgkmcnt(12)
s_mov_b32 s31, s32
v_rcp_f32 v210, v210
v_mfma_f32_16x16x32_bf16 v[32:35], v[80:83], a[0:3], 0
ds_read_b64_tr_b16 v[116:117], v8
v_mul_f32 v212, v212, v208
v_mfma_f32_16x16x32_bf16 v[32:35], v[84:87], a[4:7], v[32:35]
ds_read_b64_tr_b16 v[118:119], v8 offset:1024
v_rcp_f32 v211, v211
v_mfma_f32_16x16x32_bf16 v[32:35], v[88:91], a[8:11], v[32:35]
s_waitcnt lgkmcnt(8)
buffer_load_dwordx4 v9, s[48:51], s31 offen lds
v_mul_f32 v213, v213, v209
v_mfma_f32_16x16x32_bf16 v[32:35], v[92:95], a[12:15], v[32:35]
ds_read_b64_tr_b16 v[120:121], v8 offset:2048
v_mul_f32 v214, v214, v210
v_mfma_f32_16x16x32_bf16 v[32:35], v[96:99], a[16:19], v[32:35]
v_mul_f32 v215, v215, v211
v_cvt_pk_bf16_f32 v158, v212, v213
v_mfma_f32_16x16x32_bf16 v[32:35], v[100:103], a[20:23], v[32:35]
s_waitcnt lgkmcnt(3)
ds_read_b64_tr_b16 v[122:123], v8 offset:3072
v_cvt_pk_bf16_f32 v159, v214, v215
v_mfma_f32_16x16x32_bf16 v[32:35], v[104:107], a[24:27], v[32:35]
s_add_u32 m0, m0, 4096
s_add_u32 s35, s34, 147456
buffer_store_dwordx4 v[156:159], v2, s[56:59], s35 offen sc1
v_mul_f32 v200, v56, v56
v_mfma_f32_16x16x32_bf16 v[32:35], v[108:111], a[28:31], v[32:35]
s_add_u32 s31, s31, 589824
ds_read_b64_tr_b16 v[124:125], v8 offset:4096
v_mul_f32 v201, v57, v57
v_mfma_f32_16x16x32_bf16 v[32:35], v[112:115], a[32:35], v[32:35]
v_mul_f32 v202, v58, v58
v_mul_f32 v203, v59, v59
v_mfma_f32_16x16x32_bf16 v[36:39], v[80:83], a[72:75], 0
ds_read_b64_tr_b16 v[126:127], v8 offset:5120
v_fmamk_f32 v200, v200, 0xbdd2d3e8, v15
v_mfma_f32_16x16x32_bf16 v[36:39], v[84:87], a[76:79], v[36:39]
buffer_load_dwordx4 v9, s[48:51], s31 offen lds
v_fmamk_f32 v201, v201, 0xbdd2d3e8, v15
v_mfma_f32_16x16x32_bf16 v[36:39], v[88:91], a[80:83], v[36:39]
ds_read_b64_tr_b16 v[128:129], v8 offset:6144
v_fmamk_f32 v202, v202, 0xbdd2d3e8, v15
v_mfma_f32_16x16x32_bf16 v[36:39], v[92:95], a[84:87], v[36:39]
v_fmamk_f32 v203, v203, 0xbdd2d3e8, v15
v_mul_f32 v200, v56, v200
v_mfma_f32_16x16x32_bf16 v[36:39], v[96:99], a[88:91], v[36:39]
ds_read_b64_tr_b16 v[130:131], v8 offset:7168
v_mul_f32 v201, v57, v201
v_mfma_f32_16x16x32_bf16 v[36:39], v[100:103], a[92:95], v[36:39]
s_add_u32 m0, m0, 4096
v_mul_f32 v202, v58, v202
v_mul_f32 v203, v59, v203
v_mfma_f32_16x16x32_bf16 v[36:39], v[104:107], a[96:99], v[36:39]
s_add_u32 s31, s31, 589824
ds_read_b64_tr_b16 v[132:133], v8 offset:8192
v_mfma_f32_16x16x32_bf16 v[36:39], v[108:111], a[100:103], v[36:39]
v_exp_f32 v200, v200
v_mfma_f32_16x16x32_bf16 v[36:39], v[112:115], a[104:107], v[36:39]
ds_read_b64_tr_b16 v[134:135], v8 offset:9216
v_mul_f32 v204, v56, v72
v_mfma_f32_16x16x32_bf16 v[40:43], v[80:83], a[144:147], 0
ds_read_b64_tr_b16 v[136:137], v8 offset:10240
v_exp_f32 v201, v201
v_mfma_f32_16x16x32_bf16 v[40:43], v[84:87], a[148:151], v[40:43]
buffer_load_dwordx4 v9, s[48:51], s31 offen lds
v_mul_f32 v205, v57, v73
v_mfma_f32_16x16x32_bf16 v[40:43], v[88:91], a[152:155], v[40:43]
ds_read_b64_tr_b16 v[138:139], v8 offset:11264
v_mfma_f32_16x16x32_bf16 v[40:43], v[92:95], a[156:159], v[40:43]
v_exp_f32 v202, v202
v_mfma_f32_16x16x32_bf16 v[40:43], v[96:99], a[160:163], v[40:43]
s_add_u32 m0, m0, 4096
ds_read_b64_tr_b16 v[140:141], v8 offset:12288
v_mul_f32 v206, v58, v74
v_mfma_f32_16x16x32_bf16 v[40:43], v[100:103], a[164:167], v[40:43]
s_add_u32 s31, s31, 589824
v_exp_f32 v203, v203
v_mfma_f32_16x16x32_bf16 v[40:43], v[104:107], a[168:171], v[40:43]
ds_read_b64_tr_b16 v[142:143], v8 offset:13312
v_mul_f32 v207, v59, v75
v_mfma_f32_16x16x32_bf16 v[40:43], v[108:111], a[172:175], v[40:43]
buffer_load_dwordx4 v9, s[48:51], s31 offen lds
v_add_f32 v200, 1.0, v200
v_mfma_f32_16x16x32_bf16 v[40:43], v[112:115], a[176:179], v[40:43]
ds_read_b64_tr_b16 v[144:145], v8 offset:14336
v_add_f32 v201, 1.0, v201
v_mfma_f32_16x16x32_bf16 v[44:47], v[80:83], a[216:219], 0
v_rcp_f32 v200, v200
v_mfma_f32_16x16x32_bf16 v[44:47], v[84:87], a[220:223], v[44:47]
ds_read_b64_tr_b16 v[146:147], v8 offset:15360
v_add_f32 v202, 1.0, v202
v_mfma_f32_16x16x32_bf16 v[44:47], v[88:91], a[224:227], v[44:47]
s_add_u32 m0, m0, 4096
v_rcp_f32 v201, v201
v_mfma_f32_16x16x32_bf16 v[44:47], v[92:95], a[228:231], v[44:47]
s_add_u32 s31, s31, 589824
ds_read_b64_tr_b16 v[148:149], v8 offset:16384
v_add_f32 v203, 1.0, v203
v_mfma_f32_16x16x32_bf16 v[44:47], v[96:99], a[232:235], v[44:47]
v_rcp_f32 v202, v202
v_mfma_f32_16x16x32_bf16 v[44:47], v[100:103], a[236:239], v[44:47]
ds_read_b64_tr_b16 v[150:151], v8 offset:17408
v_mul_f32 v204, v204, v200
v_mfma_f32_16x16x32_bf16 v[44:47], v[104:107], a[240:243], v[44:47]
buffer_load_dwordx4 v9, s[48:51], s31 offen lds
v_mfma_f32_16x16x32_bf16 v[44:47], v[108:111], a[244:247], v[44:47]
v_rcp_f32 v203, v203
v_mfma_f32_16x16x32_bf16 v[44:47], v[112:115], a[248:251], v[44:47]
s_waitcnt lgkmcnt(12)
v_add_u32 v7, s27, v4
v_mul_f32 v205, v205, v201
v_mfma_f32_16x16x32_bf16 v[32:35], v[116:119], a[36:39], v[32:35]
ds_read_b64_tr_b16 v[80:81], v7
v_mul_f32 v206, v206, v202
v_mfma_f32_16x16x32_bf16 v[32:35], v[120:123], a[40:43], v[32:35]
s_add_u32 m0, m0, 4096
ds_read_b64_tr_b16 v[82:83], v7 offset:1024
v_mul_f32 v207, v207, v203
v_cvt_pk_bf16_f32 v162, v204, v205
v_mfma_f32_16x16x32_bf16 v[32:35], v[124:127], a[44:47], v[32:35]
s_waitcnt lgkmcnt(8)
s_add_u32 s31, s31, 589824
v_cvt_pk_bf16_f32 v163, v206, v207
v_mfma_f32_16x16x32_bf16 v[32:35], v[128:131], a[48:51], v[32:35]
ds_read_b64_tr_b16 v[84:85], v7 offset:2048
v_mfma_f32_16x16x32_bf16 v[32:35], v[132:135], a[52:55], v[32:35]
s_add_u32 s35, s34, 294912
buffer_store_dwordx4 v[160:163], v2, s[56:59], s35 offen sc1
v_mul_f32 v208, v60, v60
v_mfma_f32_16x16x32_bf16 v[32:35], v[136:139], a[56:59], v[32:35]
s_waitcnt lgkmcnt(3)
ds_read_b64_tr_b16 v[86:87], v7 offset:3072
v_mul_f32 v209, v61, v61
v_mul_f32 v210, v62, v62
v_mfma_f32_16x16x32_bf16 v[32:35], v[140:143], a[60:63], v[32:35]
buffer_load_dwordx4 v9, s[48:51], s31 offen lds
v_mul_f32 v211, v63, v63
v_mfma_f32_16x16x32_bf16 v[32:35], v[144:147], a[64:67], v[32:35]
ds_read_b64_tr_b16 v[88:89], v7 offset:4096
v_fmamk_f32 v208, v208, 0xbdd2d3e8, v15
v_mfma_f32_16x16x32_bf16 v[32:35], v[148:151], a[68:71], v[32:35]
v_fmamk_f32 v209, v209, 0xbdd2d3e8, v15
v_fmamk_f32 v210, v210, 0xbdd2d3e8, v15
v_mfma_f32_16x16x32_bf16 v[36:39], v[116:119], a[108:111], v[36:39]
s_add_u32 m0, m0, 4096
ds_read_b64_tr_b16 v[90:91], v7 offset:5120
v_fmamk_f32 v211, v211, 0xbdd2d3e8, v15
v_mfma_f32_16x16x32_bf16 v[36:39], v[120:123], a[112:115], v[36:39]
s_add_u32 s31, s31, 589824
v_mul_f32 v208, v60, v208
v_mul_f32 v209, v61, v209
v_mfma_f32_16x16x32_bf16 v[36:39], v[124:127], a[116:119], v[36:39]
ds_read_b64_tr_b16 v[92:93], v7 offset:6144
v_mul_f32 v210, v62, v210
v_mfma_f32_16x16x32_bf16 v[36:39], v[128:131], a[120:123], v[36:39]
buffer_load_dwordx4 v9, s[48:51], s31 offen lds
v_mul_f32 v211, v63, v211
v_mfma_f32_16x16x32_bf16 v[36:39], v[132:135], a[124:127], v[36:39]
ds_read_b64_tr_b16 v[94:95], v7 offset:7168
v_exp_f32 v208, v208
v_mfma_f32_16x16x32_bf16 v[36:39], v[136:139], a[128:131], v[36:39]
v_mul_f32 v212, v60, v76
v_mfma_f32_16x16x32_bf16 v[36:39], v[140:143], a[132:135], v[36:39]
ds_read_b64_tr_b16 v[96:97], v7 offset:8192
v_exp_f32 v209, v209
v_mfma_f32_16x16x32_bf16 v[36:39], v[144:147], a[136:139], v[36:39]
v_mul_f32 v213, v61, v77
v_mfma_f32_16x16x32_bf16 v[36:39], v[148:151], a[140:143], v[36:39]
s_add_u32 m0, m0, 4096
ds_read_b64_tr_b16 v[98:99], v7 offset:9216
v_exp_f32 v210, v210
v_mfma_f32_16x16x32_bf16 v[40:43], v[116:119], a[180:183], v[40:43]
s_add_u32 s31, s31, 589824
ds_read_b64_tr_b16 v[100:101], v7 offset:10240
v_mul_f32 v214, v62, v78
v_mfma_f32_16x16x32_bf16 v[40:43], v[120:123], a[184:187], v[40:43]
v_exp_f32 v211, v211
v_mfma_f32_16x16x32_bf16 v[40:43], v[124:127], a[188:191], v[40:43]
ds_read_b64_tr_b16 v[102:103], v7 offset:11264
v_mul_f32 v215, v63, v79
v_mfma_f32_16x16x32_bf16 v[40:43], v[128:131], a[192:195], v[40:43]
buffer_load_dwordx4 v9, s[48:51], s31 offen lds
v_add_f32 v208, 1.0, v208
v_mfma_f32_16x16x32_bf16 v[40:43], v[132:135], a[196:199], v[40:43]
ds_read_b64_tr_b16 v[104:105], v7 offset:12288
v_add_f32 v209, 1.0, v209
v_mfma_f32_16x16x32_bf16 v[40:43], v[136:139], a[200:203], v[40:43]
v_rcp_f32 v208, v208
v_mfma_f32_16x16x32_bf16 v[40:43], v[140:143], a[204:207], v[40:43]
ds_read_b64_tr_b16 v[106:107], v7 offset:13312
v_add_f32 v210, 1.0, v210
v_mfma_f32_16x16x32_bf16 v[40:43], v[144:147], a[208:211], v[40:43]
s_add_u32 m0, m0, 4096
v_rcp_f32 v209, v209
v_mfma_f32_16x16x32_bf16 v[40:43], v[148:151], a[212:215], v[40:43]
s_add_u32 s31, s31, 589824
ds_read_b64_tr_b16 v[108:109], v7 offset:14336
v_add_f32 v211, 1.0, v211
v_mfma_f32_16x16x32_bf16 v[44:47], v[116:119], a[252:255], v[44:47]
v_rcp_f32 v210, v210
v_mfma_f32_16x16x32_bf16 v[44:47], v[120:123], v[168:171], v[44:47]
ds_read_b64_tr_b16 v[110:111], v7 offset:15360
v_mul_f32 v212, v212, v208
v_mfma_f32_16x16x32_bf16 v[44:47], v[124:127], v[172:175], v[44:47]
buffer_load_dwordx4 v9, s[48:51], s31 offen lds
v_mfma_f32_16x16x32_bf16 v[44:47], v[128:131], v[176:179], v[44:47]
ds_read_b64_tr_b16 v[112:113], v7 offset:16384
v_rcp_f32 v211, v211
v_mfma_f32_16x16x32_bf16 v[44:47], v[132:135], v[180:183], v[44:47]
v_mul_f32 v213, v213, v209
v_mul_f32 v214, v214, v210
v_mfma_f32_16x16x32_bf16 v[44:47], v[136:139], v[184:187], v[44:47]
ds_read_b64_tr_b16 v[114:115], v7 offset:17408
v_mul_f32 v215, v215, v211
v_mfma_f32_16x16x32_bf16 v[44:47], v[140:143], v[188:191], v[44:47]
v_cvt_pk_bf16_f32 v166, v212, v213
v_cvt_pk_bf16_f32 v167, v214, v215
v_mfma_f32_16x16x32_bf16 v[44:47], v[144:147], v[192:195], v[44:47]
s_add_u32 s35, s34, 442368
buffer_store_dwordx4 v[164:167], v2, s[56:59], s35 offen sc1
v_add_u32 v8, s28, v4
v_mfma_f32_16x16x32_bf16 v[44:47], v[148:151], v[196:199], v[44:47]
s_waitcnt lgkmcnt(12)
v_mfma_f32_16x16x32_bf16 v[48:51], v[80:83], a[0:3], 0
ds_read_b64_tr_b16 v[116:117], v8
v_mfma_f32_16x16x32_bf16 v[48:51], v[84:87], a[4:7], v[48:51]
ds_read_b64_tr_b16 v[118:119], v8 offset:1024
v_mfma_f32_16x16x32_bf16 v[48:51], v[88:91], a[8:11], v[48:51]
s_waitcnt lgkmcnt(8)
v_mfma_f32_16x16x32_bf16 v[48:51], v[92:95], a[12:15], v[48:51]
ds_read_b64_tr_b16 v[120:121], v8 offset:2048
v_mfma_f32_16x16x32_bf16 v[48:51], v[96:99], a[16:19], v[48:51]
v_mfma_f32_16x16x32_bf16 v[48:51], v[100:103], a[20:23], v[48:51]
s_waitcnt lgkmcnt(3)
ds_read_b64_tr_b16 v[122:123], v8 offset:3072
v_mfma_f32_16x16x32_bf16 v[48:51], v[104:107], a[24:27], v[48:51]
v_mfma_f32_16x16x32_bf16 v[48:51], v[108:111], a[28:31], v[48:51]
ds_read_b64_tr_b16 v[124:125], v8 offset:4096
v_mfma_f32_16x16x32_bf16 v[48:51], v[112:115], a[32:35], v[48:51]
v_mfma_f32_16x16x32_bf16 v[52:55], v[80:83], a[72:75], 0
ds_read_b64_tr_b16 v[126:127], v8 offset:5120
v_mul_f32 v200, v16, v16
v_mfma_f32_16x16x32_bf16 v[52:55], v[84:87], a[76:79], v[52:55]
v_mul_f32 v201, v17, v17
v_mul_f32 v202, v18, v18
v_mfma_f32_16x16x32_bf16 v[52:55], v[88:91], a[80:83], v[52:55]
ds_read_b64_tr_b16 v[128:129], v8 offset:6144
v_mul_f32 v203, v19, v19
v_mfma_f32_16x16x32_bf16 v[52:55], v[92:95], a[84:87], v[52:55]
v_fmamk_f32 v200, v200, 0xbdd2d3e8, v15
v_fmamk_f32 v201, v201, 0xbdd2d3e8, v15
v_mfma_f32_16x16x32_bf16 v[52:55], v[96:99], a[88:91], v[52:55]
ds_read_b64_tr_b16 v[130:131], v8 offset:7168
v_fmamk_f32 v202, v202, 0xbdd2d3e8, v15
v_mfma_f32_16x16x32_bf16 v[52:55], v[100:103], a[92:95], v[52:55]
v_fmamk_f32 v203, v203, 0xbdd2d3e8, v15
v_mul_f32 v200, v16, v200
v_mfma_f32_16x16x32_bf16 v[52:55], v[104:107], a[96:99], v[52:55]
ds_read_b64_tr_b16 v[132:133], v8 offset:8192
v_mul_f32 v201, v17, v201
v_mfma_f32_16x16x32_bf16 v[52:55], v[108:111], a[100:103], v[52:55]
v_mul_f32 v202, v18, v202
v_mul_f32 v203, v19, v203
v_mfma_f32_16x16x32_bf16 v[52:55], v[112:115], a[104:107], v[52:55]
s_cmp_gt_u32 s22, 4
s_cselect_b32 s74, s77, 0
s_bitcmp1_b32 s78, 0
s_cselect_b32 s74, 0, s74
ds_read_b64_tr_b16 v[134:135], v8 offset:9216
v_mfma_f32_16x16x32_bf16 v[56:59], v[80:83], a[144:147], 0
ds_read_b64_tr_b16 v[136:137], v8 offset:10240
v_mfma_f32_16x16x32_bf16 v[56:59], v[84:87], a[148:151], v[56:59]
s_waitcnt vmcnt(22)
buffer_load_dword v232, v216, s[72:75], s76 offen
s_add_u32 s76, s76, 64
v_mfma_f32_16x16x32_bf16 v[56:59], v[88:91], a[152:155], v[56:59]
ds_read_b64_tr_b16 v[138:139], v8 offset:11264
v_mfma_f32_16x16x32_bf16 v[56:59], v[92:95], a[156:159], v[56:59]
s_add_u32 s78, s78, 1
v_exp_f32 v200, v200
v_mfma_f32_16x16x32_bf16 v[56:59], v[96:99], a[160:163], v[56:59]
ds_read_b64_tr_b16 v[140:141], v8 offset:12288
v_mul_f32 v204, v16, v32
v_mfma_f32_16x16x32_bf16 v[56:59], v[100:103], a[164:167], v[56:59]
v_exp_f32 v201, v201
v_mfma_f32_16x16x32_bf16 v[56:59], v[104:107], a[168:171], v[56:59]
ds_read_b64_tr_b16 v[142:143], v8 offset:13312
v_mul_f32 v205, v17, v33
v_mfma_f32_16x16x32_bf16 v[56:59], v[108:111], a[172:175], v[56:59]
v_exp_f32 v202, v202
v_mfma_f32_16x16x32_bf16 v[56:59], v[112:115], a[176:179], v[56:59]
ds_read_b64_tr_b16 v[144:145], v8 offset:14336
v_mul_f32 v206, v18, v34
v_mfma_f32_16x16x32_bf16 v[60:63], v[80:83], a[216:219], 0
v_exp_f32 v203, v203
v_mfma_f32_16x16x32_bf16 v[60:63], v[84:87], a[220:223], v[60:63]
ds_read_b64_tr_b16 v[146:147], v8 offset:15360
v_mul_f32 v207, v19, v35
v_mfma_f32_16x16x32_bf16 v[60:63], v[88:91], a[224:227], v[60:63]
v_add_f32 v200, 1.0, v200
v_add_f32 v201, 1.0, v201
v_mfma_f32_16x16x32_bf16 v[60:63], v[92:95], a[228:231], v[60:63]
ds_read_b64_tr_b16 v[148:149], v8 offset:16384
v_mfma_f32_16x16x32_bf16 v[60:63], v[96:99], a[232:235], v[60:63]
v_rcp_f32 v200, v200
v_mfma_f32_16x16x32_bf16 v[60:63], v[100:103], a[236:239], v[60:63]
ds_read_b64_tr_b16 v[150:151], v8 offset:17408
v_add_f32 v202, 1.0, v202
v_mfma_f32_16x16x32_bf16 v[60:63], v[104:107], a[240:243], v[60:63]
v_rcp_f32 v201, v201
v_mfma_f32_16x16x32_bf16 v[60:63], v[108:111], a[244:247], v[60:63]
v_add_u32 v7, s27, v6
v_add_f32 v203, 1.0, v203
v_mfma_f32_16x16x32_bf16 v[60:63], v[112:115], a[248:251], v[60:63]
s_waitcnt lgkmcnt(12)
v_rcp_f32 v202, v202
v_mfma_f32_16x16x32_bf16 v[48:51], v[116:119], a[36:39], v[48:51]
ds_read_b64_tr_b16 v[80:81], v7
v_mul_f32 v204, v204, v200
v_mfma_f32_16x16x32_bf16 v[48:51], v[120:123], a[40:43], v[48:51]
ds_read_b64_tr_b16 v[82:83], v7 offset:1024
v_mfma_f32_16x16x32_bf16 v[48:51], v[124:127], a[44:47], v[48:51]
s_waitcnt lgkmcnt(8)
v_rcp_f32 v203, v203
v_mfma_f32_16x16x32_bf16 v[48:51], v[128:131], a[48:51], v[48:51]
ds_read_b64_tr_b16 v[84:85], v7 offset:2048
v_mul_f32 v205, v205, v201
v_mfma_f32_16x16x32_bf16 v[48:51], v[132:135], a[52:55], v[48:51]
v_mul_f32 v206, v206, v202
v_mul_f32 v207, v207, v203
v_mfma_f32_16x16x32_bf16 v[48:51], v[136:139], a[56:59], v[48:51]
s_waitcnt lgkmcnt(3)
ds_read_b64_tr_b16 v[86:87], v7 offset:3072
v_cvt_pk_bf16_f32 v152, v204, v205
v_mfma_f32_16x16x32_bf16 v[48:51], v[140:143], a[60:63], v[48:51]
v_cvt_pk_bf16_f32 v153, v206, v207
v_mul_f32 v208, v20, v20
v_mfma_f32_16x16x32_bf16 v[48:51], v[144:147], a[64:67], v[48:51]
ds_read_b64_tr_b16 v[88:89], v7 offset:4096
v_mul_f32 v209, v21, v21
v_mfma_f32_16x16x32_bf16 v[48:51], v[148:151], a[68:71], v[48:51]
v_mul_f32 v210, v22, v22
v_mul_f32 v211, v23, v23
v_mfma_f32_16x16x32_bf16 v[52:55], v[116:119], a[108:111], v[52:55]
ds_read_b64_tr_b16 v[90:91], v7 offset:5120
v_fmamk_f32 v208, v208, 0xbdd2d3e8, v15
v_mfma_f32_16x16x32_bf16 v[52:55], v[120:123], a[112:115], v[52:55]
v_fmamk_f32 v209, v209, 0xbdd2d3e8, v15
v_fmamk_f32 v210, v210, 0xbdd2d3e8, v15
v_mfma_f32_16x16x32_bf16 v[52:55], v[124:127], a[116:119], v[52:55]
ds_read_b64_tr_b16 v[92:93], v7 offset:6144
v_fmamk_f32 v211, v211, 0xbdd2d3e8, v15
v_mfma_f32_16x16x32_bf16 v[52:55], v[128:131], a[120:123], v[52:55]
v_mul_f32 v208, v20, v208
v_mul_f32 v209, v21, v209
v_mfma_f32_16x16x32_bf16 v[52:55], v[132:135], a[124:127], v[52:55]
ds_read_b64_tr_b16 v[94:95], v7 offset:7168
v_mul_f32 v210, v22, v210
v_mfma_f32_16x16x32_bf16 v[52:55], v[136:139], a[128:131], v[52:55]
v_mul_f32 v211, v23, v211
v_mfma_f32_16x16x32_bf16 v[52:55], v[140:143], a[132:135], v[52:55]
ds_read_b64_tr_b16 v[96:97], v7 offset:8192
v_mfma_f32_16x16x32_bf16 v[52:55], v[144:147], a[136:139], v[52:55]
v_exp_f32 v208, v208
v_mfma_f32_16x16x32_bf16 v[52:55], v[148:151], a[140:143], v[52:55]
ds_read_b64_tr_b16 v[98:99], v7 offset:9216
v_mul_f32 v212, v20, v36
v_mfma_f32_16x16x32_bf16 v[56:59], v[116:119], a[180:183], v[56:59]
ds_read_b64_tr_b16 v[100:101], v7 offset:10240
v_mfma_f32_16x16x32_bf16 v[56:59], v[120:123], a[184:187], v[56:59]
v_exp_f32 v209, v209
v_mfma_f32_16x16x32_bf16 v[56:59], v[124:127], a[188:191], v[56:59]
ds_read_b64_tr_b16 v[102:103], v7 offset:11264
v_mul_f32 v213, v21, v37
v_mfma_f32_16x16x32_bf16 v[56:59], v[128:131], a[192:195], v[56:59]
v_exp_f32 v210, v210
v_mfma_f32_16x16x32_bf16 v[56:59], v[132:135], a[196:199], v[56:59]
ds_read_b64_tr_b16 v[104:105], v7 offset:12288
v_mul_f32 v214, v22, v38
v_mfma_f32_16x16x32_bf16 v[56:59], v[136:139], a[200:203], v[56:59]
v_exp_f32 v211, v211
v_mfma_f32_16x16x32_bf16 v[56:59], v[140:143], a[204:207], v[56:59]
ds_read_b64_tr_b16 v[106:107], v7 offset:13312
v_mul_f32 v215, v23, v39
v_mfma_f32_16x16x32_bf16 v[56:59], v[144:147], a[208:211], v[56:59]
v_add_f32 v208, 1.0, v208
v_add_f32 v209, 1.0, v209
v_mfma_f32_16x16x32_bf16 v[56:59], v[148:151], a[212:215], v[56:59]
ds_read_b64_tr_b16 v[108:109], v7 offset:14336
v_mfma_f32_16x16x32_bf16 v[60:63], v[116:119], a[252:255], v[60:63]
v_rcp_f32 v208, v208
v_mfma_f32_16x16x32_bf16 v[60:63], v[120:123], v[168:171], v[60:63]
ds_read_b64_tr_b16 v[110:111], v7 offset:15360
v_add_f32 v210, 1.0, v210
v_mfma_f32_16x16x32_bf16 v[60:63], v[124:127], v[172:175], v[60:63]
v_rcp_f32 v209, v209
v_mfma_f32_16x16x32_bf16 v[60:63], v[128:131], v[176:179], v[60:63]
ds_read_b64_tr_b16 v[112:113], v7 offset:16384
v_add_f32 v211, 1.0, v211
v_mfma_f32_16x16x32_bf16 v[60:63], v[132:135], v[180:183], v[60:63]
v_rcp_f32 v210, v210
v_mfma_f32_16x16x32_bf16 v[60:63], v[136:139], v[184:187], v[60:63]
ds_read_b64_tr_b16 v[114:115], v7 offset:17408
v_mul_f32 v212, v212, v208
v_mfma_f32_16x16x32_bf16 v[60:63], v[140:143], v[188:191], v[60:63]
v_rcp_f32 v211, v211
v_mfma_f32_16x16x32_bf16 v[60:63], v[144:147], v[192:195], v[60:63]
v_add_u32 v8, s28, v6
v_mul_f32 v213, v213, v209
v_mfma_f32_16x16x32_bf16 v[60:63], v[148:151], v[196:199], v[60:63]
s_waitcnt lgkmcnt(12)
v_mul_f32 v214, v214, v210
v_mul_f32 v215, v215, v211
v_mfma_f32_16x16x32_bf16 v[64:67], v[80:83], a[0:3], 0
ds_read_b64_tr_b16 v[116:117], v8
v_cvt_pk_bf16_f32 v156, v212, v213
v_mfma_f32_16x16x32_bf16 v[64:67], v[84:87], a[4:7], v[64:67]
ds_read_b64_tr_b16 v[118:119], v8 offset:1024
v_cvt_pk_bf16_f32 v157, v214, v215
v_mfma_f32_16x16x32_bf16 v[64:67], v[88:91], a[8:11], v[64:67]
s_waitcnt lgkmcnt(8)
v_mul_f32 v200, v24, v24
v_mul_f32 v201, v25, v25
v_mfma_f32_16x16x32_bf16 v[64:67], v[92:95], a[12:15], v[64:67]
ds_read_b64_tr_b16 v[120:121], v8 offset:2048
v_mul_f32 v202, v26, v26
v_mfma_f32_16x16x32_bf16 v[64:67], v[96:99], a[16:19], v[64:67]
v_mul_f32 v203, v27, v27
v_fmamk_f32 v200, v200, 0xbdd2d3e8, v15
v_mfma_f32_16x16x32_bf16 v[64:67], v[100:103], a[20:23], v[64:67]
s_waitcnt lgkmcnt(3)
ds_read_b64_tr_b16 v[122:123], v8 offset:3072
v_fmamk_f32 v201, v201, 0xbdd2d3e8, v15
v_mfma_f32_16x16x32_bf16 v[64:67], v[104:107], a[24:27], v[64:67]
v_fmamk_f32 v202, v202, 0xbdd2d3e8, v15
v_fmamk_f32 v203, v203, 0xbdd2d3e8, v15
v_mfma_f32_16x16x32_bf16 v[64:67], v[108:111], a[28:31], v[64:67]
ds_read_b64_tr_b16 v[124:125], v8 offset:4096
v_mul_f32 v200, v24, v200
v_mfma_f32_16x16x32_bf16 v[64:67], v[112:115], a[32:35], v[64:67]
v_mul_f32 v201, v25, v201
v_mul_f32 v202, v26, v202
v_mfma_f32_16x16x32_bf16 v[68:71], v[80:83], a[72:75], 0
ds_read_b64_tr_b16 v[126:127], v8 offset:5120
v_mul_f32 v203, v27, v203
v_mfma_f32_16x16x32_bf16 v[68:71], v[84:87], a[76:79], v[68:71]
v_exp_f32 v200, v200
v_mfma_f32_16x16x32_bf16 v[68:71], v[88:91], a[80:83], v[68:71]
ds_read_b64_tr_b16 v[128:129], v8 offset:6144
v_mul_f32 v204, v24, v40
v_mfma_f32_16x16x32_bf16 v[68:71], v[92:95], a[84:87], v[68:71]
v_exp_f32 v201, v201
v_mfma_f32_16x16x32_bf16 v[68:71], v[96:99], a[88:91], v[68:71]
ds_read_b64_tr_b16 v[130:131], v8 offset:7168
v_mul_f32 v205, v25, v41
v_mfma_f32_16x16x32_bf16 v[68:71], v[100:103], a[92:95], v[68:71]
v_exp_f32 v202, v202
v_mfma_f32_16x16x32_bf16 v[68:71], v[104:107], a[96:99], v[68:71]
ds_read_b64_tr_b16 v[132:133], v8 offset:8192
v_mfma_f32_16x16x32_bf16 v[68:71], v[108:111], a[100:103], v[68:71]
v_mul_f32 v206, v26, v42
v_mfma_f32_16x16x32_bf16 v[68:71], v[112:115], a[104:107], v[68:71]
ds_read_b64_tr_b16 v[134:135], v8 offset:9216
v_mfma_f32_16x16x32_bf16 v[72:75], v[80:83], a[144:147], 0
ds_read_b64_tr_b16 v[136:137], v8 offset:10240
v_mfma_f32_16x16x32_bf16 v[72:75], v[84:87], a[148:151], v[72:75]
v_exp_f32 v203, v203
v_mfma_f32_16x16x32_bf16 v[72:75], v[88:91], a[152:155], v[72:75]
ds_read_b64_tr_b16 v[138:139], v8 offset:11264
v_mul_f32 v207, v27, v43
v_mfma_f32_16x16x32_bf16 v[72:75], v[92:95], a[156:159], v[72:75]
v_add_f32 v200, 1.0, v200
v_add_f32 v201, 1.0, v201
v_mfma_f32_16x16x32_bf16 v[72:75], v[96:99], a[160:163], v[72:75]
ds_read_b64_tr_b16 v[140:141], v8 offset:12288
v_mfma_f32_16x16x32_bf16 v[72:75], v[100:103], a[164:167], v[72:75]
v_rcp_f32 v200, v200
v_mfma_f32_16x16x32_bf16 v[72:75], v[104:107], a[168:171], v[72:75]
ds_read_b64_tr_b16 v[142:143], v8 offset:13312
v_add_f32 v202, 1.0, v202
v_mfma_f32_16x16x32_bf16 v[72:75], v[108:111], a[172:175], v[72:75]
v_rcp_f32 v201, v201
v_mfma_f32_16x16x32_bf16 v[72:75], v[112:115], a[176:179], v[72:75]
ds_read_b64_tr_b16 v[144:145], v8 offset:14336
v_add_f32 v203, 1.0, v203
v_mfma_f32_16x16x32_bf16 v[76:79], v[80:83], a[216:219], 0
v_rcp_f32 v202, v202
v_mfma_f32_16x16x32_bf16 v[76:79], v[84:87], a[220:223], v[76:79]
ds_read_b64_tr_b16 v[146:147], v8 offset:15360
v_mul_f32 v204, v204, v200
v_mfma_f32_16x16x32_bf16 v[76:79], v[88:91], a[224:227], v[76:79]
v_rcp_f32 v203, v203
v_mfma_f32_16x16x32_bf16 v[76:79], v[92:95], a[228:231], v[76:79]
ds_read_b64_tr_b16 v[148:149], v8 offset:16384
v_mul_f32 v205, v205, v201
v_mfma_f32_16x16x32_bf16 v[76:79], v[96:99], a[232:235], v[76:79]
v_mul_f32 v206, v206, v202
v_mul_f32 v207, v207, v203
v_mfma_f32_16x16x32_bf16 v[76:79], v[100:103], a[236:239], v[76:79]
ds_read_b64_tr_b16 v[150:151], v8 offset:17408
v_cvt_pk_bf16_f32 v160, v204, v205
v_mfma_f32_16x16x32_bf16 v[76:79], v[104:107], a[240:243], v[76:79]
v_cvt_pk_bf16_f32 v161, v206, v207
v_mul_f32 v208, v28, v28
v_mfma_f32_16x16x32_bf16 v[76:79], v[108:111], a[244:247], v[76:79]
v_mul_f32 v209, v29, v29
v_mul_f32 v210, v30, v30
v_mfma_f32_16x16x32_bf16 v[76:79], v[112:115], a[248:251], v[76:79]
s_waitcnt lgkmcnt(12)
v_mul_f32 v211, v31, v31
v_mfma_f32_16x16x32_bf16 v[64:67], v[116:119], a[36:39], v[64:67]
v_fmamk_f32 v208, v208, 0xbdd2d3e8, v15
v_mfma_f32_16x16x32_bf16 v[64:67], v[120:123], a[40:43], v[64:67]
v_fmamk_f32 v209, v209, 0xbdd2d3e8, v15
v_fmamk_f32 v210, v210, 0xbdd2d3e8, v15
v_mfma_f32_16x16x32_bf16 v[64:67], v[124:127], a[44:47], v[64:67]
s_waitcnt lgkmcnt(6)
v_fmamk_f32 v211, v211, 0xbdd2d3e8, v15
v_mfma_f32_16x16x32_bf16 v[64:67], v[128:131], a[48:51], v[64:67]
v_mul_f32 v208, v28, v208
v_mfma_f32_16x16x32_bf16 v[64:67], v[132:135], a[52:55], v[64:67]
v_mul_f32 v209, v29, v209
v_mfma_f32_16x16x32_bf16 v[64:67], v[136:139], a[56:59], v[64:67]
s_waitcnt lgkmcnt(0)
v_mul_f32 v210, v30, v210
v_mul_f32 v211, v31, v211
v_mfma_f32_16x16x32_bf16 v[64:67], v[140:143], a[60:63], v[64:67]
v_exp_f32 v208, v208
v_mfma_f32_16x16x32_bf16 v[64:67], v[144:147], a[64:67], v[64:67]
v_mfma_f32_16x16x32_bf16 v[64:67], v[148:151], a[68:71], v[64:67]
v_add_u32 v7, s29, v3
v_mul_f32 v212, v28, v44
v_mfma_f32_16x16x32_bf16 v[68:71], v[116:119], a[108:111], v[68:71]
s_waitcnt vmcnt(2)
s_barrier
v_exp_f32 v209, v209
v_mfma_f32_16x16x32_bf16 v[68:71], v[120:123], a[112:115], v[68:71]
ds_read_b64_tr_b16 v[80:81], v7
v_mul_f32 v213, v29, v45
v_mfma_f32_16x16x32_bf16 v[68:71], v[124:127], a[116:119], v[68:71]
s_xor_b32 s27, s27, 73728
ds_read_b64_tr_b16 v[82:83], v7 offset:1024
v_mfma_f32_16x16x32_bf16 v[68:71], v[128:131], a[120:123], v[68:71]
ds_read_b64_tr_b16 v[84:85], v7 offset:2048
v_mfma_f32_16x16x32_bf16 v[68:71], v[132:135], a[124:127], v[68:71]
s_xor_b32 s29, s29, 73728
ds_read_b64_tr_b16 v[86:87], v7 offset:3072
v_mfma_f32_16x16x32_bf16 v[68:71], v[136:139], a[128:131], v[68:71]
ds_read_b64_tr_b16 v[88:89], v7 offset:4096
v_mfma_f32_16x16x32_bf16 v[68:71], v[140:143], a[132:135], v[68:71]
s_add_u32 s28, s27, 18432
ds_read_b64_tr_b16 v[90:91], v7 offset:5120
v_mfma_f32_16x16x32_bf16 v[68:71], v[144:147], a[136:139], v[68:71]
v_exp_f32 v210, v210
v_mfma_f32_16x16x32_bf16 v[68:71], v[148:151], a[140:143], v[68:71]
s_sub_u32 s22, s22, 1
ds_read_b64_tr_b16 v[92:93], v7 offset:6144
v_mul_f32 v214, v30, v46
v_mfma_f32_16x16x32_bf16 v[72:75], v[116:119], a[180:183], v[72:75]
ds_read_b64_tr_b16 v[94:95], v7 offset:7168
v_mfma_f32_16x16x32_bf16 v[72:75], v[120:123], a[184:187], v[72:75]
ds_read_b64_tr_b16 v[96:97], v7 offset:8192
v_mfma_f32_16x16x32_bf16 v[72:75], v[124:127], a[188:191], v[72:75]
ds_read_b64_tr_b16 v[98:99], v7 offset:9216
v_exp_f32 v211, v211
v_mfma_f32_16x16x32_bf16 v[72:75], v[128:131], a[192:195], v[72:75]
ds_read_b64_tr_b16 v[100:101], v7 offset:10240
v_mul_f32 v215, v31, v47
v_mfma_f32_16x16x32_bf16 v[72:75], v[132:135], a[196:199], v[72:75]
ds_read_b64_tr_b16 v[102:103], v7 offset:11264
v_add_f32 v208, 1.0, v208
v_mfma_f32_16x16x32_bf16 v[72:75], v[136:139], a[200:203], v[72:75]
v_add_f32 v209, 1.0, v209
v_mfma_f32_16x16x32_bf16 v[72:75], v[140:143], a[204:207], v[72:75]
ds_read_b64_tr_b16 v[104:105], v7 offset:12288
v_rcp_f32 v208, v208
v_mfma_f32_16x16x32_bf16 v[72:75], v[144:147], a[208:211], v[72:75]
ds_read_b64_tr_b16 v[106:107], v7 offset:13312
v_add_f32 v210, 1.0, v210
v_mfma_f32_16x16x32_bf16 v[72:75], v[148:151], a[212:215], v[72:75]
ds_read_b64_tr_b16 v[108:109], v7 offset:14336
v_rcp_f32 v209, v209
v_mfma_f32_16x16x32_bf16 v[76:79], v[116:119], a[252:255], v[76:79]
ds_read_b64_tr_b16 v[110:111], v7 offset:15360
v_add_f32 v211, 1.0, v211
v_mfma_f32_16x16x32_bf16 v[76:79], v[120:123], v[168:171], v[76:79]
ds_read_b64_tr_b16 v[112:113], v7 offset:16384
v_mfma_f32_16x16x32_bf16 v[76:79], v[124:127], v[172:175], v[76:79]
ds_read_b64_tr_b16 v[114:115], v7 offset:17408
v_rcp_f32 v210, v210
v_mfma_f32_16x16x32_bf16 v[76:79], v[128:131], v[176:179], v[76:79]
v_mul_f32 v212, v212, v208
v_mfma_f32_16x16x32_bf16 v[76:79], v[132:135], v[180:183], v[76:79]
v_rcp_f32 v211, v211
v_mfma_f32_16x16x32_bf16 v[76:79], v[136:139], v[184:187], v[76:79]
v_mul_f32 v213, v213, v209
v_mul_f32 v214, v214, v210
v_mfma_f32_16x16x32_bf16 v[76:79], v[140:143], v[188:191], v[76:79]
v_mul_f32 v215, v215, v211
v_cvt_pk_bf16_f32 v164, v212, v213
v_mfma_f32_16x16x32_bf16 v[76:79], v[144:147], v[192:195], v[76:79]
v_cvt_pk_bf16_f32 v165, v214, v215
v_mfma_f32_16x16x32_bf16 v[76:79], v[148:151], v[196:199], v[76:79]
s_mov_b32 s34, s33
s_mov_b32 s58, s54
s_add_u32 s33, s33, 1024
s_cmp_lg_u32 s22, 0
s_cbranch_scc1 L_p1_loopG
s_nop 7
v_mul_f32 v200, v48, v48
v_mul_f32 v201, v49, v49
v_mul_f32 v202, v50, v50
v_mul_f32 v203, v51, v51
v_fmamk_f32 v200, v200, 0xbdd2d3e8, v15
v_fmamk_f32 v201, v201, 0xbdd2d3e8, v15
v_fmamk_f32 v202, v202, 0xbdd2d3e8, v15
v_fmamk_f32 v203, v203, 0xbdd2d3e8, v15
v_mul_f32 v200, v48, v200
v_mul_f32 v201, v49, v201
v_mul_f32 v202, v50, v202
v_mul_f32 v203, v51, v203
v_exp_f32 v200, v200
v_mul_f32 v204, v48, v64
v_exp_f32 v201, v201
v_mul_f32 v205, v49, v65
v_exp_f32 v202, v202
v_mul_f32 v206, v50, v66
v_exp_f32 v203, v203
v_mul_f32 v207, v51, v67
v_add_f32 v200, 1.0, v200
v_add_f32 v201, 1.0, v201
v_rcp_f32 v200, v200
v_add_f32 v202, 1.0, v202
v_rcp_f32 v201, v201
v_add_f32 v203, 1.0, v203
v_rcp_f32 v202, v202
v_mul_f32 v204, v204, v200
v_rcp_f32 v203, v203
v_mul_f32 v205, v205, v201
v_mul_f32 v206, v206, v202
v_mul_f32 v207, v207, v203
v_cvt_pk_bf16_f32 v154, v204, v205
v_cvt_pk_bf16_f32 v155, v206, v207
buffer_store_dwordx4 v[152:155], v2, s[56:59], s34 offen sc1
v_mul_f32 v208, v52, v52
v_mul_f32 v209, v53, v53
v_mul_f32 v210, v54, v54
v_mul_f32 v211, v55, v55
v_fmamk_f32 v208, v208, 0xbdd2d3e8, v15
v_fmamk_f32 v209, v209, 0xbdd2d3e8, v15
v_fmamk_f32 v210, v210, 0xbdd2d3e8, v15
v_fmamk_f32 v211, v211, 0xbdd2d3e8, v15
v_mul_f32 v208, v52, v208
v_mul_f32 v209, v53, v209
v_mul_f32 v210, v54, v210
v_mul_f32 v211, v55, v211
v_exp_f32 v208, v208
v_mul_f32 v212, v52, v68
v_exp_f32 v209, v209
v_mul_f32 v213, v53, v69
v_exp_f32 v210, v210
v_mul_f32 v214, v54, v70
v_exp_f32 v211, v211
v_mul_f32 v215, v55, v71
v_add_f32 v208, 1.0, v208
v_add_f32 v209, 1.0, v209
v_rcp_f32 v208, v208
v_add_f32 v210, 1.0, v210
v_rcp_f32 v209, v209
v_add_f32 v211, 1.0, v211
v_rcp_f32 v210, v210
v_mul_f32 v212, v212, v208
v_rcp_f32 v211, v211
v_mul_f32 v213, v213, v209
v_mul_f32 v214, v214, v210
v_mul_f32 v215, v215, v211
v_cvt_pk_bf16_f32 v158, v212, v213
v_cvt_pk_bf16_f32 v159, v214, v215
s_add_u32 s35, s34, 147456
buffer_store_dwordx4 v[156:159], v2, s[56:59], s35 offen sc1
v_mul_f32 v200, v56, v56
v_mul_f32 v201, v57, v57
v_mul_f32 v202, v58, v58
v_mul_f32 v203, v59, v59
v_fmamk_f32 v200, v200, 0xbdd2d3e8, v15
v_fmamk_f32 v201, v201, 0xbdd2d3e8, v15
v_fmamk_f32 v202, v202, 0xbdd2d3e8, v15
v_fmamk_f32 v203, v203, 0xbdd2d3e8, v15
v_mul_f32 v200, v56, v200
v_mul_f32 v201, v57, v201
v_mul_f32 v202, v58, v202
v_mul_f32 v203, v59, v203
v_exp_f32 v200, v200
v_mul_f32 v204, v56, v72
v_exp_f32 v201, v201
v_mul_f32 v205, v57, v73
v_exp_f32 v202, v202
v_mul_f32 v206, v58, v74
v_exp_f32 v203, v203
v_mul_f32 v207, v59, v75
v_add_f32 v200, 1.0, v200
v_add_f32 v201, 1.0, v201
v_rcp_f32 v200, v200
v_add_f32 v202, 1.0, v202
v_rcp_f32 v201, v201
v_add_f32 v203, 1.0, v203
v_rcp_f32 v202, v202
v_mul_f32 v204, v204, v200
v_rcp_f32 v203, v203
v_mul_f32 v205, v205, v201
v_mul_f32 v206, v206, v202
v_mul_f32 v207, v207, v203
v_cvt_pk_bf16_f32 v162, v204, v205
v_cvt_pk_bf16_f32 v163, v206, v207
s_add_u32 s35, s34, 294912
buffer_store_dwordx4 v[160:163], v2, s[56:59], s35 offen sc1
v_mul_f32 v208, v60, v60
v_mul_f32 v209, v61, v61
v_mul_f32 v210, v62, v62
v_mul_f32 v211, v63, v63
v_fmamk_f32 v208, v208, 0xbdd2d3e8, v15
v_fmamk_f32 v209, v209, 0xbdd2d3e8, v15
v_fmamk_f32 v210, v210, 0xbdd2d3e8, v15
v_fmamk_f32 v211, v211, 0xbdd2d3e8, v15
v_mul_f32 v208, v60, v208
v_mul_f32 v209, v61, v209
v_mul_f32 v210, v62, v210
v_mul_f32 v211, v63, v211
v_exp_f32 v208, v208
v_mul_f32 v212, v60, v76
v_exp_f32 v209, v209
v_mul_f32 v213, v61, v77
v_exp_f32 v210, v210
v_mul_f32 v214, v62, v78
v_exp_f32 v211, v211
v_mul_f32 v215, v63, v79
v_add_f32 v208, 1.0, v208
v_add_f32 v209, 1.0, v209
v_rcp_f32 v208, v208
v_add_f32 v210, 1.0, v210
v_rcp_f32 v209, v209
v_add_f32 v211, 1.0, v211
v_rcp_f32 v210, v210
v_mul_f32 v212, v212, v208
v_rcp_f32 v211, v211
v_mul_f32 v213, v213, v209
v_mul_f32 v214, v214, v210
v_mul_f32 v215, v215, v211
v_cvt_pk_bf16_f32 v166, v212, v213
v_cvt_pk_bf16_f32 v167, v214, v215
s_add_u32 s35, s34, 442368
buffer_store_dwordx4 v[164:167], v2, s[56:59], s35 offen sc1
s_branch L_p1_fin
L_p1_segK:
s_load_dwordx2 s[64:65], s[0:1], 24
s_load_dwordx2 s[68:69], s[0:1], 96
v_and_b32 v10, 63, v0
v_lshlrev_b32 v2, 4, v10
v_lshrrev_b32 v11, 3, v10
v_mul_u32_u24 v11, 8192, v11
v_lshrrev_b32 v12, 4, v10
v_lshlrev_b32 v12, 1, v12
v_and_b32 v13, 7, v10
v_xor_b32 v12, v12, v13
v_lshl_add_u32 v9, v12, 4, v11
v_lshrrev_b32 v11, 2, v10
v_and_b32 v12, 3, v10
v_lshlrev_b32 v12, 3, v12
v_lshl_add_u32 v12, v11, 7, v12
v_lshrrev_b32 v13, 1, v11
v_and_b32 v13, 3, v13
v_xor_b32 v14, 0, v13
v_lshl_add_u32 v3, v14, 5, v12
v_xor_b32 v14, 1, v13
v_lshl_add_u32 v4, v14, 5, v12
v_xor_b32 v14, 2, v13
v_lshl_add_u32 v5, v14, 5, v12
v_xor_b32 v14, 3, v13
v_lshl_add_u32 v6, v14, 5, v12
s_waitcnt lgkmcnt(0)
s_mov_b32 s44, s64
s_mov_b32 s45, s65
s_mov_b32 s46, 0x400000
s_mov_b32 s47, 0x20000
s_add_u32 s52, s68, 0x1800000
s_addc_u32 s53, s69, 0
s_mov_b32 s54, 0x2000000
s_mov_b32 s55, 0x20000
s_add_u32 s56, s68, 0x1800000
s_addc_u32 s57, s69, 0
s_mov_b32 s58, 0x0
s_mov_b32 s59, 0x20000
s_mul_i32 s32, s21, 128
s_mul_i32 s35, s20, 65536
s_add_u32 s32, s32, s35
s_lshl_b32 s30, s20, 10
s_mov_b32 s27, 0
s_mov_b32 s28, 32768
s_mov_b32 s29, 65536
s_lshr_b32 s35, s21, 1
s_lshl_b32 s33, s35, 20
s_lshr_b32 s35, s26, 1
s_lshl_b32 s35, s35, 14
s_add_u32 s33, s33, s35
s_and_b32 s35, s21, 1
s_lshl_b32 s35, s35, 11
s_add_u32 s33, s33, s35
s_mov_b32 s34, s33
s_lshr_b32 s35, s26, 4
s_mul_i32 s35, s35, 524288
s_add_u32 s36, s21, 4
s_mul_i32 s36, s36, 128
s_add_u32 s76, s35, s36
v_lshrrev_b32 v10, 1, v0
v_and_b32 v11, 1, v0
v_mul_u32_u24 v216, 8192, v10
v_lshl_add_u32 v216, v11, 7, v216
s_mov_b32 s72, s44
s_mov_b32 s73, s45
s_mov_b32 s74, s46
s_mov_b32 s75, s47
v_mov_b32 v12, 0x7fffffff
v_cmp_gt_u32 vcc, 64, v10
s_nop 1
v_cndmask_b32 v216, v12, v216, vcc
s_mov_b32 s77, s74
s_getpc_b64 s[90:91]
L_ct_p1K:
s_add_u32 s90, s90, L_p1_tkjK-L_ct_p1K
s_addc_u32 s91, s91, 0
s_lshr_b32 s35, s2, 3
s_and_b32 s35, s35, 3
s_mul_i32 s35, s35, 8192
v_min_u32 v238, 63, v0
v_lshlrev_b32 v238, 7, v238
v_add_u32 v238, s35, v238
global_load_dword v239, v238, s[90:91]
s_branch L_p1_tkjK
L_p1_taskK:
v_and_b32 v97, 63, v0
v_lshrrev_b32 v99, 4, v97
v_and_b32 v100, 15, v97
s_lshr_b32 s80, s26, 4
s_lshl_b32 s80, s80, 8
s_lshl_b32 s81, s42, 3
s_add_u32 s80, s80, s81
s_and_b32 s81, s20, 1
s_lshl_b32 s81, s81, 2
s_add_u32 s80, s80, s81
v_add_u32 v101, s80, v99
v_lshrrev_b32 v102, 3, v100
v_lshlrev_b32 v102, 10, v102
v_and_b32 v103, 3, v100
v_lshlrev_b32 v103, 4, v103
v_and_b32 v104, 15, v101
v_add_u32 v103, v103, v104
v_lshlrev_b32 v103, 4, v103
v_add_u32 v102, v102, v103
v_lshrrev_b32 v103, 2, v100
v_and_b32 v103, 1, v103
v_lshlrev_b32 v103, 3, v103
v_add_u32 v102, v102, v103
v_lshrrev_b32 v105, 4, v101
s_cmp_ge_u32 s20, 2
s_cbranch_scc1 L_p1_cklK
s_mov_b32 s8, s4
s_mov_b32 s9, s5
s_mov_b32 s10, 0x240000
s_mov_b32 s11, 0x20000
s_mov_b32 s16, s68
s_mov_b32 s17, s69
s_mov_b32 s18, 0x240000
s_mov_b32 s19, 0x20000
s_movk_i32 s80, 1152
v_mul_lo_u32 v106, v101, s80
v_lshl_add_u32 v106, v100, 3, v106
buffer_load_dwordx2 v[108:109], v106, s[8:11], 0 offen
buffer_load_dwordx2 v[110:111], v106, s[8:11], 0 offen offset:128
buffer_load_dwordx2 v[112:113], v106, s[8:11], 0 offen offset:256
buffer_load_dwordx2 v[114:115], v106, s[8:11], 0 offen offset:384
buffer_load_dwordx2 v[116:117], v106, s[8:11], 0 offen offset:512
buffer_load_dwordx2 v[118:119], v106, s[8:11], 0 offen offset:640
buffer_load_dwordx2 v[120:121], v106, s[8:11], 0 offen offset:768
buffer_load_dwordx2 v[122:123], v106, s[8:11], 0 offen offset:896
buffer_load_dwordx2 v[124:125], v106, s[8:11], 0 offen offset:1024
s_movk_i32 s80, 18432
v_mul_lo_u32 v105, v105, s80
v_add_u32 v102, v102, v105
s_branch L_p1_tkjK
L_p1_cklK:
s_mov_b32 s8, s6
s_mov_b32 s9, s7
s_mov_b32 s10, 0x200000
s_mov_b32 s11, 0x20000
s_add_u32 s16, s68, 0x400000
s_addc_u32 s17, s69, 0
s_mov_b32 s18, 0x200000
s_mov_b32 s19, 0x20000
v_lshlrev_b32 v106, 10, v101
v_lshl_add_u32 v106, v100, 3, v106
buffer_load_dwordx2 v[108:109], v106, s[8:11], 0 offen
buffer_load_dwordx2 v[110:111], v106, s[8:11], 0 offen offset:128
buffer_load_dwordx2 v[112:113], v106, s[8:11], 0 offen offset:256
buffer_load_dwordx2 v[114:115], v106, s[8:11], 0 offen offset:384
buffer_load_dwordx2 v[116:117], v106, s[8:11], 0 offen offset:512
buffer_load_dwordx2 v[118:119], v106, s[8:11], 0 offen offset:640
buffer_load_dwordx2 v[120:121], v106, s[8:11], 0 offen offset:768
buffer_load_dwordx2 v[122:123], v106, s[8:11], 0 offen offset:896
v_mov_b32 v107, 0x7fffffff
buffer_load_dwordx2 v[124:125], v107, s[8:11], 0 offen
v_lshlrev_b32 v105, 14, v105
v_add_u32 v102, v102, v105
L_p1_tkjK:
s_cmp_lg_u32 s43, 0
s_cbranch_scc1 L_p1_tkwK
s_branch L_p1_tkcK
L_p1_tkwK:
s_waitcnt vmcnt(0)
L_p1_tkcK:
s_cmp_ge_u32 s20, 2
s_cbranch_scc1 L_p1_ckcK
s_waitcnt vmcnt(9)
v_lshlrev_b32 v128, 16, v108
v_and_b32 v129, 0xffff0000, v108
v_lshlrev_b32 v130, 16, v109
v_and_b32 v131, 0xffff0000, v109
s_waitcnt vmcnt(8)
v_lshlrev_b32 v132, 16, v110
v_and_b32 v133, 0xffff0000, v110
v_lshlrev_b32 v134, 16, v111
v_and_b32 v135, 0xffff0000, v111
s_waitcnt vmcnt(7)
v_lshlrev_b32 v136, 16, v112
v_and_b32 v137, 0xffff0000, v112
v_lshlrev_b32 v138, 16, v113
v_and_b32 v139, 0xffff0000, v113
s_waitcnt vmcnt(6)
v_lshlrev_b32 v140, 16, v114
v_and_b32 v141, 0xffff0000, v114
v_lshlrev_b32 v142, 16, v115
v_and_b32 v143, 0xffff0000, v115
s_waitcnt vmcnt(5)
v_lshlrev_b32 v144, 16, v116
v_and_b32 v145, 0xffff0000, v116
v_lshlrev_b32 v146, 16, v117
v_and_b32 v147, 0xffff0000, v117
s_waitcnt vmcnt(4)
v_lshlrev_b32 v148, 16, v118
v_and_b32 v149, 0xffff0000, v118
v_lshlrev_b32 v150, 16, v119
v_and_b32 v151, 0xffff0000, v119
s_waitcnt vmcnt(3)
v_lshlrev_b32 v152, 16, v120
v_and_b32 v153, 0xffff0000, v120
v_lshlrev_b32 v154, 16, v121
v_and_b32 v155, 0xffff0000, v121
s_waitcnt vmcnt(2)
v_lshlrev_b32 v156, 16, v122
v_and_b32 v157, 0xffff0000, v122
v_lshlrev_b32 v158, 16, v123
v_and_b32 v159, 0xffff0000, v123
s_waitcnt vmcnt(1)
v_lshlrev_b32 v160, 16, v124
v_and_b32 v161, 0xffff0000, v124
v_lshlrev_b32 v162, 16, v125
v_and_b32 v163, 0xffff0000, v125
v_add_f32 v166, v128, v129
v_add_f32 v167, v130, v131
v_add_f32 v168, v132, v133
v_add_f32 v169, v134, v135
v_add_f32 v166, v166, v136
v_add_f32 v167, v167, v137
v_add_f32 v168, v168, v138
v_add_f32 v169, v169, v139
v_add_f32 v166, v166, v140
v_add_f32 v167, v167, v141
v_add_f32 v168, v168, v142
v_add_f32 v169, v169, v143
v_add_f32 v166, v166, v144
v_add_f32 v167, v167, v145
v_add_f32 v168, v168, v146
v_add_f32 v169, v169, v147
v_add_f32 v166, v166, v148
v_add_f32 v167, v167, v149
v_add_f32 v168, v168, v150
v_add_f32 v169, v169, v151
v_add_f32 v166, v166, v152
v_add_f32 v167, v167, v153
v_add_f32 v168, v168, v154
v_add_f32 v169, v169, v155
v_add_f32 v166, v166, v156
v_add_f32 v167, v167, v157
v_add_f32 v168, v168, v158
v_add_f32 v169, v169, v159
v_add_f32 v166, v166, v160
v_add_f32 v167, v167, v161
v_add_f32 v168, v168, v162
v_add_f32 v169, v169, v163
v_add_f32 v166, v166, v167
v_add_f32 v168, v168, v169
s_nop 0
v_add_f32 v166, v166, v168
s_nop 1
v_add_f32_dpp v166, v166, v166 row_ror:8 row_mask:0xf bank_mask:0xf
s_nop 1
v_add_f32_dpp v166, v166, v166 row_ror:4 row_mask:0xf bank_mask:0xf
s_nop 1
v_add_f32_dpp v166, v166, v166 row_ror:2 row_mask:0xf bank_mask:0xf
s_nop 1
v_add_f32_dpp v166, v166, v166 row_ror:1 row_mask:0xf bank_mask:0xf
s_mov_b32 s80, 0x3ae38e39
v_mul_f32 v166, s80, v166
v_sub_f32 v170, v128, v166
v_mul_f32 v172, v170, v170
v_sub_f32 v170, v129, v166
v_mul_f32 v173, v170, v170
v_sub_f32 v170, v130, v166
v_mul_f32 v174, v170, v170
v_sub_f32 v170, v131, v166
v_mul_f32 v175, v170, v170
v_sub_f32 v170, v132, v166
v_fmac_f32 v172, v170, v170
v_sub_f32 v170, v133, v166
v_fmac_f32 v173, v170, v170
v_sub_f32 v170, v134, v166
v_fmac_f32 v174, v170, v170
v_sub_f32 v170, v135, v166
v_fmac_f32 v175, v170, v170
v_sub_f32 v170, v136, v166
v_fmac_f32 v172, v170, v170
v_sub_f32 v170, v137, v166
v_fmac_f32 v173, v170, v170
v_sub_f32 v170, v138, v166
v_fmac_f32 v174, v170, v170
v_sub_f32 v170, v139, v166
v_fmac_f32 v175, v170, v170
v_sub_f32 v170, v140, v166
v_fmac_f32 v172, v170, v170
v_sub_f32 v170, v141, v166
v_fmac_f32 v173, v170, v170
v_sub_f32 v170, v142, v166
v_fmac_f32 v174, v170, v170
v_sub_f32 v170, v143, v166
v_fmac_f32 v175, v170, v170
v_sub_f32 v170, v144, v166
v_fmac_f32 v172, v170, v170
v_sub_f32 v170, v145, v166
v_fmac_f32 v173, v170, v170
v_sub_f32 v170, v146, v166
v_fmac_f32 v174, v170, v170
v_sub_f32 v170, v147, v166
v_fmac_f32 v175, v170, v170
v_sub_f32 v170, v148, v166
v_fmac_f32 v172, v170, v170
v_sub_f32 v170, v149, v166
v_fmac_f32 v173, v170, v170
v_sub_f32 v170, v150, v166
v_fmac_f32 v174, v170, v170
v_sub_f32 v170, v151, v166
v_fmac_f32 v175, v170, v170
v_sub_f32 v170, v152, v166
v_fmac_f32 v172, v170, v170
v_sub_f32 v170, v153, v166
v_fmac_f32 v173, v170, v170
v_sub_f32 v170, v154, v166
v_fmac_f32 v174, v170, v170
v_sub_f32 v170, v155, v166
v_fmac_f32 v175, v170, v170
v_sub_f32 v170, v156, v166
v_fmac_f32 v172, v170, v170
v_sub_f32 v170, v157, v166
v_fmac_f32 v173, v170, v170
v_sub_f32 v170, v158, v166
v_fmac_f32 v174, v170, v170
v_sub_f32 v170, v159, v166
v_fmac_f32 v175, v170, v170
v_sub_f32 v170, v160, v166
v_fmac_f32 v172, v170, v170
v_sub_f32 v170, v161, v166
v_fmac_f32 v173, v170, v170
v_sub_f32 v170, v162, v166
v_fmac_f32 v174, v170, v170
v_sub_f32 v170, v163, v166
v_fmac_f32 v175, v170, v170
v_add_f32 v172, v172, v173
v_add_f32 v174, v174, v175
s_nop 0
v_add_f32 v172, v172, v174
s_nop 1
v_add_f32_dpp v172, v172, v172 row_ror:8 row_mask:0xf bank_mask:0xf
s_nop 1
v_add_f32_dpp v172, v172, v172 row_ror:4 row_mask:0xf bank_mask:0xf
s_nop 1
v_add_f32_dpp v172, v172, v172 row_ror:2 row_mask:0xf bank_mask:0xf
s_nop 1
v_add_f32_dpp v172, v172, v172 row_ror:1 row_mask:0xf bank_mask:0xf
v_mul_f32 v172, s80, v172
v_cvt_pk_bf16_f32 v166, v166, v172
v_and_b32 v172, 0xffff0000, v166
v_lshlrev_b32 v166, 16, v166
v_add_f32 v172, 0x3727c5ac, v172
v_cvt_pk_bf16_f32 v172, v172, v172
v_lshlrev_b32 v172, 16, v172
v_sqrt_f32 v172, v172
s_nop 0
v_cvt_pk_bf16_f32 v172, v172, v172
v_lshlrev_b32 v172, 16, v172
v_rcp_f32 v173, v172
s_nop 0
v_sub_f32 v128, v128, v166
v_sub_f32 v129, v129, v166
v_cvt_pk_bf16_f32 v176, v128, v129
v_lshlrev_b32 v177, 16, v176
v_and_b32 v178, 0xffff0000, v176
v_mul_f32 v179, v177, v173
v_mul_f32 v180, v178, v173
v_cvt_pk_bf16_f32 v108, v179, v180
v_sub_f32 v130, v130, v166
v_sub_f32 v131, v131, v166
v_cvt_pk_bf16_f32 v176, v130, v131
v_lshlrev_b32 v177, 16, v176
v_and_b32 v178, 0xffff0000, v176
v_mul_f32 v179, v177, v173
v_mul_f32 v180, v178, v173
v_cvt_pk_bf16_f32 v109, v179, v180
v_sub_f32 v132, v132, v166
v_sub_f32 v133, v133, v166
v_cvt_pk_bf16_f32 v176, v132, v133
v_lshlrev_b32 v177, 16, v176
v_and_b32 v178, 0xffff0000, v176
v_mul_f32 v179, v177, v173
v_mul_f32 v180, v178, v173
v_cvt_pk_bf16_f32 v110, v179, v180
v_sub_f32 v134, v134, v166
v_sub_f32 v135, v135, v166
v_cvt_pk_bf16_f32 v176, v134, v135
v_lshlrev_b32 v177, 16, v176
v_and_b32 v178, 0xffff0000, v176
v_mul_f32 v179, v177, v173
v_mul_f32 v180, v178, v173
v_cvt_pk_bf16_f32 v111, v179, v180
v_sub_f32 v136, v136, v166
v_sub_f32 v137, v137, v166
v_cvt_pk_bf16_f32 v176, v136, v137
v_lshlrev_b32 v177, 16, v176
v_and_b32 v178, 0xffff0000, v176
v_mul_f32 v179, v177, v173
v_mul_f32 v180, v178, v173
v_cvt_pk_bf16_f32 v112, v179, v180
v_sub_f32 v138, v138, v166
v_sub_f32 v139, v139, v166
v_cvt_pk_bf16_f32 v176, v138, v139
v_lshlrev_b32 v177, 16, v176
v_and_b32 v178, 0xffff0000, v176
v_mul_f32 v179, v177, v173
v_mul_f32 v180, v178, v173
v_cvt_pk_bf16_f32 v113, v179, v180
v_sub_f32 v140, v140, v166
v_sub_f32 v141, v141, v166
v_cvt_pk_bf16_f32 v176, v140, v141
v_lshlrev_b32 v177, 16, v176
v_and_b32 v178, 0xffff0000, v176
v_mul_f32 v179, v177, v173
v_mul_f32 v180, v178, v173
v_cvt_pk_bf16_f32 v114, v179, v180
v_sub_f32 v142, v142, v166
v_sub_f32 v143, v143, v166
v_cvt_pk_bf16_f32 v176, v142, v143
v_lshlrev_b32 v177, 16, v176
v_and_b32 v178, 0xffff0000, v176
v_mul_f32 v179, v177, v173
v_mul_f32 v180, v178, v173
v_cvt_pk_bf16_f32 v115, v179, v180
v_sub_f32 v144, v144, v166
v_sub_f32 v145, v145, v166
v_cvt_pk_bf16_f32 v176, v144, v145
v_lshlrev_b32 v177, 16, v176
v_and_b32 v178, 0xffff0000, v176
v_mul_f32 v179, v177, v173
v_mul_f32 v180, v178, v173
v_cvt_pk_bf16_f32 v116, v179, v180
v_sub_f32 v146, v146, v166
v_sub_f32 v147, v147, v166
v_cvt_pk_bf16_f32 v176, v146, v147
v_lshlrev_b32 v177, 16, v176
v_and_b32 v178, 0xffff0000, v176
v_mul_f32 v179, v177, v173
v_mul_f32 v180, v178, v173
v_cvt_pk_bf16_f32 v117, v179, v180
v_sub_f32 v148, v148, v166
v_sub_f32 v149, v149, v166
v_cvt_pk_bf16_f32 v176, v148, v149
v_lshlrev_b32 v177, 16, v176
v_and_b32 v178, 0xffff0000, v176
v_mul_f32 v179, v177, v173
v_mul_f32 v180, v178, v173
v_cvt_pk_bf16_f32 v118, v179, v180
v_sub_f32 v150, v150, v166
v_sub_f32 v151, v151, v166
v_cvt_pk_bf16_f32 v176, v150, v151
v_lshlrev_b32 v177, 16, v176
v_and_b32 v178, 0xffff0000, v176
v_mul_f32 v179, v177, v173
v_mul_f32 v180, v178, v173
v_cvt_pk_bf16_f32 v119, v179, v180
v_sub_f32 v152, v152, v166
v_sub_f32 v153, v153, v166
v_cvt_pk_bf16_f32 v176, v152, v153
v_lshlrev_b32 v177, 16, v176
v_and_b32 v178, 0xffff0000, v176
v_mul_f32 v179, v177, v173
v_mul_f32 v180, v178, v173
v_cvt_pk_bf16_f32 v120, v179, v180
v_sub_f32 v154, v154, v166
v_sub_f32 v155, v155, v166
v_cvt_pk_bf16_f32 v176, v154, v155
v_lshlrev_b32 v177, 16, v176
v_and_b32 v178, 0xffff0000, v176
v_mul_f32 v179, v177, v173
v_mul_f32 v180, v178, v173
v_cvt_pk_bf16_f32 v121, v179, v180
v_sub_f32 v156, v156, v166
v_sub_f32 v157, v157, v166
v_cvt_pk_bf16_f32 v176, v156, v157
v_lshlrev_b32 v177, 16, v176
v_and_b32 v178, 0xffff0000, v176
v_mul_f32 v179, v177, v173
v_mul_f32 v180, v178, v173
v_cvt_pk_bf16_f32 v122, v179, v180
v_sub_f32 v158, v158, v166
v_sub_f32 v159, v159, v166
v_cvt_pk_bf16_f32 v176, v158, v159
v_lshlrev_b32 v177, 16, v176
v_and_b32 v178, 0xffff0000, v176
v_mul_f32 v179, v177, v173
v_mul_f32 v180, v178, v173
v_cvt_pk_bf16_f32 v123, v179, v180
v_sub_f32 v160, v160, v166
v_sub_f32 v161, v161, v166
v_cvt_pk_bf16_f32 v176, v160, v161
v_lshlrev_b32 v177, 16, v176
v_and_b32 v178, 0xffff0000, v176
v_mul_f32 v179, v177, v173
v_mul_f32 v180, v178, v173
v_cvt_pk_bf16_f32 v124, v179, v180
v_sub_f32 v162, v162, v166
v_sub_f32 v163, v163, v166
v_cvt_pk_bf16_f32 v176, v162, v163
v_lshlrev_b32 v177, 16, v176
v_and_b32 v178, 0xffff0000, v176
v_mul_f32 v179, v177, v173
v_mul_f32 v180, v178, v173
v_cvt_pk_bf16_f32 v125, v179, v180
s_movk_i32 s80, 0
buffer_store_dwordx2 v[108:109], v102, s[16:19], s80 offen sc1
s_movk_i32 s80, 2048
buffer_store_dwordx2 v[110:111], v102, s[16:19], s80 offen sc1
s_movk_i32 s80, 4096
buffer_store_dwordx2 v[112:113], v102, s[16:19], s80 offen sc1
s_movk_i32 s80, 6144
buffer_store_dwordx2 v[114:115], v102, s[16:19], s80 offen sc1
s_movk_i32 s80, 8192
buffer_store_dwordx2 v[116:117], v102, s[16:19], s80 offen sc1
s_movk_i32 s80, 10240
buffer_store_dwordx2 v[118:119], v102, s[16:19], s80 offen sc1
s_movk_i32 s80, 12288
buffer_store_dwordx2 v[120:121], v102, s[16:19], s80 offen sc1
s_movk_i32 s80, 14336
buffer_store_dwordx2 v[122:123], v102, s[16:19], s80 offen sc1
s_movk_i32 s80, 16384
buffer_store_dwordx2 v[124:125], v102, s[16:19], s80 offen sc1
s_branch L_p1_tkdK
L_p1_ckcK:
s_movk_i32 s80, 0
s_waitcnt vmcnt(9)
buffer_store_dwordx2 v[108:109], v102, s[16:19], s80 offen sc1
s_movk_i32 s80, 2048
s_waitcnt vmcnt(9)
buffer_store_dwordx2 v[110:111], v102, s[16:19], s80 offen sc1
s_movk_i32 s80, 4096
s_waitcnt vmcnt(9)
buffer_store_dwordx2 v[112:113], v102, s[16:19], s80 offen sc1
s_movk_i32 s80, 6144
s_waitcnt vmcnt(9)
buffer_store_dwordx2 v[114:115], v102, s[16:19], s80 offen sc1
s_movk_i32 s80, 8192
s_waitcnt vmcnt(9)
buffer_store_dwordx2 v[116:117], v102, s[16:19], s80 offen sc1
s_movk_i32 s80, 10240
s_waitcnt vmcnt(9)
buffer_store_dwordx2 v[118:119], v102, s[16:19], s80 offen sc1
s_movk_i32 s80, 12288
s_waitcnt vmcnt(9)
buffer_store_dwordx2 v[120:121], v102, s[16:19], s80 offen sc1
s_movk_i32 s80, 14336
s_waitcnt vmcnt(9)
buffer_store_dwordx2 v[122:123], v102, s[16:19], s80 offen sc1
L_p1_tkdK:
s_waitcnt vmcnt(0)
s_barrier
s_cmp_lg_u32 s43, 0
s_cbranch_scc1 L_p1_fbnK
s_cmp_lg_u32 s20, 3
s_cbranch_scc1 L_p1_tkw1K
s_mov_b32 s92, s88
s_mov_b32 s93, s89
s_movk_i32 s94, 256
s_mov_b32 s95, 0x20000
s_lshr_b32 s80, s26, 4
s_lshl_b32 s84, s80, 5
v_mov_b32 v97, s84
v_mov_b32 v98, 1
s_mov_b64 exec, 1
buffer_atomic_add v98, v97, s[92:95], 0 offen sc0
s_lshl_b32 s85, s80, 12
s_waitcnt vmcnt(0)
v_readfirstlane_b32 s82, v98
s_add_u32 s92, s68, 0x6d10000
s_addc_u32 s93, s69, 0
s_mov_b32 s94, 0x8000
s_mov_b32 s95, 0x20000
s_cmp_lg_u32 s82, 31
s_cbranch_scc1 L_p1_notlastK
s_mov_b32 exec_lo, -1
s_mov_b32 exec_hi, 0
v_and_b32 v99, 63, v0
v_lshlrev_b32 v99, 7, v99
v_mov_b32 v100, 1
buffer_store_dword v100, v99, s[92:95], s85 offen sc1
s_mov_b64 exec, 1
s_mov_b32 s83, 1
s_branch L_p1_pubK
L_p1_notlastK:
s_lshl_b32 s84, s42, 7
s_add_u32 s84, s84, s85
v_mov_b32 v97, s84
s_mov_b32 s81, 0
L_p1_pollK:
buffer_load_dword v99, v97, s[92:95], 0 offen sc1
s_waitcnt vmcnt(0)
v_readfirstlane_b32 s82, v99
s_nop 3
s_cmp_eq_u32 s82, 1
s_cselect_b32 s83, 1, 0
s_cbranch_scc1 L_p1_pubK
s_sleep 4
s_add_u32 s81, s81, 1
s_cmp_lt_u32 s81, 4000
s_cbranch_scc1 L_p1_pollK
L_p1_pubK:
v_mov_b32 v97, 131068
v_mov_b32 v98, s83
ds_write_b32 v97, v98
s_mov_b64 exec, -1
s_add_u32 m0, s30, 0
s_add_u32 s31, s32, 0
buffer_load_dwordx4 v9, s[44:47], s31 offen lds
s_add_u32 m0, s30, 4096
s_add_u32 s31, s32, 262144
buffer_load_dwordx4 v9, s[44:47], s31 offen lds
s_add_u32 m0, s30, 8192
s_add_u32 s31, s32, 524288
buffer_load_dwordx4 v9, s[44:47], s31 offen lds
s_add_u32 m0, s30, 12288
s_add_u32 s31, s32, 786432
buffer_load_dwordx4 v9, s[44:47], s31 offen lds
s_add_u32 m0, s30, 16384
s_add_u32 s31, s32, 1048576
buffer_load_dwordx4 v9, s[44:47], s31 offen lds
s_add_u32 m0, s30, 20480
s_add_u32 s31, s32, 1310720
buffer_load_dwordx4 v9, s[44:47], s31 offen lds
s_add_u32 m0, s30, 24576
s_add_u32 s31, s32, 1572864
buffer_load_dwordx4 v9, s[44:47], s31 offen lds
s_add_u32 m0, s30, 28672
s_add_u32 s31, s32, 1835008
buffer_load_dwordx4 v9, s[44:47], s31 offen lds
s_waitcnt lgkmcnt(0)
L_p1_tkmK:
s_barrier
v_mov_b32 v97, 131068
ds_read_b32 v98, v97
s_waitcnt lgkmcnt(0)
v_readfirstlane_b32 s83, v98
s_nop 3
s_cmp_lg_u32 s83, 0
s_cbranch_scc1 L_p1_goK
s_mov_b32 s43, 1
s_mov_b32 s42, 0
s_barrier
s_branch L_p1_taskK
L_p1_tkw1K:
s_add_u32 m0, s30, 0
s_add_u32 s31, s32, 0
buffer_load_dwordx4 v9, s[44:47], s31 offen lds
s_add_u32 m0, s30, 4096
s_add_u32 s31, s32, 262144
buffer_load_dwordx4 v9, s[44:47], s31 offen lds
s_add_u32 m0, s30, 8192
s_add_u32 s31, s32, 524288
buffer_load_dwordx4 v9, s[44:47], s31 offen lds
s_add_u32 m0, s30, 12288
s_add_u32 s31, s32, 786432
buffer_load_dwordx4 v9, s[44:47], s31 offen lds
s_add_u32 m0, s30, 16384
s_add_u32 s31, s32, 1048576
buffer_load_dwordx4 v9, s[44:47], s31 offen lds
s_add_u32 m0, s30, 20480
s_add_u32 s31, s32, 1310720
buffer_load_dwordx4 v9, s[44:47], s31 offen lds
s_add_u32 m0, s30, 24576
s_add_u32 s31, s32, 1572864
buffer_load_dwordx4 v9, s[44:47], s31 offen lds
s_add_u32 m0, s30, 28672
s_add_u32 s31, s32, 1835008
buffer_load_dwordx4 v9, s[44:47], s31 offen lds
s_sub_u32 s35, s76, 512
buffer_load_dword v237, v216, s[72:75], s35 offen
s_branch L_p1_tkmK
L_p1_fbnK:
s_add_u32 s42, s42, 1
s_cmp_lt_u32 s42, 32
s_cbranch_scc1 L_p1_taskK
L_p1_goK:
s_add_u32 s60, s68, 0x400000
s_addc_u32 s61, s69, 0
s_mov_b32 s62, 0x200000
s_mov_b32 s63, 0x20000
s_mul_i32 s12, s26, 16384
s_add_u32 s13, s12, 16384
s_add_u32 s14, s12, 32768
s_add_u32 s15, s12, 49152
buffer_load_dwordx4 a[0:3], v2, s[60:63], s12 offen sc1
buffer_load_dwordx4 a[64:67], v2, s[60:63], s13 offen sc1
buffer_load_dwordx4 a[128:131], v2, s[60:63], s14 offen sc1
buffer_load_dwordx4 a[192:195], v2, s[60:63], s15 offen sc1
buffer_load_dwordx4 a[4:7], v2, s[60:63], s12 offen offset:1024 sc1
buffer_load_dwordx4 a[68:71], v2, s[60:63], s13 offen offset:1024 sc1
buffer_load_dwordx4 a[132:135], v2, s[60:63], s14 offen offset:1024 sc1
buffer_load_dwordx4 a[196:199], v2, s[60:63], s15 offen offset:1024 sc1
buffer_load_dwordx4 a[8:11], v2, s[60:63], s12 offen offset:2048 sc1
buffer_load_dwordx4 a[72:75], v2, s[60:63], s13 offen offset:2048 sc1
buffer_load_dwordx4 a[136:139], v2, s[60:63], s14 offen offset:2048 sc1
buffer_load_dwordx4 a[200:203], v2, s[60:63], s15 offen offset:2048 sc1
buffer_load_dwordx4 a[12:15], v2, s[60:63], s12 offen offset:3072 sc1
buffer_load_dwordx4 a[76:79], v2, s[60:63], s13 offen offset:3072 sc1
buffer_load_dwordx4 a[140:143], v2, s[60:63], s14 offen offset:3072 sc1
buffer_load_dwordx4 a[204:207], v2, s[60:63], s15 offen offset:3072 sc1
s_add_u32 s12, s12, 4096
s_add_u32 s13, s13, 4096
s_add_u32 s14, s14, 4096
s_add_u32 s15, s15, 4096
buffer_load_dwordx4 a[16:19], v2, s[60:63], s12 offen sc1
buffer_load_dwordx4 a[80:83], v2, s[60:63], s13 offen sc1
buffer_load_dwordx4 a[144:147], v2, s[60:63], s14 offen sc1
buffer_load_dwordx4 a[208:211], v2, s[60:63], s15 offen sc1
buffer_load_dwordx4 a[20:23], v2, s[60:63], s12 offen offset:1024 sc1
buffer_load_dwordx4 a[84:87], v2, s[60:63], s13 offen offset:1024 sc1
buffer_load_dwordx4 a[148:151], v2, s[60:63], s14 offen offset:1024 sc1
buffer_load_dwordx4 a[212:215], v2, s[60:63], s15 offen offset:1024 sc1
buffer_load_dwordx4 a[24:27], v2, s[60:63], s12 offen offset:2048 sc1
buffer_load_dwordx4 a[88:91], v2, s[60:63], s13 offen offset:2048 sc1
buffer_load_dwordx4 a[152:155], v2, s[60:63], s14 offen offset:2048 sc1
buffer_load_dwordx4 a[216:219], v2, s[60:63], s15 offen offset:2048 sc1
buffer_load_dwordx4 a[28:31], v2, s[60:63], s12 offen offset:3072 sc1
buffer_load_dwordx4 a[92:95], v2, s[60:63], s13 offen offset:3072 sc1
buffer_load_dwordx4 a[156:159], v2, s[60:63], s14 offen offset:3072 sc1
buffer_load_dwordx4 a[220:223], v2, s[60:63], s15 offen offset:3072 sc1
s_add_u32 s12, s12, 4096
s_add_u32 s13, s13, 4096
s_add_u32 s14, s14, 4096
s_add_u32 s15, s15, 4096
v_add_u32 v200, s27, v3
v_add_u32 v201, s28, v3
v_add_u32 v202, s27, v4
v_add_u32 v203, s28, v4
v_add_u32 v204, s27, v5
v_add_u32 v205, s28, v5
v_add_u32 v206, s27, v6
v_add_u32 v207, s28, v6
s_lshr_b32 s35, s26, 4
s_cmp_eq_u32 s23, 0
s_load_dwordx2 s[88:89], s[0:1], 32
s_cselect_b32 s38, 0, 4194304
s_mul_i32 s35, s35, 524288
s_add_u32 s35, s35, 7680
v_lshrrev_b32 v10, 2, v0
v_and_b32 v11, 3, v0
v_lshlrev_b32 v12, 13, v10
v_lshl_add_u32 v12, v11, 7, v12
s_waitcnt lgkmcnt(0)
s_mov_b32 s92, s88
s_mov_b32 s93, s89
s_mov_b32 s94, s38
s_mov_b32 s95, 0x20000
buffer_load_dword v233, v12, s[92:95], s35 offen
s_sub_u32 s35, s76, 256
buffer_load_dword v235, v216, s[72:75], s35 offen
s_waitcnt vmcnt(38)
s_barrier
ds_read_b64_tr_b16 v[112:113], v200
ds_read_b64_tr_b16 v[114:115], v200 offset:2048
ds_read_b64_tr_b16 v[116:117], v202
ds_read_b64_tr_b16 v[118:119], v202 offset:2048
ds_read_b64_tr_b16 v[120:121], v204
ds_read_b64_tr_b16 v[122:123], v204 offset:2048
ds_read_b64_tr_b16 v[124:125], v206
ds_read_b64_tr_b16 v[126:127], v206 offset:2048
ds_read_b64_tr_b16 v[128:129], v200 offset:4096
ds_read_b64_tr_b16 v[130:131], v200 offset:6144
ds_read_b64_tr_b16 v[132:133], v202 offset:4096
ds_read_b64_tr_b16 v[134:135], v202 offset:6144
s_waitcnt vmcnt(33) lgkmcnt(10)
v_mfma_f32_16x16x32_bf16 v[16:19], v[112:115], a[0:3], 0
s_waitcnt vmcnt(32)
ds_read_b64_tr_b16 v[136:137], v204 offset:4096
v_mfma_f32_16x16x32_bf16 v[20:23], v[112:115], a[64:67], 0
s_waitcnt vmcnt(31)
s_add_u32 m0, s30, 32768
s_add_u32 s31, s32, 2097152
buffer_load_dwordx4 v9, s[44:47], s31 offen lds
v_mfma_f32_16x16x32_bf16 v[24:27], v[112:115], a[128:131], 0
s_waitcnt vmcnt(31)
ds_read_b64_tr_b16 v[138:139], v204 offset:6144
v_mfma_f32_16x16x32_bf16 v[28:31], v[112:115], a[192:195], 0
s_waitcnt lgkmcnt(10)
s_add_u32 m0, s30, 36864
s_add_u32 s31, s32, 2359296
buffer_load_dwordx4 v9, s[44:47], s31 offen lds
v_mfma_f32_16x16x32_bf16 v[32:35], v[116:119], a[0:3], 0
ds_read_b64_tr_b16 v[140:141], v206 offset:4096
v_mfma_f32_16x16x32_bf16 v[36:39], v[116:119], a[64:67], 0
s_add_u32 m0, s30, 40960
s_add_u32 s31, s32, 2621440
buffer_load_dwordx4 v9, s[44:47], s31 offen lds
v_mfma_f32_16x16x32_bf16 v[40:43], v[116:119], a[128:131], 0
ds_read_b64_tr_b16 v[142:143], v206 offset:6144
v_mfma_f32_16x16x32_bf16 v[44:47], v[116:119], a[192:195], 0
s_waitcnt lgkmcnt(10)
s_add_u32 m0, s30, 45056
s_add_u32 s31, s32, 2883584
buffer_load_dwordx4 v9, s[44:47], s31 offen lds
v_mfma_f32_16x16x32_bf16 v[48:51], v[120:123], a[0:3], 0
ds_read_b64_tr_b16 v[112:113], v200 offset:8192
v_mfma_f32_16x16x32_bf16 v[52:55], v[120:123], a[64:67], 0
buffer_load_dwordx4 a[32:35], v2, s[60:63], s12 offen sc1
v_mfma_f32_16x16x32_bf16 v[56:59], v[120:123], a[128:131], 0
ds_read_b64_tr_b16 v[114:115], v200 offset:10240
v_mfma_f32_16x16x32_bf16 v[60:63], v[120:123], a[192:195], 0
s_waitcnt lgkmcnt(10)
buffer_load_dwordx4 a[96:99], v2, s[60:63], s13 offen sc1
v_mfma_f32_16x16x32_bf16 v[64:67], v[124:127], a[0:3], 0
ds_read_b64_tr_b16 v[116:117], v202 offset:8192
v_mfma_f32_16x16x32_bf16 v[68:71], v[124:127], a[64:67], 0
buffer_load_dwordx4 a[160:163], v2, s[60:63], s14 offen sc1
v_mfma_f32_16x16x32_bf16 v[72:75], v[124:127], a[128:131], 0
ds_read_b64_tr_b16 v[118:119], v202 offset:10240
v_mfma_f32_16x16x32_bf16 v[76:79], v[124:127], a[192:195], 0
s_waitcnt vmcnt(36) lgkmcnt(10)
buffer_load_dwordx4 a[224:227], v2, s[60:63], s15 offen sc1
v_mfma_f32_16x16x32_bf16 v[16:19], v[128:131], a[4:7], v[16:19]
s_waitcnt vmcnt(36)
ds_read_b64_tr_b16 v[120:121], v204 offset:8192
v_mfma_f32_16x16x32_bf16 v[20:23], v[128:131], a[68:71], v[20:23]
s_waitcnt vmcnt(35)
buffer_load_dwordx4 a[36:39], v2, s[60:63], s12 offen offset:1024 sc1
v_mfma_f32_16x16x32_bf16 v[24:27], v[128:131], a[132:135], v[24:27]
s_waitcnt vmcnt(35)
ds_read_b64_tr_b16 v[122:123], v204 offset:10240
v_mfma_f32_16x16x32_bf16 v[28:31], v[128:131], a[196:199], v[28:31]
s_waitcnt lgkmcnt(10)
v_mfma_f32_16x16x32_bf16 v[32:35], v[132:135], a[4:7], v[32:35]
ds_read_b64_tr_b16 v[124:125], v206 offset:8192
v_mfma_f32_16x16x32_bf16 v[36:39], v[132:135], a[68:71], v[36:39]
buffer_load_dwordx4 a[100:103], v2, s[60:63], s13 offen offset:1024 sc1
v_mfma_f32_16x16x32_bf16 v[40:43], v[132:135], a[132:135], v[40:43]
ds_read_b64_tr_b16 v[126:127], v206 offset:10240
v_mfma_f32_16x16x32_bf16 v[44:47], v[132:135], a[196:199], v[44:47]
s_waitcnt lgkmcnt(10)
buffer_load_dwordx4 a[164:167], v2, s[60:63], s14 offen offset:1024 sc1
v_mfma_f32_16x16x32_bf16 v[48:51], v[136:139], a[4:7], v[48:51]
ds_read_b64_tr_b16 v[128:129], v200 offset:12288
v_mfma_f32_16x16x32_bf16 v[52:55], v[136:139], a[68:71], v[52:55]
buffer_load_dwordx4 a[228:231], v2, s[60:63], s15 offen offset:1024 sc1
v_mfma_f32_16x16x32_bf16 v[56:59], v[136:139], a[132:135], v[56:59]
ds_read_b64_tr_b16 v[130:131], v200 offset:14336
v_mfma_f32_16x16x32_bf16 v[60:63], v[136:139], a[196:199], v[60:63]
s_waitcnt lgkmcnt(10)
buffer_load_dwordx4 a[40:43], v2, s[60:63], s12 offen offset:2048 sc1
v_mfma_f32_16x16x32_bf16 v[64:67], v[140:143], a[4:7], v[64:67]
ds_read_b64_tr_b16 v[132:133], v202 offset:12288
v_mfma_f32_16x16x32_bf16 v[68:71], v[140:143], a[68:71], v[68:71]
buffer_load_dwordx4 a[104:107], v2, s[60:63], s13 offen offset:2048 sc1
v_mfma_f32_16x16x32_bf16 v[72:75], v[140:143], a[132:135], v[72:75]
ds_read_b64_tr_b16 v[134:135], v202 offset:14336
v_mfma_f32_16x16x32_bf16 v[76:79], v[140:143], a[196:199], v[76:79]
s_waitcnt vmcnt(39) lgkmcnt(10)
buffer_load_dwordx4 a[168:171], v2, s[60:63], s14 offen offset:2048 sc1
v_mfma_f32_16x16x32_bf16 v[16:19], v[112:115], a[8:11], v[16:19]
s_waitcnt vmcnt(39)
ds_read_b64_tr_b16 v[136:137], v204 offset:12288
v_mfma_f32_16x16x32_bf16 v[20:23], v[112:115], a[72:75], v[20:23]
s_waitcnt vmcnt(38)
buffer_load_dwordx4 a[232:235], v2, s[60:63], s15 offen offset:2048 sc1
v_mfma_f32_16x16x32_bf16 v[24:27], v[112:115], a[136:139], v[24:27]
s_waitcnt vmcnt(38)
ds_read_b64_tr_b16 v[138:139], v204 offset:14336
v_mfma_f32_16x16x32_bf16 v[28:31], v[112:115], a[200:203], v[28:31]
s_waitcnt lgkmcnt(10)
buffer_load_dwordx4 a[44:47], v2, s[60:63], s12 offen offset:3072 sc1
v_mfma_f32_16x16x32_bf16 v[32:35], v[116:119], a[8:11], v[32:35]
ds_read_b64_tr_b16 v[140:141], v206 offset:12288
v_mfma_f32_16x16x32_bf16 v[36:39], v[116:119], a[72:75], v[36:39]
buffer_load_dwordx4 a[108:111], v2, s[60:63], s13 offen offset:3072 sc1
v_mfma_f32_16x16x32_bf16 v[40:43], v[116:119], a[136:139], v[40:43]
ds_read_b64_tr_b16 v[142:143], v206 offset:14336
v_mfma_f32_16x16x32_bf16 v[44:47], v[116:119], a[200:203], v[44:47]
s_barrier
buffer_load_dwordx4 a[172:175], v2, s[60:63], s14 offen offset:3072 sc1
s_waitcnt lgkmcnt(10)
v_mfma_f32_16x16x32_bf16 v[48:51], v[120:123], a[8:11], v[48:51]
ds_read_b64_tr_b16 v[112:113], v200 offset:16384
v_mfma_f32_16x16x32_bf16 v[52:55], v[120:123], a[72:75], v[52:55]
buffer_load_dwordx4 a[236:239], v2, s[60:63], s15 offen offset:3072 sc1
s_add_u32 s12, s12, 4096
s_add_u32 s13, s13, 4096
s_add_u32 s14, s14, 4096
s_add_u32 s15, s15, 4096
v_mfma_f32_16x16x32_bf16 v[56:59], v[120:123], a[136:139], v[56:59]
ds_read_b64_tr_b16 v[114:115], v200 offset:18432
v_mfma_f32_16x16x32_bf16 v[60:63], v[120:123], a[200:203], v[60:63]
s_waitcnt lgkmcnt(10)
s_add_u32 m0, s30, 49152
s_add_u32 s31, s32, 3145728
buffer_load_dwordx4 v9, s[44:47], s31 offen lds
v_mfma_f32_16x16x32_bf16 v[64:67], v[124:127], a[8:11], v[64:67]
ds_read_b64_tr_b16 v[116:117], v202 offset:16384
v_mfma_f32_16x16x32_bf16 v[68:71], v[124:127], a[72:75], v[68:71]
s_add_u32 m0, s30, 53248
s_add_u32 s31, s32, 3407872
buffer_load_dwordx4 v9, s[44:47], s31 offen lds
v_mfma_f32_16x16x32_bf16 v[72:75], v[124:127], a[136:139], v[72:75]
ds_read_b64_tr_b16 v[118:119], v202 offset:18432
v_mfma_f32_16x16x32_bf16 v[76:79], v[124:127], a[200:203], v[76:79]
s_waitcnt vmcnt(43) lgkmcnt(10)
s_add_u32 m0, s30, 57344
s_add_u32 s31, s32, 3670016
buffer_load_dwordx4 v9, s[44:47], s31 offen lds
v_mfma_f32_16x16x32_bf16 v[16:19], v[128:131], a[12:15], v[16:19]
s_waitcnt vmcnt(43)
ds_read_b64_tr_b16 v[120:121], v204 offset:16384
v_mfma_f32_16x16x32_bf16 v[20:23], v[128:131], a[76:79], v[20:23]
s_waitcnt vmcnt(42)
s_add_u32 m0, s30, 61440
s_add_u32 s31, s32, 3932160
buffer_load_dwordx4 v9, s[44:47], s31 offen lds
v_mfma_f32_16x16x32_bf16 v[24:27], v[128:131], a[140:143], v[24:27]
s_waitcnt vmcnt(42)
ds_read_b64_tr_b16 v[122:123], v204 offset:18432
v_mfma_f32_16x16x32_bf16 v[28:31], v[128:131], a[204:207], v[28:31]
s_waitcnt lgkmcnt(10)
buffer_load_dwordx4 a[48:51], v2, s[60:63], s12 offen sc1
v_mfma_f32_16x16x32_bf16 v[32:35], v[132:135], a[12:15], v[32:35]
ds_read_b64_tr_b16 v[124:125], v206 offset:16384
v_mfma_f32_16x16x32_bf16 v[36:39], v[132:135], a[76:79], v[36:39]
buffer_load_dwordx4 a[112:115], v2, s[60:63], s13 offen sc1
v_mfma_f32_16x16x32_bf16 v[40:43], v[132:135], a[140:143], v[40:43]
ds_read_b64_tr_b16 v[126:127], v206 offset:18432
v_mfma_f32_16x16x32_bf16 v[44:47], v[132:135], a[204:207], v[44:47]
s_waitcnt lgkmcnt(10)
buffer_load_dwordx4 a[176:179], v2, s[60:63], s14 offen sc1
v_mfma_f32_16x16x32_bf16 v[48:51], v[136:139], a[12:15], v[48:51]
ds_read_b64_tr_b16 v[128:129], v200 offset:20480
v_mfma_f32_16x16x32_bf16 v[52:55], v[136:139], a[76:79], v[52:55]
v_mfma_f32_16x16x32_bf16 v[56:59], v[136:139], a[140:143], v[56:59]
ds_read_b64_tr_b16 v[130:131], v200 offset:22528
v_mfma_f32_16x16x32_bf16 v[60:63], v[136:139], a[204:207], v[60:63]
s_waitcnt lgkmcnt(10)
buffer_load_dwordx4 a[240:243], v2, s[60:63], s15 offen sc1
v_mfma_f32_16x16x32_bf16 v[64:67], v[140:143], a[12:15], v[64:67]
ds_read_b64_tr_b16 v[132:133], v202 offset:20480
v_mfma_f32_16x16x32_bf16 v[68:71], v[140:143], a[76:79], v[68:71]
buffer_load_dwordx4 a[52:55], v2, s[60:63], s12 offen offset:1024 sc1
v_mfma_f32_16x16x32_bf16 v[72:75], v[140:143], a[140:143], v[72:75]
ds_read_b64_tr_b16 v[134:135], v202 offset:22528
v_mfma_f32_16x16x32_bf16 v[76:79], v[140:143], a[204:207], v[76:79]
s_waitcnt vmcnt(46) lgkmcnt(10)
buffer_load_dwordx4 a[116:119], v2, s[60:63], s13 offen offset:1024 sc1
v_mfma_f32_16x16x32_bf16 v[16:19], v[112:115], a[16:19], v[16:19]
s_waitcnt vmcnt(46)
ds_read_b64_tr_b16 v[136:137], v204 offset:20480
v_mfma_f32_16x16x32_bf16 v[20:23], v[112:115], a[80:83], v[20:23]
s_waitcnt vmcnt(45)
buffer_load_dwordx4 a[180:183], v2, s[60:63], s14 offen offset:1024 sc1
v_mfma_f32_16x16x32_bf16 v[24:27], v[112:115], a[144:147], v[24:27]
s_waitcnt vmcnt(45)
ds_read_b64_tr_b16 v[138:139], v204 offset:22528
v_mfma_f32_16x16x32_bf16 v[28:31], v[112:115], a[208:211], v[28:31]
s_waitcnt lgkmcnt(10)
buffer_load_dwordx4 a[244:247], v2, s[60:63], s15 offen offset:1024 sc1
v_mfma_f32_16x16x32_bf16 v[32:35], v[116:119], a[16:19], v[32:35]
ds_read_b64_tr_b16 v[140:141], v206 offset:20480
v_mfma_f32_16x16x32_bf16 v[36:39], v[116:119], a[80:83], v[36:39]
buffer_load_dwordx4 a[56:59], v2, s[60:63], s12 offen offset:2048 sc1
v_mfma_f32_16x16x32_bf16 v[40:43], v[116:119], a[144:147], v[40:43]
ds_read_b64_tr_b16 v[142:143], v206 offset:22528
v_mfma_f32_16x16x32_bf16 v[44:47], v[116:119], a[208:211], v[44:47]
s_waitcnt lgkmcnt(10)
buffer_load_dwordx4 a[120:123], v2, s[60:63], s13 offen offset:2048 sc1
v_mfma_f32_16x16x32_bf16 v[48:51], v[120:123], a[16:19], v[48:51]
ds_read_b64_tr_b16 v[112:113], v200 offset:24576
v_mfma_f32_16x16x32_bf16 v[52:55], v[120:123], a[80:83], v[52:55]
buffer_load_dwordx4 a[184:187], v2, s[60:63], s14 offen offset:2048 sc1
v_mfma_f32_16x16x32_bf16 v[56:59], v[120:123], a[144:147], v[56:59]
ds_read_b64_tr_b16 v[114:115], v200 offset:26624
v_mfma_f32_16x16x32_bf16 v[60:63], v[120:123], a[208:211], v[60:63]
s_waitcnt lgkmcnt(10)
buffer_load_dwordx4 a[248:251], v2, s[60:63], s15 offen offset:2048 sc1
v_mfma_f32_16x16x32_bf16 v[64:67], v[124:127], a[16:19], v[64:67]
ds_read_b64_tr_b16 v[116:117], v202 offset:24576
v_mfma_f32_16x16x32_bf16 v[68:71], v[124:127], a[80:83], v[68:71]
buffer_load_dwordx4 a[60:63], v2, s[60:63], s12 offen offset:3072 sc1
v_mfma_f32_16x16x32_bf16 v[72:75], v[124:127], a[144:147], v[72:75]
ds_read_b64_tr_b16 v[118:119], v202 offset:26624
v_mfma_f32_16x16x32_bf16 v[76:79], v[124:127], a[208:211], v[76:79]
s_waitcnt vmcnt(50) lgkmcnt(10)
buffer_load_dwordx4 a[124:127], v2, s[60:63], s13 offen offset:3072 sc1
v_mfma_f32_16x16x32_bf16 v[16:19], v[128:131], a[20:23], v[16:19]
s_waitcnt vmcnt(50)
ds_read_b64_tr_b16 v[120:121], v204 offset:24576
v_mfma_f32_16x16x32_bf16 v[20:23], v[128:131], a[84:87], v[20:23]
s_waitcnt vmcnt(49)
buffer_load_dwordx4 a[188:191], v2, s[60:63], s14 offen offset:3072 sc1
v_mfma_f32_16x16x32_bf16 v[24:27], v[128:131], a[148:151], v[24:27]
s_waitcnt vmcnt(49)
ds_read_b64_tr_b16 v[122:123], v204 offset:26624
v_mfma_f32_16x16x32_bf16 v[28:31], v[128:131], a[212:215], v[28:31]
s_waitcnt lgkmcnt(10)
buffer_load_dwordx4 a[252:255], v2, s[60:63], s15 offen offset:3072 sc1
s_add_u32 s12, s12, 4096
s_add_u32 s13, s13, 4096
s_add_u32 s14, s14, 4096
s_add_u32 s15, s15, 4096
v_mfma_f32_16x16x32_bf16 v[32:35], v[132:135], a[20:23], v[32:35]
ds_read_b64_tr_b16 v[124:125], v206 offset:24576
v_mfma_f32_16x16x32_bf16 v[36:39], v[132:135], a[84:87], v[36:39]
v_mfma_f32_16x16x32_bf16 v[40:43], v[132:135], a[148:151], v[40:43]
ds_read_b64_tr_b16 v[126:127], v206 offset:26624
v_mfma_f32_16x16x32_bf16 v[44:47], v[132:135], a[212:215], v[44:47]
s_waitcnt lgkmcnt(10)
v_mfma_f32_16x16x32_bf16 v[48:51], v[136:139], a[20:23], v[48:51]
ds_read_b64_tr_b16 v[128:129], v200 offset:28672
v_mfma_f32_16x16x32_bf16 v[52:55], v[136:139], a[84:87], v[52:55]
v_mfma_f32_16x16x32_bf16 v[56:59], v[136:139], a[148:151], v[56:59]
ds_read_b64_tr_b16 v[130:131], v200 offset:30720
v_mfma_f32_16x16x32_bf16 v[60:63], v[136:139], a[212:215], v[60:63]
s_waitcnt lgkmcnt(10)
v_mfma_f32_16x16x32_bf16 v[64:67], v[140:143], a[20:23], v[64:67]
s_add_u32 s32, s32, 128
s_xor_b32 s30, s30, 65536
ds_read_b64_tr_b16 v[132:133], v202 offset:28672
v_mfma_f32_16x16x32_bf16 v[68:71], v[140:143], a[84:87], v[68:71]
s_cmp_eq_u32 s22, 1
s_cselect_b32 s46, 0, s46
v_mfma_f32_16x16x32_bf16 v[72:75], v[140:143], a[148:151], v[72:75]
ds_read_b64_tr_b16 v[134:135], v202 offset:30720
v_mfma_f32_16x16x32_bf16 v[76:79], v[140:143], a[212:215], v[76:79]
s_waitcnt vmcnt(49) lgkmcnt(10)
s_mov_b32 m0, s30
s_mov_b32 s31, s32
buffer_load_dwordx4 v9, s[44:47], s31 offen lds
v_mfma_f32_16x16x32_bf16 v[16:19], v[112:115], a[24:27], v[16:19]
s_waitcnt vmcnt(49)
ds_read_b64_tr_b16 v[136:137], v204 offset:28672
v_mfma_f32_16x16x32_bf16 v[20:23], v[112:115], a[88:91], v[20:23]
s_waitcnt vmcnt(48)
s_add_u32 m0, m0, 4096
s_add_u32 s31, s31, 262144
buffer_load_dwordx4 v9, s[44:47], s31 offen lds
v_mfma_f32_16x16x32_bf16 v[24:27], v[112:115], a[152:155], v[24:27]
s_waitcnt vmcnt(48)
ds_read_b64_tr_b16 v[138:139], v204 offset:30720
v_mfma_f32_16x16x32_bf16 v[28:31], v[112:115], a[216:219], v[28:31]
s_waitcnt lgkmcnt(10)
v_mfma_f32_16x16x32_bf16 v[32:35], v[116:119], a[24:27], v[32:35]
ds_read_b64_tr_b16 v[140:141], v206 offset:28672
v_mfma_f32_16x16x32_bf16 v[36:39], v[116:119], a[88:91], v[36:39]
v_mfma_f32_16x16x32_bf16 v[40:43], v[116:119], a[152:155], v[40:43]
ds_read_b64_tr_b16 v[142:143], v206 offset:30720
v_mfma_f32_16x16x32_bf16 v[44:47], v[116:119], a[216:219], v[44:47]
s_waitcnt vmcnt(38)
s_barrier
s_add_u32 m0, m0, 4096
s_add_u32 s31, s31, 262144
buffer_load_dwordx4 v9, s[44:47], s31 offen lds
s_waitcnt lgkmcnt(10)
v_mfma_f32_16x16x32_bf16 v[48:51], v[120:123], a[24:27], v[48:51]
ds_read_b64_tr_b16 v[112:113], v201
v_mfma_f32_16x16x32_bf16 v[52:55], v[120:123], a[88:91], v[52:55]
v_mfma_f32_16x16x32_bf16 v[56:59], v[120:123], a[152:155], v[56:59]
ds_read_b64_tr_b16 v[114:115], v201 offset:2048
v_mfma_f32_16x16x32_bf16 v[60:63], v[120:123], a[216:219], v[60:63]
s_waitcnt lgkmcnt(10)
v_mfma_f32_16x16x32_bf16 v[64:67], v[124:127], a[24:27], v[64:67]
ds_read_b64_tr_b16 v[116:117], v203
v_mfma_f32_16x16x32_bf16 v[68:71], v[124:127], a[88:91], v[68:71]
s_add_u32 m0, m0, 4096
s_add_u32 s31, s31, 262144
buffer_load_dwordx4 v9, s[44:47], s31 offen lds
v_mfma_f32_16x16x32_bf16 v[72:75], v[124:127], a[152:155], v[72:75]
ds_read_b64_tr_b16 v[118:119], v203 offset:2048
v_mfma_f32_16x16x32_bf16 v[76:79], v[124:127], a[216:219], v[76:79]
s_waitcnt lgkmcnt(10)
v_mfma_f32_16x16x32_bf16 v[16:19], v[128:131], a[28:31], v[16:19]
ds_read_b64_tr_b16 v[120:121], v205
v_mfma_f32_16x16x32_bf16 v[20:23], v[128:131], a[92:95], v[20:23]
v_mfma_f32_16x16x32_bf16 v[24:27], v[128:131], a[156:159], v[24:27]
ds_read_b64_tr_b16 v[122:123], v205 offset:2048
v_mfma_f32_16x16x32_bf16 v[28:31], v[128:131], a[220:223], v[28:31]
s_waitcnt lgkmcnt(10)
s_add_u32 m0, m0, 4096
s_add_u32 s31, s31, 262144
buffer_load_dwordx4 v9, s[44:47], s31 offen lds
v_mfma_f32_16x16x32_bf16 v[32:35], v[132:135], a[28:31], v[32:35]
ds_read_b64_tr_b16 v[124:125], v207
v_mfma_f32_16x16x32_bf16 v[36:39], v[132:135], a[92:95], v[36:39]
v_mfma_f32_16x16x32_bf16 v[40:43], v[132:135], a[156:159], v[40:43]
ds_read_b64_tr_b16 v[126:127], v207 offset:2048
v_mfma_f32_16x16x32_bf16 v[44:47], v[132:135], a[220:223], v[44:47]
s_waitcnt lgkmcnt(10)
v_mfma_f32_16x16x32_bf16 v[48:51], v[136:139], a[28:31], v[48:51]
ds_read_b64_tr_b16 v[128:129], v201 offset:4096
v_mfma_f32_16x16x32_bf16 v[52:55], v[136:139], a[92:95], v[52:55]
s_add_u32 m0, m0, 4096
s_add_u32 s31, s31, 262144
buffer_load_dwordx4 v9, s[44:47], s31 offen lds
v_mfma_f32_16x16x32_bf16 v[56:59], v[136:139], a[156:159], v[56:59]
ds_read_b64_tr_b16 v[130:131], v201 offset:6144
v_mfma_f32_16x16x32_bf16 v[60:63], v[136:139], a[220:223], v[60:63]
s_waitcnt lgkmcnt(10)
v_mfma_f32_16x16x32_bf16 v[64:67], v[140:143], a[28:31], v[64:67]
ds_read_b64_tr_b16 v[132:133], v203 offset:4096
v_mfma_f32_16x16x32_bf16 v[68:71], v[140:143], a[92:95], v[68:71]
s_add_u32 m0, m0, 4096
s_add_u32 s31, s31, 262144
buffer_load_dwordx4 v9, s[44:47], s31 offen lds
v_mfma_f32_16x16x32_bf16 v[72:75], v[140:143], a[156:159], v[72:75]
ds_read_b64_tr_b16 v[134:135], v203 offset:6144
v_mfma_f32_16x16x32_bf16 v[76:79], v[140:143], a[220:223], v[76:79]
s_waitcnt vmcnt(42) lgkmcnt(10)
v_mfma_f32_16x16x32_bf16 v[16:19], v[112:115], a[32:35], v[16:19]
s_waitcnt vmcnt(41)
ds_read_b64_tr_b16 v[136:137], v205 offset:4096
v_mfma_f32_16x16x32_bf16 v[20:23], v[112:115], a[96:99], v[20:23]
s_waitcnt vmcnt(40)
v_mfma_f32_16x16x32_bf16 v[24:27], v[112:115], a[160:163], v[24:27]
s_waitcnt vmcnt(39)
ds_read_b64_tr_b16 v[138:139], v205 offset:6144
v_mfma_f32_16x16x32_bf16 v[28:31], v[112:115], a[224:227], v[28:31]
s_waitcnt lgkmcnt(10)
s_add_u32 m0, m0, 4096
s_add_u32 s31, s31, 262144
buffer_load_dwordx4 v9, s[44:47], s31 offen lds
v_mfma_f32_16x16x32_bf16 v[32:35], v[116:119], a[32:35], v[32:35]
ds_read_b64_tr_b16 v[140:141], v207 offset:4096
v_mfma_f32_16x16x32_bf16 v[36:39], v[116:119], a[96:99], v[36:39]
v_mfma_f32_16x16x32_bf16 v[40:43], v[116:119], a[160:163], v[40:43]
ds_read_b64_tr_b16 v[142:143], v207 offset:6144
v_mfma_f32_16x16x32_bf16 v[44:47], v[116:119], a[224:227], v[44:47]
s_waitcnt lgkmcnt(10)
v_mfma_f32_16x16x32_bf16 v[48:51], v[120:123], a[32:35], v[48:51]
ds_read_b64_tr_b16 v[112:113], v201 offset:8192
v_mfma_f32_16x16x32_bf16 v[52:55], v[120:123], a[96:99], v[52:55]
s_add_u32 m0, m0, 4096
s_add_u32 s31, s31, 262144
buffer_load_dwordx4 v9, s[44:47], s31 offen lds
v_mfma_f32_16x16x32_bf16 v[56:59], v[120:123], a[160:163], v[56:59]
ds_read_b64_tr_b16 v[114:115], v201 offset:10240
v_mfma_f32_16x16x32_bf16 v[60:63], v[120:123], a[224:227], v[60:63]
s_waitcnt lgkmcnt(10)
v_mfma_f32_16x16x32_bf16 v[64:67], v[124:127], a[32:35], v[64:67]
ds_read_b64_tr_b16 v[116:117], v203 offset:8192
v_mfma_f32_16x16x32_bf16 v[68:71], v[124:127], a[96:99], v[68:71]
v_mfma_f32_16x16x32_bf16 v[72:75], v[124:127], a[160:163], v[72:75]
ds_read_b64_tr_b16 v[118:119], v203 offset:10240
v_mfma_f32_16x16x32_bf16 v[76:79], v[124:127], a[224:227], v[76:79]
s_waitcnt vmcnt(40) lgkmcnt(10)
s_add_u32 m0, m0, 4096
s_add_u32 s31, s31, 262144
buffer_load_dwordx4 v9, s[44:47], s31 offen lds
v_mfma_f32_16x16x32_bf16 v[16:19], v[128:131], a[36:39], v[16:19]
s_waitcnt vmcnt(40)
ds_read_b64_tr_b16 v[120:121], v205 offset:8192
v_mfma_f32_16x16x32_bf16 v[20:23], v[128:131], a[100:103], v[20:23]
s_waitcnt vmcnt(39)
v_mfma_f32_16x16x32_bf16 v[24:27], v[128:131], a[164:167], v[24:27]
s_waitcnt vmcnt(38)
ds_read_b64_tr_b16 v[122:123], v205 offset:10240
v_mfma_f32_16x16x32_bf16 v[28:31], v[128:131], a[228:231], v[28:31]
s_waitcnt lgkmcnt(10)
v_mfma_f32_16x16x32_bf16 v[32:35], v[132:135], a[36:39], v[32:35]
ds_read_b64_tr_b16 v[124:125], v207 offset:8192
v_mfma_f32_16x16x32_bf16 v[36:39], v[132:135], a[100:103], v[36:39]
s_add_u32 m0, m0, 4096
s_add_u32 s31, s31, 262144
buffer_load_dwordx4 v9, s[44:47], s31 offen lds
v_mfma_f32_16x16x32_bf16 v[40:43], v[132:135], a[164:167], v[40:43]
ds_read_b64_tr_b16 v[126:127], v207 offset:10240
v_mfma_f32_16x16x32_bf16 v[44:47], v[132:135], a[228:231], v[44:47]
s_waitcnt lgkmcnt(10)
v_mfma_f32_16x16x32_bf16 v[48:51], v[136:139], a[36:39], v[48:51]
ds_read_b64_tr_b16 v[128:129], v201 offset:12288
v_mfma_f32_16x16x32_bf16 v[52:55], v[136:139], a[100:103], v[52:55]
s_add_u32 m0, m0, 4096
s_add_u32 s31, s31, 262144
buffer_load_dwordx4 v9, s[44:47], s31 offen lds
v_mfma_f32_16x16x32_bf16 v[56:59], v[136:139], a[164:167], v[56:59]
ds_read_b64_tr_b16 v[130:131], v201 offset:14336
v_mfma_f32_16x16x32_bf16 v[60:63], v[136:139], a[228:231], v[60:63]
s_waitcnt lgkmcnt(10)
v_mfma_f32_16x16x32_bf16 v[64:67], v[140:143], a[36:39], v[64:67]
ds_read_b64_tr_b16 v[132:133], v203 offset:12288
v_mfma_f32_16x16x32_bf16 v[68:71], v[140:143], a[100:103], v[68:71]
v_mfma_f32_16x16x32_bf16 v[72:75], v[140:143], a[164:167], v[72:75]
ds_read_b64_tr_b16 v[134:135], v203 offset:14336
v_mfma_f32_16x16x32_bf16 v[76:79], v[140:143], a[228:231], v[76:79]
s_waitcnt vmcnt(39) lgkmcnt(10)
s_add_u32 m0, m0, 4096
s_add_u32 s31, s31, 262144
buffer_load_dwordx4 v9, s[44:47], s31 offen lds
v_mfma_f32_16x16x32_bf16 v[16:19], v[112:115], a[40:43], v[16:19]
s_waitcnt vmcnt(39)
ds_read_b64_tr_b16 v[136:137], v205 offset:12288
v_mfma_f32_16x16x32_bf16 v[20:23], v[112:115], a[104:107], v[20:23]
s_waitcnt vmcnt(38)
v_mfma_f32_16x16x32_bf16 v[24:27], v[112:115], a[168:171], v[24:27]
s_waitcnt vmcnt(37)
ds_read_b64_tr_b16 v[138:139], v205 offset:14336
v_mfma_f32_16x16x32_bf16 v[28:31], v[112:115], a[232:235], v[28:31]
s_waitcnt lgkmcnt(10)
v_mfma_f32_16x16x32_bf16 v[32:35], v[116:119], a[40:43], v[32:35]
ds_read_b64_tr_b16 v[140:141], v207 offset:12288
v_mfma_f32_16x16x32_bf16 v[36:39], v[116:119], a[104:107], v[36:39]
s_add_u32 m0, m0, 4096
s_add_u32 s31, s31, 262144
buffer_load_dwordx4 v9, s[44:47], s31 offen lds
v_mfma_f32_16x16x32_bf16 v[40:43], v[116:119], a[168:171], v[40:43]
ds_read_b64_tr_b16 v[142:143], v207 offset:14336
v_mfma_f32_16x16x32_bf16 v[44:47], v[116:119], a[232:235], v[44:47]
s_waitcnt vmcnt(30)
s_barrier
s_waitcnt lgkmcnt(10)
v_mfma_f32_16x16x32_bf16 v[48:51], v[120:123], a[40:43], v[48:51]
ds_read_b64_tr_b16 v[112:113], v201 offset:16384
v_mfma_f32_16x16x32_bf16 v[52:55], v[120:123], a[104:107], v[52:55]
v_mfma_f32_16x16x32_bf16 v[56:59], v[120:123], a[168:171], v[56:59]
ds_read_b64_tr_b16 v[114:115], v201 offset:18432
v_mfma_f32_16x16x32_bf16 v[60:63], v[120:123], a[232:235], v[60:63]
s_waitcnt lgkmcnt(10)
s_add_u32 m0, m0, 4096
s_add_u32 s31, s31, 262144
buffer_load_dwordx4 v9, s[44:47], s31 offen lds
v_mfma_f32_16x16x32_bf16 v[64:67], v[124:127], a[40:43], v[64:67]
ds_read_b64_tr_b16 v[116:117], v203 offset:16384
v_mfma_f32_16x16x32_bf16 v[68:71], v[124:127], a[104:107], v[68:71]
v_mfma_f32_16x16x32_bf16 v[72:75], v[124:127], a[168:171], v[72:75]
ds_read_b64_tr_b16 v[118:119], v203 offset:18432
v_mfma_f32_16x16x32_bf16 v[76:79], v[124:127], a[232:235], v[76:79]
s_waitcnt lgkmcnt(10)
v_mfma_f32_16x16x32_bf16 v[16:19], v[128:131], a[44:47], v[16:19]
ds_read_b64_tr_b16 v[120:121], v205 offset:16384
v_mfma_f32_16x16x32_bf16 v[20:23], v[128:131], a[108:111], v[20:23]
s_add_u32 m0, m0, 4096
s_add_u32 s31, s31, 262144
buffer_load_dwordx4 v9, s[44:47], s31 offen lds
v_mfma_f32_16x16x32_bf16 v[24:27], v[128:131], a[172:175], v[24:27]
ds_read_b64_tr_b16 v[122:123], v205 offset:18432
v_mfma_f32_16x16x32_bf16 v[28:31], v[128:131], a[236:239], v[28:31]
s_waitcnt lgkmcnt(10)
v_mfma_f32_16x16x32_bf16 v[32:35], v[132:135], a[44:47], v[32:35]
ds_read_b64_tr_b16 v[124:125], v207 offset:16384
v_mfma_f32_16x16x32_bf16 v[36:39], v[132:135], a[108:111], v[36:39]
v_mfma_f32_16x16x32_bf16 v[40:43], v[132:135], a[172:175], v[40:43]
ds_read_b64_tr_b16 v[126:127], v207 offset:18432
v_mfma_f32_16x16x32_bf16 v[44:47], v[132:135], a[236:239], v[44:47]
s_waitcnt lgkmcnt(10)
v_mfma_f32_16x16x32_bf16 v[48:51], v[136:139], a[44:47], v[48:51]
ds_read_b64_tr_b16 v[128:129], v201 offset:20480
v_mfma_f32_16x16x32_bf16 v[52:55], v[136:139], a[108:111], v[52:55]
v_mfma_f32_16x16x32_bf16 v[56:59], v[136:139], a[172:175], v[56:59]
ds_read_b64_tr_b16 v[130:131], v201 offset:22528
v_mfma_f32_16x16x32_bf16 v[60:63], v[136:139], a[236:239], v[60:63]
s_waitcnt lgkmcnt(10)
v_mfma_f32_16x16x32_bf16 v[64:67], v[140:143], a[44:47], v[64:67]
ds_read_b64_tr_b16 v[132:133], v203 offset:20480
v_mfma_f32_16x16x32_bf16 v[68:71], v[140:143], a[108:111], v[68:71]
v_mfma_f32_16x16x32_bf16 v[72:75], v[140:143], a[172:175], v[72:75]
ds_read_b64_tr_b16 v[134:135], v203 offset:22528
v_mfma_f32_16x16x32_bf16 v[76:79], v[140:143], a[236:239], v[76:79]
s_waitcnt vmcnt(31) lgkmcnt(10)
v_mfma_f32_16x16x32_bf16 v[16:19], v[112:115], a[48:51], v[16:19]
s_waitcnt vmcnt(30)
ds_read_b64_tr_b16 v[136:137], v205 offset:20480
v_mfma_f32_16x16x32_bf16 v[20:23], v[112:115], a[112:115], v[20:23]
s_waitcnt vmcnt(29)
v_mfma_f32_16x16x32_bf16 v[24:27], v[112:115], a[176:179], v[24:27]
s_waitcnt vmcnt(28)
s_cmp_gt_u32 s22, 4
s_cselect_b32 s74, s77, 0
s_bitcmp1_b32 s78, 0
s_cselect_b32 s74, 0, s74
ds_read_b64_tr_b16 v[138:139], v205 offset:22528
v_mfma_f32_16x16x32_bf16 v[28:31], v[112:115], a[240:243], v[28:31]
s_waitcnt lgkmcnt(10)
buffer_load_dword v232, v216, s[72:75], s76 offen
v_mfma_f32_16x16x32_bf16 v[32:35], v[116:119], a[48:51], v[32:35]
s_add_u32 s76, s76, 128
ds_read_b64_tr_b16 v[140:141], v207 offset:20480
v_mfma_f32_16x16x32_bf16 v[36:39], v[116:119], a[112:115], v[36:39]
v_mfma_f32_16x16x32_bf16 v[40:43], v[116:119], a[176:179], v[40:43]
s_add_u32 s78, s78, 1
ds_read_b64_tr_b16 v[142:143], v207 offset:22528
v_mfma_f32_16x16x32_bf16 v[44:47], v[116:119], a[240:243], v[44:47]
s_waitcnt lgkmcnt(10)
v_mfma_f32_16x16x32_bf16 v[48:51], v[120:123], a[48:51], v[48:51]
ds_read_b64_tr_b16 v[112:113], v201 offset:24576
v_mfma_f32_16x16x32_bf16 v[52:55], v[120:123], a[112:115], v[52:55]
v_mfma_f32_16x16x32_bf16 v[56:59], v[120:123], a[176:179], v[56:59]
ds_read_b64_tr_b16 v[114:115], v201 offset:26624
v_mfma_f32_16x16x32_bf16 v[60:63], v[120:123], a[240:243], v[60:63]
s_waitcnt lgkmcnt(10)
v_mfma_f32_16x16x32_bf16 v[64:67], v[124:127], a[48:51], v[64:67]
ds_read_b64_tr_b16 v[116:117], v203 offset:24576
v_mfma_f32_16x16x32_bf16 v[68:71], v[124:127], a[112:115], v[68:71]
v_mfma_f32_16x16x32_bf16 v[72:75], v[124:127], a[176:179], v[72:75]
ds_read_b64_tr_b16 v[118:119], v203 offset:26624
v_mfma_f32_16x16x32_bf16 v[76:79], v[124:127], a[240:243], v[76:79]
s_waitcnt vmcnt(28) lgkmcnt(10)
v_mfma_f32_16x16x32_bf16 v[16:19], v[128:131], a[52:55], v[16:19]
s_waitcnt vmcnt(27)
ds_read_b64_tr_b16 v[120:121], v205 offset:24576
v_mfma_f32_16x16x32_bf16 v[20:23], v[128:131], a[116:119], v[20:23]
s_waitcnt vmcnt(26)
v_mfma_f32_16x16x32_bf16 v[24:27], v[128:131], a[180:183], v[24:27]
s_waitcnt vmcnt(25)
ds_read_b64_tr_b16 v[122:123], v205 offset:26624
v_mfma_f32_16x16x32_bf16 v[28:31], v[128:131], a[244:247], v[28:31]
s_waitcnt lgkmcnt(10)
v_mfma_f32_16x16x32_bf16 v[32:35], v[132:135], a[52:55], v[32:35]
ds_read_b64_tr_b16 v[124:125], v207 offset:24576
v_mfma_f32_16x16x32_bf16 v[36:39], v[132:135], a[116:119], v[36:39]
v_mfma_f32_16x16x32_bf16 v[40:43], v[132:135], a[180:183], v[40:43]
ds_read_b64_tr_b16 v[126:127], v207 offset:26624
v_mfma_f32_16x16x32_bf16 v[44:47], v[132:135], a[244:247], v[44:47]
s_waitcnt lgkmcnt(10)
v_mfma_f32_16x16x32_bf16 v[48:51], v[136:139], a[52:55], v[48:51]
ds_read_b64_tr_b16 v[128:129], v201 offset:28672
v_mfma_f32_16x16x32_bf16 v[52:55], v[136:139], a[116:119], v[52:55]
v_mfma_f32_16x16x32_bf16 v[56:59], v[136:139], a[180:183], v[56:59]
ds_read_b64_tr_b16 v[130:131], v201 offset:30720
v_mfma_f32_16x16x32_bf16 v[60:63], v[136:139], a[244:247], v[60:63]
s_waitcnt lgkmcnt(10)
v_mfma_f32_16x16x32_bf16 v[64:67], v[140:143], a[52:55], v[64:67]
ds_read_b64_tr_b16 v[132:133], v203 offset:28672
v_mfma_f32_16x16x32_bf16 v[68:71], v[140:143], a[116:119], v[68:71]
v_mfma_f32_16x16x32_bf16 v[72:75], v[140:143], a[180:183], v[72:75]
ds_read_b64_tr_b16 v[134:135], v203 offset:30720
v_mfma_f32_16x16x32_bf16 v[76:79], v[140:143], a[244:247], v[76:79]
s_waitcnt vmcnt(24) lgkmcnt(10)
v_mfma_f32_16x16x32_bf16 v[16:19], v[112:115], a[56:59], v[16:19]
s_waitcnt vmcnt(23)
ds_read_b64_tr_b16 v[136:137], v205 offset:28672
v_mfma_f32_16x16x32_bf16 v[20:23], v[112:115], a[120:123], v[20:23]
s_waitcnt vmcnt(22)
v_mfma_f32_16x16x32_bf16 v[24:27], v[112:115], a[184:187], v[24:27]
s_waitcnt vmcnt(21)
ds_read_b64_tr_b16 v[138:139], v205 offset:30720
v_mfma_f32_16x16x32_bf16 v[28:31], v[112:115], a[248:251], v[28:31]
s_waitcnt lgkmcnt(10)
v_mfma_f32_16x16x32_bf16 v[32:35], v[116:119], a[56:59], v[32:35]
ds_read_b64_tr_b16 v[140:141], v207 offset:28672
v_mfma_f32_16x16x32_bf16 v[36:39], v[116:119], a[120:123], v[36:39]
v_mfma_f32_16x16x32_bf16 v[40:43], v[116:119], a[184:187], v[40:43]
ds_read_b64_tr_b16 v[142:143], v207 offset:30720
v_add_u32 v7, s29, v3
s_waitcnt vmcnt(1) lgkmcnt(0)
s_barrier
v_mfma_f32_16x16x32_bf16 v[44:47], v[116:119], a[248:251], v[44:47]
ds_read_b64_tr_b16 v[80:81], v7
v_mfma_f32_16x16x32_bf16 v[48:51], v[120:123], a[56:59], v[48:51]
ds_read_b64_tr_b16 v[82:83], v7 offset:2048
v_mfma_f32_16x16x32_bf16 v[52:55], v[120:123], a[120:123], v[52:55]
ds_read_b64_tr_b16 v[84:85], v7 offset:4096
v_mfma_f32_16x16x32_bf16 v[56:59], v[120:123], a[184:187], v[56:59]
ds_read_b64_tr_b16 v[86:87], v7 offset:6144
v_mfma_f32_16x16x32_bf16 v[60:63], v[120:123], a[248:251], v[60:63]
ds_read_b64_tr_b16 v[88:89], v7 offset:8192
v_mfma_f32_16x16x32_bf16 v[64:67], v[124:127], a[56:59], v[64:67]
ds_read_b64_tr_b16 v[90:91], v7 offset:10240
v_mfma_f32_16x16x32_bf16 v[68:71], v[124:127], a[120:123], v[68:71]
ds_read_b64_tr_b16 v[92:93], v7 offset:12288
v_mfma_f32_16x16x32_bf16 v[72:75], v[124:127], a[184:187], v[72:75]
v_mfma_f32_16x16x32_bf16 v[76:79], v[124:127], a[248:251], v[76:79]
ds_read_b64_tr_b16 v[94:95], v7 offset:14336
v_mfma_f32_16x16x32_bf16 v[16:19], v[128:131], a[60:63], v[16:19]
ds_read_b64_tr_b16 v[96:97], v7 offset:16384
v_mfma_f32_16x16x32_bf16 v[20:23], v[128:131], a[124:127], v[20:23]
ds_read_b64_tr_b16 v[98:99], v7 offset:18432
v_mfma_f32_16x16x32_bf16 v[24:27], v[128:131], a[188:191], v[24:27]
v_mfma_f32_16x16x32_bf16 v[28:31], v[128:131], a[252:255], v[28:31]
ds_read_b64_tr_b16 v[100:101], v7 offset:20480
v_mfma_f32_16x16x32_bf16 v[32:35], v[132:135], a[60:63], v[32:35]
ds_read_b64_tr_b16 v[102:103], v7 offset:22528
v_mfma_f32_16x16x32_bf16 v[36:39], v[132:135], a[124:127], v[36:39]
v_mfma_f32_16x16x32_bf16 v[40:43], v[132:135], a[188:191], v[40:43]
ds_read_b64_tr_b16 v[104:105], v7 offset:24576
v_mfma_f32_16x16x32_bf16 v[44:47], v[132:135], a[252:255], v[44:47]
ds_read_b64_tr_b16 v[106:107], v7 offset:26624
v_mfma_f32_16x16x32_bf16 v[48:51], v[136:139], a[60:63], v[48:51]
v_mfma_f32_16x16x32_bf16 v[52:55], v[136:139], a[124:127], v[52:55]
ds_read_b64_tr_b16 v[108:109], v7 offset:28672
v_mfma_f32_16x16x32_bf16 v[56:59], v[136:139], a[188:191], v[56:59]
ds_read_b64_tr_b16 v[110:111], v7 offset:30720
v_mfma_f32_16x16x32_bf16 v[60:63], v[136:139], a[252:255], v[60:63]
v_mfma_f32_16x16x32_bf16 v[64:67], v[140:143], a[60:63], v[64:67]
v_mfma_f32_16x16x32_bf16 v[68:71], v[140:143], a[124:127], v[68:71]
v_mfma_f32_16x16x32_bf16 v[72:75], v[140:143], a[188:191], v[72:75]
v_mfma_f32_16x16x32_bf16 v[76:79], v[140:143], a[252:255], v[76:79]
s_nop 7
v_cvt_pk_bf16_f32 v152, v16, v17
v_cvt_pk_bf16_f32 v153, v18, v19
v_cvt_pk_bf16_f32 v154, v32, v33
v_cvt_pk_bf16_f32 v155, v34, v35
buffer_store_dwordx4 v[152:155], v2, s[52:55], s33 offen sc1
v_cvt_pk_bf16_f32 v156, v20, v21
v_cvt_pk_bf16_f32 v157, v22, v23
v_cvt_pk_bf16_f32 v158, v36, v37
v_cvt_pk_bf16_f32 v159, v38, v39
s_add_u32 s35, s33, 4096
buffer_store_dwordx4 v[156:159], v2, s[52:55], s35 offen sc1
v_cvt_pk_bf16_f32 v160, v24, v25
v_cvt_pk_bf16_f32 v161, v26, v27
v_cvt_pk_bf16_f32 v162, v40, v41
v_cvt_pk_bf16_f32 v163, v42, v43
s_add_u32 s35, s33, 16384
buffer_store_dwordx4 v[160:163], v2, s[52:55], s35 offen sc1
v_cvt_pk_bf16_f32 v164, v28, v29
v_cvt_pk_bf16_f32 v165, v30, v31
v_cvt_pk_bf16_f32 v166, v44, v45
v_cvt_pk_bf16_f32 v167, v46, v47
s_add_u32 s35, s33, 20480
buffer_store_dwordx4 v[164:167], v2, s[52:55], s35 offen sc1
s_getpc_b64 s[90:91]
L_ct_apK:
s_add_u32 s90, s90, ap_kernel-L_ct_apK
s_addc_u32 s91, s91, 0
s_lshr_b32 s38, s2, 3
s_and_b32 s38, s38, 31
s_mul_i32 s38, s38, 2176
v_min_u32 v238, 16, v0
v_lshlrev_b32 v238, 7, v238
v_add_u32 v238, s38, v238
global_load_dword v240, v238, s[90:91]
s_mov_b32 s34, s33
s_mov_b32 s58, s54
s_add_u32 s21, s21, 1
s_bitcmp1_b32 s21, 0
s_cselect_b32 s37, 0, 1044480
s_add_u32 s33, s33, 2048
s_add_u32 s33, s33, s37
s_xor_b32 s27, s27, 65536
s_xor_b32 s29, s29, 65536
s_add_u32 s28, s27, 32768
s_sub_u32 s22, s22, 1
s_cmp_lg_u32 s22, 0
s_branch L_p1_loopK

L_p1_loopK:
s_waitcnt lgkmcnt(10)
v_mfma_f32_16x16x32_bf16 v[16:19], v[80:83], a[0:3], 0
s_add_u32 s32, s32, 128
v_add_u32 v8, s28, v3
v_mfma_f32_16x16x32_bf16 v[16:19], v[84:87], a[4:7], v[16:19]
s_xor_b32 s30, s30, 65536
ds_read_b64_tr_b16 v[112:113], v8
v_mfma_f32_16x16x32_bf16 v[16:19], v[88:91], a[8:11], v[16:19]
s_waitcnt lgkmcnt(5)
s_cmp_eq_u32 s22, 1
s_cselect_b32 s46, 0, s46
s_mov_b32 m0, s30
ds_read_b64_tr_b16 v[114:115], v8 offset:2048
v_mfma_f32_16x16x32_bf16 v[16:19], v[92:95], a[12:15], v[16:19]
s_mov_b32 s31, s32
ds_read_b64_tr_b16 v[116:117], v8 offset:4096
v_mfma_f32_16x16x32_bf16 v[16:19], v[96:99], a[16:19], v[16:19]
buffer_load_dwordx4 v9, s[44:47], s31 offen lds
v_mfma_f32_16x16x32_bf16 v[16:19], v[100:103], a[20:23], v[16:19]
s_waitcnt lgkmcnt(3)
ds_read_b64_tr_b16 v[118:119], v8 offset:6144
v_mfma_f32_16x16x32_bf16 v[16:19], v[104:107], a[24:27], v[16:19]
v_mfma_f32_16x16x32_bf16 v[16:19], v[108:111], a[28:31], v[16:19]
s_add_u32 m0, m0, 4096
ds_read_b64_tr_b16 v[120:121], v8 offset:8192
v_mfma_f32_16x16x32_bf16 v[20:23], v[80:83], a[64:67], 0
s_add_u32 s31, s31, 262144
v_mfma_f32_16x16x32_bf16 v[20:23], v[84:87], a[68:71], v[20:23]
ds_read_b64_tr_b16 v[122:123], v8 offset:10240
v_cvt_pk_bf16_f32 v152, v48, v49
v_mfma_f32_16x16x32_bf16 v[20:23], v[88:91], a[72:75], v[20:23]
buffer_load_dwordx4 v9, s[44:47], s31 offen lds
v_mfma_f32_16x16x32_bf16 v[20:23], v[92:95], a[76:79], v[20:23]
ds_read_b64_tr_b16 v[124:125], v8 offset:12288
v_mfma_f32_16x16x32_bf16 v[20:23], v[96:99], a[80:83], v[20:23]
v_cvt_pk_bf16_f32 v153, v50, v51
v_mfma_f32_16x16x32_bf16 v[20:23], v[100:103], a[84:87], v[20:23]
ds_read_b64_tr_b16 v[126:127], v8 offset:14336
v_mfma_f32_16x16x32_bf16 v[20:23], v[104:107], a[88:91], v[20:23]
v_mfma_f32_16x16x32_bf16 v[20:23], v[108:111], a[92:95], v[20:23]
s_add_u32 m0, m0, 4096
ds_read_b64_tr_b16 v[128:129], v8 offset:16384
v_mfma_f32_16x16x32_bf16 v[24:27], v[80:83], a[128:131], 0
s_add_u32 s31, s31, 262144
ds_read_b64_tr_b16 v[130:131], v8 offset:18432
v_mfma_f32_16x16x32_bf16 v[24:27], v[84:87], a[132:135], v[24:27]
v_mfma_f32_16x16x32_bf16 v[24:27], v[88:91], a[136:139], v[24:27]
ds_read_b64_tr_b16 v[132:133], v8 offset:20480
v_cvt_pk_bf16_f32 v154, v64, v65
v_mfma_f32_16x16x32_bf16 v[24:27], v[92:95], a[140:143], v[24:27]
buffer_load_dwordx4 v9, s[44:47], s31 offen lds
v_mfma_f32_16x16x32_bf16 v[24:27], v[96:99], a[144:147], v[24:27]
ds_read_b64_tr_b16 v[134:135], v8 offset:22528
v_mfma_f32_16x16x32_bf16 v[24:27], v[100:103], a[148:151], v[24:27]
v_mfma_f32_16x16x32_bf16 v[24:27], v[104:107], a[152:155], v[24:27]
ds_read_b64_tr_b16 v[136:137], v8 offset:24576
v_mfma_f32_16x16x32_bf16 v[24:27], v[108:111], a[156:159], v[24:27]
s_add_u32 m0, m0, 4096
v_mfma_f32_16x16x32_bf16 v[28:31], v[80:83], a[192:195], 0
s_add_u32 s31, s31, 262144
ds_read_b64_tr_b16 v[138:139], v8 offset:26624
v_cvt_pk_bf16_f32 v155, v66, v67
v_mfma_f32_16x16x32_bf16 v[28:31], v[84:87], a[196:199], v[28:31]
v_mfma_f32_16x16x32_bf16 v[28:31], v[88:91], a[200:203], v[28:31]
ds_read_b64_tr_b16 v[140:141], v8 offset:28672
v_mfma_f32_16x16x32_bf16 v[28:31], v[92:95], a[204:207], v[28:31]
buffer_load_dwordx4 v9, s[44:47], s31 offen lds
v_mfma_f32_16x16x32_bf16 v[28:31], v[96:99], a[208:211], v[28:31]
ds_read_b64_tr_b16 v[142:143], v8 offset:30720
v_mfma_f32_16x16x32_bf16 v[28:31], v[100:103], a[212:215], v[28:31]
v_mfma_f32_16x16x32_bf16 v[28:31], v[104:107], a[216:219], v[28:31]
buffer_store_dwordx4 v[152:155], v2, s[56:59], s34 offen offset:1024 sc1
v_add_u32 v7, s27, v4
v_mfma_f32_16x16x32_bf16 v[28:31], v[108:111], a[220:223], v[28:31]
s_waitcnt lgkmcnt(10)
s_add_u32 m0, m0, 4096
v_mfma_f32_16x16x32_bf16 v[16:19], v[112:115], a[32:35], v[16:19]
s_add_u32 s31, s31, 262144
ds_read_b64_tr_b16 v[80:81], v7
v_mfma_f32_16x16x32_bf16 v[16:19], v[116:119], a[36:39], v[16:19]
ds_read_b64_tr_b16 v[82:83], v7 offset:2048
v_mfma_f32_16x16x32_bf16 v[16:19], v[120:123], a[40:43], v[16:19]
s_waitcnt lgkmcnt(6)
buffer_load_dwordx4 v9, s[44:47], s31 offen lds
v_mfma_f32_16x16x32_bf16 v[16:19], v[124:127], a[44:47], v[16:19]
ds_read_b64_tr_b16 v[84:85], v7 offset:4096
v_cvt_pk_bf16_f32 v156, v52, v53
v_mfma_f32_16x16x32_bf16 v[16:19], v[128:131], a[48:51], v[16:19]
v_mfma_f32_16x16x32_bf16 v[16:19], v[132:135], a[52:55], v[16:19]
s_waitcnt lgkmcnt(3)
ds_read_b64_tr_b16 v[86:87], v7 offset:6144
v_mfma_f32_16x16x32_bf16 v[16:19], v[136:139], a[56:59], v[16:19]
v_mfma_f32_16x16x32_bf16 v[16:19], v[140:143], a[60:63], v[16:19]
s_add_u32 m0, m0, 4096
ds_read_b64_tr_b16 v[88:89], v7 offset:8192
v_mfma_f32_16x16x32_bf16 v[20:23], v[112:115], a[96:99], v[20:23]
s_add_u32 s31, s31, 262144
v_mfma_f32_16x16x32_bf16 v[20:23], v[116:119], a[100:103], v[20:23]
ds_read_b64_tr_b16 v[90:91], v7 offset:10240
v_cvt_pk_bf16_f32 v157, v54, v55
v_mfma_f32_16x16x32_bf16 v[20:23], v[120:123], a[104:107], v[20:23]
buffer_load_dwordx4 v9, s[44:47], s31 offen lds
v_mfma_f32_16x16x32_bf16 v[20:23], v[124:127], a[108:111], v[20:23]
ds_read_b64_tr_b16 v[92:93], v7 offset:12288
v_mfma_f32_16x16x32_bf16 v[20:23], v[128:131], a[112:115], v[20:23]
v_mfma_f32_16x16x32_bf16 v[20:23], v[132:135], a[116:119], v[20:23]
ds_read_b64_tr_b16 v[94:95], v7 offset:14336
v_mfma_f32_16x16x32_bf16 v[20:23], v[136:139], a[120:123], v[20:23]
s_add_u32 m0, m0, 4096
v_mfma_f32_16x16x32_bf16 v[20:23], v[140:143], a[124:127], v[20:23]
s_add_u32 s31, s31, 262144
ds_read_b64_tr_b16 v[96:97], v7 offset:16384
v_cvt_pk_bf16_f32 v158, v68, v69
v_mfma_f32_16x16x32_bf16 v[24:27], v[112:115], a[160:163], v[24:27]
ds_read_b64_tr_b16 v[98:99], v7 offset:18432
v_mfma_f32_16x16x32_bf16 v[24:27], v[116:119], a[164:167], v[24:27]
buffer_load_dwordx4 v9, s[44:47], s31 offen lds
v_mfma_f32_16x16x32_bf16 v[24:27], v[120:123], a[168:171], v[24:27]
ds_read_b64_tr_b16 v[100:101], v7 offset:20480
v_mfma_f32_16x16x32_bf16 v[24:27], v[124:127], a[172:175], v[24:27]
v_mfma_f32_16x16x32_bf16 v[24:27], v[128:131], a[176:179], v[24:27]
ds_read_b64_tr_b16 v[102:103], v7 offset:22528
v_mfma_f32_16x16x32_bf16 v[24:27], v[132:135], a[180:183], v[24:27]
v_cvt_pk_bf16_f32 v159, v70, v71
v_mfma_f32_16x16x32_bf16 v[24:27], v[136:139], a[184:187], v[24:27]
s_add_u32 m0, m0, 4096
ds_read_b64_tr_b16 v[104:105], v7 offset:24576
v_mfma_f32_16x16x32_bf16 v[24:27], v[140:143], a[188:191], v[24:27]
s_add_u32 s31, s31, 262144
v_mfma_f32_16x16x32_bf16 v[28:31], v[112:115], a[224:227], v[28:31]
ds_read_b64_tr_b16 v[106:107], v7 offset:26624
v_mfma_f32_16x16x32_bf16 v[28:31], v[116:119], a[228:231], v[28:31]
buffer_load_dwordx4 v9, s[44:47], s31 offen lds
v_mfma_f32_16x16x32_bf16 v[28:31], v[120:123], a[232:235], v[28:31]
ds_read_b64_tr_b16 v[108:109], v7 offset:28672
v_mfma_f32_16x16x32_bf16 v[28:31], v[124:127], a[236:239], v[28:31]
s_add_u32 s35, s34, 4096
buffer_store_dwordx4 v[156:159], v2, s[56:59], s35 offen offset:1024 sc1
v_mfma_f32_16x16x32_bf16 v[28:31], v[128:131], a[240:243], v[28:31]
ds_read_b64_tr_b16 v[110:111], v7 offset:30720
v_mfma_f32_16x16x32_bf16 v[28:31], v[132:135], a[244:247], v[28:31]
v_mfma_f32_16x16x32_bf16 v[28:31], v[136:139], a[248:251], v[28:31]
s_add_u32 m0, m0, 4096
v_add_u32 v8, s28, v4
v_mfma_f32_16x16x32_bf16 v[28:31], v[140:143], a[252:255], v[28:31]
s_waitcnt lgkmcnt(10)
s_add_u32 s31, s31, 262144
v_mfma_f32_16x16x32_bf16 v[32:35], v[80:83], a[0:3], 0
ds_read_b64_tr_b16 v[112:113], v8
v_cvt_pk_bf16_f32 v160, v56, v57
v_mfma_f32_16x16x32_bf16 v[32:35], v[84:87], a[4:7], v[32:35]
ds_read_b64_tr_b16 v[114:115], v8 offset:2048
v_mfma_f32_16x16x32_bf16 v[32:35], v[88:91], a[8:11], v[32:35]
s_waitcnt lgkmcnt(6)
buffer_load_dwordx4 v9, s[44:47], s31 offen lds
v_mfma_f32_16x16x32_bf16 v[32:35], v[92:95], a[12:15], v[32:35]
ds_read_b64_tr_b16 v[116:117], v8 offset:4096
v_mfma_f32_16x16x32_bf16 v[32:35], v[96:99], a[16:19], v[32:35]
v_mfma_f32_16x16x32_bf16 v[32:35], v[100:103], a[20:23], v[32:35]
s_waitcnt lgkmcnt(3)
ds_read_b64_tr_b16 v[118:119], v8 offset:6144
v_mfma_f32_16x16x32_bf16 v[32:35], v[104:107], a[24:27], v[32:35]
s_add_u32 m0, m0, 4096
v_cvt_pk_bf16_f32 v161, v58, v59
v_mfma_f32_16x16x32_bf16 v[32:35], v[108:111], a[28:31], v[32:35]
s_add_u32 s31, s31, 262144
ds_read_b64_tr_b16 v[120:121], v8 offset:8192
v_mfma_f32_16x16x32_bf16 v[36:39], v[80:83], a[64:67], 0
v_mfma_f32_16x16x32_bf16 v[36:39], v[84:87], a[68:71], v[36:39]
ds_read_b64_tr_b16 v[122:123], v8 offset:10240
v_mfma_f32_16x16x32_bf16 v[36:39], v[88:91], a[72:75], v[36:39]
buffer_load_dwordx4 v9, s[44:47], s31 offen lds
v_mfma_f32_16x16x32_bf16 v[36:39], v[92:95], a[76:79], v[36:39]
ds_read_b64_tr_b16 v[124:125], v8 offset:12288
v_mfma_f32_16x16x32_bf16 v[36:39], v[96:99], a[80:83], v[36:39]
v_cvt_pk_bf16_f32 v162, v72, v73
v_mfma_f32_16x16x32_bf16 v[36:39], v[100:103], a[84:87], v[36:39]
ds_read_b64_tr_b16 v[126:127], v8 offset:14336
v_mfma_f32_16x16x32_bf16 v[36:39], v[104:107], a[88:91], v[36:39]
s_add_u32 m0, m0, 4096
v_mfma_f32_16x16x32_bf16 v[36:39], v[108:111], a[92:95], v[36:39]
s_add_u32 s31, s31, 262144
ds_read_b64_tr_b16 v[128:129], v8 offset:16384
v_mfma_f32_16x16x32_bf16 v[40:43], v[80:83], a[128:131], 0
ds_read_b64_tr_b16 v[130:131], v8 offset:18432
v_mfma_f32_16x16x32_bf16 v[40:43], v[84:87], a[132:135], v[40:43]
buffer_load_dwordx4 v9, s[44:47], s31 offen lds
v_cvt_pk_bf16_f32 v163, v74, v75
v_mfma_f32_16x16x32_bf16 v[40:43], v[88:91], a[136:139], v[40:43]
ds_read_b64_tr_b16 v[132:133], v8 offset:20480
v_mfma_f32_16x16x32_bf16 v[40:43], v[92:95], a[140:143], v[40:43]
v_mfma_f32_16x16x32_bf16 v[40:43], v[96:99], a[144:147], v[40:43]
ds_read_b64_tr_b16 v[134:135], v8 offset:22528
v_mfma_f32_16x16x32_bf16 v[40:43], v[100:103], a[148:151], v[40:43]
s_add_u32 m0, m0, 4096
v_mfma_f32_16x16x32_bf16 v[40:43], v[104:107], a[152:155], v[40:43]
s_add_u32 s31, s31, 262144
ds_read_b64_tr_b16 v[136:137], v8 offset:24576
v_mfma_f32_16x16x32_bf16 v[40:43], v[108:111], a[156:159], v[40:43]
s_add_u32 s35, s34, 16384
buffer_store_dwordx4 v[160:163], v2, s[56:59], s35 offen offset:1024 sc1
v_mfma_f32_16x16x32_bf16 v[44:47], v[80:83], a[192:195], 0
ds_read_b64_tr_b16 v[138:139], v8 offset:26624
v_mfma_f32_16x16x32_bf16 v[44:47], v[84:87], a[196:199], v[44:47]
buffer_load_dwordx4 v9, s[44:47], s31 offen lds
v_mfma_f32_16x16x32_bf16 v[44:47], v[88:91], a[200:203], v[44:47]
ds_read_b64_tr_b16 v[140:141], v8 offset:28672
v_mfma_f32_16x16x32_bf16 v[44:47], v[92:95], a[204:207], v[44:47]
v_mfma_f32_16x16x32_bf16 v[44:47], v[96:99], a[208:211], v[44:47]
ds_read_b64_tr_b16 v[142:143], v8 offset:30720
v_mfma_f32_16x16x32_bf16 v[44:47], v[100:103], a[212:215], v[44:47]
s_add_u32 m0, m0, 4096
v_cvt_pk_bf16_f32 v164, v60, v61
v_mfma_f32_16x16x32_bf16 v[44:47], v[104:107], a[216:219], v[44:47]
s_add_u32 s31, s31, 262144
v_add_u32 v7, s27, v5
v_mfma_f32_16x16x32_bf16 v[44:47], v[108:111], a[220:223], v[44:47]
s_waitcnt lgkmcnt(10)
v_mfma_f32_16x16x32_bf16 v[32:35], v[112:115], a[32:35], v[32:35]
ds_read_b64_tr_b16 v[80:81], v7
v_mfma_f32_16x16x32_bf16 v[32:35], v[116:119], a[36:39], v[32:35]
ds_read_b64_tr_b16 v[82:83], v7 offset:2048
v_mfma_f32_16x16x32_bf16 v[32:35], v[120:123], a[40:43], v[32:35]
s_waitcnt lgkmcnt(6)
buffer_load_dwordx4 v9, s[44:47], s31 offen lds
v_mfma_f32_16x16x32_bf16 v[32:35], v[124:127], a[44:47], v[32:35]
ds_read_b64_tr_b16 v[84:85], v7 offset:4096
v_cvt_pk_bf16_f32 v165, v62, v63
v_mfma_f32_16x16x32_bf16 v[32:35], v[128:131], a[48:51], v[32:35]
v_mfma_f32_16x16x32_bf16 v[32:35], v[132:135], a[52:55], v[32:35]
s_waitcnt lgkmcnt(3)
s_add_u32 m0, m0, 4096
ds_read_b64_tr_b16 v[86:87], v7 offset:6144
v_mfma_f32_16x16x32_bf16 v[32:35], v[136:139], a[56:59], v[32:35]
s_add_u32 s31, s31, 262144
v_mfma_f32_16x16x32_bf16 v[32:35], v[140:143], a[60:63], v[32:35]
ds_read_b64_tr_b16 v[88:89], v7 offset:8192
v_mfma_f32_16x16x32_bf16 v[36:39], v[112:115], a[96:99], v[36:39]
buffer_load_dwordx4 v9, s[44:47], s31 offen lds
v_cvt_pk_bf16_f32 v166, v76, v77
v_mfma_f32_16x16x32_bf16 v[36:39], v[116:119], a[100:103], v[36:39]
ds_read_b64_tr_b16 v[90:91], v7 offset:10240
v_mfma_f32_16x16x32_bf16 v[36:39], v[120:123], a[104:107], v[36:39]
v_mfma_f32_16x16x32_bf16 v[36:39], v[124:127], a[108:111], v[36:39]
ds_read_b64_tr_b16 v[92:93], v7 offset:12288
v_mfma_f32_16x16x32_bf16 v[36:39], v[128:131], a[112:115], v[36:39]
v_mfma_f32_16x16x32_bf16 v[36:39], v[132:135], a[116:119], v[36:39]
s_add_u32 m0, m0, 4096
ds_read_b64_tr_b16 v[94:95], v7 offset:14336
v_mfma_f32_16x16x32_bf16 v[36:39], v[136:139], a[120:123], v[36:39]
s_add_u32 s31, s31, 262144
v_cvt_pk_bf16_f32 v167, v78, v79
v_mfma_f32_16x16x32_bf16 v[36:39], v[140:143], a[124:127], v[36:39]
ds_read_b64_tr_b16 v[96:97], v7 offset:16384
v_mfma_f32_16x16x32_bf16 v[40:43], v[112:115], a[160:163], v[40:43]
ds_read_b64_tr_b16 v[98:99], v7 offset:18432
v_mfma_f32_16x16x32_bf16 v[40:43], v[116:119], a[164:167], v[40:43]
buffer_load_dwordx4 v9, s[44:47], s31 offen lds
v_mfma_f32_16x16x32_bf16 v[40:43], v[120:123], a[168:171], v[40:43]
ds_read_b64_tr_b16 v[100:101], v7 offset:20480
v_mfma_f32_16x16x32_bf16 v[40:43], v[124:127], a[172:175], v[40:43]
v_mfma_f32_16x16x32_bf16 v[40:43], v[128:131], a[176:179], v[40:43]
ds_read_b64_tr_b16 v[102:103], v7 offset:22528
v_mfma_f32_16x16x32_bf16 v[40:43], v[132:135], a[180:183], v[40:43]
s_add_u32 m0, m0, 4096
s_add_u32 s35, s34, 20480
buffer_store_dwordx4 v[164:167], v2, s[56:59], s35 offen offset:1024 sc1
v_mfma_f32_16x16x32_bf16 v[40:43], v[136:139], a[184:187], v[40:43]
s_add_u32 s31, s31, 262144
ds_read_b64_tr_b16 v[104:105], v7 offset:24576
v_mfma_f32_16x16x32_bf16 v[40:43], v[140:143], a[188:191], v[40:43]
v_mfma_f32_16x16x32_bf16 v[44:47], v[112:115], a[224:227], v[44:47]
ds_read_b64_tr_b16 v[106:107], v7 offset:26624
v_mfma_f32_16x16x32_bf16 v[44:47], v[116:119], a[228:231], v[44:47]
buffer_load_dwordx4 v9, s[44:47], s31 offen lds
v_mfma_f32_16x16x32_bf16 v[44:47], v[120:123], a[232:235], v[44:47]
ds_read_b64_tr_b16 v[108:109], v7 offset:28672
v_mfma_f32_16x16x32_bf16 v[44:47], v[124:127], a[236:239], v[44:47]
v_mfma_f32_16x16x32_bf16 v[44:47], v[128:131], a[240:243], v[44:47]
ds_read_b64_tr_b16 v[110:111], v7 offset:30720
v_mfma_f32_16x16x32_bf16 v[44:47], v[132:135], a[244:247], v[44:47]
v_mfma_f32_16x16x32_bf16 v[44:47], v[136:139], a[248:251], v[44:47]
v_add_u32 v8, s28, v5
v_mfma_f32_16x16x32_bf16 v[44:47], v[140:143], a[252:255], v[44:47]
s_waitcnt lgkmcnt(10)
v_mfma_f32_16x16x32_bf16 v[48:51], v[80:83], a[0:3], 0
ds_read_b64_tr_b16 v[112:113], v8
v_mfma_f32_16x16x32_bf16 v[48:51], v[84:87], a[4:7], v[48:51]
ds_read_b64_tr_b16 v[114:115], v8 offset:2048
v_mfma_f32_16x16x32_bf16 v[48:51], v[88:91], a[8:11], v[48:51]
s_waitcnt lgkmcnt(6)
v_mfma_f32_16x16x32_bf16 v[48:51], v[92:95], a[12:15], v[48:51]
ds_read_b64_tr_b16 v[116:117], v8 offset:4096
v_mfma_f32_16x16x32_bf16 v[48:51], v[96:99], a[16:19], v[48:51]
v_mfma_f32_16x16x32_bf16 v[48:51], v[100:103], a[20:23], v[48:51]
s_waitcnt lgkmcnt(3)
ds_read_b64_tr_b16 v[118:119], v8 offset:6144
v_mfma_f32_16x16x32_bf16 v[48:51], v[104:107], a[24:27], v[48:51]
v_mfma_f32_16x16x32_bf16 v[48:51], v[108:111], a[28:31], v[48:51]
ds_read_b64_tr_b16 v[120:121], v8 offset:8192
v_mfma_f32_16x16x32_bf16 v[52:55], v[80:83], a[64:67], 0
v_mfma_f32_16x16x32_bf16 v[52:55], v[84:87], a[68:71], v[52:55]
ds_read_b64_tr_b16 v[122:123], v8 offset:10240
v_cvt_pk_bf16_f32 v152, v16, v17
v_mfma_f32_16x16x32_bf16 v[52:55], v[88:91], a[72:75], v[52:55]
v_mfma_f32_16x16x32_bf16 v[52:55], v[92:95], a[76:79], v[52:55]
ds_read_b64_tr_b16 v[124:125], v8 offset:12288
v_mfma_f32_16x16x32_bf16 v[52:55], v[96:99], a[80:83], v[52:55]
v_cvt_pk_bf16_f32 v153, v18, v19
v_mfma_f32_16x16x32_bf16 v[52:55], v[100:103], a[84:87], v[52:55]
ds_read_b64_tr_b16 v[126:127], v8 offset:14336
v_mfma_f32_16x16x32_bf16 v[52:55], v[104:107], a[88:91], v[52:55]
v_mfma_f32_16x16x32_bf16 v[52:55], v[108:111], a[92:95], v[52:55]
s_cmp_gt_u32 s22, 4
s_cselect_b32 s74, s77, 0
s_bitcmp1_b32 s78, 0
s_cselect_b32 s74, 0, s74
ds_read_b64_tr_b16 v[128:129], v8 offset:16384
v_mfma_f32_16x16x32_bf16 v[56:59], v[80:83], a[128:131], 0
ds_read_b64_tr_b16 v[130:131], v8 offset:18432
v_mfma_f32_16x16x32_bf16 v[56:59], v[84:87], a[132:135], v[56:59]
s_waitcnt vmcnt(24)
buffer_load_dword v232, v216, s[72:75], s76 offen
s_add_u32 s76, s76, 128
v_mfma_f32_16x16x32_bf16 v[56:59], v[88:91], a[136:139], v[56:59]
ds_read_b64_tr_b16 v[132:133], v8 offset:20480
v_cvt_pk_bf16_f32 v154, v32, v33
v_mfma_f32_16x16x32_bf16 v[56:59], v[92:95], a[140:143], v[56:59]
s_add_u32 s78, s78, 1
v_mfma_f32_16x16x32_bf16 v[56:59], v[96:99], a[144:147], v[56:59]
ds_read_b64_tr_b16 v[134:135], v8 offset:22528
v_mfma_f32_16x16x32_bf16 v[56:59], v[100:103], a[148:151], v[56:59]
v_mfma_f32_16x16x32_bf16 v[56:59], v[104:107], a[152:155], v[56:59]
ds_read_b64_tr_b16 v[136:137], v8 offset:24576
v_mfma_f32_16x16x32_bf16 v[56:59], v[108:111], a[156:159], v[56:59]
v_mfma_f32_16x16x32_bf16 v[60:63], v[80:83], a[192:195], 0
ds_read_b64_tr_b16 v[138:139], v8 offset:26624
v_cvt_pk_bf16_f32 v155, v34, v35
v_mfma_f32_16x16x32_bf16 v[60:63], v[84:87], a[196:199], v[60:63]
v_mfma_f32_16x16x32_bf16 v[60:63], v[88:91], a[200:203], v[60:63]
ds_read_b64_tr_b16 v[140:141], v8 offset:28672
v_mfma_f32_16x16x32_bf16 v[60:63], v[92:95], a[204:207], v[60:63]
v_mfma_f32_16x16x32_bf16 v[60:63], v[96:99], a[208:211], v[60:63]
ds_read_b64_tr_b16 v[142:143], v8 offset:30720
v_mfma_f32_16x16x32_bf16 v[60:63], v[100:103], a[212:215], v[60:63]
v_mfma_f32_16x16x32_bf16 v[60:63], v[104:107], a[216:219], v[60:63]
buffer_store_dwordx4 v[152:155], v2, s[52:55], s33 offen sc1
v_add_u32 v7, s27, v6
v_mfma_f32_16x16x32_bf16 v[60:63], v[108:111], a[220:223], v[60:63]
s_waitcnt lgkmcnt(10)
v_mfma_f32_16x16x32_bf16 v[48:51], v[112:115], a[32:35], v[48:51]
ds_read_b64_tr_b16 v[80:81], v7
v_mfma_f32_16x16x32_bf16 v[48:51], v[116:119], a[36:39], v[48:51]
ds_read_b64_tr_b16 v[82:83], v7 offset:2048
v_mfma_f32_16x16x32_bf16 v[48:51], v[120:123], a[40:43], v[48:51]
s_waitcnt lgkmcnt(6)
v_mfma_f32_16x16x32_bf16 v[48:51], v[124:127], a[44:47], v[48:51]
ds_read_b64_tr_b16 v[84:85], v7 offset:4096
v_cvt_pk_bf16_f32 v156, v20, v21
v_mfma_f32_16x16x32_bf16 v[48:51], v[128:131], a[48:51], v[48:51]
v_mfma_f32_16x16x32_bf16 v[48:51], v[132:135], a[52:55], v[48:51]
s_waitcnt lgkmcnt(3)
ds_read_b64_tr_b16 v[86:87], v7 offset:6144
v_mfma_f32_16x16x32_bf16 v[48:51], v[136:139], a[56:59], v[48:51]
v_mfma_f32_16x16x32_bf16 v[48:51], v[140:143], a[60:63], v[48:51]
ds_read_b64_tr_b16 v[88:89], v7 offset:8192
v_mfma_f32_16x16x32_bf16 v[52:55], v[112:115], a[96:99], v[52:55]
v_mfma_f32_16x16x32_bf16 v[52:55], v[116:119], a[100:103], v[52:55]
ds_read_b64_tr_b16 v[90:91], v7 offset:10240
v_cvt_pk_bf16_f32 v157, v22, v23
v_mfma_f32_16x16x32_bf16 v[52:55], v[120:123], a[104:107], v[52:55]
v_mfma_f32_16x16x32_bf16 v[52:55], v[124:127], a[108:111], v[52:55]
ds_read_b64_tr_b16 v[92:93], v7 offset:12288
v_mfma_f32_16x16x32_bf16 v[52:55], v[128:131], a[112:115], v[52:55]
v_mfma_f32_16x16x32_bf16 v[52:55], v[132:135], a[116:119], v[52:55]
ds_read_b64_tr_b16 v[94:95], v7 offset:14336
v_mfma_f32_16x16x32_bf16 v[52:55], v[136:139], a[120:123], v[52:55]
v_mfma_f32_16x16x32_bf16 v[52:55], v[140:143], a[124:127], v[52:55]
ds_read_b64_tr_b16 v[96:97], v7 offset:16384
v_cvt_pk_bf16_f32 v158, v36, v37
v_mfma_f32_16x16x32_bf16 v[56:59], v[112:115], a[160:163], v[56:59]
ds_read_b64_tr_b16 v[98:99], v7 offset:18432
v_mfma_f32_16x16x32_bf16 v[56:59], v[116:119], a[164:167], v[56:59]
v_mfma_f32_16x16x32_bf16 v[56:59], v[120:123], a[168:171], v[56:59]
ds_read_b64_tr_b16 v[100:101], v7 offset:20480
v_mfma_f32_16x16x32_bf16 v[56:59], v[124:127], a[172:175], v[56:59]
v_mfma_f32_16x16x32_bf16 v[56:59], v[128:131], a[176:179], v[56:59]
ds_read_b64_tr_b16 v[102:103], v7 offset:22528
v_mfma_f32_16x16x32_bf16 v[56:59], v[132:135], a[180:183], v[56:59]
v_cvt_pk_bf16_f32 v159, v38, v39
v_mfma_f32_16x16x32_bf16 v[56:59], v[136:139], a[184:187], v[56:59]
ds_read_b64_tr_b16 v[104:105], v7 offset:24576
v_mfma_f32_16x16x32_bf16 v[56:59], v[140:143], a[188:191], v[56:59]
v_mfma_f32_16x16x32_bf16 v[60:63], v[112:115], a[224:227], v[60:63]
ds_read_b64_tr_b16 v[106:107], v7 offset:26624
v_mfma_f32_16x16x32_bf16 v[60:63], v[116:119], a[228:231], v[60:63]
v_mfma_f32_16x16x32_bf16 v[60:63], v[120:123], a[232:235], v[60:63]
ds_read_b64_tr_b16 v[108:109], v7 offset:28672
v_mfma_f32_16x16x32_bf16 v[60:63], v[124:127], a[236:239], v[60:63]
s_add_u32 s35, s33, 4096
buffer_store_dwordx4 v[156:159], v2, s[52:55], s35 offen sc1
v_mfma_f32_16x16x32_bf16 v[60:63], v[128:131], a[240:243], v[60:63]
ds_read_b64_tr_b16 v[110:111], v7 offset:30720
v_mfma_f32_16x16x32_bf16 v[60:63], v[132:135], a[244:247], v[60:63]
v_mfma_f32_16x16x32_bf16 v[60:63], v[136:139], a[248:251], v[60:63]
v_add_u32 v8, s28, v6
v_mfma_f32_16x16x32_bf16 v[60:63], v[140:143], a[252:255], v[60:63]
s_waitcnt lgkmcnt(10)
v_mfma_f32_16x16x32_bf16 v[64:67], v[80:83], a[0:3], 0
ds_read_b64_tr_b16 v[112:113], v8
v_cvt_pk_bf16_f32 v160, v24, v25
v_mfma_f32_16x16x32_bf16 v[64:67], v[84:87], a[4:7], v[64:67]
ds_read_b64_tr_b16 v[114:115], v8 offset:2048
v_mfma_f32_16x16x32_bf16 v[64:67], v[88:91], a[8:11], v[64:67]
s_waitcnt lgkmcnt(6)
v_mfma_f32_16x16x32_bf16 v[64:67], v[92:95], a[12:15], v[64:67]
ds_read_b64_tr_b16 v[116:117], v8 offset:4096
v_mfma_f32_16x16x32_bf16 v[64:67], v[96:99], a[16:19], v[64:67]
v_mfma_f32_16x16x32_bf16 v[64:67], v[100:103], a[20:23], v[64:67]
s_waitcnt lgkmcnt(3)
ds_read_b64_tr_b16 v[118:119], v8 offset:6144
v_mfma_f32_16x16x32_bf16 v[64:67], v[104:107], a[24:27], v[64:67]
v_cvt_pk_bf16_f32 v161, v26, v27
v_mfma_f32_16x16x32_bf16 v[64:67], v[108:111], a[28:31], v[64:67]
ds_read_b64_tr_b16 v[120:121], v8 offset:8192
v_mfma_f32_16x16x32_bf16 v[68:71], v[80:83], a[64:67], 0
v_mfma_f32_16x16x32_bf16 v[68:71], v[84:87], a[68:71], v[68:71]
ds_read_b64_tr_b16 v[122:123], v8 offset:10240
v_mfma_f32_16x16x32_bf16 v[68:71], v[88:91], a[72:75], v[68:71]
v_mfma_f32_16x16x32_bf16 v[68:71], v[92:95], a[76:79], v[68:71]
ds_read_b64_tr_b16 v[124:125], v8 offset:12288
v_mfma_f32_16x16x32_bf16 v[68:71], v[96:99], a[80:83], v[68:71]
v_cvt_pk_bf16_f32 v162, v40, v41
v_mfma_f32_16x16x32_bf16 v[68:71], v[100:103], a[84:87], v[68:71]
ds_read_b64_tr_b16 v[126:127], v8 offset:14336
v_mfma_f32_16x16x32_bf16 v[68:71], v[104:107], a[88:91], v[68:71]
v_mfma_f32_16x16x32_bf16 v[68:71], v[108:111], a[92:95], v[68:71]
ds_read_b64_tr_b16 v[128:129], v8 offset:16384
v_mfma_f32_16x16x32_bf16 v[72:75], v[80:83], a[128:131], 0
ds_read_b64_tr_b16 v[130:131], v8 offset:18432
v_mfma_f32_16x16x32_bf16 v[72:75], v[84:87], a[132:135], v[72:75]
v_cvt_pk_bf16_f32 v163, v42, v43
v_mfma_f32_16x16x32_bf16 v[72:75], v[88:91], a[136:139], v[72:75]
ds_read_b64_tr_b16 v[132:133], v8 offset:20480
v_mfma_f32_16x16x32_bf16 v[72:75], v[92:95], a[140:143], v[72:75]
v_mfma_f32_16x16x32_bf16 v[72:75], v[96:99], a[144:147], v[72:75]
ds_read_b64_tr_b16 v[134:135], v8 offset:22528
v_mfma_f32_16x16x32_bf16 v[72:75], v[100:103], a[148:151], v[72:75]
v_mfma_f32_16x16x32_bf16 v[72:75], v[104:107], a[152:155], v[72:75]
ds_read_b64_tr_b16 v[136:137], v8 offset:24576
v_mfma_f32_16x16x32_bf16 v[72:75], v[108:111], a[156:159], v[72:75]
s_add_u32 s35, s33, 16384
buffer_store_dwordx4 v[160:163], v2, s[52:55], s35 offen sc1
v_mfma_f32_16x16x32_bf16 v[76:79], v[80:83], a[192:195], 0
ds_read_b64_tr_b16 v[138:139], v8 offset:26624
v_mfma_f32_16x16x32_bf16 v[76:79], v[84:87], a[196:199], v[76:79]
v_mfma_f32_16x16x32_bf16 v[76:79], v[88:91], a[200:203], v[76:79]
ds_read_b64_tr_b16 v[140:141], v8 offset:28672
v_mfma_f32_16x16x32_bf16 v[76:79], v[92:95], a[204:207], v[76:79]
v_mfma_f32_16x16x32_bf16 v[76:79], v[96:99], a[208:211], v[76:79]
ds_read_b64_tr_b16 v[142:143], v8 offset:30720
v_mfma_f32_16x16x32_bf16 v[76:79], v[100:103], a[212:215], v[76:79]
v_cvt_pk_bf16_f32 v164, v28, v29
v_mfma_f32_16x16x32_bf16 v[76:79], v[104:107], a[216:219], v[76:79]
v_mfma_f32_16x16x32_bf16 v[76:79], v[108:111], a[220:223], v[76:79]
s_waitcnt lgkmcnt(10)
v_mfma_f32_16x16x32_bf16 v[64:67], v[112:115], a[32:35], v[64:67]
v_mfma_f32_16x16x32_bf16 v[64:67], v[116:119], a[36:39], v[64:67]
v_mfma_f32_16x16x32_bf16 v[64:67], v[120:123], a[40:43], v[64:67]
s_waitcnt lgkmcnt(4)
v_mfma_f32_16x16x32_bf16 v[64:67], v[124:127], a[44:47], v[64:67]
v_cvt_pk_bf16_f32 v165, v30, v31
v_mfma_f32_16x16x32_bf16 v[64:67], v[128:131], a[48:51], v[64:67]
v_mfma_f32_16x16x32_bf16 v[64:67], v[132:135], a[52:55], v[64:67]
s_waitcnt lgkmcnt(0)
v_mfma_f32_16x16x32_bf16 v[64:67], v[136:139], a[56:59], v[64:67]
v_mfma_f32_16x16x32_bf16 v[64:67], v[140:143], a[60:63], v[64:67]
v_add_u32 v7, s29, v3
v_mfma_f32_16x16x32_bf16 v[68:71], v[112:115], a[96:99], v[68:71]
s_waitcnt vmcnt(4)
s_barrier
v_cvt_pk_bf16_f32 v166, v44, v45
v_mfma_f32_16x16x32_bf16 v[68:71], v[116:119], a[100:103], v[68:71]
ds_read_b64_tr_b16 v[80:81], v7
v_mfma_f32_16x16x32_bf16 v[68:71], v[120:123], a[104:107], v[68:71]
s_xor_b32 s27, s27, 65536
ds_read_b64_tr_b16 v[82:83], v7 offset:2048
v_mfma_f32_16x16x32_bf16 v[68:71], v[124:127], a[108:111], v[68:71]
ds_read_b64_tr_b16 v[84:85], v7 offset:4096
v_mfma_f32_16x16x32_bf16 v[68:71], v[128:131], a[112:115], v[68:71]
s_xor_b32 s29, s29, 65536
ds_read_b64_tr_b16 v[86:87], v7 offset:6144
v_mfma_f32_16x16x32_bf16 v[68:71], v[132:135], a[116:119], v[68:71]
ds_read_b64_tr_b16 v[88:89], v7 offset:8192
v_mfma_f32_16x16x32_bf16 v[68:71], v[136:139], a[120:123], v[68:71]
s_add_u32 s28, s27, 32768
ds_read_b64_tr_b16 v[90:91], v7 offset:10240
v_cvt_pk_bf16_f32 v167, v46, v47
v_mfma_f32_16x16x32_bf16 v[68:71], v[140:143], a[124:127], v[68:71]
ds_read_b64_tr_b16 v[92:93], v7 offset:12288
v_mfma_f32_16x16x32_bf16 v[72:75], v[112:115], a[160:163], v[72:75]
s_sub_u32 s22, s22, 1
ds_read_b64_tr_b16 v[94:95], v7 offset:14336
v_mfma_f32_16x16x32_bf16 v[72:75], v[116:119], a[164:167], v[72:75]
v_mfma_f32_16x16x32_bf16 v[72:75], v[120:123], a[168:171], v[72:75]
s_add_u32 s21, s21, 1
s_bitcmp1_b32 s21, 0
s_cselect_b32 s37, 0, 1044480
ds_read_b64_tr_b16 v[96:97], v7 offset:16384
v_mfma_f32_16x16x32_bf16 v[72:75], v[124:127], a[172:175], v[72:75]
ds_read_b64_tr_b16 v[98:99], v7 offset:18432
v_mfma_f32_16x16x32_bf16 v[72:75], v[128:131], a[176:179], v[72:75]
ds_read_b64_tr_b16 v[100:101], v7 offset:20480
v_mfma_f32_16x16x32_bf16 v[72:75], v[132:135], a[180:183], v[72:75]
ds_read_b64_tr_b16 v[102:103], v7 offset:22528
v_mfma_f32_16x16x32_bf16 v[72:75], v[136:139], a[184:187], v[72:75]
ds_read_b64_tr_b16 v[104:105], v7 offset:24576
v_mfma_f32_16x16x32_bf16 v[72:75], v[140:143], a[188:191], v[72:75]
ds_read_b64_tr_b16 v[106:107], v7 offset:26624
v_mfma_f32_16x16x32_bf16 v[76:79], v[112:115], a[224:227], v[76:79]
ds_read_b64_tr_b16 v[108:109], v7 offset:28672
v_mfma_f32_16x16x32_bf16 v[76:79], v[116:119], a[228:231], v[76:79]
ds_read_b64_tr_b16 v[110:111], v7 offset:30720
v_mfma_f32_16x16x32_bf16 v[76:79], v[120:123], a[232:235], v[76:79]
s_add_u32 s35, s33, 20480
buffer_store_dwordx4 v[164:167], v2, s[52:55], s35 offen sc1
v_mfma_f32_16x16x32_bf16 v[76:79], v[124:127], a[236:239], v[76:79]
v_mfma_f32_16x16x32_bf16 v[76:79], v[128:131], a[240:243], v[76:79]
v_mfma_f32_16x16x32_bf16 v[76:79], v[132:135], a[244:247], v[76:79]
v_mfma_f32_16x16x32_bf16 v[76:79], v[136:139], a[248:251], v[76:79]
v_mfma_f32_16x16x32_bf16 v[76:79], v[140:143], a[252:255], v[76:79]
s_mov_b32 s34, s33
s_mov_b32 s58, s54
s_add_u32 s33, s33, 2048
s_add_u32 s33, s33, s37
s_cmp_lg_u32 s22, 0
s_cbranch_scc1 L_p1_loopK
s_nop 7
v_cvt_pk_bf16_f32 v152, v48, v49
v_cvt_pk_bf16_f32 v153, v50, v51
v_cvt_pk_bf16_f32 v154, v64, v65
v_cvt_pk_bf16_f32 v155, v66, v67
buffer_store_dwordx4 v[152:155], v2, s[56:59], s34 offen offset:1024 sc1
v_cvt_pk_bf16_f32 v156, v52, v53
v_cvt_pk_bf16_f32 v157, v54, v55
v_cvt_pk_bf16_f32 v158, v68, v69
v_cvt_pk_bf16_f32 v159, v70, v71
s_add_u32 s35, s34, 4096
buffer_store_dwordx4 v[156:159], v2, s[56:59], s35 offen offset:1024 sc1
v_cvt_pk_bf16_f32 v160, v56, v57
v_cvt_pk_bf16_f32 v161, v58, v59
v_cvt_pk_bf16_f32 v162, v72, v73
v_cvt_pk_bf16_f32 v163, v74, v75
s_add_u32 s35, s34, 16384
buffer_store_dwordx4 v[160:163], v2, s[56:59], s35 offen offset:1024 sc1
v_cvt_pk_bf16_f32 v164, v60, v61
v_cvt_pk_bf16_f32 v165, v62, v63
v_cvt_pk_bf16_f32 v166, v76, v77
v_cvt_pk_bf16_f32 v167, v78, v79
s_add_u32 s35, s34, 20480
buffer_store_dwordx4 v[164:167], v2, s[56:59], s35 offen offset:1024 sc1
s_cmp_eq_u32 s23, 0
s_cbranch_scc1 L_p1_fin
s_mov_b32 s25, 0
s_mov_b32 s22, 4
s_mov_b32 s23, 0
s_mov_b32 s21, 60
s_waitcnt vmcnt(0) lgkmcnt(0)
s_barrier
s_branch L_p1_segV
L_p1_segV:
s_load_dwordx2 s[64:65], s[0:1], 32
s_load_dwordx2 s[68:69], s[0:1], 96
v_and_b32 v10, 63, v0
v_lshlrev_b32 v2, 4, v10
v_lshrrev_b32 v11, 3, v10
v_mul_u32_u24 v11, 8192, v11
v_lshrrev_b32 v12, 4, v10
v_lshlrev_b32 v12, 1, v12
v_and_b32 v13, 7, v10
v_xor_b32 v12, v12, v13
v_lshl_add_u32 v9, v12, 4, v11
v_lshrrev_b32 v11, 2, v10
v_and_b32 v12, 3, v10
v_lshlrev_b32 v12, 3, v12
v_lshl_add_u32 v12, v11, 7, v12
v_lshrrev_b32 v13, 1, v11
v_and_b32 v13, 3, v13
v_xor_b32 v14, 0, v13
v_lshl_add_u32 v3, v14, 5, v12
v_xor_b32 v14, 1, v13
v_lshl_add_u32 v4, v14, 5, v12
v_xor_b32 v14, 2, v13
v_lshl_add_u32 v5, v14, 5, v12
v_xor_b32 v14, 3, v13
v_lshl_add_u32 v6, v14, 5, v12
s_waitcnt lgkmcnt(0)
s_mov_b32 s44, s64
s_mov_b32 s45, s65
s_mov_b32 s46, 0x400000
s_mov_b32 s47, 0x20000
s_add_u32 s52, s68, 0x1800000
s_addc_u32 s53, s69, 0
s_mov_b32 s54, 0x2000000
s_mov_b32 s55, 0x20000
s_add_u32 s56, s68, 0x1800000
s_addc_u32 s57, s69, 0
s_mov_b32 s58, 0x0
s_mov_b32 s59, 0x20000
s_mul_i32 s32, s21, 128
s_mul_i32 s35, s20, 65536
s_add_u32 s32, s32, s35
s_lshl_b32 s30, s20, 10
s_mov_b32 s27, 0
s_mov_b32 s28, 32768
s_mov_b32 s29, 65536
s_lshr_b32 s35, s21, 1
s_lshl_b32 s33, s35, 20
s_lshr_b32 s35, s26, 1
s_lshl_b32 s35, s35, 14
s_add_u32 s33, s33, s35
s_and_b32 s35, s21, 1
s_lshl_b32 s35, s35, 12
s_add_u32 s35, s35, 8192
s_add_u32 s33, s33, s35
s_mov_b32 s34, s33
s_lshr_b32 s35, s26, 4
s_mul_i32 s35, s35, 524288
s_add_u32 s36, s21, 4
s_mul_i32 s36, s36, 128
s_add_u32 s76, s35, s36
v_lshrrev_b32 v10, 1, v0
v_and_b32 v11, 1, v0
v_mul_u32_u24 v216, 8192, v10
v_lshl_add_u32 v216, v11, 7, v216
s_mov_b32 s72, s44
s_mov_b32 s73, s45
s_mov_b32 s74, s46
s_mov_b32 s75, s47
v_mov_b32 v12, 0x7fffffff
v_cmp_gt_u32 vcc, 64, v10
s_nop 1
v_cndmask_b32 v216, v12, v216, vcc
s_mov_b32 s77, s74
s_cmp_eq_u32 s25, 0
s_cbranch_scc1 L_p1_oldV
s_getpc_b64 s[90:91]
L_ct_p1V:
s_add_u32 s90, s90, L_p1_tkjV-L_ct_p1V
s_addc_u32 s91, s91, 0
s_lshr_b32 s35, s2, 3
s_and_b32 s35, s35, 3
s_mul_i32 s35, s35, 8192
v_min_u32 v238, 63, v0
v_lshlrev_b32 v238, 7, v238
v_add_u32 v238, s35, v238
global_load_dword v239, v238, s[90:91]
s_branch L_p1_tkjV
L_p1_taskV:
v_and_b32 v97, 63, v0
v_lshrrev_b32 v99, 4, v97
v_and_b32 v100, 15, v97
s_lshr_b32 s80, s26, 4
s_lshl_b32 s80, s80, 8
s_lshl_b32 s81, s42, 3
s_add_u32 s80, s80, s81
s_and_b32 s81, s20, 1
s_lshl_b32 s81, s81, 2
s_add_u32 s80, s80, s81
v_add_u32 v101, s80, v99
v_lshrrev_b32 v102, 3, v100
v_lshlrev_b32 v102, 10, v102
v_and_b32 v103, 3, v100
v_lshlrev_b32 v103, 4, v103
v_and_b32 v104, 15, v101
v_add_u32 v103, v103, v104
v_lshlrev_b32 v103, 4, v103
v_add_u32 v102, v102, v103
v_lshrrev_b32 v103, 2, v100
v_and_b32 v103, 1, v103
v_lshlrev_b32 v103, 3, v103
v_add_u32 v102, v102, v103
v_lshrrev_b32 v105, 4, v101
s_cmp_ge_u32 s20, 2
s_cbranch_scc1 L_p1_cklV
s_mov_b32 s8, s4
s_mov_b32 s9, s5
s_mov_b32 s10, 0x240000
s_mov_b32 s11, 0x20000
s_mov_b32 s16, s68
s_mov_b32 s17, s69
s_mov_b32 s18, 0x240000
s_mov_b32 s19, 0x20000
s_movk_i32 s80, 1152
v_mul_lo_u32 v106, v101, s80
v_lshl_add_u32 v106, v100, 3, v106
buffer_load_dwordx2 v[108:109], v106, s[8:11], 0 offen
buffer_load_dwordx2 v[110:111], v106, s[8:11], 0 offen offset:128
buffer_load_dwordx2 v[112:113], v106, s[8:11], 0 offen offset:256
buffer_load_dwordx2 v[114:115], v106, s[8:11], 0 offen offset:384
buffer_load_dwordx2 v[116:117], v106, s[8:11], 0 offen offset:512
buffer_load_dwordx2 v[118:119], v106, s[8:11], 0 offen offset:640
buffer_load_dwordx2 v[120:121], v106, s[8:11], 0 offen offset:768
buffer_load_dwordx2 v[122:123], v106, s[8:11], 0 offen offset:896
buffer_load_dwordx2 v[124:125], v106, s[8:11], 0 offen offset:1024
s_movk_i32 s80, 18432
v_mul_lo_u32 v105, v105, s80
v_add_u32 v102, v102, v105
s_branch L_p1_tkjV
L_p1_cklV:
s_mov_b32 s8, s6
s_mov_b32 s9, s7
s_mov_b32 s10, 0x200000
s_mov_b32 s11, 0x20000
s_add_u32 s16, s68, 0x400000
s_addc_u32 s17, s69, 0
s_mov_b32 s18, 0x200000
s_mov_b32 s19, 0x20000
v_lshlrev_b32 v106, 10, v101
v_lshl_add_u32 v106, v100, 3, v106
buffer_load_dwordx2 v[108:109], v106, s[8:11], 0 offen
buffer_load_dwordx2 v[110:111], v106, s[8:11], 0 offen offset:128
buffer_load_dwordx2 v[112:113], v106, s[8:11], 0 offen offset:256
buffer_load_dwordx2 v[114:115], v106, s[8:11], 0 offen offset:384
buffer_load_dwordx2 v[116:117], v106, s[8:11], 0 offen offset:512
buffer_load_dwordx2 v[118:119], v106, s[8:11], 0 offen offset:640
buffer_load_dwordx2 v[120:121], v106, s[8:11], 0 offen offset:768
buffer_load_dwordx2 v[122:123], v106, s[8:11], 0 offen offset:896
v_mov_b32 v107, 0x7fffffff
buffer_load_dwordx2 v[124:125], v107, s[8:11], 0 offen
v_lshlrev_b32 v105, 14, v105
v_add_u32 v102, v102, v105
L_p1_tkjV:
s_cmp_lg_u32 s43, 0
s_cbranch_scc1 L_p1_tkwV
s_branch L_p1_tkcV
L_p1_tkwV:
s_waitcnt vmcnt(0)
L_p1_tkcV:
s_cmp_ge_u32 s20, 2
s_cbranch_scc1 L_p1_ckcV
s_waitcnt vmcnt(9)
v_lshlrev_b32 v128, 16, v108
v_and_b32 v129, 0xffff0000, v108
v_lshlrev_b32 v130, 16, v109
v_and_b32 v131, 0xffff0000, v109
s_waitcnt vmcnt(8)
v_lshlrev_b32 v132, 16, v110
v_and_b32 v133, 0xffff0000, v110
v_lshlrev_b32 v134, 16, v111
v_and_b32 v135, 0xffff0000, v111
s_waitcnt vmcnt(7)
v_lshlrev_b32 v136, 16, v112
v_and_b32 v137, 0xffff0000, v112
v_lshlrev_b32 v138, 16, v113
v_and_b32 v139, 0xffff0000, v113
s_waitcnt vmcnt(6)
v_lshlrev_b32 v140, 16, v114
v_and_b32 v141, 0xffff0000, v114
v_lshlrev_b32 v142, 16, v115
v_and_b32 v143, 0xffff0000, v115
s_waitcnt vmcnt(5)
v_lshlrev_b32 v144, 16, v116
v_and_b32 v145, 0xffff0000, v116
v_lshlrev_b32 v146, 16, v117
v_and_b32 v147, 0xffff0000, v117
s_waitcnt vmcnt(4)
v_lshlrev_b32 v148, 16, v118
v_and_b32 v149, 0xffff0000, v118
v_lshlrev_b32 v150, 16, v119
v_and_b32 v151, 0xffff0000, v119
s_waitcnt vmcnt(3)
v_lshlrev_b32 v152, 16, v120
v_and_b32 v153, 0xffff0000, v120
v_lshlrev_b32 v154, 16, v121
v_and_b32 v155, 0xffff0000, v121
s_waitcnt vmcnt(2)
v_lshlrev_b32 v156, 16, v122
v_and_b32 v157, 0xffff0000, v122
v_lshlrev_b32 v158, 16, v123
v_and_b32 v159, 0xffff0000, v123
s_waitcnt vmcnt(1)
v_lshlrev_b32 v160, 16, v124
v_and_b32 v161, 0xffff0000, v124
v_lshlrev_b32 v162, 16, v125
v_and_b32 v163, 0xffff0000, v125
v_add_f32 v166, v128, v129
v_add_f32 v167, v130, v131
v_add_f32 v168, v132, v133
v_add_f32 v169, v134, v135
v_add_f32 v166, v166, v136
v_add_f32 v167, v167, v137
v_add_f32 v168, v168, v138
v_add_f32 v169, v169, v139
v_add_f32 v166, v166, v140
v_add_f32 v167, v167, v141
v_add_f32 v168, v168, v142
v_add_f32 v169, v169, v143
v_add_f32 v166, v166, v144
v_add_f32 v167, v167, v145
v_add_f32 v168, v168, v146
v_add_f32 v169, v169, v147
v_add_f32 v166, v166, v148
v_add_f32 v167, v167, v149
v_add_f32 v168, v168, v150
v_add_f32 v169, v169, v151
v_add_f32 v166, v166, v152
v_add_f32 v167, v167, v153
v_add_f32 v168, v168, v154
v_add_f32 v169, v169, v155
v_add_f32 v166, v166, v156
v_add_f32 v167, v167, v157
v_add_f32 v168, v168, v158
v_add_f32 v169, v169, v159
v_add_f32 v166, v166, v160
v_add_f32 v167, v167, v161
v_add_f32 v168, v168, v162
v_add_f32 v169, v169, v163
v_add_f32 v166, v166, v167
v_add_f32 v168, v168, v169
s_nop 0
v_add_f32 v166, v166, v168
s_nop 1
v_add_f32_dpp v166, v166, v166 row_ror:8 row_mask:0xf bank_mask:0xf
s_nop 1
v_add_f32_dpp v166, v166, v166 row_ror:4 row_mask:0xf bank_mask:0xf
s_nop 1
v_add_f32_dpp v166, v166, v166 row_ror:2 row_mask:0xf bank_mask:0xf
s_nop 1
v_add_f32_dpp v166, v166, v166 row_ror:1 row_mask:0xf bank_mask:0xf
s_mov_b32 s80, 0x3ae38e39
v_mul_f32 v166, s80, v166
v_sub_f32 v170, v128, v166
v_mul_f32 v172, v170, v170
v_sub_f32 v170, v129, v166
v_mul_f32 v173, v170, v170
v_sub_f32 v170, v130, v166
v_mul_f32 v174, v170, v170
v_sub_f32 v170, v131, v166
v_mul_f32 v175, v170, v170
v_sub_f32 v170, v132, v166
v_fmac_f32 v172, v170, v170
v_sub_f32 v170, v133, v166
v_fmac_f32 v173, v170, v170
v_sub_f32 v170, v134, v166
v_fmac_f32 v174, v170, v170
v_sub_f32 v170, v135, v166
v_fmac_f32 v175, v170, v170
v_sub_f32 v170, v136, v166
v_fmac_f32 v172, v170, v170
v_sub_f32 v170, v137, v166
v_fmac_f32 v173, v170, v170
v_sub_f32 v170, v138, v166
v_fmac_f32 v174, v170, v170
v_sub_f32 v170, v139, v166
v_fmac_f32 v175, v170, v170
v_sub_f32 v170, v140, v166
v_fmac_f32 v172, v170, v170
v_sub_f32 v170, v141, v166
v_fmac_f32 v173, v170, v170
v_sub_f32 v170, v142, v166
v_fmac_f32 v174, v170, v170
v_sub_f32 v170, v143, v166
v_fmac_f32 v175, v170, v170
v_sub_f32 v170, v144, v166
v_fmac_f32 v172, v170, v170
v_sub_f32 v170, v145, v166
v_fmac_f32 v173, v170, v170
v_sub_f32 v170, v146, v166
v_fmac_f32 v174, v170, v170
v_sub_f32 v170, v147, v166
v_fmac_f32 v175, v170, v170
v_sub_f32 v170, v148, v166
v_fmac_f32 v172, v170, v170
v_sub_f32 v170, v149, v166
v_fmac_f32 v173, v170, v170
v_sub_f32 v170, v150, v166
v_fmac_f32 v174, v170, v170
v_sub_f32 v170, v151, v166
v_fmac_f32 v175, v170, v170
v_sub_f32 v170, v152, v166
v_fmac_f32 v172, v170, v170
v_sub_f32 v170, v153, v166
v_fmac_f32 v173, v170, v170
v_sub_f32 v170, v154, v166
v_fmac_f32 v174, v170, v170
v_sub_f32 v170, v155, v166
v_fmac_f32 v175, v170, v170
v_sub_f32 v170, v156, v166
v_fmac_f32 v172, v170, v170
v_sub_f32 v170, v157, v166
v_fmac_f32 v173, v170, v170
v_sub_f32 v170, v158, v166
v_fmac_f32 v174, v170, v170
v_sub_f32 v170, v159, v166
v_fmac_f32 v175, v170, v170
v_sub_f32 v170, v160, v166
v_fmac_f32 v172, v170, v170
v_sub_f32 v170, v161, v166
v_fmac_f32 v173, v170, v170
v_sub_f32 v170, v162, v166
v_fmac_f32 v174, v170, v170
v_sub_f32 v170, v163, v166
v_fmac_f32 v175, v170, v170
v_add_f32 v172, v172, v173
v_add_f32 v174, v174, v175
s_nop 0
v_add_f32 v172, v172, v174
s_nop 1
v_add_f32_dpp v172, v172, v172 row_ror:8 row_mask:0xf bank_mask:0xf
s_nop 1
v_add_f32_dpp v172, v172, v172 row_ror:4 row_mask:0xf bank_mask:0xf
s_nop 1
v_add_f32_dpp v172, v172, v172 row_ror:2 row_mask:0xf bank_mask:0xf
s_nop 1
v_add_f32_dpp v172, v172, v172 row_ror:1 row_mask:0xf bank_mask:0xf
v_mul_f32 v172, s80, v172
v_cvt_pk_bf16_f32 v166, v166, v172
v_and_b32 v172, 0xffff0000, v166
v_lshlrev_b32 v166, 16, v166
v_add_f32 v172, 0x3727c5ac, v172
v_cvt_pk_bf16_f32 v172, v172, v172
v_lshlrev_b32 v172, 16, v172
v_sqrt_f32 v172, v172
s_nop 0
v_cvt_pk_bf16_f32 v172, v172, v172
v_lshlrev_b32 v172, 16, v172
v_rcp_f32 v173, v172
s_nop 0
v_sub_f32 v128, v128, v166
v_sub_f32 v129, v129, v166
v_cvt_pk_bf16_f32 v176, v128, v129
v_lshlrev_b32 v177, 16, v176
v_and_b32 v178, 0xffff0000, v176
v_mul_f32 v179, v177, v173
v_mul_f32 v180, v178, v173
v_cvt_pk_bf16_f32 v108, v179, v180
v_sub_f32 v130, v130, v166
v_sub_f32 v131, v131, v166
v_cvt_pk_bf16_f32 v176, v130, v131
v_lshlrev_b32 v177, 16, v176
v_and_b32 v178, 0xffff0000, v176
v_mul_f32 v179, v177, v173
v_mul_f32 v180, v178, v173
v_cvt_pk_bf16_f32 v109, v179, v180
v_sub_f32 v132, v132, v166
v_sub_f32 v133, v133, v166
v_cvt_pk_bf16_f32 v176, v132, v133
v_lshlrev_b32 v177, 16, v176
v_and_b32 v178, 0xffff0000, v176
v_mul_f32 v179, v177, v173
v_mul_f32 v180, v178, v173
v_cvt_pk_bf16_f32 v110, v179, v180
v_sub_f32 v134, v134, v166
v_sub_f32 v135, v135, v166
v_cvt_pk_bf16_f32 v176, v134, v135
v_lshlrev_b32 v177, 16, v176
v_and_b32 v178, 0xffff0000, v176
v_mul_f32 v179, v177, v173
v_mul_f32 v180, v178, v173
v_cvt_pk_bf16_f32 v111, v179, v180
v_sub_f32 v136, v136, v166
v_sub_f32 v137, v137, v166
v_cvt_pk_bf16_f32 v176, v136, v137
v_lshlrev_b32 v177, 16, v176
v_and_b32 v178, 0xffff0000, v176
v_mul_f32 v179, v177, v173
v_mul_f32 v180, v178, v173
v_cvt_pk_bf16_f32 v112, v179, v180
v_sub_f32 v138, v138, v166
v_sub_f32 v139, v139, v166
v_cvt_pk_bf16_f32 v176, v138, v139
v_lshlrev_b32 v177, 16, v176
v_and_b32 v178, 0xffff0000, v176
v_mul_f32 v179, v177, v173
v_mul_f32 v180, v178, v173
v_cvt_pk_bf16_f32 v113, v179, v180
v_sub_f32 v140, v140, v166
v_sub_f32 v141, v141, v166
v_cvt_pk_bf16_f32 v176, v140, v141
v_lshlrev_b32 v177, 16, v176
v_and_b32 v178, 0xffff0000, v176
v_mul_f32 v179, v177, v173
v_mul_f32 v180, v178, v173
v_cvt_pk_bf16_f32 v114, v179, v180
v_sub_f32 v142, v142, v166
v_sub_f32 v143, v143, v166
v_cvt_pk_bf16_f32 v176, v142, v143
v_lshlrev_b32 v177, 16, v176
v_and_b32 v178, 0xffff0000, v176
v_mul_f32 v179, v177, v173
v_mul_f32 v180, v178, v173
v_cvt_pk_bf16_f32 v115, v179, v180
v_sub_f32 v144, v144, v166
v_sub_f32 v145, v145, v166
v_cvt_pk_bf16_f32 v176, v144, v145
v_lshlrev_b32 v177, 16, v176
v_and_b32 v178, 0xffff0000, v176
v_mul_f32 v179, v177, v173
v_mul_f32 v180, v178, v173
v_cvt_pk_bf16_f32 v116, v179, v180
v_sub_f32 v146, v146, v166
v_sub_f32 v147, v147, v166
v_cvt_pk_bf16_f32 v176, v146, v147
v_lshlrev_b32 v177, 16, v176
v_and_b32 v178, 0xffff0000, v176
v_mul_f32 v179, v177, v173
v_mul_f32 v180, v178, v173
v_cvt_pk_bf16_f32 v117, v179, v180
v_sub_f32 v148, v148, v166
v_sub_f32 v149, v149, v166
v_cvt_pk_bf16_f32 v176, v148, v149
v_lshlrev_b32 v177, 16, v176
v_and_b32 v178, 0xffff0000, v176
v_mul_f32 v179, v177, v173
v_mul_f32 v180, v178, v173
v_cvt_pk_bf16_f32 v118, v179, v180
v_sub_f32 v150, v150, v166
v_sub_f32 v151, v151, v166
v_cvt_pk_bf16_f32 v176, v150, v151
v_lshlrev_b32 v177, 16, v176
v_and_b32 v178, 0xffff0000, v176
v_mul_f32 v179, v177, v173
v_mul_f32 v180, v178, v173
v_cvt_pk_bf16_f32 v119, v179, v180
v_sub_f32 v152, v152, v166
v_sub_f32 v153, v153, v166
v_cvt_pk_bf16_f32 v176, v152, v153
v_lshlrev_b32 v177, 16, v176
v_and_b32 v178, 0xffff0000, v176
v_mul_f32 v179, v177, v173
v_mul_f32 v180, v178, v173
v_cvt_pk_bf16_f32 v120, v179, v180
v_sub_f32 v154, v154, v166
v_sub_f32 v155, v155, v166
v_cvt_pk_bf16_f32 v176, v154, v155
v_lshlrev_b32 v177, 16, v176
v_and_b32 v178, 0xffff0000, v176
v_mul_f32 v179, v177, v173
v_mul_f32 v180, v178, v173
v_cvt_pk_bf16_f32 v121, v179, v180
v_sub_f32 v156, v156, v166
v_sub_f32 v157, v157, v166
v_cvt_pk_bf16_f32 v176, v156, v157
v_lshlrev_b32 v177, 16, v176
v_and_b32 v178, 0xffff0000, v176
v_mul_f32 v179, v177, v173
v_mul_f32 v180, v178, v173
v_cvt_pk_bf16_f32 v122, v179, v180
v_sub_f32 v158, v158, v166
v_sub_f32 v159, v159, v166
v_cvt_pk_bf16_f32 v176, v158, v159
v_lshlrev_b32 v177, 16, v176
v_and_b32 v178, 0xffff0000, v176
v_mul_f32 v179, v177, v173
v_mul_f32 v180, v178, v173
v_cvt_pk_bf16_f32 v123, v179, v180
v_sub_f32 v160, v160, v166
v_sub_f32 v161, v161, v166
v_cvt_pk_bf16_f32 v176, v160, v161
v_lshlrev_b32 v177, 16, v176
v_and_b32 v178, 0xffff0000, v176
v_mul_f32 v179, v177, v173
v_mul_f32 v180, v178, v173
v_cvt_pk_bf16_f32 v124, v179, v180
v_sub_f32 v162, v162, v166
v_sub_f32 v163, v163, v166
v_cvt_pk_bf16_f32 v176, v162, v163
v_lshlrev_b32 v177, 16, v176
v_and_b32 v178, 0xffff0000, v176
v_mul_f32 v179, v177, v173
v_mul_f32 v180, v178, v173
v_cvt_pk_bf16_f32 v125, v179, v180
s_movk_i32 s80, 0
buffer_store_dwordx2 v[108:109], v102, s[16:19], s80 offen sc1
s_movk_i32 s80, 2048
buffer_store_dwordx2 v[110:111], v102, s[16:19], s80 offen sc1
s_movk_i32 s80, 4096
buffer_store_dwordx2 v[112:113], v102, s[16:19], s80 offen sc1
s_movk_i32 s80, 6144
buffer_store_dwordx2 v[114:115], v102, s[16:19], s80 offen sc1
s_movk_i32 s80, 8192
buffer_store_dwordx2 v[116:117], v102, s[16:19], s80 offen sc1
s_movk_i32 s80, 10240
buffer_store_dwordx2 v[118:119], v102, s[16:19], s80 offen sc1
s_movk_i32 s80, 12288
buffer_store_dwordx2 v[120:121], v102, s[16:19], s80 offen sc1
s_movk_i32 s80, 14336
buffer_store_dwordx2 v[122:123], v102, s[16:19], s80 offen sc1
s_movk_i32 s80, 16384
buffer_store_dwordx2 v[124:125], v102, s[16:19], s80 offen sc1
s_branch L_p1_tkdV
L_p1_ckcV:
s_movk_i32 s80, 0
s_waitcnt vmcnt(9)
buffer_store_dwordx2 v[108:109], v102, s[16:19], s80 offen sc1
s_movk_i32 s80, 2048
s_waitcnt vmcnt(9)
buffer_store_dwordx2 v[110:111], v102, s[16:19], s80 offen sc1
s_movk_i32 s80, 4096
s_waitcnt vmcnt(9)
buffer_store_dwordx2 v[112:113], v102, s[16:19], s80 offen sc1
s_movk_i32 s80, 6144
s_waitcnt vmcnt(9)
buffer_store_dwordx2 v[114:115], v102, s[16:19], s80 offen sc1
s_movk_i32 s80, 8192
s_waitcnt vmcnt(9)
buffer_store_dwordx2 v[116:117], v102, s[16:19], s80 offen sc1
s_movk_i32 s80, 10240
s_waitcnt vmcnt(9)
buffer_store_dwordx2 v[118:119], v102, s[16:19], s80 offen sc1
s_movk_i32 s80, 12288
s_waitcnt vmcnt(9)
buffer_store_dwordx2 v[120:121], v102, s[16:19], s80 offen sc1
s_movk_i32 s80, 14336
s_waitcnt vmcnt(9)
buffer_store_dwordx2 v[122:123], v102, s[16:19], s80 offen sc1
L_p1_tkdV:
s_waitcnt vmcnt(0)
s_barrier
s_cmp_lg_u32 s43, 0
s_cbranch_scc1 L_p1_fbnV
s_cmp_lg_u32 s20, 3
s_cbranch_scc1 L_p1_tkw1V
s_mov_b32 s92, s88
s_mov_b32 s93, s89
s_movk_i32 s94, 256
s_mov_b32 s95, 0x20000
s_lshr_b32 s80, s26, 4
s_lshl_b32 s84, s80, 5
v_mov_b32 v97, s84
v_mov_b32 v98, 1
s_mov_b64 exec, 1
buffer_atomic_add v98, v97, s[92:95], 0 offen sc0
s_lshl_b32 s85, s80, 12
s_waitcnt vmcnt(0)
v_readfirstlane_b32 s82, v98
s_add_u32 s92, s68, 0x6d10000
s_addc_u32 s93, s69, 0
s_mov_b32 s94, 0x8000
s_mov_b32 s95, 0x20000
s_cmp_lg_u32 s82, 31
s_cbranch_scc1 L_p1_notlastV
s_mov_b32 exec_lo, -1
s_mov_b32 exec_hi, 0
v_and_b32 v99, 63, v0
v_lshlrev_b32 v99, 7, v99
v_mov_b32 v100, 1
buffer_store_dword v100, v99, s[92:95], s85 offen sc1
s_mov_b64 exec, 1
s_mov_b32 s83, 1
s_branch L_p1_pubV
L_p1_notlastV:
s_lshl_b32 s84, s42, 7
s_add_u32 s84, s84, s85
v_mov_b32 v97, s84
s_mov_b32 s81, 0
L_p1_pollV:
buffer_load_dword v99, v97, s[92:95], 0 offen sc1
s_waitcnt vmcnt(0)
v_readfirstlane_b32 s82, v99
s_nop 3
s_cmp_eq_u32 s82, 1
s_cselect_b32 s83, 1, 0
s_cbranch_scc1 L_p1_pubV
s_sleep 4
s_add_u32 s81, s81, 1
s_cmp_lt_u32 s81, 4000
s_cbranch_scc1 L_p1_pollV
L_p1_pubV:
v_mov_b32 v97, 131068
v_mov_b32 v98, s83
ds_write_b32 v97, v98
s_mov_b64 exec, -1
s_add_u32 m0, s30, 0
s_add_u32 s31, s32, 0
buffer_load_dwordx4 v9, s[44:47], s31 offen lds
s_add_u32 m0, s30, 4096
s_add_u32 s31, s32, 262144
buffer_load_dwordx4 v9, s[44:47], s31 offen lds
s_add_u32 m0, s30, 8192
s_add_u32 s31, s32, 524288
buffer_load_dwordx4 v9, s[44:47], s31 offen lds
s_add_u32 m0, s30, 12288
s_add_u32 s31, s32, 786432
buffer_load_dwordx4 v9, s[44:47], s31 offen lds
s_add_u32 m0, s30, 16384
s_add_u32 s31, s32, 1048576
buffer_load_dwordx4 v9, s[44:47], s31 offen lds
s_add_u32 m0, s30, 20480
s_add_u32 s31, s32, 1310720
buffer_load_dwordx4 v9, s[44:47], s31 offen lds
s_add_u32 m0, s30, 24576
s_add_u32 s31, s32, 1572864
buffer_load_dwordx4 v9, s[44:47], s31 offen lds
s_add_u32 m0, s30, 28672
s_add_u32 s31, s32, 1835008
buffer_load_dwordx4 v9, s[44:47], s31 offen lds
s_waitcnt lgkmcnt(0)
L_p1_tkmV:
s_barrier
v_mov_b32 v97, 131068
ds_read_b32 v98, v97
s_waitcnt lgkmcnt(0)
v_readfirstlane_b32 s83, v98
s_nop 3
s_cmp_lg_u32 s83, 0
s_cbranch_scc1 L_p1_goV
s_mov_b32 s43, 1
s_mov_b32 s42, 0
s_barrier
s_branch L_p1_taskV
L_p1_tkw1V:
s_add_u32 m0, s30, 0
s_add_u32 s31, s32, 0
buffer_load_dwordx4 v9, s[44:47], s31 offen lds
s_add_u32 m0, s30, 4096
s_add_u32 s31, s32, 262144
buffer_load_dwordx4 v9, s[44:47], s31 offen lds
s_add_u32 m0, s30, 8192
s_add_u32 s31, s32, 524288
buffer_load_dwordx4 v9, s[44:47], s31 offen lds
s_add_u32 m0, s30, 12288
s_add_u32 s31, s32, 786432
buffer_load_dwordx4 v9, s[44:47], s31 offen lds
s_add_u32 m0, s30, 16384
s_add_u32 s31, s32, 1048576
buffer_load_dwordx4 v9, s[44:47], s31 offen lds
s_add_u32 m0, s30, 20480
s_add_u32 s31, s32, 1310720
buffer_load_dwordx4 v9, s[44:47], s31 offen lds
s_add_u32 m0, s30, 24576
s_add_u32 s31, s32, 1572864
buffer_load_dwordx4 v9, s[44:47], s31 offen lds
s_add_u32 m0, s30, 28672
s_add_u32 s31, s32, 1835008
buffer_load_dwordx4 v9, s[44:47], s31 offen lds
s_sub_u32 s35, s76, 512
buffer_load_dword v237, v216, s[72:75], s35 offen
s_branch L_p1_tkmV
L_p1_fbnV:
s_add_u32 s42, s42, 1
s_cmp_lt_u32 s42, 32
s_cbranch_scc1 L_p1_taskV
L_p1_goV:
s_add_u32 s60, s68, 0x400000
s_addc_u32 s61, s69, 0
s_mov_b32 s62, 0x200000
s_mov_b32 s63, 0x20000
s_mul_i32 s12, s26, 16384
s_add_u32 s13, s12, 16384
s_add_u32 s14, s12, 32768
s_add_u32 s15, s12, 49152
buffer_load_dwordx4 a[0:3], v2, s[60:63], s12 offen sc1
buffer_load_dwordx4 a[64:67], v2, s[60:63], s13 offen sc1
buffer_load_dwordx4 a[128:131], v2, s[60:63], s14 offen sc1
buffer_load_dwordx4 a[192:195], v2, s[60:63], s15 offen sc1
buffer_load_dwordx4 a[4:7], v2, s[60:63], s12 offen offset:1024 sc1
buffer_load_dwordx4 a[68:71], v2, s[60:63], s13 offen offset:1024 sc1
buffer_load_dwordx4 a[132:135], v2, s[60:63], s14 offen offset:1024 sc1
buffer_load_dwordx4 a[196:199], v2, s[60:63], s15 offen offset:1024 sc1
buffer_load_dwordx4 a[8:11], v2, s[60:63], s12 offen offset:2048 sc1
buffer_load_dwordx4 a[72:75], v2, s[60:63], s13 offen offset:2048 sc1
buffer_load_dwordx4 a[136:139], v2, s[60:63], s14 offen offset:2048 sc1
buffer_load_dwordx4 a[200:203], v2, s[60:63], s15 offen offset:2048 sc1
buffer_load_dwordx4 a[12:15], v2, s[60:63], s12 offen offset:3072 sc1
buffer_load_dwordx4 a[76:79], v2, s[60:63], s13 offen offset:3072 sc1
buffer_load_dwordx4 a[140:143], v2, s[60:63], s14 offen offset:3072 sc1
buffer_load_dwordx4 a[204:207], v2, s[60:63], s15 offen offset:3072 sc1
s_add_u32 s12, s12, 4096
s_add_u32 s13, s13, 4096
s_add_u32 s14, s14, 4096
s_add_u32 s15, s15, 4096
buffer_load_dwordx4 a[16:19], v2, s[60:63], s12 offen sc1
buffer_load_dwordx4 a[80:83], v2, s[60:63], s13 offen sc1
buffer_load_dwordx4 a[144:147], v2, s[60:63], s14 offen sc1
buffer_load_dwordx4 a[208:211], v2, s[60:63], s15 offen sc1
buffer_load_dwordx4 a[20:23], v2, s[60:63], s12 offen offset:1024 sc1
buffer_load_dwordx4 a[84:87], v2, s[60:63], s13 offen offset:1024 sc1
buffer_load_dwordx4 a[148:151], v2, s[60:63], s14 offen offset:1024 sc1
buffer_load_dwordx4 a[212:215], v2, s[60:63], s15 offen offset:1024 sc1
buffer_load_dwordx4 a[24:27], v2, s[60:63], s12 offen offset:2048 sc1
buffer_load_dwordx4 a[88:91], v2, s[60:63], s13 offen offset:2048 sc1
buffer_load_dwordx4 a[152:155], v2, s[60:63], s14 offen offset:2048 sc1
buffer_load_dwordx4 a[216:219], v2, s[60:63], s15 offen offset:2048 sc1
buffer_load_dwordx4 a[28:31], v2, s[60:63], s12 offen offset:3072 sc1
buffer_load_dwordx4 a[92:95], v2, s[60:63], s13 offen offset:3072 sc1
buffer_load_dwordx4 a[156:159], v2, s[60:63], s14 offen offset:3072 sc1
buffer_load_dwordx4 a[220:223], v2, s[60:63], s15 offen offset:3072 sc1
s_add_u32 s12, s12, 4096
s_add_u32 s13, s13, 4096
s_add_u32 s14, s14, 4096
s_add_u32 s15, s15, 4096
v_add_u32 v200, s27, v3
v_add_u32 v201, s28, v3
v_add_u32 v202, s27, v4
v_add_u32 v203, s28, v4
v_add_u32 v204, s27, v5
v_add_u32 v205, s28, v5
v_add_u32 v206, s27, v6
v_add_u32 v207, s28, v6
s_sub_u32 s35, s76, 256
buffer_load_dword v235, v216, s[72:75], s35 offen
s_waitcnt vmcnt(37)
s_barrier
ds_read_b64_tr_b16 v[112:113], v200
ds_read_b64_tr_b16 v[114:115], v200 offset:2048
ds_read_b64_tr_b16 v[116:117], v202
ds_read_b64_tr_b16 v[118:119], v202 offset:2048
ds_read_b64_tr_b16 v[120:121], v204
ds_read_b64_tr_b16 v[122:123], v204 offset:2048
ds_read_b64_tr_b16 v[124:125], v206
ds_read_b64_tr_b16 v[126:127], v206 offset:2048
ds_read_b64_tr_b16 v[128:129], v200 offset:4096
ds_read_b64_tr_b16 v[130:131], v200 offset:6144
ds_read_b64_tr_b16 v[132:133], v202 offset:4096
ds_read_b64_tr_b16 v[134:135], v202 offset:6144
s_waitcnt vmcnt(32) lgkmcnt(10)
v_mfma_f32_16x16x32_bf16 v[16:19], a[0:3], v[112:115], 0
s_waitcnt vmcnt(31)
ds_read_b64_tr_b16 v[136:137], v204 offset:4096
v_mfma_f32_16x16x32_bf16 v[20:23], a[64:67], v[112:115], 0
s_waitcnt vmcnt(30)
s_add_u32 m0, s30, 32768
s_add_u32 s31, s32, 2097152
buffer_load_dwordx4 v9, s[44:47], s31 offen lds
v_mfma_f32_16x16x32_bf16 v[24:27], a[128:131], v[112:115], 0
s_waitcnt vmcnt(30)
ds_read_b64_tr_b16 v[138:139], v204 offset:6144
v_mfma_f32_16x16x32_bf16 v[28:31], a[192:195], v[112:115], 0
s_waitcnt lgkmcnt(10)
s_add_u32 m0, s30, 36864
s_add_u32 s31, s32, 2359296
buffer_load_dwordx4 v9, s[44:47], s31 offen lds
v_mfma_f32_16x16x32_bf16 v[32:35], a[0:3], v[116:119], 0
ds_read_b64_tr_b16 v[140:141], v206 offset:4096
v_mfma_f32_16x16x32_bf16 v[36:39], a[64:67], v[116:119], 0
s_add_u32 m0, s30, 40960
s_add_u32 s31, s32, 2621440
buffer_load_dwordx4 v9, s[44:47], s31 offen lds
v_mfma_f32_16x16x32_bf16 v[40:43], a[128:131], v[116:119], 0
ds_read_b64_tr_b16 v[142:143], v206 offset:6144
v_mfma_f32_16x16x32_bf16 v[44:47], a[192:195], v[116:119], 0
s_waitcnt lgkmcnt(10)
s_add_u32 m0, s30, 45056
s_add_u32 s31, s32, 2883584
buffer_load_dwordx4 v9, s[44:47], s31 offen lds
v_mfma_f32_16x16x32_bf16 v[48:51], a[0:3], v[120:123], 0
ds_read_b64_tr_b16 v[112:113], v200 offset:8192
v_mfma_f32_16x16x32_bf16 v[52:55], a[64:67], v[120:123], 0
buffer_load_dwordx4 a[32:35], v2, s[60:63], s12 offen sc1
v_mfma_f32_16x16x32_bf16 v[56:59], a[128:131], v[120:123], 0
ds_read_b64_tr_b16 v[114:115], v200 offset:10240
v_mfma_f32_16x16x32_bf16 v[60:63], a[192:195], v[120:123], 0
s_waitcnt lgkmcnt(10)
buffer_load_dwordx4 a[96:99], v2, s[60:63], s13 offen sc1
v_mfma_f32_16x16x32_bf16 v[64:67], a[0:3], v[124:127], 0
ds_read_b64_tr_b16 v[116:117], v202 offset:8192
v_mfma_f32_16x16x32_bf16 v[68:71], a[64:67], v[124:127], 0
buffer_load_dwordx4 a[160:163], v2, s[60:63], s14 offen sc1
v_mfma_f32_16x16x32_bf16 v[72:75], a[128:131], v[124:127], 0
ds_read_b64_tr_b16 v[118:119], v202 offset:10240
v_mfma_f32_16x16x32_bf16 v[76:79], a[192:195], v[124:127], 0
s_waitcnt vmcnt(35) lgkmcnt(10)
buffer_load_dwordx4 a[224:227], v2, s[60:63], s15 offen sc1
v_mfma_f32_16x16x32_bf16 v[16:19], a[4:7], v[128:131], v[16:19]
s_waitcnt vmcnt(35)
ds_read_b64_tr_b16 v[120:121], v204 offset:8192
v_mfma_f32_16x16x32_bf16 v[20:23], a[68:71], v[128:131], v[20:23]
s_waitcnt vmcnt(34)
buffer_load_dwordx4 a[36:39], v2, s[60:63], s12 offen offset:1024 sc1
v_mfma_f32_16x16x32_bf16 v[24:27], a[132:135], v[128:131], v[24:27]
s_waitcnt vmcnt(34)
ds_read_b64_tr_b16 v[122:123], v204 offset:10240
v_mfma_f32_16x16x32_bf16 v[28:31], a[196:199], v[128:131], v[28:31]
s_waitcnt lgkmcnt(10)
v_mfma_f32_16x16x32_bf16 v[32:35], a[4:7], v[132:135], v[32:35]
ds_read_b64_tr_b16 v[124:125], v206 offset:8192
v_mfma_f32_16x16x32_bf16 v[36:39], a[68:71], v[132:135], v[36:39]
buffer_load_dwordx4 a[100:103], v2, s[60:63], s13 offen offset:1024 sc1
v_mfma_f32_16x16x32_bf16 v[40:43], a[132:135], v[132:135], v[40:43]
ds_read_b64_tr_b16 v[126:127], v206 offset:10240
v_mfma_f32_16x16x32_bf16 v[44:47], a[196:199], v[132:135], v[44:47]
s_waitcnt lgkmcnt(10)
buffer_load_dwordx4 a[164:167], v2, s[60:63], s14 offen offset:1024 sc1
v_mfma_f32_16x16x32_bf16 v[48:51], a[4:7], v[136:139], v[48:51]
ds_read_b64_tr_b16 v[128:129], v200 offset:12288
v_mfma_f32_16x16x32_bf16 v[52:55], a[68:71], v[136:139], v[52:55]
buffer_load_dwordx4 a[228:231], v2, s[60:63], s15 offen offset:1024 sc1
v_mfma_f32_16x16x32_bf16 v[56:59], a[132:135], v[136:139], v[56:59]
ds_read_b64_tr_b16 v[130:131], v200 offset:14336
v_mfma_f32_16x16x32_bf16 v[60:63], a[196:199], v[136:139], v[60:63]
s_waitcnt lgkmcnt(10)
buffer_load_dwordx4 a[40:43], v2, s[60:63], s12 offen offset:2048 sc1
v_mfma_f32_16x16x32_bf16 v[64:67], a[4:7], v[140:143], v[64:67]
ds_read_b64_tr_b16 v[132:133], v202 offset:12288
v_mfma_f32_16x16x32_bf16 v[68:71], a[68:71], v[140:143], v[68:71]
buffer_load_dwordx4 a[104:107], v2, s[60:63], s13 offen offset:2048 sc1
v_mfma_f32_16x16x32_bf16 v[72:75], a[132:135], v[140:143], v[72:75]
ds_read_b64_tr_b16 v[134:135], v202 offset:14336
v_mfma_f32_16x16x32_bf16 v[76:79], a[196:199], v[140:143], v[76:79]
s_waitcnt vmcnt(38) lgkmcnt(10)
buffer_load_dwordx4 a[168:171], v2, s[60:63], s14 offen offset:2048 sc1
v_mfma_f32_16x16x32_bf16 v[16:19], a[8:11], v[112:115], v[16:19]
s_waitcnt vmcnt(38)
ds_read_b64_tr_b16 v[136:137], v204 offset:12288
v_mfma_f32_16x16x32_bf16 v[20:23], a[72:75], v[112:115], v[20:23]
s_waitcnt vmcnt(37)
buffer_load_dwordx4 a[232:235], v2, s[60:63], s15 offen offset:2048 sc1
v_mfma_f32_16x16x32_bf16 v[24:27], a[136:139], v[112:115], v[24:27]
s_waitcnt vmcnt(37)
ds_read_b64_tr_b16 v[138:139], v204 offset:14336
v_mfma_f32_16x16x32_bf16 v[28:31], a[200:203], v[112:115], v[28:31]
s_waitcnt lgkmcnt(10)
buffer_load_dwordx4 a[44:47], v2, s[60:63], s12 offen offset:3072 sc1
v_mfma_f32_16x16x32_bf16 v[32:35], a[8:11], v[116:119], v[32:35]
ds_read_b64_tr_b16 v[140:141], v206 offset:12288
v_mfma_f32_16x16x32_bf16 v[36:39], a[72:75], v[116:119], v[36:39]
buffer_load_dwordx4 a[108:111], v2, s[60:63], s13 offen offset:3072 sc1
v_mfma_f32_16x16x32_bf16 v[40:43], a[136:139], v[116:119], v[40:43]
ds_read_b64_tr_b16 v[142:143], v206 offset:14336
v_mfma_f32_16x16x32_bf16 v[44:47], a[200:203], v[116:119], v[44:47]
s_barrier
buffer_load_dwordx4 a[172:175], v2, s[60:63], s14 offen offset:3072 sc1
s_waitcnt lgkmcnt(10)
v_mfma_f32_16x16x32_bf16 v[48:51], a[8:11], v[120:123], v[48:51]
ds_read_b64_tr_b16 v[112:113], v200 offset:16384
v_mfma_f32_16x16x32_bf16 v[52:55], a[72:75], v[120:123], v[52:55]
buffer_load_dwordx4 a[236:239], v2, s[60:63], s15 offen offset:3072 sc1
s_add_u32 s12, s12, 4096
s_add_u32 s13, s13, 4096
s_add_u32 s14, s14, 4096
s_add_u32 s15, s15, 4096
v_mfma_f32_16x16x32_bf16 v[56:59], a[136:139], v[120:123], v[56:59]
ds_read_b64_tr_b16 v[114:115], v200 offset:18432
v_mfma_f32_16x16x32_bf16 v[60:63], a[200:203], v[120:123], v[60:63]
s_waitcnt lgkmcnt(10)
s_add_u32 m0, s30, 49152
s_add_u32 s31, s32, 3145728
buffer_load_dwordx4 v9, s[44:47], s31 offen lds
v_mfma_f32_16x16x32_bf16 v[64:67], a[8:11], v[124:127], v[64:67]
ds_read_b64_tr_b16 v[116:117], v202 offset:16384
v_mfma_f32_16x16x32_bf16 v[68:71], a[72:75], v[124:127], v[68:71]
s_add_u32 m0, s30, 53248
s_add_u32 s31, s32, 3407872
buffer_load_dwordx4 v9, s[44:47], s31 offen lds
v_mfma_f32_16x16x32_bf16 v[72:75], a[136:139], v[124:127], v[72:75]
ds_read_b64_tr_b16 v[118:119], v202 offset:18432
v_mfma_f32_16x16x32_bf16 v[76:79], a[200:203], v[124:127], v[76:79]
s_waitcnt vmcnt(42) lgkmcnt(10)
s_add_u32 m0, s30, 57344
s_add_u32 s31, s32, 3670016
buffer_load_dwordx4 v9, s[44:47], s31 offen lds
v_mfma_f32_16x16x32_bf16 v[16:19], a[12:15], v[128:131], v[16:19]
s_waitcnt vmcnt(42)
ds_read_b64_tr_b16 v[120:121], v204 offset:16384
v_mfma_f32_16x16x32_bf16 v[20:23], a[76:79], v[128:131], v[20:23]
s_waitcnt vmcnt(41)
s_add_u32 m0, s30, 61440
s_add_u32 s31, s32, 3932160
buffer_load_dwordx4 v9, s[44:47], s31 offen lds
v_mfma_f32_16x16x32_bf16 v[24:27], a[140:143], v[128:131], v[24:27]
s_waitcnt vmcnt(41)
ds_read_b64_tr_b16 v[122:123], v204 offset:18432
v_mfma_f32_16x16x32_bf16 v[28:31], a[204:207], v[128:131], v[28:31]
s_waitcnt lgkmcnt(10)
buffer_load_dwordx4 a[48:51], v2, s[60:63], s12 offen sc1
v_mfma_f32_16x16x32_bf16 v[32:35], a[12:15], v[132:135], v[32:35]
ds_read_b64_tr_b16 v[124:125], v206 offset:16384
v_mfma_f32_16x16x32_bf16 v[36:39], a[76:79], v[132:135], v[36:39]
buffer_load_dwordx4 a[112:115], v2, s[60:63], s13 offen sc1
v_mfma_f32_16x16x32_bf16 v[40:43], a[140:143], v[132:135], v[40:43]
ds_read_b64_tr_b16 v[126:127], v206 offset:18432
v_mfma_f32_16x16x32_bf16 v[44:47], a[204:207], v[132:135], v[44:47]
s_waitcnt lgkmcnt(10)
buffer_load_dwordx4 a[176:179], v2, s[60:63], s14 offen sc1
v_mfma_f32_16x16x32_bf16 v[48:51], a[12:15], v[136:139], v[48:51]
ds_read_b64_tr_b16 v[128:129], v200 offset:20480
v_mfma_f32_16x16x32_bf16 v[52:55], a[76:79], v[136:139], v[52:55]
v_mfma_f32_16x16x32_bf16 v[56:59], a[140:143], v[136:139], v[56:59]
ds_read_b64_tr_b16 v[130:131], v200 offset:22528
v_mfma_f32_16x16x32_bf16 v[60:63], a[204:207], v[136:139], v[60:63]
s_waitcnt lgkmcnt(10)
buffer_load_dwordx4 a[240:243], v2, s[60:63], s15 offen sc1
v_mfma_f32_16x16x32_bf16 v[64:67], a[12:15], v[140:143], v[64:67]
ds_read_b64_tr_b16 v[132:133], v202 offset:20480
v_mfma_f32_16x16x32_bf16 v[68:71], a[76:79], v[140:143], v[68:71]
buffer_load_dwordx4 a[52:55], v2, s[60:63], s12 offen offset:1024 sc1
v_mfma_f32_16x16x32_bf16 v[72:75], a[140:143], v[140:143], v[72:75]
ds_read_b64_tr_b16 v[134:135], v202 offset:22528
v_mfma_f32_16x16x32_bf16 v[76:79], a[204:207], v[140:143], v[76:79]
s_waitcnt vmcnt(45) lgkmcnt(10)
buffer_load_dwordx4 a[116:119], v2, s[60:63], s13 offen offset:1024 sc1
v_mfma_f32_16x16x32_bf16 v[16:19], a[16:19], v[112:115], v[16:19]
s_waitcnt vmcnt(45)
ds_read_b64_tr_b16 v[136:137], v204 offset:20480
v_mfma_f32_16x16x32_bf16 v[20:23], a[80:83], v[112:115], v[20:23]
s_waitcnt vmcnt(44)
buffer_load_dwordx4 a[180:183], v2, s[60:63], s14 offen offset:1024 sc1
v_mfma_f32_16x16x32_bf16 v[24:27], a[144:147], v[112:115], v[24:27]
s_waitcnt vmcnt(44)
ds_read_b64_tr_b16 v[138:139], v204 offset:22528
v_mfma_f32_16x16x32_bf16 v[28:31], a[208:211], v[112:115], v[28:31]
s_waitcnt lgkmcnt(10)
buffer_load_dwordx4 a[244:247], v2, s[60:63], s15 offen offset:1024 sc1
v_mfma_f32_16x16x32_bf16 v[32:35], a[16:19], v[116:119], v[32:35]
ds_read_b64_tr_b16 v[140:141], v206 offset:20480
v_mfma_f32_16x16x32_bf16 v[36:39], a[80:83], v[116:119], v[36:39]
buffer_load_dwordx4 a[56:59], v2, s[60:63], s12 offen offset:2048 sc1
v_mfma_f32_16x16x32_bf16 v[40:43], a[144:147], v[116:119], v[40:43]
ds_read_b64_tr_b16 v[142:143], v206 offset:22528
v_mfma_f32_16x16x32_bf16 v[44:47], a[208:211], v[116:119], v[44:47]
s_waitcnt lgkmcnt(10)
buffer_load_dwordx4 a[120:123], v2, s[60:63], s13 offen offset:2048 sc1
v_mfma_f32_16x16x32_bf16 v[48:51], a[16:19], v[120:123], v[48:51]
ds_read_b64_tr_b16 v[112:113], v200 offset:24576
v_mfma_f32_16x16x32_bf16 v[52:55], a[80:83], v[120:123], v[52:55]
buffer_load_dwordx4 a[184:187], v2, s[60:63], s14 offen offset:2048 sc1
v_mfma_f32_16x16x32_bf16 v[56:59], a[144:147], v[120:123], v[56:59]
ds_read_b64_tr_b16 v[114:115], v200 offset:26624
v_mfma_f32_16x16x32_bf16 v[60:63], a[208:211], v[120:123], v[60:63]
s_waitcnt lgkmcnt(10)
buffer_load_dwordx4 a[248:251], v2, s[60:63], s15 offen offset:2048 sc1
v_mfma_f32_16x16x32_bf16 v[64:67], a[16:19], v[124:127], v[64:67]
ds_read_b64_tr_b16 v[116:117], v202 offset:24576
v_mfma_f32_16x16x32_bf16 v[68:71], a[80:83], v[124:127], v[68:71]
buffer_load_dwordx4 a[60:63], v2, s[60:63], s12 offen offset:3072 sc1
v_mfma_f32_16x16x32_bf16 v[72:75], a[144:147], v[124:127], v[72:75]
ds_read_b64_tr_b16 v[118:119], v202 offset:26624
v_mfma_f32_16x16x32_bf16 v[76:79], a[208:211], v[124:127], v[76:79]
s_waitcnt vmcnt(49) lgkmcnt(10)
buffer_load_dwordx4 a[124:127], v2, s[60:63], s13 offen offset:3072 sc1
v_mfma_f32_16x16x32_bf16 v[16:19], a[20:23], v[128:131], v[16:19]
s_waitcnt vmcnt(49)
ds_read_b64_tr_b16 v[120:121], v204 offset:24576
v_mfma_f32_16x16x32_bf16 v[20:23], a[84:87], v[128:131], v[20:23]
s_waitcnt vmcnt(48)
buffer_load_dwordx4 a[188:191], v2, s[60:63], s14 offen offset:3072 sc1
v_mfma_f32_16x16x32_bf16 v[24:27], a[148:151], v[128:131], v[24:27]
s_waitcnt vmcnt(48)
ds_read_b64_tr_b16 v[122:123], v204 offset:26624
v_mfma_f32_16x16x32_bf16 v[28:31], a[212:215], v[128:131], v[28:31]
s_waitcnt lgkmcnt(10)
buffer_load_dwordx4 a[252:255], v2, s[60:63], s15 offen offset:3072 sc1
s_add_u32 s12, s12, 4096
s_add_u32 s13, s13, 4096
s_add_u32 s14, s14, 4096
s_add_u32 s15, s15, 4096
v_mfma_f32_16x16x32_bf16 v[32:35], a[20:23], v[132:135], v[32:35]
ds_read_b64_tr_b16 v[124:125], v206 offset:24576
v_mfma_f32_16x16x32_bf16 v[36:39], a[84:87], v[132:135], v[36:39]
v_mfma_f32_16x16x32_bf16 v[40:43], a[148:151], v[132:135], v[40:43]
ds_read_b64_tr_b16 v[126:127], v206 offset:26624
v_mfma_f32_16x16x32_bf16 v[44:47], a[212:215], v[132:135], v[44:47]
s_waitcnt lgkmcnt(10)
v_mfma_f32_16x16x32_bf16 v[48:51], a[20:23], v[136:139], v[48:51]
ds_read_b64_tr_b16 v[128:129], v200 offset:28672
v_mfma_f32_16x16x32_bf16 v[52:55], a[84:87], v[136:139], v[52:55]
v_mfma_f32_16x16x32_bf16 v[56:59], a[148:151], v[136:139], v[56:59]
ds_read_b64_tr_b16 v[130:131], v200 offset:30720
v_mfma_f32_16x16x32_bf16 v[60:63], a[212:215], v[136:139], v[60:63]
s_waitcnt lgkmcnt(10)
v_mfma_f32_16x16x32_bf16 v[64:67], a[20:23], v[140:143], v[64:67]
s_add_u32 s32, s32, 128
s_xor_b32 s30, s30, 65536
ds_read_b64_tr_b16 v[132:133], v202 offset:28672
v_mfma_f32_16x16x32_bf16 v[68:71], a[84:87], v[140:143], v[68:71]
s_cmp_eq_u32 s22, 1
s_cselect_b32 s46, 0, s46
v_mfma_f32_16x16x32_bf16 v[72:75], a[148:151], v[140:143], v[72:75]
ds_read_b64_tr_b16 v[134:135], v202 offset:30720
v_mfma_f32_16x16x32_bf16 v[76:79], a[212:215], v[140:143], v[76:79]
s_waitcnt vmcnt(48) lgkmcnt(10)
s_mov_b32 m0, s30
s_mov_b32 s31, s32
buffer_load_dwordx4 v9, s[44:47], s31 offen lds
v_mfma_f32_16x16x32_bf16 v[16:19], a[24:27], v[112:115], v[16:19]
s_waitcnt vmcnt(48)
ds_read_b64_tr_b16 v[136:137], v204 offset:28672
v_mfma_f32_16x16x32_bf16 v[20:23], a[88:91], v[112:115], v[20:23]
s_waitcnt vmcnt(47)
s_add_u32 m0, m0, 4096
s_add_u32 s31, s31, 262144
buffer_load_dwordx4 v9, s[44:47], s31 offen lds
v_mfma_f32_16x16x32_bf16 v[24:27], a[152:155], v[112:115], v[24:27]
s_waitcnt vmcnt(47)
ds_read_b64_tr_b16 v[138:139], v204 offset:30720
v_mfma_f32_16x16x32_bf16 v[28:31], a[216:219], v[112:115], v[28:31]
s_waitcnt lgkmcnt(10)
v_mfma_f32_16x16x32_bf16 v[32:35], a[24:27], v[116:119], v[32:35]
ds_read_b64_tr_b16 v[140:141], v206 offset:28672
v_mfma_f32_16x16x32_bf16 v[36:39], a[88:91], v[116:119], v[36:39]
v_mfma_f32_16x16x32_bf16 v[40:43], a[152:155], v[116:119], v[40:43]
ds_read_b64_tr_b16 v[142:143], v206 offset:30720
v_mfma_f32_16x16x32_bf16 v[44:47], a[216:219], v[116:119], v[44:47]
s_waitcnt vmcnt(38)
s_barrier
s_add_u32 m0, m0, 4096
s_add_u32 s31, s31, 262144
buffer_load_dwordx4 v9, s[44:47], s31 offen lds
s_waitcnt lgkmcnt(10)
v_mfma_f32_16x16x32_bf16 v[48:51], a[24:27], v[120:123], v[48:51]
ds_read_b64_tr_b16 v[112:113], v201
v_mfma_f32_16x16x32_bf16 v[52:55], a[88:91], v[120:123], v[52:55]
v_mfma_f32_16x16x32_bf16 v[56:59], a[152:155], v[120:123], v[56:59]
ds_read_b64_tr_b16 v[114:115], v201 offset:2048
v_mfma_f32_16x16x32_bf16 v[60:63], a[216:219], v[120:123], v[60:63]
s_waitcnt lgkmcnt(10)
v_mfma_f32_16x16x32_bf16 v[64:67], a[24:27], v[124:127], v[64:67]
ds_read_b64_tr_b16 v[116:117], v203
v_mfma_f32_16x16x32_bf16 v[68:71], a[88:91], v[124:127], v[68:71]
s_add_u32 m0, m0, 4096
s_add_u32 s31, s31, 262144
buffer_load_dwordx4 v9, s[44:47], s31 offen lds
v_mfma_f32_16x16x32_bf16 v[72:75], a[152:155], v[124:127], v[72:75]
ds_read_b64_tr_b16 v[118:119], v203 offset:2048
v_mfma_f32_16x16x32_bf16 v[76:79], a[216:219], v[124:127], v[76:79]
s_waitcnt lgkmcnt(10)
v_mfma_f32_16x16x32_bf16 v[16:19], a[28:31], v[128:131], v[16:19]
ds_read_b64_tr_b16 v[120:121], v205
v_mfma_f32_16x16x32_bf16 v[20:23], a[92:95], v[128:131], v[20:23]
v_mfma_f32_16x16x32_bf16 v[24:27], a[156:159], v[128:131], v[24:27]
ds_read_b64_tr_b16 v[122:123], v205 offset:2048
v_mfma_f32_16x16x32_bf16 v[28:31], a[220:223], v[128:131], v[28:31]
s_waitcnt lgkmcnt(10)
s_add_u32 m0, m0, 4096
s_add_u32 s31, s31, 262144
buffer_load_dwordx4 v9, s[44:47], s31 offen lds
v_mfma_f32_16x16x32_bf16 v[32:35], a[28:31], v[132:135], v[32:35]
ds_read_b64_tr_b16 v[124:125], v207
v_mfma_f32_16x16x32_bf16 v[36:39], a[92:95], v[132:135], v[36:39]
v_mfma_f32_16x16x32_bf16 v[40:43], a[156:159], v[132:135], v[40:43]
ds_read_b64_tr_b16 v[126:127], v207 offset:2048
v_mfma_f32_16x16x32_bf16 v[44:47], a[220:223], v[132:135], v[44:47]
s_waitcnt lgkmcnt(10)
v_mfma_f32_16x16x32_bf16 v[48:51], a[28:31], v[136:139], v[48:51]
ds_read_b64_tr_b16 v[128:129], v201 offset:4096
v_mfma_f32_16x16x32_bf16 v[52:55], a[92:95], v[136:139], v[52:55]
s_add_u32 m0, m0, 4096
s_add_u32 s31, s31, 262144
buffer_load_dwordx4 v9, s[44:47], s31 offen lds
v_mfma_f32_16x16x32_bf16 v[56:59], a[156:159], v[136:139], v[56:59]
ds_read_b64_tr_b16 v[130:131], v201 offset:6144
v_mfma_f32_16x16x32_bf16 v[60:63], a[220:223], v[136:139], v[60:63]
s_waitcnt lgkmcnt(10)
v_mfma_f32_16x16x32_bf16 v[64:67], a[28:31], v[140:143], v[64:67]
ds_read_b64_tr_b16 v[132:133], v203 offset:4096
v_mfma_f32_16x16x32_bf16 v[68:71], a[92:95], v[140:143], v[68:71]
s_add_u32 m0, m0, 4096
s_add_u32 s31, s31, 262144
buffer_load_dwordx4 v9, s[44:47], s31 offen lds
v_mfma_f32_16x16x32_bf16 v[72:75], a[156:159], v[140:143], v[72:75]
ds_read_b64_tr_b16 v[134:135], v203 offset:6144
v_mfma_f32_16x16x32_bf16 v[76:79], a[220:223], v[140:143], v[76:79]
s_waitcnt vmcnt(42) lgkmcnt(10)
v_mfma_f32_16x16x32_bf16 v[16:19], a[32:35], v[112:115], v[16:19]
s_waitcnt vmcnt(41)
ds_read_b64_tr_b16 v[136:137], v205 offset:4096
v_mfma_f32_16x16x32_bf16 v[20:23], a[96:99], v[112:115], v[20:23]
s_waitcnt vmcnt(40)
v_mfma_f32_16x16x32_bf16 v[24:27], a[160:163], v[112:115], v[24:27]
s_waitcnt vmcnt(39)
ds_read_b64_tr_b16 v[138:139], v205 offset:6144
v_mfma_f32_16x16x32_bf16 v[28:31], a[224:227], v[112:115], v[28:31]
s_waitcnt lgkmcnt(10)
s_add_u32 m0, m0, 4096
s_add_u32 s31, s31, 262144
buffer_load_dwordx4 v9, s[44:47], s31 offen lds
v_mfma_f32_16x16x32_bf16 v[32:35], a[32:35], v[116:119], v[32:35]
ds_read_b64_tr_b16 v[140:141], v207 offset:4096
v_mfma_f32_16x16x32_bf16 v[36:39], a[96:99], v[116:119], v[36:39]
v_mfma_f32_16x16x32_bf16 v[40:43], a[160:163], v[116:119], v[40:43]
ds_read_b64_tr_b16 v[142:143], v207 offset:6144
v_mfma_f32_16x16x32_bf16 v[44:47], a[224:227], v[116:119], v[44:47]
s_waitcnt lgkmcnt(10)
v_mfma_f32_16x16x32_bf16 v[48:51], a[32:35], v[120:123], v[48:51]
ds_read_b64_tr_b16 v[112:113], v201 offset:8192
v_mfma_f32_16x16x32_bf16 v[52:55], a[96:99], v[120:123], v[52:55]
s_add_u32 m0, m0, 4096
s_add_u32 s31, s31, 262144
buffer_load_dwordx4 v9, s[44:47], s31 offen lds
v_mfma_f32_16x16x32_bf16 v[56:59], a[160:163], v[120:123], v[56:59]
ds_read_b64_tr_b16 v[114:115], v201 offset:10240
v_mfma_f32_16x16x32_bf16 v[60:63], a[224:227], v[120:123], v[60:63]
s_waitcnt lgkmcnt(10)
v_mfma_f32_16x16x32_bf16 v[64:67], a[32:35], v[124:127], v[64:67]
ds_read_b64_tr_b16 v[116:117], v203 offset:8192
v_mfma_f32_16x16x32_bf16 v[68:71], a[96:99], v[124:127], v[68:71]
v_mfma_f32_16x16x32_bf16 v[72:75], a[160:163], v[124:127], v[72:75]
ds_read_b64_tr_b16 v[118:119], v203 offset:10240
v_mfma_f32_16x16x32_bf16 v[76:79], a[224:227], v[124:127], v[76:79]
s_waitcnt vmcnt(40) lgkmcnt(10)
s_add_u32 m0, m0, 4096
s_add_u32 s31, s31, 262144
buffer_load_dwordx4 v9, s[44:47], s31 offen lds
v_mfma_f32_16x16x32_bf16 v[16:19], a[36:39], v[128:131], v[16:19]
s_waitcnt vmcnt(40)
ds_read_b64_tr_b16 v[120:121], v205 offset:8192
v_mfma_f32_16x16x32_bf16 v[20:23], a[100:103], v[128:131], v[20:23]
s_waitcnt vmcnt(39)
v_mfma_f32_16x16x32_bf16 v[24:27], a[164:167], v[128:131], v[24:27]
s_waitcnt vmcnt(38)
ds_read_b64_tr_b16 v[122:123], v205 offset:10240
v_mfma_f32_16x16x32_bf16 v[28:31], a[228:231], v[128:131], v[28:31]
s_waitcnt lgkmcnt(10)
v_mfma_f32_16x16x32_bf16 v[32:35], a[36:39], v[132:135], v[32:35]
ds_read_b64_tr_b16 v[124:125], v207 offset:8192
v_mfma_f32_16x16x32_bf16 v[36:39], a[100:103], v[132:135], v[36:39]
s_add_u32 m0, m0, 4096
s_add_u32 s31, s31, 262144
buffer_load_dwordx4 v9, s[44:47], s31 offen lds
v_mfma_f32_16x16x32_bf16 v[40:43], a[164:167], v[132:135], v[40:43]
ds_read_b64_tr_b16 v[126:127], v207 offset:10240
v_mfma_f32_16x16x32_bf16 v[44:47], a[228:231], v[132:135], v[44:47]
s_waitcnt lgkmcnt(10)
v_mfma_f32_16x16x32_bf16 v[48:51], a[36:39], v[136:139], v[48:51]
ds_read_b64_tr_b16 v[128:129], v201 offset:12288
v_mfma_f32_16x16x32_bf16 v[52:55], a[100:103], v[136:139], v[52:55]
s_add_u32 m0, m0, 4096
s_add_u32 s31, s31, 262144
buffer_load_dwordx4 v9, s[44:47], s31 offen lds
v_mfma_f32_16x16x32_bf16 v[56:59], a[164:167], v[136:139], v[56:59]
ds_read_b64_tr_b16 v[130:131], v201 offset:14336
v_mfma_f32_16x16x32_bf16 v[60:63], a[228:231], v[136:139], v[60:63]
s_waitcnt lgkmcnt(10)
v_mfma_f32_16x16x32_bf16 v[64:67], a[36:39], v[140:143], v[64:67]
ds_read_b64_tr_b16 v[132:133], v203 offset:12288
v_mfma_f32_16x16x32_bf16 v[68:71], a[100:103], v[140:143], v[68:71]
v_mfma_f32_16x16x32_bf16 v[72:75], a[164:167], v[140:143], v[72:75]
ds_read_b64_tr_b16 v[134:135], v203 offset:14336
v_mfma_f32_16x16x32_bf16 v[76:79], a[228:231], v[140:143], v[76:79]
s_waitcnt vmcnt(39) lgkmcnt(10)
s_add_u32 m0, m0, 4096
s_add_u32 s31, s31, 262144
buffer_load_dwordx4 v9, s[44:47], s31 offen lds
v_mfma_f32_16x16x32_bf16 v[16:19], a[40:43], v[112:115], v[16:19]
s_waitcnt vmcnt(39)
ds_read_b64_tr_b16 v[136:137], v205 offset:12288
v_mfma_f32_16x16x32_bf16 v[20:23], a[104:107], v[112:115], v[20:23]
s_waitcnt vmcnt(38)
v_mfma_f32_16x16x32_bf16 v[24:27], a[168:171], v[112:115], v[24:27]
s_waitcnt vmcnt(37)
ds_read_b64_tr_b16 v[138:139], v205 offset:14336
v_mfma_f32_16x16x32_bf16 v[28:31], a[232:235], v[112:115], v[28:31]
s_waitcnt lgkmcnt(10)
v_mfma_f32_16x16x32_bf16 v[32:35], a[40:43], v[116:119], v[32:35]
ds_read_b64_tr_b16 v[140:141], v207 offset:12288
v_mfma_f32_16x16x32_bf16 v[36:39], a[104:107], v[116:119], v[36:39]
s_add_u32 m0, m0, 4096
s_add_u32 s31, s31, 262144
buffer_load_dwordx4 v9, s[44:47], s31 offen lds
v_mfma_f32_16x16x32_bf16 v[40:43], a[168:171], v[116:119], v[40:43]
ds_read_b64_tr_b16 v[142:143], v207 offset:14336
v_mfma_f32_16x16x32_bf16 v[44:47], a[232:235], v[116:119], v[44:47]
s_waitcnt vmcnt(30)
s_barrier
s_waitcnt lgkmcnt(10)
v_mfma_f32_16x16x32_bf16 v[48:51], a[40:43], v[120:123], v[48:51]
ds_read_b64_tr_b16 v[112:113], v201 offset:16384
v_mfma_f32_16x16x32_bf16 v[52:55], a[104:107], v[120:123], v[52:55]
v_mfma_f32_16x16x32_bf16 v[56:59], a[168:171], v[120:123], v[56:59]
ds_read_b64_tr_b16 v[114:115], v201 offset:18432
v_mfma_f32_16x16x32_bf16 v[60:63], a[232:235], v[120:123], v[60:63]
s_waitcnt lgkmcnt(10)
s_add_u32 m0, m0, 4096
s_add_u32 s31, s31, 262144
buffer_load_dwordx4 v9, s[44:47], s31 offen lds
v_mfma_f32_16x16x32_bf16 v[64:67], a[40:43], v[124:127], v[64:67]
ds_read_b64_tr_b16 v[116:117], v203 offset:16384
v_mfma_f32_16x16x32_bf16 v[68:71], a[104:107], v[124:127], v[68:71]
v_mfma_f32_16x16x32_bf16 v[72:75], a[168:171], v[124:127], v[72:75]
ds_read_b64_tr_b16 v[118:119], v203 offset:18432
v_mfma_f32_16x16x32_bf16 v[76:79], a[232:235], v[124:127], v[76:79]
s_waitcnt lgkmcnt(10)
v_mfma_f32_16x16x32_bf16 v[16:19], a[44:47], v[128:131], v[16:19]
ds_read_b64_tr_b16 v[120:121], v205 offset:16384
v_mfma_f32_16x16x32_bf16 v[20:23], a[108:111], v[128:131], v[20:23]
s_add_u32 m0, m0, 4096
s_add_u32 s31, s31, 262144
buffer_load_dwordx4 v9, s[44:47], s31 offen lds
v_mfma_f32_16x16x32_bf16 v[24:27], a[172:175], v[128:131], v[24:27]
ds_read_b64_tr_b16 v[122:123], v205 offset:18432
v_mfma_f32_16x16x32_bf16 v[28:31], a[236:239], v[128:131], v[28:31]
s_waitcnt lgkmcnt(10)
v_mfma_f32_16x16x32_bf16 v[32:35], a[44:47], v[132:135], v[32:35]
ds_read_b64_tr_b16 v[124:125], v207 offset:16384
v_mfma_f32_16x16x32_bf16 v[36:39], a[108:111], v[132:135], v[36:39]
v_mfma_f32_16x16x32_bf16 v[40:43], a[172:175], v[132:135], v[40:43]
ds_read_b64_tr_b16 v[126:127], v207 offset:18432
v_mfma_f32_16x16x32_bf16 v[44:47], a[236:239], v[132:135], v[44:47]
s_waitcnt lgkmcnt(10)
v_mfma_f32_16x16x32_bf16 v[48:51], a[44:47], v[136:139], v[48:51]
ds_read_b64_tr_b16 v[128:129], v201 offset:20480
v_mfma_f32_16x16x32_bf16 v[52:55], a[108:111], v[136:139], v[52:55]
v_mfma_f32_16x16x32_bf16 v[56:59], a[172:175], v[136:139], v[56:59]
ds_read_b64_tr_b16 v[130:131], v201 offset:22528
v_mfma_f32_16x16x32_bf16 v[60:63], a[236:239], v[136:139], v[60:63]
s_waitcnt lgkmcnt(10)
v_mfma_f32_16x16x32_bf16 v[64:67], a[44:47], v[140:143], v[64:67]
ds_read_b64_tr_b16 v[132:133], v203 offset:20480
v_mfma_f32_16x16x32_bf16 v[68:71], a[108:111], v[140:143], v[68:71]
v_mfma_f32_16x16x32_bf16 v[72:75], a[172:175], v[140:143], v[72:75]
ds_read_b64_tr_b16 v[134:135], v203 offset:22528
v_mfma_f32_16x16x32_bf16 v[76:79], a[236:239], v[140:143], v[76:79]
s_waitcnt vmcnt(31) lgkmcnt(10)
v_mfma_f32_16x16x32_bf16 v[16:19], a[48:51], v[112:115], v[16:19]
s_waitcnt vmcnt(30)
ds_read_b64_tr_b16 v[136:137], v205 offset:20480
v_mfma_f32_16x16x32_bf16 v[20:23], a[112:115], v[112:115], v[20:23]
s_waitcnt vmcnt(29)
v_mfma_f32_16x16x32_bf16 v[24:27], a[176:179], v[112:115], v[24:27]
s_waitcnt vmcnt(28)
s_cmp_gt_u32 s22, 4
s_cselect_b32 s74, s77, 0
s_bitcmp1_b32 s78, 0
s_cselect_b32 s74, 0, s74
ds_read_b64_tr_b16 v[138:139], v205 offset:22528
v_mfma_f32_16x16x32_bf16 v[28:31], a[240:243], v[112:115], v[28:31]
s_waitcnt lgkmcnt(10)
buffer_load_dword v232, v216, s[72:75], s76 offen
v_mfma_f32_16x16x32_bf16 v[32:35], a[48:51], v[116:119], v[32:35]
s_add_u32 s76, s76, 128
ds_read_b64_tr_b16 v[140:141], v207 offset:20480
v_mfma_f32_16x16x32_bf16 v[36:39], a[112:115], v[116:119], v[36:39]
v_mfma_f32_16x16x32_bf16 v[40:43], a[176:179], v[116:119], v[40:43]
s_add_u32 s78, s78, 1
ds_read_b64_tr_b16 v[142:143], v207 offset:22528
v_mfma_f32_16x16x32_bf16 v[44:47], a[240:243], v[116:119], v[44:47]
s_waitcnt lgkmcnt(10)
v_mfma_f32_16x16x32_bf16 v[48:51], a[48:51], v[120:123], v[48:51]
ds_read_b64_tr_b16 v[112:113], v201 offset:24576
v_mfma_f32_16x16x32_bf16 v[52:55], a[112:115], v[120:123], v[52:55]
v_mfma_f32_16x16x32_bf16 v[56:59], a[176:179], v[120:123], v[56:59]
ds_read_b64_tr_b16 v[114:115], v201 offset:26624
v_mfma_f32_16x16x32_bf16 v[60:63], a[240:243], v[120:123], v[60:63]
s_waitcnt lgkmcnt(10)
v_mfma_f32_16x16x32_bf16 v[64:67], a[48:51], v[124:127], v[64:67]
ds_read_b64_tr_b16 v[116:117], v203 offset:24576
v_mfma_f32_16x16x32_bf16 v[68:71], a[112:115], v[124:127], v[68:71]
v_mfma_f32_16x16x32_bf16 v[72:75], a[176:179], v[124:127], v[72:75]
ds_read_b64_tr_b16 v[118:119], v203 offset:26624
v_mfma_f32_16x16x32_bf16 v[76:79], a[240:243], v[124:127], v[76:79]
s_waitcnt vmcnt(28) lgkmcnt(10)
v_mfma_f32_16x16x32_bf16 v[16:19], a[52:55], v[128:131], v[16:19]
s_waitcnt vmcnt(27)
ds_read_b64_tr_b16 v[120:121], v205 offset:24576
v_mfma_f32_16x16x32_bf16 v[20:23], a[116:119], v[128:131], v[20:23]
s_waitcnt vmcnt(26)
v_mfma_f32_16x16x32_bf16 v[24:27], a[180:183], v[128:131], v[24:27]
s_waitcnt vmcnt(25)
ds_read_b64_tr_b16 v[122:123], v205 offset:26624
v_mfma_f32_16x16x32_bf16 v[28:31], a[244:247], v[128:131], v[28:31]
s_waitcnt lgkmcnt(10)
v_mfma_f32_16x16x32_bf16 v[32:35], a[52:55], v[132:135], v[32:35]
ds_read_b64_tr_b16 v[124:125], v207 offset:24576
v_mfma_f32_16x16x32_bf16 v[36:39], a[116:119], v[132:135], v[36:39]
v_mfma_f32_16x16x32_bf16 v[40:43], a[180:183], v[132:135], v[40:43]
ds_read_b64_tr_b16 v[126:127], v207 offset:26624
v_mfma_f32_16x16x32_bf16 v[44:47], a[244:247], v[132:135], v[44:47]
s_waitcnt lgkmcnt(10)
v_mfma_f32_16x16x32_bf16 v[48:51], a[52:55], v[136:139], v[48:51]
ds_read_b64_tr_b16 v[128:129], v201 offset:28672
v_mfma_f32_16x16x32_bf16 v[52:55], a[116:119], v[136:139], v[52:55]
v_mfma_f32_16x16x32_bf16 v[56:59], a[180:183], v[136:139], v[56:59]
ds_read_b64_tr_b16 v[130:131], v201 offset:30720
v_mfma_f32_16x16x32_bf16 v[60:63], a[244:247], v[136:139], v[60:63]
s_waitcnt lgkmcnt(10)
v_mfma_f32_16x16x32_bf16 v[64:67], a[52:55], v[140:143], v[64:67]
ds_read_b64_tr_b16 v[132:133], v203 offset:28672
v_mfma_f32_16x16x32_bf16 v[68:71], a[116:119], v[140:143], v[68:71]
v_mfma_f32_16x16x32_bf16 v[72:75], a[180:183], v[140:143], v[72:75]
ds_read_b64_tr_b16 v[134:135], v203 offset:30720
v_mfma_f32_16x16x32_bf16 v[76:79], a[244:247], v[140:143], v[76:79]
s_waitcnt vmcnt(24) lgkmcnt(10)
v_mfma_f32_16x16x32_bf16 v[16:19], a[56:59], v[112:115], v[16:19]
s_waitcnt vmcnt(23)
ds_read_b64_tr_b16 v[136:137], v205 offset:28672
v_mfma_f32_16x16x32_bf16 v[20:23], a[120:123], v[112:115], v[20:23]
s_waitcnt vmcnt(22)
v_mfma_f32_16x16x32_bf16 v[24:27], a[184:187], v[112:115], v[24:27]
s_waitcnt vmcnt(21)
ds_read_b64_tr_b16 v[138:139], v205 offset:30720
v_mfma_f32_16x16x32_bf16 v[28:31], a[248:251], v[112:115], v[28:31]
s_waitcnt lgkmcnt(10)
v_mfma_f32_16x16x32_bf16 v[32:35], a[56:59], v[116:119], v[32:35]
ds_read_b64_tr_b16 v[140:141], v207 offset:28672
v_mfma_f32_16x16x32_bf16 v[36:39], a[120:123], v[116:119], v[36:39]
v_mfma_f32_16x16x32_bf16 v[40:43], a[184:187], v[116:119], v[40:43]
ds_read_b64_tr_b16 v[142:143], v207 offset:30720
v_add_u32 v7, s29, v3
s_waitcnt vmcnt(1) lgkmcnt(0)
s_barrier
v_mfma_f32_16x16x32_bf16 v[44:47], a[248:251], v[116:119], v[44:47]
ds_read_b64_tr_b16 v[80:81], v7
v_mfma_f32_16x16x32_bf16 v[48:51], a[56:59], v[120:123], v[48:51]
ds_read_b64_tr_b16 v[82:83], v7 offset:2048
v_mfma_f32_16x16x32_bf16 v[52:55], a[120:123], v[120:123], v[52:55]
ds_read_b64_tr_b16 v[84:85], v7 offset:4096
v_mfma_f32_16x16x32_bf16 v[56:59], a[184:187], v[120:123], v[56:59]
ds_read_b64_tr_b16 v[86:87], v7 offset:6144
v_mfma_f32_16x16x32_bf16 v[60:63], a[248:251], v[120:123], v[60:63]
ds_read_b64_tr_b16 v[88:89], v7 offset:8192
v_mfma_f32_16x16x32_bf16 v[64:67], a[56:59], v[124:127], v[64:67]
ds_read_b64_tr_b16 v[90:91], v7 offset:10240
v_mfma_f32_16x16x32_bf16 v[68:71], a[120:123], v[124:127], v[68:71]
ds_read_b64_tr_b16 v[92:93], v7 offset:12288
v_mfma_f32_16x16x32_bf16 v[72:75], a[184:187], v[124:127], v[72:75]
v_mfma_f32_16x16x32_bf16 v[76:79], a[248:251], v[124:127], v[76:79]
ds_read_b64_tr_b16 v[94:95], v7 offset:14336
v_mfma_f32_16x16x32_bf16 v[16:19], a[60:63], v[128:131], v[16:19]
ds_read_b64_tr_b16 v[96:97], v7 offset:16384
v_mfma_f32_16x16x32_bf16 v[20:23], a[124:127], v[128:131], v[20:23]
ds_read_b64_tr_b16 v[98:99], v7 offset:18432
v_mfma_f32_16x16x32_bf16 v[24:27], a[188:191], v[128:131], v[24:27]
v_mfma_f32_16x16x32_bf16 v[28:31], a[252:255], v[128:131], v[28:31]
ds_read_b64_tr_b16 v[100:101], v7 offset:20480
v_mfma_f32_16x16x32_bf16 v[32:35], a[60:63], v[132:135], v[32:35]
ds_read_b64_tr_b16 v[102:103], v7 offset:22528
v_mfma_f32_16x16x32_bf16 v[36:39], a[124:127], v[132:135], v[36:39]
v_mfma_f32_16x16x32_bf16 v[40:43], a[188:191], v[132:135], v[40:43]
ds_read_b64_tr_b16 v[104:105], v7 offset:24576
v_mfma_f32_16x16x32_bf16 v[44:47], a[252:255], v[132:135], v[44:47]
ds_read_b64_tr_b16 v[106:107], v7 offset:26624
v_mfma_f32_16x16x32_bf16 v[48:51], a[60:63], v[136:139], v[48:51]
v_mfma_f32_16x16x32_bf16 v[52:55], a[124:127], v[136:139], v[52:55]
ds_read_b64_tr_b16 v[108:109], v7 offset:28672
v_mfma_f32_16x16x32_bf16 v[56:59], a[188:191], v[136:139], v[56:59]
ds_read_b64_tr_b16 v[110:111], v7 offset:30720
v_mfma_f32_16x16x32_bf16 v[60:63], a[252:255], v[136:139], v[60:63]
v_mfma_f32_16x16x32_bf16 v[64:67], a[60:63], v[140:143], v[64:67]
v_mfma_f32_16x16x32_bf16 v[68:71], a[124:127], v[140:143], v[68:71]
v_mfma_f32_16x16x32_bf16 v[72:75], a[188:191], v[140:143], v[72:75]
v_mfma_f32_16x16x32_bf16 v[76:79], a[252:255], v[140:143], v[76:79]
s_nop 7
v_cvt_pk_bf16_f32 v152, v16, v17
v_cvt_pk_bf16_f32 v153, v18, v19
v_cvt_pk_bf16_f32 v154, v20, v21
v_cvt_pk_bf16_f32 v155, v22, v23
buffer_store_dwordx4 v[152:155], v2, s[52:55], s33 offen sc1
v_cvt_pk_bf16_f32 v156, v24, v25
v_cvt_pk_bf16_f32 v157, v26, v27
v_cvt_pk_bf16_f32 v158, v28, v29
v_cvt_pk_bf16_f32 v159, v30, v31
s_add_u32 s35, s33, 16384
buffer_store_dwordx4 v[156:159], v2, s[52:55], s35 offen sc1
v_cvt_pk_bf16_f32 v160, v32, v33
v_cvt_pk_bf16_f32 v161, v34, v35
v_cvt_pk_bf16_f32 v162, v36, v37
v_cvt_pk_bf16_f32 v163, v38, v39
buffer_store_dwordx4 v[160:163], v2, s[52:55], s33 offen offset:1024 sc1
v_cvt_pk_bf16_f32 v164, v40, v41
v_cvt_pk_bf16_f32 v165, v42, v43
v_cvt_pk_bf16_f32 v166, v44, v45
v_cvt_pk_bf16_f32 v167, v46, v47
s_add_u32 s35, s33, 16384
buffer_store_dwordx4 v[164:167], v2, s[52:55], s35 offen offset:1024 sc1
s_getpc_b64 s[90:91]
L_ct_apV:
s_add_u32 s90, s90, ap_kernel-L_ct_apV
s_addc_u32 s91, s91, 0
s_lshr_b32 s38, s2, 3
s_and_b32 s38, s38, 31
s_mul_i32 s38, s38, 2176
v_min_u32 v238, 16, v0
v_lshlrev_b32 v238, 7, v238
v_add_u32 v238, s38, v238
global_load_dword v240, v238, s[90:91]
s_mov_b32 s34, s33
s_mov_b32 s58, s54
s_add_u32 s21, s21, 1
s_bitcmp1_b32 s21, 0
s_cselect_b32 s37, 0, 1040384
s_add_u32 s33, s33, 4096
s_add_u32 s33, s33, s37
s_xor_b32 s27, s27, 65536
s_xor_b32 s29, s29, 65536
s_add_u32 s28, s27, 32768
s_sub_u32 s22, s22, 1
s_cmp_lg_u32 s22, 0
s_branch L_p1_loopV
L_p1_oldV:
s_mov_b32 m0, s30
s_mov_b32 s31, s32
buffer_load_dwordx4 v9, s[44:47], s31 offen lds
s_add_u32 m0, m0, 4096
s_add_u32 s31, s31, 262144
buffer_load_dwordx4 v9, s[44:47], s31 offen lds
s_add_u32 m0, m0, 4096
s_add_u32 s31, s31, 262144
buffer_load_dwordx4 v9, s[44:47], s31 offen lds
s_add_u32 m0, m0, 4096
s_add_u32 s31, s31, 262144
buffer_load_dwordx4 v9, s[44:47], s31 offen lds
s_add_u32 m0, m0, 4096
s_add_u32 s31, s31, 262144
buffer_load_dwordx4 v9, s[44:47], s31 offen lds
s_add_u32 m0, m0, 4096
s_add_u32 s31, s31, 262144
buffer_load_dwordx4 v9, s[44:47], s31 offen lds
s_add_u32 m0, m0, 4096
s_add_u32 s31, s31, 262144
buffer_load_dwordx4 v9, s[44:47], s31 offen lds
s_add_u32 m0, m0, 4096
s_add_u32 s31, s31, 262144
buffer_load_dwordx4 v9, s[44:47], s31 offen lds
s_add_u32 m0, m0, 4096
s_add_u32 s31, s31, 262144
buffer_load_dwordx4 v9, s[44:47], s31 offen lds
s_add_u32 m0, m0, 4096
s_add_u32 s31, s31, 262144
buffer_load_dwordx4 v9, s[44:47], s31 offen lds
s_add_u32 m0, m0, 4096
s_add_u32 s31, s31, 262144
buffer_load_dwordx4 v9, s[44:47], s31 offen lds
s_add_u32 m0, m0, 4096
s_add_u32 s31, s31, 262144
buffer_load_dwordx4 v9, s[44:47], s31 offen lds
s_add_u32 m0, m0, 4096
s_add_u32 s31, s31, 262144
buffer_load_dwordx4 v9, s[44:47], s31 offen lds
s_add_u32 m0, m0, 4096
s_add_u32 s31, s31, 262144
buffer_load_dwordx4 v9, s[44:47], s31 offen lds
s_add_u32 m0, m0, 4096
s_add_u32 s31, s31, 262144
buffer_load_dwordx4 v9, s[44:47], s31 offen lds
s_add_u32 m0, m0, 4096
s_add_u32 s31, s31, 262144
buffer_load_dwordx4 v9, s[44:47], s31 offen lds
s_waitcnt vmcnt(0)
s_barrier
v_add_u32 v7, s27, v3
s_nop 0
ds_read_b64_tr_b16 v[80:81], v7
ds_read_b64_tr_b16 v[82:83], v7 offset:2048
ds_read_b64_tr_b16 v[84:85], v7 offset:4096
ds_read_b64_tr_b16 v[86:87], v7 offset:6144
ds_read_b64_tr_b16 v[88:89], v7 offset:8192
ds_read_b64_tr_b16 v[90:91], v7 offset:10240
ds_read_b64_tr_b16 v[92:93], v7 offset:12288
ds_read_b64_tr_b16 v[94:95], v7 offset:14336
ds_read_b64_tr_b16 v[96:97], v7 offset:16384
ds_read_b64_tr_b16 v[98:99], v7 offset:18432
ds_read_b64_tr_b16 v[100:101], v7 offset:20480
ds_read_b64_tr_b16 v[102:103], v7 offset:22528
ds_read_b64_tr_b16 v[104:105], v7 offset:24576
ds_read_b64_tr_b16 v[106:107], v7 offset:26624
ds_read_b64_tr_b16 v[108:109], v7 offset:28672
ds_read_b64_tr_b16 v[110:111], v7 offset:30720
L_p1_loopV:
s_waitcnt lgkmcnt(10)
v_mfma_f32_16x16x32_bf16 v[16:19], a[0:3], v[80:83], 0
s_add_u32 s32, s32, 128
v_add_u32 v8, s28, v3
v_mfma_f32_16x16x32_bf16 v[16:19], a[4:7], v[84:87], v[16:19]
s_xor_b32 s30, s30, 65536
ds_read_b64_tr_b16 v[112:113], v8
v_mfma_f32_16x16x32_bf16 v[16:19], a[8:11], v[88:91], v[16:19]
s_waitcnt lgkmcnt(5)
s_cmp_eq_u32 s22, 1
s_cselect_b32 s46, 0, s46
s_mov_b32 m0, s30
ds_read_b64_tr_b16 v[114:115], v8 offset:2048
v_mfma_f32_16x16x32_bf16 v[16:19], a[12:15], v[92:95], v[16:19]
s_mov_b32 s31, s32
ds_read_b64_tr_b16 v[116:117], v8 offset:4096
v_mfma_f32_16x16x32_bf16 v[16:19], a[16:19], v[96:99], v[16:19]
buffer_load_dwordx4 v9, s[44:47], s31 offen lds
v_mfma_f32_16x16x32_bf16 v[16:19], a[20:23], v[100:103], v[16:19]
s_waitcnt lgkmcnt(3)
ds_read_b64_tr_b16 v[118:119], v8 offset:6144
v_mfma_f32_16x16x32_bf16 v[16:19], a[24:27], v[104:107], v[16:19]
v_mfma_f32_16x16x32_bf16 v[16:19], a[28:31], v[108:111], v[16:19]
s_add_u32 m0, m0, 4096
ds_read_b64_tr_b16 v[120:121], v8 offset:8192
v_mfma_f32_16x16x32_bf16 v[20:23], a[64:67], v[80:83], 0
s_add_u32 s31, s31, 262144
v_mfma_f32_16x16x32_bf16 v[20:23], a[68:71], v[84:87], v[20:23]
ds_read_b64_tr_b16 v[122:123], v8 offset:10240
v_cvt_pk_bf16_f32 v152, v48, v49
v_mfma_f32_16x16x32_bf16 v[20:23], a[72:75], v[88:91], v[20:23]
buffer_load_dwordx4 v9, s[44:47], s31 offen lds
v_mfma_f32_16x16x32_bf16 v[20:23], a[76:79], v[92:95], v[20:23]
ds_read_b64_tr_b16 v[124:125], v8 offset:12288
v_mfma_f32_16x16x32_bf16 v[20:23], a[80:83], v[96:99], v[20:23]
v_cvt_pk_bf16_f32 v153, v50, v51
v_mfma_f32_16x16x32_bf16 v[20:23], a[84:87], v[100:103], v[20:23]
ds_read_b64_tr_b16 v[126:127], v8 offset:14336
v_mfma_f32_16x16x32_bf16 v[20:23], a[88:91], v[104:107], v[20:23]
v_mfma_f32_16x16x32_bf16 v[20:23], a[92:95], v[108:111], v[20:23]
s_add_u32 m0, m0, 4096
ds_read_b64_tr_b16 v[128:129], v8 offset:16384
v_mfma_f32_16x16x32_bf16 v[24:27], a[128:131], v[80:83], 0
s_add_u32 s31, s31, 262144
ds_read_b64_tr_b16 v[130:131], v8 offset:18432
v_mfma_f32_16x16x32_bf16 v[24:27], a[132:135], v[84:87], v[24:27]
v_mfma_f32_16x16x32_bf16 v[24:27], a[136:139], v[88:91], v[24:27]
ds_read_b64_tr_b16 v[132:133], v8 offset:20480
v_cvt_pk_bf16_f32 v154, v52, v53
v_mfma_f32_16x16x32_bf16 v[24:27], a[140:143], v[92:95], v[24:27]
buffer_load_dwordx4 v9, s[44:47], s31 offen lds
v_mfma_f32_16x16x32_bf16 v[24:27], a[144:147], v[96:99], v[24:27]
ds_read_b64_tr_b16 v[134:135], v8 offset:22528
v_mfma_f32_16x16x32_bf16 v[24:27], a[148:151], v[100:103], v[24:27]
v_mfma_f32_16x16x32_bf16 v[24:27], a[152:155], v[104:107], v[24:27]
ds_read_b64_tr_b16 v[136:137], v8 offset:24576
v_mfma_f32_16x16x32_bf16 v[24:27], a[156:159], v[108:111], v[24:27]
s_add_u32 m0, m0, 4096
v_mfma_f32_16x16x32_bf16 v[28:31], a[192:195], v[80:83], 0
s_add_u32 s31, s31, 262144
ds_read_b64_tr_b16 v[138:139], v8 offset:26624
v_cvt_pk_bf16_f32 v155, v54, v55
v_mfma_f32_16x16x32_bf16 v[28:31], a[196:199], v[84:87], v[28:31]
v_mfma_f32_16x16x32_bf16 v[28:31], a[200:203], v[88:91], v[28:31]
ds_read_b64_tr_b16 v[140:141], v8 offset:28672
v_mfma_f32_16x16x32_bf16 v[28:31], a[204:207], v[92:95], v[28:31]
buffer_load_dwordx4 v9, s[44:47], s31 offen lds
v_mfma_f32_16x16x32_bf16 v[28:31], a[208:211], v[96:99], v[28:31]
ds_read_b64_tr_b16 v[142:143], v8 offset:30720
v_mfma_f32_16x16x32_bf16 v[28:31], a[212:215], v[100:103], v[28:31]
v_mfma_f32_16x16x32_bf16 v[28:31], a[216:219], v[104:107], v[28:31]
buffer_store_dwordx4 v[152:155], v2, s[56:59], s34 offen offset:2048 sc1
v_add_u32 v7, s27, v4
v_mfma_f32_16x16x32_bf16 v[28:31], a[220:223], v[108:111], v[28:31]
s_waitcnt lgkmcnt(10)
s_add_u32 m0, m0, 4096
v_mfma_f32_16x16x32_bf16 v[16:19], a[32:35], v[112:115], v[16:19]
s_add_u32 s31, s31, 262144
ds_read_b64_tr_b16 v[80:81], v7
v_mfma_f32_16x16x32_bf16 v[16:19], a[36:39], v[116:119], v[16:19]
ds_read_b64_tr_b16 v[82:83], v7 offset:2048
v_mfma_f32_16x16x32_bf16 v[16:19], a[40:43], v[120:123], v[16:19]
s_waitcnt lgkmcnt(6)
buffer_load_dwordx4 v9, s[44:47], s31 offen lds
v_mfma_f32_16x16x32_bf16 v[16:19], a[44:47], v[124:127], v[16:19]
ds_read_b64_tr_b16 v[84:85], v7 offset:4096
v_cvt_pk_bf16_f32 v156, v56, v57
v_mfma_f32_16x16x32_bf16 v[16:19], a[48:51], v[128:131], v[16:19]
v_mfma_f32_16x16x32_bf16 v[16:19], a[52:55], v[132:135], v[16:19]
s_waitcnt lgkmcnt(3)
ds_read_b64_tr_b16 v[86:87], v7 offset:6144
v_mfma_f32_16x16x32_bf16 v[16:19], a[56:59], v[136:139], v[16:19]
v_mfma_f32_16x16x32_bf16 v[16:19], a[60:63], v[140:143], v[16:19]
s_add_u32 m0, m0, 4096
ds_read_b64_tr_b16 v[88:89], v7 offset:8192
v_mfma_f32_16x16x32_bf16 v[20:23], a[96:99], v[112:115], v[20:23]
s_add_u32 s31, s31, 262144
v_mfma_f32_16x16x32_bf16 v[20:23], a[100:103], v[116:119], v[20:23]
ds_read_b64_tr_b16 v[90:91], v7 offset:10240
v_cvt_pk_bf16_f32 v157, v58, v59
v_mfma_f32_16x16x32_bf16 v[20:23], a[104:107], v[120:123], v[20:23]
buffer_load_dwordx4 v9, s[44:47], s31 offen lds
v_mfma_f32_16x16x32_bf16 v[20:23], a[108:111], v[124:127], v[20:23]
ds_read_b64_tr_b16 v[92:93], v7 offset:12288
v_mfma_f32_16x16x32_bf16 v[20:23], a[112:115], v[128:131], v[20:23]
v_mfma_f32_16x16x32_bf16 v[20:23], a[116:119], v[132:135], v[20:23]
ds_read_b64_tr_b16 v[94:95], v7 offset:14336
v_mfma_f32_16x16x32_bf16 v[20:23], a[120:123], v[136:139], v[20:23]
s_add_u32 m0, m0, 4096
v_mfma_f32_16x16x32_bf16 v[20:23], a[124:127], v[140:143], v[20:23]
s_add_u32 s31, s31, 262144
ds_read_b64_tr_b16 v[96:97], v7 offset:16384
v_cvt_pk_bf16_f32 v158, v60, v61
v_mfma_f32_16x16x32_bf16 v[24:27], a[160:163], v[112:115], v[24:27]
ds_read_b64_tr_b16 v[98:99], v7 offset:18432
v_mfma_f32_16x16x32_bf16 v[24:27], a[164:167], v[116:119], v[24:27]
buffer_load_dwordx4 v9, s[44:47], s31 offen lds
v_mfma_f32_16x16x32_bf16 v[24:27], a[168:171], v[120:123], v[24:27]
ds_read_b64_tr_b16 v[100:101], v7 offset:20480
v_mfma_f32_16x16x32_bf16 v[24:27], a[172:175], v[124:127], v[24:27]
v_mfma_f32_16x16x32_bf16 v[24:27], a[176:179], v[128:131], v[24:27]
ds_read_b64_tr_b16 v[102:103], v7 offset:22528
v_mfma_f32_16x16x32_bf16 v[24:27], a[180:183], v[132:135], v[24:27]
v_cvt_pk_bf16_f32 v159, v62, v63
v_mfma_f32_16x16x32_bf16 v[24:27], a[184:187], v[136:139], v[24:27]
s_add_u32 m0, m0, 4096
ds_read_b64_tr_b16 v[104:105], v7 offset:24576
v_mfma_f32_16x16x32_bf16 v[24:27], a[188:191], v[140:143], v[24:27]
s_add_u32 s31, s31, 262144
v_mfma_f32_16x16x32_bf16 v[28:31], a[224:227], v[112:115], v[28:31]
ds_read_b64_tr_b16 v[106:107], v7 offset:26624
v_mfma_f32_16x16x32_bf16 v[28:31], a[228:231], v[116:119], v[28:31]
buffer_load_dwordx4 v9, s[44:47], s31 offen lds
v_mfma_f32_16x16x32_bf16 v[28:31], a[232:235], v[120:123], v[28:31]
ds_read_b64_tr_b16 v[108:109], v7 offset:28672
v_mfma_f32_16x16x32_bf16 v[28:31], a[236:239], v[124:127], v[28:31]
s_add_u32 s35, s34, 16384
buffer_store_dwordx4 v[156:159], v2, s[56:59], s35 offen offset:2048 sc1
v_mfma_f32_16x16x32_bf16 v[28:31], a[240:243], v[128:131], v[28:31]
ds_read_b64_tr_b16 v[110:111], v7 offset:30720
v_mfma_f32_16x16x32_bf16 v[28:31], a[244:247], v[132:135], v[28:31]
v_mfma_f32_16x16x32_bf16 v[28:31], a[248:251], v[136:139], v[28:31]
s_add_u32 m0, m0, 4096
v_add_u32 v8, s28, v4
v_mfma_f32_16x16x32_bf16 v[28:31], a[252:255], v[140:143], v[28:31]
s_waitcnt lgkmcnt(10)
s_add_u32 s31, s31, 262144
v_mfma_f32_16x16x32_bf16 v[32:35], a[0:3], v[80:83], 0
ds_read_b64_tr_b16 v[112:113], v8
v_cvt_pk_bf16_f32 v160, v64, v65
v_mfma_f32_16x16x32_bf16 v[32:35], a[4:7], v[84:87], v[32:35]
ds_read_b64_tr_b16 v[114:115], v8 offset:2048
v_mfma_f32_16x16x32_bf16 v[32:35], a[8:11], v[88:91], v[32:35]
s_waitcnt lgkmcnt(6)
buffer_load_dwordx4 v9, s[44:47], s31 offen lds
v_mfma_f32_16x16x32_bf16 v[32:35], a[12:15], v[92:95], v[32:35]
ds_read_b64_tr_b16 v[116:117], v8 offset:4096
v_mfma_f32_16x16x32_bf16 v[32:35], a[16:19], v[96:99], v[32:35]
v_mfma_f32_16x16x32_bf16 v[32:35], a[20:23], v[100:103], v[32:35]
s_waitcnt lgkmcnt(3)
ds_read_b64_tr_b16 v[118:119], v8 offset:6144
v_mfma_f32_16x16x32_bf16 v[32:35], a[24:27], v[104:107], v[32:35]
s_add_u32 m0, m0, 4096
v_cvt_pk_bf16_f32 v161, v66, v67
v_mfma_f32_16x16x32_bf16 v[32:35], a[28:31], v[108:111], v[32:35]
s_add_u32 s31, s31, 262144
ds_read_b64_tr_b16 v[120:121], v8 offset:8192
v_mfma_f32_16x16x32_bf16 v[36:39], a[64:67], v[80:83], 0
v_mfma_f32_16x16x32_bf16 v[36:39], a[68:71], v[84:87], v[36:39]
ds_read_b64_tr_b16 v[122:123], v8 offset:10240
v_mfma_f32_16x16x32_bf16 v[36:39], a[72:75], v[88:91], v[36:39]
buffer_load_dwordx4 v9, s[44:47], s31 offen lds
v_mfma_f32_16x16x32_bf16 v[36:39], a[76:79], v[92:95], v[36:39]
ds_read_b64_tr_b16 v[124:125], v8 offset:12288
v_mfma_f32_16x16x32_bf16 v[36:39], a[80:83], v[96:99], v[36:39]
v_cvt_pk_bf16_f32 v162, v68, v69
v_mfma_f32_16x16x32_bf16 v[36:39], a[84:87], v[100:103], v[36:39]
ds_read_b64_tr_b16 v[126:127], v8 offset:14336
v_mfma_f32_16x16x32_bf16 v[36:39], a[88:91], v[104:107], v[36:39]
s_add_u32 m0, m0, 4096
v_mfma_f32_16x16x32_bf16 v[36:39], a[92:95], v[108:111], v[36:39]
s_add_u32 s31, s31, 262144
ds_read_b64_tr_b16 v[128:129], v8 offset:16384
v_mfma_f32_16x16x32_bf16 v[40:43], a[128:131], v[80:83], 0
ds_read_b64_tr_b16 v[130:131], v8 offset:18432
v_mfma_f32_16x16x32_bf16 v[40:43], a[132:135], v[84:87], v[40:43]
buffer_load_dwordx4 v9, s[44:47], s31 offen lds
v_cvt_pk_bf16_f32 v163, v70, v71
v_mfma_f32_16x16x32_bf16 v[40:43], a[136:139], v[88:91], v[40:43]
ds_read_b64_tr_b16 v[132:133], v8 offset:20480
v_mfma_f32_16x16x32_bf16 v[40:43], a[140:143], v[92:95], v[40:43]
v_mfma_f32_16x16x32_bf16 v[40:43], a[144:147], v[96:99], v[40:43]
ds_read_b64_tr_b16 v[134:135], v8 offset:22528
v_mfma_f32_16x16x32_bf16 v[40:43], a[148:151], v[100:103], v[40:43]
s_add_u32 m0, m0, 4096
v_mfma_f32_16x16x32_bf16 v[40:43], a[152:155], v[104:107], v[40:43]
s_add_u32 s31, s31, 262144
ds_read_b64_tr_b16 v[136:137], v8 offset:24576
v_mfma_f32_16x16x32_bf16 v[40:43], a[156:159], v[108:111], v[40:43]
buffer_store_dwordx4 v[160:163], v2, s[56:59], s34 offen offset:3072 sc1
v_mfma_f32_16x16x32_bf16 v[44:47], a[192:195], v[80:83], 0
ds_read_b64_tr_b16 v[138:139], v8 offset:26624
v_mfma_f32_16x16x32_bf16 v[44:47], a[196:199], v[84:87], v[44:47]
buffer_load_dwordx4 v9, s[44:47], s31 offen lds
v_mfma_f32_16x16x32_bf16 v[44:47], a[200:203], v[88:91], v[44:47]
ds_read_b64_tr_b16 v[140:141], v8 offset:28672
v_mfma_f32_16x16x32_bf16 v[44:47], a[204:207], v[92:95], v[44:47]
v_mfma_f32_16x16x32_bf16 v[44:47], a[208:211], v[96:99], v[44:47]
ds_read_b64_tr_b16 v[142:143], v8 offset:30720
v_mfma_f32_16x16x32_bf16 v[44:47], a[212:215], v[100:103], v[44:47]
s_add_u32 m0, m0, 4096
v_cvt_pk_bf16_f32 v164, v72, v73
v_mfma_f32_16x16x32_bf16 v[44:47], a[216:219], v[104:107], v[44:47]
s_add_u32 s31, s31, 262144
v_add_u32 v7, s27, v5
v_mfma_f32_16x16x32_bf16 v[44:47], a[220:223], v[108:111], v[44:47]
s_waitcnt lgkmcnt(10)
v_mfma_f32_16x16x32_bf16 v[32:35], a[32:35], v[112:115], v[32:35]
ds_read_b64_tr_b16 v[80:81], v7
v_mfma_f32_16x16x32_bf16 v[32:35], a[36:39], v[116:119], v[32:35]
ds_read_b64_tr_b16 v[82:83], v7 offset:2048
v_mfma_f32_16x16x32_bf16 v[32:35], a[40:43], v[120:123], v[32:35]
s_waitcnt lgkmcnt(6)
buffer_load_dwordx4 v9, s[44:47], s31 offen lds
v_mfma_f32_16x16x32_bf16 v[32:35], a[44:47], v[124:127], v[32:35]
ds_read_b64_tr_b16 v[84:85], v7 offset:4096
v_cvt_pk_bf16_f32 v165, v74, v75
v_mfma_f32_16x16x32_bf16 v[32:35], a[48:51], v[128:131], v[32:35]
v_mfma_f32_16x16x32_bf16 v[32:35], a[52:55], v[132:135], v[32:35]
s_waitcnt lgkmcnt(3)
s_add_u32 m0, m0, 4096
ds_read_b64_tr_b16 v[86:87], v7 offset:6144
v_mfma_f32_16x16x32_bf16 v[32:35], a[56:59], v[136:139], v[32:35]
s_add_u32 s31, s31, 262144
v_mfma_f32_16x16x32_bf16 v[32:35], a[60:63], v[140:143], v[32:35]
ds_read_b64_tr_b16 v[88:89], v7 offset:8192
v_mfma_f32_16x16x32_bf16 v[36:39], a[96:99], v[112:115], v[36:39]
buffer_load_dwordx4 v9, s[44:47], s31 offen lds
v_cvt_pk_bf16_f32 v166, v76, v77
v_mfma_f32_16x16x32_bf16 v[36:39], a[100:103], v[116:119], v[36:39]
ds_read_b64_tr_b16 v[90:91], v7 offset:10240
v_mfma_f32_16x16x32_bf16 v[36:39], a[104:107], v[120:123], v[36:39]
v_mfma_f32_16x16x32_bf16 v[36:39], a[108:111], v[124:127], v[36:39]
ds_read_b64_tr_b16 v[92:93], v7 offset:12288
v_mfma_f32_16x16x32_bf16 v[36:39], a[112:115], v[128:131], v[36:39]
v_mfma_f32_16x16x32_bf16 v[36:39], a[116:119], v[132:135], v[36:39]
s_add_u32 m0, m0, 4096
ds_read_b64_tr_b16 v[94:95], v7 offset:14336
v_mfma_f32_16x16x32_bf16 v[36:39], a[120:123], v[136:139], v[36:39]
s_add_u32 s31, s31, 262144
v_cvt_pk_bf16_f32 v167, v78, v79
v_mfma_f32_16x16x32_bf16 v[36:39], a[124:127], v[140:143], v[36:39]
ds_read_b64_tr_b16 v[96:97], v7 offset:16384
v_mfma_f32_16x16x32_bf16 v[40:43], a[160:163], v[112:115], v[40:43]
ds_read_b64_tr_b16 v[98:99], v7 offset:18432
v_mfma_f32_16x16x32_bf16 v[40:43], a[164:167], v[116:119], v[40:43]
buffer_load_dwordx4 v9, s[44:47], s31 offen lds
v_mfma_f32_16x16x32_bf16 v[40:43], a[168:171], v[120:123], v[40:43]
ds_read_b64_tr_b16 v[100:101], v7 offset:20480
v_mfma_f32_16x16x32_bf16 v[40:43], a[172:175], v[124:127], v[40:43]
v_mfma_f32_16x16x32_bf16 v[40:43], a[176:179], v[128:131], v[40:43]
ds_read_b64_tr_b16 v[102:103], v7 offset:22528
v_mfma_f32_16x16x32_bf16 v[40:43], a[180:183], v[132:135], v[40:43]
s_add_u32 m0, m0, 4096
s_add_u32 s35, s34, 16384
buffer_store_dwordx4 v[164:167], v2, s[56:59], s35 offen offset:3072 sc1
v_mfma_f32_16x16x32_bf16 v[40:43], a[184:187], v[136:139], v[40:43]
s_add_u32 s31, s31, 262144
ds_read_b64_tr_b16 v[104:105], v7 offset:24576
v_mfma_f32_16x16x32_bf16 v[40:43], a[188:191], v[140:143], v[40:43]
v_mfma_f32_16x16x32_bf16 v[44:47], a[224:227], v[112:115], v[44:47]
ds_read_b64_tr_b16 v[106:107], v7 offset:26624
v_mfma_f32_16x16x32_bf16 v[44:47], a[228:231], v[116:119], v[44:47]
buffer_load_dwordx4 v9, s[44:47], s31 offen lds
v_mfma_f32_16x16x32_bf16 v[44:47], a[232:235], v[120:123], v[44:47]
ds_read_b64_tr_b16 v[108:109], v7 offset:28672
v_mfma_f32_16x16x32_bf16 v[44:47], a[236:239], v[124:127], v[44:47]
v_mfma_f32_16x16x32_bf16 v[44:47], a[240:243], v[128:131], v[44:47]
ds_read_b64_tr_b16 v[110:111], v7 offset:30720
v_mfma_f32_16x16x32_bf16 v[44:47], a[244:247], v[132:135], v[44:47]
v_mfma_f32_16x16x32_bf16 v[44:47], a[248:251], v[136:139], v[44:47]
v_add_u32 v8, s28, v5
v_mfma_f32_16x16x32_bf16 v[44:47], a[252:255], v[140:143], v[44:47]
s_waitcnt lgkmcnt(10)
v_mfma_f32_16x16x32_bf16 v[48:51], a[0:3], v[80:83], 0
ds_read_b64_tr_b16 v[112:113], v8
v_mfma_f32_16x16x32_bf16 v[48:51], a[4:7], v[84:87], v[48:51]
ds_read_b64_tr_b16 v[114:115], v8 offset:2048
v_mfma_f32_16x16x32_bf16 v[48:51], a[8:11], v[88:91], v[48:51]
s_waitcnt lgkmcnt(6)
v_mfma_f32_16x16x32_bf16 v[48:51], a[12:15], v[92:95], v[48:51]
ds_read_b64_tr_b16 v[116:117], v8 offset:4096
v_mfma_f32_16x16x32_bf16 v[48:51], a[16:19], v[96:99], v[48:51]
v_mfma_f32_16x16x32_bf16 v[48:51], a[20:23], v[100:103], v[48:51]
s_waitcnt lgkmcnt(3)
ds_read_b64_tr_b16 v[118:119], v8 offset:6144
v_mfma_f32_16x16x32_bf16 v[48:51], a[24:27], v[104:107], v[48:51]
v_mfma_f32_16x16x32_bf16 v[48:51], a[28:31], v[108:111], v[48:51]
ds_read_b64_tr_b16 v[120:121], v8 offset:8192
v_mfma_f32_16x16x32_bf16 v[52:55], a[64:67], v[80:83], 0
v_mfma_f32_16x16x32_bf16 v[52:55], a[68:71], v[84:87], v[52:55]
ds_read_b64_tr_b16 v[122:123], v8 offset:10240
v_cvt_pk_bf16_f32 v152, v16, v17
v_mfma_f32_16x16x32_bf16 v[52:55], a[72:75], v[88:91], v[52:55]
v_mfma_f32_16x16x32_bf16 v[52:55], a[76:79], v[92:95], v[52:55]
ds_read_b64_tr_b16 v[124:125], v8 offset:12288
v_mfma_f32_16x16x32_bf16 v[52:55], a[80:83], v[96:99], v[52:55]
v_cvt_pk_bf16_f32 v153, v18, v19
v_mfma_f32_16x16x32_bf16 v[52:55], a[84:87], v[100:103], v[52:55]
ds_read_b64_tr_b16 v[126:127], v8 offset:14336
v_mfma_f32_16x16x32_bf16 v[52:55], a[88:91], v[104:107], v[52:55]
v_mfma_f32_16x16x32_bf16 v[52:55], a[92:95], v[108:111], v[52:55]
s_cmp_gt_u32 s22, 4
s_cselect_b32 s74, s77, 0
s_bitcmp1_b32 s78, 0
s_cselect_b32 s74, 0, s74
ds_read_b64_tr_b16 v[128:129], v8 offset:16384
v_mfma_f32_16x16x32_bf16 v[56:59], a[128:131], v[80:83], 0
ds_read_b64_tr_b16 v[130:131], v8 offset:18432
v_mfma_f32_16x16x32_bf16 v[56:59], a[132:135], v[84:87], v[56:59]
s_waitcnt vmcnt(24)
buffer_load_dword v232, v216, s[72:75], s76 offen
s_add_u32 s76, s76, 128
v_mfma_f32_16x16x32_bf16 v[56:59], a[136:139], v[88:91], v[56:59]
ds_read_b64_tr_b16 v[132:133], v8 offset:20480
v_cvt_pk_bf16_f32 v154, v20, v21
v_mfma_f32_16x16x32_bf16 v[56:59], a[140:143], v[92:95], v[56:59]
s_add_u32 s78, s78, 1
v_mfma_f32_16x16x32_bf16 v[56:59], a[144:147], v[96:99], v[56:59]
ds_read_b64_tr_b16 v[134:135], v8 offset:22528
v_mfma_f32_16x16x32_bf16 v[56:59], a[148:151], v[100:103], v[56:59]
v_mfma_f32_16x16x32_bf16 v[56:59], a[152:155], v[104:107], v[56:59]
ds_read_b64_tr_b16 v[136:137], v8 offset:24576
v_mfma_f32_16x16x32_bf16 v[56:59], a[156:159], v[108:111], v[56:59]
v_mfma_f32_16x16x32_bf16 v[60:63], a[192:195], v[80:83], 0
ds_read_b64_tr_b16 v[138:139], v8 offset:26624
v_cvt_pk_bf16_f32 v155, v22, v23
v_mfma_f32_16x16x32_bf16 v[60:63], a[196:199], v[84:87], v[60:63]
v_mfma_f32_16x16x32_bf16 v[60:63], a[200:203], v[88:91], v[60:63]
ds_read_b64_tr_b16 v[140:141], v8 offset:28672
v_mfma_f32_16x16x32_bf16 v[60:63], a[204:207], v[92:95], v[60:63]
v_mfma_f32_16x16x32_bf16 v[60:63], a[208:211], v[96:99], v[60:63]
ds_read_b64_tr_b16 v[142:143], v8 offset:30720
v_mfma_f32_16x16x32_bf16 v[60:63], a[212:215], v[100:103], v[60:63]
v_mfma_f32_16x16x32_bf16 v[60:63], a[216:219], v[104:107], v[60:63]
buffer_store_dwordx4 v[152:155], v2, s[52:55], s33 offen sc1
v_add_u32 v7, s27, v6
v_mfma_f32_16x16x32_bf16 v[60:63], a[220:223], v[108:111], v[60:63]
s_waitcnt lgkmcnt(10)
v_mfma_f32_16x16x32_bf16 v[48:51], a[32:35], v[112:115], v[48:51]
ds_read_b64_tr_b16 v[80:81], v7
v_mfma_f32_16x16x32_bf16 v[48:51], a[36:39], v[116:119], v[48:51]
ds_read_b64_tr_b16 v[82:83], v7 offset:2048
v_mfma_f32_16x16x32_bf16 v[48:51], a[40:43], v[120:123], v[48:51]
s_waitcnt lgkmcnt(6)
v_mfma_f32_16x16x32_bf16 v[48:51], a[44:47], v[124:127], v[48:51]
ds_read_b64_tr_b16 v[84:85], v7 offset:4096
v_cvt_pk_bf16_f32 v156, v24, v25
v_mfma_f32_16x16x32_bf16 v[48:51], a[48:51], v[128:131], v[48:51]
v_mfma_f32_16x16x32_bf16 v[48:51], a[52:55], v[132:135], v[48:51]
s_waitcnt lgkmcnt(3)
ds_read_b64_tr_b16 v[86:87], v7 offset:6144
v_mfma_f32_16x16x32_bf16 v[48:51], a[56:59], v[136:139], v[48:51]
v_mfma_f32_16x16x32_bf16 v[48:51], a[60:63], v[140:143], v[48:51]
ds_read_b64_tr_b16 v[88:89], v7 offset:8192
v_mfma_f32_16x16x32_bf16 v[52:55], a[96:99], v[112:115], v[52:55]
v_mfma_f32_16x16x32_bf16 v[52:55], a[100:103], v[116:119], v[52:55]
ds_read_b64_tr_b16 v[90:91], v7 offset:10240
v_cvt_pk_bf16_f32 v157, v26, v27
v_mfma_f32_16x16x32_bf16 v[52:55], a[104:107], v[120:123], v[52:55]
v_mfma_f32_16x16x32_bf16 v[52:55], a[108:111], v[124:127], v[52:55]
ds_read_b64_tr_b16 v[92:93], v7 offset:12288
v_mfma_f32_16x16x32_bf16 v[52:55], a[112:115], v[128:131], v[52:55]
v_mfma_f32_16x16x32_bf16 v[52:55], a[116:119], v[132:135], v[52:55]
ds_read_b64_tr_b16 v[94:95], v7 offset:14336
v_mfma_f32_16x16x32_bf16 v[52:55], a[120:123], v[136:139], v[52:55]
v_mfma_f32_16x16x32_bf16 v[52:55], a[124:127], v[140:143], v[52:55]
ds_read_b64_tr_b16 v[96:97], v7 offset:16384
v_cvt_pk_bf16_f32 v158, v28, v29
v_mfma_f32_16x16x32_bf16 v[56:59], a[160:163], v[112:115], v[56:59]
ds_read_b64_tr_b16 v[98:99], v7 offset:18432
v_mfma_f32_16x16x32_bf16 v[56:59], a[164:167], v[116:119], v[56:59]
v_mfma_f32_16x16x32_bf16 v[56:59], a[168:171], v[120:123], v[56:59]
ds_read_b64_tr_b16 v[100:101], v7 offset:20480
v_mfma_f32_16x16x32_bf16 v[56:59], a[172:175], v[124:127], v[56:59]
v_mfma_f32_16x16x32_bf16 v[56:59], a[176:179], v[128:131], v[56:59]
ds_read_b64_tr_b16 v[102:103], v7 offset:22528
v_mfma_f32_16x16x32_bf16 v[56:59], a[180:183], v[132:135], v[56:59]
v_cvt_pk_bf16_f32 v159, v30, v31
v_mfma_f32_16x16x32_bf16 v[56:59], a[184:187], v[136:139], v[56:59]
ds_read_b64_tr_b16 v[104:105], v7 offset:24576
v_mfma_f32_16x16x32_bf16 v[56:59], a[188:191], v[140:143], v[56:59]
v_mfma_f32_16x16x32_bf16 v[60:63], a[224:227], v[112:115], v[60:63]
ds_read_b64_tr_b16 v[106:107], v7 offset:26624
v_mfma_f32_16x16x32_bf16 v[60:63], a[228:231], v[116:119], v[60:63]
v_mfma_f32_16x16x32_bf16 v[60:63], a[232:235], v[120:123], v[60:63]
ds_read_b64_tr_b16 v[108:109], v7 offset:28672
v_mfma_f32_16x16x32_bf16 v[60:63], a[236:239], v[124:127], v[60:63]
s_add_u32 s35, s33, 16384
buffer_store_dwordx4 v[156:159], v2, s[52:55], s35 offen sc1
v_mfma_f32_16x16x32_bf16 v[60:63], a[240:243], v[128:131], v[60:63]
ds_read_b64_tr_b16 v[110:111], v7 offset:30720
v_mfma_f32_16x16x32_bf16 v[60:63], a[244:247], v[132:135], v[60:63]
v_mfma_f32_16x16x32_bf16 v[60:63], a[248:251], v[136:139], v[60:63]
v_add_u32 v8, s28, v6
v_mfma_f32_16x16x32_bf16 v[60:63], a[252:255], v[140:143], v[60:63]
s_waitcnt lgkmcnt(10)
v_mfma_f32_16x16x32_bf16 v[64:67], a[0:3], v[80:83], 0
ds_read_b64_tr_b16 v[112:113], v8
v_cvt_pk_bf16_f32 v160, v32, v33
v_mfma_f32_16x16x32_bf16 v[64:67], a[4:7], v[84:87], v[64:67]
ds_read_b64_tr_b16 v[114:115], v8 offset:2048
v_mfma_f32_16x16x32_bf16 v[64:67], a[8:11], v[88:91], v[64:67]
s_waitcnt lgkmcnt(6)
v_mfma_f32_16x16x32_bf16 v[64:67], a[12:15], v[92:95], v[64:67]
ds_read_b64_tr_b16 v[116:117], v8 offset:4096
v_mfma_f32_16x16x32_bf16 v[64:67], a[16:19], v[96:99], v[64:67]
v_mfma_f32_16x16x32_bf16 v[64:67], a[20:23], v[100:103], v[64:67]
s_waitcnt lgkmcnt(3)
ds_read_b64_tr_b16 v[118:119], v8 offset:6144
v_mfma_f32_16x16x32_bf16 v[64:67], a[24:27], v[104:107], v[64:67]
v_cvt_pk_bf16_f32 v161, v34, v35
v_mfma_f32_16x16x32_bf16 v[64:67], a[28:31], v[108:111], v[64:67]
ds_read_b64_tr_b16 v[120:121], v8 offset:8192
v_mfma_f32_16x16x32_bf16 v[68:71], a[64:67], v[80:83], 0
v_mfma_f32_16x16x32_bf16 v[68:71], a[68:71], v[84:87], v[68:71]
ds_read_b64_tr_b16 v[122:123], v8 offset:10240
v_mfma_f32_16x16x32_bf16 v[68:71], a[72:75], v[88:91], v[68:71]
v_mfma_f32_16x16x32_bf16 v[68:71], a[76:79], v[92:95], v[68:71]
ds_read_b64_tr_b16 v[124:125], v8 offset:12288
v_mfma_f32_16x16x32_bf16 v[68:71], a[80:83], v[96:99], v[68:71]
v_cvt_pk_bf16_f32 v162, v36, v37
v_mfma_f32_16x16x32_bf16 v[68:71], a[84:87], v[100:103], v[68:71]
ds_read_b64_tr_b16 v[126:127], v8 offset:14336
v_mfma_f32_16x16x32_bf16 v[68:71], a[88:91], v[104:107], v[68:71]
v_mfma_f32_16x16x32_bf16 v[68:71], a[92:95], v[108:111], v[68:71]
ds_read_b64_tr_b16 v[128:129], v8 offset:16384
v_mfma_f32_16x16x32_bf16 v[72:75], a[128:131], v[80:83], 0
ds_read_b64_tr_b16 v[130:131], v8 offset:18432
v_mfma_f32_16x16x32_bf16 v[72:75], a[132:135], v[84:87], v[72:75]
v_cvt_pk_bf16_f32 v163, v38, v39
v_mfma_f32_16x16x32_bf16 v[72:75], a[136:139], v[88:91], v[72:75]
ds_read_b64_tr_b16 v[132:133], v8 offset:20480
v_mfma_f32_16x16x32_bf16 v[72:75], a[140:143], v[92:95], v[72:75]
v_mfma_f32_16x16x32_bf16 v[72:75], a[144:147], v[96:99], v[72:75]
ds_read_b64_tr_b16 v[134:135], v8 offset:22528
v_mfma_f32_16x16x32_bf16 v[72:75], a[148:151], v[100:103], v[72:75]
v_mfma_f32_16x16x32_bf16 v[72:75], a[152:155], v[104:107], v[72:75]
ds_read_b64_tr_b16 v[136:137], v8 offset:24576
v_mfma_f32_16x16x32_bf16 v[72:75], a[156:159], v[108:111], v[72:75]
buffer_store_dwordx4 v[160:163], v2, s[52:55], s33 offen offset:1024 sc1
v_mfma_f32_16x16x32_bf16 v[76:79], a[192:195], v[80:83], 0
ds_read_b64_tr_b16 v[138:139], v8 offset:26624
v_mfma_f32_16x16x32_bf16 v[76:79], a[196:199], v[84:87], v[76:79]
v_mfma_f32_16x16x32_bf16 v[76:79], a[200:203], v[88:91], v[76:79]
ds_read_b64_tr_b16 v[140:141], v8 offset:28672
v_mfma_f32_16x16x32_bf16 v[76:79], a[204:207], v[92:95], v[76:79]
v_mfma_f32_16x16x32_bf16 v[76:79], a[208:211], v[96:99], v[76:79]
ds_read_b64_tr_b16 v[142:143], v8 offset:30720
v_mfma_f32_16x16x32_bf16 v[76:79], a[212:215], v[100:103], v[76:79]
v_cvt_pk_bf16_f32 v164, v40, v41
v_mfma_f32_16x16x32_bf16 v[76:79], a[216:219], v[104:107], v[76:79]
v_mfma_f32_16x16x32_bf16 v[76:79], a[220:223], v[108:111], v[76:79]
s_waitcnt lgkmcnt(10)
v_mfma_f32_16x16x32_bf16 v[64:67], a[32:35], v[112:115], v[64:67]
v_mfma_f32_16x16x32_bf16 v[64:67], a[36:39], v[116:119], v[64:67]
v_mfma_f32_16x16x32_bf16 v[64:67], a[40:43], v[120:123], v[64:67]
s_waitcnt lgkmcnt(4)
v_mfma_f32_16x16x32_bf16 v[64:67], a[44:47], v[124:127], v[64:67]
v_cvt_pk_bf16_f32 v165, v42, v43
v_mfma_f32_16x16x32_bf16 v[64:67], a[48:51], v[128:131], v[64:67]
v_mfma_f32_16x16x32_bf16 v[64:67], a[52:55], v[132:135], v[64:67]
s_waitcnt lgkmcnt(0)
v_mfma_f32_16x16x32_bf16 v[64:67], a[56:59], v[136:139], v[64:67]
v_mfma_f32_16x16x32_bf16 v[64:67], a[60:63], v[140:143], v[64:67]
v_add_u32 v7, s29, v3
v_mfma_f32_16x16x32_bf16 v[68:71], a[96:99], v[112:115], v[68:71]
s_waitcnt vmcnt(4)
s_barrier
v_cvt_pk_bf16_f32 v166, v44, v45
v_mfma_f32_16x16x32_bf16 v[68:71], a[100:103], v[116:119], v[68:71]
ds_read_b64_tr_b16 v[80:81], v7
v_mfma_f32_16x16x32_bf16 v[68:71], a[104:107], v[120:123], v[68:71]
s_xor_b32 s27, s27, 65536
ds_read_b64_tr_b16 v[82:83], v7 offset:2048
v_mfma_f32_16x16x32_bf16 v[68:71], a[108:111], v[124:127], v[68:71]
ds_read_b64_tr_b16 v[84:85], v7 offset:4096
v_mfma_f32_16x16x32_bf16 v[68:71], a[112:115], v[128:131], v[68:71]
s_xor_b32 s29, s29, 65536
ds_read_b64_tr_b16 v[86:87], v7 offset:6144
v_mfma_f32_16x16x32_bf16 v[68:71], a[116:119], v[132:135], v[68:71]
ds_read_b64_tr_b16 v[88:89], v7 offset:8192
v_mfma_f32_16x16x32_bf16 v[68:71], a[120:123], v[136:139], v[68:71]
s_add_u32 s28, s27, 32768
ds_read_b64_tr_b16 v[90:91], v7 offset:10240
v_cvt_pk_bf16_f32 v167, v46, v47
v_mfma_f32_16x16x32_bf16 v[68:71], a[124:127], v[140:143], v[68:71]
ds_read_b64_tr_b16 v[92:93], v7 offset:12288
v_mfma_f32_16x16x32_bf16 v[72:75], a[160:163], v[112:115], v[72:75]
s_sub_u32 s22, s22, 1
ds_read_b64_tr_b16 v[94:95], v7 offset:14336
v_mfma_f32_16x16x32_bf16 v[72:75], a[164:167], v[116:119], v[72:75]
v_mfma_f32_16x16x32_bf16 v[72:75], a[168:171], v[120:123], v[72:75]
s_add_u32 s21, s21, 1
s_bitcmp1_b32 s21, 0
s_cselect_b32 s37, 0, 1040384
ds_read_b64_tr_b16 v[96:97], v7 offset:16384
v_mfma_f32_16x16x32_bf16 v[72:75], a[172:175], v[124:127], v[72:75]
ds_read_b64_tr_b16 v[98:99], v7 offset:18432
v_mfma_f32_16x16x32_bf16 v[72:75], a[176:179], v[128:131], v[72:75]
ds_read_b64_tr_b16 v[100:101], v7 offset:20480
v_mfma_f32_16x16x32_bf16 v[72:75], a[180:183], v[132:135], v[72:75]
ds_read_b64_tr_b16 v[102:103], v7 offset:22528
v_mfma_f32_16x16x32_bf16 v[72:75], a[184:187], v[136:139], v[72:75]
ds_read_b64_tr_b16 v[104:105], v7 offset:24576
v_mfma_f32_16x16x32_bf16 v[72:75], a[188:191], v[140:143], v[72:75]
ds_read_b64_tr_b16 v[106:107], v7 offset:26624
v_mfma_f32_16x16x32_bf16 v[76:79], a[224:227], v[112:115], v[76:79]
ds_read_b64_tr_b16 v[108:109], v7 offset:28672
v_mfma_f32_16x16x32_bf16 v[76:79], a[228:231], v[116:119], v[76:79]
ds_read_b64_tr_b16 v[110:111], v7 offset:30720
v_mfma_f32_16x16x32_bf16 v[76:79], a[232:235], v[120:123], v[76:79]
s_add_u32 s35, s33, 16384
buffer_store_dwordx4 v[164:167], v2, s[52:55], s35 offen offset:1024 sc1
v_mfma_f32_16x16x32_bf16 v[76:79], a[236:239], v[124:127], v[76:79]
v_mfma_f32_16x16x32_bf16 v[76:79], a[240:243], v[128:131], v[76:79]
v_mfma_f32_16x16x32_bf16 v[76:79], a[244:247], v[132:135], v[76:79]
v_mfma_f32_16x16x32_bf16 v[76:79], a[248:251], v[136:139], v[76:79]
v_mfma_f32_16x16x32_bf16 v[76:79], a[252:255], v[140:143], v[76:79]
s_mov_b32 s34, s33
s_mov_b32 s58, s54
s_add_u32 s33, s33, 4096
s_add_u32 s33, s33, s37
s_cmp_lg_u32 s22, 0
s_cbranch_scc1 L_p1_loopV
s_nop 7
v_cvt_pk_bf16_f32 v152, v48, v49
v_cvt_pk_bf16_f32 v153, v50, v51
v_cvt_pk_bf16_f32 v154, v52, v53
v_cvt_pk_bf16_f32 v155, v54, v55
buffer_store_dwordx4 v[152:155], v2, s[56:59], s34 offen offset:2048 sc1
v_cvt_pk_bf16_f32 v156, v56, v57
v_cvt_pk_bf16_f32 v157, v58, v59
v_cvt_pk_bf16_f32 v158, v60, v61
v_cvt_pk_bf16_f32 v159, v62, v63
s_add_u32 s35, s34, 16384
buffer_store_dwordx4 v[156:159], v2, s[56:59], s35 offen offset:2048 sc1
v_cvt_pk_bf16_f32 v160, v64, v65
v_cvt_pk_bf16_f32 v161, v66, v67
v_cvt_pk_bf16_f32 v162, v68, v69
v_cvt_pk_bf16_f32 v163, v70, v71
buffer_store_dwordx4 v[160:163], v2, s[56:59], s34 offen offset:3072 sc1
v_cvt_pk_bf16_f32 v164, v72, v73
v_cvt_pk_bf16_f32 v165, v74, v75
v_cvt_pk_bf16_f32 v166, v76, v77
v_cvt_pk_bf16_f32 v167, v78, v79
s_add_u32 s35, s34, 16384
buffer_store_dwordx4 v[164:167], v2, s[56:59], s35 offen offset:3072 sc1
s_branch L_p1_fin
L_p1_fin:
L_p1_end:
s_endpgm
.section .rodata,"a"
.p2align 6
.amdhsa_kernel p1_kernel
  .amdhsa_next_free_vgpr 512
  .amdhsa_next_free_sgpr 102
  .amdhsa_accum_offset 256
  .amdhsa_group_segment_fixed_size 0
  .amdhsa_kernarg_size 104
  .amdhsa_user_sgpr_count 2
  .amdhsa_user_sgpr_kernarg_segment_ptr 1
  .amdhsa_system_sgpr_workgroup_id_x 1
  .amdhsa_float_denorm_mode_32 3
.end_amdhsa_kernel
.text
.globl ap_kernel
.p2align 8
.type ap_kernel,@function
ap_kernel:
s_cmp_ge_u32 s2, 256
s_cbranch_scc1 L_ap_end
s_load_dwordx2 s[52:53], s[0:1], 96
s_load_dwordx2 s[60:61], s[0:1], 40
s_load_dwordx2 s[64:65], s[0:1], 72
v_lshrrev_b32 v1, 6, v0
s_and_b32 s21, s2, 31
v_readfirstlane_b32 s20, v1
s_lshr_b32 s22, s2, 5
v_and_b32 v1, 63, v0
v_lshlrev_b32 v2, 4, v1
s_lshl_b32 s24, s20, 13
s_mov_b32 s25, s24
s_mov_b32 s26, s20
s_sub_u32 s33, 15, s22
s_lshl_b32 s33, s33, 3
s_add_u32 s33, s33, s26
s_lshl_b32 s34, s22, 3
s_add_u32 s34, s34, s26
s_lshl_b32 s28, s21, 12
s_add_u32 s27, s33, 0
s_lshl_b32 s27, s27, 17
s_add_u32 s56, s27, s28
s_add_u32 s27, s33, 4
s_lshl_b32 s27, s27, 17
s_add_u32 s57, s27, s28
s_add_u32 s27, s34, 0
s_lshl_b32 s27, s27, 17
s_add_u32 s58, s27, s28
s_add_u32 s27, s34, 4
s_lshl_b32 s27, s27, 17
s_add_u32 s59, s27, s28
s_lshl_b32 s29, s21, 20
s_add_u32 s29, s29, 0x1800000
s_lshl_b32 s26, s22, 16
s_sub_u32 s42, 0x100000, s26
s_mov_b32 s43, 0x20000
s_waitcnt lgkmcnt(0)
s_add_u32 s40, s52, s29
s_addc_u32 s41, s53, 0
s_add_u32 s44, s52, 0x800000
s_addc_u32 s45, s53, 0
s_mov_b32 s46, 0x1000000
s_mov_b32 s47, 0x20000
s_mov_b32 m0, s25
s_mov_b32 s26, s24
buffer_load_dwordx4 v2, s[40:43], s26 offen lds
buffer_load_dwordx4 v2, s[40:43], s26 offen offset:1024 lds
buffer_load_dwordx4 v2, s[40:43], s26 offen offset:2048 lds
buffer_load_dwordx4 v2, s[40:43], s26 offen offset:3072 lds
s_add_u32 m0, m0, 4096
s_add_u32 s26, s26, 4096
buffer_load_dwordx4 v2, s[40:43], s26 offen lds
buffer_load_dwordx4 v2, s[40:43], s26 offen offset:1024 lds
buffer_load_dwordx4 v2, s[40:43], s26 offen offset:2048 lds
buffer_load_dwordx4 v2, s[40:43], s26 offen offset:3072 lds
s_add_u32 s24, s24, 32768
s_add_u32 s25, s25, 32768
s_and_b32 s25, s25, 0x1ffff
buffer_load_dwordx4 a[144:147], v2, s[44:47], s56 offen
buffer_load_dwordx4 a[148:151], v2, s[44:47], s56 offen offset:1024
buffer_load_dwordx4 a[152:155], v2, s[44:47], s56 offen offset:2048
buffer_load_dwordx4 a[156:159], v2, s[44:47], s56 offen offset:3072
buffer_load_dwordx4 a[160:163], v2, s[44:47], s57 offen
buffer_load_dwordx4 a[164:167], v2, s[44:47], s57 offen offset:1024
buffer_load_dwordx4 a[168:171], v2, s[44:47], s57 offen offset:2048
buffer_load_dwordx4 a[172:175], v2, s[44:47], s57 offen offset:3072
buffer_load_dwordx4 a[176:179], v2, s[44:47], s58 offen
buffer_load_dwordx4 a[180:183], v2, s[44:47], s58 offen offset:1024
buffer_load_dwordx4 a[184:187], v2, s[44:47], s58 offen offset:2048
buffer_load_dwordx4 a[188:191], v2, s[44:47], s58 offen offset:3072
buffer_load_dwordx4 a[192:195], v2, s[44:47], s59 offen
buffer_load_dwordx4 a[196:199], v2, s[44:47], s59 offen offset:1024
buffer_load_dwordx4 a[200:203], v2, s[44:47], s59 offen offset:2048
buffer_load_dwordx4 a[204:207], v2, s[44:47], s59 offen offset:3072
s_mov_b32 m0, s25
s_mov_b32 s26, s24
buffer_load_dwordx4 v2, s[40:43], s26 offen lds
buffer_load_dwordx4 v2, s[40:43], s26 offen offset:1024 lds
buffer_load_dwordx4 v2, s[40:43], s26 offen offset:2048 lds
buffer_load_dwordx4 v2, s[40:43], s26 offen offset:3072 lds
s_add_u32 m0, m0, 4096
s_add_u32 s26, s26, 4096
buffer_load_dwordx4 v2, s[40:43], s26 offen lds
buffer_load_dwordx4 v2, s[40:43], s26 offen offset:1024 lds
buffer_load_dwordx4 v2, s[40:43], s26 offen offset:2048 lds
buffer_load_dwordx4 v2, s[40:43], s26 offen offset:3072 lds
s_add_u32 s24, s24, 32768
s_add_u32 s25, s25, 32768
s_and_b32 s25, s25, 0x1ffff
s_add_u32 s48, s52, 0x4a00000
s_addc_u32 s49, s53, 0
s_mov_b32 s50, 0x1000000
s_mov_b32 s51, 0x20000
s_getpc_b64 s[70:71]
L_ct_att:
s_add_u32 s70, s70, L_att_F0-L_ct_att
s_addc_u32 s71, s71, 0
s_lshr_b32 s26, s2, 3
s_and_b32 s26, s26, 31
s_mul_i32 s26, s26, 2048
v_min_u32 v24, 15, v0
v_lshlrev_b32 v24, 7, v24
v_add_u32 v24, s26, v24
global_load_dword v23, v24, s[70:71]
v_mov_b32 v3, v2
v_add_u32 v4, 0x10000, v2
v_mov_b32 v28, 0x3f803f80
v_mov_b32 v29, 0x3f803f80
v_mov_b32 v30, 0x3f803f80
v_mov_b32 v31, 0x3f803f80
v_mov_b32 v10, 0xf149f2ca
v_and_b32 v11, 15, v1
v_lshrrev_b32 v12, 4, v1
v_lshlrev_b32 v12, 2, v12
v_sub_u32 v11, v11, v12
s_lshl_b32 s26, s20, 4
v_add_u32 v11, s26, v11
v_cvt_f32_i32 v5, v11
v_subrev_f32 v6, 0x3f800000, v5
v_subrev_f32 v7, 0x40000000, v5
v_subrev_f32 v8, 0x40400000, v5
s_mov_b32 s32, 0
s_mov_b32 s62, 4718592
s_mov_b32 s63, 0x20000
s_mov_b32 s66, 5308416
s_mov_b32 s67, 0x20000
s_sub_u32 s68, s2, 128
s_mul_i32 s68, s68, 624
s_mul_i32 s26, s20, 26
s_add_u32 s68, s68, s26
s_cmp_ge_u32 s2, 128
s_cselect_b32 s26, 26, 0
v_add_u32 v9, s68, v1
v_lshlrev_b32 v9, 7, v9
v_mov_b32 v13, 0x70000000
v_cmp_gt_u32 vcc, s26, v1
s_nop 1
v_cndmask_b32 v9, v13, v9, vcc
v_subrev_u32 v22, 4718592, v9
s_mov_b32 s35, 0x00000000
v_sub_f32_e64 v224, s35, v5 clamp
v_sub_f32_e64 v225, s35, v6 clamp
v_sub_f32_e64 v226, s35, v7 clamp
v_sub_f32_e64 v227, s35, v8 clamp
v_mul_f32 v224, v224, v10
v_mul_f32 v225, v225, v10
v_mul_f32 v226, v226, v10
v_mul_f32 v227, v227, v10
s_mov_b32 s35, 0x41800000
v_sub_f32_e64 v228, s35, v5 clamp
v_sub_f32_e64 v229, s35, v6 clamp
v_sub_f32_e64 v230, s35, v7 clamp
v_sub_f32_e64 v231, s35, v8 clamp
v_mul_f32 v228, v228, v10
v_mul_f32 v229, v229, v10
v_mul_f32 v230, v230, v10
v_mul_f32 v231, v231, v10
s_mov_b32 s35, 0x42000000
v_sub_f32_e64 v232, s35, v5 clamp
v_sub_f32_e64 v233, s35, v6 clamp
v_sub_f32_e64 v234, s35, v7 clamp
v_sub_f32_e64 v235, s35, v8 clamp
v_mul_f32 v232, v232, v10
v_mul_f32 v233, v233, v10
v_mul_f32 v234, v234, v10
v_mul_f32 v235, v235, v10
s_mov_b32 s35, 0x42400000
v_sub_f32_e64 v236, s35, v5 clamp
v_sub_f32_e64 v237, s35, v6 clamp
v_sub_f32_e64 v238, s35, v7 clamp
v_sub_f32_e64 v239, s35, v8 clamp
v_mul_f32 v236, v236, v10
v_mul_f32 v237, v237, v10
v_mul_f32 v238, v238, v10
v_mul_f32 v239, v239, v10
s_cmp_eq_u32 s22, 0
s_cselect_b32 s35, 1.0, 0
v_mul_f32 v208, s35, v224
v_mul_f32 v209, s35, v225
v_mul_f32 v210, s35, v226
v_mul_f32 v211, s35, v227
v_accvgpr_write_b32 a0, 0
v_accvgpr_write_b32 a1, 0
v_accvgpr_write_b32 a2, 0
v_accvgpr_write_b32 a3, 0
v_accvgpr_write_b32 a4, 0
v_accvgpr_write_b32 a5, 0
v_accvgpr_write_b32 a6, 0
v_accvgpr_write_b32 a7, 0
v_accvgpr_write_b32 a8, 0
v_accvgpr_write_b32 a9, 0
v_accvgpr_write_b32 a10, 0
v_accvgpr_write_b32 a11, 0
v_accvgpr_write_b32 a12, 0
v_accvgpr_write_b32 a13, 0
v_accvgpr_write_b32 a14, 0
v_accvgpr_write_b32 a15, 0
v_accvgpr_write_b32 a16, 0
v_accvgpr_write_b32 a17, 0
v_accvgpr_write_b32 a18, 0
v_accvgpr_write_b32 a19, 0
v_accvgpr_write_b32 a20, 0
v_accvgpr_write_b32 a21, 0
v_accvgpr_write_b32 a22, 0
v_accvgpr_write_b32 a23, 0
v_accvgpr_write_b32 a24, 0
v_accvgpr_write_b32 a25, 0
v_accvgpr_write_b32 a26, 0
v_accvgpr_write_b32 a27, 0
v_accvgpr_write_b32 a28, 0
v_accvgpr_write_b32 a29, 0
v_accvgpr_write_b32 a30, 0
v_accvgpr_write_b32 a31, 0
v_accvgpr_write_b32 a32, 0
v_accvgpr_write_b32 a33, 0
v_accvgpr_write_b32 a34, 0
v_accvgpr_write_b32 a35, 0
v_accvgpr_write_b32 a36, 0
v_accvgpr_write_b32 a37, 0
v_accvgpr_write_b32 a38, 0
v_accvgpr_write_b32 a39, 0
v_accvgpr_write_b32 a40, 0
v_accvgpr_write_b32 a41, 0
v_accvgpr_write_b32 a42, 0
v_accvgpr_write_b32 a43, 0
v_accvgpr_write_b32 a44, 0
v_accvgpr_write_b32 a45, 0
v_accvgpr_write_b32 a46, 0
v_accvgpr_write_b32 a47, 0
v_accvgpr_write_b32 a48, 0
v_accvgpr_write_b32 a49, 0
v_accvgpr_write_b32 a50, 0
v_accvgpr_write_b32 a51, 0
v_accvgpr_write_b32 a52, 0
v_accvgpr_write_b32 a53, 0
v_accvgpr_write_b32 a54, 0
v_accvgpr_write_b32 a55, 0
v_accvgpr_write_b32 a56, 0
v_accvgpr_write_b32 a57, 0
v_accvgpr_write_b32 a58, 0
v_accvgpr_write_b32 a59, 0
v_accvgpr_write_b32 a60, 0
v_accvgpr_write_b32 a61, 0
v_accvgpr_write_b32 a62, 0
v_accvgpr_write_b32 a63, 0
v_accvgpr_write_b32 a64, 0
v_accvgpr_write_b32 a65, 0
v_accvgpr_write_b32 a66, 0
v_accvgpr_write_b32 a67, 0
v_accvgpr_write_b32 a68, 0
v_accvgpr_write_b32 a69, 0
v_accvgpr_write_b32 a70, 0
v_accvgpr_write_b32 a71, 0
v_accvgpr_write_b32 a72, 0
v_accvgpr_write_b32 a73, 0
v_accvgpr_write_b32 a74, 0
v_accvgpr_write_b32 a75, 0
v_accvgpr_write_b32 a76, 0
v_accvgpr_write_b32 a77, 0
v_accvgpr_write_b32 a78, 0
v_accvgpr_write_b32 a79, 0
v_accvgpr_write_b32 a80, 0
v_accvgpr_write_b32 a81, 0
v_accvgpr_write_b32 a82, 0
v_accvgpr_write_b32 a83, 0
v_accvgpr_write_b32 a84, 0
v_accvgpr_write_b32 a85, 0
v_accvgpr_write_b32 a86, 0
v_accvgpr_write_b32 a87, 0
v_accvgpr_write_b32 a88, 0
v_accvgpr_write_b32 a89, 0
v_accvgpr_write_b32 a90, 0
v_accvgpr_write_b32 a91, 0
v_accvgpr_write_b32 a92, 0
v_accvgpr_write_b32 a93, 0
v_accvgpr_write_b32 a94, 0
v_accvgpr_write_b32 a95, 0
v_accvgpr_write_b32 a96, 0
v_accvgpr_write_b32 a97, 0
v_accvgpr_write_b32 a98, 0
v_accvgpr_write_b32 a99, 0
v_accvgpr_write_b32 a100, 0
v_accvgpr_write_b32 a101, 0
v_accvgpr_write_b32 a102, 0
v_accvgpr_write_b32 a103, 0
v_accvgpr_write_b32 a104, 0
v_accvgpr_write_b32 a105, 0
v_accvgpr_write_b32 a106, 0
v_accvgpr_write_b32 a107, 0
v_accvgpr_write_b32 a108, 0
v_accvgpr_write_b32 a109, 0
v_accvgpr_write_b32 a110, 0
v_accvgpr_write_b32 a111, 0
v_accvgpr_write_b32 a112, 0
v_accvgpr_write_b32 a113, 0
v_accvgpr_write_b32 a114, 0
v_accvgpr_write_b32 a115, 0
v_accvgpr_write_b32 a116, 0
v_accvgpr_write_b32 a117, 0
v_accvgpr_write_b32 a118, 0
v_accvgpr_write_b32 a119, 0
v_accvgpr_write_b32 a120, 0
v_accvgpr_write_b32 a121, 0
v_accvgpr_write_b32 a122, 0
v_accvgpr_write_b32 a123, 0
v_accvgpr_write_b32 a124, 0
v_accvgpr_write_b32 a125, 0
v_accvgpr_write_b32 a126, 0
v_accvgpr_write_b32 a127, 0
v_accvgpr_write_b32 a128, 0
v_accvgpr_write_b32 a129, 0
v_accvgpr_write_b32 a130, 0
v_accvgpr_write_b32 a131, 0
v_accvgpr_write_b32 a132, 0
v_accvgpr_write_b32 a133, 0
v_accvgpr_write_b32 a134, 0
v_accvgpr_write_b32 a135, 0
v_accvgpr_write_b32 a136, 0
v_accvgpr_write_b32 a137, 0
v_accvgpr_write_b32 a138, 0
v_accvgpr_write_b32 a139, 0
v_accvgpr_write_b32 a140, 0
v_accvgpr_write_b32 a141, 0
v_accvgpr_write_b32 a142, 0
v_accvgpr_write_b32 a143, 0
s_waitcnt vmcnt(25)
s_barrier
ds_read_b128 a[208:211], v3
ds_read_b128 a[212:215], v3 offset:1024
ds_read_b128 a[216:219], v3 offset:2048
ds_read_b128 a[220:223], v3 offset:3072
ds_read_b128 a[224:227], v3 offset:4096
ds_read_b128 a[228:231], v3 offset:5120
ds_read_b128 a[232:235], v3 offset:6144
ds_read_b128 a[236:239], v3 offset:7168
s_waitcnt vmcnt(24) lgkmcnt(7)
v_mfma_f32_16x16x32_bf16 v[64:67], a[208:211], a[144:147], 0
s_waitcnt vmcnt(23) lgkmcnt(6)
v_mfma_f32_16x16x32_bf16 v[64:67], a[212:215], a[148:151], v[64:67]
s_waitcnt vmcnt(22) lgkmcnt(5)
v_mfma_f32_16x16x32_bf16 v[64:67], a[216:219], a[152:155], v[64:67]
s_waitcnt vmcnt(21) lgkmcnt(4)
v_mfma_f32_16x16x32_bf16 v[64:67], a[220:223], a[156:159], v[64:67]
s_waitcnt vmcnt(20)
v_mfma_f32_16x16x32_bf16 v[68:71], a[208:211], a[160:163], 0
s_waitcnt vmcnt(19)
v_mfma_f32_16x16x32_bf16 v[68:71], a[212:215], a[164:167], v[68:71]
s_waitcnt vmcnt(18)
v_mfma_f32_16x16x32_bf16 v[68:71], a[216:219], a[168:171], v[68:71]
s_waitcnt vmcnt(17)
v_mfma_f32_16x16x32_bf16 v[68:71], a[220:223], a[172:175], v[68:71]
s_waitcnt vmcnt(16)
v_mfma_f32_16x16x32_bf16 v[72:75], a[208:211], a[176:179], v[208:211]
s_waitcnt vmcnt(15)
v_mfma_f32_16x16x32_bf16 v[72:75], a[212:215], a[180:183], v[72:75]
s_waitcnt vmcnt(14)
v_mfma_f32_16x16x32_bf16 v[72:75], a[216:219], a[184:187], v[72:75]
s_waitcnt vmcnt(13)
v_mfma_f32_16x16x32_bf16 v[72:75], a[220:223], a[188:191], v[72:75]
s_waitcnt vmcnt(12)
v_mfma_f32_16x16x32_bf16 v[76:79], a[208:211], a[192:195], 0
s_waitcnt vmcnt(11)
v_mfma_f32_16x16x32_bf16 v[76:79], a[212:215], a[196:199], v[76:79]
s_waitcnt vmcnt(10)
v_mfma_f32_16x16x32_bf16 v[76:79], a[216:219], a[200:203], v[76:79]
s_waitcnt vmcnt(9)
v_mfma_f32_16x16x32_bf16 v[76:79], a[220:223], a[204:207], v[76:79]
s_nop 4
v_max3_f32 v11, v64, v65, v66
v_max3_f32 v12, v68, v69, v70
v_max3_f32 v13, v72, v73, v74
s_nop 2
v_max3_f32 v14, v76, v77, v78
v_max_f32 v11, v11, v67
v_max_f32 v12, v12, v71
v_max_f32 v13, v13, v75
v_max_f32 v14, v14, v79
v_mov_b32 v15, v11
v_mov_b32 v16, v12
v_mov_b32 v17, v13
v_mov_b32 v18, v14
v_permlane16_swap_b32 v11, v15
v_permlane16_swap_b32 v12, v16
v_permlane16_swap_b32 v13, v17
v_permlane16_swap_b32 v14, v18
v_max_f32 v11, v11, v15
v_max_f32 v12, v12, v16
v_max_f32 v13, v13, v17
v_max_f32 v14, v14, v18
v_mov_b32 v15, v11
v_mov_b32 v16, v12
v_mov_b32 v17, v13
v_mov_b32 v18, v14
v_permlane32_swap_b32 v11, v15
v_permlane32_swap_b32 v12, v16
v_permlane32_swap_b32 v13, v17
v_permlane32_swap_b32 v14, v18
v_max_f32 v11, v11, v15
v_max_f32 v12, v12, v16
v_max_f32 v13, v13, v17
v_max_f32 v14, v14, v18
v_sub_f32 v192, 0, v11
v_sub_f32 v193, 0, v11
v_sub_f32 v194, 0, v11
v_sub_f32 v195, 0, v11
v_sub_f32 v196, 0, v12
v_sub_f32 v197, 0, v12
v_sub_f32 v198, 0, v12
v_sub_f32 v199, 0, v12
v_sub_f32 v200, 0, v13
v_sub_f32 v201, 0, v13
v_sub_f32 v202, 0, v13
v_sub_f32 v203, 0, v13
v_sub_f32 v204, 0, v14
v_sub_f32 v205, 0, v14
v_sub_f32 v206, 0, v14
v_sub_f32 v207, 0, v14
s_nop 1
s_cmp_eq_u32 s22, 0
s_cbranch_scc1 L_att_Fm0
L_att_F0:
v_mfma_f32_16x16x32_bf16 v[64:67], a[208:211], a[144:147], v[192:195]
ds_read_b128 a[240:243], v3 offset:16384
v_mfma_f32_16x16x32_bf16 v[64:67], a[212:215], a[148:151], v[64:67]
v_mfma_f32_16x16x32_bf16 v[64:67], a[216:219], a[152:155], v[64:67]
s_mov_b32 m0, s25
s_mov_b32 s26, s24
buffer_load_dwordx4 v2, s[40:43], s26 offen lds
v_mfma_f32_16x16x32_bf16 v[64:67], a[220:223], a[156:159], v[64:67]
ds_read_b128 a[244:247], v3 offset:17408
v_mfma_f32_16x16x32_bf16 v[68:71], a[208:211], a[160:163], v[196:199]
v_mfma_f32_16x16x32_bf16 v[68:71], a[212:215], a[164:167], v[68:71]
v_mfma_f32_16x16x32_bf16 v[68:71], a[216:219], a[168:171], v[68:71]
buffer_load_dwordx4 v2, s[40:43], s26 offen offset:1024 lds
v_mfma_f32_16x16x32_bf16 v[68:71], a[220:223], a[172:175], v[68:71]
ds_read_b128 a[248:251], v3 offset:18432
v_mfma_f32_16x16x32_bf16 v[72:75], a[208:211], a[176:179], v[200:203]
v_mfma_f32_16x16x32_bf16 v[72:75], a[212:215], a[180:183], v[72:75]
v_mfma_f32_16x16x32_bf16 v[72:75], a[216:219], a[184:187], v[72:75]
v_mfma_f32_16x16x32_bf16 v[72:75], a[220:223], a[188:191], v[72:75]
ds_read_b128 a[252:255], v3 offset:19456
v_mfma_f32_16x16x32_bf16 v[76:79], a[208:211], a[192:195], v[204:207]
buffer_load_dwordx4 v2, s[40:43], s26 offen offset:2048 lds
v_mfma_f32_16x16x32_bf16 v[76:79], a[212:215], a[196:199], v[76:79]
v_exp_f32 v64, v64
v_mfma_f32_16x16x32_bf16 v[76:79], a[216:219], a[200:203], v[76:79]
v_exp_f32 v65, v65
v_mfma_f32_16x16x32_bf16 v[76:79], a[220:223], a[204:207], v[76:79]
s_waitcnt lgkmcnt(4)
v_exp_f32 v66, v66
v_exp_f32 v67, v67
v_mfma_f32_16x16x32_bf16 v[80:83], a[224:227], a[144:147], v[192:195]
ds_read_b128 v[240:243], v3 offset:20480
v_cvt_pk_bf16_f32 v128, v64, v65
v_cvt_pk_bf16_f32 v129, v66, v67
v_mfma_f32_16x16x32_bf16 v[80:83], a[228:231], a[148:151], v[80:83]
buffer_load_dwordx4 v2, s[40:43], s26 offen offset:3072 lds
v_mfma_f32_16x16x32_bf16 v[80:83], a[232:235], a[152:155], v[80:83]
v_exp_f32 v68, v68
v_mfma_f32_16x16x32_bf16 v[80:83], a[236:239], a[156:159], v[80:83]
ds_read_b128 v[244:247], v3 offset:21504
v_exp_f32 v69, v69
v_mfma_f32_16x16x32_bf16 v[84:87], a[224:227], a[160:163], v[196:199]
v_exp_f32 v70, v70
v_exp_f32 v71, v71
v_mfma_f32_16x16x32_bf16 v[84:87], a[228:231], a[164:167], v[84:87]
v_cvt_pk_bf16_f32 v136, v68, v69
v_cvt_pk_bf16_f32 v137, v70, v71
v_mfma_f32_16x16x32_bf16 v[84:87], a[232:235], a[168:171], v[84:87]
s_add_u32 m0, m0, 4096
s_add_u32 s26, s26, 4096
buffer_load_dwordx4 v2, s[40:43], s26 offen lds
v_mfma_f32_16x16x32_bf16 v[84:87], a[236:239], a[172:175], v[84:87]
ds_read_b128 v[248:251], v3 offset:22528
v_exp_f32 v72, v72
v_mfma_f32_16x16x32_bf16 v[88:91], a[224:227], a[176:179], v[200:203]
v_exp_f32 v73, v73
v_exp_f32 v74, v74
v_mfma_f32_16x16x32_bf16 v[88:91], a[228:231], a[180:183], v[88:91]
buffer_load_dwordx4 v2, s[40:43], s26 offen offset:1024 lds
v_exp_f32 v75, v75
v_mfma_f32_16x16x32_bf16 v[88:91], a[232:235], a[184:187], v[88:91]
v_cvt_pk_bf16_f32 v144, v72, v73
v_cvt_pk_bf16_f32 v145, v74, v75
v_mfma_f32_16x16x32_bf16 v[88:91], a[236:239], a[188:191], v[88:91]
ds_read_b128 v[252:255], v3 offset:23552
v_exp_f32 v76, v76
v_mfma_f32_16x16x32_bf16 v[92:95], a[224:227], a[192:195], v[204:207]
v_exp_f32 v77, v77
v_exp_f32 v78, v78
v_mfma_f32_16x16x32_bf16 v[92:95], a[228:231], a[196:199], v[92:95]
v_exp_f32 v79, v79
v_cvt_pk_bf16_f32 v152, v76, v77
v_mfma_f32_16x16x32_bf16 v[92:95], a[232:235], a[200:203], v[92:95]
buffer_load_dwordx4 v2, s[40:43], s26 offen offset:2048 lds
v_cvt_pk_bf16_f32 v153, v78, v79
v_mfma_f32_16x16x32_bf16 v[92:95], a[236:239], a[204:207], v[92:95]
s_waitcnt lgkmcnt(4)
v_exp_f32 v80, v80
v_exp_f32 v81, v81
v_mfma_f32_16x16x32_bf16 v[96:99], a[240:243], a[144:147], v[192:195]
v_exp_f32 v82, v82
v_exp_f32 v83, v83
v_mfma_f32_16x16x32_bf16 v[96:99], a[244:247], a[148:151], v[96:99]
v_cvt_pk_bf16_f32 v130, v80, v81
v_cvt_pk_bf16_f32 v131, v82, v83
v_mfma_f32_16x16x32_bf16 v[96:99], a[248:251], a[152:155], v[96:99]
v_exp_f32 v84, v84
v_mfma_f32_16x16x32_bf16 v[96:99], a[252:255], a[156:159], v[96:99]
buffer_load_dwordx4 v2, s[40:43], s26 offen offset:3072 lds
s_add_u32 s24, s24, 32768
s_add_u32 s25, s25, 32768
s_and_b32 s25, s25, 0x1ffff
v_exp_f32 v85, v85
v_mfma_f32_16x16x32_bf16 v[100:103], a[240:243], a[160:163], v[196:199]
v_exp_f32 v86, v86
v_exp_f32 v87, v87
v_mfma_f32_16x16x32_bf16 v[100:103], a[244:247], a[164:167], v[100:103]
v_cvt_pk_bf16_f32 v138, v84, v85
v_cvt_pk_bf16_f32 v139, v86, v87
v_mfma_f32_16x16x32_bf16 v[100:103], a[248:251], a[168:171], v[100:103]
v_exp_f32 v88, v88
v_mfma_f32_16x16x32_bf16 v[100:103], a[252:255], a[172:175], v[100:103]
v_exp_f32 v89, v89
v_exp_f32 v90, v90
v_mfma_f32_16x16x32_bf16 v[104:107], a[240:243], a[176:179], v[200:203]
v_exp_f32 v91, v91
v_cvt_pk_bf16_f32 v146, v88, v89
v_mfma_f32_16x16x32_bf16 v[104:107], a[244:247], a[180:183], v[104:107]
v_cvt_pk_bf16_f32 v147, v90, v91
v_mfma_f32_16x16x32_bf16 v[104:107], a[248:251], a[184:187], v[104:107]
v_exp_f32 v92, v92
v_mfma_f32_16x16x32_bf16 v[104:107], a[252:255], a[188:191], v[104:107]
v_exp_f32 v93, v93
v_exp_f32 v94, v94
v_mfma_f32_16x16x32_bf16 v[108:111], a[240:243], a[192:195], v[204:207]
v_exp_f32 v95, v95
v_cvt_pk_bf16_f32 v154, v92, v93
v_mfma_f32_16x16x32_bf16 v[108:111], a[244:247], a[196:199], v[108:111]
v_cvt_pk_bf16_f32 v155, v94, v95
v_mfma_f32_16x16x32_bf16 v[108:111], a[248:251], a[200:203], v[108:111]
v_exp_f32 v96, v96
v_mfma_f32_16x16x32_bf16 v[108:111], a[252:255], a[204:207], v[108:111]
s_waitcnt lgkmcnt(0)
v_exp_f32 v97, v97
v_exp_f32 v98, v98
v_mfma_f32_16x16x32_bf16 v[112:115], v[240:243], a[144:147], v[192:195]
s_waitcnt vmcnt(9)
s_barrier
v_exp_f32 v99, v99
v_cvt_pk_bf16_f32 v132, v96, v97
v_mfma_f32_16x16x32_bf16 v[112:115], v[244:247], a[148:151], v[112:115]
ds_read_b128 a[208:211], v3 offset:32768
v_cvt_pk_bf16_f32 v133, v98, v99
v_mfma_f32_16x16x32_bf16 v[112:115], v[248:251], a[152:155], v[112:115]
ds_read_b128 a[212:215], v3 offset:33792
v_mfma_f32_16x16x32_bf16 v[112:115], v[252:255], a[156:159], v[112:115]
v_exp_f32 v100, v100
v_exp_f32 v101, v101
v_mfma_f32_16x16x32_bf16 v[116:119], v[240:243], a[160:163], v[196:199]
ds_read_b128 a[216:219], v3 offset:34816
v_exp_f32 v102, v102
v_mfma_f32_16x16x32_bf16 v[116:119], v[244:247], a[164:167], v[116:119]
ds_read_b128 a[220:223], v3 offset:35840
v_exp_f32 v103, v103
v_mfma_f32_16x16x32_bf16 v[116:119], v[248:251], a[168:171], v[116:119]
v_cvt_pk_bf16_f32 v140, v100, v101
v_cvt_pk_bf16_f32 v141, v102, v103
v_mfma_f32_16x16x32_bf16 v[116:119], v[252:255], a[172:175], v[116:119]
ds_read_b128 a[224:227], v3 offset:36864
v_exp_f32 v104, v104
v_mfma_f32_16x16x32_bf16 v[120:123], v[240:243], a[176:179], v[200:203]
v_exp_f32 v105, v105
v_exp_f32 v106, v106
v_mfma_f32_16x16x32_bf16 v[120:123], v[244:247], a[180:183], v[120:123]
ds_read_b128 a[228:231], v3 offset:37888
v_exp_f32 v107, v107
v_mfma_f32_16x16x32_bf16 v[120:123], v[248:251], a[184:187], v[120:123]
ds_read_b128 a[232:235], v3 offset:38912
v_cvt_pk_bf16_f32 v148, v104, v105
v_cvt_pk_bf16_f32 v149, v106, v107
v_mfma_f32_16x16x32_bf16 v[120:123], v[252:255], a[188:191], v[120:123]
v_exp_f32 v108, v108
v_exp_f32 v109, v109
v_mfma_f32_16x16x32_bf16 v[124:127], v[240:243], a[192:195], v[204:207]
ds_read_b128 a[236:239], v3 offset:39936
v_exp_f32 v110, v110
v_mfma_f32_16x16x32_bf16 v[124:127], v[244:247], a[196:199], v[124:127]
v_exp_f32 v111, v111
v_cvt_pk_bf16_f32 v156, v108, v109
v_mfma_f32_16x16x32_bf16 v[124:127], v[248:251], a[200:203], v[124:127]
v_cvt_pk_bf16_f32 v157, v110, v111
v_mfma_f32_16x16x32_bf16 v[124:127], v[252:255], a[204:207], v[124:127]
v_exp_f32 v112, v112
v_exp_f32 v113, v113
v_exp_f32 v114, v114
v_exp_f32 v115, v115
v_cvt_pk_bf16_f32 v134, v112, v113
v_cvt_pk_bf16_f32 v135, v114, v115
v_exp_f32 v116, v116
v_exp_f32 v117, v117
v_exp_f32 v118, v118
v_exp_f32 v119, v119
v_cvt_pk_bf16_f32 v142, v116, v117
v_cvt_pk_bf16_f32 v143, v118, v119
L_att_DD1a:
s_waitcnt lgkmcnt(4)
v_mfma_f32_16x16x32_bf16 v[64:67], a[208:211], a[144:147], v[192:195]
ds_read_b128 a[240:243], v3 offset:49152
v_mfma_f32_16x16x32_bf16 v[64:67], a[212:215], a[148:151], v[64:67]
v_exp_f32 v120, v120
v_mfma_f32_16x16x32_bf16 v[64:67], a[216:219], a[152:155], v[64:67]
s_mov_b32 m0, s25
s_mov_b32 s26, s24
buffer_load_dwordx4 v2, s[40:43], s26 offen lds
v_mfma_f32_16x16x32_bf16 v[64:67], a[220:223], a[156:159], v[64:67]
ds_read_b128 a[244:247], v3 offset:50176
v_mfma_f32_16x16x32_bf16 v[68:71], a[208:211], a[160:163], v[196:199]
v_exp_f32 v121, v121
v_mfma_f32_16x16x32_bf16 v[68:71], a[212:215], a[164:167], v[68:71]
v_exp_f32 v122, v122
v_mfma_f32_16x16x32_bf16 v[68:71], a[216:219], a[168:171], v[68:71]
v_exp_f32 v123, v123
v_mfma_f32_16x16x32_bf16 v[68:71], a[220:223], a[172:175], v[68:71]
ds_read_b128 a[248:251], v3 offset:51200
v_cvt_pk_bf16_f32 v150, v120, v121
v_mfma_f32_16x16x32_bf16 v[72:75], a[208:211], a[176:179], v[200:203]
v_cvt_pk_bf16_f32 v151, v122, v123
v_mfma_f32_16x16x32_bf16 v[72:75], a[212:215], a[180:183], v[72:75]
v_exp_f32 v124, v124
v_mfma_f32_16x16x32_bf16 v[72:75], a[216:219], a[184:187], v[72:75]
v_exp_f32 v125, v125
v_mfma_f32_16x16x32_bf16 v[72:75], a[220:223], a[188:191], v[72:75]
ds_read_b128 a[252:255], v3 offset:52224
v_mfma_f32_16x16x32_bf16 v[76:79], a[208:211], a[192:195], v[204:207]
v_exp_f32 v126, v126
v_mfma_f32_16x16x32_bf16 v[76:79], a[212:215], a[196:199], v[76:79]
buffer_load_dwordx4 v2, s[40:43], s26 offen offset:1024 lds
v_mfma_f32_16x16x32_bf16 v[76:79], a[216:219], a[200:203], v[76:79]
v_exp_f32 v127, v127
v_mfma_f32_16x16x32_bf16 v[76:79], a[220:223], a[204:207], v[76:79]
s_waitcnt lgkmcnt(4)
v_cvt_pk_bf16_f32 v158, v124, v125
v_cvt_pk_bf16_f32 v159, v126, v127
v_mfma_f32_16x16x32_bf16 v[80:83], a[224:227], a[144:147], v[192:195]
ds_read_b128 v[240:243], v3 offset:53248
v_mfma_f32_16x16x32_bf16 v[80:83], a[228:231], a[148:151], v[80:83]
v_exp_f32 v64, v64
v_mfma_f32_16x16x32_bf16 v[80:83], a[232:235], a[152:155], v[80:83]
v_exp_f32 v65, v65
v_mfma_f32_16x16x32_bf16 v[80:83], a[236:239], a[156:159], v[80:83]
ds_read_b128 v[244:247], v3 offset:54272
v_mfma_f32_16x16x32_bf16 v[84:87], a[224:227], a[160:163], v[196:199]
v_exp_f32 v66, v66
v_mfma_f32_16x16x32_bf16 v[84:87], a[228:231], a[164:167], v[84:87]
v_exp_f32 v67, v67
v_mfma_f32_16x16x32_bf16 v[84:87], a[232:235], a[168:171], v[84:87]
v_cvt_pk_bf16_f32 v160, v64, v65
v_cvt_pk_bf16_f32 v161, v66, v67
v_mfma_f32_16x16x32_bf16 v[84:87], a[236:239], a[172:175], v[84:87]
ds_read_b128 v[248:251], v3 offset:55296
v_mfma_f32_16x16x32_bf16 v[88:91], a[224:227], a[176:179], v[200:203]
buffer_load_dwordx4 v2, s[40:43], s26 offen offset:2048 lds
v_mfma_f32_16x16x32_bf16 v[88:91], a[228:231], a[180:183], v[88:91]
v_exp_f32 v68, v68
v_mfma_f32_16x16x32_bf16 v[88:91], a[232:235], a[184:187], v[88:91]
v_exp_f32 v69, v69
v_mfma_f32_16x16x32_bf16 v[88:91], a[236:239], a[188:191], v[88:91]
ds_read_b128 v[252:255], v3 offset:56320
v_mfma_f32_16x16x32_bf16 v[92:95], a[224:227], a[192:195], v[204:207]
v_exp_f32 v70, v70
v_mfma_f32_16x16x32_bf16 v[92:95], a[228:231], a[196:199], v[92:95]
v_exp_f32 v71, v71
v_mfma_f32_16x16x32_bf16 v[92:95], a[232:235], a[200:203], v[92:95]
v_cvt_pk_bf16_f32 v168, v68, v69
v_cvt_pk_bf16_f32 v169, v70, v71
v_mfma_f32_16x16x32_bf16 v[92:95], a[236:239], a[204:207], v[92:95]
s_waitcnt lgkmcnt(4)
v_exp_f32 v72, v72
v_mfma_f32_16x16x32_bf16 v[96:99], a[240:243], a[144:147], v[192:195]
ds_read_b128 v[32:35], v3 offset:8192
v_mfma_f32_16x16x32_bf16 v[96:99], a[244:247], a[148:151], v[96:99]
v_exp_f32 v73, v73
v_mfma_f32_16x16x32_bf16 v[96:99], a[248:251], a[152:155], v[96:99]
v_exp_f32 v74, v74
v_mfma_f32_16x16x32_bf16 v[96:99], a[252:255], a[156:159], v[96:99]
buffer_load_dwordx4 v2, s[40:43], s26 offen offset:3072 lds
v_mfma_f32_16x16x32_bf16 v[100:103], a[240:243], a[160:163], v[196:199]
v_exp_f32 v75, v75
v_mfma_f32_16x16x32_bf16 v[100:103], a[244:247], a[164:167], v[100:103]
ds_read_b128 v[36:39], v3 offset:24576
v_cvt_pk_bf16_f32 v176, v72, v73
v_mfma_f32_16x16x32_bf16 v[100:103], a[248:251], a[168:171], v[100:103]
v_cvt_pk_bf16_f32 v177, v74, v75
v_mfma_f32_16x16x32_bf16 v[100:103], a[252:255], a[172:175], v[100:103]
v_exp_f32 v76, v76
v_mfma_f32_16x16x32_bf16 v[104:107], a[240:243], a[176:179], v[200:203]
v_exp_f32 v77, v77
v_mfma_f32_16x16x32_bf16 v[104:107], a[244:247], a[180:183], v[104:107]
v_exp_f32 v78, v78
v_mfma_f32_16x16x32_bf16 v[104:107], a[248:251], a[184:187], v[104:107]
ds_read_b128 v[40:43], v3 offset:9216
v_mfma_f32_16x16x32_bf16 v[104:107], a[252:255], a[188:191], v[104:107]
v_exp_f32 v79, v79
v_mfma_f32_16x16x32_bf16 v[108:111], a[240:243], a[192:195], v[204:207]
v_cvt_pk_bf16_f32 v184, v76, v77
v_mfma_f32_16x16x32_bf16 v[108:111], a[244:247], a[196:199], v[108:111]
v_cvt_pk_bf16_f32 v185, v78, v79
v_mfma_f32_16x16x32_bf16 v[108:111], a[248:251], a[200:203], v[108:111]
s_add_u32 m0, m0, 4096
s_add_u32 s26, s26, 4096
buffer_load_dwordx4 v2, s[40:43], s26 offen lds
v_mfma_f32_16x16x32_bf16 v[108:111], a[252:255], a[204:207], v[108:111]
s_waitcnt lgkmcnt(3)
ds_read_b128 v[44:47], v3 offset:25600
v_mfma_f32_16x16x32_bf16 v[112:115], v[240:243], a[144:147], v[192:195]
v_exp_f32 v80, v80
v_mfma_f32_16x16x32_bf16 v[112:115], v[244:247], a[148:151], v[112:115]
v_exp_f32 v81, v81
v_mfma_f32_16x16x32_bf16 v[112:115], v[248:251], a[152:155], v[112:115]
v_exp_f32 v82, v82
v_mfma_f32_16x16x32_bf16 v[112:115], v[252:255], a[156:159], v[112:115]
v_exp_f32 v83, v83
v_mfma_f32_16x16x32_bf16 v[116:119], v[240:243], a[160:163], v[196:199]
ds_read_b128 v[48:51], v3 offset:10240
v_cvt_pk_bf16_f32 v162, v80, v81
v_mfma_f32_16x16x32_bf16 v[116:119], v[244:247], a[164:167], v[116:119]
v_cvt_pk_bf16_f32 v163, v82, v83
v_mfma_f32_16x16x32_bf16 v[116:119], v[248:251], a[168:171], v[116:119]
v_exp_f32 v84, v84
v_mfma_f32_16x16x32_bf16 v[116:119], v[252:255], a[172:175], v[116:119]
v_mfma_f32_16x16x32_bf16 v[120:123], v[240:243], a[176:179], v[200:203]
v_exp_f32 v85, v85
v_mfma_f32_16x16x32_bf16 v[120:123], v[244:247], a[180:183], v[120:123]
ds_read_b128 v[52:55], v3 offset:26624
v_mfma_f32_16x16x32_bf16 v[120:123], v[248:251], a[184:187], v[120:123]
buffer_load_dwordx4 v2, s[40:43], s26 offen offset:1024 lds
v_mfma_f32_16x16x32_bf16 v[120:123], v[252:255], a[188:191], v[120:123]
v_exp_f32 v86, v86
v_mfma_f32_16x16x32_bf16 v[124:127], v[240:243], a[192:195], v[204:207]
v_exp_f32 v87, v87
v_mfma_f32_16x16x32_bf16 v[124:127], v[244:247], a[196:199], v[124:127]
v_cvt_pk_bf16_f32 v170, v84, v85
v_mfma_f32_16x16x32_bf16 v[124:127], v[248:251], a[200:203], v[124:127]
v_cvt_pk_bf16_f32 v171, v86, v87
v_mfma_f32_16x16x32_bf16 v[124:127], v[252:255], a[204:207], v[124:127]
s_waitcnt lgkmcnt(4)
v_exp_f32 v88, v88
v_mfma_f32_16x16x32_bf16 a[0:3], v[32:35], v[128:131], a[0:3]
ds_read_b128 v[56:59], v3 offset:11264
v_mfma_f32_16x16x32_bf16 a[0:3], v[36:39], v[132:135], a[0:3]
v_exp_f32 v89, v89
v_mfma_f32_16x16x32_bf16 a[32:35], v[32:35], v[136:139], a[32:35]
v_exp_f32 v90, v90
v_mfma_f32_16x16x32_bf16 a[32:35], v[36:39], v[140:143], a[32:35]
v_mfma_f32_16x16x32_bf16 a[64:67], v[32:35], v[144:147], a[64:67]
ds_read_b128 v[60:63], v3 offset:27648
v_mfma_f32_16x16x32_bf16 a[64:67], v[36:39], v[148:151], a[64:67]
buffer_load_dwordx4 v2, s[40:43], s26 offen offset:2048 lds
v_mfma_f32_16x16x32_bf16 a[96:99], v[32:35], v[152:155], a[96:99]
v_exp_f32 v91, v91
v_mfma_f32_16x16x32_bf16 a[96:99], v[36:39], v[156:159], a[96:99]
s_waitcnt lgkmcnt(4)
v_cvt_pk_bf16_f32 v178, v88, v89
v_cvt_pk_bf16_f32 v179, v90, v91
v_mfma_f32_16x16x32_bf16 a[4:7], v[40:43], v[128:131], a[4:7]
ds_read_b128 v[32:35], v3 offset:12288
v_mfma_f32_16x16x32_bf16 a[4:7], v[44:47], v[132:135], a[4:7]
v_exp_f32 v92, v92
v_mfma_f32_16x16x32_bf16 a[36:39], v[40:43], v[136:139], a[36:39]
v_exp_f32 v93, v93
v_mfma_f32_16x16x32_bf16 a[36:39], v[44:47], v[140:143], a[36:39]
v_exp_f32 v94, v94
v_mfma_f32_16x16x32_bf16 a[68:71], v[40:43], v[144:147], a[68:71]
ds_read_b128 v[36:39], v3 offset:28672
v_mfma_f32_16x16x32_bf16 a[68:71], v[44:47], v[148:151], a[68:71]
v_exp_f32 v95, v95
v_mfma_f32_16x16x32_bf16 a[100:103], v[40:43], v[152:155], a[100:103]
v_cvt_pk_bf16_f32 v186, v92, v93
v_cvt_pk_bf16_f32 v187, v94, v95
v_mfma_f32_16x16x32_bf16 a[100:103], v[44:47], v[156:159], a[100:103]
s_waitcnt lgkmcnt(4)
buffer_load_dwordx4 v2, s[40:43], s26 offen offset:3072 lds
s_add_u32 s24, s24, 32768
s_add_u32 s25, s25, 32768
s_and_b32 s25, s25, 0x1ffff
v_mfma_f32_16x16x32_bf16 a[8:11], v[48:51], v[128:131], a[8:11]
ds_read_b128 v[40:43], v3 offset:13312
v_mfma_f32_16x16x32_bf16 a[8:11], v[52:55], v[132:135], a[8:11]
v_exp_f32 v96, v96
v_mfma_f32_16x16x32_bf16 a[40:43], v[48:51], v[136:139], a[40:43]
v_exp_f32 v97, v97
v_mfma_f32_16x16x32_bf16 a[40:43], v[52:55], v[140:143], a[40:43]
v_exp_f32 v98, v98
v_mfma_f32_16x16x32_bf16 a[72:75], v[48:51], v[144:147], a[72:75]
ds_read_b128 v[44:47], v3 offset:29696
v_mfma_f32_16x16x32_bf16 a[72:75], v[52:55], v[148:151], a[72:75]
v_exp_f32 v99, v99
v_mfma_f32_16x16x32_bf16 a[104:107], v[48:51], v[152:155], a[104:107]
v_cvt_pk_bf16_f32 v164, v96, v97
v_mfma_f32_16x16x32_bf16 a[104:107], v[52:55], v[156:159], a[104:107]
s_waitcnt lgkmcnt(4)
v_cvt_pk_bf16_f32 v165, v98, v99
v_mfma_f32_16x16x32_bf16 a[12:15], v[56:59], v[128:131], a[12:15]
ds_read_b128 v[48:51], v3 offset:14336
v_mfma_f32_16x16x32_bf16 a[12:15], v[60:63], v[132:135], a[12:15]
v_exp_f32 v100, v100
v_mfma_f32_16x16x32_bf16 a[44:47], v[56:59], v[136:139], a[44:47]
v_exp_f32 v101, v101
v_mfma_f32_16x16x32_bf16 a[44:47], v[60:63], v[140:143], a[44:47]
v_exp_f32 v102, v102
v_mfma_f32_16x16x32_bf16 a[76:79], v[56:59], v[144:147], a[76:79]
ds_read_b128 v[52:55], v3 offset:30720
v_mfma_f32_16x16x32_bf16 a[76:79], v[60:63], v[148:151], a[76:79]
v_exp_f32 v103, v103
v_mfma_f32_16x16x32_bf16 a[108:111], v[56:59], v[152:155], a[108:111]
v_cvt_pk_bf16_f32 v172, v100, v101
v_mfma_f32_16x16x32_bf16 a[108:111], v[60:63], v[156:159], a[108:111]
s_waitcnt lgkmcnt(4)
v_cvt_pk_bf16_f32 v173, v102, v103
v_mfma_f32_16x16x32_bf16 a[16:19], v[32:35], v[128:131], a[16:19]
ds_read_b128 v[56:59], v3 offset:15360
v_mfma_f32_16x16x32_bf16 a[16:19], v[36:39], v[132:135], a[16:19]
v_exp_f32 v104, v104
v_mfma_f32_16x16x32_bf16 a[48:51], v[32:35], v[136:139], a[48:51]
v_exp_f32 v105, v105
v_mfma_f32_16x16x32_bf16 a[48:51], v[36:39], v[140:143], a[48:51]
v_exp_f32 v106, v106
v_mfma_f32_16x16x32_bf16 a[80:83], v[32:35], v[144:147], a[80:83]
ds_read_b128 v[60:63], v3 offset:31744
v_mfma_f32_16x16x32_bf16 a[80:83], v[36:39], v[148:151], a[80:83]
v_exp_f32 v107, v107
v_mfma_f32_16x16x32_bf16 a[112:115], v[32:35], v[152:155], a[112:115]
v_mfma_f32_16x16x32_bf16 a[112:115], v[36:39], v[156:159], a[112:115]
s_waitcnt lgkmcnt(4)
v_cvt_pk_bf16_f32 v180, v104, v105
v_mfma_f32_16x16x32_bf16 a[20:23], v[40:43], v[128:131], a[20:23]
v_cvt_pk_bf16_f32 v181, v106, v107
v_mfma_f32_16x16x32_bf16 a[20:23], v[44:47], v[132:135], a[20:23]
v_exp_f32 v108, v108
v_mfma_f32_16x16x32_bf16 a[52:55], v[40:43], v[136:139], a[52:55]
v_exp_f32 v109, v109
v_mfma_f32_16x16x32_bf16 a[52:55], v[44:47], v[140:143], a[52:55]
v_mfma_f32_16x16x32_bf16 a[84:87], v[40:43], v[144:147], a[84:87]
v_exp_f32 v110, v110
v_mfma_f32_16x16x32_bf16 a[84:87], v[44:47], v[148:151], a[84:87]
v_exp_f32 v111, v111
v_mfma_f32_16x16x32_bf16 a[116:119], v[40:43], v[152:155], a[116:119]
v_mfma_f32_16x16x32_bf16 a[116:119], v[44:47], v[156:159], a[116:119]
s_waitcnt lgkmcnt(2)
v_cvt_pk_bf16_f32 v188, v108, v109
v_mfma_f32_16x16x32_bf16 a[24:27], v[48:51], v[128:131], a[24:27]
s_waitcnt vmcnt(8) lgkmcnt(0)
s_barrier
v_cvt_pk_bf16_f32 v189, v110, v111
v_mfma_f32_16x16x32_bf16 a[24:27], v[52:55], v[132:135], a[24:27]
ds_read_b128 a[208:211], v4
v_mfma_f32_16x16x32_bf16 a[56:59], v[48:51], v[136:139], a[56:59]
v_exp_f32 v112, v112
v_mfma_f32_16x16x32_bf16 a[56:59], v[52:55], v[140:143], a[56:59]
ds_read_b128 a[212:215], v4 offset:1024
v_mfma_f32_16x16x32_bf16 a[88:91], v[48:51], v[144:147], a[88:91]
v_exp_f32 v113, v113
v_mfma_f32_16x16x32_bf16 a[88:91], v[52:55], v[148:151], a[88:91]
v_exp_f32 v114, v114
v_mfma_f32_16x16x32_bf16 a[120:123], v[48:51], v[152:155], a[120:123]
ds_read_b128 a[216:219], v4 offset:2048
v_mfma_f32_16x16x32_bf16 a[120:123], v[52:55], v[156:159], a[120:123]
v_exp_f32 v115, v115
v_mfma_f32_16x16x32_bf16 a[28:31], v[56:59], v[128:131], a[28:31]
ds_read_b128 a[220:223], v4 offset:3072
v_cvt_pk_bf16_f32 v166, v112, v113
v_mfma_f32_16x16x32_bf16 a[28:31], v[60:63], v[132:135], a[28:31]
v_cvt_pk_bf16_f32 v167, v114, v115
v_mfma_f32_16x16x32_bf16 a[60:63], v[56:59], v[136:139], a[60:63]
v_exp_f32 v116, v116
v_mfma_f32_16x16x32_bf16 a[60:63], v[60:63], v[140:143], a[60:63]
ds_read_b128 a[224:227], v4 offset:4096
v_mfma_f32_16x16x32_bf16 a[92:95], v[56:59], v[144:147], a[92:95]
v_exp_f32 v117, v117
v_mfma_f32_16x16x32_bf16 a[92:95], v[60:63], v[148:151], a[92:95]
v_exp_f32 v118, v118
v_mfma_f32_16x16x32_bf16 a[124:127], v[56:59], v[152:155], a[124:127]
ds_read_b128 a[228:231], v4 offset:5120
v_mfma_f32_16x16x32_bf16 a[124:127], v[60:63], v[156:159], a[124:127]
v_exp_f32 v119, v119
v_mfma_f32_16x16x32_bf16 a[128:131], v[28:31], v[128:131], a[128:131]
ds_read_b128 a[232:235], v4 offset:6144
v_cvt_pk_bf16_f32 v174, v116, v117
v_mfma_f32_16x16x32_bf16 a[128:131], v[28:31], v[132:135], a[128:131]
v_cvt_pk_bf16_f32 v175, v118, v119
v_mfma_f32_16x16x32_bf16 a[132:135], v[28:31], v[136:139], a[132:135]
v_mfma_f32_16x16x32_bf16 a[132:135], v[28:31], v[140:143], a[132:135]
ds_read_b128 a[236:239], v4 offset:7168
v_mfma_f32_16x16x32_bf16 a[136:139], v[28:31], v[144:147], a[136:139]
v_mfma_f32_16x16x32_bf16 a[136:139], v[28:31], v[148:151], a[136:139]
v_mfma_f32_16x16x32_bf16 a[140:143], v[28:31], v[152:155], a[140:143]
v_mfma_f32_16x16x32_bf16 a[140:143], v[28:31], v[156:159], a[140:143]
v_xor_b32 v3, 0x10000, v3
v_xor_b32 v4, 0x10000, v4
s_sub_u32 s23, s22, 1
s_cmp_eq_u32 s23, 0
s_cbranch_scc1 L_att_DDm0
L_att_DD0:
s_waitcnt lgkmcnt(4)
v_mfma_f32_16x16x32_bf16 v[64:67], a[208:211], a[144:147], v[192:195]
ds_read_b128 a[240:243], v3 offset:16384
v_mfma_f32_16x16x32_bf16 v[64:67], a[212:215], a[148:151], v[64:67]
v_exp_f32 v120, v120
v_mfma_f32_16x16x32_bf16 v[64:67], a[216:219], a[152:155], v[64:67]
s_mov_b32 m0, s25
s_mov_b32 s26, s24
buffer_load_dwordx4 v2, s[40:43], s26 offen lds
v_mfma_f32_16x16x32_bf16 v[64:67], a[220:223], a[156:159], v[64:67]
ds_read_b128 a[244:247], v3 offset:17408
v_mfma_f32_16x16x32_bf16 v[68:71], a[208:211], a[160:163], v[196:199]
v_exp_f32 v121, v121
v_mfma_f32_16x16x32_bf16 v[68:71], a[212:215], a[164:167], v[68:71]
v_exp_f32 v122, v122
v_mfma_f32_16x16x32_bf16 v[68:71], a[216:219], a[168:171], v[68:71]
v_exp_f32 v123, v123
v_mfma_f32_16x16x32_bf16 v[68:71], a[220:223], a[172:175], v[68:71]
ds_read_b128 a[248:251], v3 offset:18432
v_cvt_pk_bf16_f32 v182, v120, v121
v_mfma_f32_16x16x32_bf16 v[72:75], a[208:211], a[176:179], v[200:203]
v_cvt_pk_bf16_f32 v183, v122, v123
v_mfma_f32_16x16x32_bf16 v[72:75], a[212:215], a[180:183], v[72:75]
v_exp_f32 v124, v124
v_mfma_f32_16x16x32_bf16 v[72:75], a[216:219], a[184:187], v[72:75]
v_exp_f32 v125, v125
v_mfma_f32_16x16x32_bf16 v[72:75], a[220:223], a[188:191], v[72:75]
ds_read_b128 a[252:255], v3 offset:19456
v_mfma_f32_16x16x32_bf16 v[76:79], a[208:211], a[192:195], v[204:207]
v_exp_f32 v126, v126
v_mfma_f32_16x16x32_bf16 v[76:79], a[212:215], a[196:199], v[76:79]
buffer_load_dwordx4 v2, s[40:43], s26 offen offset:1024 lds
v_mfma_f32_16x16x32_bf16 v[76:79], a[216:219], a[200:203], v[76:79]
v_exp_f32 v127, v127
v_mfma_f32_16x16x32_bf16 v[76:79], a[220:223], a[204:207], v[76:79]
s_waitcnt lgkmcnt(4)
v_cvt_pk_bf16_f32 v190, v124, v125
v_cvt_pk_bf16_f32 v191, v126, v127
v_mfma_f32_16x16x32_bf16 v[80:83], a[224:227], a[144:147], v[192:195]
ds_read_b128 v[240:243], v3 offset:20480
v_mfma_f32_16x16x32_bf16 v[80:83], a[228:231], a[148:151], v[80:83]
v_exp_f32 v64, v64
v_mfma_f32_16x16x32_bf16 v[80:83], a[232:235], a[152:155], v[80:83]
v_exp_f32 v65, v65
v_mfma_f32_16x16x32_bf16 v[80:83], a[236:239], a[156:159], v[80:83]
ds_read_b128 v[244:247], v3 offset:21504
v_mfma_f32_16x16x32_bf16 v[84:87], a[224:227], a[160:163], v[196:199]
v_exp_f32 v66, v66
v_mfma_f32_16x16x32_bf16 v[84:87], a[228:231], a[164:167], v[84:87]
v_exp_f32 v67, v67
v_mfma_f32_16x16x32_bf16 v[84:87], a[232:235], a[168:171], v[84:87]
v_cvt_pk_bf16_f32 v128, v64, v65
v_cvt_pk_bf16_f32 v129, v66, v67
v_mfma_f32_16x16x32_bf16 v[84:87], a[236:239], a[172:175], v[84:87]
ds_read_b128 v[248:251], v3 offset:22528
v_mfma_f32_16x16x32_bf16 v[88:91], a[224:227], a[176:179], v[200:203]
buffer_load_dwordx4 v2, s[40:43], s26 offen offset:2048 lds
v_mfma_f32_16x16x32_bf16 v[88:91], a[228:231], a[180:183], v[88:91]
v_exp_f32 v68, v68
v_mfma_f32_16x16x32_bf16 v[88:91], a[232:235], a[184:187], v[88:91]
v_exp_f32 v69, v69
v_mfma_f32_16x16x32_bf16 v[88:91], a[236:239], a[188:191], v[88:91]
ds_read_b128 v[252:255], v3 offset:23552
v_mfma_f32_16x16x32_bf16 v[92:95], a[224:227], a[192:195], v[204:207]
v_exp_f32 v70, v70
v_mfma_f32_16x16x32_bf16 v[92:95], a[228:231], a[196:199], v[92:95]
v_exp_f32 v71, v71
v_mfma_f32_16x16x32_bf16 v[92:95], a[232:235], a[200:203], v[92:95]
v_cvt_pk_bf16_f32 v136, v68, v69
v_cvt_pk_bf16_f32 v137, v70, v71
v_mfma_f32_16x16x32_bf16 v[92:95], a[236:239], a[204:207], v[92:95]
s_waitcnt lgkmcnt(4)
v_exp_f32 v72, v72
v_mfma_f32_16x16x32_bf16 v[96:99], a[240:243], a[144:147], v[192:195]
ds_read_b128 v[32:35], v4 offset:40960
v_mfma_f32_16x16x32_bf16 v[96:99], a[244:247], a[148:151], v[96:99]
v_exp_f32 v73, v73
v_mfma_f32_16x16x32_bf16 v[96:99], a[248:251], a[152:155], v[96:99]
v_exp_f32 v74, v74
v_mfma_f32_16x16x32_bf16 v[96:99], a[252:255], a[156:159], v[96:99]
buffer_load_dwordx4 v2, s[40:43], s26 offen offset:3072 lds
v_mfma_f32_16x16x32_bf16 v[100:103], a[240:243], a[160:163], v[196:199]
v_exp_f32 v75, v75
v_mfma_f32_16x16x32_bf16 v[100:103], a[244:247], a[164:167], v[100:103]
ds_read_b128 v[36:39], v4 offset:57344
v_cvt_pk_bf16_f32 v144, v72, v73
v_mfma_f32_16x16x32_bf16 v[100:103], a[248:251], a[168:171], v[100:103]
v_cvt_pk_bf16_f32 v145, v74, v75
v_mfma_f32_16x16x32_bf16 v[100:103], a[252:255], a[172:175], v[100:103]
v_exp_f32 v76, v76
v_mfma_f32_16x16x32_bf16 v[104:107], a[240:243], a[176:179], v[200:203]
v_exp_f32 v77, v77
v_mfma_f32_16x16x32_bf16 v[104:107], a[244:247], a[180:183], v[104:107]
v_exp_f32 v78, v78
v_mfma_f32_16x16x32_bf16 v[104:107], a[248:251], a[184:187], v[104:107]
ds_read_b128 v[40:43], v4 offset:41984
v_mfma_f32_16x16x32_bf16 v[104:107], a[252:255], a[188:191], v[104:107]
v_exp_f32 v79, v79
v_mfma_f32_16x16x32_bf16 v[108:111], a[240:243], a[192:195], v[204:207]
v_cvt_pk_bf16_f32 v152, v76, v77
v_mfma_f32_16x16x32_bf16 v[108:111], a[244:247], a[196:199], v[108:111]
v_cvt_pk_bf16_f32 v153, v78, v79
v_mfma_f32_16x16x32_bf16 v[108:111], a[248:251], a[200:203], v[108:111]
s_add_u32 m0, m0, 4096
s_add_u32 s26, s26, 4096
buffer_load_dwordx4 v2, s[40:43], s26 offen lds
v_mfma_f32_16x16x32_bf16 v[108:111], a[252:255], a[204:207], v[108:111]
s_waitcnt lgkmcnt(3)
ds_read_b128 v[44:47], v4 offset:58368
v_mfma_f32_16x16x32_bf16 v[112:115], v[240:243], a[144:147], v[192:195]
v_exp_f32 v80, v80
v_mfma_f32_16x16x32_bf16 v[112:115], v[244:247], a[148:151], v[112:115]
v_exp_f32 v81, v81
v_mfma_f32_16x16x32_bf16 v[112:115], v[248:251], a[152:155], v[112:115]
v_exp_f32 v82, v82
v_mfma_f32_16x16x32_bf16 v[112:115], v[252:255], a[156:159], v[112:115]
v_exp_f32 v83, v83
v_mfma_f32_16x16x32_bf16 v[116:119], v[240:243], a[160:163], v[196:199]
ds_read_b128 v[48:51], v4 offset:43008
v_cvt_pk_bf16_f32 v130, v80, v81
v_mfma_f32_16x16x32_bf16 v[116:119], v[244:247], a[164:167], v[116:119]
v_cvt_pk_bf16_f32 v131, v82, v83
v_mfma_f32_16x16x32_bf16 v[116:119], v[248:251], a[168:171], v[116:119]
v_exp_f32 v84, v84
v_mfma_f32_16x16x32_bf16 v[116:119], v[252:255], a[172:175], v[116:119]
v_mfma_f32_16x16x32_bf16 v[120:123], v[240:243], a[176:179], v[200:203]
v_exp_f32 v85, v85
v_mfma_f32_16x16x32_bf16 v[120:123], v[244:247], a[180:183], v[120:123]
ds_read_b128 v[52:55], v4 offset:59392
v_mfma_f32_16x16x32_bf16 v[120:123], v[248:251], a[184:187], v[120:123]
buffer_load_dwordx4 v2, s[40:43], s26 offen offset:1024 lds
v_mfma_f32_16x16x32_bf16 v[120:123], v[252:255], a[188:191], v[120:123]
v_exp_f32 v86, v86
v_mfma_f32_16x16x32_bf16 v[124:127], v[240:243], a[192:195], v[204:207]
v_exp_f32 v87, v87
v_mfma_f32_16x16x32_bf16 v[124:127], v[244:247], a[196:199], v[124:127]
v_cvt_pk_bf16_f32 v138, v84, v85
v_mfma_f32_16x16x32_bf16 v[124:127], v[248:251], a[200:203], v[124:127]
v_cvt_pk_bf16_f32 v139, v86, v87
v_mfma_f32_16x16x32_bf16 v[124:127], v[252:255], a[204:207], v[124:127]
s_waitcnt lgkmcnt(4)
v_exp_f32 v88, v88
v_mfma_f32_16x16x32_bf16 a[0:3], v[32:35], v[160:163], a[0:3]
ds_read_b128 v[56:59], v4 offset:44032
v_mfma_f32_16x16x32_bf16 a[0:3], v[36:39], v[164:167], a[0:3]
v_exp_f32 v89, v89
v_mfma_f32_16x16x32_bf16 a[32:35], v[32:35], v[168:171], a[32:35]
v_exp_f32 v90, v90
v_mfma_f32_16x16x32_bf16 a[32:35], v[36:39], v[172:175], a[32:35]
v_mfma_f32_16x16x32_bf16 a[64:67], v[32:35], v[176:179], a[64:67]
ds_read_b128 v[60:63], v4 offset:60416
v_mfma_f32_16x16x32_bf16 a[64:67], v[36:39], v[180:183], a[64:67]
buffer_load_dwordx4 v2, s[40:43], s26 offen offset:2048 lds
v_mfma_f32_16x16x32_bf16 a[96:99], v[32:35], v[184:187], a[96:99]
v_exp_f32 v91, v91
v_mfma_f32_16x16x32_bf16 a[96:99], v[36:39], v[188:191], a[96:99]
s_waitcnt lgkmcnt(4)
v_cvt_pk_bf16_f32 v146, v88, v89
v_cvt_pk_bf16_f32 v147, v90, v91
v_mfma_f32_16x16x32_bf16 a[4:7], v[40:43], v[160:163], a[4:7]
ds_read_b128 v[32:35], v4 offset:45056
v_mfma_f32_16x16x32_bf16 a[4:7], v[44:47], v[164:167], a[4:7]
v_exp_f32 v92, v92
v_mfma_f32_16x16x32_bf16 a[36:39], v[40:43], v[168:171], a[36:39]
v_exp_f32 v93, v93
v_mfma_f32_16x16x32_bf16 a[36:39], v[44:47], v[172:175], a[36:39]
v_exp_f32 v94, v94
v_mfma_f32_16x16x32_bf16 a[68:71], v[40:43], v[176:179], a[68:71]
ds_read_b128 v[36:39], v4 offset:61440
v_mfma_f32_16x16x32_bf16 a[68:71], v[44:47], v[180:183], a[68:71]
v_exp_f32 v95, v95
v_mfma_f32_16x16x32_bf16 a[100:103], v[40:43], v[184:187], a[100:103]
v_cvt_pk_bf16_f32 v154, v92, v93
v_cvt_pk_bf16_f32 v155, v94, v95
v_mfma_f32_16x16x32_bf16 a[100:103], v[44:47], v[188:191], a[100:103]
s_waitcnt lgkmcnt(4)
buffer_load_dwordx4 v2, s[40:43], s26 offen offset:3072 lds
s_add_u32 s24, s24, 32768
s_add_u32 s25, s25, 32768
s_and_b32 s25, s25, 0x1ffff
v_mfma_f32_16x16x32_bf16 a[8:11], v[48:51], v[160:163], a[8:11]
ds_read_b128 v[40:43], v4 offset:46080
v_mfma_f32_16x16x32_bf16 a[8:11], v[52:55], v[164:167], a[8:11]
v_exp_f32 v96, v96
v_mfma_f32_16x16x32_bf16 a[40:43], v[48:51], v[168:171], a[40:43]
v_exp_f32 v97, v97
v_mfma_f32_16x16x32_bf16 a[40:43], v[52:55], v[172:175], a[40:43]
v_exp_f32 v98, v98
v_mfma_f32_16x16x32_bf16 a[72:75], v[48:51], v[176:179], a[72:75]
ds_read_b128 v[44:47], v4 offset:62464
v_mfma_f32_16x16x32_bf16 a[72:75], v[52:55], v[180:183], a[72:75]
v_exp_f32 v99, v99
v_mfma_f32_16x16x32_bf16 a[104:107], v[48:51], v[184:187], a[104:107]
v_cvt_pk_bf16_f32 v132, v96, v97
v_mfma_f32_16x16x32_bf16 a[104:107], v[52:55], v[188:191], a[104:107]
s_waitcnt lgkmcnt(4)
v_cvt_pk_bf16_f32 v133, v98, v99
v_mfma_f32_16x16x32_bf16 a[12:15], v[56:59], v[160:163], a[12:15]
ds_read_b128 v[48:51], v4 offset:47104
v_mfma_f32_16x16x32_bf16 a[12:15], v[60:63], v[164:167], a[12:15]
v_exp_f32 v100, v100
v_mfma_f32_16x16x32_bf16 a[44:47], v[56:59], v[168:171], a[44:47]
v_exp_f32 v101, v101
v_mfma_f32_16x16x32_bf16 a[44:47], v[60:63], v[172:175], a[44:47]
v_exp_f32 v102, v102
v_mfma_f32_16x16x32_bf16 a[76:79], v[56:59], v[176:179], a[76:79]
ds_read_b128 v[52:55], v4 offset:63488
v_mfma_f32_16x16x32_bf16 a[76:79], v[60:63], v[180:183], a[76:79]
v_exp_f32 v103, v103
v_mfma_f32_16x16x32_bf16 a[108:111], v[56:59], v[184:187], a[108:111]
v_cvt_pk_bf16_f32 v140, v100, v101
v_mfma_f32_16x16x32_bf16 a[108:111], v[60:63], v[188:191], a[108:111]
s_waitcnt lgkmcnt(4)
v_cvt_pk_bf16_f32 v141, v102, v103
v_mfma_f32_16x16x32_bf16 a[16:19], v[32:35], v[160:163], a[16:19]
ds_read_b128 v[56:59], v4 offset:48128
v_mfma_f32_16x16x32_bf16 a[16:19], v[36:39], v[164:167], a[16:19]
v_exp_f32 v104, v104
v_mfma_f32_16x16x32_bf16 a[48:51], v[32:35], v[168:171], a[48:51]
v_exp_f32 v105, v105
v_mfma_f32_16x16x32_bf16 a[48:51], v[36:39], v[172:175], a[48:51]
v_exp_f32 v106, v106
v_mfma_f32_16x16x32_bf16 a[80:83], v[32:35], v[176:179], a[80:83]
ds_read_b128 v[60:63], v4 offset:64512
v_mfma_f32_16x16x32_bf16 a[80:83], v[36:39], v[180:183], a[80:83]
v_exp_f32 v107, v107
v_mfma_f32_16x16x32_bf16 a[112:115], v[32:35], v[184:187], a[112:115]
v_mfma_f32_16x16x32_bf16 a[112:115], v[36:39], v[188:191], a[112:115]
s_waitcnt lgkmcnt(4)
v_cvt_pk_bf16_f32 v148, v104, v105
v_mfma_f32_16x16x32_bf16 a[20:23], v[40:43], v[160:163], a[20:23]
v_cvt_pk_bf16_f32 v149, v106, v107
v_mfma_f32_16x16x32_bf16 a[20:23], v[44:47], v[164:167], a[20:23]
v_exp_f32 v108, v108
v_mfma_f32_16x16x32_bf16 a[52:55], v[40:43], v[168:171], a[52:55]
v_exp_f32 v109, v109
v_mfma_f32_16x16x32_bf16 a[52:55], v[44:47], v[172:175], a[52:55]
v_mfma_f32_16x16x32_bf16 a[84:87], v[40:43], v[176:179], a[84:87]
v_exp_f32 v110, v110
v_mfma_f32_16x16x32_bf16 a[84:87], v[44:47], v[180:183], a[84:87]
v_exp_f32 v111, v111
v_mfma_f32_16x16x32_bf16 a[116:119], v[40:43], v[184:187], a[116:119]
v_mfma_f32_16x16x32_bf16 a[116:119], v[44:47], v[188:191], a[116:119]
s_waitcnt lgkmcnt(2)
v_cvt_pk_bf16_f32 v156, v108, v109
v_mfma_f32_16x16x32_bf16 a[24:27], v[48:51], v[160:163], a[24:27]
s_waitcnt vmcnt(8) lgkmcnt(0)
s_barrier
v_cvt_pk_bf16_f32 v157, v110, v111
v_mfma_f32_16x16x32_bf16 a[24:27], v[52:55], v[164:167], a[24:27]
ds_read_b128 a[208:211], v3 offset:32768
v_mfma_f32_16x16x32_bf16 a[56:59], v[48:51], v[168:171], a[56:59]
v_exp_f32 v112, v112
v_mfma_f32_16x16x32_bf16 a[56:59], v[52:55], v[172:175], a[56:59]
ds_read_b128 a[212:215], v3 offset:33792
v_mfma_f32_16x16x32_bf16 a[88:91], v[48:51], v[176:179], a[88:91]
v_exp_f32 v113, v113
v_mfma_f32_16x16x32_bf16 a[88:91], v[52:55], v[180:183], a[88:91]
v_exp_f32 v114, v114
v_mfma_f32_16x16x32_bf16 a[120:123], v[48:51], v[184:187], a[120:123]
ds_read_b128 a[216:219], v3 offset:34816
v_mfma_f32_16x16x32_bf16 a[120:123], v[52:55], v[188:191], a[120:123]
v_exp_f32 v115, v115
v_mfma_f32_16x16x32_bf16 a[28:31], v[56:59], v[160:163], a[28:31]
ds_read_b128 a[220:223], v3 offset:35840
v_cvt_pk_bf16_f32 v134, v112, v113
v_mfma_f32_16x16x32_bf16 a[28:31], v[60:63], v[164:167], a[28:31]
v_cvt_pk_bf16_f32 v135, v114, v115
v_mfma_f32_16x16x32_bf16 a[60:63], v[56:59], v[168:171], a[60:63]
v_exp_f32 v116, v116
v_mfma_f32_16x16x32_bf16 a[60:63], v[60:63], v[172:175], a[60:63]
ds_read_b128 a[224:227], v3 offset:36864
v_mfma_f32_16x16x32_bf16 a[92:95], v[56:59], v[176:179], a[92:95]
v_exp_f32 v117, v117
v_mfma_f32_16x16x32_bf16 a[92:95], v[60:63], v[180:183], a[92:95]
v_exp_f32 v118, v118
v_mfma_f32_16x16x32_bf16 a[124:127], v[56:59], v[184:187], a[124:127]
ds_read_b128 a[228:231], v3 offset:37888
v_mfma_f32_16x16x32_bf16 a[124:127], v[60:63], v[188:191], a[124:127]
v_exp_f32 v119, v119
v_mfma_f32_16x16x32_bf16 a[128:131], v[28:31], v[160:163], a[128:131]
ds_read_b128 a[232:235], v3 offset:38912
v_cvt_pk_bf16_f32 v142, v116, v117
v_mfma_f32_16x16x32_bf16 a[128:131], v[28:31], v[164:167], a[128:131]
v_cvt_pk_bf16_f32 v143, v118, v119
v_mfma_f32_16x16x32_bf16 a[132:135], v[28:31], v[168:171], a[132:135]
v_mfma_f32_16x16x32_bf16 a[132:135], v[28:31], v[172:175], a[132:135]
ds_read_b128 a[236:239], v3 offset:39936
v_mfma_f32_16x16x32_bf16 a[136:139], v[28:31], v[176:179], a[136:139]
v_mfma_f32_16x16x32_bf16 a[136:139], v[28:31], v[180:183], a[136:139]
v_mfma_f32_16x16x32_bf16 a[140:143], v[28:31], v[184:187], a[140:143]
v_mfma_f32_16x16x32_bf16 a[140:143], v[28:31], v[188:191], a[140:143]
L_att_DD1:
s_waitcnt lgkmcnt(4)
v_mfma_f32_16x16x32_bf16 v[64:67], a[208:211], a[144:147], v[192:195]
ds_read_b128 a[240:243], v3 offset:49152
v_mfma_f32_16x16x32_bf16 v[64:67], a[212:215], a[148:151], v[64:67]
v_exp_f32 v120, v120
v_mfma_f32_16x16x32_bf16 v[64:67], a[216:219], a[152:155], v[64:67]
s_mov_b32 m0, s25
s_mov_b32 s26, s24
buffer_load_dwordx4 v2, s[40:43], s26 offen lds
v_mfma_f32_16x16x32_bf16 v[64:67], a[220:223], a[156:159], v[64:67]
ds_read_b128 a[244:247], v3 offset:50176
v_mfma_f32_16x16x32_bf16 v[68:71], a[208:211], a[160:163], v[196:199]
v_exp_f32 v121, v121
v_mfma_f32_16x16x32_bf16 v[68:71], a[212:215], a[164:167], v[68:71]
v_exp_f32 v122, v122
v_mfma_f32_16x16x32_bf16 v[68:71], a[216:219], a[168:171], v[68:71]
v_exp_f32 v123, v123
v_mfma_f32_16x16x32_bf16 v[68:71], a[220:223], a[172:175], v[68:71]
ds_read_b128 a[248:251], v3 offset:51200
v_cvt_pk_bf16_f32 v150, v120, v121
v_mfma_f32_16x16x32_bf16 v[72:75], a[208:211], a[176:179], v[200:203]
v_cvt_pk_bf16_f32 v151, v122, v123
v_mfma_f32_16x16x32_bf16 v[72:75], a[212:215], a[180:183], v[72:75]
v_exp_f32 v124, v124
v_mfma_f32_16x16x32_bf16 v[72:75], a[216:219], a[184:187], v[72:75]
v_exp_f32 v125, v125
v_mfma_f32_16x16x32_bf16 v[72:75], a[220:223], a[188:191], v[72:75]
ds_read_b128 a[252:255], v3 offset:52224
v_mfma_f32_16x16x32_bf16 v[76:79], a[208:211], a[192:195], v[204:207]
v_exp_f32 v126, v126
v_mfma_f32_16x16x32_bf16 v[76:79], a[212:215], a[196:199], v[76:79]
buffer_load_dwordx4 v2, s[40:43], s26 offen offset:1024 lds
v_mfma_f32_16x16x32_bf16 v[76:79], a[216:219], a[200:203], v[76:79]
v_exp_f32 v127, v127
v_mfma_f32_16x16x32_bf16 v[76:79], a[220:223], a[204:207], v[76:79]
s_waitcnt lgkmcnt(4)
v_cvt_pk_bf16_f32 v158, v124, v125
v_cvt_pk_bf16_f32 v159, v126, v127
v_mfma_f32_16x16x32_bf16 v[80:83], a[224:227], a[144:147], v[192:195]
ds_read_b128 v[240:243], v3 offset:53248
v_mfma_f32_16x16x32_bf16 v[80:83], a[228:231], a[148:151], v[80:83]
v_exp_f32 v64, v64
v_mfma_f32_16x16x32_bf16 v[80:83], a[232:235], a[152:155], v[80:83]
v_exp_f32 v65, v65
v_mfma_f32_16x16x32_bf16 v[80:83], a[236:239], a[156:159], v[80:83]
ds_read_b128 v[244:247], v3 offset:54272
v_mfma_f32_16x16x32_bf16 v[84:87], a[224:227], a[160:163], v[196:199]
v_exp_f32 v66, v66
v_mfma_f32_16x16x32_bf16 v[84:87], a[228:231], a[164:167], v[84:87]
v_exp_f32 v67, v67
v_mfma_f32_16x16x32_bf16 v[84:87], a[232:235], a[168:171], v[84:87]
v_cvt_pk_bf16_f32 v160, v64, v65
v_cvt_pk_bf16_f32 v161, v66, v67
v_mfma_f32_16x16x32_bf16 v[84:87], a[236:239], a[172:175], v[84:87]
ds_read_b128 v[248:251], v3 offset:55296
v_mfma_f32_16x16x32_bf16 v[88:91], a[224:227], a[176:179], v[200:203]
buffer_load_dwordx4 v2, s[40:43], s26 offen offset:2048 lds
v_mfma_f32_16x16x32_bf16 v[88:91], a[228:231], a[180:183], v[88:91]
v_exp_f32 v68, v68
v_mfma_f32_16x16x32_bf16 v[88:91], a[232:235], a[184:187], v[88:91]
v_exp_f32 v69, v69
v_mfma_f32_16x16x32_bf16 v[88:91], a[236:239], a[188:191], v[88:91]
ds_read_b128 v[252:255], v3 offset:56320
v_mfma_f32_16x16x32_bf16 v[92:95], a[224:227], a[192:195], v[204:207]
v_exp_f32 v70, v70
v_mfma_f32_16x16x32_bf16 v[92:95], a[228:231], a[196:199], v[92:95]
v_exp_f32 v71, v71
v_mfma_f32_16x16x32_bf16 v[92:95], a[232:235], a[200:203], v[92:95]
v_cvt_pk_bf16_f32 v168, v68, v69
v_cvt_pk_bf16_f32 v169, v70, v71
v_mfma_f32_16x16x32_bf16 v[92:95], a[236:239], a[204:207], v[92:95]
s_waitcnt lgkmcnt(4)
v_exp_f32 v72, v72
v_mfma_f32_16x16x32_bf16 v[96:99], a[240:243], a[144:147], v[192:195]
ds_read_b128 v[32:35], v3 offset:8192
v_mfma_f32_16x16x32_bf16 v[96:99], a[244:247], a[148:151], v[96:99]
v_exp_f32 v73, v73
v_mfma_f32_16x16x32_bf16 v[96:99], a[248:251], a[152:155], v[96:99]
v_exp_f32 v74, v74
v_mfma_f32_16x16x32_bf16 v[96:99], a[252:255], a[156:159], v[96:99]
buffer_load_dwordx4 v2, s[40:43], s26 offen offset:3072 lds
v_mfma_f32_16x16x32_bf16 v[100:103], a[240:243], a[160:163], v[196:199]
v_exp_f32 v75, v75
v_mfma_f32_16x16x32_bf16 v[100:103], a[244:247], a[164:167], v[100:103]
ds_read_b128 v[36:39], v3 offset:24576
v_cvt_pk_bf16_f32 v176, v72, v73
v_mfma_f32_16x16x32_bf16 v[100:103], a[248:251], a[168:171], v[100:103]
v_cvt_pk_bf16_f32 v177, v74, v75
v_mfma_f32_16x16x32_bf16 v[100:103], a[252:255], a[172:175], v[100:103]
v_exp_f32 v76, v76
v_mfma_f32_16x16x32_bf16 v[104:107], a[240:243], a[176:179], v[200:203]
v_exp_f32 v77, v77
v_mfma_f32_16x16x32_bf16 v[104:107], a[244:247], a[180:183], v[104:107]
v_exp_f32 v78, v78
v_mfma_f32_16x16x32_bf16 v[104:107], a[248:251], a[184:187], v[104:107]
ds_read_b128 v[40:43], v3 offset:9216
v_mfma_f32_16x16x32_bf16 v[104:107], a[252:255], a[188:191], v[104:107]
v_exp_f32 v79, v79
v_mfma_f32_16x16x32_bf16 v[108:111], a[240:243], a[192:195], v[204:207]
v_cvt_pk_bf16_f32 v184, v76, v77
v_mfma_f32_16x16x32_bf16 v[108:111], a[244:247], a[196:199], v[108:111]
v_cvt_pk_bf16_f32 v185, v78, v79
v_mfma_f32_16x16x32_bf16 v[108:111], a[248:251], a[200:203], v[108:111]
s_add_u32 m0, m0, 4096
s_add_u32 s26, s26, 4096
buffer_load_dwordx4 v2, s[40:43], s26 offen lds
v_mfma_f32_16x16x32_bf16 v[108:111], a[252:255], a[204:207], v[108:111]
s_waitcnt lgkmcnt(3)
ds_read_b128 v[44:47], v3 offset:25600
v_mfma_f32_16x16x32_bf16 v[112:115], v[240:243], a[144:147], v[192:195]
v_exp_f32 v80, v80
v_mfma_f32_16x16x32_bf16 v[112:115], v[244:247], a[148:151], v[112:115]
v_exp_f32 v81, v81
v_mfma_f32_16x16x32_bf16 v[112:115], v[248:251], a[152:155], v[112:115]
v_exp_f32 v82, v82
v_mfma_f32_16x16x32_bf16 v[112:115], v[252:255], a[156:159], v[112:115]
v_exp_f32 v83, v83
v_mfma_f32_16x16x32_bf16 v[116:119], v[240:243], a[160:163], v[196:199]
ds_read_b128 v[48:51], v3 offset:10240
v_cvt_pk_bf16_f32 v162, v80, v81
v_mfma_f32_16x16x32_bf16 v[116:119], v[244:247], a[164:167], v[116:119]
v_cvt_pk_bf16_f32 v163, v82, v83
v_mfma_f32_16x16x32_bf16 v[116:119], v[248:251], a[168:171], v[116:119]
v_exp_f32 v84, v84
v_mfma_f32_16x16x32_bf16 v[116:119], v[252:255], a[172:175], v[116:119]
v_mfma_f32_16x16x32_bf16 v[120:123], v[240:243], a[176:179], v[200:203]
v_exp_f32 v85, v85
v_mfma_f32_16x16x32_bf16 v[120:123], v[244:247], a[180:183], v[120:123]
ds_read_b128 v[52:55], v3 offset:26624
v_mfma_f32_16x16x32_bf16 v[120:123], v[248:251], a[184:187], v[120:123]
buffer_load_dwordx4 v2, s[40:43], s26 offen offset:1024 lds
v_mfma_f32_16x16x32_bf16 v[120:123], v[252:255], a[188:191], v[120:123]
v_exp_f32 v86, v86
v_mfma_f32_16x16x32_bf16 v[124:127], v[240:243], a[192:195], v[204:207]
v_exp_f32 v87, v87
v_mfma_f32_16x16x32_bf16 v[124:127], v[244:247], a[196:199], v[124:127]
v_cvt_pk_bf16_f32 v170, v84, v85
v_mfma_f32_16x16x32_bf16 v[124:127], v[248:251], a[200:203], v[124:127]
v_cvt_pk_bf16_f32 v171, v86, v87
v_mfma_f32_16x16x32_bf16 v[124:127], v[252:255], a[204:207], v[124:127]
s_waitcnt lgkmcnt(4)
v_exp_f32 v88, v88
v_mfma_f32_16x16x32_bf16 a[0:3], v[32:35], v[128:131], a[0:3]
ds_read_b128 v[56:59], v3 offset:11264
v_mfma_f32_16x16x32_bf16 a[0:3], v[36:39], v[132:135], a[0:3]
v_exp_f32 v89, v89
v_mfma_f32_16x16x32_bf16 a[32:35], v[32:35], v[136:139], a[32:35]
v_exp_f32 v90, v90
v_mfma_f32_16x16x32_bf16 a[32:35], v[36:39], v[140:143], a[32:35]
v_mfma_f32_16x16x32_bf16 a[64:67], v[32:35], v[144:147], a[64:67]
ds_read_b128 v[60:63], v3 offset:27648
v_mfma_f32_16x16x32_bf16 a[64:67], v[36:39], v[148:151], a[64:67]
buffer_load_dwordx4 v2, s[40:43], s26 offen offset:2048 lds
v_mfma_f32_16x16x32_bf16 a[96:99], v[32:35], v[152:155], a[96:99]
v_exp_f32 v91, v91
v_mfma_f32_16x16x32_bf16 a[96:99], v[36:39], v[156:159], a[96:99]
s_waitcnt lgkmcnt(4)
v_cvt_pk_bf16_f32 v178, v88, v89
v_cvt_pk_bf16_f32 v179, v90, v91
v_mfma_f32_16x16x32_bf16 a[4:7], v[40:43], v[128:131], a[4:7]
ds_read_b128 v[32:35], v3 offset:12288
v_mfma_f32_16x16x32_bf16 a[4:7], v[44:47], v[132:135], a[4:7]
v_exp_f32 v92, v92
v_mfma_f32_16x16x32_bf16 a[36:39], v[40:43], v[136:139], a[36:39]
v_exp_f32 v93, v93
v_mfma_f32_16x16x32_bf16 a[36:39], v[44:47], v[140:143], a[36:39]
v_exp_f32 v94, v94
v_mfma_f32_16x16x32_bf16 a[68:71], v[40:43], v[144:147], a[68:71]
ds_read_b128 v[36:39], v3 offset:28672
v_mfma_f32_16x16x32_bf16 a[68:71], v[44:47], v[148:151], a[68:71]
v_exp_f32 v95, v95
v_mfma_f32_16x16x32_bf16 a[100:103], v[40:43], v[152:155], a[100:103]
v_cvt_pk_bf16_f32 v186, v92, v93
v_cvt_pk_bf16_f32 v187, v94, v95
v_mfma_f32_16x16x32_bf16 a[100:103], v[44:47], v[156:159], a[100:103]
s_waitcnt lgkmcnt(4)
buffer_load_dwordx4 v2, s[40:43], s26 offen offset:3072 lds
s_add_u32 s24, s24, 32768
s_add_u32 s25, s25, 32768
s_and_b32 s25, s25, 0x1ffff
v_mfma_f32_16x16x32_bf16 a[8:11], v[48:51], v[128:131], a[8:11]
ds_read_b128 v[40:43], v3 offset:13312
v_mfma_f32_16x16x32_bf16 a[8:11], v[52:55], v[132:135], a[8:11]
v_exp_f32 v96, v96
v_mfma_f32_16x16x32_bf16 a[40:43], v[48:51], v[136:139], a[40:43]
v_exp_f32 v97, v97
v_mfma_f32_16x16x32_bf16 a[40:43], v[52:55], v[140:143], a[40:43]
v_exp_f32 v98, v98
v_mfma_f32_16x16x32_bf16 a[72:75], v[48:51], v[144:147], a[72:75]
ds_read_b128 v[44:47], v3 offset:29696
v_mfma_f32_16x16x32_bf16 a[72:75], v[52:55], v[148:151], a[72:75]
v_exp_f32 v99, v99
v_mfma_f32_16x16x32_bf16 a[104:107], v[48:51], v[152:155], a[104:107]
v_cvt_pk_bf16_f32 v164, v96, v97
v_mfma_f32_16x16x32_bf16 a[104:107], v[52:55], v[156:159], a[104:107]
s_waitcnt lgkmcnt(4)
v_cvt_pk_bf16_f32 v165, v98, v99
v_mfma_f32_16x16x32_bf16 a[12:15], v[56:59], v[128:131], a[12:15]
ds_read_b128 v[48:51], v3 offset:14336
v_mfma_f32_16x16x32_bf16 a[12:15], v[60:63], v[132:135], a[12:15]
v_exp_f32 v100, v100
v_mfma_f32_16x16x32_bf16 a[44:47], v[56:59], v[136:139], a[44:47]
v_exp_f32 v101, v101
v_mfma_f32_16x16x32_bf16 a[44:47], v[60:63], v[140:143], a[44:47]
v_exp_f32 v102, v102
v_mfma_f32_16x16x32_bf16 a[76:79], v[56:59], v[144:147], a[76:79]
ds_read_b128 v[52:55], v3 offset:30720
v_mfma_f32_16x16x32_bf16 a[76:79], v[60:63], v[148:151], a[76:79]
v_exp_f32 v103, v103
v_mfma_f32_16x16x32_bf16 a[108:111], v[56:59], v[152:155], a[108:111]
v_cvt_pk_bf16_f32 v172, v100, v101
v_mfma_f32_16x16x32_bf16 a[108:111], v[60:63], v[156:159], a[108:111]
s_waitcnt lgkmcnt(4)
v_cvt_pk_bf16_f32 v173, v102, v103
v_mfma_f32_16x16x32_bf16 a[16:19], v[32:35], v[128:131], a[16:19]
ds_read_b128 v[56:59], v3 offset:15360
v_mfma_f32_16x16x32_bf16 a[16:19], v[36:39], v[132:135], a[16:19]
v_exp_f32 v104, v104
v_mfma_f32_16x16x32_bf16 a[48:51], v[32:35], v[136:139], a[48:51]
v_exp_f32 v105, v105
v_mfma_f32_16x16x32_bf16 a[48:51], v[36:39], v[140:143], a[48:51]
v_exp_f32 v106, v106
v_mfma_f32_16x16x32_bf16 a[80:83], v[32:35], v[144:147], a[80:83]
ds_read_b128 v[60:63], v3 offset:31744
v_mfma_f32_16x16x32_bf16 a[80:83], v[36:39], v[148:151], a[80:83]
v_exp_f32 v107, v107
v_mfma_f32_16x16x32_bf16 a[112:115], v[32:35], v[152:155], a[112:115]
v_mfma_f32_16x16x32_bf16 a[112:115], v[36:39], v[156:159], a[112:115]
s_waitcnt lgkmcnt(4)
v_cvt_pk_bf16_f32 v180, v104, v105
v_mfma_f32_16x16x32_bf16 a[20:23], v[40:43], v[128:131], a[20:23]
v_cvt_pk_bf16_f32 v181, v106, v107
v_mfma_f32_16x16x32_bf16 a[20:23], v[44:47], v[132:135], a[20:23]
v_exp_f32 v108, v108
v_mfma_f32_16x16x32_bf16 a[52:55], v[40:43], v[136:139], a[52:55]
buffer_load_dword v23, v9, s[60:63], 0 offen
v_mfma_f32_16x16x32_bf16 a[52:55], v[44:47], v[140:143], a[52:55]
v_exp_f32 v109, v109
v_mfma_f32_16x16x32_bf16 a[84:87], v[40:43], v[144:147], a[84:87]
v_exp_f32 v110, v110
v_mfma_f32_16x16x32_bf16 a[84:87], v[44:47], v[148:151], a[84:87]
buffer_load_dword v24, v22, s[64:67], 0 offen
v_mfma_f32_16x16x32_bf16 a[116:119], v[40:43], v[152:155], a[116:119]
v_exp_f32 v111, v111
v_mfma_f32_16x16x32_bf16 a[116:119], v[44:47], v[156:159], a[116:119]
s_waitcnt lgkmcnt(2)
v_cvt_pk_bf16_f32 v188, v108, v109
v_mfma_f32_16x16x32_bf16 a[24:27], v[48:51], v[128:131], a[24:27]
s_waitcnt vmcnt(10) lgkmcnt(0)
s_barrier
v_cvt_pk_bf16_f32 v189, v110, v111
v_mfma_f32_16x16x32_bf16 a[24:27], v[52:55], v[132:135], a[24:27]
ds_read_b128 a[208:211], v4
v_add_u32 v9, 13312, v9
v_mfma_f32_16x16x32_bf16 a[56:59], v[48:51], v[136:139], a[56:59]
v_exp_f32 v112, v112
v_mfma_f32_16x16x32_bf16 a[56:59], v[52:55], v[140:143], a[56:59]
ds_read_b128 a[212:215], v4 offset:1024
v_add_u32 v22, 13312, v22
v_mfma_f32_16x16x32_bf16 a[88:91], v[48:51], v[144:147], a[88:91]
v_exp_f32 v113, v113
v_mfma_f32_16x16x32_bf16 a[88:91], v[52:55], v[148:151], a[88:91]
v_exp_f32 v114, v114
v_mfma_f32_16x16x32_bf16 a[120:123], v[48:51], v[152:155], a[120:123]
ds_read_b128 a[216:219], v4 offset:2048
v_mfma_f32_16x16x32_bf16 a[120:123], v[52:55], v[156:159], a[120:123]
v_exp_f32 v115, v115
v_mfma_f32_16x16x32_bf16 a[28:31], v[56:59], v[128:131], a[28:31]
ds_read_b128 a[220:223], v4 offset:3072
v_cvt_pk_bf16_f32 v166, v112, v113
v_mfma_f32_16x16x32_bf16 a[28:31], v[60:63], v[132:135], a[28:31]
v_cvt_pk_bf16_f32 v167, v114, v115
v_mfma_f32_16x16x32_bf16 a[60:63], v[56:59], v[136:139], a[60:63]
v_exp_f32 v116, v116
v_mfma_f32_16x16x32_bf16 a[60:63], v[60:63], v[140:143], a[60:63]
ds_read_b128 a[224:227], v4 offset:4096
v_mfma_f32_16x16x32_bf16 a[92:95], v[56:59], v[144:147], a[92:95]
v_exp_f32 v117, v117
v_mfma_f32_16x16x32_bf16 a[92:95], v[60:63], v[148:151], a[92:95]
v_exp_f32 v118, v118
v_mfma_f32_16x16x32_bf16 a[124:127], v[56:59], v[152:155], a[124:127]
ds_read_b128 a[228:231], v4 offset:5120
v_mfma_f32_16x16x32_bf16 a[124:127], v[60:63], v[156:159], a[124:127]
v_exp_f32 v119, v119
v_mfma_f32_16x16x32_bf16 a[128:131], v[28:31], v[128:131], a[128:131]
ds_read_b128 a[232:235], v4 offset:6144
v_cvt_pk_bf16_f32 v174, v116, v117
v_mfma_f32_16x16x32_bf16 a[128:131], v[28:31], v[132:135], a[128:131]
v_cvt_pk_bf16_f32 v175, v118, v119
v_mfma_f32_16x16x32_bf16 a[132:135], v[28:31], v[136:139], a[132:135]
v_mfma_f32_16x16x32_bf16 a[132:135], v[28:31], v[140:143], a[132:135]
ds_read_b128 a[236:239], v4 offset:7168
v_mfma_f32_16x16x32_bf16 a[136:139], v[28:31], v[144:147], a[136:139]
v_mfma_f32_16x16x32_bf16 a[136:139], v[28:31], v[148:151], a[136:139]
v_mfma_f32_16x16x32_bf16 a[140:143], v[28:31], v[152:155], a[140:143]
v_mfma_f32_16x16x32_bf16 a[140:143], v[28:31], v[156:159], a[140:143]
v_xor_b32 v3, 0x10000, v3
v_xor_b32 v4, 0x10000, v4
s_sub_u32 s23, s23, 1
s_cmp_lg_u32 s23, 0
s_cbranch_scc1 L_att_DD0
L_att_DDm0:
s_waitcnt lgkmcnt(4)
v_mfma_f32_16x16x32_bf16 v[64:67], a[208:211], a[144:147], v[192:195]
ds_read_b128 a[240:243], v3 offset:16384
v_add_f32 v208, v224, v200
v_mfma_f32_16x16x32_bf16 v[64:67], a[212:215], a[148:151], v[64:67]
v_add_f32 v209, v225, v200
v_add_f32 v210, v226, v200
v_mfma_f32_16x16x32_bf16 v[64:67], a[216:219], a[152:155], v[64:67]
s_mov_b32 m0, s25
s_mov_b32 s26, s24
buffer_load_dwordx4 v2, s[40:43], s26 offen lds
v_mfma_f32_16x16x32_bf16 v[64:67], a[220:223], a[156:159], v[64:67]
ds_read_b128 a[244:247], v3 offset:17408
v_add_f32 v211, v227, v200
v_mfma_f32_16x16x32_bf16 v[68:71], a[208:211], a[160:163], v[196:199]
v_exp_f32 v120, v120
v_mfma_f32_16x16x32_bf16 v[68:71], a[212:215], a[164:167], v[68:71]
v_exp_f32 v121, v121
v_mfma_f32_16x16x32_bf16 v[68:71], a[216:219], a[168:171], v[68:71]
v_exp_f32 v122, v122
v_mfma_f32_16x16x32_bf16 v[68:71], a[220:223], a[172:175], v[68:71]
ds_read_b128 a[248:251], v3 offset:18432
v_add_f32 v212, v228, v200
v_mfma_f32_16x16x32_bf16 v[72:75], a[208:211], a[176:179], v[208:211]
v_exp_f32 v123, v123
v_mfma_f32_16x16x32_bf16 v[72:75], a[212:215], a[180:183], v[72:75]
v_cvt_pk_bf16_f32 v182, v120, v121
v_cvt_pk_bf16_f32 v183, v122, v123
v_mfma_f32_16x16x32_bf16 v[72:75], a[216:219], a[184:187], v[72:75]
v_exp_f32 v124, v124
v_mfma_f32_16x16x32_bf16 v[72:75], a[220:223], a[188:191], v[72:75]
ds_read_b128 a[252:255], v3 offset:19456
v_add_f32 v213, v229, v200
v_mfma_f32_16x16x32_bf16 v[76:79], a[208:211], a[192:195], v[204:207]
v_exp_f32 v125, v125
v_mfma_f32_16x16x32_bf16 v[76:79], a[212:215], a[196:199], v[76:79]
buffer_load_dwordx4 v2, s[40:43], s26 offen offset:1024 lds
v_add_f32 v214, v230, v200
v_mfma_f32_16x16x32_bf16 v[76:79], a[216:219], a[200:203], v[76:79]
v_exp_f32 v126, v126
v_mfma_f32_16x16x32_bf16 v[76:79], a[220:223], a[204:207], v[76:79]
s_waitcnt lgkmcnt(4)
v_exp_f32 v127, v127
v_mfma_f32_16x16x32_bf16 v[80:83], a[224:227], a[144:147], v[192:195]
ds_read_b128 v[240:243], v3 offset:20480
v_cvt_pk_bf16_f32 v190, v124, v125
v_mfma_f32_16x16x32_bf16 v[80:83], a[228:231], a[148:151], v[80:83]
v_cvt_pk_bf16_f32 v191, v126, v127
v_add_f32 v215, v231, v200
v_mfma_f32_16x16x32_bf16 v[80:83], a[232:235], a[152:155], v[80:83]
v_exp_f32 v64, v64
v_mfma_f32_16x16x32_bf16 v[80:83], a[236:239], a[156:159], v[80:83]
ds_read_b128 v[244:247], v3 offset:21504
v_add_f32 v216, v232, v200
v_mfma_f32_16x16x32_bf16 v[84:87], a[224:227], a[160:163], v[196:199]
v_exp_f32 v65, v65
v_mfma_f32_16x16x32_bf16 v[84:87], a[228:231], a[164:167], v[84:87]
v_exp_f32 v66, v66
v_mfma_f32_16x16x32_bf16 v[84:87], a[232:235], a[168:171], v[84:87]
v_exp_f32 v67, v67
v_mfma_f32_16x16x32_bf16 v[84:87], a[236:239], a[172:175], v[84:87]
ds_read_b128 v[248:251], v3 offset:22528
v_cvt_pk_bf16_f32 v128, v64, v65
v_mfma_f32_16x16x32_bf16 v[88:91], a[224:227], a[176:179], v[212:215]
buffer_load_dwordx4 v2, s[40:43], s26 offen offset:2048 lds
v_cvt_pk_bf16_f32 v129, v66, v67
v_mfma_f32_16x16x32_bf16 v[88:91], a[228:231], a[180:183], v[88:91]
v_exp_f32 v68, v68
v_mfma_f32_16x16x32_bf16 v[88:91], a[232:235], a[184:187], v[88:91]
v_exp_f32 v69, v69
v_mfma_f32_16x16x32_bf16 v[88:91], a[236:239], a[188:191], v[88:91]
ds_read_b128 v[252:255], v3 offset:23552
v_add_f32 v217, v233, v200
v_mfma_f32_16x16x32_bf16 v[92:95], a[224:227], a[192:195], v[204:207]
v_exp_f32 v70, v70
v_mfma_f32_16x16x32_bf16 v[92:95], a[228:231], a[196:199], v[92:95]
v_exp_f32 v71, v71
v_mfma_f32_16x16x32_bf16 v[92:95], a[232:235], a[200:203], v[92:95]
v_add_f32 v218, v234, v200
v_cvt_pk_bf16_f32 v136, v68, v69
v_mfma_f32_16x16x32_bf16 v[92:95], a[236:239], a[204:207], v[92:95]
s_waitcnt lgkmcnt(4)
v_add_f32 v219, v235, v200
v_cvt_pk_bf16_f32 v137, v70, v71
v_mfma_f32_16x16x32_bf16 v[96:99], a[240:243], a[144:147], v[192:195]
ds_read_b128 v[32:35], v4 offset:40960
v_add_f32 v220, v236, v200
v_mfma_f32_16x16x32_bf16 v[96:99], a[244:247], a[148:151], v[96:99]
v_exp_f32 v72, v72
v_mfma_f32_16x16x32_bf16 v[96:99], a[248:251], a[152:155], v[96:99]
v_exp_f32 v73, v73
v_mfma_f32_16x16x32_bf16 v[96:99], a[252:255], a[156:159], v[96:99]
buffer_load_dwordx4 v2, s[40:43], s26 offen offset:3072 lds
v_add_f32 v221, v237, v200
v_mfma_f32_16x16x32_bf16 v[100:103], a[240:243], a[160:163], v[196:199]
v_exp_f32 v74, v74
v_mfma_f32_16x16x32_bf16 v[100:103], a[244:247], a[164:167], v[100:103]
ds_read_b128 v[36:39], v4 offset:57344
v_add_f32 v222, v238, v200
v_mfma_f32_16x16x32_bf16 v[100:103], a[248:251], a[168:171], v[100:103]
v_exp_f32 v75, v75
v_mfma_f32_16x16x32_bf16 v[100:103], a[252:255], a[172:175], v[100:103]
v_cvt_pk_bf16_f32 v144, v72, v73
v_cvt_pk_bf16_f32 v145, v74, v75
v_mfma_f32_16x16x32_bf16 v[104:107], a[240:243], a[176:179], v[216:219]
v_exp_f32 v76, v76
v_mfma_f32_16x16x32_bf16 v[104:107], a[244:247], a[180:183], v[104:107]
v_exp_f32 v77, v77
v_mfma_f32_16x16x32_bf16 v[104:107], a[248:251], a[184:187], v[104:107]
ds_read_b128 v[40:43], v4 offset:41984
v_add_f32 v223, v239, v200
v_mfma_f32_16x16x32_bf16 v[104:107], a[252:255], a[188:191], v[104:107]
v_exp_f32 v78, v78
v_mfma_f32_16x16x32_bf16 v[108:111], a[240:243], a[192:195], v[204:207]
v_exp_f32 v79, v79
v_mfma_f32_16x16x32_bf16 v[108:111], a[244:247], a[196:199], v[108:111]
v_cvt_pk_bf16_f32 v152, v76, v77
v_cvt_pk_bf16_f32 v153, v78, v79
v_mfma_f32_16x16x32_bf16 v[108:111], a[248:251], a[200:203], v[108:111]
s_add_u32 m0, m0, 4096
s_add_u32 s26, s26, 4096
buffer_load_dwordx4 v2, s[40:43], s26 offen lds
v_mfma_f32_16x16x32_bf16 v[108:111], a[252:255], a[204:207], v[108:111]
s_waitcnt lgkmcnt(3)
ds_read_b128 v[44:47], v4 offset:58368
v_mfma_f32_16x16x32_bf16 v[112:115], v[240:243], a[144:147], v[192:195]
v_exp_f32 v80, v80
v_mfma_f32_16x16x32_bf16 v[112:115], v[244:247], a[148:151], v[112:115]
v_exp_f32 v81, v81
v_mfma_f32_16x16x32_bf16 v[112:115], v[248:251], a[152:155], v[112:115]
v_exp_f32 v82, v82
v_mfma_f32_16x16x32_bf16 v[112:115], v[252:255], a[156:159], v[112:115]
v_exp_f32 v83, v83
v_mfma_f32_16x16x32_bf16 v[116:119], v[240:243], a[160:163], v[196:199]
ds_read_b128 v[48:51], v4 offset:43008
v_cvt_pk_bf16_f32 v130, v80, v81
v_mfma_f32_16x16x32_bf16 v[116:119], v[244:247], a[164:167], v[116:119]
v_cvt_pk_bf16_f32 v131, v82, v83
v_mfma_f32_16x16x32_bf16 v[116:119], v[248:251], a[168:171], v[116:119]
v_exp_f32 v84, v84
v_mfma_f32_16x16x32_bf16 v[116:119], v[252:255], a[172:175], v[116:119]
v_mfma_f32_16x16x32_bf16 v[120:123], v[240:243], a[176:179], v[220:223]
v_exp_f32 v85, v85
v_mfma_f32_16x16x32_bf16 v[120:123], v[244:247], a[180:183], v[120:123]
ds_read_b128 v[52:55], v4 offset:59392
v_mfma_f32_16x16x32_bf16 v[120:123], v[248:251], a[184:187], v[120:123]
buffer_load_dwordx4 v2, s[40:43], s26 offen offset:1024 lds
v_mfma_f32_16x16x32_bf16 v[120:123], v[252:255], a[188:191], v[120:123]
v_exp_f32 v86, v86
v_mfma_f32_16x16x32_bf16 v[124:127], v[240:243], a[192:195], v[204:207]
v_exp_f32 v87, v87
v_mfma_f32_16x16x32_bf16 v[124:127], v[244:247], a[196:199], v[124:127]
v_cvt_pk_bf16_f32 v138, v84, v85
v_mfma_f32_16x16x32_bf16 v[124:127], v[248:251], a[200:203], v[124:127]
v_cvt_pk_bf16_f32 v139, v86, v87
v_mfma_f32_16x16x32_bf16 v[124:127], v[252:255], a[204:207], v[124:127]
s_waitcnt lgkmcnt(4)
v_exp_f32 v88, v88
v_mfma_f32_16x16x32_bf16 a[0:3], v[32:35], v[160:163], a[0:3]
ds_read_b128 v[56:59], v4 offset:44032
v_mfma_f32_16x16x32_bf16 a[0:3], v[36:39], v[164:167], a[0:3]
v_exp_f32 v89, v89
v_mfma_f32_16x16x32_bf16 a[32:35], v[32:35], v[168:171], a[32:35]
v_exp_f32 v90, v90
v_mfma_f32_16x16x32_bf16 a[32:35], v[36:39], v[172:175], a[32:35]
v_mfma_f32_16x16x32_bf16 a[64:67], v[32:35], v[176:179], a[64:67]
ds_read_b128 v[60:63], v4 offset:60416
v_mfma_f32_16x16x32_bf16 a[64:67], v[36:39], v[180:183], a[64:67]
buffer_load_dwordx4 v2, s[40:43], s26 offen offset:2048 lds
v_mfma_f32_16x16x32_bf16 a[96:99], v[32:35], v[184:187], a[96:99]
v_exp_f32 v91, v91
v_mfma_f32_16x16x32_bf16 a[96:99], v[36:39], v[188:191], a[96:99]
s_waitcnt lgkmcnt(4)
v_cvt_pk_bf16_f32 v146, v88, v89
v_cvt_pk_bf16_f32 v147, v90, v91
v_mfma_f32_16x16x32_bf16 a[4:7], v[40:43], v[160:163], a[4:7]
ds_read_b128 v[32:35], v4 offset:45056
v_mfma_f32_16x16x32_bf16 a[4:7], v[44:47], v[164:167], a[4:7]
v_exp_f32 v92, v92
v_mfma_f32_16x16x32_bf16 a[36:39], v[40:43], v[168:171], a[36:39]
v_exp_f32 v93, v93
v_mfma_f32_16x16x32_bf16 a[36:39], v[44:47], v[172:175], a[36:39]
v_exp_f32 v94, v94
v_mfma_f32_16x16x32_bf16 a[68:71], v[40:43], v[176:179], a[68:71]
ds_read_b128 v[36:39], v4 offset:61440
v_mfma_f32_16x16x32_bf16 a[68:71], v[44:47], v[180:183], a[68:71]
v_exp_f32 v95, v95
v_mfma_f32_16x16x32_bf16 a[100:103], v[40:43], v[184:187], a[100:103]
v_cvt_pk_bf16_f32 v154, v92, v93
v_cvt_pk_bf16_f32 v155, v94, v95
v_mfma_f32_16x16x32_bf16 a[100:103], v[44:47], v[188:191], a[100:103]
s_waitcnt lgkmcnt(4)
buffer_load_dwordx4 v2, s[40:43], s26 offen offset:3072 lds
s_add_u32 s24, s24, 32768
s_add_u32 s25, s25, 32768
s_and_b32 s25, s25, 0x1ffff
v_mfma_f32_16x16x32_bf16 a[8:11], v[48:51], v[160:163], a[8:11]
ds_read_b128 v[40:43], v4 offset:46080
v_mfma_f32_16x16x32_bf16 a[8:11], v[52:55], v[164:167], a[8:11]
v_exp_f32 v96, v96
v_mfma_f32_16x16x32_bf16 a[40:43], v[48:51], v[168:171], a[40:43]
v_exp_f32 v97, v97
v_mfma_f32_16x16x32_bf16 a[40:43], v[52:55], v[172:175], a[40:43]
v_exp_f32 v98, v98
v_mfma_f32_16x16x32_bf16 a[72:75], v[48:51], v[176:179], a[72:75]
ds_read_b128 v[44:47], v4 offset:62464
v_mfma_f32_16x16x32_bf16 a[72:75], v[52:55], v[180:183], a[72:75]
v_exp_f32 v99, v99
v_mfma_f32_16x16x32_bf16 a[104:107], v[48:51], v[184:187], a[104:107]
v_cvt_pk_bf16_f32 v132, v96, v97
v_mfma_f32_16x16x32_bf16 a[104:107], v[52:55], v[188:191], a[104:107]
s_waitcnt lgkmcnt(4)
v_cvt_pk_bf16_f32 v133, v98, v99
v_mfma_f32_16x16x32_bf16 a[12:15], v[56:59], v[160:163], a[12:15]
ds_read_b128 v[48:51], v4 offset:47104
v_mfma_f32_16x16x32_bf16 a[12:15], v[60:63], v[164:167], a[12:15]
v_exp_f32 v100, v100
v_mfma_f32_16x16x32_bf16 a[44:47], v[56:59], v[168:171], a[44:47]
v_exp_f32 v101, v101
v_mfma_f32_16x16x32_bf16 a[44:47], v[60:63], v[172:175], a[44:47]
v_exp_f32 v102, v102
v_mfma_f32_16x16x32_bf16 a[76:79], v[56:59], v[176:179], a[76:79]
ds_read_b128 v[52:55], v4 offset:63488
v_mfma_f32_16x16x32_bf16 a[76:79], v[60:63], v[180:183], a[76:79]
v_exp_f32 v103, v103
v_mfma_f32_16x16x32_bf16 a[108:111], v[56:59], v[184:187], a[108:111]
v_cvt_pk_bf16_f32 v140, v100, v101
v_mfma_f32_16x16x32_bf16 a[108:111], v[60:63], v[188:191], a[108:111]
s_waitcnt lgkmcnt(4)
v_cvt_pk_bf16_f32 v141, v102, v103
v_mfma_f32_16x16x32_bf16 a[16:19], v[32:35], v[160:163], a[16:19]
ds_read_b128 v[56:59], v4 offset:48128
v_mfma_f32_16x16x32_bf16 a[16:19], v[36:39], v[164:167], a[16:19]
v_exp_f32 v104, v104
v_mfma_f32_16x16x32_bf16 a[48:51], v[32:35], v[168:171], a[48:51]
v_exp_f32 v105, v105
v_mfma_f32_16x16x32_bf16 a[48:51], v[36:39], v[172:175], a[48:51]
v_exp_f32 v106, v106
v_mfma_f32_16x16x32_bf16 a[80:83], v[32:35], v[176:179], a[80:83]
ds_read_b128 v[60:63], v4 offset:64512
v_mfma_f32_16x16x32_bf16 a[80:83], v[36:39], v[180:183], a[80:83]
v_exp_f32 v107, v107
v_mfma_f32_16x16x32_bf16 a[112:115], v[32:35], v[184:187], a[112:115]
v_mfma_f32_16x16x32_bf16 a[112:115], v[36:39], v[188:191], a[112:115]
s_waitcnt lgkmcnt(4)
v_cvt_pk_bf16_f32 v148, v104, v105
v_mfma_f32_16x16x32_bf16 a[20:23], v[40:43], v[160:163], a[20:23]
v_cvt_pk_bf16_f32 v149, v106, v107
v_mfma_f32_16x16x32_bf16 a[20:23], v[44:47], v[164:167], a[20:23]
v_exp_f32 v108, v108
v_mfma_f32_16x16x32_bf16 a[52:55], v[40:43], v[168:171], a[52:55]
v_exp_f32 v109, v109
v_mfma_f32_16x16x32_bf16 a[52:55], v[44:47], v[172:175], a[52:55]
v_mfma_f32_16x16x32_bf16 a[84:87], v[40:43], v[176:179], a[84:87]
v_exp_f32 v110, v110
v_mfma_f32_16x16x32_bf16 a[84:87], v[44:47], v[180:183], a[84:87]
v_exp_f32 v111, v111
v_mfma_f32_16x16x32_bf16 a[116:119], v[40:43], v[184:187], a[116:119]
v_mfma_f32_16x16x32_bf16 a[116:119], v[44:47], v[188:191], a[116:119]
s_waitcnt lgkmcnt(2)
v_cvt_pk_bf16_f32 v156, v108, v109
v_mfma_f32_16x16x32_bf16 a[24:27], v[48:51], v[160:163], a[24:27]
s_waitcnt vmcnt(8) lgkmcnt(0)
s_barrier
v_cvt_pk_bf16_f32 v157, v110, v111
v_mfma_f32_16x16x32_bf16 a[24:27], v[52:55], v[164:167], a[24:27]
ds_read_b128 a[208:211], v3 offset:32768
v_mfma_f32_16x16x32_bf16 a[56:59], v[48:51], v[168:171], a[56:59]
v_exp_f32 v112, v112
v_mfma_f32_16x16x32_bf16 a[56:59], v[52:55], v[172:175], a[56:59]
ds_read_b128 a[212:215], v3 offset:33792
v_mfma_f32_16x16x32_bf16 a[88:91], v[48:51], v[176:179], a[88:91]
v_exp_f32 v113, v113
v_mfma_f32_16x16x32_bf16 a[88:91], v[52:55], v[180:183], a[88:91]
v_exp_f32 v114, v114
v_mfma_f32_16x16x32_bf16 a[120:123], v[48:51], v[184:187], a[120:123]
ds_read_b128 a[216:219], v3 offset:34816
v_mfma_f32_16x16x32_bf16 a[120:123], v[52:55], v[188:191], a[120:123]
v_exp_f32 v115, v115
v_mfma_f32_16x16x32_bf16 a[28:31], v[56:59], v[160:163], a[28:31]
ds_read_b128 a[220:223], v3 offset:35840
v_cvt_pk_bf16_f32 v134, v112, v113
v_mfma_f32_16x16x32_bf16 a[28:31], v[60:63], v[164:167], a[28:31]
v_cvt_pk_bf16_f32 v135, v114, v115
v_mfma_f32_16x16x32_bf16 a[60:63], v[56:59], v[168:171], a[60:63]
v_exp_f32 v116, v116
v_mfma_f32_16x16x32_bf16 a[60:63], v[60:63], v[172:175], a[60:63]
ds_read_b128 a[224:227], v3 offset:36864
v_mfma_f32_16x16x32_bf16 a[92:95], v[56:59], v[176:179], a[92:95]
v_exp_f32 v117, v117
v_mfma_f32_16x16x32_bf16 a[92:95], v[60:63], v[180:183], a[92:95]
v_exp_f32 v118, v118
v_mfma_f32_16x16x32_bf16 a[124:127], v[56:59], v[184:187], a[124:127]
ds_read_b128 a[228:231], v3 offset:37888
v_mfma_f32_16x16x32_bf16 a[124:127], v[60:63], v[188:191], a[124:127]
v_exp_f32 v119, v119
v_mfma_f32_16x16x32_bf16 a[128:131], v[28:31], v[160:163], a[128:131]
ds_read_b128 a[232:235], v3 offset:38912
v_cvt_pk_bf16_f32 v142, v116, v117
v_mfma_f32_16x16x32_bf16 a[128:131], v[28:31], v[164:167], a[128:131]
v_cvt_pk_bf16_f32 v143, v118, v119
v_mfma_f32_16x16x32_bf16 a[132:135], v[28:31], v[168:171], a[132:135]
v_mfma_f32_16x16x32_bf16 a[132:135], v[28:31], v[172:175], a[132:135]
ds_read_b128 a[236:239], v3 offset:39936
v_mfma_f32_16x16x32_bf16 a[136:139], v[28:31], v[176:179], a[136:139]
v_mfma_f32_16x16x32_bf16 a[136:139], v[28:31], v[180:183], a[136:139]
v_mfma_f32_16x16x32_bf16 a[140:143], v[28:31], v[184:187], a[140:143]
v_mfma_f32_16x16x32_bf16 a[140:143], v[28:31], v[188:191], a[140:143]
L_att_DDm1:
s_waitcnt lgkmcnt(4)
v_mfma_f32_16x16x32_bf16 v[64:67], a[208:211], a[144:147], v[192:195]
ds_read_b128 a[240:243], v3 offset:49152
v_add_f32 v208, v224, v204
v_mfma_f32_16x16x32_bf16 v[64:67], a[212:215], a[148:151], v[64:67]
v_add_f32 v209, v225, v204
v_add_f32 v210, v226, v204
v_mfma_f32_16x16x32_bf16 v[64:67], a[216:219], a[152:155], v[64:67]
ds_read_b128 a[244:247], v3 offset:50176
v_add_f32 v211, v227, v204
v_mfma_f32_16x16x32_bf16 v[64:67], a[220:223], a[156:159], v[64:67]
s_mov_b32 m0, s25
s_mov_b32 s26, s24
buffer_load_dwordx4 v2, s[40:43], s26 offen lds
v_mfma_f32_16x16x32_bf16 v[68:71], a[208:211], a[160:163], v[196:199]
v_exp_f32 v124, v124
v_mfma_f32_16x16x32_bf16 v[68:71], a[212:215], a[164:167], v[68:71]
ds_read_b128 a[248:251], v3 offset:51200
v_exp_f32 v125, v125
v_mfma_f32_16x16x32_bf16 v[68:71], a[216:219], a[168:171], v[68:71]
v_exp_f32 v126, v126
v_mfma_f32_16x16x32_bf16 v[68:71], a[220:223], a[172:175], v[68:71]
v_exp_f32 v127, v127
v_mfma_f32_16x16x32_bf16 v[76:79], a[208:211], a[192:195], v[208:211]
ds_read_b128 a[252:255], v3 offset:52224
v_cvt_pk_bf16_f32 v158, v124, v125
v_mfma_f32_16x16x32_bf16 v[76:79], a[212:215], a[196:199], v[76:79]
v_cvt_pk_bf16_f32 v159, v126, v127
v_add_f32 v212, v228, v204
v_mfma_f32_16x16x32_bf16 v[76:79], a[216:219], a[200:203], v[76:79]
v_exp_f32 v120, v120
v_mfma_f32_16x16x32_bf16 v[76:79], a[220:223], a[204:207], v[76:79]
s_waitcnt lgkmcnt(4)
buffer_load_dwordx4 v2, s[40:43], s26 offen offset:1024 lds
v_add_f32 v213, v229, v204
v_mfma_f32_16x16x32_bf16 v[80:83], a[224:227], a[144:147], v[192:195]
ds_read_b128 v[240:243], v3 offset:53248
v_add_f32 v214, v230, v204
v_mfma_f32_16x16x32_bf16 v[80:83], a[228:231], a[148:151], v[80:83]
v_exp_f32 v121, v121
v_mfma_f32_16x16x32_bf16 v[80:83], a[232:235], a[152:155], v[80:83]
ds_read_b128 v[244:247], v3 offset:54272
v_add_f32 v215, v231, v204
v_mfma_f32_16x16x32_bf16 v[80:83], a[236:239], a[156:159], v[80:83]
v_exp_f32 v122, v122
v_mfma_f32_16x16x32_bf16 v[84:87], a[224:227], a[160:163], v[196:199]
v_exp_f32 v123, v123
v_mfma_f32_16x16x32_bf16 v[84:87], a[228:231], a[164:167], v[84:87]
ds_read_b128 v[248:251], v3 offset:55296
v_cvt_pk_bf16_f32 v150, v120, v121
v_mfma_f32_16x16x32_bf16 v[84:87], a[232:235], a[168:171], v[84:87]
v_cvt_pk_bf16_f32 v151, v122, v123
v_add_f32 v216, v232, v204
v_mfma_f32_16x16x32_bf16 v[84:87], a[236:239], a[172:175], v[84:87]
v_exp_f32 v64, v64
v_mfma_f32_16x16x32_bf16 v[92:95], a[224:227], a[192:195], v[212:215]
ds_read_b128 v[252:255], v3 offset:56320
v_add_f32 v217, v233, v204
v_mfma_f32_16x16x32_bf16 v[92:95], a[228:231], a[196:199], v[92:95]
buffer_load_dwordx4 v2, s[40:43], s26 offen offset:2048 lds
v_add_f32 v218, v234, v204
v_mfma_f32_16x16x32_bf16 v[92:95], a[232:235], a[200:203], v[92:95]
v_exp_f32 v65, v65
v_mfma_f32_16x16x32_bf16 v[92:95], a[236:239], a[204:207], v[92:95]
s_waitcnt lgkmcnt(4)
v_exp_f32 v66, v66
v_mfma_f32_16x16x32_bf16 v[96:99], a[240:243], a[144:147], v[192:195]
ds_read_b128 v[32:35], v3 offset:8192
v_add_f32 v219, v235, v204
v_mfma_f32_16x16x32_bf16 v[96:99], a[244:247], a[148:151], v[96:99]
v_exp_f32 v67, v67
v_mfma_f32_16x16x32_bf16 v[96:99], a[248:251], a[152:155], v[96:99]
v_cvt_pk_bf16_f32 v160, v64, v65
v_cvt_pk_bf16_f32 v161, v66, v67
v_mfma_f32_16x16x32_bf16 v[96:99], a[252:255], a[156:159], v[96:99]
ds_read_b128 v[36:39], v3 offset:24576
v_add_f32 v220, v236, v204
v_mfma_f32_16x16x32_bf16 v[100:103], a[240:243], a[160:163], v[196:199]
v_exp_f32 v68, v68
v_mfma_f32_16x16x32_bf16 v[100:103], a[244:247], a[164:167], v[100:103]
v_exp_f32 v69, v69
v_mfma_f32_16x16x32_bf16 v[100:103], a[248:251], a[168:171], v[100:103]
buffer_load_dwordx4 v2, s[40:43], s26 offen offset:3072 lds
v_add_f32 v221, v237, v204
v_mfma_f32_16x16x32_bf16 v[100:103], a[252:255], a[172:175], v[100:103]
ds_read_b128 v[40:43], v3 offset:9216
v_add_f32 v222, v238, v204
v_mfma_f32_16x16x32_bf16 v[108:111], a[240:243], a[192:195], v[216:219]
v_exp_f32 v70, v70
v_mfma_f32_16x16x32_bf16 v[108:111], a[244:247], a[196:199], v[108:111]
v_exp_f32 v71, v71
v_mfma_f32_16x16x32_bf16 v[108:111], a[248:251], a[200:203], v[108:111]
v_add_f32 v223, v239, v204
v_cvt_pk_bf16_f32 v168, v68, v69
v_mfma_f32_16x16x32_bf16 v[108:111], a[252:255], a[204:207], v[108:111]
s_waitcnt lgkmcnt(3)
ds_read_b128 v[44:47], v3 offset:25600
v_cvt_pk_bf16_f32 v169, v70, v71
v_mfma_f32_16x16x32_bf16 v[112:115], v[240:243], a[144:147], v[192:195]
v_exp_f32 v76, v76
v_mfma_f32_16x16x32_bf16 v[112:115], v[244:247], a[148:151], v[112:115]
v_exp_f32 v77, v77
v_mfma_f32_16x16x32_bf16 v[112:115], v[248:251], a[152:155], v[112:115]
ds_read_b128 v[48:51], v3 offset:10240
v_mfma_f32_16x16x32_bf16 v[112:115], v[252:255], a[156:159], v[112:115]
v_exp_f32 v78, v78
v_mfma_f32_16x16x32_bf16 v[116:119], v[240:243], a[160:163], v[196:199]
s_add_u32 m0, m0, 4096
s_add_u32 s26, s26, 4096
buffer_load_dwordx4 v2, s[40:43], s26 offen lds
v_mfma_f32_16x16x32_bf16 v[116:119], v[244:247], a[164:167], v[116:119]
v_exp_f32 v79, v79
v_mfma_f32_16x16x32_bf16 v[116:119], v[248:251], a[168:171], v[116:119]
ds_read_b128 v[52:55], v3 offset:26624
v_mfma_f32_16x16x32_bf16 v[116:119], v[252:255], a[172:175], v[116:119]
v_cvt_pk_bf16_f32 v184, v76, v77
v_mfma_f32_16x16x32_bf16 v[124:127], v[240:243], a[192:195], v[220:223]
v_cvt_pk_bf16_f32 v185, v78, v79
v_mfma_f32_16x16x32_bf16 v[124:127], v[244:247], a[196:199], v[124:127]
v_exp_f32 v80, v80
v_mfma_f32_16x16x32_bf16 v[124:127], v[248:251], a[200:203], v[124:127]
v_mfma_f32_16x16x32_bf16 v[124:127], v[252:255], a[204:207], v[124:127]
s_waitcnt lgkmcnt(4)
v_exp_f32 v81, v81
v_mfma_f32_16x16x32_bf16 a[0:3], v[32:35], v[128:131], a[0:3]
ds_read_b128 v[56:59], v3 offset:11264
v_mfma_f32_16x16x32_bf16 a[0:3], v[36:39], v[132:135], a[0:3]
buffer_load_dwordx4 v2, s[40:43], s26 offen offset:1024 lds
v_mfma_f32_16x16x32_bf16 a[32:35], v[32:35], v[136:139], a[32:35]
v_exp_f32 v82, v82
v_mfma_f32_16x16x32_bf16 a[32:35], v[36:39], v[140:143], a[32:35]
v_exp_f32 v83, v83
v_mfma_f32_16x16x32_bf16 a[64:67], v[32:35], v[144:147], a[64:67]
ds_read_b128 v[60:63], v3 offset:27648
v_mfma_f32_16x16x32_bf16 a[64:67], v[36:39], v[148:151], a[64:67]
v_cvt_pk_bf16_f32 v162, v80, v81
v_mfma_f32_16x16x32_bf16 a[96:99], v[32:35], v[152:155], a[96:99]
v_cvt_pk_bf16_f32 v163, v82, v83
v_mfma_f32_16x16x32_bf16 a[96:99], v[36:39], v[156:159], a[96:99]
s_waitcnt lgkmcnt(4)
v_exp_f32 v84, v84
v_mfma_f32_16x16x32_bf16 a[4:7], v[40:43], v[128:131], a[4:7]
ds_read_b128 v[32:35], v3 offset:12288
v_mfma_f32_16x16x32_bf16 a[4:7], v[44:47], v[132:135], a[4:7]
v_exp_f32 v85, v85
v_mfma_f32_16x16x32_bf16 a[36:39], v[40:43], v[136:139], a[36:39]
v_exp_f32 v86, v86
v_mfma_f32_16x16x32_bf16 a[36:39], v[44:47], v[140:143], a[36:39]
buffer_load_dwordx4 v2, s[40:43], s26 offen offset:2048 lds
v_mfma_f32_16x16x32_bf16 a[68:71], v[40:43], v[144:147], a[68:71]
ds_read_b128 v[36:39], v3 offset:28672
v_mfma_f32_16x16x32_bf16 a[68:71], v[44:47], v[148:151], a[68:71]
v_exp_f32 v87, v87
v_mfma_f32_16x16x32_bf16 a[100:103], v[40:43], v[152:155], a[100:103]
v_cvt_pk_bf16_f32 v170, v84, v85
v_mfma_f32_16x16x32_bf16 a[100:103], v[44:47], v[156:159], a[100:103]
s_waitcnt lgkmcnt(4)
v_cvt_pk_bf16_f32 v171, v86, v87
v_mfma_f32_16x16x32_bf16 a[8:11], v[48:51], v[128:131], a[8:11]
ds_read_b128 v[40:43], v3 offset:13312
v_mfma_f32_16x16x32_bf16 a[8:11], v[52:55], v[132:135], a[8:11]
v_exp_f32 v92, v92
v_mfma_f32_16x16x32_bf16 a[40:43], v[48:51], v[136:139], a[40:43]
v_exp_f32 v93, v93
v_mfma_f32_16x16x32_bf16 a[40:43], v[52:55], v[140:143], a[40:43]
v_mfma_f32_16x16x32_bf16 a[72:75], v[48:51], v[144:147], a[72:75]
ds_read_b128 v[44:47], v3 offset:29696
v_mfma_f32_16x16x32_bf16 a[72:75], v[52:55], v[148:151], a[72:75]
buffer_load_dwordx4 v2, s[40:43], s26 offen offset:3072 lds
s_add_u32 s24, s24, 32768
s_add_u32 s25, s25, 32768
s_and_b32 s25, s25, 0x1ffff
v_mfma_f32_16x16x32_bf16 a[104:107], v[48:51], v[152:155], a[104:107]
v_exp_f32 v94, v94
v_mfma_f32_16x16x32_bf16 a[104:107], v[52:55], v[156:159], a[104:107]
s_waitcnt lgkmcnt(4)
v_exp_f32 v95, v95
v_mfma_f32_16x16x32_bf16 a[12:15], v[56:59], v[128:131], a[12:15]
ds_read_b128 v[48:51], v3 offset:14336
v_cvt_pk_bf16_f32 v186, v92, v93
v_mfma_f32_16x16x32_bf16 a[12:15], v[60:63], v[132:135], a[12:15]
v_cvt_pk_bf16_f32 v187, v94, v95
v_mfma_f32_16x16x32_bf16 a[44:47], v[56:59], v[136:139], a[44:47]
v_exp_f32 v96, v96
v_mfma_f32_16x16x32_bf16 a[44:47], v[60:63], v[140:143], a[44:47]
v_mfma_f32_16x16x32_bf16 a[76:79], v[56:59], v[144:147], a[76:79]
ds_read_b128 v[52:55], v3 offset:30720
v_mfma_f32_16x16x32_bf16 a[76:79], v[60:63], v[148:151], a[76:79]
v_exp_f32 v97, v97
v_mfma_f32_16x16x32_bf16 a[108:111], v[56:59], v[152:155], a[108:111]
v_exp_f32 v98, v98
v_mfma_f32_16x16x32_bf16 a[108:111], v[60:63], v[156:159], a[108:111]
s_waitcnt lgkmcnt(4)
v_mfma_f32_16x16x32_bf16 a[16:19], v[32:35], v[128:131], a[16:19]
ds_read_b128 v[56:59], v3 offset:15360
v_mfma_f32_16x16x32_bf16 a[16:19], v[36:39], v[132:135], a[16:19]
v_exp_f32 v99, v99
v_mfma_f32_16x16x32_bf16 a[48:51], v[32:35], v[136:139], a[48:51]
v_cvt_pk_bf16_f32 v164, v96, v97
v_mfma_f32_16x16x32_bf16 a[48:51], v[36:39], v[140:143], a[48:51]
v_cvt_pk_bf16_f32 v165, v98, v99
v_mfma_f32_16x16x32_bf16 a[80:83], v[32:35], v[144:147], a[80:83]
ds_read_b128 v[60:63], v3 offset:31744
v_mfma_f32_16x16x32_bf16 a[80:83], v[36:39], v[148:151], a[80:83]
v_exp_f32 v100, v100
v_mfma_f32_16x16x32_bf16 a[112:115], v[32:35], v[152:155], a[112:115]
v_exp_f32 v101, v101
v_mfma_f32_16x16x32_bf16 a[112:115], v[36:39], v[156:159], a[112:115]
s_waitcnt lgkmcnt(4)
v_mfma_f32_16x16x32_bf16 a[20:23], v[40:43], v[128:131], a[20:23]
v_exp_f32 v102, v102
v_mfma_f32_16x16x32_bf16 a[20:23], v[44:47], v[132:135], a[20:23]
v_mfma_f32_16x16x32_bf16 a[52:55], v[40:43], v[136:139], a[52:55]
v_exp_f32 v103, v103
v_mfma_f32_16x16x32_bf16 a[52:55], v[44:47], v[140:143], a[52:55]
v_mfma_f32_16x16x32_bf16 a[84:87], v[40:43], v[144:147], a[84:87]
v_cvt_pk_bf16_f32 v172, v100, v101
v_mfma_f32_16x16x32_bf16 a[84:87], v[44:47], v[148:151], a[84:87]
v_cvt_pk_bf16_f32 v173, v102, v103
v_mfma_f32_16x16x32_bf16 a[116:119], v[40:43], v[152:155], a[116:119]
v_exp_f32 v108, v108
v_mfma_f32_16x16x32_bf16 a[116:119], v[44:47], v[156:159], a[116:119]
s_waitcnt lgkmcnt(2)
v_mfma_f32_16x16x32_bf16 a[24:27], v[48:51], v[128:131], a[24:27]
s_waitcnt vmcnt(8) lgkmcnt(0)
s_barrier
v_exp_f32 v109, v109
v_mfma_f32_16x16x32_bf16 a[24:27], v[52:55], v[132:135], a[24:27]
ds_read_b128 a[208:211], v4
v_mfma_f32_16x16x32_bf16 a[56:59], v[48:51], v[136:139], a[56:59]
v_exp_f32 v110, v110
v_mfma_f32_16x16x32_bf16 a[56:59], v[52:55], v[140:143], a[56:59]
ds_read_b128 a[212:215], v4 offset:1024
v_mfma_f32_16x16x32_bf16 a[88:91], v[48:51], v[144:147], a[88:91]
v_exp_f32 v111, v111
v_mfma_f32_16x16x32_bf16 a[88:91], v[52:55], v[148:151], a[88:91]
v_mfma_f32_16x16x32_bf16 a[120:123], v[48:51], v[152:155], a[120:123]
ds_read_b128 a[216:219], v4 offset:2048
v_cvt_pk_bf16_f32 v188, v108, v109
v_mfma_f32_16x16x32_bf16 a[120:123], v[52:55], v[156:159], a[120:123]
v_cvt_pk_bf16_f32 v189, v110, v111
v_mfma_f32_16x16x32_bf16 a[28:31], v[56:59], v[128:131], a[28:31]
ds_read_b128 a[220:223], v4 offset:3072
v_mfma_f32_16x16x32_bf16 a[28:31], v[60:63], v[132:135], a[28:31]
v_exp_f32 v112, v112
v_mfma_f32_16x16x32_bf16 a[60:63], v[56:59], v[136:139], a[60:63]
v_exp_f32 v113, v113
v_mfma_f32_16x16x32_bf16 a[60:63], v[60:63], v[140:143], a[60:63]
ds_read_b128 a[224:227], v4 offset:4096
v_mfma_f32_16x16x32_bf16 a[92:95], v[56:59], v[144:147], a[92:95]
v_exp_f32 v114, v114
v_mfma_f32_16x16x32_bf16 a[92:95], v[60:63], v[148:151], a[92:95]
v_mfma_f32_16x16x32_bf16 a[124:127], v[56:59], v[152:155], a[124:127]
ds_read_b128 a[228:231], v4 offset:5120
v_mfma_f32_16x16x32_bf16 a[124:127], v[60:63], v[156:159], a[124:127]
v_exp_f32 v115, v115
v_mfma_f32_16x16x32_bf16 a[128:131], v[28:31], v[128:131], a[128:131]
ds_read_b128 a[232:235], v4 offset:6144
v_cvt_pk_bf16_f32 v166, v112, v113
v_mfma_f32_16x16x32_bf16 a[128:131], v[28:31], v[132:135], a[128:131]
v_cvt_pk_bf16_f32 v167, v114, v115
v_mfma_f32_16x16x32_bf16 a[132:135], v[28:31], v[136:139], a[132:135]
v_mfma_f32_16x16x32_bf16 a[132:135], v[28:31], v[140:143], a[132:135]
ds_read_b128 a[236:239], v4 offset:7168
v_mfma_f32_16x16x32_bf16 a[136:139], v[28:31], v[144:147], a[136:139]
v_mfma_f32_16x16x32_bf16 a[136:139], v[28:31], v[148:151], a[136:139]
v_mfma_f32_16x16x32_bf16 a[140:143], v[28:31], v[152:155], a[140:143]
v_mfma_f32_16x16x32_bf16 a[140:143], v[28:31], v[156:159], a[140:143]
v_xor_b32 v3, 0x10000, v3
v_xor_b32 v4, 0x10000, v4
s_cmp_eq_u32 s22, 7
s_cbranch_scc1 L_att_SDm0
s_branch L_att_SD0
L_att_SD0:
s_waitcnt lgkmcnt(4)
v_mfma_f32_16x16x32_bf16 v[64:67], a[208:211], a[144:147], v[192:195]
ds_read_b128 a[240:243], v3 offset:16384
v_mfma_f32_16x16x32_bf16 v[64:67], a[212:215], a[148:151], v[64:67]
ds_read_b128 a[244:247], v3 offset:17408
v_mfma_f32_16x16x32_bf16 v[64:67], a[216:219], a[152:155], v[64:67]
s_mov_b32 m0, s25
s_mov_b32 s26, s24
buffer_load_dwordx4 v2, s[40:43], s26 offen lds
v_mfma_f32_16x16x32_bf16 v[64:67], a[220:223], a[156:159], v[64:67]
ds_read_b128 a[248:251], v3 offset:18432
v_mfma_f32_16x16x32_bf16 v[68:71], a[208:211], a[160:163], v[196:199]
v_exp_f32 v116, v116
v_mfma_f32_16x16x32_bf16 v[68:71], a[212:215], a[164:167], v[68:71]
ds_read_b128 a[252:255], v3 offset:19456
v_mfma_f32_16x16x32_bf16 v[68:71], a[216:219], a[168:171], v[68:71]
v_exp_f32 v117, v117
v_mfma_f32_16x16x32_bf16 v[68:71], a[220:223], a[172:175], v[68:71]
s_waitcnt lgkmcnt(4)
v_exp_f32 v118, v118
v_mfma_f32_16x16x32_bf16 v[80:83], a[224:227], a[144:147], v[192:195]
ds_read_b128 v[240:243], v3 offset:20480
v_mfma_f32_16x16x32_bf16 v[80:83], a[228:231], a[148:151], v[80:83]
ds_read_b128 v[244:247], v3 offset:21504
v_mfma_f32_16x16x32_bf16 v[80:83], a[232:235], a[152:155], v[80:83]
buffer_load_dwordx4 v2, s[40:43], s26 offen offset:1024 lds
v_exp_f32 v119, v119
v_mfma_f32_16x16x32_bf16 v[80:83], a[236:239], a[156:159], v[80:83]
ds_read_b128 v[248:251], v3 offset:22528
v_cvt_pk_bf16_f32 v174, v116, v117
v_mfma_f32_16x16x32_bf16 v[84:87], a[224:227], a[160:163], v[196:199]
v_cvt_pk_bf16_f32 v175, v118, v119
v_mfma_f32_16x16x32_bf16 v[84:87], a[228:231], a[164:167], v[84:87]
ds_read_b128 v[252:255], v3 offset:23552
v_mfma_f32_16x16x32_bf16 v[84:87], a[232:235], a[168:171], v[84:87]
v_exp_f32 v124, v124
v_mfma_f32_16x16x32_bf16 v[84:87], a[236:239], a[172:175], v[84:87]
s_waitcnt lgkmcnt(4)
buffer_load_dwordx4 v2, s[40:43], s26 offen offset:2048 lds
v_mfma_f32_16x16x32_bf16 v[96:99], a[240:243], a[144:147], v[192:195]
ds_read_b128 v[32:35], v4 offset:40960
v_exp_f32 v125, v125
v_mfma_f32_16x16x32_bf16 v[96:99], a[244:247], a[148:151], v[96:99]
v_exp_f32 v126, v126
v_mfma_f32_16x16x32_bf16 v[96:99], a[248:251], a[152:155], v[96:99]
ds_read_b128 v[36:39], v4 offset:57344
v_mfma_f32_16x16x32_bf16 v[96:99], a[252:255], a[156:159], v[96:99]
v_exp_f32 v127, v127
v_mfma_f32_16x16x32_bf16 v[100:103], a[240:243], a[160:163], v[196:199]
ds_read_b128 v[40:43], v4 offset:41984
v_cvt_pk_bf16_f32 v190, v124, v125
v_mfma_f32_16x16x32_bf16 v[100:103], a[244:247], a[164:167], v[100:103]
v_cvt_pk_bf16_f32 v191, v126, v127
v_mfma_f32_16x16x32_bf16 v[100:103], a[248:251], a[168:171], v[100:103]
buffer_load_dwordx4 v2, s[40:43], s26 offen offset:3072 lds
v_mfma_f32_16x16x32_bf16 v[100:103], a[252:255], a[172:175], v[100:103]
s_waitcnt lgkmcnt(3)
ds_read_b128 v[44:47], v4 offset:58368
v_mfma_f32_16x16x32_bf16 v[112:115], v[240:243], a[144:147], v[192:195]
v_exp_f32 v64, v64
v_mfma_f32_16x16x32_bf16 v[112:115], v[244:247], a[148:151], v[112:115]
ds_read_b128 v[48:51], v4 offset:43008
v_mfma_f32_16x16x32_bf16 v[112:115], v[248:251], a[152:155], v[112:115]
v_exp_f32 v65, v65
v_mfma_f32_16x16x32_bf16 v[112:115], v[252:255], a[156:159], v[112:115]
ds_read_b128 v[52:55], v4 offset:59392
v_mfma_f32_16x16x32_bf16 v[116:119], v[240:243], a[160:163], v[196:199]
v_exp_f32 v66, v66
v_mfma_f32_16x16x32_bf16 v[116:119], v[244:247], a[164:167], v[116:119]
s_add_u32 m0, m0, 4096
s_add_u32 s26, s26, 4096
buffer_load_dwordx4 v2, s[40:43], s26 offen lds
v_mfma_f32_16x16x32_bf16 v[116:119], v[248:251], a[168:171], v[116:119]
v_exp_f32 v67, v67
v_mfma_f32_16x16x32_bf16 v[116:119], v[252:255], a[172:175], v[116:119]
s_waitcnt lgkmcnt(4)
v_cvt_pk_bf16_f32 v128, v64, v65
v_cvt_pk_bf16_f32 v129, v66, v67
v_mfma_f32_16x16x32_bf16 a[0:3], v[32:35], v[160:163], a[0:3]
ds_read_b128 v[56:59], v4 offset:44032
v_mfma_f32_16x16x32_bf16 a[0:3], v[36:39], v[164:167], a[0:3]
v_exp_f32 v68, v68
v_mfma_f32_16x16x32_bf16 a[32:35], v[32:35], v[168:171], a[32:35]
v_exp_f32 v69, v69
v_mfma_f32_16x16x32_bf16 a[32:35], v[36:39], v[172:175], a[32:35]
ds_read_b128 v[60:63], v4 offset:60416
v_mfma_f32_16x16x32_bf16 a[96:99], v[32:35], v[184:187], a[96:99]
buffer_load_dwordx4 v2, s[40:43], s26 offen offset:1024 lds
v_mfma_f32_16x16x32_bf16 a[96:99], v[36:39], v[188:191], a[96:99]
s_waitcnt lgkmcnt(4)
v_exp_f32 v70, v70
v_mfma_f32_16x16x32_bf16 a[4:7], v[40:43], v[160:163], a[4:7]
ds_read_b128 v[32:35], v4 offset:45056
v_mfma_f32_16x16x32_bf16 a[4:7], v[44:47], v[164:167], a[4:7]
v_exp_f32 v71, v71
v_mfma_f32_16x16x32_bf16 a[36:39], v[40:43], v[168:171], a[36:39]
v_cvt_pk_bf16_f32 v136, v68, v69
v_cvt_pk_bf16_f32 v137, v70, v71
v_mfma_f32_16x16x32_bf16 a[36:39], v[44:47], v[172:175], a[36:39]
ds_read_b128 v[36:39], v4 offset:61440
v_mfma_f32_16x16x32_bf16 a[100:103], v[40:43], v[184:187], a[100:103]
buffer_load_dwordx4 v2, s[40:43], s26 offen offset:2048 lds
v_mfma_f32_16x16x32_bf16 a[100:103], v[44:47], v[188:191], a[100:103]
s_waitcnt lgkmcnt(4)
v_exp_f32 v80, v80
v_mfma_f32_16x16x32_bf16 a[8:11], v[48:51], v[160:163], a[8:11]
ds_read_b128 v[40:43], v4 offset:46080
v_mfma_f32_16x16x32_bf16 a[8:11], v[52:55], v[164:167], a[8:11]
v_exp_f32 v81, v81
v_mfma_f32_16x16x32_bf16 a[40:43], v[48:51], v[168:171], a[40:43]
v_exp_f32 v82, v82
v_mfma_f32_16x16x32_bf16 a[40:43], v[52:55], v[172:175], a[40:43]
ds_read_b128 v[44:47], v4 offset:62464
v_mfma_f32_16x16x32_bf16 a[104:107], v[48:51], v[184:187], a[104:107]
v_exp_f32 v83, v83
v_mfma_f32_16x16x32_bf16 a[104:107], v[52:55], v[188:191], a[104:107]
s_waitcnt lgkmcnt(4)
buffer_load_dwordx4 v2, s[40:43], s26 offen offset:3072 lds
s_add_u32 s24, s24, 32768
s_add_u32 s25, s25, 32768
s_and_b32 s25, s25, 0x1ffff
v_cvt_pk_bf16_f32 v130, v80, v81
v_mfma_f32_16x16x32_bf16 a[12:15], v[56:59], v[160:163], a[12:15]
ds_read_b128 v[48:51], v4 offset:47104
v_cvt_pk_bf16_f32 v131, v82, v83
v_mfma_f32_16x16x32_bf16 a[12:15], v[60:63], v[164:167], a[12:15]
v_exp_f32 v84, v84
v_mfma_f32_16x16x32_bf16 a[44:47], v[56:59], v[168:171], a[44:47]
v_exp_f32 v85, v85
v_mfma_f32_16x16x32_bf16 a[44:47], v[60:63], v[172:175], a[44:47]
ds_read_b128 v[52:55], v4 offset:63488
v_mfma_f32_16x16x32_bf16 a[108:111], v[56:59], v[184:187], a[108:111]
v_exp_f32 v86, v86
v_mfma_f32_16x16x32_bf16 a[108:111], v[60:63], v[188:191], a[108:111]
s_waitcnt lgkmcnt(4)
v_exp_f32 v87, v87
v_mfma_f32_16x16x32_bf16 a[16:19], v[32:35], v[160:163], a[16:19]
ds_read_b128 v[56:59], v4 offset:48128
v_cvt_pk_bf16_f32 v138, v84, v85
v_mfma_f32_16x16x32_bf16 a[16:19], v[36:39], v[164:167], a[16:19]
v_cvt_pk_bf16_f32 v139, v86, v87
v_mfma_f32_16x16x32_bf16 a[48:51], v[32:35], v[168:171], a[48:51]
v_mfma_f32_16x16x32_bf16 a[48:51], v[36:39], v[172:175], a[48:51]
ds_read_b128 v[60:63], v4 offset:64512
v_mfma_f32_16x16x32_bf16 a[112:115], v[32:35], v[184:187], a[112:115]
v_exp_f32 v96, v96
v_mfma_f32_16x16x32_bf16 a[112:115], v[36:39], v[188:191], a[112:115]
s_waitcnt lgkmcnt(4)
v_exp_f32 v97, v97
v_mfma_f32_16x16x32_bf16 a[20:23], v[40:43], v[160:163], a[20:23]
v_mfma_f32_16x16x32_bf16 a[20:23], v[44:47], v[164:167], a[20:23]
v_exp_f32 v98, v98
v_mfma_f32_16x16x32_bf16 a[52:55], v[40:43], v[168:171], a[52:55]
v_mfma_f32_16x16x32_bf16 a[52:55], v[44:47], v[172:175], a[52:55]
v_exp_f32 v99, v99
v_mfma_f32_16x16x32_bf16 a[116:119], v[40:43], v[184:187], a[116:119]
v_mfma_f32_16x16x32_bf16 a[116:119], v[44:47], v[188:191], a[116:119]
s_waitcnt lgkmcnt(2)
v_cvt_pk_bf16_f32 v132, v96, v97
v_mfma_f32_16x16x32_bf16 a[24:27], v[48:51], v[160:163], a[24:27]
s_waitcnt vmcnt(8) lgkmcnt(0)
s_barrier
v_cvt_pk_bf16_f32 v133, v98, v99
v_mfma_f32_16x16x32_bf16 a[24:27], v[52:55], v[164:167], a[24:27]
ds_read_b128 a[208:211], v3 offset:32768
v_mfma_f32_16x16x32_bf16 a[56:59], v[48:51], v[168:171], a[56:59]
ds_read_b128 a[212:215], v3 offset:33792
v_mfma_f32_16x16x32_bf16 a[56:59], v[52:55], v[172:175], a[56:59]
v_exp_f32 v100, v100
v_mfma_f32_16x16x32_bf16 a[120:123], v[48:51], v[184:187], a[120:123]
ds_read_b128 a[216:219], v3 offset:34816
v_mfma_f32_16x16x32_bf16 a[120:123], v[52:55], v[188:191], a[120:123]
v_exp_f32 v101, v101
v_mfma_f32_16x16x32_bf16 a[28:31], v[56:59], v[160:163], a[28:31]
ds_read_b128 a[220:223], v3 offset:35840
v_mfma_f32_16x16x32_bf16 a[28:31], v[60:63], v[164:167], a[28:31]
v_exp_f32 v102, v102
v_mfma_f32_16x16x32_bf16 a[60:63], v[56:59], v[168:171], a[60:63]
ds_read_b128 a[224:227], v3 offset:36864
v_mfma_f32_16x16x32_bf16 a[60:63], v[60:63], v[172:175], a[60:63]
v_exp_f32 v103, v103
v_mfma_f32_16x16x32_bf16 a[124:127], v[56:59], v[184:187], a[124:127]
ds_read_b128 a[228:231], v3 offset:37888
v_cvt_pk_bf16_f32 v140, v100, v101
v_mfma_f32_16x16x32_bf16 a[124:127], v[60:63], v[188:191], a[124:127]
v_cvt_pk_bf16_f32 v141, v102, v103
v_mfma_f32_16x16x32_bf16 a[128:131], v[28:31], v[160:163], a[128:131]
ds_read_b128 a[232:235], v3 offset:38912
v_mfma_f32_16x16x32_bf16 a[128:131], v[28:31], v[164:167], a[128:131]
v_mfma_f32_16x16x32_bf16 a[132:135], v[28:31], v[168:171], a[132:135]
ds_read_b128 a[236:239], v3 offset:39936
v_mfma_f32_16x16x32_bf16 a[132:135], v[28:31], v[172:175], a[132:135]
v_mfma_f32_16x16x32_bf16 a[140:143], v[28:31], v[184:187], a[140:143]
v_mfma_f32_16x16x32_bf16 a[140:143], v[28:31], v[188:191], a[140:143]
s_mov_b32 s36, 0x57800000
v_mov_b32 v12, s36
s_nop 7
v_accvgpr_read_b32 v11, a136
s_nop 0
v_cmp_nlt_f32 vcc, v11, v12
v_rcp_f32 v11, v11
s_nop 2
s_cmp_lg_u64 vcc, 0
s_cselect_b32 s27, 4, 0
s_or_b32 s32, s32, s27
v_accvgpr_read_b32 v13, a64
v_accvgpr_read_b32 v14, a65
v_accvgpr_read_b32 v15, a66
v_accvgpr_read_b32 v16, a67
v_accvgpr_read_b32 v17, a68
v_accvgpr_read_b32 v18, a69
v_accvgpr_read_b32 v19, a70
v_accvgpr_read_b32 v20, a71
v_mul_f32 v13, v13, v11
v_mul_f32 v14, v14, v11
v_mul_f32 v15, v15, v11
v_mul_f32 v16, v16, v11
v_mul_f32 v17, v17, v11
v_mul_f32 v18, v18, v11
v_mul_f32 v19, v19, v11
v_mul_f32 v20, v20, v11
v_cvt_pk_bf16_f32 v208, v13, v14
v_cvt_pk_bf16_f32 v209, v15, v16
v_cvt_pk_bf16_f32 v210, v17, v18
v_cvt_pk_bf16_f32 v211, v19, v20
buffer_store_dwordx4 v[208:211], v2, s[48:51], s58 offen sc1
v_accvgpr_read_b32 v216, a72
v_accvgpr_read_b32 v217, a73
v_accvgpr_read_b32 v218, a74
v_accvgpr_read_b32 v219, a75
v_accvgpr_read_b32 v220, a76
v_accvgpr_read_b32 v221, a77
v_accvgpr_read_b32 v222, a78
v_accvgpr_read_b32 v223, a79
v_mul_f32 v216, v216, v11
v_mul_f32 v217, v217, v11
v_mul_f32 v218, v218, v11
v_mul_f32 v219, v219, v11
v_mul_f32 v220, v220, v11
v_mul_f32 v221, v221, v11
v_mul_f32 v222, v222, v11
v_mul_f32 v223, v223, v11
v_cvt_pk_bf16_f32 v212, v216, v217
v_cvt_pk_bf16_f32 v213, v218, v219
v_cvt_pk_bf16_f32 v214, v220, v221
v_cvt_pk_bf16_f32 v215, v222, v223
buffer_store_dwordx4 v[212:215], v2, s[48:51], s58 offen offset:1024 sc1
v_accvgpr_read_b32 v13, a80
v_accvgpr_read_b32 v14, a81
v_accvgpr_read_b32 v15, a82
v_accvgpr_read_b32 v16, a83
v_accvgpr_read_b32 v17, a84
v_accvgpr_read_b32 v18, a85
v_accvgpr_read_b32 v19, a86
v_accvgpr_read_b32 v20, a87
v_mul_f32 v13, v13, v11
v_mul_f32 v14, v14, v11
v_mul_f32 v15, v15, v11
v_mul_f32 v16, v16, v11
v_mul_f32 v17, v17, v11
v_mul_f32 v18, v18, v11
v_mul_f32 v19, v19, v11
v_mul_f32 v20, v20, v11
v_cvt_pk_bf16_f32 v208, v13, v14
v_cvt_pk_bf16_f32 v209, v15, v16
v_cvt_pk_bf16_f32 v210, v17, v18
v_cvt_pk_bf16_f32 v211, v19, v20
buffer_store_dwordx4 v[208:211], v2, s[48:51], s58 offen offset:2048 sc1
v_accvgpr_read_b32 v216, a88
v_accvgpr_read_b32 v217, a89
v_accvgpr_read_b32 v218, a90
v_accvgpr_read_b32 v219, a91
v_accvgpr_read_b32 v220, a92
v_accvgpr_read_b32 v221, a93
v_accvgpr_read_b32 v222, a94
v_accvgpr_read_b32 v223, a95
v_mul_f32 v216, v216, v11
v_mul_f32 v217, v217, v11
v_mul_f32 v218, v218, v11
v_mul_f32 v219, v219, v11
v_mul_f32 v220, v220, v11
v_mul_f32 v221, v221, v11
v_mul_f32 v222, v222, v11
v_mul_f32 v223, v223, v11
v_cvt_pk_bf16_f32 v212, v216, v217
v_cvt_pk_bf16_f32 v213, v218, v219
v_cvt_pk_bf16_f32 v214, v220, v221
v_cvt_pk_bf16_f32 v215, v222, v223
buffer_store_dwordx4 v[212:215], v2, s[48:51], s58 offen offset:3072 sc1
v_accvgpr_read_b32 v11, a140
s_nop 0
v_cmp_nlt_f32 vcc, v11, v12
v_rcp_f32 v11, v11
s_nop 2
s_cmp_lg_u64 vcc, 0
s_cselect_b32 s27, 8, 0
s_or_b32 s32, s32, s27
v_accvgpr_read_b32 v13, a96
v_accvgpr_read_b32 v14, a97
v_accvgpr_read_b32 v15, a98
v_accvgpr_read_b32 v16, a99
v_accvgpr_read_b32 v17, a100
v_accvgpr_read_b32 v18, a101
v_accvgpr_read_b32 v19, a102
v_accvgpr_read_b32 v20, a103
v_mul_f32 v13, v13, v11
v_mul_f32 v14, v14, v11
v_mul_f32 v15, v15, v11
v_mul_f32 v16, v16, v11
v_mul_f32 v17, v17, v11
v_mul_f32 v18, v18, v11
v_mul_f32 v19, v19, v11
v_mul_f32 v20, v20, v11
v_cvt_pk_bf16_f32 v208, v13, v14
v_cvt_pk_bf16_f32 v209, v15, v16
v_cvt_pk_bf16_f32 v210, v17, v18
v_cvt_pk_bf16_f32 v211, v19, v20
buffer_store_dwordx4 v[208:211], v2, s[48:51], s59 offen sc1
v_accvgpr_read_b32 v216, a104
v_accvgpr_read_b32 v217, a105
v_accvgpr_read_b32 v218, a106
v_accvgpr_read_b32 v219, a107
v_accvgpr_read_b32 v220, a108
v_accvgpr_read_b32 v221, a109
v_accvgpr_read_b32 v222, a110
v_accvgpr_read_b32 v223, a111
v_mul_f32 v216, v216, v11
v_mul_f32 v217, v217, v11
v_mul_f32 v218, v218, v11
v_mul_f32 v219, v219, v11
v_mul_f32 v220, v220, v11
v_mul_f32 v221, v221, v11
v_mul_f32 v222, v222, v11
v_mul_f32 v223, v223, v11
v_cvt_pk_bf16_f32 v212, v216, v217
v_cvt_pk_bf16_f32 v213, v218, v219
v_cvt_pk_bf16_f32 v214, v220, v221
v_cvt_pk_bf16_f32 v215, v222, v223
buffer_store_dwordx4 v[212:215], v2, s[48:51], s59 offen offset:1024 sc1
v_accvgpr_read_b32 v13, a112
v_accvgpr_read_b32 v14, a113
v_accvgpr_read_b32 v15, a114
v_accvgpr_read_b32 v16, a115
v_accvgpr_read_b32 v17, a116
v_accvgpr_read_b32 v18, a117
v_accvgpr_read_b32 v19, a118
v_accvgpr_read_b32 v20, a119
v_mul_f32 v13, v13, v11
v_mul_f32 v14, v14, v11
v_mul_f32 v15, v15, v11
v_mul_f32 v16, v16, v11
v_mul_f32 v17, v17, v11
v_mul_f32 v18, v18, v11
v_mul_f32 v19, v19, v11
v_mul_f32 v20, v20, v11
v_cvt_pk_bf16_f32 v208, v13, v14
v_cvt_pk_bf16_f32 v209, v15, v16
v_cvt_pk_bf16_f32 v210, v17, v18
v_cvt_pk_bf16_f32 v211, v19, v20
buffer_store_dwordx4 v[208:211], v2, s[48:51], s59 offen offset:2048 sc1
v_accvgpr_read_b32 v216, a120
v_accvgpr_read_b32 v217, a121
v_accvgpr_read_b32 v218, a122
v_accvgpr_read_b32 v219, a123
v_accvgpr_read_b32 v220, a124
v_accvgpr_read_b32 v221, a125
v_accvgpr_read_b32 v222, a126
v_accvgpr_read_b32 v223, a127
v_mul_f32 v216, v216, v11
v_mul_f32 v217, v217, v11
v_mul_f32 v218, v218, v11
v_mul_f32 v219, v219, v11
v_mul_f32 v220, v220, v11
v_mul_f32 v221, v221, v11
v_mul_f32 v222, v222, v11
v_mul_f32 v223, v223, v11
v_cvt_pk_bf16_f32 v212, v216, v217
v_cvt_pk_bf16_f32 v213, v218, v219
v_cvt_pk_bf16_f32 v214, v220, v221
v_cvt_pk_bf16_f32 v215, v222, v223
buffer_store_dwordx4 v[212:215], v2, s[48:51], s59 offen offset:3072 sc1
L_att_SS1a:
s_waitcnt lgkmcnt(4)
v_mfma_f32_16x16x32_bf16 v[64:67], a[208:211], a[144:147], v[192:195]
ds_read_b128 a[240:243], v3 offset:49152
v_mfma_f32_16x16x32_bf16 v[64:67], a[212:215], a[148:151], v[64:67]
ds_read_b128 a[244:247], v3 offset:50176
v_mfma_f32_16x16x32_bf16 v[64:67], a[216:219], a[152:155], v[64:67]
s_mov_b32 m0, s25
s_mov_b32 s26, s24
buffer_load_dwordx4 v2, s[40:43], s26 offen lds
v_mfma_f32_16x16x32_bf16 v[64:67], a[220:223], a[156:159], v[64:67]
ds_read_b128 a[248:251], v3 offset:51200
v_mfma_f32_16x16x32_bf16 v[68:71], a[208:211], a[160:163], v[196:199]
v_exp_f32 v112, v112
v_mfma_f32_16x16x32_bf16 v[68:71], a[212:215], a[164:167], v[68:71]
ds_read_b128 a[252:255], v3 offset:52224
v_exp_f32 v113, v113
v_mfma_f32_16x16x32_bf16 v[68:71], a[216:219], a[168:171], v[68:71]
v_exp_f32 v114, v114
v_mfma_f32_16x16x32_bf16 v[68:71], a[220:223], a[172:175], v[68:71]
s_waitcnt lgkmcnt(4)
buffer_load_dwordx4 v2, s[40:43], s26 offen offset:1024 lds
v_mfma_f32_16x16x32_bf16 v[80:83], a[224:227], a[144:147], v[192:195]
ds_read_b128 v[240:243], v3 offset:53248
v_exp_f32 v115, v115
v_mfma_f32_16x16x32_bf16 v[80:83], a[228:231], a[148:151], v[80:83]
ds_read_b128 v[244:247], v3 offset:54272
v_cvt_pk_bf16_f32 v134, v112, v113
v_mfma_f32_16x16x32_bf16 v[80:83], a[232:235], a[152:155], v[80:83]
v_cvt_pk_bf16_f32 v135, v114, v115
v_mfma_f32_16x16x32_bf16 v[80:83], a[236:239], a[156:159], v[80:83]
ds_read_b128 v[248:251], v3 offset:55296
v_mfma_f32_16x16x32_bf16 v[84:87], a[224:227], a[160:163], v[196:199]
v_exp_f32 v116, v116
v_mfma_f32_16x16x32_bf16 v[84:87], a[228:231], a[164:167], v[84:87]
ds_read_b128 v[252:255], v3 offset:56320
v_exp_f32 v117, v117
v_mfma_f32_16x16x32_bf16 v[84:87], a[232:235], a[168:171], v[84:87]
buffer_load_dwordx4 v2, s[40:43], s26 offen offset:2048 lds
v_mfma_f32_16x16x32_bf16 v[84:87], a[236:239], a[172:175], v[84:87]
s_waitcnt lgkmcnt(4)
v_exp_f32 v118, v118
v_mfma_f32_16x16x32_bf16 v[96:99], a[240:243], a[144:147], v[192:195]
ds_read_b128 v[32:35], v3 offset:8192
v_mfma_f32_16x16x32_bf16 v[96:99], a[244:247], a[148:151], v[96:99]
v_exp_f32 v119, v119
v_mfma_f32_16x16x32_bf16 v[96:99], a[248:251], a[152:155], v[96:99]
ds_read_b128 v[36:39], v3 offset:24576
v_cvt_pk_bf16_f32 v142, v116, v117
v_mfma_f32_16x16x32_bf16 v[96:99], a[252:255], a[156:159], v[96:99]
buffer_load_dwordx4 v2, s[40:43], s26 offen offset:3072 lds
v_cvt_pk_bf16_f32 v143, v118, v119
v_mfma_f32_16x16x32_bf16 v[100:103], a[240:243], a[160:163], v[196:199]
ds_read_b128 v[40:43], v3 offset:9216
v_exp_f32 v64, v64
v_mfma_f32_16x16x32_bf16 v[100:103], a[244:247], a[164:167], v[100:103]
v_exp_f32 v65, v65
v_mfma_f32_16x16x32_bf16 v[100:103], a[248:251], a[168:171], v[100:103]
v_exp_f32 v66, v66
v_mfma_f32_16x16x32_bf16 v[100:103], a[252:255], a[172:175], v[100:103]
s_waitcnt lgkmcnt(3)
ds_read_b128 v[44:47], v3 offset:25600
v_mfma_f32_16x16x32_bf16 v[112:115], v[240:243], a[144:147], v[192:195]
s_add_u32 m0, m0, 4096
s_add_u32 s26, s26, 4096
buffer_load_dwordx4 v2, s[40:43], s26 offen lds
v_mfma_f32_16x16x32_bf16 v[112:115], v[244:247], a[148:151], v[112:115]
ds_read_b128 v[48:51], v3 offset:10240
v_exp_f32 v67, v67
v_mfma_f32_16x16x32_bf16 v[112:115], v[248:251], a[152:155], v[112:115]
v_cvt_pk_bf16_f32 v160, v64, v65
v_cvt_pk_bf16_f32 v161, v66, v67
v_mfma_f32_16x16x32_bf16 v[112:115], v[252:255], a[156:159], v[112:115]
ds_read_b128 v[52:55], v3 offset:26624
v_mfma_f32_16x16x32_bf16 v[116:119], v[240:243], a[160:163], v[196:199]
v_exp_f32 v68, v68
v_mfma_f32_16x16x32_bf16 v[116:119], v[244:247], a[164:167], v[116:119]
buffer_load_dwordx4 v2, s[40:43], s26 offen offset:1024 lds
v_mfma_f32_16x16x32_bf16 v[116:119], v[248:251], a[168:171], v[116:119]
v_exp_f32 v69, v69
v_mfma_f32_16x16x32_bf16 v[116:119], v[252:255], a[172:175], v[116:119]
s_waitcnt lgkmcnt(4)
v_exp_f32 v70, v70
v_mfma_f32_16x16x32_bf16 a[0:3], v[32:35], v[128:131], a[0:3]
ds_read_b128 v[56:59], v3 offset:11264
v_mfma_f32_16x16x32_bf16 a[0:3], v[36:39], v[132:135], a[0:3]
v_exp_f32 v71, v71
v_mfma_f32_16x16x32_bf16 a[32:35], v[32:35], v[136:139], a[32:35]
ds_read_b128 v[60:63], v3 offset:27648
v_cvt_pk_bf16_f32 v168, v68, v69
v_mfma_f32_16x16x32_bf16 a[32:35], v[36:39], v[140:143], a[32:35]
s_waitcnt lgkmcnt(4)
buffer_load_dwordx4 v2, s[40:43], s26 offen offset:2048 lds
v_cvt_pk_bf16_f32 v169, v70, v71
v_mfma_f32_16x16x32_bf16 a[4:7], v[40:43], v[128:131], a[4:7]
ds_read_b128 v[32:35], v3 offset:12288
v_mfma_f32_16x16x32_bf16 a[4:7], v[44:47], v[132:135], a[4:7]
v_exp_f32 v80, v80
v_mfma_f32_16x16x32_bf16 a[36:39], v[40:43], v[136:139], a[36:39]
ds_read_b128 v[36:39], v3 offset:28672
v_exp_f32 v81, v81
v_mfma_f32_16x16x32_bf16 a[36:39], v[44:47], v[140:143], a[36:39]
s_waitcnt lgkmcnt(4)
v_exp_f32 v82, v82
v_mfma_f32_16x16x32_bf16 a[8:11], v[48:51], v[128:131], a[8:11]
ds_read_b128 v[40:43], v3 offset:13312
v_mfma_f32_16x16x32_bf16 a[8:11], v[52:55], v[132:135], a[8:11]
buffer_load_dwordx4 v2, s[40:43], s26 offen offset:3072 lds
s_add_u32 s24, s24, 32768
s_add_u32 s25, s25, 32768
s_and_b32 s25, s25, 0x1ffff
v_exp_f32 v83, v83
v_mfma_f32_16x16x32_bf16 a[40:43], v[48:51], v[136:139], a[40:43]
ds_read_b128 v[44:47], v3 offset:29696
v_cvt_pk_bf16_f32 v162, v80, v81
v_mfma_f32_16x16x32_bf16 a[40:43], v[52:55], v[140:143], a[40:43]
s_waitcnt lgkmcnt(4)
v_cvt_pk_bf16_f32 v163, v82, v83
v_mfma_f32_16x16x32_bf16 a[12:15], v[56:59], v[128:131], a[12:15]
ds_read_b128 v[48:51], v3 offset:14336
v_mfma_f32_16x16x32_bf16 a[12:15], v[60:63], v[132:135], a[12:15]
v_exp_f32 v84, v84
v_mfma_f32_16x16x32_bf16 a[44:47], v[56:59], v[136:139], a[44:47]
ds_read_b128 v[52:55], v3 offset:30720
v_exp_f32 v85, v85
v_mfma_f32_16x16x32_bf16 a[44:47], v[60:63], v[140:143], a[44:47]
s_waitcnt lgkmcnt(4)
v_exp_f32 v86, v86
v_mfma_f32_16x16x32_bf16 a[16:19], v[32:35], v[128:131], a[16:19]
ds_read_b128 v[56:59], v3 offset:15360
v_mfma_f32_16x16x32_bf16 a[16:19], v[36:39], v[132:135], a[16:19]
v_exp_f32 v87, v87
v_mfma_f32_16x16x32_bf16 a[48:51], v[32:35], v[136:139], a[48:51]
ds_read_b128 v[60:63], v3 offset:31744
v_cvt_pk_bf16_f32 v170, v84, v85
v_mfma_f32_16x16x32_bf16 a[48:51], v[36:39], v[140:143], a[48:51]
s_waitcnt lgkmcnt(4)
v_cvt_pk_bf16_f32 v171, v86, v87
v_mfma_f32_16x16x32_bf16 a[20:23], v[40:43], v[128:131], a[20:23]
v_exp_f32 v96, v96
v_mfma_f32_16x16x32_bf16 a[20:23], v[44:47], v[132:135], a[20:23]
v_exp_f32 v97, v97
v_mfma_f32_16x16x32_bf16 a[52:55], v[40:43], v[136:139], a[52:55]
v_exp_f32 v98, v98
v_mfma_f32_16x16x32_bf16 a[52:55], v[44:47], v[140:143], a[52:55]
s_waitcnt lgkmcnt(2)
v_exp_f32 v99, v99
v_mfma_f32_16x16x32_bf16 a[24:27], v[48:51], v[128:131], a[24:27]
s_waitcnt vmcnt(16) lgkmcnt(0)
s_barrier
v_cvt_pk_bf16_f32 v164, v96, v97
v_cvt_pk_bf16_f32 v165, v98, v99
v_mfma_f32_16x16x32_bf16 a[24:27], v[52:55], v[132:135], a[24:27]
ds_read_b128 a[208:211], v4
v_mfma_f32_16x16x32_bf16 a[56:59], v[48:51], v[136:139], a[56:59]
ds_read_b128 a[212:215], v4 offset:1024
v_mfma_f32_16x16x32_bf16 a[56:59], v[52:55], v[140:143], a[56:59]
ds_read_b128 a[216:219], v4 offset:2048
v_mfma_f32_16x16x32_bf16 a[28:31], v[56:59], v[128:131], a[28:31]
ds_read_b128 a[220:223], v4 offset:3072
v_mfma_f32_16x16x32_bf16 a[28:31], v[60:63], v[132:135], a[28:31]
ds_read_b128 a[224:227], v4 offset:4096
v_exp_f32 v100, v100
v_mfma_f32_16x16x32_bf16 a[60:63], v[56:59], v[136:139], a[60:63]
ds_read_b128 a[228:231], v4 offset:5120
v_mfma_f32_16x16x32_bf16 a[60:63], v[60:63], v[140:143], a[60:63]
ds_read_b128 a[232:235], v4 offset:6144
v_exp_f32 v101, v101
v_mfma_f32_16x16x32_bf16 a[128:131], v[28:31], v[128:131], a[128:131]
ds_read_b128 a[236:239], v4 offset:7168
v_mfma_f32_16x16x32_bf16 a[128:131], v[28:31], v[132:135], a[128:131]
v_exp_f32 v102, v102
v_mfma_f32_16x16x32_bf16 a[132:135], v[28:31], v[136:139], a[132:135]
v_exp_f32 v103, v103
v_mfma_f32_16x16x32_bf16 a[132:135], v[28:31], v[140:143], a[132:135]
v_cvt_pk_bf16_f32 v172, v100, v101
v_cvt_pk_bf16_f32 v173, v102, v103
v_xor_b32 v3, 0x10000, v3
v_xor_b32 v4, 0x10000, v4
s_lshl_b32 s23, s22, 1
s_sub_u32 s23, 13, s23
L_att_SS0:
s_waitcnt lgkmcnt(4)
v_mfma_f32_16x16x32_bf16 v[64:67], a[208:211], a[144:147], v[192:195]
ds_read_b128 a[240:243], v3 offset:16384
v_mfma_f32_16x16x32_bf16 v[64:67], a[212:215], a[148:151], v[64:67]
ds_read_b128 a[244:247], v3 offset:17408
v_mfma_f32_16x16x32_bf16 v[64:67], a[216:219], a[152:155], v[64:67]
s_mov_b32 m0, s25
s_mov_b32 s26, s24
buffer_load_dwordx4 v2, s[40:43], s26 offen lds
v_mfma_f32_16x16x32_bf16 v[64:67], a[220:223], a[156:159], v[64:67]
ds_read_b128 a[248:251], v3 offset:18432
v_mfma_f32_16x16x32_bf16 v[68:71], a[208:211], a[160:163], v[196:199]
v_exp_f32 v112, v112
v_mfma_f32_16x16x32_bf16 v[68:71], a[212:215], a[164:167], v[68:71]
ds_read_b128 a[252:255], v3 offset:19456
v_exp_f32 v113, v113
v_mfma_f32_16x16x32_bf16 v[68:71], a[216:219], a[168:171], v[68:71]
v_exp_f32 v114, v114
v_mfma_f32_16x16x32_bf16 v[68:71], a[220:223], a[172:175], v[68:71]
s_waitcnt lgkmcnt(4)
buffer_load_dwordx4 v2, s[40:43], s26 offen offset:1024 lds
v_mfma_f32_16x16x32_bf16 v[80:83], a[224:227], a[144:147], v[192:195]
ds_read_b128 v[240:243], v3 offset:20480
v_exp_f32 v115, v115
v_mfma_f32_16x16x32_bf16 v[80:83], a[228:231], a[148:151], v[80:83]
ds_read_b128 v[244:247], v3 offset:21504
v_cvt_pk_bf16_f32 v166, v112, v113
v_mfma_f32_16x16x32_bf16 v[80:83], a[232:235], a[152:155], v[80:83]
v_cvt_pk_bf16_f32 v167, v114, v115
v_mfma_f32_16x16x32_bf16 v[80:83], a[236:239], a[156:159], v[80:83]
ds_read_b128 v[248:251], v3 offset:22528
v_mfma_f32_16x16x32_bf16 v[84:87], a[224:227], a[160:163], v[196:199]
v_exp_f32 v116, v116
v_mfma_f32_16x16x32_bf16 v[84:87], a[228:231], a[164:167], v[84:87]
ds_read_b128 v[252:255], v3 offset:23552
v_exp_f32 v117, v117
v_mfma_f32_16x16x32_bf16 v[84:87], a[232:235], a[168:171], v[84:87]
buffer_load_dwordx4 v2, s[40:43], s26 offen offset:2048 lds
v_mfma_f32_16x16x32_bf16 v[84:87], a[236:239], a[172:175], v[84:87]
s_waitcnt lgkmcnt(4)
v_exp_f32 v118, v118
v_mfma_f32_16x16x32_bf16 v[96:99], a[240:243], a[144:147], v[192:195]
ds_read_b128 v[32:35], v4 offset:40960
v_mfma_f32_16x16x32_bf16 v[96:99], a[244:247], a[148:151], v[96:99]
v_exp_f32 v119, v119
v_mfma_f32_16x16x32_bf16 v[96:99], a[248:251], a[152:155], v[96:99]
ds_read_b128 v[36:39], v4 offset:57344
v_cvt_pk_bf16_f32 v174, v116, v117
v_mfma_f32_16x16x32_bf16 v[96:99], a[252:255], a[156:159], v[96:99]
buffer_load_dwordx4 v2, s[40:43], s26 offen offset:3072 lds
v_cvt_pk_bf16_f32 v175, v118, v119
v_mfma_f32_16x16x32_bf16 v[100:103], a[240:243], a[160:163], v[196:199]
ds_read_b128 v[40:43], v4 offset:41984
v_exp_f32 v64, v64
v_mfma_f32_16x16x32_bf16 v[100:103], a[244:247], a[164:167], v[100:103]
v_exp_f32 v65, v65
v_mfma_f32_16x16x32_bf16 v[100:103], a[248:251], a[168:171], v[100:103]
v_exp_f32 v66, v66
v_mfma_f32_16x16x32_bf16 v[100:103], a[252:255], a[172:175], v[100:103]
s_waitcnt lgkmcnt(3)
ds_read_b128 v[44:47], v4 offset:58368
v_mfma_f32_16x16x32_bf16 v[112:115], v[240:243], a[144:147], v[192:195]
s_add_u32 m0, m0, 4096
s_add_u32 s26, s26, 4096
buffer_load_dwordx4 v2, s[40:43], s26 offen lds
v_mfma_f32_16x16x32_bf16 v[112:115], v[244:247], a[148:151], v[112:115]
ds_read_b128 v[48:51], v4 offset:43008
v_exp_f32 v67, v67
v_mfma_f32_16x16x32_bf16 v[112:115], v[248:251], a[152:155], v[112:115]
v_cvt_pk_bf16_f32 v128, v64, v65
v_cvt_pk_bf16_f32 v129, v66, v67
v_mfma_f32_16x16x32_bf16 v[112:115], v[252:255], a[156:159], v[112:115]
ds_read_b128 v[52:55], v4 offset:59392
v_mfma_f32_16x16x32_bf16 v[116:119], v[240:243], a[160:163], v[196:199]
v_exp_f32 v68, v68
v_mfma_f32_16x16x32_bf16 v[116:119], v[244:247], a[164:167], v[116:119]
buffer_load_dwordx4 v2, s[40:43], s26 offen offset:1024 lds
v_mfma_f32_16x16x32_bf16 v[116:119], v[248:251], a[168:171], v[116:119]
v_exp_f32 v69, v69
v_mfma_f32_16x16x32_bf16 v[116:119], v[252:255], a[172:175], v[116:119]
s_waitcnt lgkmcnt(4)
v_exp_f32 v70, v70
v_mfma_f32_16x16x32_bf16 a[0:3], v[32:35], v[160:163], a[0:3]
ds_read_b128 v[56:59], v4 offset:44032
v_mfma_f32_16x16x32_bf16 a[0:3], v[36:39], v[164:167], a[0:3]
v_exp_f32 v71, v71
v_mfma_f32_16x16x32_bf16 a[32:35], v[32:35], v[168:171], a[32:35]
ds_read_b128 v[60:63], v4 offset:60416
v_cvt_pk_bf16_f32 v136, v68, v69
v_mfma_f32_16x16x32_bf16 a[32:35], v[36:39], v[172:175], a[32:35]
s_waitcnt lgkmcnt(4)
buffer_load_dwordx4 v2, s[40:43], s26 offen offset:2048 lds
v_cvt_pk_bf16_f32 v137, v70, v71
v_mfma_f32_16x16x32_bf16 a[4:7], v[40:43], v[160:163], a[4:7]
ds_read_b128 v[32:35], v4 offset:45056
v_mfma_f32_16x16x32_bf16 a[4:7], v[44:47], v[164:167], a[4:7]
v_exp_f32 v80, v80
v_mfma_f32_16x16x32_bf16 a[36:39], v[40:43], v[168:171], a[36:39]
ds_read_b128 v[36:39], v4 offset:61440
v_exp_f32 v81, v81
v_mfma_f32_16x16x32_bf16 a[36:39], v[44:47], v[172:175], a[36:39]
s_waitcnt lgkmcnt(4)
v_exp_f32 v82, v82
v_mfma_f32_16x16x32_bf16 a[8:11], v[48:51], v[160:163], a[8:11]
ds_read_b128 v[40:43], v4 offset:46080
v_mfma_f32_16x16x32_bf16 a[8:11], v[52:55], v[164:167], a[8:11]
buffer_load_dwordx4 v2, s[40:43], s26 offen offset:3072 lds
s_add_u32 s24, s24, 32768
s_add_u32 s25, s25, 32768
s_and_b32 s25, s25, 0x1ffff
v_exp_f32 v83, v83
v_mfma_f32_16x16x32_bf16 a[40:43], v[48:51], v[168:171], a[40:43]
ds_read_b128 v[44:47], v4 offset:62464
v_cvt_pk_bf16_f32 v130, v80, v81
v_mfma_f32_16x16x32_bf16 a[40:43], v[52:55], v[172:175], a[40:43]
s_waitcnt lgkmcnt(4)
v_cvt_pk_bf16_f32 v131, v82, v83
v_mfma_f32_16x16x32_bf16 a[12:15], v[56:59], v[160:163], a[12:15]
ds_read_b128 v[48:51], v4 offset:47104
v_mfma_f32_16x16x32_bf16 a[12:15], v[60:63], v[164:167], a[12:15]
v_exp_f32 v84, v84
v_mfma_f32_16x16x32_bf16 a[44:47], v[56:59], v[168:171], a[44:47]
ds_read_b128 v[52:55], v4 offset:63488
v_exp_f32 v85, v85
v_mfma_f32_16x16x32_bf16 a[44:47], v[60:63], v[172:175], a[44:47]
s_waitcnt lgkmcnt(4)
v_exp_f32 v86, v86
v_mfma_f32_16x16x32_bf16 a[16:19], v[32:35], v[160:163], a[16:19]
ds_read_b128 v[56:59], v4 offset:48128
v_mfma_f32_16x16x32_bf16 a[16:19], v[36:39], v[164:167], a[16:19]
v_exp_f32 v87, v87
v_mfma_f32_16x16x32_bf16 a[48:51], v[32:35], v[168:171], a[48:51]
ds_read_b128 v[60:63], v4 offset:64512
v_cvt_pk_bf16_f32 v138, v84, v85
v_mfma_f32_16x16x32_bf16 a[48:51], v[36:39], v[172:175], a[48:51]
s_waitcnt lgkmcnt(4)
v_cvt_pk_bf16_f32 v139, v86, v87
v_mfma_f32_16x16x32_bf16 a[20:23], v[40:43], v[160:163], a[20:23]
v_exp_f32 v96, v96
v_mfma_f32_16x16x32_bf16 a[20:23], v[44:47], v[164:167], a[20:23]
v_exp_f32 v97, v97
v_mfma_f32_16x16x32_bf16 a[52:55], v[40:43], v[168:171], a[52:55]
v_exp_f32 v98, v98
v_mfma_f32_16x16x32_bf16 a[52:55], v[44:47], v[172:175], a[52:55]
s_waitcnt lgkmcnt(2)
v_exp_f32 v99, v99
v_mfma_f32_16x16x32_bf16 a[24:27], v[48:51], v[160:163], a[24:27]
s_waitcnt vmcnt(8) lgkmcnt(0)
s_barrier
v_cvt_pk_bf16_f32 v132, v96, v97
v_cvt_pk_bf16_f32 v133, v98, v99
v_mfma_f32_16x16x32_bf16 a[24:27], v[52:55], v[164:167], a[24:27]
ds_read_b128 a[208:211], v3 offset:32768
v_mfma_f32_16x16x32_bf16 a[56:59], v[48:51], v[168:171], a[56:59]
ds_read_b128 a[212:215], v3 offset:33792
v_mfma_f32_16x16x32_bf16 a[56:59], v[52:55], v[172:175], a[56:59]
ds_read_b128 a[216:219], v3 offset:34816
v_mfma_f32_16x16x32_bf16 a[28:31], v[56:59], v[160:163], a[28:31]
ds_read_b128 a[220:223], v3 offset:35840
v_mfma_f32_16x16x32_bf16 a[28:31], v[60:63], v[164:167], a[28:31]
ds_read_b128 a[224:227], v3 offset:36864
v_exp_f32 v100, v100
v_mfma_f32_16x16x32_bf16 a[60:63], v[56:59], v[168:171], a[60:63]
ds_read_b128 a[228:231], v3 offset:37888
v_mfma_f32_16x16x32_bf16 a[60:63], v[60:63], v[172:175], a[60:63]
ds_read_b128 a[232:235], v3 offset:38912
v_exp_f32 v101, v101
v_mfma_f32_16x16x32_bf16 a[128:131], v[28:31], v[160:163], a[128:131]
ds_read_b128 a[236:239], v3 offset:39936
v_mfma_f32_16x16x32_bf16 a[128:131], v[28:31], v[164:167], a[128:131]
v_exp_f32 v102, v102
v_mfma_f32_16x16x32_bf16 a[132:135], v[28:31], v[168:171], a[132:135]
v_exp_f32 v103, v103
v_mfma_f32_16x16x32_bf16 a[132:135], v[28:31], v[172:175], a[132:135]
v_cvt_pk_bf16_f32 v140, v100, v101
v_cvt_pk_bf16_f32 v141, v102, v103
L_att_SS1:
s_waitcnt lgkmcnt(4)
v_mfma_f32_16x16x32_bf16 v[64:67], a[208:211], a[144:147], v[192:195]
ds_read_b128 a[240:243], v3 offset:49152
v_mfma_f32_16x16x32_bf16 v[64:67], a[212:215], a[148:151], v[64:67]
ds_read_b128 a[244:247], v3 offset:50176
v_mfma_f32_16x16x32_bf16 v[64:67], a[216:219], a[152:155], v[64:67]
s_mov_b32 m0, s25
s_mov_b32 s26, s24
buffer_load_dwordx4 v2, s[40:43], s26 offen lds
v_mfma_f32_16x16x32_bf16 v[64:67], a[220:223], a[156:159], v[64:67]
ds_read_b128 a[248:251], v3 offset:51200
v_mfma_f32_16x16x32_bf16 v[68:71], a[208:211], a[160:163], v[196:199]
v_exp_f32 v112, v112
v_mfma_f32_16x16x32_bf16 v[68:71], a[212:215], a[164:167], v[68:71]
ds_read_b128 a[252:255], v3 offset:52224
v_exp_f32 v113, v113
v_mfma_f32_16x16x32_bf16 v[68:71], a[216:219], a[168:171], v[68:71]
v_exp_f32 v114, v114
v_mfma_f32_16x16x32_bf16 v[68:71], a[220:223], a[172:175], v[68:71]
s_waitcnt lgkmcnt(4)
buffer_load_dwordx4 v2, s[40:43], s26 offen offset:1024 lds
v_mfma_f32_16x16x32_bf16 v[80:83], a[224:227], a[144:147], v[192:195]
ds_read_b128 v[240:243], v3 offset:53248
v_exp_f32 v115, v115
v_mfma_f32_16x16x32_bf16 v[80:83], a[228:231], a[148:151], v[80:83]
ds_read_b128 v[244:247], v3 offset:54272
v_cvt_pk_bf16_f32 v134, v112, v113
v_mfma_f32_16x16x32_bf16 v[80:83], a[232:235], a[152:155], v[80:83]
v_cvt_pk_bf16_f32 v135, v114, v115
v_mfma_f32_16x16x32_bf16 v[80:83], a[236:239], a[156:159], v[80:83]
ds_read_b128 v[248:251], v3 offset:55296
v_mfma_f32_16x16x32_bf16 v[84:87], a[224:227], a[160:163], v[196:199]
v_exp_f32 v116, v116
v_mfma_f32_16x16x32_bf16 v[84:87], a[228:231], a[164:167], v[84:87]
ds_read_b128 v[252:255], v3 offset:56320
v_exp_f32 v117, v117
v_mfma_f32_16x16x32_bf16 v[84:87], a[232:235], a[168:171], v[84:87]
buffer_load_dwordx4 v2, s[40:43], s26 offen offset:2048 lds
v_mfma_f32_16x16x32_bf16 v[84:87], a[236:239], a[172:175], v[84:87]
s_waitcnt lgkmcnt(4)
v_exp_f32 v118, v118
v_mfma_f32_16x16x32_bf16 v[96:99], a[240:243], a[144:147], v[192:195]
ds_read_b128 v[32:35], v3 offset:8192
v_mfma_f32_16x16x32_bf16 v[96:99], a[244:247], a[148:151], v[96:99]
v_exp_f32 v119, v119
v_mfma_f32_16x16x32_bf16 v[96:99], a[248:251], a[152:155], v[96:99]
ds_read_b128 v[36:39], v3 offset:24576
v_cvt_pk_bf16_f32 v142, v116, v117
v_mfma_f32_16x16x32_bf16 v[96:99], a[252:255], a[156:159], v[96:99]
buffer_load_dwordx4 v2, s[40:43], s26 offen offset:3072 lds
v_cvt_pk_bf16_f32 v143, v118, v119
v_mfma_f32_16x16x32_bf16 v[100:103], a[240:243], a[160:163], v[196:199]
ds_read_b128 v[40:43], v3 offset:9216
v_exp_f32 v64, v64
v_mfma_f32_16x16x32_bf16 v[100:103], a[244:247], a[164:167], v[100:103]
v_exp_f32 v65, v65
v_mfma_f32_16x16x32_bf16 v[100:103], a[248:251], a[168:171], v[100:103]
v_exp_f32 v66, v66
v_mfma_f32_16x16x32_bf16 v[100:103], a[252:255], a[172:175], v[100:103]
s_waitcnt lgkmcnt(3)
ds_read_b128 v[44:47], v3 offset:25600
v_mfma_f32_16x16x32_bf16 v[112:115], v[240:243], a[144:147], v[192:195]
s_add_u32 m0, m0, 4096
s_add_u32 s26, s26, 4096
buffer_load_dwordx4 v2, s[40:43], s26 offen lds
v_mfma_f32_16x16x32_bf16 v[112:115], v[244:247], a[148:151], v[112:115]
ds_read_b128 v[48:51], v3 offset:10240
v_exp_f32 v67, v67
v_mfma_f32_16x16x32_bf16 v[112:115], v[248:251], a[152:155], v[112:115]
v_cvt_pk_bf16_f32 v160, v64, v65
v_cvt_pk_bf16_f32 v161, v66, v67
v_mfma_f32_16x16x32_bf16 v[112:115], v[252:255], a[156:159], v[112:115]
ds_read_b128 v[52:55], v3 offset:26624
v_mfma_f32_16x16x32_bf16 v[116:119], v[240:243], a[160:163], v[196:199]
v_exp_f32 v68, v68
v_mfma_f32_16x16x32_bf16 v[116:119], v[244:247], a[164:167], v[116:119]
buffer_load_dwordx4 v2, s[40:43], s26 offen offset:1024 lds
v_mfma_f32_16x16x32_bf16 v[116:119], v[248:251], a[168:171], v[116:119]
v_exp_f32 v69, v69
v_mfma_f32_16x16x32_bf16 v[116:119], v[252:255], a[172:175], v[116:119]
s_waitcnt lgkmcnt(4)
v_exp_f32 v70, v70
v_mfma_f32_16x16x32_bf16 a[0:3], v[32:35], v[128:131], a[0:3]
ds_read_b128 v[56:59], v3 offset:11264
v_mfma_f32_16x16x32_bf16 a[0:3], v[36:39], v[132:135], a[0:3]
v_exp_f32 v71, v71
v_mfma_f32_16x16x32_bf16 a[32:35], v[32:35], v[136:139], a[32:35]
ds_read_b128 v[60:63], v3 offset:27648
v_cvt_pk_bf16_f32 v168, v68, v69
v_mfma_f32_16x16x32_bf16 a[32:35], v[36:39], v[140:143], a[32:35]
s_waitcnt lgkmcnt(4)
buffer_load_dwordx4 v2, s[40:43], s26 offen offset:2048 lds
v_cvt_pk_bf16_f32 v169, v70, v71
v_mfma_f32_16x16x32_bf16 a[4:7], v[40:43], v[128:131], a[4:7]
ds_read_b128 v[32:35], v3 offset:12288
v_mfma_f32_16x16x32_bf16 a[4:7], v[44:47], v[132:135], a[4:7]
v_exp_f32 v80, v80
v_mfma_f32_16x16x32_bf16 a[36:39], v[40:43], v[136:139], a[36:39]
ds_read_b128 v[36:39], v3 offset:28672
v_exp_f32 v81, v81
v_mfma_f32_16x16x32_bf16 a[36:39], v[44:47], v[140:143], a[36:39]
s_waitcnt lgkmcnt(4)
v_exp_f32 v82, v82
v_mfma_f32_16x16x32_bf16 a[8:11], v[48:51], v[128:131], a[8:11]
ds_read_b128 v[40:43], v3 offset:13312
v_mfma_f32_16x16x32_bf16 a[8:11], v[52:55], v[132:135], a[8:11]
buffer_load_dwordx4 v2, s[40:43], s26 offen offset:3072 lds
s_add_u32 s24, s24, 32768
s_add_u32 s25, s25, 32768
s_and_b32 s25, s25, 0x1ffff
v_exp_f32 v83, v83
v_mfma_f32_16x16x32_bf16 a[40:43], v[48:51], v[136:139], a[40:43]
ds_read_b128 v[44:47], v3 offset:29696
v_cvt_pk_bf16_f32 v162, v80, v81
v_mfma_f32_16x16x32_bf16 a[40:43], v[52:55], v[140:143], a[40:43]
s_waitcnt lgkmcnt(4)
v_cvt_pk_bf16_f32 v163, v82, v83
v_mfma_f32_16x16x32_bf16 a[12:15], v[56:59], v[128:131], a[12:15]
ds_read_b128 v[48:51], v3 offset:14336
v_mfma_f32_16x16x32_bf16 a[12:15], v[60:63], v[132:135], a[12:15]
v_exp_f32 v84, v84
v_mfma_f32_16x16x32_bf16 a[44:47], v[56:59], v[136:139], a[44:47]
ds_read_b128 v[52:55], v3 offset:30720
v_exp_f32 v85, v85
v_mfma_f32_16x16x32_bf16 a[44:47], v[60:63], v[140:143], a[44:47]
s_waitcnt lgkmcnt(4)
v_exp_f32 v86, v86
v_mfma_f32_16x16x32_bf16 a[16:19], v[32:35], v[128:131], a[16:19]
ds_read_b128 v[56:59], v3 offset:15360
v_mfma_f32_16x16x32_bf16 a[16:19], v[36:39], v[132:135], a[16:19]
v_exp_f32 v87, v87
v_mfma_f32_16x16x32_bf16 a[48:51], v[32:35], v[136:139], a[48:51]
ds_read_b128 v[60:63], v3 offset:31744
v_cvt_pk_bf16_f32 v170, v84, v85
v_mfma_f32_16x16x32_bf16 a[48:51], v[36:39], v[140:143], a[48:51]
s_waitcnt lgkmcnt(4)
buffer_load_dword v23, v9, s[60:63], 0 offen
v_cvt_pk_bf16_f32 v171, v86, v87
v_mfma_f32_16x16x32_bf16 a[20:23], v[40:43], v[128:131], a[20:23]
v_exp_f32 v96, v96
v_mfma_f32_16x16x32_bf16 a[20:23], v[44:47], v[132:135], a[20:23]
buffer_load_dword v24, v22, s[64:67], 0 offen
v_mfma_f32_16x16x32_bf16 a[52:55], v[40:43], v[136:139], a[52:55]
v_exp_f32 v97, v97
v_mfma_f32_16x16x32_bf16 a[52:55], v[44:47], v[140:143], a[52:55]
s_waitcnt lgkmcnt(2)
v_exp_f32 v98, v98
v_mfma_f32_16x16x32_bf16 a[24:27], v[48:51], v[128:131], a[24:27]
s_waitcnt vmcnt(10) lgkmcnt(0)
s_barrier
v_exp_f32 v99, v99
v_mfma_f32_16x16x32_bf16 a[24:27], v[52:55], v[132:135], a[24:27]
ds_read_b128 a[208:211], v4
v_cvt_pk_bf16_f32 v164, v96, v97
v_mfma_f32_16x16x32_bf16 a[56:59], v[48:51], v[136:139], a[56:59]
ds_read_b128 a[212:215], v4 offset:1024
v_cvt_pk_bf16_f32 v165, v98, v99
v_mfma_f32_16x16x32_bf16 a[56:59], v[52:55], v[140:143], a[56:59]
ds_read_b128 a[216:219], v4 offset:2048
v_add_u32 v9, 13312, v9
v_mfma_f32_16x16x32_bf16 a[28:31], v[56:59], v[128:131], a[28:31]
ds_read_b128 a[220:223], v4 offset:3072
v_add_u32 v22, 13312, v22
v_mfma_f32_16x16x32_bf16 a[28:31], v[60:63], v[132:135], a[28:31]
ds_read_b128 a[224:227], v4 offset:4096
v_exp_f32 v100, v100
v_mfma_f32_16x16x32_bf16 a[60:63], v[56:59], v[136:139], a[60:63]
ds_read_b128 a[228:231], v4 offset:5120
v_mfma_f32_16x16x32_bf16 a[60:63], v[60:63], v[140:143], a[60:63]
ds_read_b128 a[232:235], v4 offset:6144
v_exp_f32 v101, v101
v_mfma_f32_16x16x32_bf16 a[128:131], v[28:31], v[128:131], a[128:131]
ds_read_b128 a[236:239], v4 offset:7168
v_mfma_f32_16x16x32_bf16 a[128:131], v[28:31], v[132:135], a[128:131]
v_exp_f32 v102, v102
v_mfma_f32_16x16x32_bf16 a[132:135], v[28:31], v[136:139], a[132:135]
v_exp_f32 v103, v103
v_mfma_f32_16x16x32_bf16 a[132:135], v[28:31], v[140:143], a[132:135]
v_cvt_pk_bf16_f32 v172, v100, v101
v_cvt_pk_bf16_f32 v173, v102, v103
v_xor_b32 v3, 0x10000, v3
v_xor_b32 v4, 0x10000, v4
s_sub_u32 s23, s23, 1
s_cmp_lg_u32 s23, 0
s_cbranch_scc1 L_att_SS0
L_att_SSm0:
v_add_f32 v208, v224, v192
v_add_f32 v209, v225, v192
v_add_f32 v210, v226, v192
v_add_f32 v211, v227, v192
s_nop 1
s_waitcnt lgkmcnt(4)
v_mfma_f32_16x16x32_bf16 v[64:67], a[208:211], a[144:147], v[208:211]
ds_read_b128 a[240:243], v3 offset:16384
v_add_f32 v212, v228, v192
v_mfma_f32_16x16x32_bf16 v[64:67], a[212:215], a[148:151], v[64:67]
ds_read_b128 a[244:247], v3 offset:17408
v_add_f32 v213, v229, v192
v_mfma_f32_16x16x32_bf16 v[64:67], a[216:219], a[152:155], v[64:67]
s_mov_b32 m0, s25
s_mov_b32 s26, s24
buffer_load_dwordx4 v2, s[40:43], s26 offen lds
v_mfma_f32_16x16x32_bf16 v[64:67], a[220:223], a[156:159], v[64:67]
ds_read_b128 a[248:251], v3 offset:18432
v_add_f32 v214, v230, v192
v_mfma_f32_16x16x32_bf16 v[68:71], a[208:211], a[160:163], v[196:199]
v_add_f32 v215, v231, v192
v_exp_f32 v112, v112
v_mfma_f32_16x16x32_bf16 v[68:71], a[212:215], a[164:167], v[68:71]
ds_read_b128 a[252:255], v3 offset:19456
v_exp_f32 v113, v113
v_mfma_f32_16x16x32_bf16 v[68:71], a[216:219], a[168:171], v[68:71]
v_exp_f32 v114, v114
v_mfma_f32_16x16x32_bf16 v[68:71], a[220:223], a[172:175], v[68:71]
s_waitcnt lgkmcnt(4)
buffer_load_dwordx4 v2, s[40:43], s26 offen offset:1024 lds
v_add_f32 v216, v232, v192
v_mfma_f32_16x16x32_bf16 v[80:83], a[224:227], a[144:147], v[212:215]
ds_read_b128 v[240:243], v3 offset:20480
v_exp_f32 v115, v115
v_mfma_f32_16x16x32_bf16 v[80:83], a[228:231], a[148:151], v[80:83]
ds_read_b128 v[244:247], v3 offset:21504
v_add_f32 v217, v233, v192
v_mfma_f32_16x16x32_bf16 v[80:83], a[232:235], a[152:155], v[80:83]
v_cvt_pk_bf16_f32 v166, v112, v113
v_add_f32 v218, v234, v192
v_mfma_f32_16x16x32_bf16 v[80:83], a[236:239], a[156:159], v[80:83]
ds_read_b128 v[248:251], v3 offset:22528
v_cvt_pk_bf16_f32 v167, v114, v115
v_mfma_f32_16x16x32_bf16 v[84:87], a[224:227], a[160:163], v[196:199]
v_add_f32 v219, v235, v192
v_exp_f32 v116, v116
v_mfma_f32_16x16x32_bf16 v[84:87], a[228:231], a[164:167], v[84:87]
ds_read_b128 v[252:255], v3 offset:23552
v_exp_f32 v117, v117
v_mfma_f32_16x16x32_bf16 v[84:87], a[232:235], a[168:171], v[84:87]
buffer_load_dwordx4 v2, s[40:43], s26 offen offset:2048 lds
v_add_f32 v220, v236, v192
v_mfma_f32_16x16x32_bf16 v[84:87], a[236:239], a[172:175], v[84:87]
s_waitcnt lgkmcnt(4)
v_exp_f32 v118, v118
v_mfma_f32_16x16x32_bf16 v[96:99], a[240:243], a[144:147], v[216:219]
ds_read_b128 v[32:35], v4 offset:40960
v_add_f32 v221, v237, v192
v_mfma_f32_16x16x32_bf16 v[96:99], a[244:247], a[148:151], v[96:99]
v_exp_f32 v119, v119
v_mfma_f32_16x16x32_bf16 v[96:99], a[248:251], a[152:155], v[96:99]
ds_read_b128 v[36:39], v4 offset:57344
v_cvt_pk_bf16_f32 v174, v116, v117
v_mfma_f32_16x16x32_bf16 v[96:99], a[252:255], a[156:159], v[96:99]
buffer_load_dwordx4 v2, s[40:43], s26 offen offset:3072 lds
v_add_f32 v222, v238, v192
v_cvt_pk_bf16_f32 v175, v118, v119
v_mfma_f32_16x16x32_bf16 v[100:103], a[240:243], a[160:163], v[196:199]
ds_read_b128 v[40:43], v4 offset:41984
v_add_f32 v223, v239, v192
v_exp_f32 v64, v64
v_mfma_f32_16x16x32_bf16 v[100:103], a[244:247], a[164:167], v[100:103]
v_exp_f32 v65, v65
v_mfma_f32_16x16x32_bf16 v[100:103], a[248:251], a[168:171], v[100:103]
v_exp_f32 v66, v66
v_mfma_f32_16x16x32_bf16 v[100:103], a[252:255], a[172:175], v[100:103]
s_waitcnt lgkmcnt(3)
ds_read_b128 v[44:47], v4 offset:58368
v_mfma_f32_16x16x32_bf16 v[112:115], v[240:243], a[144:147], v[220:223]
s_add_u32 m0, m0, 4096
s_add_u32 s26, s26, 4096
buffer_load_dwordx4 v2, s[40:43], s26 offen lds
v_mfma_f32_16x16x32_bf16 v[112:115], v[244:247], a[148:151], v[112:115]
ds_read_b128 v[48:51], v4 offset:43008
v_exp_f32 v67, v67
v_mfma_f32_16x16x32_bf16 v[112:115], v[248:251], a[152:155], v[112:115]
v_cvt_pk_bf16_f32 v128, v64, v65
v_cvt_pk_bf16_f32 v129, v66, v67
v_mfma_f32_16x16x32_bf16 v[112:115], v[252:255], a[156:159], v[112:115]
ds_read_b128 v[52:55], v4 offset:59392
v_mfma_f32_16x16x32_bf16 v[116:119], v[240:243], a[160:163], v[196:199]
v_exp_f32 v68, v68
v_mfma_f32_16x16x32_bf16 v[116:119], v[244:247], a[164:167], v[116:119]
buffer_load_dwordx4 v2, s[40:43], s26 offen offset:1024 lds
v_mfma_f32_16x16x32_bf16 v[116:119], v[248:251], a[168:171], v[116:119]
v_exp_f32 v69, v69
v_mfma_f32_16x16x32_bf16 v[116:119], v[252:255], a[172:175], v[116:119]
s_waitcnt lgkmcnt(4)
v_exp_f32 v70, v70
v_mfma_f32_16x16x32_bf16 a[0:3], v[32:35], v[160:163], a[0:3]
ds_read_b128 v[56:59], v4 offset:44032
v_mfma_f32_16x16x32_bf16 a[0:3], v[36:39], v[164:167], a[0:3]
v_exp_f32 v71, v71
v_mfma_f32_16x16x32_bf16 a[32:35], v[32:35], v[168:171], a[32:35]
ds_read_b128 v[60:63], v4 offset:60416
v_cvt_pk_bf16_f32 v136, v68, v69
v_mfma_f32_16x16x32_bf16 a[32:35], v[36:39], v[172:175], a[32:35]
s_waitcnt lgkmcnt(4)
buffer_load_dwordx4 v2, s[40:43], s26 offen offset:2048 lds
v_cvt_pk_bf16_f32 v137, v70, v71
v_mfma_f32_16x16x32_bf16 a[4:7], v[40:43], v[160:163], a[4:7]
ds_read_b128 v[32:35], v4 offset:45056
v_mfma_f32_16x16x32_bf16 a[4:7], v[44:47], v[164:167], a[4:7]
v_exp_f32 v80, v80
v_mfma_f32_16x16x32_bf16 a[36:39], v[40:43], v[168:171], a[36:39]
ds_read_b128 v[36:39], v4 offset:61440
v_exp_f32 v81, v81
v_mfma_f32_16x16x32_bf16 a[36:39], v[44:47], v[172:175], a[36:39]
s_waitcnt lgkmcnt(4)
v_exp_f32 v82, v82
v_mfma_f32_16x16x32_bf16 a[8:11], v[48:51], v[160:163], a[8:11]
ds_read_b128 v[40:43], v4 offset:46080
v_mfma_f32_16x16x32_bf16 a[8:11], v[52:55], v[164:167], a[8:11]
buffer_load_dwordx4 v2, s[40:43], s26 offen offset:3072 lds
s_add_u32 s24, s24, 32768
s_add_u32 s25, s25, 32768
s_and_b32 s25, s25, 0x1ffff
v_exp_f32 v83, v83
v_mfma_f32_16x16x32_bf16 a[40:43], v[48:51], v[168:171], a[40:43]
ds_read_b128 v[44:47], v4 offset:62464
v_cvt_pk_bf16_f32 v130, v80, v81
v_mfma_f32_16x16x32_bf16 a[40:43], v[52:55], v[172:175], a[40:43]
s_waitcnt lgkmcnt(4)
v_cvt_pk_bf16_f32 v131, v82, v83
v_mfma_f32_16x16x32_bf16 a[12:15], v[56:59], v[160:163], a[12:15]
ds_read_b128 v[48:51], v4 offset:47104
v_mfma_f32_16x16x32_bf16 a[12:15], v[60:63], v[164:167], a[12:15]
v_exp_f32 v84, v84
v_mfma_f32_16x16x32_bf16 a[44:47], v[56:59], v[168:171], a[44:47]
ds_read_b128 v[52:55], v4 offset:63488
v_exp_f32 v85, v85
v_mfma_f32_16x16x32_bf16 a[44:47], v[60:63], v[172:175], a[44:47]
s_waitcnt lgkmcnt(4)
v_exp_f32 v86, v86
v_mfma_f32_16x16x32_bf16 a[16:19], v[32:35], v[160:163], a[16:19]
ds_read_b128 v[56:59], v4 offset:48128
v_mfma_f32_16x16x32_bf16 a[16:19], v[36:39], v[164:167], a[16:19]
v_exp_f32 v87, v87
v_mfma_f32_16x16x32_bf16 a[48:51], v[32:35], v[168:171], a[48:51]
ds_read_b128 v[60:63], v4 offset:64512
v_cvt_pk_bf16_f32 v138, v84, v85
v_mfma_f32_16x16x32_bf16 a[48:51], v[36:39], v[172:175], a[48:51]
s_waitcnt lgkmcnt(4)
v_cvt_pk_bf16_f32 v139, v86, v87
v_mfma_f32_16x16x32_bf16 a[20:23], v[40:43], v[160:163], a[20:23]
v_exp_f32 v96, v96
v_mfma_f32_16x16x32_bf16 a[20:23], v[44:47], v[164:167], a[20:23]
v_exp_f32 v97, v97
v_mfma_f32_16x16x32_bf16 a[52:55], v[40:43], v[168:171], a[52:55]
v_exp_f32 v98, v98
v_mfma_f32_16x16x32_bf16 a[52:55], v[44:47], v[172:175], a[52:55]
s_waitcnt lgkmcnt(2)
v_exp_f32 v99, v99
v_mfma_f32_16x16x32_bf16 a[24:27], v[48:51], v[160:163], a[24:27]
s_waitcnt vmcnt(10) lgkmcnt(0)
s_barrier
v_cvt_pk_bf16_f32 v132, v96, v97
v_cvt_pk_bf16_f32 v133, v98, v99
v_mfma_f32_16x16x32_bf16 a[24:27], v[52:55], v[164:167], a[24:27]
ds_read_b128 a[208:211], v3 offset:32768
v_mfma_f32_16x16x32_bf16 a[56:59], v[48:51], v[168:171], a[56:59]
ds_read_b128 a[212:215], v3 offset:33792
v_mfma_f32_16x16x32_bf16 a[56:59], v[52:55], v[172:175], a[56:59]
ds_read_b128 a[216:219], v3 offset:34816
v_mfma_f32_16x16x32_bf16 a[28:31], v[56:59], v[160:163], a[28:31]
ds_read_b128 a[220:223], v3 offset:35840
v_mfma_f32_16x16x32_bf16 a[28:31], v[60:63], v[164:167], a[28:31]
ds_read_b128 a[224:227], v3 offset:36864
v_exp_f32 v100, v100
v_mfma_f32_16x16x32_bf16 a[60:63], v[56:59], v[168:171], a[60:63]
ds_read_b128 a[228:231], v3 offset:37888
v_mfma_f32_16x16x32_bf16 a[60:63], v[60:63], v[172:175], a[60:63]
ds_read_b128 a[232:235], v3 offset:38912
v_exp_f32 v101, v101
v_mfma_f32_16x16x32_bf16 a[128:131], v[28:31], v[160:163], a[128:131]
ds_read_b128 a[236:239], v3 offset:39936
v_mfma_f32_16x16x32_bf16 a[128:131], v[28:31], v[164:167], a[128:131]
v_exp_f32 v102, v102
v_mfma_f32_16x16x32_bf16 a[132:135], v[28:31], v[168:171], a[132:135]
v_exp_f32 v103, v103
v_mfma_f32_16x16x32_bf16 a[132:135], v[28:31], v[172:175], a[132:135]
v_cvt_pk_bf16_f32 v140, v100, v101
v_cvt_pk_bf16_f32 v141, v102, v103
L_att_SSm1:
v_add_f32 v208, v224, v196
v_add_f32 v209, v225, v196
v_add_f32 v210, v226, v196
v_add_f32 v211, v227, v196
v_add_f32 v212, v228, v196
v_add_f32 v213, v229, v196
v_add_f32 v214, v230, v196
s_nop 1
s_waitcnt lgkmcnt(4)
v_mfma_f32_16x16x32_bf16 v[68:71], a[208:211], a[160:163], v[208:211]
ds_read_b128 a[240:243], v3 offset:49152
v_add_f32 v215, v231, v196
v_mfma_f32_16x16x32_bf16 v[68:71], a[212:215], a[164:167], v[68:71]
ds_read_b128 a[244:247], v3 offset:50176
v_add_f32 v216, v232, v196
v_mfma_f32_16x16x32_bf16 v[68:71], a[216:219], a[168:171], v[68:71]
ds_read_b128 a[248:251], v3 offset:51200
v_add_f32 v217, v233, v196
v_mfma_f32_16x16x32_bf16 v[68:71], a[220:223], a[172:175], v[68:71]
s_waitcnt lgkmcnt(3)
ds_read_b128 a[252:255], v3 offset:52224
v_add_f32 v218, v234, v196
v_mfma_f32_16x16x32_bf16 v[84:87], a[224:227], a[160:163], v[212:215]
ds_read_b128 v[240:243], v3 offset:53248
v_add_f32 v219, v235, v196
v_exp_f32 v116, v116
v_mfma_f32_16x16x32_bf16 v[84:87], a[228:231], a[164:167], v[84:87]
ds_read_b128 v[244:247], v3 offset:54272
v_add_f32 v220, v236, v196
v_exp_f32 v117, v117
v_mfma_f32_16x16x32_bf16 v[84:87], a[232:235], a[168:171], v[84:87]
ds_read_b128 v[248:251], v3 offset:55296
v_add_f32 v221, v237, v196
v_exp_f32 v118, v118
v_mfma_f32_16x16x32_bf16 v[84:87], a[236:239], a[172:175], v[84:87]
s_waitcnt lgkmcnt(3)
ds_read_b128 v[252:255], v3 offset:56320
v_add_f32 v222, v238, v196
v_exp_f32 v119, v119
v_mfma_f32_16x16x32_bf16 v[100:103], a[240:243], a[160:163], v[216:219]
ds_read_b128 v[32:35], v3 offset:8192
v_add_f32 v223, v239, v196
v_cvt_pk_bf16_f32 v142, v116, v117
v_mfma_f32_16x16x32_bf16 v[100:103], a[244:247], a[164:167], v[100:103]
ds_read_b128 v[36:39], v3 offset:24576
v_cvt_pk_bf16_f32 v143, v118, v119
v_exp_f32 v112, v112
v_exp_f32 v113, v113
v_exp_f32 v114, v114
v_mfma_f32_16x16x32_bf16 v[100:103], a[248:251], a[168:171], v[100:103]
ds_read_b128 v[40:43], v3 offset:9216
v_exp_f32 v115, v115
v_mfma_f32_16x16x32_bf16 v[100:103], a[252:255], a[172:175], v[100:103]
s_waitcnt lgkmcnt(3)
ds_read_b128 v[44:47], v3 offset:25600
v_cvt_pk_bf16_f32 v134, v112, v113
v_mfma_f32_16x16x32_bf16 v[116:119], v[240:243], a[160:163], v[220:223]
ds_read_b128 v[48:51], v3 offset:10240
v_cvt_pk_bf16_f32 v135, v114, v115
v_mfma_f32_16x16x32_bf16 v[116:119], v[244:247], a[164:167], v[116:119]
ds_read_b128 v[52:55], v3 offset:26624
v_mfma_f32_16x16x32_bf16 v[116:119], v[248:251], a[168:171], v[116:119]
s_mov_b32 m0, s25
s_mov_b32 s26, s24
buffer_load_dwordx4 v2, s[40:43], s26 offen lds
v_mfma_f32_16x16x32_bf16 v[116:119], v[252:255], a[172:175], v[116:119]
s_waitcnt lgkmcnt(4)
buffer_load_dwordx4 v2, s[40:43], s26 offen offset:1024 lds
v_mfma_f32_16x16x32_bf16 a[0:3], v[32:35], v[128:131], a[0:3]
ds_read_b128 v[56:59], v3 offset:11264
v_mfma_f32_16x16x32_bf16 a[0:3], v[36:39], v[132:135], a[0:3]
buffer_load_dwordx4 v2, s[40:43], s26 offen offset:2048 lds
v_mfma_f32_16x16x32_bf16 a[32:35], v[32:35], v[136:139], a[32:35]
ds_read_b128 v[60:63], v3 offset:27648
v_mfma_f32_16x16x32_bf16 a[32:35], v[36:39], v[140:143], a[32:35]
s_waitcnt lgkmcnt(4)
buffer_load_dwordx4 v2, s[40:43], s26 offen offset:3072 lds
v_mfma_f32_16x16x32_bf16 a[4:7], v[40:43], v[128:131], a[4:7]
ds_read_b128 v[32:35], v3 offset:12288
v_mfma_f32_16x16x32_bf16 a[4:7], v[44:47], v[132:135], a[4:7]
s_add_u32 m0, m0, 4096
s_add_u32 s26, s26, 4096
buffer_load_dwordx4 v2, s[40:43], s26 offen lds
v_mfma_f32_16x16x32_bf16 a[36:39], v[40:43], v[136:139], a[36:39]
ds_read_b128 v[36:39], v3 offset:28672
v_mfma_f32_16x16x32_bf16 a[36:39], v[44:47], v[140:143], a[36:39]
s_waitcnt lgkmcnt(4)
buffer_load_dwordx4 v2, s[40:43], s26 offen offset:1024 lds
v_mfma_f32_16x16x32_bf16 a[8:11], v[48:51], v[128:131], a[8:11]
ds_read_b128 v[40:43], v3 offset:13312
v_exp_f32 v68, v68
v_mfma_f32_16x16x32_bf16 a[8:11], v[52:55], v[132:135], a[8:11]
v_exp_f32 v69, v69
v_mfma_f32_16x16x32_bf16 a[40:43], v[48:51], v[136:139], a[40:43]
ds_read_b128 v[44:47], v3 offset:29696
v_mfma_f32_16x16x32_bf16 a[40:43], v[52:55], v[140:143], a[40:43]
s_waitcnt lgkmcnt(4)
buffer_load_dwordx4 v2, s[40:43], s26 offen offset:2048 lds
v_mfma_f32_16x16x32_bf16 a[12:15], v[56:59], v[128:131], a[12:15]
ds_read_b128 v[48:51], v3 offset:14336
v_exp_f32 v70, v70
v_mfma_f32_16x16x32_bf16 a[12:15], v[60:63], v[132:135], a[12:15]
v_exp_f32 v71, v71
v_mfma_f32_16x16x32_bf16 a[44:47], v[56:59], v[136:139], a[44:47]
ds_read_b128 v[52:55], v3 offset:30720
v_cvt_pk_bf16_f32 v168, v68, v69
v_mfma_f32_16x16x32_bf16 a[44:47], v[60:63], v[140:143], a[44:47]
s_waitcnt lgkmcnt(4)
buffer_load_dwordx4 v2, s[40:43], s26 offen offset:3072 lds
s_add_u32 s24, s24, 32768
s_add_u32 s25, s25, 32768
s_and_b32 s25, s25, 0x1ffff
v_cvt_pk_bf16_f32 v169, v70, v71
v_mfma_f32_16x16x32_bf16 a[16:19], v[32:35], v[128:131], a[16:19]
ds_read_b128 v[56:59], v3 offset:15360
v_mfma_f32_16x16x32_bf16 a[16:19], v[36:39], v[132:135], a[16:19]
v_exp_f32 v84, v84
v_mfma_f32_16x16x32_bf16 a[48:51], v[32:35], v[136:139], a[48:51]
ds_read_b128 v[60:63], v3 offset:31744
v_mfma_f32_16x16x32_bf16 a[48:51], v[36:39], v[140:143], a[48:51]
s_waitcnt lgkmcnt(4)
v_exp_f32 v85, v85
v_mfma_f32_16x16x32_bf16 a[20:23], v[40:43], v[128:131], a[20:23]
v_exp_f32 v86, v86
v_mfma_f32_16x16x32_bf16 a[20:23], v[44:47], v[132:135], a[20:23]
v_exp_f32 v87, v87
v_mfma_f32_16x16x32_bf16 a[52:55], v[40:43], v[136:139], a[52:55]
v_cvt_pk_bf16_f32 v170, v84, v85
v_cvt_pk_bf16_f32 v171, v86, v87
v_mfma_f32_16x16x32_bf16 a[52:55], v[44:47], v[140:143], a[52:55]
s_waitcnt lgkmcnt(2)
v_exp_f32 v100, v100
v_mfma_f32_16x16x32_bf16 a[24:27], v[48:51], v[128:131], a[24:27]
s_waitcnt vmcnt(8) lgkmcnt(0)
s_barrier
v_exp_f32 v101, v101
v_mfma_f32_16x16x32_bf16 a[24:27], v[52:55], v[132:135], a[24:27]
ds_read_b128 a[208:211], v4
v_mfma_f32_16x16x32_bf16 a[56:59], v[48:51], v[136:139], a[56:59]
ds_read_b128 a[212:215], v4 offset:1024
v_mfma_f32_16x16x32_bf16 a[56:59], v[52:55], v[140:143], a[56:59]
ds_read_b128 a[216:219], v4 offset:2048
v_mfma_f32_16x16x32_bf16 a[28:31], v[56:59], v[128:131], a[28:31]
ds_read_b128 a[220:223], v4 offset:3072
v_mfma_f32_16x16x32_bf16 a[28:31], v[60:63], v[132:135], a[28:31]
ds_read_b128 a[224:227], v4 offset:4096
v_mfma_f32_16x16x32_bf16 a[60:63], v[56:59], v[136:139], a[60:63]
ds_read_b128 a[228:231], v4 offset:5120
v_mfma_f32_16x16x32_bf16 a[60:63], v[60:63], v[140:143], a[60:63]
ds_read_b128 a[232:235], v4 offset:6144
v_mfma_f32_16x16x32_bf16 a[128:131], v[28:31], v[128:131], a[128:131]
ds_read_b128 a[236:239], v4 offset:7168
v_exp_f32 v102, v102
v_mfma_f32_16x16x32_bf16 a[128:131], v[28:31], v[132:135], a[128:131]
v_exp_f32 v103, v103
v_mfma_f32_16x16x32_bf16 a[132:135], v[28:31], v[136:139], a[132:135]
v_cvt_pk_bf16_f32 v172, v100, v101
v_cvt_pk_bf16_f32 v173, v102, v103
v_mfma_f32_16x16x32_bf16 a[132:135], v[28:31], v[140:143], a[132:135]
v_xor_b32 v3, 0x10000, v3
v_xor_b32 v4, 0x10000, v4
ds_read_b128 v[32:35], v4 offset:40960
ds_read_b128 v[36:39], v4 offset:57344
ds_read_b128 v[40:43], v4 offset:41984
ds_read_b128 v[44:47], v4 offset:58368
ds_read_b128 v[48:51], v4 offset:43008
ds_read_b128 v[52:55], v4 offset:59392
ds_read_b128 v[56:59], v4 offset:44032
ds_read_b128 v[60:63], v4 offset:60416
v_exp_f32 v116, v116
v_exp_f32 v117, v117
v_exp_f32 v118, v118
v_exp_f32 v119, v119
v_cvt_pk_bf16_f32 v174, v116, v117
v_cvt_pk_bf16_f32 v175, v118, v119
s_nop 1
s_waitcnt lgkmcnt(7)
v_mfma_f32_16x16x32_bf16 a[32:35], v[32:35], v[168:171], a[32:35]
s_waitcnt lgkmcnt(6)
v_mfma_f32_16x16x32_bf16 a[32:35], v[36:39], v[172:175], a[32:35]
s_waitcnt lgkmcnt(5)
ds_read_b128 v[32:35], v4 offset:45056
v_mfma_f32_16x16x32_bf16 a[36:39], v[40:43], v[168:171], a[36:39]
s_waitcnt lgkmcnt(5)
ds_read_b128 v[36:39], v4 offset:61440
v_mfma_f32_16x16x32_bf16 a[36:39], v[44:47], v[172:175], a[36:39]
s_waitcnt lgkmcnt(5)
ds_read_b128 v[40:43], v4 offset:46080
v_mfma_f32_16x16x32_bf16 a[40:43], v[48:51], v[168:171], a[40:43]
s_waitcnt lgkmcnt(5)
ds_read_b128 v[44:47], v4 offset:62464
v_mfma_f32_16x16x32_bf16 a[40:43], v[52:55], v[172:175], a[40:43]
s_waitcnt lgkmcnt(5)
ds_read_b128 v[48:51], v4 offset:47104
v_mfma_f32_16x16x32_bf16 a[44:47], v[56:59], v[168:171], a[44:47]
s_waitcnt lgkmcnt(5)
ds_read_b128 v[52:55], v4 offset:63488
v_mfma_f32_16x16x32_bf16 a[44:47], v[60:63], v[172:175], a[44:47]
s_waitcnt lgkmcnt(5)
ds_read_b128 v[56:59], v4 offset:48128
v_mfma_f32_16x16x32_bf16 a[48:51], v[32:35], v[168:171], a[48:51]
s_waitcnt lgkmcnt(5)
ds_read_b128 v[60:63], v4 offset:64512
v_mfma_f32_16x16x32_bf16 a[48:51], v[36:39], v[172:175], a[48:51]
s_waitcnt lgkmcnt(5)
v_mfma_f32_16x16x32_bf16 a[52:55], v[40:43], v[168:171], a[52:55]
s_waitcnt lgkmcnt(4)
v_mfma_f32_16x16x32_bf16 a[52:55], v[44:47], v[172:175], a[52:55]
s_waitcnt lgkmcnt(3)
v_mfma_f32_16x16x32_bf16 a[56:59], v[48:51], v[168:171], a[56:59]
s_waitcnt lgkmcnt(2)
v_mfma_f32_16x16x32_bf16 a[56:59], v[52:55], v[172:175], a[56:59]
s_waitcnt lgkmcnt(1)
v_mfma_f32_16x16x32_bf16 a[60:63], v[56:59], v[168:171], a[60:63]
s_waitcnt lgkmcnt(0)
v_mfma_f32_16x16x32_bf16 a[60:63], v[60:63], v[172:175], a[60:63]
v_mfma_f32_16x16x32_bf16 a[132:135], v[28:31], v[168:171], a[132:135]
v_mfma_f32_16x16x32_bf16 a[132:135], v[28:31], v[172:175], a[132:135]
v_mov_b32 v12, 0x57800000
s_nop 7
v_accvgpr_read_b32 v11, a128
s_nop 0
v_cmp_nlt_f32 vcc, v11, v12
v_rcp_f32 v11, v11
s_nop 2
s_cmp_lg_u64 vcc, 0
s_cselect_b32 s27, 1, 0
s_or_b32 s32, s32, s27
v_accvgpr_read_b32 v13, a0
v_accvgpr_read_b32 v14, a1
v_accvgpr_read_b32 v15, a2
v_accvgpr_read_b32 v16, a3
v_accvgpr_read_b32 v17, a4
v_accvgpr_read_b32 v18, a5
v_accvgpr_read_b32 v19, a6
v_accvgpr_read_b32 v20, a7
v_mul_f32 v13, v13, v11
v_mul_f32 v14, v14, v11
v_mul_f32 v15, v15, v11
v_mul_f32 v16, v16, v11
v_mul_f32 v17, v17, v11
v_mul_f32 v18, v18, v11
v_mul_f32 v19, v19, v11
v_mul_f32 v20, v20, v11
v_cvt_pk_bf16_f32 v208, v13, v14
v_cvt_pk_bf16_f32 v209, v15, v16
v_cvt_pk_bf16_f32 v210, v17, v18
v_cvt_pk_bf16_f32 v211, v19, v20
buffer_store_dwordx4 v[208:211], v2, s[48:51], s56 offen sc1
v_accvgpr_read_b32 v216, a8
v_accvgpr_read_b32 v217, a9
v_accvgpr_read_b32 v218, a10
v_accvgpr_read_b32 v219, a11
v_accvgpr_read_b32 v220, a12
v_accvgpr_read_b32 v221, a13
v_accvgpr_read_b32 v222, a14
v_accvgpr_read_b32 v223, a15
v_mul_f32 v216, v216, v11
v_mul_f32 v217, v217, v11
v_mul_f32 v218, v218, v11
v_mul_f32 v219, v219, v11
v_mul_f32 v220, v220, v11
v_mul_f32 v221, v221, v11
v_mul_f32 v222, v222, v11
v_mul_f32 v223, v223, v11
v_cvt_pk_bf16_f32 v212, v216, v217
v_cvt_pk_bf16_f32 v213, v218, v219
v_cvt_pk_bf16_f32 v214, v220, v221
v_cvt_pk_bf16_f32 v215, v222, v223
buffer_store_dwordx4 v[212:215], v2, s[48:51], s56 offen offset:1024 sc1
v_accvgpr_read_b32 v13, a16
v_accvgpr_read_b32 v14, a17
v_accvgpr_read_b32 v15, a18
v_accvgpr_read_b32 v16, a19
v_accvgpr_read_b32 v17, a20
v_accvgpr_read_b32 v18, a21
v_accvgpr_read_b32 v19, a22
v_accvgpr_read_b32 v20, a23
v_mul_f32 v13, v13, v11
v_mul_f32 v14, v14, v11
v_mul_f32 v15, v15, v11
v_mul_f32 v16, v16, v11
v_mul_f32 v17, v17, v11
v_mul_f32 v18, v18, v11
v_mul_f32 v19, v19, v11
v_mul_f32 v20, v20, v11
v_cvt_pk_bf16_f32 v208, v13, v14
v_cvt_pk_bf16_f32 v209, v15, v16
v_cvt_pk_bf16_f32 v210, v17, v18
v_cvt_pk_bf16_f32 v211, v19, v20
buffer_store_dwordx4 v[208:211], v2, s[48:51], s56 offen offset:2048 sc1
v_accvgpr_read_b32 v216, a24
v_accvgpr_read_b32 v217, a25
v_accvgpr_read_b32 v218, a26
v_accvgpr_read_b32 v219, a27
v_accvgpr_read_b32 v220, a28
v_accvgpr_read_b32 v221, a29
v_accvgpr_read_b32 v222, a30
v_accvgpr_read_b32 v223, a31
v_mul_f32 v216, v216, v11
v_mul_f32 v217, v217, v11
v_mul_f32 v218, v218, v11
v_mul_f32 v219, v219, v11
v_mul_f32 v220, v220, v11
v_mul_f32 v221, v221, v11
v_mul_f32 v222, v222, v11
v_mul_f32 v223, v223, v11
v_cvt_pk_bf16_f32 v212, v216, v217
v_cvt_pk_bf16_f32 v213, v218, v219
v_cvt_pk_bf16_f32 v214, v220, v221
v_cvt_pk_bf16_f32 v215, v222, v223
buffer_store_dwordx4 v[212:215], v2, s[48:51], s56 offen offset:3072 sc1
v_accvgpr_read_b32 v11, a132
s_nop 0
v_cmp_nlt_f32 vcc, v11, v12
v_rcp_f32 v11, v11
s_nop 2
s_cmp_lg_u64 vcc, 0
s_cselect_b32 s27, 2, 0
s_or_b32 s32, s32, s27
v_accvgpr_read_b32 v13, a32
v_accvgpr_read_b32 v14, a33
v_accvgpr_read_b32 v15, a34
v_accvgpr_read_b32 v16, a35
v_accvgpr_read_b32 v17, a36
v_accvgpr_read_b32 v18, a37
v_accvgpr_read_b32 v19, a38
v_accvgpr_read_b32 v20, a39
v_mul_f32 v13, v13, v11
v_mul_f32 v14, v14, v11
v_mul_f32 v15, v15, v11
v_mul_f32 v16, v16, v11
v_mul_f32 v17, v17, v11
v_mul_f32 v18, v18, v11
v_mul_f32 v19, v19, v11
v_mul_f32 v20, v20, v11
v_cvt_pk_bf16_f32 v208, v13, v14
v_cvt_pk_bf16_f32 v209, v15, v16
v_cvt_pk_bf16_f32 v210, v17, v18
v_cvt_pk_bf16_f32 v211, v19, v20
buffer_store_dwordx4 v[208:211], v2, s[48:51], s57 offen sc1
v_accvgpr_read_b32 v216, a40
v_accvgpr_read_b32 v217, a41
v_accvgpr_read_b32 v218, a42
v_accvgpr_read_b32 v219, a43
v_accvgpr_read_b32 v220, a44
v_accvgpr_read_b32 v221, a45
v_accvgpr_read_b32 v222, a46
v_accvgpr_read_b32 v223, a47
v_mul_f32 v216, v216, v11
v_mul_f32 v217, v217, v11
v_mul_f32 v218, v218, v11
v_mul_f32 v219, v219, v11
v_mul_f32 v220, v220, v11
v_mul_f32 v221, v221, v11
v_mul_f32 v222, v222, v11
v_mul_f32 v223, v223, v11
v_cvt_pk_bf16_f32 v212, v216, v217
v_cvt_pk_bf16_f32 v213, v218, v219
v_cvt_pk_bf16_f32 v214, v220, v221
v_cvt_pk_bf16_f32 v215, v222, v223
buffer_store_dwordx4 v[212:215], v2, s[48:51], s57 offen offset:1024 sc1
v_accvgpr_read_b32 v13, a48
v_accvgpr_read_b32 v14, a49
v_accvgpr_read_b32 v15, a50
v_accvgpr_read_b32 v16, a51
v_accvgpr_read_b32 v17, a52
v_accvgpr_read_b32 v18, a53
v_accvgpr_read_b32 v19, a54
v_accvgpr_read_b32 v20, a55
v_mul_f32 v13, v13, v11
v_mul_f32 v14, v14, v11
v_mul_f32 v15, v15, v11
v_mul_f32 v16, v16, v11
v_mul_f32 v17, v17, v11
v_mul_f32 v18, v18, v11
v_mul_f32 v19, v19, v11
v_mul_f32 v20, v20, v11
v_cvt_pk_bf16_f32 v208, v13, v14
v_cvt_pk_bf16_f32 v209, v15, v16
v_cvt_pk_bf16_f32 v210, v17, v18
v_cvt_pk_bf16_f32 v211, v19, v20
buffer_store_dwordx4 v[208:211], v2, s[48:51], s57 offen offset:2048 sc1
v_accvgpr_read_b32 v216, a56
v_accvgpr_read_b32 v217, a57
v_accvgpr_read_b32 v218, a58
v_accvgpr_read_b32 v219, a59
v_accvgpr_read_b32 v220, a60
v_accvgpr_read_b32 v221, a61
v_accvgpr_read_b32 v222, a62
v_accvgpr_read_b32 v223, a63
v_mul_f32 v216, v216, v11
v_mul_f32 v217, v217, v11
v_mul_f32 v218, v218, v11
v_mul_f32 v219, v219, v11
v_mul_f32 v220, v220, v11
v_mul_f32 v221, v221, v11
v_mul_f32 v222, v222, v11
v_mul_f32 v223, v223, v11
v_cvt_pk_bf16_f32 v212, v216, v217
v_cvt_pk_bf16_f32 v213, v218, v219
v_cvt_pk_bf16_f32 v214, v220, v221
v_cvt_pk_bf16_f32 v215, v222, v223
buffer_store_dwordx4 v[212:215], v2, s[48:51], s57 offen offset:3072 sc1
s_cmp_eq_u32 s32, 0
s_cbranch_scc1 L_att_fin
s_waitcnt vmcnt(0)
s_mov_b32 s39, 0
L_att_fbloop:
s_lshr_b32 s26, s32, s39
s_bitcmp1_b32 s26, 0
s_cbranch_scc1 L_att_slow
L_att_slowret:
s_add_u32 s39, s39, 1
s_cmp_lt_u32 s39, 4
s_cbranch_scc1 L_att_fbloop
L_att_fin:
s_load_dwordx2 s[60:61], s[0:1], 96
s_load_dwordx2 s[62:63], s[0:1], 40
s_load_dwordx2 s[64:65], s[0:1], 72
s_load_dwordx2 s[66:67], s[0:1], 0
s_load_dwordx2 s[68:69], s[0:1], 80
v_and_b32 v1, 63, v0
v_add_u32 v15, 0, v1
v_mul_u32_u24 v16, 3641, v15
v_lshrrev_b32 v16, 16, v16
v_mul_u32_u24 v17, 18, v16
v_sub_u32 v17, v15, v17
v_mul_u32_u24 v16, 1152, v16
v_lshl_add_u32 v6, v17, 4, v16
v_add_u32 v15, 64, v1
v_mul_u32_u24 v16, 3641, v15
v_lshrrev_b32 v16, 16, v16
v_mul_u32_u24 v17, 18, v16
v_sub_u32 v17, v15, v17
v_mul_u32_u24 v16, 1152, v16
v_lshl_add_u32 v7, v17, 4, v16
v_add_u32 v15, 128, v1
v_mul_u32_u24 v16, 3641, v15
v_lshrrev_b32 v16, 16, v16
v_mul_u32_u24 v17, 18, v16
v_sub_u32 v17, v15, v17
v_mul_u32_u24 v16, 1152, v16
v_lshl_add_u32 v8, v17, 4, v16
v_add_u32 v15, 192, v1
v_mul_u32_u24 v16, 3641, v15
v_lshrrev_b32 v16, 16, v16
v_mul_u32_u24 v17, 18, v16
v_sub_u32 v17, v15, v17
v_mul_u32_u24 v16, 1152, v16
v_lshl_add_u32 v9, v17, 4, v16
v_add_u32 v15, 256, v1
v_mul_u32_u24 v16, 3641, v15
v_lshrrev_b32 v16, 16, v16
v_mul_u32_u24 v17, 18, v16
v_sub_u32 v17, v15, v17
v_mul_u32_u24 v16, 1152, v16
v_lshl_add_u32 v10, v17, 4, v16
v_add_u32 v15, 320, v1
v_mul_u32_u24 v16, 3641, v15
v_lshrrev_b32 v16, 16, v16
v_mul_u32_u24 v17, 18, v16
v_sub_u32 v17, v15, v17
v_mul_u32_u24 v16, 1152, v16
v_lshl_add_u32 v11, v17, 4, v16
v_add_u32 v15, 384, v1
v_mul_u32_u24 v16, 3641, v15
v_lshrrev_b32 v16, 16, v16
v_mul_u32_u24 v17, 18, v16
v_sub_u32 v17, v15, v17
v_mul_u32_u24 v16, 1152, v16
v_lshl_add_u32 v12, v17, 4, v16
v_add_u32 v15, 448, v1
v_mul_u32_u24 v16, 3641, v15
v_lshrrev_b32 v16, 16, v16
v_mul_u32_u24 v17, 18, v16
v_sub_u32 v17, v15, v17
v_mul_u32_u24 v16, 1152, v16
v_lshl_add_u32 v13, v17, 4, v16
v_add_u32 v15, 512, v1
v_mul_u32_u24 v16, 3641, v15
v_lshrrev_b32 v16, 16, v16
v_mul_u32_u24 v17, 18, v16
v_sub_u32 v17, v15, v17
v_mul_u32_u24 v16, 1152, v16
v_lshl_add_u32 v14, v17, 4, v16
v_lshrrev_b32 v15, 2, v1
v_mul_u32_u24 v15, 288, v15
v_and_b32 v16, 3, v1
v_lshl_add_u32 v28, v16, 3, v15
v_add_u32 v29, 36864, v28
v_add_u32 v30, 73728, v28
v_add_u32 v31, 110592, v28
s_waitcnt lgkmcnt(0)
s_barrier
s_add_u32 s72, s60, 0x6d00000
s_addc_u32 s73, s61, 0
s_mov_b32 s74, 0x3000
s_mov_b32 s75, 0x20000
s_lshr_b32 s27, s21, 2
s_lshr_b32 s96, s22, 1
s_lshl_b32 s96, s96, 3
s_add_u32 s96, s96, s27
s_lshl_b32 s96, s96, 7
s_sub_u32 s97, 15, s22
s_lshr_b32 s97, s97, 1
s_lshl_b32 s97, s97, 3
s_add_u32 s97, s97, s27
s_lshl_b32 s97, s97, 7
s_and_b32 s36, s2, 7
s_lshr_b32 s28, s2, 3
s_and_b32 s38, s28, 3
s_lshr_b32 s28, s2, 5
s_and_b32 s29, s36, 4
s_xor_b32 s37, s28, s29
s_and_b32 s28, s28, 4
s_and_b32 s39, s36, 3
s_or_b32 s39, s39, s28
s_mov_b32 s44, s62
s_mov_b32 s45, s63
s_mov_b32 s46, 0x480000
s_mov_b32 s47, 0x20000
s_mov_b32 s40, s64
s_mov_b32 s41, s65
s_mov_b32 s42, 0x510000
s_mov_b32 s43, 0x20000
s_add_u32 s48, s60, 0x3800000
s_addc_u32 s49, s61, 0
s_mov_b32 s50, 0x1200000
s_mov_b32 s51, 0x20000
s_add_u32 s52, s60, 0x4a00000
s_addc_u32 s53, s61, 0
s_mov_b32 s54, 0x1000000
s_mov_b32 s55, 0x20000
s_add_u32 s56, s60, 0x5a00000
s_addc_u32 s57, s61, 0
s_mov_b32 s58, 0x1200000
s_mov_b32 s59, 0x20000
s_lshl_b32 s27, s36, 2
s_mul_i32 s28, s39, 5
s_sub_u32 s28, s28, 4
s_lshl_b32 s29, s39, 2
s_cmp_lt_u32 s39, 4
s_cselect_b32 s28, s29, s28
s_mul_i32 s29, s38, 288
s_mul_i32 s30, s20, 36864
s_add_u32 s29, s29, s30
s_mul_i32 s25, s28, 147456
s_add_u32 s25, s25, s29
s_mul_i32 s26, s27, 147456
s_add_u32 s26, s26, s29
s_mul_i32 s24, s20, 9216
s_lshl_b32 s29, s37, 4
s_lshl_b32 s30, s20, 2
s_add_u32 s29, s29, s30
s_add_u32 s30, s29, 0
s_mul_i32 s32, s30, 147456
s_lshl_b32 s31, s28, 12
s_add_u32 s32, s32, s31
s_lshl_b32 s12, s30, 17
s_lshl_b32 s31, s27, 12
s_add_u32 s12, s12, s31
s_add_u32 s30, s29, 1
s_mul_i32 s33, s30, 147456
s_lshl_b32 s31, s28, 12
s_add_u32 s33, s33, s31
s_lshl_b32 s13, s30, 17
s_lshl_b32 s31, s27, 12
s_add_u32 s13, s13, s31
s_add_u32 s30, s29, 2
s_mul_i32 s34, s30, 147456
s_lshl_b32 s31, s28, 12
s_add_u32 s34, s34, s31
s_lshl_b32 s14, s30, 17
s_lshl_b32 s31, s27, 12
s_add_u32 s14, s14, s31
s_add_u32 s30, s29, 3
s_mul_i32 s35, s30, 147456
s_lshl_b32 s31, s28, 12
s_add_u32 s35, s35, s31
s_lshl_b32 s15, s30, 17
s_lshl_b32 s31, s27, 12
s_add_u32 s15, s15, s31
s_lshl_b32 s70, s37, 3
s_lshl_b32 s30, s20, 1
s_add_u32 s70, s70, s30
s_mul_i32 s70, s70, 36
s_mul_i32 s30, s38, 9
s_add_u32 s70, s70, s30
s_lshl_b32 s70, s70, 10
s_mul_i32 s30, s36, 2359296
s_add_u32 s70, s70, s30
s_lshl_b32 s30, s37, 3
s_add_u32 s30, s30, s36
s_lshl_b32 s30, s30, 7
v_mov_b32 v23, s30
s_add_u32 m0, s24, 0
s_add_u32 s21, s25, 0
buffer_load_dwordx4 v6, s[40:43], s21 offen lds
s_add_u32 m0, m0, 1024
s_nop 0
buffer_load_dwordx4 v7, s[40:43], s21 offen lds
s_add_u32 m0, m0, 1024
s_nop 0
buffer_load_dwordx4 v8, s[40:43], s21 offen lds
s_add_u32 m0, m0, 1024
s_nop 0
buffer_load_dwordx4 v9, s[40:43], s21 offen lds
s_add_u32 m0, m0, 1024
s_nop 0
buffer_load_dwordx4 v10, s[40:43], s21 offen lds
s_add_u32 m0, m0, 1024
s_nop 0
buffer_load_dwordx4 v11, s[40:43], s21 offen lds
s_add_u32 m0, m0, 1024
s_nop 0
buffer_load_dwordx4 v12, s[40:43], s21 offen lds
s_add_u32 m0, m0, 1024
s_nop 0
buffer_load_dwordx4 v13, s[40:43], s21 offen lds
s_add_u32 m0, m0, 1024
s_nop 0
buffer_load_dwordx4 v14, s[40:43], s21 offen lds
s_add_u32 s16, s32, 0
buffer_load_dwordx4 v[64:67], v2, s[48:51], s16 offen
buffer_load_dwordx4 v[68:71], v2, s[48:51], s16 offen offset:1024
buffer_load_dwordx4 v[72:75], v2, s[48:51], s16 offen offset:2048
buffer_load_dwordx4 v[76:79], v2, s[48:51], s16 offen offset:3072
s_add_u32 s17, s33, 0
buffer_load_dwordx4 v[80:83], v2, s[48:51], s17 offen
buffer_load_dwordx4 v[84:87], v2, s[48:51], s17 offen offset:1024
buffer_load_dwordx4 v[88:91], v2, s[48:51], s17 offen offset:2048
buffer_load_dwordx4 v[92:95], v2, s[48:51], s17 offen offset:3072
s_add_u32 s18, s34, 0
buffer_load_dwordx4 v[96:99], v2, s[48:51], s18 offen
buffer_load_dwordx4 v[100:103], v2, s[48:51], s18 offen offset:1024
buffer_load_dwordx4 v[104:107], v2, s[48:51], s18 offen offset:2048
buffer_load_dwordx4 v[108:111], v2, s[48:51], s18 offen offset:3072
s_add_u32 s19, s35, 0
buffer_load_dwordx4 v[112:115], v2, s[48:51], s19 offen
buffer_load_dwordx4 v[116:119], v2, s[48:51], s19 offen offset:1024
buffer_load_dwordx4 v[120:123], v2, s[48:51], s19 offen offset:2048
buffer_load_dwordx4 v[124:127], v2, s[48:51], s19 offen offset:3072
s_waitcnt vmcnt(16)
s_barrier
s_cmp_lg_u32 s20, 0
s_cbranch_scc1 L_ap_nosig
v_mov_b32 v15, s96
v_mov_b32 v16, s97
v_mov_b32 v17, 1
s_mov_b64 exec, 1
buffer_atomic_add v17, v15, s[72:75], 0 offen
buffer_atomic_add v17, v16, s[72:75], 0 offen
s_mov_b64 exec, -1
L_ap_nosig:
ds_read_b64_tr_b16 a[144:145], v28
ds_read_b64_tr_b16 a[146:147], v28 offset:4608
ds_read_b64_tr_b16 a[148:149], v28 offset:9216
ds_read_b64_tr_b16 a[150:151], v28 offset:13824
ds_read_b64_tr_b16 a[152:153], v28 offset:18432
ds_read_b64_tr_b16 a[154:155], v28 offset:23040
ds_read_b64_tr_b16 a[156:157], v28 offset:27648
ds_read_b64_tr_b16 a[158:159], v28 offset:32256
ds_read_b64_tr_b16 a[160:161], v28 offset:32
ds_read_b64_tr_b16 a[162:163], v28 offset:4640
ds_read_b64_tr_b16 a[164:165], v28 offset:9248
ds_read_b64_tr_b16 a[166:167], v28 offset:13856
ds_read_b64_tr_b16 a[168:169], v28 offset:18464
ds_read_b64_tr_b16 a[170:171], v28 offset:23072
ds_read_b64_tr_b16 a[172:173], v28 offset:27680
ds_read_b64_tr_b16 a[174:175], v28 offset:32288
s_cmp_ge_u32 s39, 4
s_cbranch_scc1 L_ap_path5
s_waitcnt vmcnt(12) lgkmcnt(8)
v_mfma_f32_16x16x32_bf16 a[0:3], a[144:147], v[64:67], 0
ds_read_b64_tr_b16 a[176:177], v28 offset:64
v_mfma_f32_16x16x32_bf16 a[0:3], a[148:151], v[68:71], a[0:3]
s_add_u32 m0, s24, 36864
s_add_u32 s21, s25, 147456
buffer_load_dwordx4 v6, s[40:43], s21 offen lds
v_mfma_f32_16x16x32_bf16 a[0:3], a[152:155], v[72:75], a[0:3]
ds_read_b64_tr_b16 a[178:179], v28 offset:4672
v_mfma_f32_16x16x32_bf16 a[0:3], a[156:159], v[76:79], a[0:3]
s_waitcnt vmcnt(9)
s_add_u32 m0, m0, 1024
s_nop 0
buffer_load_dwordx4 v7, s[40:43], s21 offen lds
v_mfma_f32_16x16x32_bf16 a[36:39], a[144:147], v[80:83], 0
ds_read_b64_tr_b16 a[180:181], v28 offset:9280
v_mfma_f32_16x16x32_bf16 a[36:39], a[148:151], v[84:87], a[36:39]
s_add_u32 m0, m0, 1024
s_nop 0
buffer_load_dwordx4 v8, s[40:43], s21 offen lds
v_mfma_f32_16x16x32_bf16 a[36:39], a[152:155], v[88:91], a[36:39]
ds_read_b64_tr_b16 a[182:183], v28 offset:13888
v_mfma_f32_16x16x32_bf16 a[36:39], a[156:159], v[92:95], a[36:39]
s_waitcnt vmcnt(7)
v_mfma_f32_16x16x32_bf16 a[72:75], a[144:147], v[96:99], 0
ds_read_b64_tr_b16 a[184:185], v28 offset:18496
v_mfma_f32_16x16x32_bf16 a[72:75], a[148:151], v[100:103], a[72:75]
s_add_u32 m0, m0, 1024
s_nop 0
buffer_load_dwordx4 v9, s[40:43], s21 offen lds
v_mfma_f32_16x16x32_bf16 a[72:75], a[152:155], v[104:107], a[72:75]
ds_read_b64_tr_b16 a[186:187], v28 offset:23104
v_mfma_f32_16x16x32_bf16 a[72:75], a[156:159], v[108:111], a[72:75]
s_waitcnt vmcnt(4)
s_add_u32 m0, m0, 1024
s_nop 0
buffer_load_dwordx4 v10, s[40:43], s21 offen lds
v_mfma_f32_16x16x32_bf16 a[108:111], a[144:147], v[112:115], 0
ds_read_b64_tr_b16 a[188:189], v28 offset:27712
v_mfma_f32_16x16x32_bf16 a[108:111], a[148:151], v[116:119], a[108:111]
s_add_u32 m0, m0, 1024
s_nop 0
buffer_load_dwordx4 v11, s[40:43], s21 offen lds
v_mfma_f32_16x16x32_bf16 a[108:111], a[152:155], v[120:123], a[108:111]
ds_read_b64_tr_b16 a[190:191], v28 offset:32320
v_mfma_f32_16x16x32_bf16 a[108:111], a[156:159], v[124:127], a[108:111]
s_waitcnt lgkmcnt(8)
s_add_u32 m0, m0, 1024
s_nop 0
buffer_load_dwordx4 v12, s[40:43], s21 offen lds
v_mfma_f32_16x16x32_bf16 a[4:7], a[160:163], v[64:67], 0
ds_read_b64_tr_b16 a[144:145], v28 offset:96
v_mfma_f32_16x16x32_bf16 a[4:7], a[164:167], v[68:71], a[4:7]
s_add_u32 m0, m0, 1024
s_nop 0
buffer_load_dwordx4 v13, s[40:43], s21 offen lds
v_mfma_f32_16x16x32_bf16 a[4:7], a[168:171], v[72:75], a[4:7]
ds_read_b64_tr_b16 a[146:147], v28 offset:4704
v_mfma_f32_16x16x32_bf16 a[4:7], a[172:175], v[76:79], a[4:7]
s_add_u32 m0, m0, 1024
s_nop 0
buffer_load_dwordx4 v14, s[40:43], s21 offen lds
v_mfma_f32_16x16x32_bf16 a[40:43], a[160:163], v[80:83], 0
ds_read_b64_tr_b16 a[148:149], v28 offset:9312
v_mfma_f32_16x16x32_bf16 a[40:43], a[164:167], v[84:87], a[40:43]
v_mfma_f32_16x16x32_bf16 a[40:43], a[168:171], v[88:91], a[40:43]
ds_read_b64_tr_b16 a[150:151], v28 offset:13920
v_mfma_f32_16x16x32_bf16 a[40:43], a[172:175], v[92:95], a[40:43]
s_add_u32 s16, s32, 4096
buffer_load_dwordx4 v[128:131], v2, s[48:51], s16 offen
v_mfma_f32_16x16x32_bf16 a[76:79], a[160:163], v[96:99], 0
ds_read_b64_tr_b16 a[152:153], v28 offset:18528
v_mfma_f32_16x16x32_bf16 a[76:79], a[164:167], v[100:103], a[76:79]
buffer_load_dwordx4 v[132:135], v2, s[48:51], s16 offen offset:1024
v_mfma_f32_16x16x32_bf16 a[76:79], a[168:171], v[104:107], a[76:79]
ds_read_b64_tr_b16 a[154:155], v28 offset:23136
v_mfma_f32_16x16x32_bf16 a[76:79], a[172:175], v[108:111], a[76:79]
buffer_load_dwordx4 v[136:139], v2, s[48:51], s16 offen offset:2048
v_mfma_f32_16x16x32_bf16 a[112:115], a[160:163], v[112:115], 0
ds_read_b64_tr_b16 a[156:157], v28 offset:27744
v_mfma_f32_16x16x32_bf16 a[112:115], a[164:167], v[116:119], a[112:115]
buffer_load_dwordx4 v[140:143], v2, s[48:51], s16 offen offset:3072
v_mfma_f32_16x16x32_bf16 a[112:115], a[168:171], v[120:123], a[112:115]
ds_read_b64_tr_b16 a[158:159], v28 offset:32352
v_mfma_f32_16x16x32_bf16 a[112:115], a[172:175], v[124:127], a[112:115]
s_waitcnt lgkmcnt(8)
s_add_u32 s17, s33, 4096
buffer_load_dwordx4 v[144:147], v2, s[48:51], s17 offen
v_mfma_f32_16x16x32_bf16 a[8:11], a[176:179], v[64:67], 0
ds_read_b64_tr_b16 a[160:161], v28 offset:128
v_mfma_f32_16x16x32_bf16 a[8:11], a[180:183], v[68:71], a[8:11]
buffer_load_dwordx4 v[148:151], v2, s[48:51], s17 offen offset:1024
v_mfma_f32_16x16x32_bf16 a[8:11], a[184:187], v[72:75], a[8:11]
ds_read_b64_tr_b16 a[162:163], v28 offset:4736
v_mfma_f32_16x16x32_bf16 a[8:11], a[188:191], v[76:79], a[8:11]
v_mfma_f32_16x16x32_bf16 a[44:47], a[176:179], v[80:83], 0
ds_read_b64_tr_b16 a[164:165], v28 offset:9344
v_mfma_f32_16x16x32_bf16 a[44:47], a[180:183], v[84:87], a[44:47]
buffer_load_dwordx4 v[152:155], v2, s[48:51], s17 offen offset:2048
v_mfma_f32_16x16x32_bf16 a[44:47], a[184:187], v[88:91], a[44:47]
ds_read_b64_tr_b16 a[166:167], v28 offset:13952
v_mfma_f32_16x16x32_bf16 a[44:47], a[188:191], v[92:95], a[44:47]
buffer_load_dwordx4 v[156:159], v2, s[48:51], s17 offen offset:3072
v_mfma_f32_16x16x32_bf16 a[80:83], a[176:179], v[96:99], 0
ds_read_b64_tr_b16 a[168:169], v28 offset:18560
v_mfma_f32_16x16x32_bf16 a[80:83], a[180:183], v[100:103], a[80:83]
s_add_u32 s18, s34, 4096
buffer_load_dwordx4 v[160:163], v2, s[48:51], s18 offen
v_mfma_f32_16x16x32_bf16 a[80:83], a[184:187], v[104:107], a[80:83]
ds_read_b64_tr_b16 a[170:171], v28 offset:23168
v_mfma_f32_16x16x32_bf16 a[80:83], a[188:191], v[108:111], a[80:83]
buffer_load_dwordx4 v[164:167], v2, s[48:51], s18 offen offset:1024
v_mfma_f32_16x16x32_bf16 a[116:119], a[176:179], v[112:115], 0
ds_read_b64_tr_b16 a[172:173], v28 offset:27776
v_mfma_f32_16x16x32_bf16 a[116:119], a[180:183], v[116:119], a[116:119]
buffer_load_dwordx4 v[168:171], v2, s[48:51], s18 offen offset:2048
v_mfma_f32_16x16x32_bf16 a[116:119], a[184:187], v[120:123], a[116:119]
ds_read_b64_tr_b16 a[174:175], v28 offset:32384
v_mfma_f32_16x16x32_bf16 a[116:119], a[188:191], v[124:127], a[116:119]
s_waitcnt lgkmcnt(8)
buffer_load_dwordx4 v[172:175], v2, s[48:51], s18 offen offset:3072
v_mfma_f32_16x16x32_bf16 a[12:15], a[144:147], v[64:67], 0
ds_read_b64_tr_b16 a[176:177], v28 offset:160
v_mfma_f32_16x16x32_bf16 a[12:15], a[148:151], v[68:71], a[12:15]
v_mfma_f32_16x16x32_bf16 a[12:15], a[152:155], v[72:75], a[12:15]
ds_read_b64_tr_b16 a[178:179], v28 offset:4768
v_mfma_f32_16x16x32_bf16 a[12:15], a[156:159], v[76:79], a[12:15]
s_add_u32 s19, s35, 4096
buffer_load_dwordx4 v[176:179], v2, s[48:51], s19 offen
v_mfma_f32_16x16x32_bf16 a[48:51], a[144:147], v[80:83], 0
ds_read_b64_tr_b16 a[180:181], v28 offset:9376
v_mfma_f32_16x16x32_bf16 a[48:51], a[148:151], v[84:87], a[48:51]
buffer_load_dwordx4 v[180:183], v2, s[48:51], s19 offen offset:1024
v_mfma_f32_16x16x32_bf16 a[48:51], a[152:155], v[88:91], a[48:51]
ds_read_b64_tr_b16 a[182:183], v28 offset:13984
v_mfma_f32_16x16x32_bf16 a[48:51], a[156:159], v[92:95], a[48:51]
buffer_load_dwordx4 v[184:187], v2, s[48:51], s19 offen offset:2048
v_mfma_f32_16x16x32_bf16 a[84:87], a[144:147], v[96:99], 0
ds_read_b64_tr_b16 a[184:185], v28 offset:18592
v_mfma_f32_16x16x32_bf16 a[84:87], a[148:151], v[100:103], a[84:87]
buffer_load_dwordx4 v[188:191], v2, s[48:51], s19 offen offset:3072
v_mfma_f32_16x16x32_bf16 a[84:87], a[152:155], v[104:107], a[84:87]
ds_read_b64_tr_b16 a[186:187], v28 offset:23200
v_mfma_f32_16x16x32_bf16 a[84:87], a[156:159], v[108:111], a[84:87]
s_add_u32 m0, s24, 73728
s_add_u32 s21, s25, 294912
buffer_load_dwordx4 v6, s[40:43], s21 offen lds
v_mfma_f32_16x16x32_bf16 a[120:123], a[144:147], v[112:115], 0
ds_read_b64_tr_b16 a[188:189], v28 offset:27808
v_mfma_f32_16x16x32_bf16 a[120:123], a[148:151], v[116:119], a[120:123]
s_add_u32 m0, m0, 1024
s_nop 0
buffer_load_dwordx4 v7, s[40:43], s21 offen lds
v_mfma_f32_16x16x32_bf16 a[120:123], a[152:155], v[120:123], a[120:123]
ds_read_b64_tr_b16 a[190:191], v28 offset:32416
v_mfma_f32_16x16x32_bf16 a[120:123], a[156:159], v[124:127], a[120:123]
s_waitcnt lgkmcnt(8)
v_mfma_f32_16x16x32_bf16 a[16:19], a[160:163], v[64:67], 0
ds_read_b64_tr_b16 a[144:145], v28 offset:192
v_mfma_f32_16x16x32_bf16 a[16:19], a[164:167], v[68:71], a[16:19]
s_add_u32 m0, m0, 1024
s_nop 0
buffer_load_dwordx4 v8, s[40:43], s21 offen lds
v_mfma_f32_16x16x32_bf16 a[16:19], a[168:171], v[72:75], a[16:19]
ds_read_b64_tr_b16 a[146:147], v28 offset:4800
v_mfma_f32_16x16x32_bf16 a[16:19], a[172:175], v[76:79], a[16:19]
s_add_u32 m0, m0, 1024
s_nop 0
buffer_load_dwordx4 v9, s[40:43], s21 offen lds
v_mfma_f32_16x16x32_bf16 a[52:55], a[160:163], v[80:83], 0
ds_read_b64_tr_b16 a[148:149], v28 offset:9408
v_mfma_f32_16x16x32_bf16 a[52:55], a[164:167], v[84:87], a[52:55]
s_add_u32 m0, m0, 1024
s_nop 0
buffer_load_dwordx4 v10, s[40:43], s21 offen lds
v_mfma_f32_16x16x32_bf16 a[52:55], a[168:171], v[88:91], a[52:55]
ds_read_b64_tr_b16 a[150:151], v28 offset:14016
v_mfma_f32_16x16x32_bf16 a[52:55], a[172:175], v[92:95], a[52:55]
s_add_u32 m0, m0, 1024
s_nop 0
buffer_load_dwordx4 v11, s[40:43], s21 offen lds
v_mfma_f32_16x16x32_bf16 a[88:91], a[160:163], v[96:99], 0
ds_read_b64_tr_b16 a[152:153], v28 offset:18624
v_mfma_f32_16x16x32_bf16 a[88:91], a[164:167], v[100:103], a[88:91]
s_add_u32 m0, m0, 1024
s_nop 0
buffer_load_dwordx4 v12, s[40:43], s21 offen lds
v_mfma_f32_16x16x32_bf16 a[88:91], a[168:171], v[104:107], a[88:91]
ds_read_b64_tr_b16 a[154:155], v28 offset:23232
v_mfma_f32_16x16x32_bf16 a[88:91], a[172:175], v[108:111], a[88:91]
s_add_u32 m0, m0, 1024
s_nop 0
buffer_load_dwordx4 v13, s[40:43], s21 offen lds
v_mfma_f32_16x16x32_bf16 a[124:127], a[160:163], v[112:115], 0
ds_read_b64_tr_b16 a[156:157], v28 offset:27840
v_mfma_f32_16x16x32_bf16 a[124:127], a[164:167], v[116:119], a[124:127]
v_mfma_f32_16x16x32_bf16 a[124:127], a[168:171], v[120:123], a[124:127]
ds_read_b64_tr_b16 a[158:159], v28 offset:32448
v_mfma_f32_16x16x32_bf16 a[124:127], a[172:175], v[124:127], a[124:127]
s_waitcnt lgkmcnt(8)
s_add_u32 m0, m0, 1024
s_nop 0
buffer_load_dwordx4 v14, s[40:43], s21 offen lds
v_mfma_f32_16x16x32_bf16 a[20:23], a[176:179], v[64:67], 0
ds_read_b64_tr_b16 a[160:161], v28 offset:224
v_mfma_f32_16x16x32_bf16 a[20:23], a[180:183], v[68:71], a[20:23]
s_add_u32 s16, s32, 8192
buffer_load_dwordx4 v[192:195], v2, s[48:51], s16 offen
v_mfma_f32_16x16x32_bf16 a[20:23], a[184:187], v[72:75], a[20:23]
ds_read_b64_tr_b16 a[162:163], v28 offset:4832
v_mfma_f32_16x16x32_bf16 a[20:23], a[188:191], v[76:79], a[20:23]
buffer_load_dwordx4 v[196:199], v2, s[48:51], s16 offen offset:1024
v_mfma_f32_16x16x32_bf16 a[56:59], a[176:179], v[80:83], 0
ds_read_b64_tr_b16 a[164:165], v28 offset:9440
v_mfma_f32_16x16x32_bf16 a[56:59], a[180:183], v[84:87], a[56:59]
s_add_u32 m0, s24, 110592
s_add_u32 s21, s25, 442368
buffer_load_dwordx4 v6, s[40:43], s21 offen lds
v_mfma_f32_16x16x32_bf16 a[56:59], a[184:187], v[88:91], a[56:59]
ds_read_b64_tr_b16 a[166:167], v28 offset:14048
v_mfma_f32_16x16x32_bf16 a[56:59], a[188:191], v[92:95], a[56:59]
buffer_load_dwordx4 v[200:203], v2, s[48:51], s16 offen offset:2048
v_mfma_f32_16x16x32_bf16 a[92:95], a[176:179], v[96:99], 0
ds_read_b64_tr_b16 a[168:169], v28 offset:18656
v_mfma_f32_16x16x32_bf16 a[92:95], a[180:183], v[100:103], a[92:95]
buffer_load_dwordx4 v[204:207], v2, s[48:51], s16 offen offset:3072
v_mfma_f32_16x16x32_bf16 a[92:95], a[184:187], v[104:107], a[92:95]
ds_read_b64_tr_b16 a[170:171], v28 offset:23264
v_mfma_f32_16x16x32_bf16 a[92:95], a[188:191], v[108:111], a[92:95]
v_mfma_f32_16x16x32_bf16 a[128:131], a[176:179], v[112:115], 0
ds_read_b64_tr_b16 a[172:173], v28 offset:27872
v_mfma_f32_16x16x32_bf16 a[128:131], a[180:183], v[116:119], a[128:131]
s_add_u32 m0, m0, 1024
s_nop 0
buffer_load_dwordx4 v7, s[40:43], s21 offen lds
v_mfma_f32_16x16x32_bf16 a[128:131], a[184:187], v[120:123], a[128:131]
ds_read_b64_tr_b16 a[174:175], v28 offset:32480
v_mfma_f32_16x16x32_bf16 a[128:131], a[188:191], v[124:127], a[128:131]
s_waitcnt lgkmcnt(8)
s_add_u32 s17, s33, 8192
buffer_load_dwordx4 v[208:211], v2, s[48:51], s17 offen
v_mfma_f32_16x16x32_bf16 a[24:27], a[144:147], v[64:67], 0
ds_read_b64_tr_b16 a[176:177], v28 offset:256
v_mfma_f32_16x16x32_bf16 a[24:27], a[148:151], v[68:71], a[24:27]
buffer_load_dwordx4 v[212:215], v2, s[48:51], s17 offen offset:1024
v_mfma_f32_16x16x32_bf16 a[24:27], a[152:155], v[72:75], a[24:27]
ds_read_b64_tr_b16 a[178:179], v28 offset:4864
v_mfma_f32_16x16x32_bf16 a[24:27], a[156:159], v[76:79], a[24:27]
s_add_u32 m0, m0, 1024
s_nop 0
buffer_load_dwordx4 v8, s[40:43], s21 offen lds
v_mfma_f32_16x16x32_bf16 a[60:63], a[144:147], v[80:83], 0
ds_read_b64_tr_b16 a[180:181], v28 offset:9472
v_mfma_f32_16x16x32_bf16 a[60:63], a[148:151], v[84:87], a[60:63]
buffer_load_dwordx4 v[216:219], v2, s[48:51], s17 offen offset:2048
v_mfma_f32_16x16x32_bf16 a[60:63], a[152:155], v[88:91], a[60:63]
ds_read_b64_tr_b16 a[182:183], v28 offset:14080
v_mfma_f32_16x16x32_bf16 a[60:63], a[156:159], v[92:95], a[60:63]
buffer_load_dwordx4 v[220:223], v2, s[48:51], s17 offen offset:3072
v_mfma_f32_16x16x32_bf16 a[96:99], a[144:147], v[96:99], 0
ds_read_b64_tr_b16 a[184:185], v28 offset:18688
v_mfma_f32_16x16x32_bf16 a[96:99], a[148:151], v[100:103], a[96:99]
v_mfma_f32_16x16x32_bf16 a[96:99], a[152:155], v[104:107], a[96:99]
ds_read_b64_tr_b16 a[186:187], v28 offset:23296
v_mfma_f32_16x16x32_bf16 a[96:99], a[156:159], v[108:111], a[96:99]
s_add_u32 m0, m0, 1024
s_nop 0
buffer_load_dwordx4 v9, s[40:43], s21 offen lds
v_mfma_f32_16x16x32_bf16 a[132:135], a[144:147], v[112:115], 0
ds_read_b64_tr_b16 a[188:189], v28 offset:27904
v_mfma_f32_16x16x32_bf16 a[132:135], a[148:151], v[116:119], a[132:135]
s_add_u32 s18, s34, 8192
buffer_load_dwordx4 v[224:227], v2, s[48:51], s18 offen
v_mfma_f32_16x16x32_bf16 a[132:135], a[152:155], v[120:123], a[132:135]
ds_read_b64_tr_b16 a[190:191], v28 offset:32512
v_mfma_f32_16x16x32_bf16 a[132:135], a[156:159], v[124:127], a[132:135]
s_waitcnt lgkmcnt(8)
buffer_load_dwordx4 v[228:231], v2, s[48:51], s18 offen offset:1024
v_mfma_f32_16x16x32_bf16 a[28:31], a[160:163], v[64:67], 0
v_mfma_f32_16x16x32_bf16 a[28:31], a[164:167], v[68:71], a[28:31]
s_add_u32 m0, m0, 1024
s_nop 0
buffer_load_dwordx4 v10, s[40:43], s21 offen lds
v_mfma_f32_16x16x32_bf16 a[28:31], a[168:171], v[72:75], a[28:31]
s_waitcnt vmcnt(40) lgkmcnt(0)
s_barrier
v_mfma_f32_16x16x32_bf16 a[28:31], a[172:175], v[76:79], a[28:31]
ds_read_b64_tr_b16 a[144:145], v29
v_mfma_f32_16x16x32_bf16 a[64:67], a[160:163], v[80:83], 0
ds_read_b64_tr_b16 a[146:147], v29 offset:4608
v_mfma_f32_16x16x32_bf16 a[64:67], a[164:167], v[84:87], a[64:67]
buffer_load_dwordx4 v[232:235], v2, s[48:51], s18 offen offset:2048
v_mfma_f32_16x16x32_bf16 a[64:67], a[168:171], v[88:91], a[64:67]
ds_read_b64_tr_b16 a[148:149], v29 offset:9216
v_mfma_f32_16x16x32_bf16 a[64:67], a[172:175], v[92:95], a[64:67]
ds_read_b64_tr_b16 a[150:151], v29 offset:13824
v_mfma_f32_16x16x32_bf16 a[100:103], a[160:163], v[96:99], 0
buffer_load_dwordx4 v[236:239], v2, s[48:51], s18 offen offset:3072
v_mfma_f32_16x16x32_bf16 a[100:103], a[164:167], v[100:103], a[100:103]
ds_read_b64_tr_b16 a[152:153], v29 offset:18432
v_mfma_f32_16x16x32_bf16 a[100:103], a[168:171], v[104:107], a[100:103]
s_add_u32 m0, m0, 1024
s_nop 0
buffer_load_dwordx4 v11, s[40:43], s21 offen lds
v_mfma_f32_16x16x32_bf16 a[100:103], a[172:175], v[108:111], a[100:103]
ds_read_b64_tr_b16 a[154:155], v29 offset:23040
v_mfma_f32_16x16x32_bf16 a[136:139], a[160:163], v[112:115], 0
ds_read_b64_tr_b16 a[156:157], v29 offset:27648
v_mfma_f32_16x16x32_bf16 a[136:139], a[164:167], v[116:119], a[136:139]
s_add_u32 s19, s35, 8192
buffer_load_dwordx4 v[240:243], v2, s[48:51], s19 offen
v_mfma_f32_16x16x32_bf16 a[136:139], a[168:171], v[120:123], a[136:139]
ds_read_b64_tr_b16 a[158:159], v29 offset:32256
v_mfma_f32_16x16x32_bf16 a[136:139], a[172:175], v[124:127], a[136:139]
buffer_load_dwordx4 v[244:247], v2, s[48:51], s19 offen offset:1024
v_mfma_f32_16x16x32_bf16 a[32:35], a[176:179], v[64:67], 0
ds_read_b64_tr_b16 a[160:161], v29 offset:32
v_mfma_f32_16x16x32_bf16 a[32:35], a[180:183], v[68:71], a[32:35]
ds_read_b64_tr_b16 a[162:163], v29 offset:4640
v_mfma_f32_16x16x32_bf16 a[32:35], a[184:187], v[72:75], a[32:35]
s_add_u32 m0, m0, 1024
s_nop 0
buffer_load_dwordx4 v12, s[40:43], s21 offen lds
v_mfma_f32_16x16x32_bf16 a[32:35], a[188:191], v[76:79], a[32:35]
ds_read_b64_tr_b16 a[164:165], v29 offset:9248
v_mfma_f32_16x16x32_bf16 a[68:71], a[176:179], v[80:83], 0
buffer_load_dwordx4 v[248:251], v2, s[48:51], s19 offen offset:2048
v_mfma_f32_16x16x32_bf16 a[68:71], a[180:183], v[84:87], a[68:71]
ds_read_b64_tr_b16 a[166:167], v29 offset:13856
v_mfma_f32_16x16x32_bf16 a[68:71], a[184:187], v[88:91], a[68:71]
buffer_load_dwordx4 v[252:255], v2, s[48:51], s19 offen offset:3072
v_mfma_f32_16x16x32_bf16 a[68:71], a[188:191], v[92:95], a[68:71]
ds_read_b64_tr_b16 a[168:169], v29 offset:18464
v_mfma_f32_16x16x32_bf16 a[104:107], a[176:179], v[96:99], 0
ds_read_b64_tr_b16 a[170:171], v29 offset:23072
v_mfma_f32_16x16x32_bf16 a[104:107], a[180:183], v[100:103], a[104:107]
s_add_u32 m0, m0, 1024
s_nop 0
buffer_load_dwordx4 v13, s[40:43], s21 offen lds
v_mfma_f32_16x16x32_bf16 a[104:107], a[184:187], v[104:107], a[104:107]
ds_read_b64_tr_b16 a[172:173], v29 offset:27680
v_mfma_f32_16x16x32_bf16 a[104:107], a[188:191], v[108:111], a[104:107]
s_add_u32 m0, m0, 1024
s_nop 0
buffer_load_dwordx4 v14, s[40:43], s21 offen lds
v_mfma_f32_16x16x32_bf16 a[140:143], a[176:179], v[112:115], 0
ds_read_b64_tr_b16 a[174:175], v29 offset:32288
v_mfma_f32_16x16x32_bf16 a[140:143], a[180:183], v[116:119], a[140:143]
v_mfma_f32_16x16x32_bf16 a[140:143], a[184:187], v[120:123], a[140:143]
v_mfma_f32_16x16x32_bf16 a[140:143], a[188:191], v[124:127], a[140:143]
s_waitcnt vmcnt(46) lgkmcnt(8)
v_mfma_f32_16x16x32_bf16 a[0:3], a[144:147], v[128:131], a[0:3]
ds_read_b64_tr_b16 a[176:177], v29 offset:64
v_mfma_f32_16x16x32_bf16 a[0:3], a[148:151], v[132:135], a[0:3]
buffer_load_dword v24, v23, s[72:75], 0 offen sc1
v_mfma_f32_16x16x32_bf16 a[0:3], a[152:155], v[136:139], a[0:3]
ds_read_b64_tr_b16 a[178:179], v29 offset:4672
v_mfma_f32_16x16x32_bf16 a[0:3], a[156:159], v[140:143], a[0:3]
s_waitcnt vmcnt(43)
v_mfma_f32_16x16x32_bf16 a[36:39], a[144:147], v[144:147], a[36:39]
ds_read_b64_tr_b16 a[180:181], v29 offset:9280
v_mfma_f32_16x16x32_bf16 a[36:39], a[148:151], v[148:151], a[36:39]
v_mfma_f32_16x16x32_bf16 a[36:39], a[152:155], v[152:155], a[36:39]
ds_read_b64_tr_b16 a[182:183], v29 offset:13888
v_mfma_f32_16x16x32_bf16 a[36:39], a[156:159], v[156:159], a[36:39]
s_waitcnt vmcnt(39)
s_add_u32 s16, s32, 12288
buffer_load_dwordx4 v[64:67], v2, s[48:51], s16 offen
v_mfma_f32_16x16x32_bf16 a[72:75], a[144:147], v[160:163], a[72:75]
ds_read_b64_tr_b16 a[184:185], v29 offset:18496
v_mfma_f32_16x16x32_bf16 a[72:75], a[148:151], v[164:167], a[72:75]
v_mfma_f32_16x16x32_bf16 a[72:75], a[152:155], v[168:171], a[72:75]
ds_read_b64_tr_b16 a[186:187], v29 offset:23104
v_mfma_f32_16x16x32_bf16 a[72:75], a[156:159], v[172:175], a[72:75]
s_waitcnt vmcnt(36)
buffer_load_dwordx4 v[68:71], v2, s[48:51], s16 offen offset:1024
v_mfma_f32_16x16x32_bf16 a[108:111], a[144:147], v[176:179], a[108:111]
ds_read_b64_tr_b16 a[188:189], v29 offset:27712
v_mfma_f32_16x16x32_bf16 a[108:111], a[148:151], v[180:183], a[108:111]
v_mfma_f32_16x16x32_bf16 a[108:111], a[152:155], v[184:187], a[108:111]
ds_read_b64_tr_b16 a[190:191], v29 offset:32320
v_mfma_f32_16x16x32_bf16 a[108:111], a[156:159], v[188:191], a[108:111]
s_waitcnt lgkmcnt(8)
v_mfma_f32_16x16x32_bf16 a[4:7], a[160:163], v[128:131], a[4:7]
ds_read_b64_tr_b16 a[144:145], v29 offset:96
v_mfma_f32_16x16x32_bf16 a[4:7], a[164:167], v[132:135], a[4:7]
s_add_u32 m0, s24, 0
s_add_u32 s21, s26, 0
buffer_load_dwordx4 v6, s[44:47], s21 offen lds
v_mfma_f32_16x16x32_bf16 a[4:7], a[168:171], v[136:139], a[4:7]
ds_read_b64_tr_b16 a[146:147], v29 offset:4704
v_mfma_f32_16x16x32_bf16 a[4:7], a[172:175], v[140:143], a[4:7]
v_mfma_f32_16x16x32_bf16 a[40:43], a[160:163], v[144:147], a[40:43]
ds_read_b64_tr_b16 a[148:149], v29 offset:9312
v_mfma_f32_16x16x32_bf16 a[40:43], a[164:167], v[148:151], a[40:43]
v_mfma_f32_16x16x32_bf16 a[40:43], a[168:171], v[152:155], a[40:43]
ds_read_b64_tr_b16 a[150:151], v29 offset:13920
v_mfma_f32_16x16x32_bf16 a[40:43], a[172:175], v[156:159], a[40:43]
buffer_load_dwordx4 v[72:75], v2, s[48:51], s16 offen offset:2048
v_mfma_f32_16x16x32_bf16 a[76:79], a[160:163], v[160:163], a[76:79]
ds_read_b64_tr_b16 a[152:153], v29 offset:18528
v_mfma_f32_16x16x32_bf16 a[76:79], a[164:167], v[164:167], a[76:79]
v_mfma_f32_16x16x32_bf16 a[76:79], a[168:171], v[168:171], a[76:79]
ds_read_b64_tr_b16 a[154:155], v29 offset:23136
v_mfma_f32_16x16x32_bf16 a[76:79], a[172:175], v[172:175], a[76:79]
buffer_load_dwordx4 v[76:79], v2, s[48:51], s16 offen offset:3072
v_mfma_f32_16x16x32_bf16 a[112:115], a[160:163], v[176:179], a[112:115]
ds_read_b64_tr_b16 a[156:157], v29 offset:27744
v_mfma_f32_16x16x32_bf16 a[112:115], a[164:167], v[180:183], a[112:115]
v_mfma_f32_16x16x32_bf16 a[112:115], a[168:171], v[184:187], a[112:115]
ds_read_b64_tr_b16 a[158:159], v29 offset:32352
v_mfma_f32_16x16x32_bf16 a[112:115], a[172:175], v[188:191], a[112:115]
s_waitcnt lgkmcnt(8)
v_mfma_f32_16x16x32_bf16 a[8:11], a[176:179], v[128:131], a[8:11]
ds_read_b64_tr_b16 a[160:161], v29 offset:128
v_mfma_f32_16x16x32_bf16 a[8:11], a[180:183], v[132:135], a[8:11]
s_add_u32 m0, m0, 1024
s_nop 0
buffer_load_dwordx4 v7, s[44:47], s21 offen lds
v_mfma_f32_16x16x32_bf16 a[8:11], a[184:187], v[136:139], a[8:11]
ds_read_b64_tr_b16 a[162:163], v29 offset:4736
v_mfma_f32_16x16x32_bf16 a[8:11], a[188:191], v[140:143], a[8:11]
v_mfma_f32_16x16x32_bf16 a[44:47], a[176:179], v[144:147], a[44:47]
ds_read_b64_tr_b16 a[164:165], v29 offset:9344
v_mfma_f32_16x16x32_bf16 a[44:47], a[180:183], v[148:151], a[44:47]
v_mfma_f32_16x16x32_bf16 a[44:47], a[184:187], v[152:155], a[44:47]
ds_read_b64_tr_b16 a[166:167], v29 offset:13952
v_mfma_f32_16x16x32_bf16 a[44:47], a[188:191], v[156:159], a[44:47]
s_add_u32 s17, s33, 12288
buffer_load_dwordx4 v[80:83], v2, s[48:51], s17 offen
v_mfma_f32_16x16x32_bf16 a[80:83], a[176:179], v[160:163], a[80:83]
ds_read_b64_tr_b16 a[168:169], v29 offset:18560
v_mfma_f32_16x16x32_bf16 a[80:83], a[180:183], v[164:167], a[80:83]
v_mfma_f32_16x16x32_bf16 a[80:83], a[184:187], v[168:171], a[80:83]
ds_read_b64_tr_b16 a[170:171], v29 offset:23168
v_mfma_f32_16x16x32_bf16 a[80:83], a[188:191], v[172:175], a[80:83]
buffer_load_dwordx4 v[84:87], v2, s[48:51], s17 offen offset:1024
v_mfma_f32_16x16x32_bf16 a[116:119], a[176:179], v[176:179], a[116:119]
ds_read_b64_tr_b16 a[172:173], v29 offset:27776
v_mfma_f32_16x16x32_bf16 a[116:119], a[180:183], v[180:183], a[116:119]
v_mfma_f32_16x16x32_bf16 a[116:119], a[184:187], v[184:187], a[116:119]
ds_read_b64_tr_b16 a[174:175], v29 offset:32384
v_mfma_f32_16x16x32_bf16 a[116:119], a[188:191], v[188:191], a[116:119]
s_waitcnt lgkmcnt(8)
v_mfma_f32_16x16x32_bf16 a[12:15], a[144:147], v[128:131], a[12:15]
ds_read_b64_tr_b16 a[176:177], v29 offset:160
v_mfma_f32_16x16x32_bf16 a[12:15], a[148:151], v[132:135], a[12:15]
s_add_u32 m0, m0, 1024
s_nop 0
buffer_load_dwordx4 v8, s[44:47], s21 offen lds
v_mfma_f32_16x16x32_bf16 a[12:15], a[152:155], v[136:139], a[12:15]
ds_read_b64_tr_b16 a[178:179], v29 offset:4768
v_mfma_f32_16x16x32_bf16 a[12:15], a[156:159], v[140:143], a[12:15]
v_mfma_f32_16x16x32_bf16 a[48:51], a[144:147], v[144:147], a[48:51]
ds_read_b64_tr_b16 a[180:181], v29 offset:9376
v_mfma_f32_16x16x32_bf16 a[48:51], a[148:151], v[148:151], a[48:51]
v_mfma_f32_16x16x32_bf16 a[48:51], a[152:155], v[152:155], a[48:51]
ds_read_b64_tr_b16 a[182:183], v29 offset:13984
v_mfma_f32_16x16x32_bf16 a[48:51], a[156:159], v[156:159], a[48:51]
buffer_load_dwordx4 v[88:91], v2, s[48:51], s17 offen offset:2048
v_mfma_f32_16x16x32_bf16 a[84:87], a[144:147], v[160:163], a[84:87]
ds_read_b64_tr_b16 a[184:185], v29 offset:18592
v_mfma_f32_16x16x32_bf16 a[84:87], a[148:151], v[164:167], a[84:87]
v_mfma_f32_16x16x32_bf16 a[84:87], a[152:155], v[168:171], a[84:87]
ds_read_b64_tr_b16 a[186:187], v29 offset:23200
v_mfma_f32_16x16x32_bf16 a[84:87], a[156:159], v[172:175], a[84:87]
buffer_load_dwordx4 v[92:95], v2, s[48:51], s17 offen offset:3072
v_mfma_f32_16x16x32_bf16 a[120:123], a[144:147], v[176:179], a[120:123]
ds_read_b64_tr_b16 a[188:189], v29 offset:27808
v_mfma_f32_16x16x32_bf16 a[120:123], a[148:151], v[180:183], a[120:123]
v_mfma_f32_16x16x32_bf16 a[120:123], a[152:155], v[184:187], a[120:123]
ds_read_b64_tr_b16 a[190:191], v29 offset:32416
v_mfma_f32_16x16x32_bf16 a[120:123], a[156:159], v[188:191], a[120:123]
s_waitcnt lgkmcnt(8)
v_mfma_f32_16x16x32_bf16 a[16:19], a[160:163], v[128:131], a[16:19]
ds_read_b64_tr_b16 a[144:145], v29 offset:192
v_mfma_f32_16x16x32_bf16 a[16:19], a[164:167], v[132:135], a[16:19]
s_add_u32 m0, m0, 1024
s_nop 0
buffer_load_dwordx4 v9, s[44:47], s21 offen lds
v_mfma_f32_16x16x32_bf16 a[16:19], a[168:171], v[136:139], a[16:19]
ds_read_b64_tr_b16 a[146:147], v29 offset:4800
v_mfma_f32_16x16x32_bf16 a[16:19], a[172:175], v[140:143], a[16:19]
v_mfma_f32_16x16x32_bf16 a[52:55], a[160:163], v[144:147], a[52:55]
ds_read_b64_tr_b16 a[148:149], v29 offset:9408
v_mfma_f32_16x16x32_bf16 a[52:55], a[164:167], v[148:151], a[52:55]
v_mfma_f32_16x16x32_bf16 a[52:55], a[168:171], v[152:155], a[52:55]
ds_read_b64_tr_b16 a[150:151], v29 offset:14016
v_mfma_f32_16x16x32_bf16 a[52:55], a[172:175], v[156:159], a[52:55]
s_add_u32 s18, s34, 12288
buffer_load_dwordx4 v[96:99], v2, s[48:51], s18 offen
v_mfma_f32_16x16x32_bf16 a[88:91], a[160:163], v[160:163], a[88:91]
ds_read_b64_tr_b16 a[152:153], v29 offset:18624
v_mfma_f32_16x16x32_bf16 a[88:91], a[164:167], v[164:167], a[88:91]
v_mfma_f32_16x16x32_bf16 a[88:91], a[168:171], v[168:171], a[88:91]
ds_read_b64_tr_b16 a[154:155], v29 offset:23232
v_mfma_f32_16x16x32_bf16 a[88:91], a[172:175], v[172:175], a[88:91]
buffer_load_dwordx4 v[100:103], v2, s[48:51], s18 offen offset:1024
v_mfma_f32_16x16x32_bf16 a[124:127], a[160:163], v[176:179], a[124:127]
ds_read_b64_tr_b16 a[156:157], v29 offset:27840
v_mfma_f32_16x16x32_bf16 a[124:127], a[164:167], v[180:183], a[124:127]
v_mfma_f32_16x16x32_bf16 a[124:127], a[168:171], v[184:187], a[124:127]
ds_read_b64_tr_b16 a[158:159], v29 offset:32448
v_mfma_f32_16x16x32_bf16 a[124:127], a[172:175], v[188:191], a[124:127]
s_waitcnt lgkmcnt(8)
v_mfma_f32_16x16x32_bf16 a[20:23], a[176:179], v[128:131], a[20:23]
ds_read_b64_tr_b16 a[160:161], v29 offset:224
v_mfma_f32_16x16x32_bf16 a[20:23], a[180:183], v[132:135], a[20:23]
s_add_u32 m0, m0, 1024
s_nop 0
buffer_load_dwordx4 v10, s[44:47], s21 offen lds
v_mfma_f32_16x16x32_bf16 a[20:23], a[184:187], v[136:139], a[20:23]
ds_read_b64_tr_b16 a[162:163], v29 offset:4832
v_mfma_f32_16x16x32_bf16 a[20:23], a[188:191], v[140:143], a[20:23]
v_mfma_f32_16x16x32_bf16 a[56:59], a[176:179], v[144:147], a[56:59]
ds_read_b64_tr_b16 a[164:165], v29 offset:9440
v_mfma_f32_16x16x32_bf16 a[56:59], a[180:183], v[148:151], a[56:59]
buffer_load_dwordx4 v[104:107], v2, s[48:51], s18 offen offset:2048
v_mfma_f32_16x16x32_bf16 a[56:59], a[184:187], v[152:155], a[56:59]
ds_read_b64_tr_b16 a[166:167], v29 offset:14048
v_mfma_f32_16x16x32_bf16 a[56:59], a[188:191], v[156:159], a[56:59]
v_mfma_f32_16x16x32_bf16 a[92:95], a[176:179], v[160:163], a[92:95]
ds_read_b64_tr_b16 a[168:169], v29 offset:18656
v_mfma_f32_16x16x32_bf16 a[92:95], a[180:183], v[164:167], a[92:95]
v_mfma_f32_16x16x32_bf16 a[92:95], a[184:187], v[168:171], a[92:95]
ds_read_b64_tr_b16 a[170:171], v29 offset:23264
v_mfma_f32_16x16x32_bf16 a[92:95], a[188:191], v[172:175], a[92:95]
buffer_load_dwordx4 v[108:111], v2, s[48:51], s18 offen offset:3072
v_mfma_f32_16x16x32_bf16 a[128:131], a[176:179], v[176:179], a[128:131]
ds_read_b64_tr_b16 a[172:173], v29 offset:27872
v_mfma_f32_16x16x32_bf16 a[128:131], a[180:183], v[180:183], a[128:131]
v_mfma_f32_16x16x32_bf16 a[128:131], a[184:187], v[184:187], a[128:131]
ds_read_b64_tr_b16 a[174:175], v29 offset:32480
v_mfma_f32_16x16x32_bf16 a[128:131], a[188:191], v[188:191], a[128:131]
s_waitcnt lgkmcnt(8)
v_mfma_f32_16x16x32_bf16 a[24:27], a[144:147], v[128:131], a[24:27]
ds_read_b64_tr_b16 a[176:177], v29 offset:256
v_mfma_f32_16x16x32_bf16 a[24:27], a[148:151], v[132:135], a[24:27]
s_add_u32 m0, m0, 1024
s_nop 0
buffer_load_dwordx4 v11, s[44:47], s21 offen lds
v_mfma_f32_16x16x32_bf16 a[24:27], a[152:155], v[136:139], a[24:27]
ds_read_b64_tr_b16 a[178:179], v29 offset:4864
v_mfma_f32_16x16x32_bf16 a[24:27], a[156:159], v[140:143], a[24:27]
v_mfma_f32_16x16x32_bf16 a[60:63], a[144:147], v[144:147], a[60:63]
ds_read_b64_tr_b16 a[180:181], v29 offset:9472
v_mfma_f32_16x16x32_bf16 a[60:63], a[148:151], v[148:151], a[60:63]
s_add_u32 s19, s35, 12288
buffer_load_dwordx4 v[112:115], v2, s[48:51], s19 offen
v_mfma_f32_16x16x32_bf16 a[60:63], a[152:155], v[152:155], a[60:63]
ds_read_b64_tr_b16 a[182:183], v29 offset:14080
v_mfma_f32_16x16x32_bf16 a[60:63], a[156:159], v[156:159], a[60:63]
v_mfma_f32_16x16x32_bf16 a[96:99], a[144:147], v[160:163], a[96:99]
ds_read_b64_tr_b16 a[184:185], v29 offset:18688
v_mfma_f32_16x16x32_bf16 a[96:99], a[148:151], v[164:167], a[96:99]
v_mfma_f32_16x16x32_bf16 a[96:99], a[152:155], v[168:171], a[96:99]
ds_read_b64_tr_b16 a[186:187], v29 offset:23296
v_mfma_f32_16x16x32_bf16 a[96:99], a[156:159], v[172:175], a[96:99]
buffer_load_dwordx4 v[116:119], v2, s[48:51], s19 offen offset:1024
v_mfma_f32_16x16x32_bf16 a[132:135], a[144:147], v[176:179], a[132:135]
ds_read_b64_tr_b16 a[188:189], v29 offset:27904
v_mfma_f32_16x16x32_bf16 a[132:135], a[148:151], v[180:183], a[132:135]
v_mfma_f32_16x16x32_bf16 a[132:135], a[152:155], v[184:187], a[132:135]
ds_read_b64_tr_b16 a[190:191], v29 offset:32512
v_mfma_f32_16x16x32_bf16 a[132:135], a[156:159], v[188:191], a[132:135]
s_waitcnt lgkmcnt(8)
v_mfma_f32_16x16x32_bf16 a[28:31], a[160:163], v[128:131], a[28:31]
s_add_u32 m0, m0, 1024
s_nop 0
buffer_load_dwordx4 v12, s[44:47], s21 offen lds
v_mfma_f32_16x16x32_bf16 a[28:31], a[164:167], v[132:135], a[28:31]
v_mfma_f32_16x16x32_bf16 a[28:31], a[168:171], v[136:139], a[28:31]
s_waitcnt vmcnt(47) lgkmcnt(0)
s_barrier
v_mfma_f32_16x16x32_bf16 a[28:31], a[172:175], v[140:143], a[28:31]
ds_read_b64_tr_b16 a[144:145], v30
v_mfma_f32_16x16x32_bf16 a[64:67], a[160:163], v[144:147], a[64:67]
ds_read_b64_tr_b16 a[146:147], v30 offset:4608
v_mfma_f32_16x16x32_bf16 a[64:67], a[164:167], v[148:151], a[64:67]
buffer_load_dwordx4 v[120:123], v2, s[48:51], s19 offen offset:2048
v_mfma_f32_16x16x32_bf16 a[64:67], a[168:171], v[152:155], a[64:67]
ds_read_b64_tr_b16 a[148:149], v30 offset:9216
v_mfma_f32_16x16x32_bf16 a[64:67], a[172:175], v[156:159], a[64:67]
ds_read_b64_tr_b16 a[150:151], v30 offset:13824
v_mfma_f32_16x16x32_bf16 a[100:103], a[160:163], v[160:163], a[100:103]
v_mfma_f32_16x16x32_bf16 a[100:103], a[164:167], v[164:167], a[100:103]
ds_read_b64_tr_b16 a[152:153], v30 offset:18432
v_mfma_f32_16x16x32_bf16 a[100:103], a[168:171], v[168:171], a[100:103]
v_mfma_f32_16x16x32_bf16 a[100:103], a[172:175], v[172:175], a[100:103]
ds_read_b64_tr_b16 a[154:155], v30 offset:23040
v_mfma_f32_16x16x32_bf16 a[136:139], a[160:163], v[176:179], a[136:139]
ds_read_b64_tr_b16 a[156:157], v30 offset:27648
v_mfma_f32_16x16x32_bf16 a[136:139], a[164:167], v[180:183], a[136:139]
buffer_load_dwordx4 v[124:127], v2, s[48:51], s19 offen offset:3072
v_mfma_f32_16x16x32_bf16 a[136:139], a[168:171], v[184:187], a[136:139]
ds_read_b64_tr_b16 a[158:159], v30 offset:32256
v_mfma_f32_16x16x32_bf16 a[136:139], a[172:175], v[188:191], a[136:139]
v_mfma_f32_16x16x32_bf16 a[32:35], a[176:179], v[128:131], a[32:35]
ds_read_b64_tr_b16 a[160:161], v30 offset:32
v_mfma_f32_16x16x32_bf16 a[32:35], a[180:183], v[132:135], a[32:35]
ds_read_b64_tr_b16 a[162:163], v30 offset:4640
v_mfma_f32_16x16x32_bf16 a[32:35], a[184:187], v[136:139], a[32:35]
s_add_u32 m0, m0, 1024
s_nop 0
buffer_load_dwordx4 v13, s[44:47], s21 offen lds
v_mfma_f32_16x16x32_bf16 a[32:35], a[188:191], v[140:143], a[32:35]
ds_read_b64_tr_b16 a[164:165], v30 offset:9248
v_mfma_f32_16x16x32_bf16 a[68:71], a[176:179], v[144:147], a[68:71]
ds_read_b64_tr_b16 a[166:167], v30 offset:13856
v_mfma_f32_16x16x32_bf16 a[68:71], a[180:183], v[148:151], a[68:71]
s_add_u32 m0, m0, 1024
s_nop 0
buffer_load_dwordx4 v14, s[44:47], s21 offen lds
v_mfma_f32_16x16x32_bf16 a[68:71], a[184:187], v[152:155], a[68:71]
ds_read_b64_tr_b16 a[168:169], v30 offset:18464
v_mfma_f32_16x16x32_bf16 a[68:71], a[188:191], v[156:159], a[68:71]
v_mfma_f32_16x16x32_bf16 a[104:107], a[176:179], v[160:163], a[104:107]
ds_read_b64_tr_b16 a[170:171], v30 offset:23072
v_mfma_f32_16x16x32_bf16 a[104:107], a[180:183], v[164:167], a[104:107]
ds_read_b64_tr_b16 a[172:173], v30 offset:27680
v_mfma_f32_16x16x32_bf16 a[104:107], a[184:187], v[168:171], a[104:107]
v_mfma_f32_16x16x32_bf16 a[104:107], a[188:191], v[172:175], a[104:107]
ds_read_b64_tr_b16 a[174:175], v30 offset:32288
v_mfma_f32_16x16x32_bf16 a[140:143], a[176:179], v[176:179], a[140:143]
v_mfma_f32_16x16x32_bf16 a[140:143], a[180:183], v[180:183], a[140:143]
v_mfma_f32_16x16x32_bf16 a[140:143], a[184:187], v[184:187], a[140:143]
v_mfma_f32_16x16x32_bf16 a[140:143], a[188:191], v[188:191], a[140:143]
s_waitcnt vmcnt(46) lgkmcnt(8)
v_mfma_f32_16x16x32_bf16 a[0:3], a[144:147], v[192:195], a[0:3]
s_waitcnt vmcnt(25)
ds_read_b64_tr_b16 a[176:177], v30 offset:64
v_readfirstlane_b32 s76, v24
s_nop 3
s_cmp_ge_u32 s76, 8
s_cbranch_scc0 L_ap_spin4
L_ap_ret4:
v_mfma_f32_16x16x32_bf16 a[0:3], a[148:151], v[196:199], a[0:3]
s_add_u32 s16, s12, 0
buffer_load_dwordx4 v[128:131], v2, s[52:55], s16 offen sc1
v_mfma_f32_16x16x32_bf16 a[0:3], a[152:155], v[200:203], a[0:3]
ds_read_b64_tr_b16 a[178:179], v30 offset:4672
v_mfma_f32_16x16x32_bf16 a[0:3], a[156:159], v[204:207], a[0:3]
v_mfma_f32_16x16x32_bf16 a[36:39], a[144:147], v[208:211], a[36:39]
ds_read_b64_tr_b16 a[180:181], v30 offset:9280
v_mfma_f32_16x16x32_bf16 a[36:39], a[148:151], v[212:215], a[36:39]
v_mfma_f32_16x16x32_bf16 a[36:39], a[152:155], v[216:219], a[36:39]
ds_read_b64_tr_b16 a[182:183], v30 offset:13888
v_mfma_f32_16x16x32_bf16 a[36:39], a[156:159], v[220:223], a[36:39]
buffer_load_dwordx4 v[132:135], v2, s[52:55], s16 offen offset:1024 sc1
v_mfma_f32_16x16x32_bf16 a[72:75], a[144:147], v[224:227], a[72:75]
ds_read_b64_tr_b16 a[184:185], v30 offset:18496
v_mfma_f32_16x16x32_bf16 a[72:75], a[148:151], v[228:231], a[72:75]
v_mfma_f32_16x16x32_bf16 a[72:75], a[152:155], v[232:235], a[72:75]
ds_read_b64_tr_b16 a[186:187], v30 offset:23104
v_mfma_f32_16x16x32_bf16 a[72:75], a[156:159], v[236:239], a[72:75]
v_mfma_f32_16x16x32_bf16 a[108:111], a[144:147], v[240:243], a[108:111]
ds_read_b64_tr_b16 a[188:189], v30 offset:27712
v_mfma_f32_16x16x32_bf16 a[108:111], a[148:151], v[244:247], a[108:111]
s_add_u32 m0, s24, 36864
s_add_u32 s21, s26, 147456
buffer_load_dwordx4 v6, s[44:47], s21 offen lds
v_mfma_f32_16x16x32_bf16 a[108:111], a[152:155], v[248:251], a[108:111]
ds_read_b64_tr_b16 a[190:191], v30 offset:32320
v_mfma_f32_16x16x32_bf16 a[108:111], a[156:159], v[252:255], a[108:111]
s_waitcnt lgkmcnt(8)
v_mfma_f32_16x16x32_bf16 a[4:7], a[160:163], v[192:195], a[4:7]
ds_read_b64_tr_b16 a[144:145], v30 offset:96
v_mfma_f32_16x16x32_bf16 a[4:7], a[164:167], v[196:199], a[4:7]
buffer_load_dwordx4 v[136:139], v2, s[52:55], s16 offen offset:2048 sc1
v_mfma_f32_16x16x32_bf16 a[4:7], a[168:171], v[200:203], a[4:7]
ds_read_b64_tr_b16 a[146:147], v30 offset:4704
v_mfma_f32_16x16x32_bf16 a[4:7], a[172:175], v[204:207], a[4:7]
v_mfma_f32_16x16x32_bf16 a[40:43], a[160:163], v[208:211], a[40:43]
ds_read_b64_tr_b16 a[148:149], v30 offset:9312
v_mfma_f32_16x16x32_bf16 a[40:43], a[164:167], v[212:215], a[40:43]
v_mfma_f32_16x16x32_bf16 a[40:43], a[168:171], v[216:219], a[40:43]
ds_read_b64_tr_b16 a[150:151], v30 offset:13920
v_mfma_f32_16x16x32_bf16 a[40:43], a[172:175], v[220:223], a[40:43]
buffer_load_dwordx4 v[140:143], v2, s[52:55], s16 offen offset:3072 sc1
v_mfma_f32_16x16x32_bf16 a[76:79], a[160:163], v[224:227], a[76:79]
ds_read_b64_tr_b16 a[152:153], v30 offset:18528
v_mfma_f32_16x16x32_bf16 a[76:79], a[164:167], v[228:231], a[76:79]
v_mfma_f32_16x16x32_bf16 a[76:79], a[168:171], v[232:235], a[76:79]
ds_read_b64_tr_b16 a[154:155], v30 offset:23136
v_mfma_f32_16x16x32_bf16 a[76:79], a[172:175], v[236:239], a[76:79]
v_mfma_f32_16x16x32_bf16 a[112:115], a[160:163], v[240:243], a[112:115]
ds_read_b64_tr_b16 a[156:157], v30 offset:27744
v_mfma_f32_16x16x32_bf16 a[112:115], a[164:167], v[244:247], a[112:115]
s_add_u32 m0, m0, 1024
s_nop 0
buffer_load_dwordx4 v7, s[44:47], s21 offen lds
v_mfma_f32_16x16x32_bf16 a[112:115], a[168:171], v[248:251], a[112:115]
ds_read_b64_tr_b16 a[158:159], v30 offset:32352
v_mfma_f32_16x16x32_bf16 a[112:115], a[172:175], v[252:255], a[112:115]
s_waitcnt lgkmcnt(8)
v_mfma_f32_16x16x32_bf16 a[8:11], a[176:179], v[192:195], a[8:11]
ds_read_b64_tr_b16 a[160:161], v30 offset:128
v_mfma_f32_16x16x32_bf16 a[8:11], a[180:183], v[196:199], a[8:11]
v_mfma_f32_16x16x32_bf16 a[8:11], a[184:187], v[200:203], a[8:11]
ds_read_b64_tr_b16 a[162:163], v30 offset:4736
v_mfma_f32_16x16x32_bf16 a[8:11], a[188:191], v[204:207], a[8:11]
s_add_u32 s17, s13, 0
buffer_load_dwordx4 v[144:147], v2, s[52:55], s17 offen sc1
v_mfma_f32_16x16x32_bf16 a[44:47], a[176:179], v[208:211], a[44:47]
ds_read_b64_tr_b16 a[164:165], v30 offset:9344
v_mfma_f32_16x16x32_bf16 a[44:47], a[180:183], v[212:215], a[44:47]
v_mfma_f32_16x16x32_bf16 a[44:47], a[184:187], v[216:219], a[44:47]
ds_read_b64_tr_b16 a[166:167], v30 offset:13952
v_mfma_f32_16x16x32_bf16 a[44:47], a[188:191], v[220:223], a[44:47]
buffer_load_dwordx4 v[148:151], v2, s[52:55], s17 offen offset:1024 sc1
v_mfma_f32_16x16x32_bf16 a[80:83], a[176:179], v[224:227], a[80:83]
ds_read_b64_tr_b16 a[168:169], v30 offset:18560
v_mfma_f32_16x16x32_bf16 a[80:83], a[180:183], v[228:231], a[80:83]
v_mfma_f32_16x16x32_bf16 a[80:83], a[184:187], v[232:235], a[80:83]
ds_read_b64_tr_b16 a[170:171], v30 offset:23168
v_mfma_f32_16x16x32_bf16 a[80:83], a[188:191], v[236:239], a[80:83]
v_mfma_f32_16x16x32_bf16 a[116:119], a[176:179], v[240:243], a[116:119]
ds_read_b64_tr_b16 a[172:173], v30 offset:27776
v_mfma_f32_16x16x32_bf16 a[116:119], a[180:183], v[244:247], a[116:119]
s_add_u32 m0, m0, 1024
s_nop 0
buffer_load_dwordx4 v8, s[44:47], s21 offen lds
v_mfma_f32_16x16x32_bf16 a[116:119], a[184:187], v[248:251], a[116:119]
ds_read_b64_tr_b16 a[174:175], v30 offset:32384
v_mfma_f32_16x16x32_bf16 a[116:119], a[188:191], v[252:255], a[116:119]
s_waitcnt lgkmcnt(8)
v_mfma_f32_16x16x32_bf16 a[12:15], a[144:147], v[192:195], a[12:15]
ds_read_b64_tr_b16 a[176:177], v30 offset:160
v_mfma_f32_16x16x32_bf16 a[12:15], a[148:151], v[196:199], a[12:15]
v_mfma_f32_16x16x32_bf16 a[12:15], a[152:155], v[200:203], a[12:15]
ds_read_b64_tr_b16 a[178:179], v30 offset:4768
v_mfma_f32_16x16x32_bf16 a[12:15], a[156:159], v[204:207], a[12:15]
buffer_load_dwordx4 v[152:155], v2, s[52:55], s17 offen offset:2048 sc1
v_mfma_f32_16x16x32_bf16 a[48:51], a[144:147], v[208:211], a[48:51]
ds_read_b64_tr_b16 a[180:181], v30 offset:9376
v_mfma_f32_16x16x32_bf16 a[48:51], a[148:151], v[212:215], a[48:51]
v_mfma_f32_16x16x32_bf16 a[48:51], a[152:155], v[216:219], a[48:51]
ds_read_b64_tr_b16 a[182:183], v30 offset:13984
v_mfma_f32_16x16x32_bf16 a[48:51], a[156:159], v[220:223], a[48:51]
v_mfma_f32_16x16x32_bf16 a[84:87], a[144:147], v[224:227], a[84:87]
ds_read_b64_tr_b16 a[184:185], v30 offset:18592
v_mfma_f32_16x16x32_bf16 a[84:87], a[148:151], v[228:231], a[84:87]
buffer_load_dwordx4 v[156:159], v2, s[52:55], s17 offen offset:3072 sc1
v_mfma_f32_16x16x32_bf16 a[84:87], a[152:155], v[232:235], a[84:87]
ds_read_b64_tr_b16 a[186:187], v30 offset:23200
v_mfma_f32_16x16x32_bf16 a[84:87], a[156:159], v[236:239], a[84:87]
v_mfma_f32_16x16x32_bf16 a[120:123], a[144:147], v[240:243], a[120:123]
ds_read_b64_tr_b16 a[188:189], v30 offset:27808
v_mfma_f32_16x16x32_bf16 a[120:123], a[148:151], v[244:247], a[120:123]
s_add_u32 m0, m0, 1024
s_nop 0
buffer_load_dwordx4 v9, s[44:47], s21 offen lds
v_mfma_f32_16x16x32_bf16 a[120:123], a[152:155], v[248:251], a[120:123]
ds_read_b64_tr_b16 a[190:191], v30 offset:32416
v_mfma_f32_16x16x32_bf16 a[120:123], a[156:159], v[252:255], a[120:123]
s_waitcnt lgkmcnt(8)
v_mfma_f32_16x16x32_bf16 a[16:19], a[160:163], v[192:195], a[16:19]
ds_read_b64_tr_b16 a[144:145], v30 offset:192
v_mfma_f32_16x16x32_bf16 a[16:19], a[164:167], v[196:199], a[16:19]
v_mfma_f32_16x16x32_bf16 a[16:19], a[168:171], v[200:203], a[16:19]
ds_read_b64_tr_b16 a[146:147], v30 offset:4800
v_mfma_f32_16x16x32_bf16 a[16:19], a[172:175], v[204:207], a[16:19]
s_add_u32 s18, s14, 0
buffer_load_dwordx4 v[160:163], v2, s[52:55], s18 offen sc1
v_mfma_f32_16x16x32_bf16 a[52:55], a[160:163], v[208:211], a[52:55]
ds_read_b64_tr_b16 a[148:149], v30 offset:9408
v_mfma_f32_16x16x32_bf16 a[52:55], a[164:167], v[212:215], a[52:55]
v_mfma_f32_16x16x32_bf16 a[52:55], a[168:171], v[216:219], a[52:55]
ds_read_b64_tr_b16 a[150:151], v30 offset:14016
v_mfma_f32_16x16x32_bf16 a[52:55], a[172:175], v[220:223], a[52:55]
v_mfma_f32_16x16x32_bf16 a[88:91], a[160:163], v[224:227], a[88:91]
ds_read_b64_tr_b16 a[152:153], v30 offset:18624
v_mfma_f32_16x16x32_bf16 a[88:91], a[164:167], v[228:231], a[88:91]
buffer_load_dwordx4 v[164:167], v2, s[52:55], s18 offen offset:1024 sc1
v_mfma_f32_16x16x32_bf16 a[88:91], a[168:171], v[232:235], a[88:91]
ds_read_b64_tr_b16 a[154:155], v30 offset:23232
v_mfma_f32_16x16x32_bf16 a[88:91], a[172:175], v[236:239], a[88:91]
v_mfma_f32_16x16x32_bf16 a[124:127], a[160:163], v[240:243], a[124:127]
ds_read_b64_tr_b16 a[156:157], v30 offset:27840
v_mfma_f32_16x16x32_bf16 a[124:127], a[164:167], v[244:247], a[124:127]
v_mfma_f32_16x16x32_bf16 a[124:127], a[168:171], v[248:251], a[124:127]
ds_read_b64_tr_b16 a[158:159], v30 offset:32448
v_mfma_f32_16x16x32_bf16 a[124:127], a[172:175], v[252:255], a[124:127]
s_waitcnt lgkmcnt(8)
s_add_u32 m0, m0, 1024
s_nop 0
buffer_load_dwordx4 v10, s[44:47], s21 offen lds
v_mfma_f32_16x16x32_bf16 a[20:23], a[176:179], v[192:195], a[20:23]
ds_read_b64_tr_b16 a[160:161], v30 offset:224
v_mfma_f32_16x16x32_bf16 a[20:23], a[180:183], v[196:199], a[20:23]
v_mfma_f32_16x16x32_bf16 a[20:23], a[184:187], v[200:203], a[20:23]
ds_read_b64_tr_b16 a[162:163], v30 offset:4832
v_mfma_f32_16x16x32_bf16 a[20:23], a[188:191], v[204:207], a[20:23]
buffer_load_dwordx4 v[168:171], v2, s[52:55], s18 offen offset:2048 sc1
v_mfma_f32_16x16x32_bf16 a[56:59], a[176:179], v[208:211], a[56:59]
ds_read_b64_tr_b16 a[164:165], v30 offset:9440
v_mfma_f32_16x16x32_bf16 a[56:59], a[180:183], v[212:215], a[56:59]
v_mfma_f32_16x16x32_bf16 a[56:59], a[184:187], v[216:219], a[56:59]
ds_read_b64_tr_b16 a[166:167], v30 offset:14048
v_mfma_f32_16x16x32_bf16 a[56:59], a[188:191], v[220:223], a[56:59]
v_mfma_f32_16x16x32_bf16 a[92:95], a[176:179], v[224:227], a[92:95]
ds_read_b64_tr_b16 a[168:169], v30 offset:18656
v_mfma_f32_16x16x32_bf16 a[92:95], a[180:183], v[228:231], a[92:95]
buffer_load_dwordx4 v[172:175], v2, s[52:55], s18 offen offset:3072 sc1
v_mfma_f32_16x16x32_bf16 a[92:95], a[184:187], v[232:235], a[92:95]
ds_read_b64_tr_b16 a[170:171], v30 offset:23264
v_mfma_f32_16x16x32_bf16 a[92:95], a[188:191], v[236:239], a[92:95]
v_mfma_f32_16x16x32_bf16 a[128:131], a[176:179], v[240:243], a[128:131]
ds_read_b64_tr_b16 a[172:173], v30 offset:27872
v_mfma_f32_16x16x32_bf16 a[128:131], a[180:183], v[244:247], a[128:131]
v_mfma_f32_16x16x32_bf16 a[128:131], a[184:187], v[248:251], a[128:131]
ds_read_b64_tr_b16 a[174:175], v30 offset:32480
v_mfma_f32_16x16x32_bf16 a[128:131], a[188:191], v[252:255], a[128:131]
s_waitcnt lgkmcnt(8)
s_add_u32 m0, m0, 1024
s_nop 0
buffer_load_dwordx4 v11, s[44:47], s21 offen lds
v_mfma_f32_16x16x32_bf16 a[24:27], a[144:147], v[192:195], a[24:27]
ds_read_b64_tr_b16 a[176:177], v30 offset:256
v_mfma_f32_16x16x32_bf16 a[24:27], a[148:151], v[196:199], a[24:27]
v_mfma_f32_16x16x32_bf16 a[24:27], a[152:155], v[200:203], a[24:27]
ds_read_b64_tr_b16 a[178:179], v30 offset:4864
v_mfma_f32_16x16x32_bf16 a[24:27], a[156:159], v[204:207], a[24:27]
v_mfma_f32_16x16x32_bf16 a[60:63], a[144:147], v[208:211], a[60:63]
ds_read_b64_tr_b16 a[180:181], v30 offset:9472
v_mfma_f32_16x16x32_bf16 a[60:63], a[148:151], v[212:215], a[60:63]
s_add_u32 s19, s15, 0
buffer_load_dwordx4 v[176:179], v2, s[52:55], s19 offen sc1
v_mfma_f32_16x16x32_bf16 a[60:63], a[152:155], v[216:219], a[60:63]
ds_read_b64_tr_b16 a[182:183], v30 offset:14080
v_mfma_f32_16x16x32_bf16 a[60:63], a[156:159], v[220:223], a[60:63]
v_mfma_f32_16x16x32_bf16 a[96:99], a[144:147], v[224:227], a[96:99]
ds_read_b64_tr_b16 a[184:185], v30 offset:18688
v_mfma_f32_16x16x32_bf16 a[96:99], a[148:151], v[228:231], a[96:99]
buffer_load_dwordx4 v[180:183], v2, s[52:55], s19 offen offset:1024 sc1
v_mfma_f32_16x16x32_bf16 a[96:99], a[152:155], v[232:235], a[96:99]
ds_read_b64_tr_b16 a[186:187], v30 offset:23296
v_mfma_f32_16x16x32_bf16 a[96:99], a[156:159], v[236:239], a[96:99]
v_mfma_f32_16x16x32_bf16 a[132:135], a[144:147], v[240:243], a[132:135]
ds_read_b64_tr_b16 a[188:189], v30 offset:27904
v_mfma_f32_16x16x32_bf16 a[132:135], a[148:151], v[244:247], a[132:135]
v_mfma_f32_16x16x32_bf16 a[132:135], a[152:155], v[248:251], a[132:135]
ds_read_b64_tr_b16 a[190:191], v30 offset:32512
v_mfma_f32_16x16x32_bf16 a[132:135], a[156:159], v[252:255], a[132:135]
s_waitcnt lgkmcnt(8)
s_add_u32 m0, m0, 1024
s_nop 0
buffer_load_dwordx4 v12, s[44:47], s21 offen lds
v_mfma_f32_16x16x32_bf16 a[28:31], a[160:163], v[192:195], a[28:31]
v_mfma_f32_16x16x32_bf16 a[28:31], a[164:167], v[196:199], a[28:31]
v_mfma_f32_16x16x32_bf16 a[28:31], a[168:171], v[200:203], a[28:31]
s_waitcnt lgkmcnt(0)
s_barrier
v_mfma_f32_16x16x32_bf16 a[28:31], a[172:175], v[204:207], a[28:31]
ds_read_b64_tr_b16 a[144:145], v31
v_mfma_f32_16x16x32_bf16 a[64:67], a[160:163], v[208:211], a[64:67]
ds_read_b64_tr_b16 a[146:147], v31 offset:4608
v_mfma_f32_16x16x32_bf16 a[64:67], a[164:167], v[212:215], a[64:67]
buffer_load_dwordx4 v[184:187], v2, s[52:55], s19 offen offset:2048 sc1
v_mfma_f32_16x16x32_bf16 a[64:67], a[168:171], v[216:219], a[64:67]
ds_read_b64_tr_b16 a[148:149], v31 offset:9216
v_mfma_f32_16x16x32_bf16 a[64:67], a[172:175], v[220:223], a[64:67]
ds_read_b64_tr_b16 a[150:151], v31 offset:13824
v_mfma_f32_16x16x32_bf16 a[100:103], a[160:163], v[224:227], a[100:103]
v_mfma_f32_16x16x32_bf16 a[100:103], a[164:167], v[228:231], a[100:103]
ds_read_b64_tr_b16 a[152:153], v31 offset:18432
v_mfma_f32_16x16x32_bf16 a[100:103], a[168:171], v[232:235], a[100:103]
buffer_load_dwordx4 v[188:191], v2, s[52:55], s19 offen offset:3072 sc1
v_mfma_f32_16x16x32_bf16 a[100:103], a[172:175], v[236:239], a[100:103]
ds_read_b64_tr_b16 a[154:155], v31 offset:23040
v_mfma_f32_16x16x32_bf16 a[136:139], a[160:163], v[240:243], a[136:139]
ds_read_b64_tr_b16 a[156:157], v31 offset:27648
v_mfma_f32_16x16x32_bf16 a[136:139], a[164:167], v[244:247], a[136:139]
v_mfma_f32_16x16x32_bf16 a[136:139], a[168:171], v[248:251], a[136:139]
ds_read_b64_tr_b16 a[158:159], v31 offset:32256
v_mfma_f32_16x16x32_bf16 a[136:139], a[172:175], v[252:255], a[136:139]
s_add_u32 m0, m0, 1024
s_nop 0
buffer_load_dwordx4 v13, s[44:47], s21 offen lds
v_mfma_f32_16x16x32_bf16 a[32:35], a[176:179], v[192:195], a[32:35]
ds_read_b64_tr_b16 a[160:161], v31 offset:32
v_mfma_f32_16x16x32_bf16 a[32:35], a[180:183], v[196:199], a[32:35]
ds_read_b64_tr_b16 a[162:163], v31 offset:4640
v_mfma_f32_16x16x32_bf16 a[32:35], a[184:187], v[200:203], a[32:35]
v_mfma_f32_16x16x32_bf16 a[32:35], a[188:191], v[204:207], a[32:35]
ds_read_b64_tr_b16 a[164:165], v31 offset:9248
v_mfma_f32_16x16x32_bf16 a[68:71], a[176:179], v[208:211], a[68:71]
ds_read_b64_tr_b16 a[166:167], v31 offset:13856
v_mfma_f32_16x16x32_bf16 a[68:71], a[180:183], v[212:215], a[68:71]
s_add_u32 m0, m0, 1024
s_nop 0
buffer_load_dwordx4 v14, s[44:47], s21 offen lds
v_mfma_f32_16x16x32_bf16 a[68:71], a[184:187], v[216:219], a[68:71]
ds_read_b64_tr_b16 a[168:169], v31 offset:18464
v_mfma_f32_16x16x32_bf16 a[68:71], a[188:191], v[220:223], a[68:71]
v_mfma_f32_16x16x32_bf16 a[104:107], a[176:179], v[224:227], a[104:107]
ds_read_b64_tr_b16 a[170:171], v31 offset:23072
v_mfma_f32_16x16x32_bf16 a[104:107], a[180:183], v[228:231], a[104:107]
ds_read_b64_tr_b16 a[172:173], v31 offset:27680
v_mfma_f32_16x16x32_bf16 a[104:107], a[184:187], v[232:235], a[104:107]
v_mfma_f32_16x16x32_bf16 a[104:107], a[188:191], v[236:239], a[104:107]
ds_read_b64_tr_b16 a[174:175], v31 offset:32288
v_mfma_f32_16x16x32_bf16 a[140:143], a[176:179], v[240:243], a[140:143]
v_mfma_f32_16x16x32_bf16 a[140:143], a[180:183], v[244:247], a[140:143]
v_mfma_f32_16x16x32_bf16 a[140:143], a[184:187], v[248:251], a[140:143]
v_mfma_f32_16x16x32_bf16 a[140:143], a[188:191], v[252:255], a[140:143]
s_waitcnt vmcnt(45) lgkmcnt(8)
v_mfma_f32_16x16x32_bf16 a[0:3], a[144:147], v[64:67], a[0:3]
ds_read_b64_tr_b16 a[176:177], v31 offset:64
v_mfma_f32_16x16x32_bf16 a[0:3], a[148:151], v[68:71], a[0:3]
s_add_u32 s16, s12, 4096
buffer_load_dwordx4 v[192:195], v2, s[52:55], s16 offen sc1
v_mfma_f32_16x16x32_bf16 a[0:3], a[152:155], v[72:75], a[0:3]
ds_read_b64_tr_b16 a[178:179], v31 offset:4672
v_mfma_f32_16x16x32_bf16 a[0:3], a[156:159], v[76:79], a[0:3]
s_waitcnt vmcnt(40)
v_mfma_f32_16x16x32_bf16 a[36:39], a[144:147], v[80:83], a[36:39]
ds_read_b64_tr_b16 a[180:181], v31 offset:9280
v_mfma_f32_16x16x32_bf16 a[36:39], a[148:151], v[84:87], a[36:39]
v_mfma_f32_16x16x32_bf16 a[36:39], a[152:155], v[88:91], a[36:39]
ds_read_b64_tr_b16 a[182:183], v31 offset:13888
v_mfma_f32_16x16x32_bf16 a[36:39], a[156:159], v[92:95], a[36:39]
s_waitcnt vmcnt(34)
buffer_load_dwordx4 v[196:199], v2, s[52:55], s16 offen offset:1024 sc1
v_mfma_f32_16x16x32_bf16 a[72:75], a[144:147], v[96:99], a[72:75]
ds_read_b64_tr_b16 a[184:185], v31 offset:18496
v_mfma_f32_16x16x32_bf16 a[72:75], a[148:151], v[100:103], a[72:75]
v_mfma_f32_16x16x32_bf16 a[72:75], a[152:155], v[104:107], a[72:75]
ds_read_b64_tr_b16 a[186:187], v31 offset:23104
v_mfma_f32_16x16x32_bf16 a[72:75], a[156:159], v[108:111], a[72:75]
s_waitcnt vmcnt(29)
v_mfma_f32_16x16x32_bf16 a[108:111], a[144:147], v[112:115], a[108:111]
ds_read_b64_tr_b16 a[188:189], v31 offset:27712
v_mfma_f32_16x16x32_bf16 a[108:111], a[148:151], v[116:119], a[108:111]
s_add_u32 m0, s24, 73728
s_add_u32 s21, s26, 294912
buffer_load_dwordx4 v6, s[44:47], s21 offen lds
v_mfma_f32_16x16x32_bf16 a[108:111], a[152:155], v[120:123], a[108:111]
ds_read_b64_tr_b16 a[190:191], v31 offset:32320
v_mfma_f32_16x16x32_bf16 a[108:111], a[156:159], v[124:127], a[108:111]
s_waitcnt lgkmcnt(8)
v_mfma_f32_16x16x32_bf16 a[4:7], a[160:163], v[64:67], a[4:7]
ds_read_b64_tr_b16 a[144:145], v31 offset:96
v_mfma_f32_16x16x32_bf16 a[4:7], a[164:167], v[68:71], a[4:7]
buffer_load_dwordx4 v[200:203], v2, s[52:55], s16 offen offset:2048 sc1
v_mfma_f32_16x16x32_bf16 a[4:7], a[168:171], v[72:75], a[4:7]
ds_read_b64_tr_b16 a[146:147], v31 offset:4704
v_mfma_f32_16x16x32_bf16 a[4:7], a[172:175], v[76:79], a[4:7]
v_mfma_f32_16x16x32_bf16 a[40:43], a[160:163], v[80:83], a[40:43]
ds_read_b64_tr_b16 a[148:149], v31 offset:9312
v_mfma_f32_16x16x32_bf16 a[40:43], a[164:167], v[84:87], a[40:43]
v_mfma_f32_16x16x32_bf16 a[40:43], a[168:171], v[88:91], a[40:43]
ds_read_b64_tr_b16 a[150:151], v31 offset:13920
v_mfma_f32_16x16x32_bf16 a[40:43], a[172:175], v[92:95], a[40:43]
buffer_load_dwordx4 v[204:207], v2, s[52:55], s16 offen offset:3072 sc1
v_mfma_f32_16x16x32_bf16 a[76:79], a[160:163], v[96:99], a[76:79]
ds_read_b64_tr_b16 a[152:153], v31 offset:18528
v_mfma_f32_16x16x32_bf16 a[76:79], a[164:167], v[100:103], a[76:79]
v_mfma_f32_16x16x32_bf16 a[76:79], a[168:171], v[104:107], a[76:79]
ds_read_b64_tr_b16 a[154:155], v31 offset:23136
v_mfma_f32_16x16x32_bf16 a[76:79], a[172:175], v[108:111], a[76:79]
v_mfma_f32_16x16x32_bf16 a[112:115], a[160:163], v[112:115], a[112:115]
ds_read_b64_tr_b16 a[156:157], v31 offset:27744
v_mfma_f32_16x16x32_bf16 a[112:115], a[164:167], v[116:119], a[112:115]
s_add_u32 m0, m0, 1024
s_nop 0
buffer_load_dwordx4 v7, s[44:47], s21 offen lds
v_mfma_f32_16x16x32_bf16 a[112:115], a[168:171], v[120:123], a[112:115]
ds_read_b64_tr_b16 a[158:159], v31 offset:32352
v_mfma_f32_16x16x32_bf16 a[112:115], a[172:175], v[124:127], a[112:115]
s_waitcnt lgkmcnt(8)
v_mfma_f32_16x16x32_bf16 a[8:11], a[176:179], v[64:67], a[8:11]
ds_read_b64_tr_b16 a[160:161], v31 offset:128
v_mfma_f32_16x16x32_bf16 a[8:11], a[180:183], v[68:71], a[8:11]
v_mfma_f32_16x16x32_bf16 a[8:11], a[184:187], v[72:75], a[8:11]
ds_read_b64_tr_b16 a[162:163], v31 offset:4736
v_mfma_f32_16x16x32_bf16 a[8:11], a[188:191], v[76:79], a[8:11]
s_add_u32 s17, s13, 4096
buffer_load_dwordx4 v[208:211], v2, s[52:55], s17 offen sc1
v_mfma_f32_16x16x32_bf16 a[44:47], a[176:179], v[80:83], a[44:47]
ds_read_b64_tr_b16 a[164:165], v31 offset:9344
v_mfma_f32_16x16x32_bf16 a[44:47], a[180:183], v[84:87], a[44:47]
v_mfma_f32_16x16x32_bf16 a[44:47], a[184:187], v[88:91], a[44:47]
ds_read_b64_tr_b16 a[166:167], v31 offset:13952
v_mfma_f32_16x16x32_bf16 a[44:47], a[188:191], v[92:95], a[44:47]
buffer_load_dwordx4 v[212:215], v2, s[52:55], s17 offen offset:1024 sc1
v_mfma_f32_16x16x32_bf16 a[80:83], a[176:179], v[96:99], a[80:83]
ds_read_b64_tr_b16 a[168:169], v31 offset:18560
v_mfma_f32_16x16x32_bf16 a[80:83], a[180:183], v[100:103], a[80:83]
v_mfma_f32_16x16x32_bf16 a[80:83], a[184:187], v[104:107], a[80:83]
ds_read_b64_tr_b16 a[170:171], v31 offset:23168
v_mfma_f32_16x16x32_bf16 a[80:83], a[188:191], v[108:111], a[80:83]
v_mfma_f32_16x16x32_bf16 a[116:119], a[176:179], v[112:115], a[116:119]
ds_read_b64_tr_b16 a[172:173], v31 offset:27776
v_mfma_f32_16x16x32_bf16 a[116:119], a[180:183], v[116:119], a[116:119]
s_add_u32 m0, m0, 1024
s_nop 0
buffer_load_dwordx4 v8, s[44:47], s21 offen lds
v_mfma_f32_16x16x32_bf16 a[116:119], a[184:187], v[120:123], a[116:119]
ds_read_b64_tr_b16 a[174:175], v31 offset:32384
v_mfma_f32_16x16x32_bf16 a[116:119], a[188:191], v[124:127], a[116:119]
s_waitcnt lgkmcnt(8)
v_mfma_f32_16x16x32_bf16 a[12:15], a[144:147], v[64:67], a[12:15]
ds_read_b64_tr_b16 a[176:177], v31 offset:160
v_mfma_f32_16x16x32_bf16 a[12:15], a[148:151], v[68:71], a[12:15]
v_mfma_f32_16x16x32_bf16 a[12:15], a[152:155], v[72:75], a[12:15]
ds_read_b64_tr_b16 a[178:179], v31 offset:4768
v_mfma_f32_16x16x32_bf16 a[12:15], a[156:159], v[76:79], a[12:15]
buffer_load_dwordx4 v[216:219], v2, s[52:55], s17 offen offset:2048 sc1
v_mfma_f32_16x16x32_bf16 a[48:51], a[144:147], v[80:83], a[48:51]
ds_read_b64_tr_b16 a[180:181], v31 offset:9376
v_mfma_f32_16x16x32_bf16 a[48:51], a[148:151], v[84:87], a[48:51]
v_mfma_f32_16x16x32_bf16 a[48:51], a[152:155], v[88:91], a[48:51]
ds_read_b64_tr_b16 a[182:183], v31 offset:13984
v_mfma_f32_16x16x32_bf16 a[48:51], a[156:159], v[92:95], a[48:51]
v_mfma_f32_16x16x32_bf16 a[84:87], a[144:147], v[96:99], a[84:87]
ds_read_b64_tr_b16 a[184:185], v31 offset:18592
v_mfma_f32_16x16x32_bf16 a[84:87], a[148:151], v[100:103], a[84:87]
buffer_load_dwordx4 v[220:223], v2, s[52:55], s17 offen offset:3072 sc1
v_mfma_f32_16x16x32_bf16 a[84:87], a[152:155], v[104:107], a[84:87]
ds_read_b64_tr_b16 a[186:187], v31 offset:23200
v_mfma_f32_16x16x32_bf16 a[84:87], a[156:159], v[108:111], a[84:87]
v_mfma_f32_16x16x32_bf16 a[120:123], a[144:147], v[112:115], a[120:123]
ds_read_b64_tr_b16 a[188:189], v31 offset:27808
v_mfma_f32_16x16x32_bf16 a[120:123], a[148:151], v[116:119], a[120:123]
s_add_u32 m0, m0, 1024
s_nop 0
buffer_load_dwordx4 v9, s[44:47], s21 offen lds
v_mfma_f32_16x16x32_bf16 a[120:123], a[152:155], v[120:123], a[120:123]
ds_read_b64_tr_b16 a[190:191], v31 offset:32416
v_mfma_f32_16x16x32_bf16 a[120:123], a[156:159], v[124:127], a[120:123]
s_waitcnt lgkmcnt(8)
v_mfma_f32_16x16x32_bf16 a[16:19], a[160:163], v[64:67], a[16:19]
ds_read_b64_tr_b16 a[144:145], v31 offset:192
v_mfma_f32_16x16x32_bf16 a[16:19], a[164:167], v[68:71], a[16:19]
v_mfma_f32_16x16x32_bf16 a[16:19], a[168:171], v[72:75], a[16:19]
ds_read_b64_tr_b16 a[146:147], v31 offset:4800
v_mfma_f32_16x16x32_bf16 a[16:19], a[172:175], v[76:79], a[16:19]
s_add_u32 s18, s14, 4096
buffer_load_dwordx4 v[224:227], v2, s[52:55], s18 offen sc1
v_mfma_f32_16x16x32_bf16 a[52:55], a[160:163], v[80:83], a[52:55]
ds_read_b64_tr_b16 a[148:149], v31 offset:9408
v_mfma_f32_16x16x32_bf16 a[52:55], a[164:167], v[84:87], a[52:55]
v_mfma_f32_16x16x32_bf16 a[52:55], a[168:171], v[88:91], a[52:55]
ds_read_b64_tr_b16 a[150:151], v31 offset:14016
v_mfma_f32_16x16x32_bf16 a[52:55], a[172:175], v[92:95], a[52:55]
v_mfma_f32_16x16x32_bf16 a[88:91], a[160:163], v[96:99], a[88:91]
ds_read_b64_tr_b16 a[152:153], v31 offset:18624
v_mfma_f32_16x16x32_bf16 a[88:91], a[164:167], v[100:103], a[88:91]
buffer_load_dwordx4 v[228:231], v2, s[52:55], s18 offen offset:1024 sc1
v_mfma_f32_16x16x32_bf16 a[88:91], a[168:171], v[104:107], a[88:91]
ds_read_b64_tr_b16 a[154:155], v31 offset:23232
v_mfma_f32_16x16x32_bf16 a[88:91], a[172:175], v[108:111], a[88:91]
v_mfma_f32_16x16x32_bf16 a[124:127], a[160:163], v[112:115], a[124:127]
ds_read_b64_tr_b16 a[156:157], v31 offset:27840
v_mfma_f32_16x16x32_bf16 a[124:127], a[164:167], v[116:119], a[124:127]
v_mfma_f32_16x16x32_bf16 a[124:127], a[168:171], v[120:123], a[124:127]
ds_read_b64_tr_b16 a[158:159], v31 offset:32448
v_mfma_f32_16x16x32_bf16 a[124:127], a[172:175], v[124:127], a[124:127]
s_waitcnt lgkmcnt(8)
s_add_u32 m0, m0, 1024
s_nop 0
buffer_load_dwordx4 v10, s[44:47], s21 offen lds
v_mfma_f32_16x16x32_bf16 a[20:23], a[176:179], v[64:67], a[20:23]
ds_read_b64_tr_b16 a[160:161], v31 offset:224
v_mfma_f32_16x16x32_bf16 a[20:23], a[180:183], v[68:71], a[20:23]
v_mfma_f32_16x16x32_bf16 a[20:23], a[184:187], v[72:75], a[20:23]
ds_read_b64_tr_b16 a[162:163], v31 offset:4832
v_mfma_f32_16x16x32_bf16 a[20:23], a[188:191], v[76:79], a[20:23]
buffer_load_dwordx4 v[232:235], v2, s[52:55], s18 offen offset:2048 sc1
v_mfma_f32_16x16x32_bf16 a[56:59], a[176:179], v[80:83], a[56:59]
ds_read_b64_tr_b16 a[164:165], v31 offset:9440
v_mfma_f32_16x16x32_bf16 a[56:59], a[180:183], v[84:87], a[56:59]
v_mfma_f32_16x16x32_bf16 a[56:59], a[184:187], v[88:91], a[56:59]
ds_read_b64_tr_b16 a[166:167], v31 offset:14048
v_mfma_f32_16x16x32_bf16 a[56:59], a[188:191], v[92:95], a[56:59]
v_mfma_f32_16x16x32_bf16 a[92:95], a[176:179], v[96:99], a[92:95]
ds_read_b64_tr_b16 a[168:169], v31 offset:18656
v_mfma_f32_16x16x32_bf16 a[92:95], a[180:183], v[100:103], a[92:95]
buffer_load_dwordx4 v[236:239], v2, s[52:55], s18 offen offset:3072 sc1
v_mfma_f32_16x16x32_bf16 a[92:95], a[184:187], v[104:107], a[92:95]
ds_read_b64_tr_b16 a[170:171], v31 offset:23264
v_mfma_f32_16x16x32_bf16 a[92:95], a[188:191], v[108:111], a[92:95]
v_mfma_f32_16x16x32_bf16 a[128:131], a[176:179], v[112:115], a[128:131]
ds_read_b64_tr_b16 a[172:173], v31 offset:27872
v_mfma_f32_16x16x32_bf16 a[128:131], a[180:183], v[116:119], a[128:131]
v_mfma_f32_16x16x32_bf16 a[128:131], a[184:187], v[120:123], a[128:131]
ds_read_b64_tr_b16 a[174:175], v31 offset:32480
v_mfma_f32_16x16x32_bf16 a[128:131], a[188:191], v[124:127], a[128:131]
s_waitcnt lgkmcnt(8)
s_add_u32 m0, m0, 1024
s_nop 0
buffer_load_dwordx4 v11, s[44:47], s21 offen lds
v_mfma_f32_16x16x32_bf16 a[24:27], a[144:147], v[64:67], a[24:27]
ds_read_b64_tr_b16 a[176:177], v31 offset:256
v_mfma_f32_16x16x32_bf16 a[24:27], a[148:151], v[68:71], a[24:27]
v_mfma_f32_16x16x32_bf16 a[24:27], a[152:155], v[72:75], a[24:27]
ds_read_b64_tr_b16 a[178:179], v31 offset:4864
v_mfma_f32_16x16x32_bf16 a[24:27], a[156:159], v[76:79], a[24:27]
v_mfma_f32_16x16x32_bf16 a[60:63], a[144:147], v[80:83], a[60:63]
ds_read_b64_tr_b16 a[180:181], v31 offset:9472
v_mfma_f32_16x16x32_bf16 a[60:63], a[148:151], v[84:87], a[60:63]
s_add_u32 s19, s15, 4096
buffer_load_dwordx4 v[240:243], v2, s[52:55], s19 offen sc1
v_mfma_f32_16x16x32_bf16 a[60:63], a[152:155], v[88:91], a[60:63]
ds_read_b64_tr_b16 a[182:183], v31 offset:14080
v_mfma_f32_16x16x32_bf16 a[60:63], a[156:159], v[92:95], a[60:63]
v_mfma_f32_16x16x32_bf16 a[96:99], a[144:147], v[96:99], a[96:99]
ds_read_b64_tr_b16 a[184:185], v31 offset:18688
v_mfma_f32_16x16x32_bf16 a[96:99], a[148:151], v[100:103], a[96:99]
buffer_load_dwordx4 v[244:247], v2, s[52:55], s19 offen offset:1024 sc1
v_mfma_f32_16x16x32_bf16 a[96:99], a[152:155], v[104:107], a[96:99]
ds_read_b64_tr_b16 a[186:187], v31 offset:23296
v_mfma_f32_16x16x32_bf16 a[96:99], a[156:159], v[108:111], a[96:99]
v_mfma_f32_16x16x32_bf16 a[132:135], a[144:147], v[112:115], a[132:135]
ds_read_b64_tr_b16 a[188:189], v31 offset:27904
v_mfma_f32_16x16x32_bf16 a[132:135], a[148:151], v[116:119], a[132:135]
v_mfma_f32_16x16x32_bf16 a[132:135], a[152:155], v[120:123], a[132:135]
ds_read_b64_tr_b16 a[190:191], v31 offset:32512
v_mfma_f32_16x16x32_bf16 a[132:135], a[156:159], v[124:127], a[132:135]
s_waitcnt lgkmcnt(8)
s_add_u32 m0, m0, 1024
s_nop 0
buffer_load_dwordx4 v12, s[44:47], s21 offen lds
v_mfma_f32_16x16x32_bf16 a[28:31], a[160:163], v[64:67], a[28:31]
v_mfma_f32_16x16x32_bf16 a[28:31], a[164:167], v[68:71], a[28:31]
v_mfma_f32_16x16x32_bf16 a[28:31], a[168:171], v[72:75], a[28:31]
s_waitcnt vmcnt(46) lgkmcnt(0)
s_barrier
v_mfma_f32_16x16x32_bf16 a[28:31], a[172:175], v[76:79], a[28:31]
ds_read_b64_tr_b16 a[144:145], v28
v_mfma_f32_16x16x32_bf16 a[64:67], a[160:163], v[80:83], a[64:67]
ds_read_b64_tr_b16 a[146:147], v28 offset:4608
v_mfma_f32_16x16x32_bf16 a[64:67], a[164:167], v[84:87], a[64:67]
buffer_load_dwordx4 v[248:251], v2, s[52:55], s19 offen offset:2048 sc1
v_mfma_f32_16x16x32_bf16 a[64:67], a[168:171], v[88:91], a[64:67]
ds_read_b64_tr_b16 a[148:149], v28 offset:9216
v_mfma_f32_16x16x32_bf16 a[64:67], a[172:175], v[92:95], a[64:67]
ds_read_b64_tr_b16 a[150:151], v28 offset:13824
v_mfma_f32_16x16x32_bf16 a[100:103], a[160:163], v[96:99], a[100:103]
v_mfma_f32_16x16x32_bf16 a[100:103], a[164:167], v[100:103], a[100:103]
ds_read_b64_tr_b16 a[152:153], v28 offset:18432
v_mfma_f32_16x16x32_bf16 a[100:103], a[168:171], v[104:107], a[100:103]
buffer_load_dwordx4 v[252:255], v2, s[52:55], s19 offen offset:3072 sc1
v_mfma_f32_16x16x32_bf16 a[100:103], a[172:175], v[108:111], a[100:103]
ds_read_b64_tr_b16 a[154:155], v28 offset:23040
v_mfma_f32_16x16x32_bf16 a[136:139], a[160:163], v[112:115], a[136:139]
ds_read_b64_tr_b16 a[156:157], v28 offset:27648
v_mfma_f32_16x16x32_bf16 a[136:139], a[164:167], v[116:119], a[136:139]
v_mfma_f32_16x16x32_bf16 a[136:139], a[168:171], v[120:123], a[136:139]
ds_read_b64_tr_b16 a[158:159], v28 offset:32256
v_mfma_f32_16x16x32_bf16 a[136:139], a[172:175], v[124:127], a[136:139]
s_add_u32 m0, m0, 1024
s_nop 0
buffer_load_dwordx4 v13, s[44:47], s21 offen lds
v_mfma_f32_16x16x32_bf16 a[32:35], a[176:179], v[64:67], a[32:35]
ds_read_b64_tr_b16 a[160:161], v28 offset:32
v_mfma_f32_16x16x32_bf16 a[32:35], a[180:183], v[68:71], a[32:35]
ds_read_b64_tr_b16 a[162:163], v28 offset:4640
v_mfma_f32_16x16x32_bf16 a[32:35], a[184:187], v[72:75], a[32:35]
v_mfma_f32_16x16x32_bf16 a[32:35], a[188:191], v[76:79], a[32:35]
ds_read_b64_tr_b16 a[164:165], v28 offset:9248
v_mfma_f32_16x16x32_bf16 a[68:71], a[176:179], v[80:83], a[68:71]
ds_read_b64_tr_b16 a[166:167], v28 offset:13856
v_mfma_f32_16x16x32_bf16 a[68:71], a[180:183], v[84:87], a[68:71]
s_add_u32 m0, m0, 1024
s_nop 0
buffer_load_dwordx4 v14, s[44:47], s21 offen lds
v_mfma_f32_16x16x32_bf16 a[68:71], a[184:187], v[88:91], a[68:71]
ds_read_b64_tr_b16 a[168:169], v28 offset:18464
v_mfma_f32_16x16x32_bf16 a[68:71], a[188:191], v[92:95], a[68:71]
v_mfma_f32_16x16x32_bf16 a[104:107], a[176:179], v[96:99], a[104:107]
ds_read_b64_tr_b16 a[170:171], v28 offset:23072
v_mfma_f32_16x16x32_bf16 a[104:107], a[180:183], v[100:103], a[104:107]
ds_read_b64_tr_b16 a[172:173], v28 offset:27680
v_mfma_f32_16x16x32_bf16 a[104:107], a[184:187], v[104:107], a[104:107]
v_mfma_f32_16x16x32_bf16 a[104:107], a[188:191], v[108:111], a[104:107]
ds_read_b64_tr_b16 a[174:175], v28 offset:32288
v_mfma_f32_16x16x32_bf16 a[140:143], a[176:179], v[112:115], a[140:143]
v_mfma_f32_16x16x32_bf16 a[140:143], a[180:183], v[116:119], a[140:143]
v_mfma_f32_16x16x32_bf16 a[140:143], a[184:187], v[120:123], a[140:143]
v_mfma_f32_16x16x32_bf16 a[140:143], a[188:191], v[124:127], a[140:143]
s_waitcnt vmcnt(45) lgkmcnt(8)
v_mfma_f32_16x16x32_bf16 a[0:3], a[144:147], v[128:131], a[0:3]
ds_read_b64_tr_b16 a[176:177], v28 offset:64
v_mfma_f32_16x16x32_bf16 a[0:3], a[148:151], v[132:135], a[0:3]
s_add_u32 s16, s12, 8192
buffer_load_dwordx4 v[64:67], v2, s[52:55], s16 offen sc1
v_mfma_f32_16x16x32_bf16 a[0:3], a[152:155], v[136:139], a[0:3]
ds_read_b64_tr_b16 a[178:179], v28 offset:4672
v_mfma_f32_16x16x32_bf16 a[0:3], a[156:159], v[140:143], a[0:3]
s_waitcnt vmcnt(40)
v_mfma_f32_16x16x32_bf16 a[36:39], a[144:147], v[144:147], a[36:39]
ds_read_b64_tr_b16 a[180:181], v28 offset:9280
v_mfma_f32_16x16x32_bf16 a[36:39], a[148:151], v[148:151], a[36:39]
v_mfma_f32_16x16x32_bf16 a[36:39], a[152:155], v[152:155], a[36:39]
ds_read_b64_tr_b16 a[182:183], v28 offset:13888
v_mfma_f32_16x16x32_bf16 a[36:39], a[156:159], v[156:159], a[36:39]
s_waitcnt vmcnt(34)
buffer_load_dwordx4 v[68:71], v2, s[52:55], s16 offen offset:1024 sc1
v_mfma_f32_16x16x32_bf16 a[72:75], a[144:147], v[160:163], a[72:75]
ds_read_b64_tr_b16 a[184:185], v28 offset:18496
v_mfma_f32_16x16x32_bf16 a[72:75], a[148:151], v[164:167], a[72:75]
v_mfma_f32_16x16x32_bf16 a[72:75], a[152:155], v[168:171], a[72:75]
ds_read_b64_tr_b16 a[186:187], v28 offset:23104
v_mfma_f32_16x16x32_bf16 a[72:75], a[156:159], v[172:175], a[72:75]
s_waitcnt vmcnt(29)
v_mfma_f32_16x16x32_bf16 a[108:111], a[144:147], v[176:179], a[108:111]
ds_read_b64_tr_b16 a[188:189], v28 offset:27712
v_mfma_f32_16x16x32_bf16 a[108:111], a[148:151], v[180:183], a[108:111]
s_add_u32 m0, s24, 110592
s_add_u32 s21, s26, 442368
buffer_load_dwordx4 v6, s[44:47], s21 offen lds
v_mfma_f32_16x16x32_bf16 a[108:111], a[152:155], v[184:187], a[108:111]
ds_read_b64_tr_b16 a[190:191], v28 offset:32320
v_mfma_f32_16x16x32_bf16 a[108:111], a[156:159], v[188:191], a[108:111]
s_waitcnt lgkmcnt(8)
v_mfma_f32_16x16x32_bf16 a[4:7], a[160:163], v[128:131], a[4:7]
ds_read_b64_tr_b16 a[144:145], v28 offset:96
v_mfma_f32_16x16x32_bf16 a[4:7], a[164:167], v[132:135], a[4:7]
buffer_load_dwordx4 v[72:75], v2, s[52:55], s16 offen offset:2048 sc1
v_mfma_f32_16x16x32_bf16 a[4:7], a[168:171], v[136:139], a[4:7]
ds_read_b64_tr_b16 a[146:147], v28 offset:4704
v_mfma_f32_16x16x32_bf16 a[4:7], a[172:175], v[140:143], a[4:7]
v_mfma_f32_16x16x32_bf16 a[40:43], a[160:163], v[144:147], a[40:43]
ds_read_b64_tr_b16 a[148:149], v28 offset:9312
v_mfma_f32_16x16x32_bf16 a[40:43], a[164:167], v[148:151], a[40:43]
v_mfma_f32_16x16x32_bf16 a[40:43], a[168:171], v[152:155], a[40:43]
ds_read_b64_tr_b16 a[150:151], v28 offset:13920
v_mfma_f32_16x16x32_bf16 a[40:43], a[172:175], v[156:159], a[40:43]
buffer_load_dwordx4 v[76:79], v2, s[52:55], s16 offen offset:3072 sc1
v_mfma_f32_16x16x32_bf16 a[76:79], a[160:163], v[160:163], a[76:79]
ds_read_b64_tr_b16 a[152:153], v28 offset:18528
v_mfma_f32_16x16x32_bf16 a[76:79], a[164:167], v[164:167], a[76:79]
v_mfma_f32_16x16x32_bf16 a[76:79], a[168:171], v[168:171], a[76:79]
ds_read_b64_tr_b16 a[154:155], v28 offset:23136
v_mfma_f32_16x16x32_bf16 a[76:79], a[172:175], v[172:175], a[76:79]
v_mfma_f32_16x16x32_bf16 a[112:115], a[160:163], v[176:179], a[112:115]
ds_read_b64_tr_b16 a[156:157], v28 offset:27744
v_mfma_f32_16x16x32_bf16 a[112:115], a[164:167], v[180:183], a[112:115]
s_add_u32 m0, m0, 1024
s_nop 0
buffer_load_dwordx4 v7, s[44:47], s21 offen lds
v_mfma_f32_16x16x32_bf16 a[112:115], a[168:171], v[184:187], a[112:115]
ds_read_b64_tr_b16 a[158:159], v28 offset:32352
v_mfma_f32_16x16x32_bf16 a[112:115], a[172:175], v[188:191], a[112:115]
s_waitcnt lgkmcnt(8)
v_mfma_f32_16x16x32_bf16 a[8:11], a[176:179], v[128:131], a[8:11]
ds_read_b64_tr_b16 a[160:161], v28 offset:128
v_mfma_f32_16x16x32_bf16 a[8:11], a[180:183], v[132:135], a[8:11]
v_mfma_f32_16x16x32_bf16 a[8:11], a[184:187], v[136:139], a[8:11]
ds_read_b64_tr_b16 a[162:163], v28 offset:4736
v_mfma_f32_16x16x32_bf16 a[8:11], a[188:191], v[140:143], a[8:11]
s_add_u32 s17, s13, 8192
buffer_load_dwordx4 v[80:83], v2, s[52:55], s17 offen sc1
v_mfma_f32_16x16x32_bf16 a[44:47], a[176:179], v[144:147], a[44:47]
ds_read_b64_tr_b16 a[164:165], v28 offset:9344
v_mfma_f32_16x16x32_bf16 a[44:47], a[180:183], v[148:151], a[44:47]
v_mfma_f32_16x16x32_bf16 a[44:47], a[184:187], v[152:155], a[44:47]
ds_read_b64_tr_b16 a[166:167], v28 offset:13952
v_mfma_f32_16x16x32_bf16 a[44:47], a[188:191], v[156:159], a[44:47]
buffer_load_dwordx4 v[84:87], v2, s[52:55], s17 offen offset:1024 sc1
v_mfma_f32_16x16x32_bf16 a[80:83], a[176:179], v[160:163], a[80:83]
ds_read_b64_tr_b16 a[168:169], v28 offset:18560
v_mfma_f32_16x16x32_bf16 a[80:83], a[180:183], v[164:167], a[80:83]
v_mfma_f32_16x16x32_bf16 a[80:83], a[184:187], v[168:171], a[80:83]
ds_read_b64_tr_b16 a[170:171], v28 offset:23168
v_mfma_f32_16x16x32_bf16 a[80:83], a[188:191], v[172:175], a[80:83]
v_mfma_f32_16x16x32_bf16 a[116:119], a[176:179], v[176:179], a[116:119]
ds_read_b64_tr_b16 a[172:173], v28 offset:27776
v_mfma_f32_16x16x32_bf16 a[116:119], a[180:183], v[180:183], a[116:119]
s_add_u32 m0, m0, 1024
s_nop 0
buffer_load_dwordx4 v8, s[44:47], s21 offen lds
v_mfma_f32_16x16x32_bf16 a[116:119], a[184:187], v[184:187], a[116:119]
ds_read_b64_tr_b16 a[174:175], v28 offset:32384
v_mfma_f32_16x16x32_bf16 a[116:119], a[188:191], v[188:191], a[116:119]
s_waitcnt lgkmcnt(8)
v_mfma_f32_16x16x32_bf16 a[12:15], a[144:147], v[128:131], a[12:15]
ds_read_b64_tr_b16 a[176:177], v28 offset:160
v_mfma_f32_16x16x32_bf16 a[12:15], a[148:151], v[132:135], a[12:15]
v_mfma_f32_16x16x32_bf16 a[12:15], a[152:155], v[136:139], a[12:15]
ds_read_b64_tr_b16 a[178:179], v28 offset:4768
v_mfma_f32_16x16x32_bf16 a[12:15], a[156:159], v[140:143], a[12:15]
buffer_load_dwordx4 v[88:91], v2, s[52:55], s17 offen offset:2048 sc1
v_mfma_f32_16x16x32_bf16 a[48:51], a[144:147], v[144:147], a[48:51]
ds_read_b64_tr_b16 a[180:181], v28 offset:9376
v_mfma_f32_16x16x32_bf16 a[48:51], a[148:151], v[148:151], a[48:51]
v_mfma_f32_16x16x32_bf16 a[48:51], a[152:155], v[152:155], a[48:51]
ds_read_b64_tr_b16 a[182:183], v28 offset:13984
v_mfma_f32_16x16x32_bf16 a[48:51], a[156:159], v[156:159], a[48:51]
v_mfma_f32_16x16x32_bf16 a[84:87], a[144:147], v[160:163], a[84:87]
ds_read_b64_tr_b16 a[184:185], v28 offset:18592
v_mfma_f32_16x16x32_bf16 a[84:87], a[148:151], v[164:167], a[84:87]
buffer_load_dwordx4 v[92:95], v2, s[52:55], s17 offen offset:3072 sc1
v_mfma_f32_16x16x32_bf16 a[84:87], a[152:155], v[168:171], a[84:87]
ds_read_b64_tr_b16 a[186:187], v28 offset:23200
v_mfma_f32_16x16x32_bf16 a[84:87], a[156:159], v[172:175], a[84:87]
v_mfma_f32_16x16x32_bf16 a[120:123], a[144:147], v[176:179], a[120:123]
ds_read_b64_tr_b16 a[188:189], v28 offset:27808
v_mfma_f32_16x16x32_bf16 a[120:123], a[148:151], v[180:183], a[120:123]
s_add_u32 m0, m0, 1024
s_nop 0
buffer_load_dwordx4 v9, s[44:47], s21 offen lds
v_mfma_f32_16x16x32_bf16 a[120:123], a[152:155], v[184:187], a[120:123]
ds_read_b64_tr_b16 a[190:191], v28 offset:32416
v_mfma_f32_16x16x32_bf16 a[120:123], a[156:159], v[188:191], a[120:123]
s_waitcnt lgkmcnt(8)
v_mfma_f32_16x16x32_bf16 a[16:19], a[160:163], v[128:131], a[16:19]
ds_read_b64_tr_b16 a[144:145], v28 offset:192
v_mfma_f32_16x16x32_bf16 a[16:19], a[164:167], v[132:135], a[16:19]
v_mfma_f32_16x16x32_bf16 a[16:19], a[168:171], v[136:139], a[16:19]
ds_read_b64_tr_b16 a[146:147], v28 offset:4800
v_mfma_f32_16x16x32_bf16 a[16:19], a[172:175], v[140:143], a[16:19]
s_add_u32 s18, s14, 8192
buffer_load_dwordx4 v[96:99], v2, s[52:55], s18 offen sc1
v_mfma_f32_16x16x32_bf16 a[52:55], a[160:163], v[144:147], a[52:55]
ds_read_b64_tr_b16 a[148:149], v28 offset:9408
v_mfma_f32_16x16x32_bf16 a[52:55], a[164:167], v[148:151], a[52:55]
v_mfma_f32_16x16x32_bf16 a[52:55], a[168:171], v[152:155], a[52:55]
ds_read_b64_tr_b16 a[150:151], v28 offset:14016
v_mfma_f32_16x16x32_bf16 a[52:55], a[172:175], v[156:159], a[52:55]
v_mfma_f32_16x16x32_bf16 a[88:91], a[160:163], v[160:163], a[88:91]
ds_read_b64_tr_b16 a[152:153], v28 offset:18624
v_mfma_f32_16x16x32_bf16 a[88:91], a[164:167], v[164:167], a[88:91]
buffer_load_dwordx4 v[100:103], v2, s[52:55], s18 offen offset:1024 sc1
v_mfma_f32_16x16x32_bf16 a[88:91], a[168:171], v[168:171], a[88:91]
ds_read_b64_tr_b16 a[154:155], v28 offset:23232
v_mfma_f32_16x16x32_bf16 a[88:91], a[172:175], v[172:175], a[88:91]
v_mfma_f32_16x16x32_bf16 a[124:127], a[160:163], v[176:179], a[124:127]
ds_read_b64_tr_b16 a[156:157], v28 offset:27840
v_mfma_f32_16x16x32_bf16 a[124:127], a[164:167], v[180:183], a[124:127]
v_mfma_f32_16x16x32_bf16 a[124:127], a[168:171], v[184:187], a[124:127]
ds_read_b64_tr_b16 a[158:159], v28 offset:32448
v_mfma_f32_16x16x32_bf16 a[124:127], a[172:175], v[188:191], a[124:127]
s_waitcnt lgkmcnt(8)
s_add_u32 m0, m0, 1024
s_nop 0
buffer_load_dwordx4 v10, s[44:47], s21 offen lds
v_mfma_f32_16x16x32_bf16 a[20:23], a[176:179], v[128:131], a[20:23]
ds_read_b64_tr_b16 a[160:161], v28 offset:224
v_mfma_f32_16x16x32_bf16 a[20:23], a[180:183], v[132:135], a[20:23]
v_mfma_f32_16x16x32_bf16 a[20:23], a[184:187], v[136:139], a[20:23]
ds_read_b64_tr_b16 a[162:163], v28 offset:4832
v_mfma_f32_16x16x32_bf16 a[20:23], a[188:191], v[140:143], a[20:23]
buffer_load_dwordx4 v[104:107], v2, s[52:55], s18 offen offset:2048 sc1
v_mfma_f32_16x16x32_bf16 a[56:59], a[176:179], v[144:147], a[56:59]
ds_read_b64_tr_b16 a[164:165], v28 offset:9440
v_mfma_f32_16x16x32_bf16 a[56:59], a[180:183], v[148:151], a[56:59]
v_mfma_f32_16x16x32_bf16 a[56:59], a[184:187], v[152:155], a[56:59]
ds_read_b64_tr_b16 a[166:167], v28 offset:14048
v_mfma_f32_16x16x32_bf16 a[56:59], a[188:191], v[156:159], a[56:59]
v_mfma_f32_16x16x32_bf16 a[92:95], a[176:179], v[160:163], a[92:95]
ds_read_b64_tr_b16 a[168:169], v28 offset:18656
v_mfma_f32_16x16x32_bf16 a[92:95], a[180:183], v[164:167], a[92:95]
buffer_load_dwordx4 v[108:111], v2, s[52:55], s18 offen offset:3072 sc1
v_mfma_f32_16x16x32_bf16 a[92:95], a[184:187], v[168:171], a[92:95]
ds_read_b64_tr_b16 a[170:171], v28 offset:23264
v_mfma_f32_16x16x32_bf16 a[92:95], a[188:191], v[172:175], a[92:95]
v_mfma_f32_16x16x32_bf16 a[128:131], a[176:179], v[176:179], a[128:131]
ds_read_b64_tr_b16 a[172:173], v28 offset:27872
v_mfma_f32_16x16x32_bf16 a[128:131], a[180:183], v[180:183], a[128:131]
v_mfma_f32_16x16x32_bf16 a[128:131], a[184:187], v[184:187], a[128:131]
ds_read_b64_tr_b16 a[174:175], v28 offset:32480
v_mfma_f32_16x16x32_bf16 a[128:131], a[188:191], v[188:191], a[128:131]
s_waitcnt lgkmcnt(8)
s_add_u32 m0, m0, 1024
s_nop 0
buffer_load_dwordx4 v11, s[44:47], s21 offen lds
v_mfma_f32_16x16x32_bf16 a[24:27], a[144:147], v[128:131], a[24:27]
ds_read_b64_tr_b16 a[176:177], v28 offset:256
v_mfma_f32_16x16x32_bf16 a[24:27], a[148:151], v[132:135], a[24:27]
v_mfma_f32_16x16x32_bf16 a[24:27], a[152:155], v[136:139], a[24:27]
ds_read_b64_tr_b16 a[178:179], v28 offset:4864
v_mfma_f32_16x16x32_bf16 a[24:27], a[156:159], v[140:143], a[24:27]
v_mfma_f32_16x16x32_bf16 a[60:63], a[144:147], v[144:147], a[60:63]
ds_read_b64_tr_b16 a[180:181], v28 offset:9472
v_mfma_f32_16x16x32_bf16 a[60:63], a[148:151], v[148:151], a[60:63]
s_add_u32 s19, s15, 8192
buffer_load_dwordx4 v[112:115], v2, s[52:55], s19 offen sc1
v_mfma_f32_16x16x32_bf16 a[60:63], a[152:155], v[152:155], a[60:63]
ds_read_b64_tr_b16 a[182:183], v28 offset:14080
v_mfma_f32_16x16x32_bf16 a[60:63], a[156:159], v[156:159], a[60:63]
v_mfma_f32_16x16x32_bf16 a[96:99], a[144:147], v[160:163], a[96:99]
ds_read_b64_tr_b16 a[184:185], v28 offset:18688
v_mfma_f32_16x16x32_bf16 a[96:99], a[148:151], v[164:167], a[96:99]
buffer_load_dwordx4 v[116:119], v2, s[52:55], s19 offen offset:1024 sc1
v_mfma_f32_16x16x32_bf16 a[96:99], a[152:155], v[168:171], a[96:99]
ds_read_b64_tr_b16 a[186:187], v28 offset:23296
v_mfma_f32_16x16x32_bf16 a[96:99], a[156:159], v[172:175], a[96:99]
v_mfma_f32_16x16x32_bf16 a[132:135], a[144:147], v[176:179], a[132:135]
ds_read_b64_tr_b16 a[188:189], v28 offset:27904
v_mfma_f32_16x16x32_bf16 a[132:135], a[148:151], v[180:183], a[132:135]
v_mfma_f32_16x16x32_bf16 a[132:135], a[152:155], v[184:187], a[132:135]
ds_read_b64_tr_b16 a[190:191], v28 offset:32512
v_mfma_f32_16x16x32_bf16 a[132:135], a[156:159], v[188:191], a[132:135]
s_waitcnt lgkmcnt(8)
s_add_u32 m0, m0, 1024
s_nop 0
buffer_load_dwordx4 v12, s[44:47], s21 offen lds
v_mfma_f32_16x16x32_bf16 a[28:31], a[160:163], v[128:131], a[28:31]
v_mfma_f32_16x16x32_bf16 a[28:31], a[164:167], v[132:135], a[28:31]
v_mfma_f32_16x16x32_bf16 a[28:31], a[168:171], v[136:139], a[28:31]
s_waitcnt vmcnt(46) lgkmcnt(0)
s_barrier
v_mfma_f32_16x16x32_bf16 a[28:31], a[172:175], v[140:143], a[28:31]
ds_read_b64_tr_b16 a[144:145], v29
v_mfma_f32_16x16x32_bf16 a[64:67], a[160:163], v[144:147], a[64:67]
ds_read_b64_tr_b16 a[146:147], v29 offset:4608
v_mfma_f32_16x16x32_bf16 a[64:67], a[164:167], v[148:151], a[64:67]
buffer_load_dwordx4 v[120:123], v2, s[52:55], s19 offen offset:2048 sc1
v_mfma_f32_16x16x32_bf16 a[64:67], a[168:171], v[152:155], a[64:67]
ds_read_b64_tr_b16 a[148:149], v29 offset:9216
v_mfma_f32_16x16x32_bf16 a[64:67], a[172:175], v[156:159], a[64:67]
ds_read_b64_tr_b16 a[150:151], v29 offset:13824
v_mfma_f32_16x16x32_bf16 a[100:103], a[160:163], v[160:163], a[100:103]
v_mfma_f32_16x16x32_bf16 a[100:103], a[164:167], v[164:167], a[100:103]
ds_read_b64_tr_b16 a[152:153], v29 offset:18432
v_mfma_f32_16x16x32_bf16 a[100:103], a[168:171], v[168:171], a[100:103]
buffer_load_dwordx4 v[124:127], v2, s[52:55], s19 offen offset:3072 sc1
v_mfma_f32_16x16x32_bf16 a[100:103], a[172:175], v[172:175], a[100:103]
ds_read_b64_tr_b16 a[154:155], v29 offset:23040
v_mfma_f32_16x16x32_bf16 a[136:139], a[160:163], v[176:179], a[136:139]
ds_read_b64_tr_b16 a[156:157], v29 offset:27648
v_mfma_f32_16x16x32_bf16 a[136:139], a[164:167], v[180:183], a[136:139]
v_mfma_f32_16x16x32_bf16 a[136:139], a[168:171], v[184:187], a[136:139]
ds_read_b64_tr_b16 a[158:159], v29 offset:32256
v_mfma_f32_16x16x32_bf16 a[136:139], a[172:175], v[188:191], a[136:139]
s_add_u32 m0, m0, 1024
s_nop 0
buffer_load_dwordx4 v13, s[44:47], s21 offen lds
v_mfma_f32_16x16x32_bf16 a[32:35], a[176:179], v[128:131], a[32:35]
ds_read_b64_tr_b16 a[160:161], v29 offset:32
v_mfma_f32_16x16x32_bf16 a[32:35], a[180:183], v[132:135], a[32:35]
ds_read_b64_tr_b16 a[162:163], v29 offset:4640
v_mfma_f32_16x16x32_bf16 a[32:35], a[184:187], v[136:139], a[32:35]
v_mfma_f32_16x16x32_bf16 a[32:35], a[188:191], v[140:143], a[32:35]
ds_read_b64_tr_b16 a[164:165], v29 offset:9248
v_mfma_f32_16x16x32_bf16 a[68:71], a[176:179], v[144:147], a[68:71]
ds_read_b64_tr_b16 a[166:167], v29 offset:13856
v_mfma_f32_16x16x32_bf16 a[68:71], a[180:183], v[148:151], a[68:71]
s_add_u32 m0, m0, 1024
s_nop 0
buffer_load_dwordx4 v14, s[44:47], s21 offen lds
v_mfma_f32_16x16x32_bf16 a[68:71], a[184:187], v[152:155], a[68:71]
ds_read_b64_tr_b16 a[168:169], v29 offset:18464
v_mfma_f32_16x16x32_bf16 a[68:71], a[188:191], v[156:159], a[68:71]
v_mfma_f32_16x16x32_bf16 a[104:107], a[176:179], v[160:163], a[104:107]
ds_read_b64_tr_b16 a[170:171], v29 offset:23072
v_mfma_f32_16x16x32_bf16 a[104:107], a[180:183], v[164:167], a[104:107]
ds_read_b64_tr_b16 a[172:173], v29 offset:27680
v_mfma_f32_16x16x32_bf16 a[104:107], a[184:187], v[168:171], a[104:107]
v_mfma_f32_16x16x32_bf16 a[104:107], a[188:191], v[172:175], a[104:107]
ds_read_b64_tr_b16 a[174:175], v29 offset:32288
v_mfma_f32_16x16x32_bf16 a[140:143], a[176:179], v[176:179], a[140:143]
v_mfma_f32_16x16x32_bf16 a[140:143], a[180:183], v[180:183], a[140:143]
v_mfma_f32_16x16x32_bf16 a[140:143], a[184:187], v[184:187], a[140:143]
v_mfma_f32_16x16x32_bf16 a[140:143], a[188:191], v[188:191], a[140:143]
s_waitcnt vmcnt(45) lgkmcnt(8)
v_mfma_f32_16x16x32_bf16 a[0:3], a[144:147], v[192:195], a[0:3]
ds_read_b64_tr_b16 a[176:177], v29 offset:64
v_mfma_f32_16x16x32_bf16 a[0:3], a[148:151], v[196:199], a[0:3]
s_add_u32 s16, s12, 12288
buffer_load_dwordx4 v[128:131], v2, s[52:55], s16 offen sc1
v_mfma_f32_16x16x32_bf16 a[0:3], a[152:155], v[200:203], a[0:3]
ds_read_b64_tr_b16 a[178:179], v29 offset:4672
v_mfma_f32_16x16x32_bf16 a[0:3], a[156:159], v[204:207], a[0:3]
s_waitcnt vmcnt(40)
v_mfma_f32_16x16x32_bf16 a[36:39], a[144:147], v[208:211], a[36:39]
ds_read_b64_tr_b16 a[180:181], v29 offset:9280
v_mfma_f32_16x16x32_bf16 a[36:39], a[148:151], v[212:215], a[36:39]
v_mfma_f32_16x16x32_bf16 a[36:39], a[152:155], v[216:219], a[36:39]
ds_read_b64_tr_b16 a[182:183], v29 offset:13888
v_mfma_f32_16x16x32_bf16 a[36:39], a[156:159], v[220:223], a[36:39]
s_waitcnt vmcnt(34)
v_mfma_f32_16x16x32_bf16 a[72:75], a[144:147], v[224:227], a[72:75]
ds_read_b64_tr_b16 a[184:185], v29 offset:18496
v_mfma_f32_16x16x32_bf16 a[72:75], a[148:151], v[228:231], a[72:75]
buffer_load_dwordx4 v[132:135], v2, s[52:55], s16 offen offset:1024 sc1
v_mfma_f32_16x16x32_bf16 a[72:75], a[152:155], v[232:235], a[72:75]
ds_read_b64_tr_b16 a[186:187], v29 offset:23104
v_mfma_f32_16x16x32_bf16 a[72:75], a[156:159], v[236:239], a[72:75]
s_waitcnt vmcnt(29)
v_mfma_f32_16x16x32_bf16 a[108:111], a[144:147], v[240:243], a[108:111]
ds_read_b64_tr_b16 a[188:189], v29 offset:27712
v_mfma_f32_16x16x32_bf16 a[108:111], a[148:151], v[244:247], a[108:111]
v_mfma_f32_16x16x32_bf16 a[108:111], a[152:155], v[248:251], a[108:111]
ds_read_b64_tr_b16 a[190:191], v29 offset:32320
v_mfma_f32_16x16x32_bf16 a[108:111], a[156:159], v[252:255], a[108:111]
s_waitcnt lgkmcnt(8)
v_mfma_f32_16x16x32_bf16 a[4:7], a[160:163], v[192:195], a[4:7]
ds_read_b64_tr_b16 a[144:145], v29 offset:96
v_mfma_f32_16x16x32_bf16 a[4:7], a[164:167], v[196:199], a[4:7]
v_mfma_f32_16x16x32_bf16 a[4:7], a[168:171], v[200:203], a[4:7]
ds_read_b64_tr_b16 a[146:147], v29 offset:4704
v_mfma_f32_16x16x32_bf16 a[4:7], a[172:175], v[204:207], a[4:7]
buffer_load_dwordx4 v[136:139], v2, s[52:55], s16 offen offset:2048 sc1
v_mfma_f32_16x16x32_bf16 a[40:43], a[160:163], v[208:211], a[40:43]
ds_read_b64_tr_b16 a[148:149], v29 offset:9312
v_mfma_f32_16x16x32_bf16 a[40:43], a[164:167], v[212:215], a[40:43]
v_mfma_f32_16x16x32_bf16 a[40:43], a[168:171], v[216:219], a[40:43]
ds_read_b64_tr_b16 a[150:151], v29 offset:13920
v_mfma_f32_16x16x32_bf16 a[40:43], a[172:175], v[220:223], a[40:43]
v_mfma_f32_16x16x32_bf16 a[76:79], a[160:163], v[224:227], a[76:79]
ds_read_b64_tr_b16 a[152:153], v29 offset:18528
v_mfma_f32_16x16x32_bf16 a[76:79], a[164:167], v[228:231], a[76:79]
v_mfma_f32_16x16x32_bf16 a[76:79], a[168:171], v[232:235], a[76:79]
ds_read_b64_tr_b16 a[154:155], v29 offset:23136
v_mfma_f32_16x16x32_bf16 a[76:79], a[172:175], v[236:239], a[76:79]
buffer_load_dwordx4 v[140:143], v2, s[52:55], s16 offen offset:3072 sc1
v_mfma_f32_16x16x32_bf16 a[112:115], a[160:163], v[240:243], a[112:115]
ds_read_b64_tr_b16 a[156:157], v29 offset:27744
v_mfma_f32_16x16x32_bf16 a[112:115], a[164:167], v[244:247], a[112:115]
v_mfma_f32_16x16x32_bf16 a[112:115], a[168:171], v[248:251], a[112:115]
ds_read_b64_tr_b16 a[158:159], v29 offset:32352
v_mfma_f32_16x16x32_bf16 a[112:115], a[172:175], v[252:255], a[112:115]
s_waitcnt lgkmcnt(8)
v_mfma_f32_16x16x32_bf16 a[8:11], a[176:179], v[192:195], a[8:11]
ds_read_b64_tr_b16 a[160:161], v29 offset:128
v_mfma_f32_16x16x32_bf16 a[8:11], a[180:183], v[196:199], a[8:11]
v_mfma_f32_16x16x32_bf16 a[8:11], a[184:187], v[200:203], a[8:11]
ds_read_b64_tr_b16 a[162:163], v29 offset:4736
v_mfma_f32_16x16x32_bf16 a[8:11], a[188:191], v[204:207], a[8:11]
s_add_u32 s17, s13, 12288
buffer_load_dwordx4 v[144:147], v2, s[52:55], s17 offen sc1
v_mfma_f32_16x16x32_bf16 a[44:47], a[176:179], v[208:211], a[44:47]
ds_read_b64_tr_b16 a[164:165], v29 offset:9344
v_mfma_f32_16x16x32_bf16 a[44:47], a[180:183], v[212:215], a[44:47]
v_mfma_f32_16x16x32_bf16 a[44:47], a[184:187], v[216:219], a[44:47]
ds_read_b64_tr_b16 a[166:167], v29 offset:13952
v_mfma_f32_16x16x32_bf16 a[44:47], a[188:191], v[220:223], a[44:47]
v_mfma_f32_16x16x32_bf16 a[80:83], a[176:179], v[224:227], a[80:83]
ds_read_b64_tr_b16 a[168:169], v29 offset:18560
v_mfma_f32_16x16x32_bf16 a[80:83], a[180:183], v[228:231], a[80:83]
v_mfma_f32_16x16x32_bf16 a[80:83], a[184:187], v[232:235], a[80:83]
ds_read_b64_tr_b16 a[170:171], v29 offset:23168
v_mfma_f32_16x16x32_bf16 a[80:83], a[188:191], v[236:239], a[80:83]
v_mfma_f32_16x16x32_bf16 a[116:119], a[176:179], v[240:243], a[116:119]
ds_read_b64_tr_b16 a[172:173], v29 offset:27776
v_mfma_f32_16x16x32_bf16 a[116:119], a[180:183], v[244:247], a[116:119]
buffer_load_dwordx4 v[148:151], v2, s[52:55], s17 offen offset:1024 sc1
v_mfma_f32_16x16x32_bf16 a[116:119], a[184:187], v[248:251], a[116:119]
ds_read_b64_tr_b16 a[174:175], v29 offset:32384
v_mfma_f32_16x16x32_bf16 a[116:119], a[188:191], v[252:255], a[116:119]
s_waitcnt lgkmcnt(8)
v_mfma_f32_16x16x32_bf16 a[12:15], a[144:147], v[192:195], a[12:15]
ds_read_b64_tr_b16 a[176:177], v29 offset:160
v_mfma_f32_16x16x32_bf16 a[12:15], a[148:151], v[196:199], a[12:15]
v_mfma_f32_16x16x32_bf16 a[12:15], a[152:155], v[200:203], a[12:15]
ds_read_b64_tr_b16 a[178:179], v29 offset:4768
v_mfma_f32_16x16x32_bf16 a[12:15], a[156:159], v[204:207], a[12:15]
v_mfma_f32_16x16x32_bf16 a[48:51], a[144:147], v[208:211], a[48:51]
ds_read_b64_tr_b16 a[180:181], v29 offset:9376
v_mfma_f32_16x16x32_bf16 a[48:51], a[148:151], v[212:215], a[48:51]
buffer_load_dwordx4 v[152:155], v2, s[52:55], s17 offen offset:2048 sc1
v_mfma_f32_16x16x32_bf16 a[48:51], a[152:155], v[216:219], a[48:51]
ds_read_b64_tr_b16 a[182:183], v29 offset:13984
v_mfma_f32_16x16x32_bf16 a[48:51], a[156:159], v[220:223], a[48:51]
v_mfma_f32_16x16x32_bf16 a[84:87], a[144:147], v[224:227], a[84:87]
ds_read_b64_tr_b16 a[184:185], v29 offset:18592
v_mfma_f32_16x16x32_bf16 a[84:87], a[148:151], v[228:231], a[84:87]
v_mfma_f32_16x16x32_bf16 a[84:87], a[152:155], v[232:235], a[84:87]
ds_read_b64_tr_b16 a[186:187], v29 offset:23200
v_mfma_f32_16x16x32_bf16 a[84:87], a[156:159], v[236:239], a[84:87]
v_mfma_f32_16x16x32_bf16 a[120:123], a[144:147], v[240:243], a[120:123]
ds_read_b64_tr_b16 a[188:189], v29 offset:27808
v_mfma_f32_16x16x32_bf16 a[120:123], a[148:151], v[244:247], a[120:123]
buffer_load_dwordx4 v[156:159], v2, s[52:55], s17 offen offset:3072 sc1
v_mfma_f32_16x16x32_bf16 a[120:123], a[152:155], v[248:251], a[120:123]
ds_read_b64_tr_b16 a[190:191], v29 offset:32416
v_mfma_f32_16x16x32_bf16 a[120:123], a[156:159], v[252:255], a[120:123]
s_waitcnt lgkmcnt(8)
v_mfma_f32_16x16x32_bf16 a[16:19], a[160:163], v[192:195], a[16:19]
ds_read_b64_tr_b16 a[144:145], v29 offset:192
v_mfma_f32_16x16x32_bf16 a[16:19], a[164:167], v[196:199], a[16:19]
v_mfma_f32_16x16x32_bf16 a[16:19], a[168:171], v[200:203], a[16:19]
ds_read_b64_tr_b16 a[146:147], v29 offset:4800
v_mfma_f32_16x16x32_bf16 a[16:19], a[172:175], v[204:207], a[16:19]
v_mfma_f32_16x16x32_bf16 a[52:55], a[160:163], v[208:211], a[52:55]
ds_read_b64_tr_b16 a[148:149], v29 offset:9408
v_mfma_f32_16x16x32_bf16 a[52:55], a[164:167], v[212:215], a[52:55]
v_mfma_f32_16x16x32_bf16 a[52:55], a[168:171], v[216:219], a[52:55]
ds_read_b64_tr_b16 a[150:151], v29 offset:14016
v_mfma_f32_16x16x32_bf16 a[52:55], a[172:175], v[220:223], a[52:55]
s_add_u32 s18, s14, 12288
buffer_load_dwordx4 v[160:163], v2, s[52:55], s18 offen sc1
v_mfma_f32_16x16x32_bf16 a[88:91], a[160:163], v[224:227], a[88:91]
ds_read_b64_tr_b16 a[152:153], v29 offset:18624
v_mfma_f32_16x16x32_bf16 a[88:91], a[164:167], v[228:231], a[88:91]
v_mfma_f32_16x16x32_bf16 a[88:91], a[168:171], v[232:235], a[88:91]
ds_read_b64_tr_b16 a[154:155], v29 offset:23232
v_mfma_f32_16x16x32_bf16 a[88:91], a[172:175], v[236:239], a[88:91]
v_mfma_f32_16x16x32_bf16 a[124:127], a[160:163], v[240:243], a[124:127]
ds_read_b64_tr_b16 a[156:157], v29 offset:27840
v_mfma_f32_16x16x32_bf16 a[124:127], a[164:167], v[244:247], a[124:127]
v_mfma_f32_16x16x32_bf16 a[124:127], a[168:171], v[248:251], a[124:127]
ds_read_b64_tr_b16 a[158:159], v29 offset:32448
v_mfma_f32_16x16x32_bf16 a[124:127], a[172:175], v[252:255], a[124:127]
s_waitcnt lgkmcnt(8)
buffer_load_dwordx4 v[164:167], v2, s[52:55], s18 offen offset:1024 sc1
v_mfma_f32_16x16x32_bf16 a[20:23], a[176:179], v[192:195], a[20:23]
ds_read_b64_tr_b16 a[160:161], v29 offset:224
v_mfma_f32_16x16x32_bf16 a[20:23], a[180:183], v[196:199], a[20:23]
v_mfma_f32_16x16x32_bf16 a[20:23], a[184:187], v[200:203], a[20:23]
ds_read_b64_tr_b16 a[162:163], v29 offset:4832
v_mfma_f32_16x16x32_bf16 a[20:23], a[188:191], v[204:207], a[20:23]
v_mfma_f32_16x16x32_bf16 a[56:59], a[176:179], v[208:211], a[56:59]
ds_read_b64_tr_b16 a[164:165], v29 offset:9440
v_mfma_f32_16x16x32_bf16 a[56:59], a[180:183], v[212:215], a[56:59]
v_mfma_f32_16x16x32_bf16 a[56:59], a[184:187], v[216:219], a[56:59]
ds_read_b64_tr_b16 a[166:167], v29 offset:14048
v_mfma_f32_16x16x32_bf16 a[56:59], a[188:191], v[220:223], a[56:59]
buffer_load_dwordx4 v[168:171], v2, s[52:55], s18 offen offset:2048 sc1
v_mfma_f32_16x16x32_bf16 a[92:95], a[176:179], v[224:227], a[92:95]
ds_read_b64_tr_b16 a[168:169], v29 offset:18656
v_mfma_f32_16x16x32_bf16 a[92:95], a[180:183], v[228:231], a[92:95]
v_mfma_f32_16x16x32_bf16 a[92:95], a[184:187], v[232:235], a[92:95]
ds_read_b64_tr_b16 a[170:171], v29 offset:23264
v_mfma_f32_16x16x32_bf16 a[92:95], a[188:191], v[236:239], a[92:95]
v_mfma_f32_16x16x32_bf16 a[128:131], a[176:179], v[240:243], a[128:131]
ds_read_b64_tr_b16 a[172:173], v29 offset:27872
v_mfma_f32_16x16x32_bf16 a[128:131], a[180:183], v[244:247], a[128:131]
v_mfma_f32_16x16x32_bf16 a[128:131], a[184:187], v[248:251], a[128:131]
ds_read_b64_tr_b16 a[174:175], v29 offset:32480
v_mfma_f32_16x16x32_bf16 a[128:131], a[188:191], v[252:255], a[128:131]
s_waitcnt lgkmcnt(8)
buffer_load_dwordx4 v[172:175], v2, s[52:55], s18 offen offset:3072 sc1
v_mfma_f32_16x16x32_bf16 a[24:27], a[144:147], v[192:195], a[24:27]
ds_read_b64_tr_b16 a[176:177], v29 offset:256
v_mfma_f32_16x16x32_bf16 a[24:27], a[148:151], v[196:199], a[24:27]
v_mfma_f32_16x16x32_bf16 a[24:27], a[152:155], v[200:203], a[24:27]
ds_read_b64_tr_b16 a[178:179], v29 offset:4864
v_mfma_f32_16x16x32_bf16 a[24:27], a[156:159], v[204:207], a[24:27]
v_mfma_f32_16x16x32_bf16 a[60:63], a[144:147], v[208:211], a[60:63]
ds_read_b64_tr_b16 a[180:181], v29 offset:9472
v_mfma_f32_16x16x32_bf16 a[60:63], a[148:151], v[212:215], a[60:63]
v_mfma_f32_16x16x32_bf16 a[60:63], a[152:155], v[216:219], a[60:63]
ds_read_b64_tr_b16 a[182:183], v29 offset:14080
v_mfma_f32_16x16x32_bf16 a[60:63], a[156:159], v[220:223], a[60:63]
v_mfma_f32_16x16x32_bf16 a[96:99], a[144:147], v[224:227], a[96:99]
ds_read_b64_tr_b16 a[184:185], v29 offset:18688
v_mfma_f32_16x16x32_bf16 a[96:99], a[148:151], v[228:231], a[96:99]
s_add_u32 s19, s15, 12288
buffer_load_dwordx4 v[176:179], v2, s[52:55], s19 offen sc1
v_mfma_f32_16x16x32_bf16 a[96:99], a[152:155], v[232:235], a[96:99]
ds_read_b64_tr_b16 a[186:187], v29 offset:23296
v_mfma_f32_16x16x32_bf16 a[96:99], a[156:159], v[236:239], a[96:99]
v_mfma_f32_16x16x32_bf16 a[132:135], a[144:147], v[240:243], a[132:135]
ds_read_b64_tr_b16 a[188:189], v29 offset:27904
v_mfma_f32_16x16x32_bf16 a[132:135], a[148:151], v[244:247], a[132:135]
v_mfma_f32_16x16x32_bf16 a[132:135], a[152:155], v[248:251], a[132:135]
ds_read_b64_tr_b16 a[190:191], v29 offset:32512
v_mfma_f32_16x16x32_bf16 a[132:135], a[156:159], v[252:255], a[132:135]
s_waitcnt lgkmcnt(8)
v_mfma_f32_16x16x32_bf16 a[28:31], a[160:163], v[192:195], a[28:31]
v_mfma_f32_16x16x32_bf16 a[28:31], a[164:167], v[196:199], a[28:31]
buffer_load_dwordx4 v[180:183], v2, s[52:55], s19 offen offset:1024 sc1
v_mfma_f32_16x16x32_bf16 a[28:31], a[168:171], v[200:203], a[28:31]
s_waitcnt vmcnt(39) lgkmcnt(0)
s_barrier
v_mfma_f32_16x16x32_bf16 a[28:31], a[172:175], v[204:207], a[28:31]
ds_read_b64_tr_b16 a[144:145], v30
v_mfma_f32_16x16x32_bf16 a[64:67], a[160:163], v[208:211], a[64:67]
ds_read_b64_tr_b16 a[146:147], v30 offset:4608
v_mfma_f32_16x16x32_bf16 a[64:67], a[164:167], v[212:215], a[64:67]
v_mfma_f32_16x16x32_bf16 a[64:67], a[168:171], v[216:219], a[64:67]
ds_read_b64_tr_b16 a[148:149], v30 offset:9216
v_mfma_f32_16x16x32_bf16 a[64:67], a[172:175], v[220:223], a[64:67]
ds_read_b64_tr_b16 a[150:151], v30 offset:13824
v_mfma_f32_16x16x32_bf16 a[100:103], a[160:163], v[224:227], a[100:103]
v_mfma_f32_16x16x32_bf16 a[100:103], a[164:167], v[228:231], a[100:103]
ds_read_b64_tr_b16 a[152:153], v30 offset:18432
v_mfma_f32_16x16x32_bf16 a[100:103], a[168:171], v[232:235], a[100:103]
buffer_load_dwordx4 v[184:187], v2, s[52:55], s19 offen offset:2048 sc1
v_mfma_f32_16x16x32_bf16 a[100:103], a[172:175], v[236:239], a[100:103]
ds_read_b64_tr_b16 a[154:155], v30 offset:23040
v_mfma_f32_16x16x32_bf16 a[136:139], a[160:163], v[240:243], a[136:139]
ds_read_b64_tr_b16 a[156:157], v30 offset:27648
v_mfma_f32_16x16x32_bf16 a[136:139], a[164:167], v[244:247], a[136:139]
v_mfma_f32_16x16x32_bf16 a[136:139], a[168:171], v[248:251], a[136:139]
ds_read_b64_tr_b16 a[158:159], v30 offset:32256
v_mfma_f32_16x16x32_bf16 a[136:139], a[172:175], v[252:255], a[136:139]
v_mfma_f32_16x16x32_bf16 a[32:35], a[176:179], v[192:195], a[32:35]
ds_read_b64_tr_b16 a[160:161], v30 offset:32
v_mfma_f32_16x16x32_bf16 a[32:35], a[180:183], v[196:199], a[32:35]
ds_read_b64_tr_b16 a[162:163], v30 offset:4640
v_mfma_f32_16x16x32_bf16 a[32:35], a[184:187], v[200:203], a[32:35]
buffer_load_dwordx4 v[188:191], v2, s[52:55], s19 offen offset:3072 sc1
v_mfma_f32_16x16x32_bf16 a[32:35], a[188:191], v[204:207], a[32:35]
ds_read_b64_tr_b16 a[164:165], v30 offset:9248
v_mfma_f32_16x16x32_bf16 a[68:71], a[176:179], v[208:211], a[68:71]
ds_read_b64_tr_b16 a[166:167], v30 offset:13856
v_mfma_f32_16x16x32_bf16 a[68:71], a[180:183], v[212:215], a[68:71]
v_mfma_f32_16x16x32_bf16 a[68:71], a[184:187], v[216:219], a[68:71]
ds_read_b64_tr_b16 a[168:169], v30 offset:18464
v_mfma_f32_16x16x32_bf16 a[68:71], a[188:191], v[220:223], a[68:71]
v_mfma_f32_16x16x32_bf16 a[104:107], a[176:179], v[224:227], a[104:107]
ds_read_b64_tr_b16 a[170:171], v30 offset:23072
v_mfma_f32_16x16x32_bf16 a[104:107], a[180:183], v[228:231], a[104:107]
ds_read_b64_tr_b16 a[172:173], v30 offset:27680
v_mfma_f32_16x16x32_bf16 a[104:107], a[184:187], v[232:235], a[104:107]
v_mfma_f32_16x16x32_bf16 a[104:107], a[188:191], v[236:239], a[104:107]
ds_read_b64_tr_b16 a[174:175], v30 offset:32288
v_mfma_f32_16x16x32_bf16 a[140:143], a[176:179], v[240:243], a[140:143]
v_mfma_f32_16x16x32_bf16 a[140:143], a[180:183], v[244:247], a[140:143]
v_mfma_f32_16x16x32_bf16 a[140:143], a[184:187], v[248:251], a[140:143]
v_mfma_f32_16x16x32_bf16 a[140:143], a[188:191], v[252:255], a[140:143]
s_waitcnt vmcnt(36) lgkmcnt(8)
v_mfma_f32_16x16x32_bf16 a[0:3], a[144:147], v[64:67], a[0:3]
ds_read_b64_tr_b16 a[176:177], v30 offset:64
v_mfma_f32_16x16x32_bf16 a[0:3], a[148:151], v[68:71], a[0:3]
v_mfma_f32_16x16x32_bf16 a[0:3], a[152:155], v[72:75], a[0:3]
ds_read_b64_tr_b16 a[178:179], v30 offset:4672
v_mfma_f32_16x16x32_bf16 a[0:3], a[156:159], v[76:79], a[0:3]
s_waitcnt vmcnt(30)
v_mfma_f32_16x16x32_bf16 a[36:39], a[144:147], v[80:83], a[36:39]
ds_read_b64_tr_b16 a[180:181], v30 offset:9280
v_mfma_f32_16x16x32_bf16 a[36:39], a[148:151], v[84:87], a[36:39]
v_mfma_f32_16x16x32_bf16 a[36:39], a[152:155], v[88:91], a[36:39]
ds_read_b64_tr_b16 a[182:183], v30 offset:13888
v_mfma_f32_16x16x32_bf16 a[36:39], a[156:159], v[92:95], a[36:39]
s_waitcnt vmcnt(24)
v_mfma_f32_16x16x32_bf16 a[72:75], a[144:147], v[96:99], a[72:75]
ds_read_b64_tr_b16 a[184:185], v30 offset:18496
v_mfma_f32_16x16x32_bf16 a[72:75], a[148:151], v[100:103], a[72:75]
v_mfma_f32_16x16x32_bf16 a[72:75], a[152:155], v[104:107], a[72:75]
ds_read_b64_tr_b16 a[186:187], v30 offset:23104
v_mfma_f32_16x16x32_bf16 a[72:75], a[156:159], v[108:111], a[72:75]
s_waitcnt vmcnt(18)
v_mfma_f32_16x16x32_bf16 a[108:111], a[144:147], v[112:115], a[108:111]
ds_read_b64_tr_b16 a[188:189], v30 offset:27712
v_mfma_f32_16x16x32_bf16 a[108:111], a[148:151], v[116:119], a[108:111]
v_mfma_f32_16x16x32_bf16 a[108:111], a[152:155], v[120:123], a[108:111]
ds_read_b64_tr_b16 a[190:191], v30 offset:32320
v_mfma_f32_16x16x32_bf16 a[108:111], a[156:159], v[124:127], a[108:111]
s_waitcnt lgkmcnt(8)
v_mfma_f32_16x16x32_bf16 a[4:7], a[160:163], v[64:67], a[4:7]
ds_read_b64_tr_b16 a[144:145], v30 offset:96
v_mfma_f32_16x16x32_bf16 a[4:7], a[164:167], v[68:71], a[4:7]
v_mfma_f32_16x16x32_bf16 a[4:7], a[168:171], v[72:75], a[4:7]
ds_read_b64_tr_b16 a[146:147], v30 offset:4704
v_mfma_f32_16x16x32_bf16 a[4:7], a[172:175], v[76:79], a[4:7]
v_mfma_f32_16x16x32_bf16 a[40:43], a[160:163], v[80:83], a[40:43]
ds_read_b64_tr_b16 a[148:149], v30 offset:9312
v_mfma_f32_16x16x32_bf16 a[40:43], a[164:167], v[84:87], a[40:43]
v_mfma_f32_16x16x32_bf16 a[40:43], a[168:171], v[88:91], a[40:43]
ds_read_b64_tr_b16 a[150:151], v30 offset:13920
v_mfma_f32_16x16x32_bf16 a[40:43], a[172:175], v[92:95], a[40:43]
v_mfma_f32_16x16x32_bf16 a[76:79], a[160:163], v[96:99], a[76:79]
ds_read_b64_tr_b16 a[152:153], v30 offset:18528
v_mfma_f32_16x16x32_bf16 a[76:79], a[164:167], v[100:103], a[76:79]
v_mfma_f32_16x16x32_bf16 a[76:79], a[168:171], v[104:107], a[76:79]
ds_read_b64_tr_b16 a[154:155], v30 offset:23136
v_mfma_f32_16x16x32_bf16 a[76:79], a[172:175], v[108:111], a[76:79]
v_mfma_f32_16x16x32_bf16 a[112:115], a[160:163], v[112:115], a[112:115]
ds_read_b64_tr_b16 a[156:157], v30 offset:27744
v_mfma_f32_16x16x32_bf16 a[112:115], a[164:167], v[116:119], a[112:115]
v_mfma_f32_16x16x32_bf16 a[112:115], a[168:171], v[120:123], a[112:115]
ds_read_b64_tr_b16 a[158:159], v30 offset:32352
v_mfma_f32_16x16x32_bf16 a[112:115], a[172:175], v[124:127], a[112:115]
s_waitcnt lgkmcnt(8)
v_mfma_f32_16x16x32_bf16 a[8:11], a[176:179], v[64:67], a[8:11]
ds_read_b64_tr_b16 a[160:161], v30 offset:128
v_mfma_f32_16x16x32_bf16 a[8:11], a[180:183], v[68:71], a[8:11]
v_mfma_f32_16x16x32_bf16 a[8:11], a[184:187], v[72:75], a[8:11]
ds_read_b64_tr_b16 a[162:163], v30 offset:4736
v_mfma_f32_16x16x32_bf16 a[8:11], a[188:191], v[76:79], a[8:11]
v_mfma_f32_16x16x32_bf16 a[44:47], a[176:179], v[80:83], a[44:47]
ds_read_b64_tr_b16 a[164:165], v30 offset:9344
v_mfma_f32_16x16x32_bf16 a[44:47], a[180:183], v[84:87], a[44:47]
v_mfma_f32_16x16x32_bf16 a[44:47], a[184:187], v[88:91], a[44:47]
ds_read_b64_tr_b16 a[166:167], v30 offset:13952
v_mfma_f32_16x16x32_bf16 a[44:47], a[188:191], v[92:95], a[44:47]
v_mfma_f32_16x16x32_bf16 a[80:83], a[176:179], v[96:99], a[80:83]
ds_read_b64_tr_b16 a[168:169], v30 offset:18560
v_mfma_f32_16x16x32_bf16 a[80:83], a[180:183], v[100:103], a[80:83]
v_mfma_f32_16x16x32_bf16 a[80:83], a[184:187], v[104:107], a[80:83]
ds_read_b64_tr_b16 a[170:171], v30 offset:23168
v_mfma_f32_16x16x32_bf16 a[80:83], a[188:191], v[108:111], a[80:83]
v_mfma_f32_16x16x32_bf16 a[116:119], a[176:179], v[112:115], a[116:119]
ds_read_b64_tr_b16 a[172:173], v30 offset:27776
v_mfma_f32_16x16x32_bf16 a[116:119], a[180:183], v[116:119], a[116:119]
v_mfma_f32_16x16x32_bf16 a[116:119], a[184:187], v[120:123], a[116:119]
ds_read_b64_tr_b16 a[174:175], v30 offset:32384
v_mfma_f32_16x16x32_bf16 a[116:119], a[188:191], v[124:127], a[116:119]
s_waitcnt lgkmcnt(8)
v_mfma_f32_16x16x32_bf16 a[12:15], a[144:147], v[64:67], a[12:15]
ds_read_b64_tr_b16 a[176:177], v30 offset:160
v_mfma_f32_16x16x32_bf16 a[12:15], a[148:151], v[68:71], a[12:15]
v_mfma_f32_16x16x32_bf16 a[12:15], a[152:155], v[72:75], a[12:15]
ds_read_b64_tr_b16 a[178:179], v30 offset:4768
v_mfma_f32_16x16x32_bf16 a[12:15], a[156:159], v[76:79], a[12:15]
v_mfma_f32_16x16x32_bf16 a[48:51], a[144:147], v[80:83], a[48:51]
ds_read_b64_tr_b16 a[180:181], v30 offset:9376
v_mfma_f32_16x16x32_bf16 a[48:51], a[148:151], v[84:87], a[48:51]
v_mfma_f32_16x16x32_bf16 a[48:51], a[152:155], v[88:91], a[48:51]
ds_read_b64_tr_b16 a[182:183], v30 offset:13984
v_mfma_f32_16x16x32_bf16 a[48:51], a[156:159], v[92:95], a[48:51]
v_mfma_f32_16x16x32_bf16 a[84:87], a[144:147], v[96:99], a[84:87]
ds_read_b64_tr_b16 a[184:185], v30 offset:18592
v_mfma_f32_16x16x32_bf16 a[84:87], a[148:151], v[100:103], a[84:87]
v_mfma_f32_16x16x32_bf16 a[84:87], a[152:155], v[104:107], a[84:87]
ds_read_b64_tr_b16 a[186:187], v30 offset:23200
v_mfma_f32_16x16x32_bf16 a[84:87], a[156:159], v[108:111], a[84:87]
v_mfma_f32_16x16x32_bf16 a[120:123], a[144:147], v[112:115], a[120:123]
ds_read_b64_tr_b16 a[188:189], v30 offset:27808
v_mfma_f32_16x16x32_bf16 a[120:123], a[148:151], v[116:119], a[120:123]
v_mfma_f32_16x16x32_bf16 a[120:123], a[152:155], v[120:123], a[120:123]
ds_read_b64_tr_b16 a[190:191], v30 offset:32416
v_mfma_f32_16x16x32_bf16 a[120:123], a[156:159], v[124:127], a[120:123]
s_waitcnt lgkmcnt(8)
v_mfma_f32_16x16x32_bf16 a[16:19], a[160:163], v[64:67], a[16:19]
ds_read_b64_tr_b16 a[144:145], v30 offset:192
v_mfma_f32_16x16x32_bf16 a[16:19], a[164:167], v[68:71], a[16:19]
v_mfma_f32_16x16x32_bf16 a[16:19], a[168:171], v[72:75], a[16:19]
ds_read_b64_tr_b16 a[146:147], v30 offset:4800
v_mfma_f32_16x16x32_bf16 a[16:19], a[172:175], v[76:79], a[16:19]
v_mfma_f32_16x16x32_bf16 a[52:55], a[160:163], v[80:83], a[52:55]
ds_read_b64_tr_b16 a[148:149], v30 offset:9408
v_mfma_f32_16x16x32_bf16 a[52:55], a[164:167], v[84:87], a[52:55]
v_mfma_f32_16x16x32_bf16 a[52:55], a[168:171], v[88:91], a[52:55]
ds_read_b64_tr_b16 a[150:151], v30 offset:14016
v_mfma_f32_16x16x32_bf16 a[52:55], a[172:175], v[92:95], a[52:55]
v_mfma_f32_16x16x32_bf16 a[88:91], a[160:163], v[96:99], a[88:91]
ds_read_b64_tr_b16 a[152:153], v30 offset:18624
v_mfma_f32_16x16x32_bf16 a[88:91], a[164:167], v[100:103], a[88:91]
v_mfma_f32_16x16x32_bf16 a[88:91], a[168:171], v[104:107], a[88:91]
ds_read_b64_tr_b16 a[154:155], v30 offset:23232
v_mfma_f32_16x16x32_bf16 a[88:91], a[172:175], v[108:111], a[88:91]
v_mfma_f32_16x16x32_bf16 a[124:127], a[160:163], v[112:115], a[124:127]
ds_read_b64_tr_b16 a[156:157], v30 offset:27840
v_mfma_f32_16x16x32_bf16 a[124:127], a[164:167], v[116:119], a[124:127]
v_mfma_f32_16x16x32_bf16 a[124:127], a[168:171], v[120:123], a[124:127]
ds_read_b64_tr_b16 a[158:159], v30 offset:32448
v_mfma_f32_16x16x32_bf16 a[124:127], a[172:175], v[124:127], a[124:127]
s_waitcnt lgkmcnt(8)
v_mfma_f32_16x16x32_bf16 a[20:23], a[176:179], v[64:67], a[20:23]
ds_read_b64_tr_b16 a[160:161], v30 offset:224
v_mfma_f32_16x16x32_bf16 a[20:23], a[180:183], v[68:71], a[20:23]
v_mfma_f32_16x16x32_bf16 a[20:23], a[184:187], v[72:75], a[20:23]
ds_read_b64_tr_b16 a[162:163], v30 offset:4832
v_mfma_f32_16x16x32_bf16 a[20:23], a[188:191], v[76:79], a[20:23]
v_mfma_f32_16x16x32_bf16 a[56:59], a[176:179], v[80:83], a[56:59]
ds_read_b64_tr_b16 a[164:165], v30 offset:9440
v_mfma_f32_16x16x32_bf16 a[56:59], a[180:183], v[84:87], a[56:59]
v_mfma_f32_16x16x32_bf16 a[56:59], a[184:187], v[88:91], a[56:59]
ds_read_b64_tr_b16 a[166:167], v30 offset:14048
v_mfma_f32_16x16x32_bf16 a[56:59], a[188:191], v[92:95], a[56:59]
v_mfma_f32_16x16x32_bf16 a[92:95], a[176:179], v[96:99], a[92:95]
ds_read_b64_tr_b16 a[168:169], v30 offset:18656
v_mfma_f32_16x16x32_bf16 a[92:95], a[180:183], v[100:103], a[92:95]
v_mfma_f32_16x16x32_bf16 a[92:95], a[184:187], v[104:107], a[92:95]
ds_read_b64_tr_b16 a[170:171], v30 offset:23264
v_mfma_f32_16x16x32_bf16 a[92:95], a[188:191], v[108:111], a[92:95]
v_mfma_f32_16x16x32_bf16 a[128:131], a[176:179], v[112:115], a[128:131]
ds_read_b64_tr_b16 a[172:173], v30 offset:27872
v_mfma_f32_16x16x32_bf16 a[128:131], a[180:183], v[116:119], a[128:131]
v_mfma_f32_16x16x32_bf16 a[128:131], a[184:187], v[120:123], a[128:131]
ds_read_b64_tr_b16 a[174:175], v30 offset:32480
v_mfma_f32_16x16x32_bf16 a[128:131], a[188:191], v[124:127], a[128:131]
s_waitcnt lgkmcnt(8)
v_mfma_f32_16x16x32_bf16 a[24:27], a[144:147], v[64:67], a[24:27]
ds_read_b64_tr_b16 a[176:177], v30 offset:256
v_mfma_f32_16x16x32_bf16 a[24:27], a[148:151], v[68:71], a[24:27]
v_mfma_f32_16x16x32_bf16 a[24:27], a[152:155], v[72:75], a[24:27]
ds_read_b64_tr_b16 a[178:179], v30 offset:4864
v_mfma_f32_16x16x32_bf16 a[24:27], a[156:159], v[76:79], a[24:27]
v_mfma_f32_16x16x32_bf16 a[60:63], a[144:147], v[80:83], a[60:63]
ds_read_b64_tr_b16 a[180:181], v30 offset:9472
v_mfma_f32_16x16x32_bf16 a[60:63], a[148:151], v[84:87], a[60:63]
v_mfma_f32_16x16x32_bf16 a[60:63], a[152:155], v[88:91], a[60:63]
ds_read_b64_tr_b16 a[182:183], v30 offset:14080
v_mfma_f32_16x16x32_bf16 a[60:63], a[156:159], v[92:95], a[60:63]
v_mfma_f32_16x16x32_bf16 a[96:99], a[144:147], v[96:99], a[96:99]
ds_read_b64_tr_b16 a[184:185], v30 offset:18688
v_mfma_f32_16x16x32_bf16 a[96:99], a[148:151], v[100:103], a[96:99]
v_mfma_f32_16x16x32_bf16 a[96:99], a[152:155], v[104:107], a[96:99]
ds_read_b64_tr_b16 a[186:187], v30 offset:23296
v_mfma_f32_16x16x32_bf16 a[96:99], a[156:159], v[108:111], a[96:99]
v_mfma_f32_16x16x32_bf16 a[132:135], a[144:147], v[112:115], a[132:135]
ds_read_b64_tr_b16 a[188:189], v30 offset:27904
v_mfma_f32_16x16x32_bf16 a[132:135], a[148:151], v[116:119], a[132:135]
v_mfma_f32_16x16x32_bf16 a[132:135], a[152:155], v[120:123], a[132:135]
ds_read_b64_tr_b16 a[190:191], v30 offset:32512
v_mfma_f32_16x16x32_bf16 a[132:135], a[156:159], v[124:127], a[132:135]
s_waitcnt lgkmcnt(8)
v_mfma_f32_16x16x32_bf16 a[28:31], a[160:163], v[64:67], a[28:31]
v_mfma_f32_16x16x32_bf16 a[28:31], a[164:167], v[68:71], a[28:31]
v_mfma_f32_16x16x32_bf16 a[28:31], a[168:171], v[72:75], a[28:31]
s_waitcnt vmcnt(16) lgkmcnt(0)
s_barrier
v_mfma_f32_16x16x32_bf16 a[28:31], a[172:175], v[76:79], a[28:31]
ds_read_b64_tr_b16 a[144:145], v31
v_mfma_f32_16x16x32_bf16 a[64:67], a[160:163], v[80:83], a[64:67]
ds_read_b64_tr_b16 a[146:147], v31 offset:4608
v_mfma_f32_16x16x32_bf16 a[64:67], a[164:167], v[84:87], a[64:67]
v_mfma_f32_16x16x32_bf16 a[64:67], a[168:171], v[88:91], a[64:67]
ds_read_b64_tr_b16 a[148:149], v31 offset:9216
v_mfma_f32_16x16x32_bf16 a[64:67], a[172:175], v[92:95], a[64:67]
ds_read_b64_tr_b16 a[150:151], v31 offset:13824
v_mfma_f32_16x16x32_bf16 a[100:103], a[160:163], v[96:99], a[100:103]
v_mfma_f32_16x16x32_bf16 a[100:103], a[164:167], v[100:103], a[100:103]
ds_read_b64_tr_b16 a[152:153], v31 offset:18432
v_mfma_f32_16x16x32_bf16 a[100:103], a[168:171], v[104:107], a[100:103]
v_mfma_f32_16x16x32_bf16 a[100:103], a[172:175], v[108:111], a[100:103]
ds_read_b64_tr_b16 a[154:155], v31 offset:23040
v_mfma_f32_16x16x32_bf16 a[136:139], a[160:163], v[112:115], a[136:139]
ds_read_b64_tr_b16 a[156:157], v31 offset:27648
v_mfma_f32_16x16x32_bf16 a[136:139], a[164:167], v[116:119], a[136:139]
v_mfma_f32_16x16x32_bf16 a[136:139], a[168:171], v[120:123], a[136:139]
ds_read_b64_tr_b16 a[158:159], v31 offset:32256
v_mfma_f32_16x16x32_bf16 a[136:139], a[172:175], v[124:127], a[136:139]
v_mfma_f32_16x16x32_bf16 a[32:35], a[176:179], v[64:67], a[32:35]
ds_read_b64_tr_b16 a[160:161], v31 offset:32
v_mfma_f32_16x16x32_bf16 a[32:35], a[180:183], v[68:71], a[32:35]
ds_read_b64_tr_b16 a[162:163], v31 offset:4640
v_mfma_f32_16x16x32_bf16 a[32:35], a[184:187], v[72:75], a[32:35]
v_mfma_f32_16x16x32_bf16 a[32:35], a[188:191], v[76:79], a[32:35]
ds_read_b64_tr_b16 a[164:165], v31 offset:9248
v_mfma_f32_16x16x32_bf16 a[68:71], a[176:179], v[80:83], a[68:71]
ds_read_b64_tr_b16 a[166:167], v31 offset:13856
v_mfma_f32_16x16x32_bf16 a[68:71], a[180:183], v[84:87], a[68:71]
v_mfma_f32_16x16x32_bf16 a[68:71], a[184:187], v[88:91], a[68:71]
ds_read_b64_tr_b16 a[168:169], v31 offset:18464
v_mfma_f32_16x16x32_bf16 a[68:71], a[188:191], v[92:95], a[68:71]
v_mfma_f32_16x16x32_bf16 a[104:107], a[176:179], v[96:99], a[104:107]
ds_read_b64_tr_b16 a[170:171], v31 offset:23072
v_mfma_f32_16x16x32_bf16 a[104:107], a[180:183], v[100:103], a[104:107]
ds_read_b64_tr_b16 a[172:173], v31 offset:27680
v_mfma_f32_16x16x32_bf16 a[104:107], a[184:187], v[104:107], a[104:107]
v_mfma_f32_16x16x32_bf16 a[104:107], a[188:191], v[108:111], a[104:107]
ds_read_b64_tr_b16 a[174:175], v31 offset:32288
v_mfma_f32_16x16x32_bf16 a[140:143], a[176:179], v[112:115], a[140:143]
v_mfma_f32_16x16x32_bf16 a[140:143], a[180:183], v[116:119], a[140:143]
v_mfma_f32_16x16x32_bf16 a[140:143], a[184:187], v[120:123], a[140:143]
v_mfma_f32_16x16x32_bf16 a[140:143], a[188:191], v[124:127], a[140:143]
s_waitcnt vmcnt(12) lgkmcnt(8)
v_mfma_f32_16x16x32_bf16 a[0:3], a[144:147], v[128:131], a[0:3]
ds_read_b64_tr_b16 a[176:177], v31 offset:64
v_mfma_f32_16x16x32_bf16 a[0:3], a[148:151], v[132:135], a[0:3]
v_mfma_f32_16x16x32_bf16 a[0:3], a[152:155], v[136:139], a[0:3]
ds_read_b64_tr_b16 a[178:179], v31 offset:4672
v_mfma_f32_16x16x32_bf16 a[0:3], a[156:159], v[140:143], a[0:3]
s_waitcnt vmcnt(8)
v_mfma_f32_16x16x32_bf16 a[36:39], a[144:147], v[144:147], a[36:39]
ds_read_b64_tr_b16 a[180:181], v31 offset:9280
v_mfma_f32_16x16x32_bf16 a[36:39], a[148:151], v[148:151], a[36:39]
v_mfma_f32_16x16x32_bf16 a[36:39], a[152:155], v[152:155], a[36:39]
ds_read_b64_tr_b16 a[182:183], v31 offset:13888
v_mfma_f32_16x16x32_bf16 a[36:39], a[156:159], v[156:159], a[36:39]
s_waitcnt vmcnt(4)
v_mfma_f32_16x16x32_bf16 a[72:75], a[144:147], v[160:163], a[72:75]
ds_read_b64_tr_b16 a[184:185], v31 offset:18496
v_mfma_f32_16x16x32_bf16 a[72:75], a[148:151], v[164:167], a[72:75]
v_mfma_f32_16x16x32_bf16 a[72:75], a[152:155], v[168:171], a[72:75]
ds_read_b64_tr_b16 a[186:187], v31 offset:23104
v_mfma_f32_16x16x32_bf16 a[72:75], a[156:159], v[172:175], a[72:75]
s_waitcnt vmcnt(0)
v_mfma_f32_16x16x32_bf16 a[108:111], a[144:147], v[176:179], a[108:111]
ds_read_b64_tr_b16 a[188:189], v31 offset:27712
v_mfma_f32_16x16x32_bf16 a[108:111], a[148:151], v[180:183], a[108:111]
v_mfma_f32_16x16x32_bf16 a[108:111], a[152:155], v[184:187], a[108:111]
ds_read_b64_tr_b16 a[190:191], v31 offset:32320
v_mfma_f32_16x16x32_bf16 a[108:111], a[156:159], v[188:191], a[108:111]
s_waitcnt lgkmcnt(8)
v_mfma_f32_16x16x32_bf16 a[4:7], a[160:163], v[128:131], a[4:7]
ds_read_b64_tr_b16 a[144:145], v31 offset:96
v_mfma_f32_16x16x32_bf16 a[4:7], a[164:167], v[132:135], a[4:7]
v_mfma_f32_16x16x32_bf16 a[4:7], a[168:171], v[136:139], a[4:7]
ds_read_b64_tr_b16 a[146:147], v31 offset:4704
v_mfma_f32_16x16x32_bf16 a[4:7], a[172:175], v[140:143], a[4:7]
v_mfma_f32_16x16x32_bf16 a[40:43], a[160:163], v[144:147], a[40:43]
ds_read_b64_tr_b16 a[148:149], v31 offset:9312
v_mfma_f32_16x16x32_bf16 a[40:43], a[164:167], v[148:151], a[40:43]
v_mfma_f32_16x16x32_bf16 a[40:43], a[168:171], v[152:155], a[40:43]
ds_read_b64_tr_b16 a[150:151], v31 offset:13920
v_mfma_f32_16x16x32_bf16 a[40:43], a[172:175], v[156:159], a[40:43]
v_mfma_f32_16x16x32_bf16 a[76:79], a[160:163], v[160:163], a[76:79]
ds_read_b64_tr_b16 a[152:153], v31 offset:18528
v_accvgpr_read_b32 v48, a0
v_mfma_f32_16x16x32_bf16 a[76:79], a[164:167], v[164:167], a[76:79]
v_accvgpr_read_b32 v49, a1
v_accvgpr_read_b32 v50, a2
v_mfma_f32_16x16x32_bf16 a[76:79], a[168:171], v[168:171], a[76:79]
ds_read_b64_tr_b16 a[154:155], v31 offset:23136
v_accvgpr_read_b32 v51, a3
v_mfma_f32_16x16x32_bf16 a[76:79], a[172:175], v[172:175], a[76:79]
v_accvgpr_read_b32 v52, a36
v_accvgpr_read_b32 v53, a37
v_mfma_f32_16x16x32_bf16 a[112:115], a[160:163], v[176:179], a[112:115]
ds_read_b64_tr_b16 a[156:157], v31 offset:27744
v_accvgpr_read_b32 v54, a38
v_mfma_f32_16x16x32_bf16 a[112:115], a[164:167], v[180:183], a[112:115]
v_accvgpr_read_b32 v55, a39
v_cvt_pk_bf16_f32 v32, v48, v49
v_mfma_f32_16x16x32_bf16 a[112:115], a[168:171], v[184:187], a[112:115]
ds_read_b64_tr_b16 a[158:159], v31 offset:32352
v_cvt_pk_bf16_f32 v33, v50, v51
v_mfma_f32_16x16x32_bf16 a[112:115], a[172:175], v[188:191], a[112:115]
s_waitcnt lgkmcnt(8)
v_cvt_pk_bf16_f32 v34, v52, v53
v_cvt_pk_bf16_f32 v35, v54, v55
v_mfma_f32_16x16x32_bf16 a[8:11], a[176:179], v[128:131], a[8:11]
ds_read_b64_tr_b16 a[160:161], v31 offset:128
v_mfma_f32_16x16x32_bf16 a[8:11], a[180:183], v[132:135], a[8:11]
s_add_u32 s29, s70, 0
buffer_store_dwordx4 v[32:35], v2, s[56:59], s29 offen sc1
v_accvgpr_read_b32 v56, a72
v_mfma_f32_16x16x32_bf16 a[8:11], a[184:187], v[136:139], a[8:11]
ds_read_b64_tr_b16 a[162:163], v31 offset:4736
v_accvgpr_read_b32 v57, a73
v_mfma_f32_16x16x32_bf16 a[8:11], a[188:191], v[140:143], a[8:11]
v_accvgpr_read_b32 v58, a74
v_accvgpr_read_b32 v59, a75
v_mfma_f32_16x16x32_bf16 a[44:47], a[176:179], v[144:147], a[44:47]
ds_read_b64_tr_b16 a[164:165], v31 offset:9344
v_accvgpr_read_b32 v60, a108
v_mfma_f32_16x16x32_bf16 a[44:47], a[180:183], v[148:151], a[44:47]
v_accvgpr_read_b32 v61, a109
v_accvgpr_read_b32 v62, a110
v_mfma_f32_16x16x32_bf16 a[44:47], a[184:187], v[152:155], a[44:47]
ds_read_b64_tr_b16 a[166:167], v31 offset:13952
v_accvgpr_read_b32 v63, a111
v_cvt_pk_bf16_f32 v36, v56, v57
v_mfma_f32_16x16x32_bf16 a[44:47], a[188:191], v[156:159], a[44:47]
v_cvt_pk_bf16_f32 v37, v58, v59
v_cvt_pk_bf16_f32 v38, v60, v61
v_mfma_f32_16x16x32_bf16 a[80:83], a[176:179], v[160:163], a[80:83]
ds_read_b64_tr_b16 a[168:169], v31 offset:18560
v_cvt_pk_bf16_f32 v39, v62, v63
v_mfma_f32_16x16x32_bf16 a[80:83], a[180:183], v[164:167], a[80:83]
s_add_u32 s29, s70, 36864
buffer_store_dwordx4 v[36:39], v2, s[56:59], s29 offen sc1
v_accvgpr_read_b32 v48, a4
v_mfma_f32_16x16x32_bf16 a[80:83], a[184:187], v[168:171], a[80:83]
ds_read_b64_tr_b16 a[170:171], v31 offset:23168
v_accvgpr_read_b32 v49, a5
v_mfma_f32_16x16x32_bf16 a[80:83], a[188:191], v[172:175], a[80:83]
v_accvgpr_read_b32 v50, a6
v_accvgpr_read_b32 v51, a7
v_mfma_f32_16x16x32_bf16 a[116:119], a[176:179], v[176:179], a[116:119]
ds_read_b64_tr_b16 a[172:173], v31 offset:27776
v_accvgpr_read_b32 v52, a40
v_mfma_f32_16x16x32_bf16 a[116:119], a[180:183], v[180:183], a[116:119]
v_accvgpr_read_b32 v53, a41
v_accvgpr_read_b32 v54, a42
v_mfma_f32_16x16x32_bf16 a[116:119], a[184:187], v[184:187], a[116:119]
ds_read_b64_tr_b16 a[174:175], v31 offset:32384
v_accvgpr_read_b32 v55, a43
v_cvt_pk_bf16_f32 v40, v48, v49
v_mfma_f32_16x16x32_bf16 a[116:119], a[188:191], v[188:191], a[116:119]
s_waitcnt lgkmcnt(8)
v_cvt_pk_bf16_f32 v41, v50, v51
v_cvt_pk_bf16_f32 v42, v52, v53
v_mfma_f32_16x16x32_bf16 a[12:15], a[144:147], v[128:131], a[12:15]
ds_read_b64_tr_b16 a[176:177], v31 offset:160
v_cvt_pk_bf16_f32 v43, v54, v55
v_mfma_f32_16x16x32_bf16 a[12:15], a[148:151], v[132:135], a[12:15]
s_add_u32 s29, s70, 0
buffer_store_dwordx4 v[40:43], v2, s[56:59], s29 offen offset:1024 sc1
v_accvgpr_read_b32 v56, a76
v_mfma_f32_16x16x32_bf16 a[12:15], a[152:155], v[136:139], a[12:15]
ds_read_b64_tr_b16 a[178:179], v31 offset:4768
v_accvgpr_read_b32 v57, a77
v_mfma_f32_16x16x32_bf16 a[12:15], a[156:159], v[140:143], a[12:15]
v_accvgpr_read_b32 v58, a78
v_accvgpr_read_b32 v59, a79
v_mfma_f32_16x16x32_bf16 a[48:51], a[144:147], v[144:147], a[48:51]
ds_read_b64_tr_b16 a[180:181], v31 offset:9376
v_accvgpr_read_b32 v60, a112
v_mfma_f32_16x16x32_bf16 a[48:51], a[148:151], v[148:151], a[48:51]
v_accvgpr_read_b32 v61, a113
v_accvgpr_read_b32 v62, a114
v_mfma_f32_16x16x32_bf16 a[48:51], a[152:155], v[152:155], a[48:51]
ds_read_b64_tr_b16 a[182:183], v31 offset:13984
v_accvgpr_read_b32 v63, a115
v_cvt_pk_bf16_f32 v44, v56, v57
v_mfma_f32_16x16x32_bf16 a[48:51], a[156:159], v[156:159], a[48:51]
v_cvt_pk_bf16_f32 v45, v58, v59
v_cvt_pk_bf16_f32 v46, v60, v61
v_mfma_f32_16x16x32_bf16 a[84:87], a[144:147], v[160:163], a[84:87]
ds_read_b64_tr_b16 a[184:185], v31 offset:18592
v_cvt_pk_bf16_f32 v47, v62, v63
v_mfma_f32_16x16x32_bf16 a[84:87], a[148:151], v[164:167], a[84:87]
s_add_u32 s29, s70, 36864
buffer_store_dwordx4 v[44:47], v2, s[56:59], s29 offen offset:1024 sc1
v_accvgpr_read_b32 v48, a8
v_mfma_f32_16x16x32_bf16 a[84:87], a[152:155], v[168:171], a[84:87]
ds_read_b64_tr_b16 a[186:187], v31 offset:23200
v_accvgpr_read_b32 v49, a9
v_mfma_f32_16x16x32_bf16 a[84:87], a[156:159], v[172:175], a[84:87]
v_accvgpr_read_b32 v50, a10
v_accvgpr_read_b32 v51, a11
v_mfma_f32_16x16x32_bf16 a[120:123], a[144:147], v[176:179], a[120:123]
ds_read_b64_tr_b16 a[188:189], v31 offset:27808
v_accvgpr_read_b32 v52, a44
v_mfma_f32_16x16x32_bf16 a[120:123], a[148:151], v[180:183], a[120:123]
v_accvgpr_read_b32 v53, a45
v_accvgpr_read_b32 v54, a46
v_mfma_f32_16x16x32_bf16 a[120:123], a[152:155], v[184:187], a[120:123]
ds_read_b64_tr_b16 a[190:191], v31 offset:32416
v_accvgpr_read_b32 v55, a47
v_cvt_pk_bf16_f32 v32, v48, v49
v_mfma_f32_16x16x32_bf16 a[120:123], a[156:159], v[188:191], a[120:123]
s_waitcnt lgkmcnt(8)
v_cvt_pk_bf16_f32 v33, v50, v51
v_cvt_pk_bf16_f32 v34, v52, v53
v_mfma_f32_16x16x32_bf16 a[16:19], a[160:163], v[128:131], a[16:19]
ds_read_b64_tr_b16 a[144:145], v31 offset:192
v_cvt_pk_bf16_f32 v35, v54, v55
v_mfma_f32_16x16x32_bf16 a[16:19], a[164:167], v[132:135], a[16:19]
s_add_u32 s29, s70, 0
buffer_store_dwordx4 v[32:35], v2, s[56:59], s29 offen offset:2048 sc1
v_accvgpr_read_b32 v56, a80
v_mfma_f32_16x16x32_bf16 a[16:19], a[168:171], v[136:139], a[16:19]
ds_read_b64_tr_b16 a[146:147], v31 offset:4800
v_accvgpr_read_b32 v57, a81
v_mfma_f32_16x16x32_bf16 a[16:19], a[172:175], v[140:143], a[16:19]
v_accvgpr_read_b32 v58, a82
v_accvgpr_read_b32 v59, a83
v_mfma_f32_16x16x32_bf16 a[52:55], a[160:163], v[144:147], a[52:55]
ds_read_b64_tr_b16 a[148:149], v31 offset:9408
v_accvgpr_read_b32 v60, a116
v_mfma_f32_16x16x32_bf16 a[52:55], a[164:167], v[148:151], a[52:55]
v_accvgpr_read_b32 v61, a117
v_accvgpr_read_b32 v62, a118
v_mfma_f32_16x16x32_bf16 a[52:55], a[168:171], v[152:155], a[52:55]
ds_read_b64_tr_b16 a[150:151], v31 offset:14016
v_accvgpr_read_b32 v63, a119
v_cvt_pk_bf16_f32 v36, v56, v57
v_mfma_f32_16x16x32_bf16 a[52:55], a[172:175], v[156:159], a[52:55]
v_cvt_pk_bf16_f32 v37, v58, v59
v_cvt_pk_bf16_f32 v38, v60, v61
v_mfma_f32_16x16x32_bf16 a[88:91], a[160:163], v[160:163], a[88:91]
ds_read_b64_tr_b16 a[152:153], v31 offset:18624
v_cvt_pk_bf16_f32 v39, v62, v63
v_mfma_f32_16x16x32_bf16 a[88:91], a[164:167], v[164:167], a[88:91]
s_add_u32 s29, s70, 36864
buffer_store_dwordx4 v[36:39], v2, s[56:59], s29 offen offset:2048 sc1
v_accvgpr_read_b32 v48, a12
v_mfma_f32_16x16x32_bf16 a[88:91], a[168:171], v[168:171], a[88:91]
ds_read_b64_tr_b16 a[154:155], v31 offset:23232
v_accvgpr_read_b32 v49, a13
v_mfma_f32_16x16x32_bf16 a[88:91], a[172:175], v[172:175], a[88:91]
v_accvgpr_read_b32 v50, a14
v_accvgpr_read_b32 v51, a15
v_mfma_f32_16x16x32_bf16 a[124:127], a[160:163], v[176:179], a[124:127]
ds_read_b64_tr_b16 a[156:157], v31 offset:27840
v_accvgpr_read_b32 v52, a48
v_mfma_f32_16x16x32_bf16 a[124:127], a[164:167], v[180:183], a[124:127]
v_accvgpr_read_b32 v53, a49
v_accvgpr_read_b32 v54, a50
v_mfma_f32_16x16x32_bf16 a[124:127], a[168:171], v[184:187], a[124:127]
ds_read_b64_tr_b16 a[158:159], v31 offset:32448
v_accvgpr_read_b32 v55, a51
v_cvt_pk_bf16_f32 v40, v48, v49
v_mfma_f32_16x16x32_bf16 a[124:127], a[172:175], v[188:191], a[124:127]
s_waitcnt lgkmcnt(8)
v_cvt_pk_bf16_f32 v41, v50, v51
v_cvt_pk_bf16_f32 v42, v52, v53
v_mfma_f32_16x16x32_bf16 a[20:23], a[176:179], v[128:131], a[20:23]
ds_read_b64_tr_b16 a[160:161], v31 offset:224
v_cvt_pk_bf16_f32 v43, v54, v55
v_mfma_f32_16x16x32_bf16 a[20:23], a[180:183], v[132:135], a[20:23]
s_add_u32 s29, s70, 0
buffer_store_dwordx4 v[40:43], v2, s[56:59], s29 offen offset:3072 sc1
v_accvgpr_read_b32 v56, a84
v_mfma_f32_16x16x32_bf16 a[20:23], a[184:187], v[136:139], a[20:23]
ds_read_b64_tr_b16 a[162:163], v31 offset:4832
v_accvgpr_read_b32 v57, a85
v_mfma_f32_16x16x32_bf16 a[20:23], a[188:191], v[140:143], a[20:23]
v_accvgpr_read_b32 v58, a86
v_accvgpr_read_b32 v59, a87
v_mfma_f32_16x16x32_bf16 a[56:59], a[176:179], v[144:147], a[56:59]
ds_read_b64_tr_b16 a[164:165], v31 offset:9440
v_accvgpr_read_b32 v60, a120
v_mfma_f32_16x16x32_bf16 a[56:59], a[180:183], v[148:151], a[56:59]
v_accvgpr_read_b32 v61, a121
v_accvgpr_read_b32 v62, a122
v_mfma_f32_16x16x32_bf16 a[56:59], a[184:187], v[152:155], a[56:59]
ds_read_b64_tr_b16 a[166:167], v31 offset:14048
v_accvgpr_read_b32 v63, a123
v_cvt_pk_bf16_f32 v44, v56, v57
v_mfma_f32_16x16x32_bf16 a[56:59], a[188:191], v[156:159], a[56:59]
v_cvt_pk_bf16_f32 v45, v58, v59
v_cvt_pk_bf16_f32 v46, v60, v61
v_mfma_f32_16x16x32_bf16 a[92:95], a[176:179], v[160:163], a[92:95]
ds_read_b64_tr_b16 a[168:169], v31 offset:18656
v_cvt_pk_bf16_f32 v47, v62, v63
v_mfma_f32_16x16x32_bf16 a[92:95], a[180:183], v[164:167], a[92:95]
s_add_u32 s29, s70, 36864
buffer_store_dwordx4 v[44:47], v2, s[56:59], s29 offen offset:3072 sc1
v_accvgpr_read_b32 v48, a16
v_mfma_f32_16x16x32_bf16 a[92:95], a[184:187], v[168:171], a[92:95]
ds_read_b64_tr_b16 a[170:171], v31 offset:23264
v_accvgpr_read_b32 v49, a17
v_mfma_f32_16x16x32_bf16 a[92:95], a[188:191], v[172:175], a[92:95]
v_accvgpr_read_b32 v50, a18
v_accvgpr_read_b32 v51, a19
v_mfma_f32_16x16x32_bf16 a[128:131], a[176:179], v[176:179], a[128:131]
ds_read_b64_tr_b16 a[172:173], v31 offset:27872
v_accvgpr_read_b32 v52, a52
v_mfma_f32_16x16x32_bf16 a[128:131], a[180:183], v[180:183], a[128:131]
v_accvgpr_read_b32 v53, a53
v_accvgpr_read_b32 v54, a54
v_mfma_f32_16x16x32_bf16 a[128:131], a[184:187], v[184:187], a[128:131]
ds_read_b64_tr_b16 a[174:175], v31 offset:32480
v_accvgpr_read_b32 v55, a55
v_cvt_pk_bf16_f32 v32, v48, v49
v_mfma_f32_16x16x32_bf16 a[128:131], a[188:191], v[188:191], a[128:131]
s_waitcnt lgkmcnt(8)
v_cvt_pk_bf16_f32 v33, v50, v51
v_cvt_pk_bf16_f32 v34, v52, v53
v_mfma_f32_16x16x32_bf16 a[24:27], a[144:147], v[128:131], a[24:27]
ds_read_b64_tr_b16 a[176:177], v31 offset:256
v_cvt_pk_bf16_f32 v35, v54, v55
v_mfma_f32_16x16x32_bf16 a[24:27], a[148:151], v[132:135], a[24:27]
s_add_u32 s29, s70, 4096
buffer_store_dwordx4 v[32:35], v2, s[56:59], s29 offen sc1
v_accvgpr_read_b32 v56, a88
v_mfma_f32_16x16x32_bf16 a[24:27], a[152:155], v[136:139], a[24:27]
ds_read_b64_tr_b16 a[178:179], v31 offset:4864
v_accvgpr_read_b32 v57, a89
v_mfma_f32_16x16x32_bf16 a[24:27], a[156:159], v[140:143], a[24:27]
v_accvgpr_read_b32 v58, a90
v_accvgpr_read_b32 v59, a91
v_mfma_f32_16x16x32_bf16 a[60:63], a[144:147], v[144:147], a[60:63]
ds_read_b64_tr_b16 a[180:181], v31 offset:9472
v_accvgpr_read_b32 v60, a124
v_mfma_f32_16x16x32_bf16 a[60:63], a[148:151], v[148:151], a[60:63]
v_accvgpr_read_b32 v61, a125
v_accvgpr_read_b32 v62, a126
v_mfma_f32_16x16x32_bf16 a[60:63], a[152:155], v[152:155], a[60:63]
ds_read_b64_tr_b16 a[182:183], v31 offset:14080
v_accvgpr_read_b32 v63, a127
v_cvt_pk_bf16_f32 v36, v56, v57
v_mfma_f32_16x16x32_bf16 a[60:63], a[156:159], v[156:159], a[60:63]
v_cvt_pk_bf16_f32 v37, v58, v59
v_cvt_pk_bf16_f32 v38, v60, v61
v_mfma_f32_16x16x32_bf16 a[96:99], a[144:147], v[160:163], a[96:99]
ds_read_b64_tr_b16 a[184:185], v31 offset:18688
v_cvt_pk_bf16_f32 v39, v62, v63
v_mfma_f32_16x16x32_bf16 a[96:99], a[148:151], v[164:167], a[96:99]
s_add_u32 s29, s70, 40960
buffer_store_dwordx4 v[36:39], v2, s[56:59], s29 offen sc1
v_accvgpr_read_b32 v48, a20
v_mfma_f32_16x16x32_bf16 a[96:99], a[152:155], v[168:171], a[96:99]
ds_read_b64_tr_b16 a[186:187], v31 offset:23296
v_accvgpr_read_b32 v49, a21
v_mfma_f32_16x16x32_bf16 a[96:99], a[156:159], v[172:175], a[96:99]
v_accvgpr_read_b32 v50, a22
v_accvgpr_read_b32 v51, a23
v_mfma_f32_16x16x32_bf16 a[132:135], a[144:147], v[176:179], a[132:135]
ds_read_b64_tr_b16 a[188:189], v31 offset:27904
v_accvgpr_read_b32 v52, a56
v_mfma_f32_16x16x32_bf16 a[132:135], a[148:151], v[180:183], a[132:135]
v_accvgpr_read_b32 v53, a57
v_accvgpr_read_b32 v54, a58
v_mfma_f32_16x16x32_bf16 a[132:135], a[152:155], v[184:187], a[132:135]
ds_read_b64_tr_b16 a[190:191], v31 offset:32512
v_accvgpr_read_b32 v55, a59
v_cvt_pk_bf16_f32 v40, v48, v49
v_mfma_f32_16x16x32_bf16 a[132:135], a[156:159], v[188:191], a[132:135]
s_waitcnt lgkmcnt(8)
v_cvt_pk_bf16_f32 v41, v50, v51
v_cvt_pk_bf16_f32 v42, v52, v53
v_mfma_f32_16x16x32_bf16 a[28:31], a[160:163], v[128:131], a[28:31]
v_cvt_pk_bf16_f32 v43, v54, v55
v_mfma_f32_16x16x32_bf16 a[28:31], a[164:167], v[132:135], a[28:31]
s_add_u32 s29, s70, 4096
buffer_store_dwordx4 v[40:43], v2, s[56:59], s29 offen offset:1024 sc1
v_accvgpr_read_b32 v56, a92
v_mfma_f32_16x16x32_bf16 a[28:31], a[168:171], v[136:139], a[28:31]
v_accvgpr_read_b32 v57, a93
v_accvgpr_read_b32 v58, a94
v_mfma_f32_16x16x32_bf16 a[28:31], a[172:175], v[140:143], a[28:31]
v_accvgpr_read_b32 v59, a95
v_accvgpr_read_b32 v60, a128
v_mfma_f32_16x16x32_bf16 a[64:67], a[160:163], v[144:147], a[64:67]
v_accvgpr_read_b32 v61, a129
v_accvgpr_read_b32 v62, a130
v_mfma_f32_16x16x32_bf16 a[64:67], a[164:167], v[148:151], a[64:67]
v_accvgpr_read_b32 v63, a131
v_cvt_pk_bf16_f32 v44, v56, v57
v_mfma_f32_16x16x32_bf16 a[64:67], a[168:171], v[152:155], a[64:67]
v_cvt_pk_bf16_f32 v45, v58, v59
v_cvt_pk_bf16_f32 v46, v60, v61
v_mfma_f32_16x16x32_bf16 a[64:67], a[172:175], v[156:159], a[64:67]
v_cvt_pk_bf16_f32 v47, v62, v63
v_mfma_f32_16x16x32_bf16 a[100:103], a[160:163], v[160:163], a[100:103]
s_add_u32 s29, s70, 40960
buffer_store_dwordx4 v[44:47], v2, s[56:59], s29 offen offset:1024 sc1
v_accvgpr_read_b32 v48, a24
v_mfma_f32_16x16x32_bf16 a[100:103], a[164:167], v[164:167], a[100:103]
v_accvgpr_read_b32 v49, a25
v_accvgpr_read_b32 v50, a26
v_mfma_f32_16x16x32_bf16 a[100:103], a[168:171], v[168:171], a[100:103]
v_accvgpr_read_b32 v51, a27
v_accvgpr_read_b32 v52, a60
v_mfma_f32_16x16x32_bf16 a[100:103], a[172:175], v[172:175], a[100:103]
v_accvgpr_read_b32 v53, a61
v_accvgpr_read_b32 v54, a62
v_mfma_f32_16x16x32_bf16 a[136:139], a[160:163], v[176:179], a[136:139]
v_accvgpr_read_b32 v55, a63
v_cvt_pk_bf16_f32 v32, v48, v49
v_mfma_f32_16x16x32_bf16 a[136:139], a[164:167], v[180:183], a[136:139]
v_cvt_pk_bf16_f32 v33, v50, v51
v_cvt_pk_bf16_f32 v34, v52, v53
v_mfma_f32_16x16x32_bf16 a[136:139], a[168:171], v[184:187], a[136:139]
v_cvt_pk_bf16_f32 v35, v54, v55
v_mfma_f32_16x16x32_bf16 a[136:139], a[172:175], v[188:191], a[136:139]
s_waitcnt lgkmcnt(0)
s_add_u32 s29, s70, 4096
buffer_store_dwordx4 v[32:35], v2, s[56:59], s29 offen offset:2048 sc1
v_accvgpr_read_b32 v56, a96
v_mfma_f32_16x16x32_bf16 a[32:35], a[176:179], v[128:131], a[32:35]
v_accvgpr_read_b32 v57, a97
v_accvgpr_read_b32 v58, a98
v_mfma_f32_16x16x32_bf16 a[32:35], a[180:183], v[132:135], a[32:35]
v_accvgpr_read_b32 v59, a99
v_accvgpr_read_b32 v60, a132
v_mfma_f32_16x16x32_bf16 a[32:35], a[184:187], v[136:139], a[32:35]
v_accvgpr_read_b32 v61, a133
v_accvgpr_read_b32 v62, a134
v_mfma_f32_16x16x32_bf16 a[32:35], a[188:191], v[140:143], a[32:35]
v_accvgpr_read_b32 v63, a135
v_cvt_pk_bf16_f32 v36, v56, v57
v_mfma_f32_16x16x32_bf16 a[68:71], a[176:179], v[144:147], a[68:71]
v_cvt_pk_bf16_f32 v37, v58, v59
v_cvt_pk_bf16_f32 v38, v60, v61
v_mfma_f32_16x16x32_bf16 a[68:71], a[180:183], v[148:151], a[68:71]
v_cvt_pk_bf16_f32 v39, v62, v63
v_mfma_f32_16x16x32_bf16 a[68:71], a[184:187], v[152:155], a[68:71]
s_add_u32 s29, s70, 40960
buffer_store_dwordx4 v[36:39], v2, s[56:59], s29 offen offset:2048 sc1
v_mfma_f32_16x16x32_bf16 a[68:71], a[188:191], v[156:159], a[68:71]
v_mfma_f32_16x16x32_bf16 a[104:107], a[176:179], v[160:163], a[104:107]
v_accvgpr_read_b32 v48, a28
v_accvgpr_read_b32 v49, a29
v_mfma_f32_16x16x32_bf16 a[104:107], a[180:183], v[164:167], a[104:107]
v_accvgpr_read_b32 v50, a30
v_accvgpr_read_b32 v51, a31
v_mfma_f32_16x16x32_bf16 a[104:107], a[184:187], v[168:171], a[104:107]
v_accvgpr_read_b32 v52, a64
v_accvgpr_read_b32 v53, a65
v_mfma_f32_16x16x32_bf16 a[104:107], a[188:191], v[172:175], a[104:107]
v_accvgpr_read_b32 v54, a66
v_accvgpr_read_b32 v55, a67
v_mfma_f32_16x16x32_bf16 a[140:143], a[176:179], v[176:179], a[140:143]
v_cvt_pk_bf16_f32 v40, v48, v49
v_cvt_pk_bf16_f32 v41, v50, v51
v_mfma_f32_16x16x32_bf16 a[140:143], a[180:183], v[180:183], a[140:143]
v_cvt_pk_bf16_f32 v42, v52, v53
v_cvt_pk_bf16_f32 v43, v54, v55
v_mfma_f32_16x16x32_bf16 a[140:143], a[184:187], v[184:187], a[140:143]
s_add_u32 s29, s70, 4096
buffer_store_dwordx4 v[40:43], v2, s[56:59], s29 offen offset:3072 sc1
v_accvgpr_read_b32 v56, a100
v_mfma_f32_16x16x32_bf16 a[140:143], a[188:191], v[188:191], a[140:143]
v_accvgpr_read_b32 v57, a101
v_accvgpr_read_b32 v58, a102
v_accvgpr_read_b32 v59, a103
v_accvgpr_read_b32 v60, a136
v_accvgpr_read_b32 v61, a137
v_accvgpr_read_b32 v62, a138
v_accvgpr_read_b32 v63, a139
v_cvt_pk_bf16_f32 v44, v56, v57
v_cvt_pk_bf16_f32 v45, v58, v59
v_cvt_pk_bf16_f32 v46, v60, v61
v_cvt_pk_bf16_f32 v47, v62, v63
s_add_u32 s29, s70, 40960
buffer_store_dwordx4 v[44:47], v2, s[56:59], s29 offen offset:3072 sc1
s_nop 7
v_accvgpr_read_b32 v48, a32
v_accvgpr_read_b32 v49, a33
v_accvgpr_read_b32 v50, a34
v_accvgpr_read_b32 v51, a35
v_accvgpr_read_b32 v52, a68
v_accvgpr_read_b32 v53, a69
v_accvgpr_read_b32 v54, a70
v_accvgpr_read_b32 v55, a71
v_cvt_pk_bf16_f32 v32, v48, v49
v_cvt_pk_bf16_f32 v33, v50, v51
v_cvt_pk_bf16_f32 v34, v52, v53
v_cvt_pk_bf16_f32 v35, v54, v55
s_add_u32 s29, s70, 8192
buffer_store_dwordx4 v[32:35], v2, s[56:59], s29 offen sc1
v_accvgpr_read_b32 v56, a104
v_accvgpr_read_b32 v57, a105
v_accvgpr_read_b32 v58, a106
v_accvgpr_read_b32 v59, a107
v_accvgpr_read_b32 v60, a140
v_accvgpr_read_b32 v61, a141
v_accvgpr_read_b32 v62, a142
v_accvgpr_read_b32 v63, a143
v_cvt_pk_bf16_f32 v36, v56, v57
v_cvt_pk_bf16_f32 v37, v58, v59
v_cvt_pk_bf16_f32 v38, v60, v61
v_cvt_pk_bf16_f32 v39, v62, v63
s_add_u32 s29, s70, 45056
buffer_store_dwordx4 v[36:39], v2, s[56:59], s29 offen sc1
s_branch L_ap_done
L_ap_path5:
s_waitcnt vmcnt(12) lgkmcnt(8)
v_mfma_f32_16x16x32_bf16 a[0:3], a[144:147], v[64:67], 0
ds_read_b64_tr_b16 a[176:177], v28 offset:64
v_mfma_f32_16x16x32_bf16 a[0:3], a[148:151], v[68:71], a[0:3]
s_add_u32 m0, s24, 36864
s_add_u32 s21, s25, 147456
buffer_load_dwordx4 v6, s[40:43], s21 offen lds
v_mfma_f32_16x16x32_bf16 a[0:3], a[152:155], v[72:75], a[0:3]
ds_read_b64_tr_b16 a[178:179], v28 offset:4672
v_mfma_f32_16x16x32_bf16 a[0:3], a[156:159], v[76:79], a[0:3]
s_waitcnt vmcnt(9)
s_add_u32 m0, m0, 1024
s_nop 0
buffer_load_dwordx4 v7, s[40:43], s21 offen lds
v_mfma_f32_16x16x32_bf16 a[36:39], a[144:147], v[80:83], 0
ds_read_b64_tr_b16 a[180:181], v28 offset:9280
v_mfma_f32_16x16x32_bf16 a[36:39], a[148:151], v[84:87], a[36:39]
s_add_u32 m0, m0, 1024
s_nop 0
buffer_load_dwordx4 v8, s[40:43], s21 offen lds
v_mfma_f32_16x16x32_bf16 a[36:39], a[152:155], v[88:91], a[36:39]
ds_read_b64_tr_b16 a[182:183], v28 offset:13888
v_mfma_f32_16x16x32_bf16 a[36:39], a[156:159], v[92:95], a[36:39]
s_waitcnt vmcnt(7)
v_mfma_f32_16x16x32_bf16 a[72:75], a[144:147], v[96:99], 0
ds_read_b64_tr_b16 a[184:185], v28 offset:18496
v_mfma_f32_16x16x32_bf16 a[72:75], a[148:151], v[100:103], a[72:75]
s_add_u32 m0, m0, 1024
s_nop 0
buffer_load_dwordx4 v9, s[40:43], s21 offen lds
v_mfma_f32_16x16x32_bf16 a[72:75], a[152:155], v[104:107], a[72:75]
ds_read_b64_tr_b16 a[186:187], v28 offset:23104
v_mfma_f32_16x16x32_bf16 a[72:75], a[156:159], v[108:111], a[72:75]
s_waitcnt vmcnt(4)
s_add_u32 m0, m0, 1024
s_nop 0
buffer_load_dwordx4 v10, s[40:43], s21 offen lds
v_mfma_f32_16x16x32_bf16 a[108:111], a[144:147], v[112:115], 0
ds_read_b64_tr_b16 a[188:189], v28 offset:27712
v_mfma_f32_16x16x32_bf16 a[108:111], a[148:151], v[116:119], a[108:111]
s_add_u32 m0, m0, 1024
s_nop 0
buffer_load_dwordx4 v11, s[40:43], s21 offen lds
v_mfma_f32_16x16x32_bf16 a[108:111], a[152:155], v[120:123], a[108:111]
ds_read_b64_tr_b16 a[190:191], v28 offset:32320
v_mfma_f32_16x16x32_bf16 a[108:111], a[156:159], v[124:127], a[108:111]
s_waitcnt lgkmcnt(8)
s_add_u32 m0, m0, 1024
s_nop 0
buffer_load_dwordx4 v12, s[40:43], s21 offen lds
v_mfma_f32_16x16x32_bf16 a[4:7], a[160:163], v[64:67], 0
ds_read_b64_tr_b16 a[144:145], v28 offset:96
v_mfma_f32_16x16x32_bf16 a[4:7], a[164:167], v[68:71], a[4:7]
s_add_u32 m0, m0, 1024
s_nop 0
buffer_load_dwordx4 v13, s[40:43], s21 offen lds
v_mfma_f32_16x16x32_bf16 a[4:7], a[168:171], v[72:75], a[4:7]
ds_read_b64_tr_b16 a[146:147], v28 offset:4704
v_mfma_f32_16x16x32_bf16 a[4:7], a[172:175], v[76:79], a[4:7]
s_add_u32 m0, m0, 1024
s_nop 0
buffer_load_dwordx4 v14, s[40:43], s21 offen lds
v_mfma_f32_16x16x32_bf16 a[40:43], a[160:163], v[80:83], 0
ds_read_b64_tr_b16 a[148:149], v28 offset:9312
v_mfma_f32_16x16x32_bf16 a[40:43], a[164:167], v[84:87], a[40:43]
v_mfma_f32_16x16x32_bf16 a[40:43], a[168:171], v[88:91], a[40:43]
ds_read_b64_tr_b16 a[150:151], v28 offset:13920
v_mfma_f32_16x16x32_bf16 a[40:43], a[172:175], v[92:95], a[40:43]
s_add_u32 s16, s32, 4096
buffer_load_dwordx4 v[128:131], v2, s[48:51], s16 offen
v_mfma_f32_16x16x32_bf16 a[76:79], a[160:163], v[96:99], 0
ds_read_b64_tr_b16 a[152:153], v28 offset:18528
v_mfma_f32_16x16x32_bf16 a[76:79], a[164:167], v[100:103], a[76:79]
buffer_load_dwordx4 v[132:135], v2, s[48:51], s16 offen offset:1024
v_mfma_f32_16x16x32_bf16 a[76:79], a[168:171], v[104:107], a[76:79]
ds_read_b64_tr_b16 a[154:155], v28 offset:23136
v_mfma_f32_16x16x32_bf16 a[76:79], a[172:175], v[108:111], a[76:79]
buffer_load_dwordx4 v[136:139], v2, s[48:51], s16 offen offset:2048
v_mfma_f32_16x16x32_bf16 a[112:115], a[160:163], v[112:115], 0
ds_read_b64_tr_b16 a[156:157], v28 offset:27744
v_mfma_f32_16x16x32_bf16 a[112:115], a[164:167], v[116:119], a[112:115]
buffer_load_dwordx4 v[140:143], v2, s[48:51], s16 offen offset:3072
v_mfma_f32_16x16x32_bf16 a[112:115], a[168:171], v[120:123], a[112:115]
ds_read_b64_tr_b16 a[158:159], v28 offset:32352
v_mfma_f32_16x16x32_bf16 a[112:115], a[172:175], v[124:127], a[112:115]
s_waitcnt lgkmcnt(8)
s_add_u32 s17, s33, 4096
buffer_load_dwordx4 v[144:147], v2, s[48:51], s17 offen
v_mfma_f32_16x16x32_bf16 a[8:11], a[176:179], v[64:67], 0
ds_read_b64_tr_b16 a[160:161], v28 offset:128
v_mfma_f32_16x16x32_bf16 a[8:11], a[180:183], v[68:71], a[8:11]
buffer_load_dwordx4 v[148:151], v2, s[48:51], s17 offen offset:1024
v_mfma_f32_16x16x32_bf16 a[8:11], a[184:187], v[72:75], a[8:11]
ds_read_b64_tr_b16 a[162:163], v28 offset:4736
v_mfma_f32_16x16x32_bf16 a[8:11], a[188:191], v[76:79], a[8:11]
v_mfma_f32_16x16x32_bf16 a[44:47], a[176:179], v[80:83], 0
ds_read_b64_tr_b16 a[164:165], v28 offset:9344
v_mfma_f32_16x16x32_bf16 a[44:47], a[180:183], v[84:87], a[44:47]
buffer_load_dwordx4 v[152:155], v2, s[48:51], s17 offen offset:2048
v_mfma_f32_16x16x32_bf16 a[44:47], a[184:187], v[88:91], a[44:47]
ds_read_b64_tr_b16 a[166:167], v28 offset:13952
v_mfma_f32_16x16x32_bf16 a[44:47], a[188:191], v[92:95], a[44:47]
buffer_load_dwordx4 v[156:159], v2, s[48:51], s17 offen offset:3072
v_mfma_f32_16x16x32_bf16 a[80:83], a[176:179], v[96:99], 0
ds_read_b64_tr_b16 a[168:169], v28 offset:18560
v_mfma_f32_16x16x32_bf16 a[80:83], a[180:183], v[100:103], a[80:83]
s_add_u32 s18, s34, 4096
buffer_load_dwordx4 v[160:163], v2, s[48:51], s18 offen
v_mfma_f32_16x16x32_bf16 a[80:83], a[184:187], v[104:107], a[80:83]
ds_read_b64_tr_b16 a[170:171], v28 offset:23168
v_mfma_f32_16x16x32_bf16 a[80:83], a[188:191], v[108:111], a[80:83]
buffer_load_dwordx4 v[164:167], v2, s[48:51], s18 offen offset:1024
v_mfma_f32_16x16x32_bf16 a[116:119], a[176:179], v[112:115], 0
ds_read_b64_tr_b16 a[172:173], v28 offset:27776
v_mfma_f32_16x16x32_bf16 a[116:119], a[180:183], v[116:119], a[116:119]
buffer_load_dwordx4 v[168:171], v2, s[48:51], s18 offen offset:2048
v_mfma_f32_16x16x32_bf16 a[116:119], a[184:187], v[120:123], a[116:119]
ds_read_b64_tr_b16 a[174:175], v28 offset:32384
v_mfma_f32_16x16x32_bf16 a[116:119], a[188:191], v[124:127], a[116:119]
s_waitcnt lgkmcnt(8)
buffer_load_dwordx4 v[172:175], v2, s[48:51], s18 offen offset:3072
v_mfma_f32_16x16x32_bf16 a[12:15], a[144:147], v[64:67], 0
ds_read_b64_tr_b16 a[176:177], v28 offset:160
v_mfma_f32_16x16x32_bf16 a[12:15], a[148:151], v[68:71], a[12:15]
v_mfma_f32_16x16x32_bf16 a[12:15], a[152:155], v[72:75], a[12:15]
ds_read_b64_tr_b16 a[178:179], v28 offset:4768
v_mfma_f32_16x16x32_bf16 a[12:15], a[156:159], v[76:79], a[12:15]
s_add_u32 s19, s35, 4096
buffer_load_dwordx4 v[176:179], v2, s[48:51], s19 offen
v_mfma_f32_16x16x32_bf16 a[48:51], a[144:147], v[80:83], 0
ds_read_b64_tr_b16 a[180:181], v28 offset:9376
v_mfma_f32_16x16x32_bf16 a[48:51], a[148:151], v[84:87], a[48:51]
buffer_load_dwordx4 v[180:183], v2, s[48:51], s19 offen offset:1024
v_mfma_f32_16x16x32_bf16 a[48:51], a[152:155], v[88:91], a[48:51]
ds_read_b64_tr_b16 a[182:183], v28 offset:13984
v_mfma_f32_16x16x32_bf16 a[48:51], a[156:159], v[92:95], a[48:51]
buffer_load_dwordx4 v[184:187], v2, s[48:51], s19 offen offset:2048
v_mfma_f32_16x16x32_bf16 a[84:87], a[144:147], v[96:99], 0
ds_read_b64_tr_b16 a[184:185], v28 offset:18592
v_mfma_f32_16x16x32_bf16 a[84:87], a[148:151], v[100:103], a[84:87]
buffer_load_dwordx4 v[188:191], v2, s[48:51], s19 offen offset:3072
v_mfma_f32_16x16x32_bf16 a[84:87], a[152:155], v[104:107], a[84:87]
ds_read_b64_tr_b16 a[186:187], v28 offset:23200
v_mfma_f32_16x16x32_bf16 a[84:87], a[156:159], v[108:111], a[84:87]
s_add_u32 m0, s24, 73728
s_add_u32 s21, s25, 294912
buffer_load_dwordx4 v6, s[40:43], s21 offen lds
v_mfma_f32_16x16x32_bf16 a[120:123], a[144:147], v[112:115], 0
ds_read_b64_tr_b16 a[188:189], v28 offset:27808
v_mfma_f32_16x16x32_bf16 a[120:123], a[148:151], v[116:119], a[120:123]
s_add_u32 m0, m0, 1024
s_nop 0
buffer_load_dwordx4 v7, s[40:43], s21 offen lds
v_mfma_f32_16x16x32_bf16 a[120:123], a[152:155], v[120:123], a[120:123]
ds_read_b64_tr_b16 a[190:191], v28 offset:32416
v_mfma_f32_16x16x32_bf16 a[120:123], a[156:159], v[124:127], a[120:123]
s_waitcnt lgkmcnt(8)
v_mfma_f32_16x16x32_bf16 a[16:19], a[160:163], v[64:67], 0
ds_read_b64_tr_b16 a[144:145], v28 offset:192
v_mfma_f32_16x16x32_bf16 a[16:19], a[164:167], v[68:71], a[16:19]
s_add_u32 m0, m0, 1024
s_nop 0
buffer_load_dwordx4 v8, s[40:43], s21 offen lds
v_mfma_f32_16x16x32_bf16 a[16:19], a[168:171], v[72:75], a[16:19]
ds_read_b64_tr_b16 a[146:147], v28 offset:4800
v_mfma_f32_16x16x32_bf16 a[16:19], a[172:175], v[76:79], a[16:19]
s_add_u32 m0, m0, 1024
s_nop 0
buffer_load_dwordx4 v9, s[40:43], s21 offen lds
v_mfma_f32_16x16x32_bf16 a[52:55], a[160:163], v[80:83], 0
ds_read_b64_tr_b16 a[148:149], v28 offset:9408
v_mfma_f32_16x16x32_bf16 a[52:55], a[164:167], v[84:87], a[52:55]
s_add_u32 m0, m0, 1024
s_nop 0
buffer_load_dwordx4 v10, s[40:43], s21 offen lds
v_mfma_f32_16x16x32_bf16 a[52:55], a[168:171], v[88:91], a[52:55]
ds_read_b64_tr_b16 a[150:151], v28 offset:14016
v_mfma_f32_16x16x32_bf16 a[52:55], a[172:175], v[92:95], a[52:55]
s_add_u32 m0, m0, 1024
s_nop 0
buffer_load_dwordx4 v11, s[40:43], s21 offen lds
v_mfma_f32_16x16x32_bf16 a[88:91], a[160:163], v[96:99], 0
ds_read_b64_tr_b16 a[152:153], v28 offset:18624
v_mfma_f32_16x16x32_bf16 a[88:91], a[164:167], v[100:103], a[88:91]
s_add_u32 m0, m0, 1024
s_nop 0
buffer_load_dwordx4 v12, s[40:43], s21 offen lds
v_mfma_f32_16x16x32_bf16 a[88:91], a[168:171], v[104:107], a[88:91]
ds_read_b64_tr_b16 a[154:155], v28 offset:23232
v_mfma_f32_16x16x32_bf16 a[88:91], a[172:175], v[108:111], a[88:91]
s_add_u32 m0, m0, 1024
s_nop 0
buffer_load_dwordx4 v13, s[40:43], s21 offen lds
v_mfma_f32_16x16x32_bf16 a[124:127], a[160:163], v[112:115], 0
ds_read_b64_tr_b16 a[156:157], v28 offset:27840
v_mfma_f32_16x16x32_bf16 a[124:127], a[164:167], v[116:119], a[124:127]
v_mfma_f32_16x16x32_bf16 a[124:127], a[168:171], v[120:123], a[124:127]
ds_read_b64_tr_b16 a[158:159], v28 offset:32448
v_mfma_f32_16x16x32_bf16 a[124:127], a[172:175], v[124:127], a[124:127]
s_waitcnt lgkmcnt(8)
s_add_u32 m0, m0, 1024
s_nop 0
buffer_load_dwordx4 v14, s[40:43], s21 offen lds
v_mfma_f32_16x16x32_bf16 a[20:23], a[176:179], v[64:67], 0
ds_read_b64_tr_b16 a[160:161], v28 offset:224
v_mfma_f32_16x16x32_bf16 a[20:23], a[180:183], v[68:71], a[20:23]
s_add_u32 s16, s32, 8192
buffer_load_dwordx4 v[192:195], v2, s[48:51], s16 offen
v_mfma_f32_16x16x32_bf16 a[20:23], a[184:187], v[72:75], a[20:23]
ds_read_b64_tr_b16 a[162:163], v28 offset:4832
v_mfma_f32_16x16x32_bf16 a[20:23], a[188:191], v[76:79], a[20:23]
buffer_load_dwordx4 v[196:199], v2, s[48:51], s16 offen offset:1024
v_mfma_f32_16x16x32_bf16 a[56:59], a[176:179], v[80:83], 0
ds_read_b64_tr_b16 a[164:165], v28 offset:9440
v_mfma_f32_16x16x32_bf16 a[56:59], a[180:183], v[84:87], a[56:59]
s_add_u32 m0, s24, 110592
s_add_u32 s21, s25, 442368
buffer_load_dwordx4 v6, s[40:43], s21 offen lds
v_mfma_f32_16x16x32_bf16 a[56:59], a[184:187], v[88:91], a[56:59]
ds_read_b64_tr_b16 a[166:167], v28 offset:14048
v_mfma_f32_16x16x32_bf16 a[56:59], a[188:191], v[92:95], a[56:59]
buffer_load_dwordx4 v[200:203], v2, s[48:51], s16 offen offset:2048
v_mfma_f32_16x16x32_bf16 a[92:95], a[176:179], v[96:99], 0
ds_read_b64_tr_b16 a[168:169], v28 offset:18656
v_mfma_f32_16x16x32_bf16 a[92:95], a[180:183], v[100:103], a[92:95]
buffer_load_dwordx4 v[204:207], v2, s[48:51], s16 offen offset:3072
v_mfma_f32_16x16x32_bf16 a[92:95], a[184:187], v[104:107], a[92:95]
ds_read_b64_tr_b16 a[170:171], v28 offset:23264
v_mfma_f32_16x16x32_bf16 a[92:95], a[188:191], v[108:111], a[92:95]
v_mfma_f32_16x16x32_bf16 a[128:131], a[176:179], v[112:115], 0
ds_read_b64_tr_b16 a[172:173], v28 offset:27872
v_mfma_f32_16x16x32_bf16 a[128:131], a[180:183], v[116:119], a[128:131]
s_add_u32 m0, m0, 1024
s_nop 0
buffer_load_dwordx4 v7, s[40:43], s21 offen lds
v_mfma_f32_16x16x32_bf16 a[128:131], a[184:187], v[120:123], a[128:131]
ds_read_b64_tr_b16 a[174:175], v28 offset:32480
v_mfma_f32_16x16x32_bf16 a[128:131], a[188:191], v[124:127], a[128:131]
s_waitcnt lgkmcnt(8)
s_add_u32 s17, s33, 8192
buffer_load_dwordx4 v[208:211], v2, s[48:51], s17 offen
v_mfma_f32_16x16x32_bf16 a[24:27], a[144:147], v[64:67], 0
ds_read_b64_tr_b16 a[176:177], v28 offset:256
v_mfma_f32_16x16x32_bf16 a[24:27], a[148:151], v[68:71], a[24:27]
buffer_load_dwordx4 v[212:215], v2, s[48:51], s17 offen offset:1024
v_mfma_f32_16x16x32_bf16 a[24:27], a[152:155], v[72:75], a[24:27]
ds_read_b64_tr_b16 a[178:179], v28 offset:4864
v_mfma_f32_16x16x32_bf16 a[24:27], a[156:159], v[76:79], a[24:27]
s_add_u32 m0, m0, 1024
s_nop 0
buffer_load_dwordx4 v8, s[40:43], s21 offen lds
v_mfma_f32_16x16x32_bf16 a[60:63], a[144:147], v[80:83], 0
ds_read_b64_tr_b16 a[180:181], v28 offset:9472
v_mfma_f32_16x16x32_bf16 a[60:63], a[148:151], v[84:87], a[60:63]
buffer_load_dwordx4 v[216:219], v2, s[48:51], s17 offen offset:2048
v_mfma_f32_16x16x32_bf16 a[60:63], a[152:155], v[88:91], a[60:63]
ds_read_b64_tr_b16 a[182:183], v28 offset:14080
v_mfma_f32_16x16x32_bf16 a[60:63], a[156:159], v[92:95], a[60:63]
buffer_load_dwordx4 v[220:223], v2, s[48:51], s17 offen offset:3072
v_mfma_f32_16x16x32_bf16 a[96:99], a[144:147], v[96:99], 0
ds_read_b64_tr_b16 a[184:185], v28 offset:18688
v_mfma_f32_16x16x32_bf16 a[96:99], a[148:151], v[100:103], a[96:99]
v_mfma_f32_16x16x32_bf16 a[96:99], a[152:155], v[104:107], a[96:99]
ds_read_b64_tr_b16 a[186:187], v28 offset:23296
v_mfma_f32_16x16x32_bf16 a[96:99], a[156:159], v[108:111], a[96:99]
s_add_u32 m0, m0, 1024
s_nop 0
buffer_load_dwordx4 v9, s[40:43], s21 offen lds
v_mfma_f32_16x16x32_bf16 a[132:135], a[144:147], v[112:115], 0
ds_read_b64_tr_b16 a[188:189], v28 offset:27904
v_mfma_f32_16x16x32_bf16 a[132:135], a[148:151], v[116:119], a[132:135]
s_add_u32 s18, s34, 8192
buffer_load_dwordx4 v[224:227], v2, s[48:51], s18 offen
v_mfma_f32_16x16x32_bf16 a[132:135], a[152:155], v[120:123], a[132:135]
ds_read_b64_tr_b16 a[190:191], v28 offset:32512
v_mfma_f32_16x16x32_bf16 a[132:135], a[156:159], v[124:127], a[132:135]
s_waitcnt lgkmcnt(8)
buffer_load_dwordx4 v[228:231], v2, s[48:51], s18 offen offset:1024
v_mfma_f32_16x16x32_bf16 a[28:31], a[160:163], v[64:67], 0
v_mfma_f32_16x16x32_bf16 a[28:31], a[164:167], v[68:71], a[28:31]
s_add_u32 m0, m0, 1024
s_nop 0
buffer_load_dwordx4 v10, s[40:43], s21 offen lds
v_mfma_f32_16x16x32_bf16 a[28:31], a[168:171], v[72:75], a[28:31]
s_waitcnt vmcnt(40) lgkmcnt(0)
s_barrier
v_mfma_f32_16x16x32_bf16 a[28:31], a[172:175], v[76:79], a[28:31]
ds_read_b64_tr_b16 a[144:145], v29
v_mfma_f32_16x16x32_bf16 a[64:67], a[160:163], v[80:83], 0
ds_read_b64_tr_b16 a[146:147], v29 offset:4608
v_mfma_f32_16x16x32_bf16 a[64:67], a[164:167], v[84:87], a[64:67]
buffer_load_dwordx4 v[232:235], v2, s[48:51], s18 offen offset:2048
v_mfma_f32_16x16x32_bf16 a[64:67], a[168:171], v[88:91], a[64:67]
ds_read_b64_tr_b16 a[148:149], v29 offset:9216
v_mfma_f32_16x16x32_bf16 a[64:67], a[172:175], v[92:95], a[64:67]
ds_read_b64_tr_b16 a[150:151], v29 offset:13824
v_mfma_f32_16x16x32_bf16 a[100:103], a[160:163], v[96:99], 0
buffer_load_dwordx4 v[236:239], v2, s[48:51], s18 offen offset:3072
v_mfma_f32_16x16x32_bf16 a[100:103], a[164:167], v[100:103], a[100:103]
ds_read_b64_tr_b16 a[152:153], v29 offset:18432
v_mfma_f32_16x16x32_bf16 a[100:103], a[168:171], v[104:107], a[100:103]
s_add_u32 m0, m0, 1024
s_nop 0
buffer_load_dwordx4 v11, s[40:43], s21 offen lds
v_mfma_f32_16x16x32_bf16 a[100:103], a[172:175], v[108:111], a[100:103]
ds_read_b64_tr_b16 a[154:155], v29 offset:23040
v_mfma_f32_16x16x32_bf16 a[136:139], a[160:163], v[112:115], 0
ds_read_b64_tr_b16 a[156:157], v29 offset:27648
v_mfma_f32_16x16x32_bf16 a[136:139], a[164:167], v[116:119], a[136:139]
s_add_u32 s19, s35, 8192
buffer_load_dwordx4 v[240:243], v2, s[48:51], s19 offen
v_mfma_f32_16x16x32_bf16 a[136:139], a[168:171], v[120:123], a[136:139]
ds_read_b64_tr_b16 a[158:159], v29 offset:32256
v_mfma_f32_16x16x32_bf16 a[136:139], a[172:175], v[124:127], a[136:139]
buffer_load_dwordx4 v[244:247], v2, s[48:51], s19 offen offset:1024
v_mfma_f32_16x16x32_bf16 a[32:35], a[176:179], v[64:67], 0
ds_read_b64_tr_b16 a[160:161], v29 offset:32
v_mfma_f32_16x16x32_bf16 a[32:35], a[180:183], v[68:71], a[32:35]
ds_read_b64_tr_b16 a[162:163], v29 offset:4640
v_mfma_f32_16x16x32_bf16 a[32:35], a[184:187], v[72:75], a[32:35]
s_add_u32 m0, m0, 1024
s_nop 0
buffer_load_dwordx4 v12, s[40:43], s21 offen lds
v_mfma_f32_16x16x32_bf16 a[32:35], a[188:191], v[76:79], a[32:35]
ds_read_b64_tr_b16 a[164:165], v29 offset:9248
v_mfma_f32_16x16x32_bf16 a[68:71], a[176:179], v[80:83], 0
buffer_load_dwordx4 v[248:251], v2, s[48:51], s19 offen offset:2048
v_mfma_f32_16x16x32_bf16 a[68:71], a[180:183], v[84:87], a[68:71]
ds_read_b64_tr_b16 a[166:167], v29 offset:13856
v_mfma_f32_16x16x32_bf16 a[68:71], a[184:187], v[88:91], a[68:71]
buffer_load_dwordx4 v[252:255], v2, s[48:51], s19 offen offset:3072
v_mfma_f32_16x16x32_bf16 a[68:71], a[188:191], v[92:95], a[68:71]
ds_read_b64_tr_b16 a[168:169], v29 offset:18464
v_mfma_f32_16x16x32_bf16 a[104:107], a[176:179], v[96:99], 0
ds_read_b64_tr_b16 a[170:171], v29 offset:23072
v_mfma_f32_16x16x32_bf16 a[104:107], a[180:183], v[100:103], a[104:107]
s_add_u32 m0, m0, 1024
s_nop 0
buffer_load_dwordx4 v13, s[40:43], s21 offen lds
v_mfma_f32_16x16x32_bf16 a[104:107], a[184:187], v[104:107], a[104:107]
ds_read_b64_tr_b16 a[172:173], v29 offset:27680
v_mfma_f32_16x16x32_bf16 a[104:107], a[188:191], v[108:111], a[104:107]
s_add_u32 m0, m0, 1024
s_nop 0
buffer_load_dwordx4 v14, s[40:43], s21 offen lds
v_mfma_f32_16x16x32_bf16 a[140:143], a[176:179], v[112:115], 0
ds_read_b64_tr_b16 a[174:175], v29 offset:32288
v_mfma_f32_16x16x32_bf16 a[140:143], a[180:183], v[116:119], a[140:143]
v_mfma_f32_16x16x32_bf16 a[140:143], a[184:187], v[120:123], a[140:143]
v_mfma_f32_16x16x32_bf16 a[140:143], a[188:191], v[124:127], a[140:143]
s_waitcnt vmcnt(46) lgkmcnt(8)
v_mfma_f32_16x16x32_bf16 a[0:3], a[144:147], v[128:131], a[0:3]
ds_read_b64_tr_b16 a[176:177], v29 offset:64
v_mfma_f32_16x16x32_bf16 a[0:3], a[148:151], v[132:135], a[0:3]
s_add_u32 s16, s32, 12288
buffer_load_dwordx4 v[64:67], v2, s[48:51], s16 offen
v_mfma_f32_16x16x32_bf16 a[0:3], a[152:155], v[136:139], a[0:3]
ds_read_b64_tr_b16 a[178:179], v29 offset:4672
v_mfma_f32_16x16x32_bf16 a[0:3], a[156:159], v[140:143], a[0:3]
s_waitcnt vmcnt(43)
v_mfma_f32_16x16x32_bf16 a[36:39], a[144:147], v[144:147], a[36:39]
ds_read_b64_tr_b16 a[180:181], v29 offset:9280
v_mfma_f32_16x16x32_bf16 a[36:39], a[148:151], v[148:151], a[36:39]
v_mfma_f32_16x16x32_bf16 a[36:39], a[152:155], v[152:155], a[36:39]
ds_read_b64_tr_b16 a[182:183], v29 offset:13888
v_mfma_f32_16x16x32_bf16 a[36:39], a[156:159], v[156:159], a[36:39]
s_waitcnt vmcnt(39)
buffer_load_dwordx4 v[68:71], v2, s[48:51], s16 offen offset:1024
v_mfma_f32_16x16x32_bf16 a[72:75], a[144:147], v[160:163], a[72:75]
ds_read_b64_tr_b16 a[184:185], v29 offset:18496
v_mfma_f32_16x16x32_bf16 a[72:75], a[148:151], v[164:167], a[72:75]
v_mfma_f32_16x16x32_bf16 a[72:75], a[152:155], v[168:171], a[72:75]
ds_read_b64_tr_b16 a[186:187], v29 offset:23104
v_mfma_f32_16x16x32_bf16 a[72:75], a[156:159], v[172:175], a[72:75]
s_waitcnt vmcnt(36)
v_mfma_f32_16x16x32_bf16 a[108:111], a[144:147], v[176:179], a[108:111]
ds_read_b64_tr_b16 a[188:189], v29 offset:27712
v_mfma_f32_16x16x32_bf16 a[108:111], a[148:151], v[180:183], a[108:111]
s_add_u32 m0, s24, 0
s_add_u32 s21, s25, 589824
buffer_load_dwordx4 v6, s[40:43], s21 offen lds
v_mfma_f32_16x16x32_bf16 a[108:111], a[152:155], v[184:187], a[108:111]
ds_read_b64_tr_b16 a[190:191], v29 offset:32320
v_mfma_f32_16x16x32_bf16 a[108:111], a[156:159], v[188:191], a[108:111]
s_waitcnt lgkmcnt(8)
v_mfma_f32_16x16x32_bf16 a[4:7], a[160:163], v[128:131], a[4:7]
ds_read_b64_tr_b16 a[144:145], v29 offset:96
v_mfma_f32_16x16x32_bf16 a[4:7], a[164:167], v[132:135], a[4:7]
buffer_load_dwordx4 v[72:75], v2, s[48:51], s16 offen offset:2048
v_mfma_f32_16x16x32_bf16 a[4:7], a[168:171], v[136:139], a[4:7]
ds_read_b64_tr_b16 a[146:147], v29 offset:4704
v_mfma_f32_16x16x32_bf16 a[4:7], a[172:175], v[140:143], a[4:7]
v_mfma_f32_16x16x32_bf16 a[40:43], a[160:163], v[144:147], a[40:43]
ds_read_b64_tr_b16 a[148:149], v29 offset:9312
v_mfma_f32_16x16x32_bf16 a[40:43], a[164:167], v[148:151], a[40:43]
v_mfma_f32_16x16x32_bf16 a[40:43], a[168:171], v[152:155], a[40:43]
ds_read_b64_tr_b16 a[150:151], v29 offset:13920
v_mfma_f32_16x16x32_bf16 a[40:43], a[172:175], v[156:159], a[40:43]
buffer_load_dwordx4 v[76:79], v2, s[48:51], s16 offen offset:3072
v_mfma_f32_16x16x32_bf16 a[76:79], a[160:163], v[160:163], a[76:79]
ds_read_b64_tr_b16 a[152:153], v29 offset:18528
v_mfma_f32_16x16x32_bf16 a[76:79], a[164:167], v[164:167], a[76:79]
v_mfma_f32_16x16x32_bf16 a[76:79], a[168:171], v[168:171], a[76:79]
ds_read_b64_tr_b16 a[154:155], v29 offset:23136
v_mfma_f32_16x16x32_bf16 a[76:79], a[172:175], v[172:175], a[76:79]
v_mfma_f32_16x16x32_bf16 a[112:115], a[160:163], v[176:179], a[112:115]
ds_read_b64_tr_b16 a[156:157], v29 offset:27744
v_mfma_f32_16x16x32_bf16 a[112:115], a[164:167], v[180:183], a[112:115]
s_add_u32 m0, m0, 1024
s_nop 0
buffer_load_dwordx4 v7, s[40:43], s21 offen lds
v_mfma_f32_16x16x32_bf16 a[112:115], a[168:171], v[184:187], a[112:115]
ds_read_b64_tr_b16 a[158:159], v29 offset:32352
v_mfma_f32_16x16x32_bf16 a[112:115], a[172:175], v[188:191], a[112:115]
s_waitcnt lgkmcnt(8)
v_mfma_f32_16x16x32_bf16 a[8:11], a[176:179], v[128:131], a[8:11]
ds_read_b64_tr_b16 a[160:161], v29 offset:128
v_mfma_f32_16x16x32_bf16 a[8:11], a[180:183], v[132:135], a[8:11]
v_mfma_f32_16x16x32_bf16 a[8:11], a[184:187], v[136:139], a[8:11]
ds_read_b64_tr_b16 a[162:163], v29 offset:4736
v_mfma_f32_16x16x32_bf16 a[8:11], a[188:191], v[140:143], a[8:11]
s_add_u32 s17, s33, 12288
buffer_load_dwordx4 v[80:83], v2, s[48:51], s17 offen
v_mfma_f32_16x16x32_bf16 a[44:47], a[176:179], v[144:147], a[44:47]
ds_read_b64_tr_b16 a[164:165], v29 offset:9344
v_mfma_f32_16x16x32_bf16 a[44:47], a[180:183], v[148:151], a[44:47]
v_mfma_f32_16x16x32_bf16 a[44:47], a[184:187], v[152:155], a[44:47]
ds_read_b64_tr_b16 a[166:167], v29 offset:13952
v_mfma_f32_16x16x32_bf16 a[44:47], a[188:191], v[156:159], a[44:47]
buffer_load_dwordx4 v[84:87], v2, s[48:51], s17 offen offset:1024
v_mfma_f32_16x16x32_bf16 a[80:83], a[176:179], v[160:163], a[80:83]
ds_read_b64_tr_b16 a[168:169], v29 offset:18560
v_mfma_f32_16x16x32_bf16 a[80:83], a[180:183], v[164:167], a[80:83]
v_mfma_f32_16x16x32_bf16 a[80:83], a[184:187], v[168:171], a[80:83]
ds_read_b64_tr_b16 a[170:171], v29 offset:23168
v_mfma_f32_16x16x32_bf16 a[80:83], a[188:191], v[172:175], a[80:83]
v_mfma_f32_16x16x32_bf16 a[116:119], a[176:179], v[176:179], a[116:119]
ds_read_b64_tr_b16 a[172:173], v29 offset:27776
v_mfma_f32_16x16x32_bf16 a[116:119], a[180:183], v[180:183], a[116:119]
s_add_u32 m0, m0, 1024
s_nop 0
buffer_load_dwordx4 v8, s[40:43], s21 offen lds
v_mfma_f32_16x16x32_bf16 a[116:119], a[184:187], v[184:187], a[116:119]
ds_read_b64_tr_b16 a[174:175], v29 offset:32384
v_mfma_f32_16x16x32_bf16 a[116:119], a[188:191], v[188:191], a[116:119]
s_waitcnt lgkmcnt(8)
v_mfma_f32_16x16x32_bf16 a[12:15], a[144:147], v[128:131], a[12:15]
ds_read_b64_tr_b16 a[176:177], v29 offset:160
v_mfma_f32_16x16x32_bf16 a[12:15], a[148:151], v[132:135], a[12:15]
v_mfma_f32_16x16x32_bf16 a[12:15], a[152:155], v[136:139], a[12:15]
ds_read_b64_tr_b16 a[178:179], v29 offset:4768
v_mfma_f32_16x16x32_bf16 a[12:15], a[156:159], v[140:143], a[12:15]
buffer_load_dwordx4 v[88:91], v2, s[48:51], s17 offen offset:2048
v_mfma_f32_16x16x32_bf16 a[48:51], a[144:147], v[144:147], a[48:51]
ds_read_b64_tr_b16 a[180:181], v29 offset:9376
v_mfma_f32_16x16x32_bf16 a[48:51], a[148:151], v[148:151], a[48:51]
v_mfma_f32_16x16x32_bf16 a[48:51], a[152:155], v[152:155], a[48:51]
ds_read_b64_tr_b16 a[182:183], v29 offset:13984
v_mfma_f32_16x16x32_bf16 a[48:51], a[156:159], v[156:159], a[48:51]
v_mfma_f32_16x16x32_bf16 a[84:87], a[144:147], v[160:163], a[84:87]
ds_read_b64_tr_b16 a[184:185], v29 offset:18592
v_mfma_f32_16x16x32_bf16 a[84:87], a[148:151], v[164:167], a[84:87]
buffer_load_dwordx4 v[92:95], v2, s[48:51], s17 offen offset:3072
v_mfma_f32_16x16x32_bf16 a[84:87], a[152:155], v[168:171], a[84:87]
ds_read_b64_tr_b16 a[186:187], v29 offset:23200
v_mfma_f32_16x16x32_bf16 a[84:87], a[156:159], v[172:175], a[84:87]
v_mfma_f32_16x16x32_bf16 a[120:123], a[144:147], v[176:179], a[120:123]
ds_read_b64_tr_b16 a[188:189], v29 offset:27808
v_mfma_f32_16x16x32_bf16 a[120:123], a[148:151], v[180:183], a[120:123]
s_add_u32 m0, m0, 1024
s_nop 0
buffer_load_dwordx4 v9, s[40:43], s21 offen lds
v_mfma_f32_16x16x32_bf16 a[120:123], a[152:155], v[184:187], a[120:123]
ds_read_b64_tr_b16 a[190:191], v29 offset:32416
v_mfma_f32_16x16x32_bf16 a[120:123], a[156:159], v[188:191], a[120:123]
s_waitcnt lgkmcnt(8)
v_mfma_f32_16x16x32_bf16 a[16:19], a[160:163], v[128:131], a[16:19]
ds_read_b64_tr_b16 a[144:145], v29 offset:192
v_mfma_f32_16x16x32_bf16 a[16:19], a[164:167], v[132:135], a[16:19]
v_mfma_f32_16x16x32_bf16 a[16:19], a[168:171], v[136:139], a[16:19]
ds_read_b64_tr_b16 a[146:147], v29 offset:4800
v_mfma_f32_16x16x32_bf16 a[16:19], a[172:175], v[140:143], a[16:19]
s_add_u32 s18, s34, 12288
buffer_load_dwordx4 v[96:99], v2, s[48:51], s18 offen
v_mfma_f32_16x16x32_bf16 a[52:55], a[160:163], v[144:147], a[52:55]
ds_read_b64_tr_b16 a[148:149], v29 offset:9408
v_mfma_f32_16x16x32_bf16 a[52:55], a[164:167], v[148:151], a[52:55]
v_mfma_f32_16x16x32_bf16 a[52:55], a[168:171], v[152:155], a[52:55]
ds_read_b64_tr_b16 a[150:151], v29 offset:14016
v_mfma_f32_16x16x32_bf16 a[52:55], a[172:175], v[156:159], a[52:55]
v_mfma_f32_16x16x32_bf16 a[88:91], a[160:163], v[160:163], a[88:91]
ds_read_b64_tr_b16 a[152:153], v29 offset:18624
v_mfma_f32_16x16x32_bf16 a[88:91], a[164:167], v[164:167], a[88:91]
buffer_load_dwordx4 v[100:103], v2, s[48:51], s18 offen offset:1024
v_mfma_f32_16x16x32_bf16 a[88:91], a[168:171], v[168:171], a[88:91]
ds_read_b64_tr_b16 a[154:155], v29 offset:23232
v_mfma_f32_16x16x32_bf16 a[88:91], a[172:175], v[172:175], a[88:91]
v_mfma_f32_16x16x32_bf16 a[124:127], a[160:163], v[176:179], a[124:127]
ds_read_b64_tr_b16 a[156:157], v29 offset:27840
v_mfma_f32_16x16x32_bf16 a[124:127], a[164:167], v[180:183], a[124:127]
v_mfma_f32_16x16x32_bf16 a[124:127], a[168:171], v[184:187], a[124:127]
ds_read_b64_tr_b16 a[158:159], v29 offset:32448
v_mfma_f32_16x16x32_bf16 a[124:127], a[172:175], v[188:191], a[124:127]
s_waitcnt lgkmcnt(8)
s_add_u32 m0, m0, 1024
s_nop 0
buffer_load_dwordx4 v10, s[40:43], s21 offen lds
v_mfma_f32_16x16x32_bf16 a[20:23], a[176:179], v[128:131], a[20:23]
ds_read_b64_tr_b16 a[160:161], v29 offset:224
v_mfma_f32_16x16x32_bf16 a[20:23], a[180:183], v[132:135], a[20:23]
v_mfma_f32_16x16x32_bf16 a[20:23], a[184:187], v[136:139], a[20:23]
ds_read_b64_tr_b16 a[162:163], v29 offset:4832
v_mfma_f32_16x16x32_bf16 a[20:23], a[188:191], v[140:143], a[20:23]
buffer_load_dwordx4 v[104:107], v2, s[48:51], s18 offen offset:2048
v_mfma_f32_16x16x32_bf16 a[56:59], a[176:179], v[144:147], a[56:59]
ds_read_b64_tr_b16 a[164:165], v29 offset:9440
v_mfma_f32_16x16x32_bf16 a[56:59], a[180:183], v[148:151], a[56:59]
v_mfma_f32_16x16x32_bf16 a[56:59], a[184:187], v[152:155], a[56:59]
ds_read_b64_tr_b16 a[166:167], v29 offset:14048
v_mfma_f32_16x16x32_bf16 a[56:59], a[188:191], v[156:159], a[56:59]
v_mfma_f32_16x16x32_bf16 a[92:95], a[176:179], v[160:163], a[92:95]
ds_read_b64_tr_b16 a[168:169], v29 offset:18656
v_mfma_f32_16x16x32_bf16 a[92:95], a[180:183], v[164:167], a[92:95]
buffer_load_dwordx4 v[108:111], v2, s[48:51], s18 offen offset:3072
v_mfma_f32_16x16x32_bf16 a[92:95], a[184:187], v[168:171], a[92:95]
ds_read_b64_tr_b16 a[170:171], v29 offset:23264
v_mfma_f32_16x16x32_bf16 a[92:95], a[188:191], v[172:175], a[92:95]
v_mfma_f32_16x16x32_bf16 a[128:131], a[176:179], v[176:179], a[128:131]
ds_read_b64_tr_b16 a[172:173], v29 offset:27872
v_mfma_f32_16x16x32_bf16 a[128:131], a[180:183], v[180:183], a[128:131]
v_mfma_f32_16x16x32_bf16 a[128:131], a[184:187], v[184:187], a[128:131]
ds_read_b64_tr_b16 a[174:175], v29 offset:32480
v_mfma_f32_16x16x32_bf16 a[128:131], a[188:191], v[188:191], a[128:131]
s_waitcnt lgkmcnt(8)
s_add_u32 m0, m0, 1024
s_nop 0
buffer_load_dwordx4 v11, s[40:43], s21 offen lds
v_mfma_f32_16x16x32_bf16 a[24:27], a[144:147], v[128:131], a[24:27]
ds_read_b64_tr_b16 a[176:177], v29 offset:256
v_mfma_f32_16x16x32_bf16 a[24:27], a[148:151], v[132:135], a[24:27]
v_mfma_f32_16x16x32_bf16 a[24:27], a[152:155], v[136:139], a[24:27]
ds_read_b64_tr_b16 a[178:179], v29 offset:4864
v_mfma_f32_16x16x32_bf16 a[24:27], a[156:159], v[140:143], a[24:27]
v_mfma_f32_16x16x32_bf16 a[60:63], a[144:147], v[144:147], a[60:63]
ds_read_b64_tr_b16 a[180:181], v29 offset:9472
v_mfma_f32_16x16x32_bf16 a[60:63], a[148:151], v[148:151], a[60:63]
s_add_u32 s19, s35, 12288
buffer_load_dwordx4 v[112:115], v2, s[48:51], s19 offen
v_mfma_f32_16x16x32_bf16 a[60:63], a[152:155], v[152:155], a[60:63]
ds_read_b64_tr_b16 a[182:183], v29 offset:14080
v_mfma_f32_16x16x32_bf16 a[60:63], a[156:159], v[156:159], a[60:63]
v_mfma_f32_16x16x32_bf16 a[96:99], a[144:147], v[160:163], a[96:99]
ds_read_b64_tr_b16 a[184:185], v29 offset:18688
v_mfma_f32_16x16x32_bf16 a[96:99], a[148:151], v[164:167], a[96:99]
buffer_load_dwordx4 v[116:119], v2, s[48:51], s19 offen offset:1024
v_mfma_f32_16x16x32_bf16 a[96:99], a[152:155], v[168:171], a[96:99]
ds_read_b64_tr_b16 a[186:187], v29 offset:23296
v_mfma_f32_16x16x32_bf16 a[96:99], a[156:159], v[172:175], a[96:99]
v_mfma_f32_16x16x32_bf16 a[132:135], a[144:147], v[176:179], a[132:135]
ds_read_b64_tr_b16 a[188:189], v29 offset:27904
v_mfma_f32_16x16x32_bf16 a[132:135], a[148:151], v[180:183], a[132:135]
v_mfma_f32_16x16x32_bf16 a[132:135], a[152:155], v[184:187], a[132:135]
ds_read_b64_tr_b16 a[190:191], v29 offset:32512
v_mfma_f32_16x16x32_bf16 a[132:135], a[156:159], v[188:191], a[132:135]
s_waitcnt lgkmcnt(8)
s_add_u32 m0, m0, 1024
s_nop 0
buffer_load_dwordx4 v12, s[40:43], s21 offen lds
v_mfma_f32_16x16x32_bf16 a[28:31], a[160:163], v[128:131], a[28:31]
v_mfma_f32_16x16x32_bf16 a[28:31], a[164:167], v[132:135], a[28:31]
v_mfma_f32_16x16x32_bf16 a[28:31], a[168:171], v[136:139], a[28:31]
s_waitcnt vmcnt(46) lgkmcnt(0)
s_barrier
v_mfma_f32_16x16x32_bf16 a[28:31], a[172:175], v[140:143], a[28:31]
ds_read_b64_tr_b16 a[144:145], v30
v_mfma_f32_16x16x32_bf16 a[64:67], a[160:163], v[144:147], a[64:67]
ds_read_b64_tr_b16 a[146:147], v30 offset:4608
v_mfma_f32_16x16x32_bf16 a[64:67], a[164:167], v[148:151], a[64:67]
buffer_load_dwordx4 v[120:123], v2, s[48:51], s19 offen offset:2048
v_mfma_f32_16x16x32_bf16 a[64:67], a[168:171], v[152:155], a[64:67]
ds_read_b64_tr_b16 a[148:149], v30 offset:9216
v_mfma_f32_16x16x32_bf16 a[64:67], a[172:175], v[156:159], a[64:67]
ds_read_b64_tr_b16 a[150:151], v30 offset:13824
v_mfma_f32_16x16x32_bf16 a[100:103], a[160:163], v[160:163], a[100:103]
v_mfma_f32_16x16x32_bf16 a[100:103], a[164:167], v[164:167], a[100:103]
ds_read_b64_tr_b16 a[152:153], v30 offset:18432
v_mfma_f32_16x16x32_bf16 a[100:103], a[168:171], v[168:171], a[100:103]
buffer_load_dwordx4 v[124:127], v2, s[48:51], s19 offen offset:3072
v_mfma_f32_16x16x32_bf16 a[100:103], a[172:175], v[172:175], a[100:103]
ds_read_b64_tr_b16 a[154:155], v30 offset:23040
v_mfma_f32_16x16x32_bf16 a[136:139], a[160:163], v[176:179], a[136:139]
ds_read_b64_tr_b16 a[156:157], v30 offset:27648
v_mfma_f32_16x16x32_bf16 a[136:139], a[164:167], v[180:183], a[136:139]
v_mfma_f32_16x16x32_bf16 a[136:139], a[168:171], v[184:187], a[136:139]
ds_read_b64_tr_b16 a[158:159], v30 offset:32256
v_mfma_f32_16x16x32_bf16 a[136:139], a[172:175], v[188:191], a[136:139]
s_add_u32 m0, m0, 1024
s_nop 0
buffer_load_dwordx4 v13, s[40:43], s21 offen lds
v_mfma_f32_16x16x32_bf16 a[32:35], a[176:179], v[128:131], a[32:35]
ds_read_b64_tr_b16 a[160:161], v30 offset:32
v_mfma_f32_16x16x32_bf16 a[32:35], a[180:183], v[132:135], a[32:35]
ds_read_b64_tr_b16 a[162:163], v30 offset:4640
v_mfma_f32_16x16x32_bf16 a[32:35], a[184:187], v[136:139], a[32:35]
v_mfma_f32_16x16x32_bf16 a[32:35], a[188:191], v[140:143], a[32:35]
ds_read_b64_tr_b16 a[164:165], v30 offset:9248
v_mfma_f32_16x16x32_bf16 a[68:71], a[176:179], v[144:147], a[68:71]
ds_read_b64_tr_b16 a[166:167], v30 offset:13856
v_mfma_f32_16x16x32_bf16 a[68:71], a[180:183], v[148:151], a[68:71]
s_add_u32 m0, m0, 1024
s_nop 0
buffer_load_dwordx4 v14, s[40:43], s21 offen lds
v_mfma_f32_16x16x32_bf16 a[68:71], a[184:187], v[152:155], a[68:71]
ds_read_b64_tr_b16 a[168:169], v30 offset:18464
v_mfma_f32_16x16x32_bf16 a[68:71], a[188:191], v[156:159], a[68:71]
v_mfma_f32_16x16x32_bf16 a[104:107], a[176:179], v[160:163], a[104:107]
ds_read_b64_tr_b16 a[170:171], v30 offset:23072
v_mfma_f32_16x16x32_bf16 a[104:107], a[180:183], v[164:167], a[104:107]
ds_read_b64_tr_b16 a[172:173], v30 offset:27680
v_mfma_f32_16x16x32_bf16 a[104:107], a[184:187], v[168:171], a[104:107]
v_mfma_f32_16x16x32_bf16 a[104:107], a[188:191], v[172:175], a[104:107]
ds_read_b64_tr_b16 a[174:175], v30 offset:32288
v_mfma_f32_16x16x32_bf16 a[140:143], a[176:179], v[176:179], a[140:143]
v_mfma_f32_16x16x32_bf16 a[140:143], a[180:183], v[180:183], a[140:143]
v_mfma_f32_16x16x32_bf16 a[140:143], a[184:187], v[184:187], a[140:143]
v_mfma_f32_16x16x32_bf16 a[140:143], a[188:191], v[188:191], a[140:143]
s_waitcnt vmcnt(45) lgkmcnt(8)
v_mfma_f32_16x16x32_bf16 a[0:3], a[144:147], v[192:195], a[0:3]
ds_read_b64_tr_b16 a[176:177], v30 offset:64
v_mfma_f32_16x16x32_bf16 a[0:3], a[148:151], v[196:199], a[0:3]
buffer_load_dword v24, v23, s[72:75], 0 offen sc1
v_mfma_f32_16x16x32_bf16 a[0:3], a[152:155], v[200:203], a[0:3]
ds_read_b64_tr_b16 a[178:179], v30 offset:4672
v_mfma_f32_16x16x32_bf16 a[0:3], a[156:159], v[204:207], a[0:3]
s_waitcnt vmcnt(40)
v_mfma_f32_16x16x32_bf16 a[36:39], a[144:147], v[208:211], a[36:39]
ds_read_b64_tr_b16 a[180:181], v30 offset:9280
v_mfma_f32_16x16x32_bf16 a[36:39], a[148:151], v[212:215], a[36:39]
v_mfma_f32_16x16x32_bf16 a[36:39], a[152:155], v[216:219], a[36:39]
ds_read_b64_tr_b16 a[182:183], v30 offset:13888
v_mfma_f32_16x16x32_bf16 a[36:39], a[156:159], v[220:223], a[36:39]
s_waitcnt vmcnt(34)
s_add_u32 s16, s32, 16384
buffer_load_dwordx4 v[128:131], v2, s[48:51], s16 offen
v_mfma_f32_16x16x32_bf16 a[72:75], a[144:147], v[224:227], a[72:75]
ds_read_b64_tr_b16 a[184:185], v30 offset:18496
v_mfma_f32_16x16x32_bf16 a[72:75], a[148:151], v[228:231], a[72:75]
v_mfma_f32_16x16x32_bf16 a[72:75], a[152:155], v[232:235], a[72:75]
ds_read_b64_tr_b16 a[186:187], v30 offset:23104
v_mfma_f32_16x16x32_bf16 a[72:75], a[156:159], v[236:239], a[72:75]
s_waitcnt vmcnt(29)
buffer_load_dwordx4 v[132:135], v2, s[48:51], s16 offen offset:1024
v_mfma_f32_16x16x32_bf16 a[108:111], a[144:147], v[240:243], a[108:111]
ds_read_b64_tr_b16 a[188:189], v30 offset:27712
v_mfma_f32_16x16x32_bf16 a[108:111], a[148:151], v[244:247], a[108:111]
v_mfma_f32_16x16x32_bf16 a[108:111], a[152:155], v[248:251], a[108:111]
ds_read_b64_tr_b16 a[190:191], v30 offset:32320
v_mfma_f32_16x16x32_bf16 a[108:111], a[156:159], v[252:255], a[108:111]
s_waitcnt lgkmcnt(8)
v_mfma_f32_16x16x32_bf16 a[4:7], a[160:163], v[192:195], a[4:7]
ds_read_b64_tr_b16 a[144:145], v30 offset:96
v_mfma_f32_16x16x32_bf16 a[4:7], a[164:167], v[196:199], a[4:7]
s_add_u32 m0, s24, 36864
s_add_u32 s21, s26, 0
buffer_load_dwordx4 v6, s[44:47], s21 offen lds
v_mfma_f32_16x16x32_bf16 a[4:7], a[168:171], v[200:203], a[4:7]
ds_read_b64_tr_b16 a[146:147], v30 offset:4704
v_mfma_f32_16x16x32_bf16 a[4:7], a[172:175], v[204:207], a[4:7]
v_mfma_f32_16x16x32_bf16 a[40:43], a[160:163], v[208:211], a[40:43]
ds_read_b64_tr_b16 a[148:149], v30 offset:9312
v_mfma_f32_16x16x32_bf16 a[40:43], a[164:167], v[212:215], a[40:43]
v_mfma_f32_16x16x32_bf16 a[40:43], a[168:171], v[216:219], a[40:43]
ds_read_b64_tr_b16 a[150:151], v30 offset:13920
v_mfma_f32_16x16x32_bf16 a[40:43], a[172:175], v[220:223], a[40:43]
buffer_load_dwordx4 v[136:139], v2, s[48:51], s16 offen offset:2048
v_mfma_f32_16x16x32_bf16 a[76:79], a[160:163], v[224:227], a[76:79]
ds_read_b64_tr_b16 a[152:153], v30 offset:18528
v_mfma_f32_16x16x32_bf16 a[76:79], a[164:167], v[228:231], a[76:79]
v_mfma_f32_16x16x32_bf16 a[76:79], a[168:171], v[232:235], a[76:79]
ds_read_b64_tr_b16 a[154:155], v30 offset:23136
v_mfma_f32_16x16x32_bf16 a[76:79], a[172:175], v[236:239], a[76:79]
buffer_load_dwordx4 v[140:143], v2, s[48:51], s16 offen offset:3072
v_mfma_f32_16x16x32_bf16 a[112:115], a[160:163], v[240:243], a[112:115]
ds_read_b64_tr_b16 a[156:157], v30 offset:27744
v_mfma_f32_16x16x32_bf16 a[112:115], a[164:167], v[244:247], a[112:115]
v_mfma_f32_16x16x32_bf16 a[112:115], a[168:171], v[248:251], a[112:115]
ds_read_b64_tr_b16 a[158:159], v30 offset:32352
v_mfma_f32_16x16x32_bf16 a[112:115], a[172:175], v[252:255], a[112:115]
s_waitcnt lgkmcnt(8)
v_mfma_f32_16x16x32_bf16 a[8:11], a[176:179], v[192:195], a[8:11]
ds_read_b64_tr_b16 a[160:161], v30 offset:128
v_mfma_f32_16x16x32_bf16 a[8:11], a[180:183], v[196:199], a[8:11]
s_add_u32 m0, m0, 1024
s_nop 0
buffer_load_dwordx4 v7, s[44:47], s21 offen lds
v_mfma_f32_16x16x32_bf16 a[8:11], a[184:187], v[200:203], a[8:11]
ds_read_b64_tr_b16 a[162:163], v30 offset:4736
v_mfma_f32_16x16x32_bf16 a[8:11], a[188:191], v[204:207], a[8:11]
v_mfma_f32_16x16x32_bf16 a[44:47], a[176:179], v[208:211], a[44:47]
ds_read_b64_tr_b16 a[164:165], v30 offset:9344
v_mfma_f32_16x16x32_bf16 a[44:47], a[180:183], v[212:215], a[44:47]
v_mfma_f32_16x16x32_bf16 a[44:47], a[184:187], v[216:219], a[44:47]
ds_read_b64_tr_b16 a[166:167], v30 offset:13952
v_mfma_f32_16x16x32_bf16 a[44:47], a[188:191], v[220:223], a[44:47]
s_add_u32 s17, s33, 16384
buffer_load_dwordx4 v[144:147], v2, s[48:51], s17 offen
v_mfma_f32_16x16x32_bf16 a[80:83], a[176:179], v[224:227], a[80:83]
ds_read_b64_tr_b16 a[168:169], v30 offset:18560
v_mfma_f32_16x16x32_bf16 a[80:83], a[180:183], v[228:231], a[80:83]
v_mfma_f32_16x16x32_bf16 a[80:83], a[184:187], v[232:235], a[80:83]
ds_read_b64_tr_b16 a[170:171], v30 offset:23168
v_mfma_f32_16x16x32_bf16 a[80:83], a[188:191], v[236:239], a[80:83]
buffer_load_dwordx4 v[148:151], v2, s[48:51], s17 offen offset:1024
v_mfma_f32_16x16x32_bf16 a[116:119], a[176:179], v[240:243], a[116:119]
ds_read_b64_tr_b16 a[172:173], v30 offset:27776
v_mfma_f32_16x16x32_bf16 a[116:119], a[180:183], v[244:247], a[116:119]
v_mfma_f32_16x16x32_bf16 a[116:119], a[184:187], v[248:251], a[116:119]
ds_read_b64_tr_b16 a[174:175], v30 offset:32384
v_mfma_f32_16x16x32_bf16 a[116:119], a[188:191], v[252:255], a[116:119]
s_waitcnt lgkmcnt(8)
v_mfma_f32_16x16x32_bf16 a[12:15], a[144:147], v[192:195], a[12:15]
ds_read_b64_tr_b16 a[176:177], v30 offset:160
v_mfma_f32_16x16x32_bf16 a[12:15], a[148:151], v[196:199], a[12:15]
s_add_u32 m0, m0, 1024
s_nop 0
buffer_load_dwordx4 v8, s[44:47], s21 offen lds
v_mfma_f32_16x16x32_bf16 a[12:15], a[152:155], v[200:203], a[12:15]
ds_read_b64_tr_b16 a[178:179], v30 offset:4768
v_mfma_f32_16x16x32_bf16 a[12:15], a[156:159], v[204:207], a[12:15]
v_mfma_f32_16x16x32_bf16 a[48:51], a[144:147], v[208:211], a[48:51]
ds_read_b64_tr_b16 a[180:181], v30 offset:9376
v_mfma_f32_16x16x32_bf16 a[48:51], a[148:151], v[212:215], a[48:51]
v_mfma_f32_16x16x32_bf16 a[48:51], a[152:155], v[216:219], a[48:51]
ds_read_b64_tr_b16 a[182:183], v30 offset:13984
v_mfma_f32_16x16x32_bf16 a[48:51], a[156:159], v[220:223], a[48:51]
buffer_load_dwordx4 v[152:155], v2, s[48:51], s17 offen offset:2048
v_mfma_f32_16x16x32_bf16 a[84:87], a[144:147], v[224:227], a[84:87]
ds_read_b64_tr_b16 a[184:185], v30 offset:18592
v_mfma_f32_16x16x32_bf16 a[84:87], a[148:151], v[228:231], a[84:87]
v_mfma_f32_16x16x32_bf16 a[84:87], a[152:155], v[232:235], a[84:87]
ds_read_b64_tr_b16 a[186:187], v30 offset:23200
v_mfma_f32_16x16x32_bf16 a[84:87], a[156:159], v[236:239], a[84:87]
buffer_load_dwordx4 v[156:159], v2, s[48:51], s17 offen offset:3072
v_mfma_f32_16x16x32_bf16 a[120:123], a[144:147], v[240:243], a[120:123]
ds_read_b64_tr_b16 a[188:189], v30 offset:27808
v_mfma_f32_16x16x32_bf16 a[120:123], a[148:151], v[244:247], a[120:123]
v_mfma_f32_16x16x32_bf16 a[120:123], a[152:155], v[248:251], a[120:123]
ds_read_b64_tr_b16 a[190:191], v30 offset:32416
v_mfma_f32_16x16x32_bf16 a[120:123], a[156:159], v[252:255], a[120:123]
s_waitcnt lgkmcnt(8)
v_mfma_f32_16x16x32_bf16 a[16:19], a[160:163], v[192:195], a[16:19]
ds_read_b64_tr_b16 a[144:145], v30 offset:192
v_mfma_f32_16x16x32_bf16 a[16:19], a[164:167], v[196:199], a[16:19]
s_add_u32 m0, m0, 1024
s_nop 0
buffer_load_dwordx4 v9, s[44:47], s21 offen lds
v_mfma_f32_16x16x32_bf16 a[16:19], a[168:171], v[200:203], a[16:19]
ds_read_b64_tr_b16 a[146:147], v30 offset:4800
v_mfma_f32_16x16x32_bf16 a[16:19], a[172:175], v[204:207], a[16:19]
v_mfma_f32_16x16x32_bf16 a[52:55], a[160:163], v[208:211], a[52:55]
ds_read_b64_tr_b16 a[148:149], v30 offset:9408
v_mfma_f32_16x16x32_bf16 a[52:55], a[164:167], v[212:215], a[52:55]
v_mfma_f32_16x16x32_bf16 a[52:55], a[168:171], v[216:219], a[52:55]
ds_read_b64_tr_b16 a[150:151], v30 offset:14016
v_mfma_f32_16x16x32_bf16 a[52:55], a[172:175], v[220:223], a[52:55]
s_add_u32 s18, s34, 16384
buffer_load_dwordx4 v[160:163], v2, s[48:51], s18 offen
v_mfma_f32_16x16x32_bf16 a[88:91], a[160:163], v[224:227], a[88:91]
ds_read_b64_tr_b16 a[152:153], v30 offset:18624
v_mfma_f32_16x16x32_bf16 a[88:91], a[164:167], v[228:231], a[88:91]
v_mfma_f32_16x16x32_bf16 a[88:91], a[168:171], v[232:235], a[88:91]
ds_read_b64_tr_b16 a[154:155], v30 offset:23232
v_mfma_f32_16x16x32_bf16 a[88:91], a[172:175], v[236:239], a[88:91]
buffer_load_dwordx4 v[164:167], v2, s[48:51], s18 offen offset:1024
v_mfma_f32_16x16x32_bf16 a[124:127], a[160:163], v[240:243], a[124:127]
ds_read_b64_tr_b16 a[156:157], v30 offset:27840
v_mfma_f32_16x16x32_bf16 a[124:127], a[164:167], v[244:247], a[124:127]
v_mfma_f32_16x16x32_bf16 a[124:127], a[168:171], v[248:251], a[124:127]
ds_read_b64_tr_b16 a[158:159], v30 offset:32448
v_mfma_f32_16x16x32_bf16 a[124:127], a[172:175], v[252:255], a[124:127]
s_waitcnt lgkmcnt(8)
v_mfma_f32_16x16x32_bf16 a[20:23], a[176:179], v[192:195], a[20:23]
ds_read_b64_tr_b16 a[160:161], v30 offset:224
v_mfma_f32_16x16x32_bf16 a[20:23], a[180:183], v[196:199], a[20:23]
s_add_u32 m0, m0, 1024
s_nop 0
buffer_load_dwordx4 v10, s[44:47], s21 offen lds
v_mfma_f32_16x16x32_bf16 a[20:23], a[184:187], v[200:203], a[20:23]
ds_read_b64_tr_b16 a[162:163], v30 offset:4832
v_mfma_f32_16x16x32_bf16 a[20:23], a[188:191], v[204:207], a[20:23]
v_mfma_f32_16x16x32_bf16 a[56:59], a[176:179], v[208:211], a[56:59]
ds_read_b64_tr_b16 a[164:165], v30 offset:9440
v_mfma_f32_16x16x32_bf16 a[56:59], a[180:183], v[212:215], a[56:59]
buffer_load_dwordx4 v[168:171], v2, s[48:51], s18 offen offset:2048
v_mfma_f32_16x16x32_bf16 a[56:59], a[184:187], v[216:219], a[56:59]
ds_read_b64_tr_b16 a[166:167], v30 offset:14048
v_mfma_f32_16x16x32_bf16 a[56:59], a[188:191], v[220:223], a[56:59]
v_mfma_f32_16x16x32_bf16 a[92:95], a[176:179], v[224:227], a[92:95]
ds_read_b64_tr_b16 a[168:169], v30 offset:18656
v_mfma_f32_16x16x32_bf16 a[92:95], a[180:183], v[228:231], a[92:95]
v_mfma_f32_16x16x32_bf16 a[92:95], a[184:187], v[232:235], a[92:95]
ds_read_b64_tr_b16 a[170:171], v30 offset:23264
v_mfma_f32_16x16x32_bf16 a[92:95], a[188:191], v[236:239], a[92:95]
buffer_load_dwordx4 v[172:175], v2, s[48:51], s18 offen offset:3072
v_mfma_f32_16x16x32_bf16 a[128:131], a[176:179], v[240:243], a[128:131]
ds_read_b64_tr_b16 a[172:173], v30 offset:27872
v_mfma_f32_16x16x32_bf16 a[128:131], a[180:183], v[244:247], a[128:131]
v_mfma_f32_16x16x32_bf16 a[128:131], a[184:187], v[248:251], a[128:131]
ds_read_b64_tr_b16 a[174:175], v30 offset:32480
v_mfma_f32_16x16x32_bf16 a[128:131], a[188:191], v[252:255], a[128:131]
s_waitcnt lgkmcnt(8)
v_mfma_f32_16x16x32_bf16 a[24:27], a[144:147], v[192:195], a[24:27]
ds_read_b64_tr_b16 a[176:177], v30 offset:256
v_mfma_f32_16x16x32_bf16 a[24:27], a[148:151], v[196:199], a[24:27]
s_add_u32 m0, m0, 1024
s_nop 0
buffer_load_dwordx4 v11, s[44:47], s21 offen lds
v_mfma_f32_16x16x32_bf16 a[24:27], a[152:155], v[200:203], a[24:27]
ds_read_b64_tr_b16 a[178:179], v30 offset:4864
v_mfma_f32_16x16x32_bf16 a[24:27], a[156:159], v[204:207], a[24:27]
v_mfma_f32_16x16x32_bf16 a[60:63], a[144:147], v[208:211], a[60:63]
ds_read_b64_tr_b16 a[180:181], v30 offset:9472
v_mfma_f32_16x16x32_bf16 a[60:63], a[148:151], v[212:215], a[60:63]
s_add_u32 s19, s35, 16384
buffer_load_dwordx4 v[176:179], v2, s[48:51], s19 offen
v_mfma_f32_16x16x32_bf16 a[60:63], a[152:155], v[216:219], a[60:63]
ds_read_b64_tr_b16 a[182:183], v30 offset:14080
v_mfma_f32_16x16x32_bf16 a[60:63], a[156:159], v[220:223], a[60:63]
v_mfma_f32_16x16x32_bf16 a[96:99], a[144:147], v[224:227], a[96:99]
ds_read_b64_tr_b16 a[184:185], v30 offset:18688
v_mfma_f32_16x16x32_bf16 a[96:99], a[148:151], v[228:231], a[96:99]
v_mfma_f32_16x16x32_bf16 a[96:99], a[152:155], v[232:235], a[96:99]
ds_read_b64_tr_b16 a[186:187], v30 offset:23296
v_mfma_f32_16x16x32_bf16 a[96:99], a[156:159], v[236:239], a[96:99]
buffer_load_dwordx4 v[180:183], v2, s[48:51], s19 offen offset:1024
v_mfma_f32_16x16x32_bf16 a[132:135], a[144:147], v[240:243], a[132:135]
ds_read_b64_tr_b16 a[188:189], v30 offset:27904
v_mfma_f32_16x16x32_bf16 a[132:135], a[148:151], v[244:247], a[132:135]
v_mfma_f32_16x16x32_bf16 a[132:135], a[152:155], v[248:251], a[132:135]
ds_read_b64_tr_b16 a[190:191], v30 offset:32512
v_mfma_f32_16x16x32_bf16 a[132:135], a[156:159], v[252:255], a[132:135]
s_waitcnt lgkmcnt(8)
v_mfma_f32_16x16x32_bf16 a[28:31], a[160:163], v[192:195], a[28:31]
s_add_u32 m0, m0, 1024
s_nop 0
buffer_load_dwordx4 v12, s[44:47], s21 offen lds
v_mfma_f32_16x16x32_bf16 a[28:31], a[164:167], v[196:199], a[28:31]
v_mfma_f32_16x16x32_bf16 a[28:31], a[168:171], v[200:203], a[28:31]
s_waitcnt vmcnt(47) lgkmcnt(0)
s_barrier
v_mfma_f32_16x16x32_bf16 a[28:31], a[172:175], v[204:207], a[28:31]
ds_read_b64_tr_b16 a[144:145], v31
v_mfma_f32_16x16x32_bf16 a[64:67], a[160:163], v[208:211], a[64:67]
ds_read_b64_tr_b16 a[146:147], v31 offset:4608
v_mfma_f32_16x16x32_bf16 a[64:67], a[164:167], v[212:215], a[64:67]
buffer_load_dwordx4 v[184:187], v2, s[48:51], s19 offen offset:2048
v_mfma_f32_16x16x32_bf16 a[64:67], a[168:171], v[216:219], a[64:67]
ds_read_b64_tr_b16 a[148:149], v31 offset:9216
v_mfma_f32_16x16x32_bf16 a[64:67], a[172:175], v[220:223], a[64:67]
ds_read_b64_tr_b16 a[150:151], v31 offset:13824
v_mfma_f32_16x16x32_bf16 a[100:103], a[160:163], v[224:227], a[100:103]
v_mfma_f32_16x16x32_bf16 a[100:103], a[164:167], v[228:231], a[100:103]
ds_read_b64_tr_b16 a[152:153], v31 offset:18432
v_mfma_f32_16x16x32_bf16 a[100:103], a[168:171], v[232:235], a[100:103]
v_mfma_f32_16x16x32_bf16 a[100:103], a[172:175], v[236:239], a[100:103]
ds_read_b64_tr_b16 a[154:155], v31 offset:23040
v_mfma_f32_16x16x32_bf16 a[136:139], a[160:163], v[240:243], a[136:139]
ds_read_b64_tr_b16 a[156:157], v31 offset:27648
v_mfma_f32_16x16x32_bf16 a[136:139], a[164:167], v[244:247], a[136:139]
buffer_load_dwordx4 v[188:191], v2, s[48:51], s19 offen offset:3072
v_mfma_f32_16x16x32_bf16 a[136:139], a[168:171], v[248:251], a[136:139]
ds_read_b64_tr_b16 a[158:159], v31 offset:32256
v_mfma_f32_16x16x32_bf16 a[136:139], a[172:175], v[252:255], a[136:139]
v_mfma_f32_16x16x32_bf16 a[32:35], a[176:179], v[192:195], a[32:35]
ds_read_b64_tr_b16 a[160:161], v31 offset:32
v_mfma_f32_16x16x32_bf16 a[32:35], a[180:183], v[196:199], a[32:35]
ds_read_b64_tr_b16 a[162:163], v31 offset:4640
v_mfma_f32_16x16x32_bf16 a[32:35], a[184:187], v[200:203], a[32:35]
s_add_u32 m0, m0, 1024
s_nop 0
buffer_load_dwordx4 v13, s[44:47], s21 offen lds
v_mfma_f32_16x16x32_bf16 a[32:35], a[188:191], v[204:207], a[32:35]
ds_read_b64_tr_b16 a[164:165], v31 offset:9248
v_mfma_f32_16x16x32_bf16 a[68:71], a[176:179], v[208:211], a[68:71]
ds_read_b64_tr_b16 a[166:167], v31 offset:13856
v_mfma_f32_16x16x32_bf16 a[68:71], a[180:183], v[212:215], a[68:71]
s_add_u32 m0, m0, 1024
s_nop 0
buffer_load_dwordx4 v14, s[44:47], s21 offen lds
v_mfma_f32_16x16x32_bf16 a[68:71], a[184:187], v[216:219], a[68:71]
ds_read_b64_tr_b16 a[168:169], v31 offset:18464
v_mfma_f32_16x16x32_bf16 a[68:71], a[188:191], v[220:223], a[68:71]
v_mfma_f32_16x16x32_bf16 a[104:107], a[176:179], v[224:227], a[104:107]
ds_read_b64_tr_b16 a[170:171], v31 offset:23072
v_mfma_f32_16x16x32_bf16 a[104:107], a[180:183], v[228:231], a[104:107]
ds_read_b64_tr_b16 a[172:173], v31 offset:27680
v_mfma_f32_16x16x32_bf16 a[104:107], a[184:187], v[232:235], a[104:107]
v_mfma_f32_16x16x32_bf16 a[104:107], a[188:191], v[236:239], a[104:107]
ds_read_b64_tr_b16 a[174:175], v31 offset:32288
v_mfma_f32_16x16x32_bf16 a[140:143], a[176:179], v[240:243], a[140:143]
v_mfma_f32_16x16x32_bf16 a[140:143], a[180:183], v[244:247], a[140:143]
v_mfma_f32_16x16x32_bf16 a[140:143], a[184:187], v[248:251], a[140:143]
v_mfma_f32_16x16x32_bf16 a[140:143], a[188:191], v[252:255], a[140:143]
s_waitcnt vmcnt(46) lgkmcnt(8)
v_mfma_f32_16x16x32_bf16 a[0:3], a[144:147], v[64:67], a[0:3]
s_waitcnt vmcnt(25)
ds_read_b64_tr_b16 a[176:177], v31 offset:64
v_readfirstlane_b32 s76, v24
s_nop 3
s_cmp_ge_u32 s76, 8
s_cbranch_scc0 L_ap_spin5
L_ap_ret5:
v_mfma_f32_16x16x32_bf16 a[0:3], a[148:151], v[68:71], a[0:3]
s_add_u32 s16, s12, 0
buffer_load_dwordx4 v[192:195], v2, s[52:55], s16 offen sc1
v_mfma_f32_16x16x32_bf16 a[0:3], a[152:155], v[72:75], a[0:3]
ds_read_b64_tr_b16 a[178:179], v31 offset:4672
v_mfma_f32_16x16x32_bf16 a[0:3], a[156:159], v[76:79], a[0:3]
v_mfma_f32_16x16x32_bf16 a[36:39], a[144:147], v[80:83], a[36:39]
ds_read_b64_tr_b16 a[180:181], v31 offset:9280
v_mfma_f32_16x16x32_bf16 a[36:39], a[148:151], v[84:87], a[36:39]
v_mfma_f32_16x16x32_bf16 a[36:39], a[152:155], v[88:91], a[36:39]
ds_read_b64_tr_b16 a[182:183], v31 offset:13888
v_mfma_f32_16x16x32_bf16 a[36:39], a[156:159], v[92:95], a[36:39]
buffer_load_dwordx4 v[196:199], v2, s[52:55], s16 offen offset:1024 sc1
v_mfma_f32_16x16x32_bf16 a[72:75], a[144:147], v[96:99], a[72:75]
ds_read_b64_tr_b16 a[184:185], v31 offset:18496
v_mfma_f32_16x16x32_bf16 a[72:75], a[148:151], v[100:103], a[72:75]
v_mfma_f32_16x16x32_bf16 a[72:75], a[152:155], v[104:107], a[72:75]
ds_read_b64_tr_b16 a[186:187], v31 offset:23104
v_mfma_f32_16x16x32_bf16 a[72:75], a[156:159], v[108:111], a[72:75]
v_mfma_f32_16x16x32_bf16 a[108:111], a[144:147], v[112:115], a[108:111]
ds_read_b64_tr_b16 a[188:189], v31 offset:27712
v_mfma_f32_16x16x32_bf16 a[108:111], a[148:151], v[116:119], a[108:111]
s_add_u32 m0, s24, 73728
s_add_u32 s21, s26, 147456
buffer_load_dwordx4 v6, s[44:47], s21 offen lds
v_mfma_f32_16x16x32_bf16 a[108:111], a[152:155], v[120:123], a[108:111]
ds_read_b64_tr_b16 a[190:191], v31 offset:32320
v_mfma_f32_16x16x32_bf16 a[108:111], a[156:159], v[124:127], a[108:111]
s_waitcnt lgkmcnt(8)
v_mfma_f32_16x16x32_bf16 a[4:7], a[160:163], v[64:67], a[4:7]
ds_read_b64_tr_b16 a[144:145], v31 offset:96
v_mfma_f32_16x16x32_bf16 a[4:7], a[164:167], v[68:71], a[4:7]
buffer_load_dwordx4 v[200:203], v2, s[52:55], s16 offen offset:2048 sc1
v_mfma_f32_16x16x32_bf16 a[4:7], a[168:171], v[72:75], a[4:7]
ds_read_b64_tr_b16 a[146:147], v31 offset:4704
v_mfma_f32_16x16x32_bf16 a[4:7], a[172:175], v[76:79], a[4:7]
v_mfma_f32_16x16x32_bf16 a[40:43], a[160:163], v[80:83], a[40:43]
ds_read_b64_tr_b16 a[148:149], v31 offset:9312
v_mfma_f32_16x16x32_bf16 a[40:43], a[164:167], v[84:87], a[40:43]
v_mfma_f32_16x16x32_bf16 a[40:43], a[168:171], v[88:91], a[40:43]
ds_read_b64_tr_b16 a[150:151], v31 offset:13920
v_mfma_f32_16x16x32_bf16 a[40:43], a[172:175], v[92:95], a[40:43]
buffer_load_dwordx4 v[204:207], v2, s[52:55], s16 offen offset:3072 sc1
v_mfma_f32_16x16x32_bf16 a[76:79], a[160:163], v[96:99], a[76:79]
ds_read_b64_tr_b16 a[152:153], v31 offset:18528
v_mfma_f32_16x16x32_bf16 a[76:79], a[164:167], v[100:103], a[76:79]
v_mfma_f32_16x16x32_bf16 a[76:79], a[168:171], v[104:107], a[76:79]
ds_read_b64_tr_b16 a[154:155], v31 offset:23136
v_mfma_f32_16x16x32_bf16 a[76:79], a[172:175], v[108:111], a[76:79]
v_mfma_f32_16x16x32_bf16 a[112:115], a[160:163], v[112:115], a[112:115]
ds_read_b64_tr_b16 a[156:157], v31 offset:27744
v_mfma_f32_16x16x32_bf16 a[112:115], a[164:167], v[116:119], a[112:115]
s_add_u32 m0, m0, 1024
s_nop 0
buffer_load_dwordx4 v7, s[44:47], s21 offen lds
v_mfma_f32_16x16x32_bf16 a[112:115], a[168:171], v[120:123], a[112:115]
ds_read_b64_tr_b16 a[158:159], v31 offset:32352
v_mfma_f32_16x16x32_bf16 a[112:115], a[172:175], v[124:127], a[112:115]
s_waitcnt lgkmcnt(8)
v_mfma_f32_16x16x32_bf16 a[8:11], a[176:179], v[64:67], a[8:11]
ds_read_b64_tr_b16 a[160:161], v31 offset:128
v_mfma_f32_16x16x32_bf16 a[8:11], a[180:183], v[68:71], a[8:11]
v_mfma_f32_16x16x32_bf16 a[8:11], a[184:187], v[72:75], a[8:11]
ds_read_b64_tr_b16 a[162:163], v31 offset:4736
v_mfma_f32_16x16x32_bf16 a[8:11], a[188:191], v[76:79], a[8:11]
s_add_u32 s17, s13, 0
buffer_load_dwordx4 v[208:211], v2, s[52:55], s17 offen sc1
v_mfma_f32_16x16x32_bf16 a[44:47], a[176:179], v[80:83], a[44:47]
ds_read_b64_tr_b16 a[164:165], v31 offset:9344
v_mfma_f32_16x16x32_bf16 a[44:47], a[180:183], v[84:87], a[44:47]
v_mfma_f32_16x16x32_bf16 a[44:47], a[184:187], v[88:91], a[44:47]
ds_read_b64_tr_b16 a[166:167], v31 offset:13952
v_mfma_f32_16x16x32_bf16 a[44:47], a[188:191], v[92:95], a[44:47]
buffer_load_dwordx4 v[212:215], v2, s[52:55], s17 offen offset:1024 sc1
v_mfma_f32_16x16x32_bf16 a[80:83], a[176:179], v[96:99], a[80:83]
ds_read_b64_tr_b16 a[168:169], v31 offset:18560
v_mfma_f32_16x16x32_bf16 a[80:83], a[180:183], v[100:103], a[80:83]
v_mfma_f32_16x16x32_bf16 a[80:83], a[184:187], v[104:107], a[80:83]
ds_read_b64_tr_b16 a[170:171], v31 offset:23168
v_mfma_f32_16x16x32_bf16 a[80:83], a[188:191], v[108:111], a[80:83]
v_mfma_f32_16x16x32_bf16 a[116:119], a[176:179], v[112:115], a[116:119]
ds_read_b64_tr_b16 a[172:173], v31 offset:27776
v_mfma_f32_16x16x32_bf16 a[116:119], a[180:183], v[116:119], a[116:119]
s_add_u32 m0, m0, 1024
s_nop 0
buffer_load_dwordx4 v8, s[44:47], s21 offen lds
v_mfma_f32_16x16x32_bf16 a[116:119], a[184:187], v[120:123], a[116:119]
ds_read_b64_tr_b16 a[174:175], v31 offset:32384
v_mfma_f32_16x16x32_bf16 a[116:119], a[188:191], v[124:127], a[116:119]
s_waitcnt lgkmcnt(8)
v_mfma_f32_16x16x32_bf16 a[12:15], a[144:147], v[64:67], a[12:15]
ds_read_b64_tr_b16 a[176:177], v31 offset:160
v_mfma_f32_16x16x32_bf16 a[12:15], a[148:151], v[68:71], a[12:15]
v_mfma_f32_16x16x32_bf16 a[12:15], a[152:155], v[72:75], a[12:15]
ds_read_b64_tr_b16 a[178:179], v31 offset:4768
v_mfma_f32_16x16x32_bf16 a[12:15], a[156:159], v[76:79], a[12:15]
buffer_load_dwordx4 v[216:219], v2, s[52:55], s17 offen offset:2048 sc1
v_mfma_f32_16x16x32_bf16 a[48:51], a[144:147], v[80:83], a[48:51]
ds_read_b64_tr_b16 a[180:181], v31 offset:9376
v_mfma_f32_16x16x32_bf16 a[48:51], a[148:151], v[84:87], a[48:51]
v_mfma_f32_16x16x32_bf16 a[48:51], a[152:155], v[88:91], a[48:51]
ds_read_b64_tr_b16 a[182:183], v31 offset:13984
v_mfma_f32_16x16x32_bf16 a[48:51], a[156:159], v[92:95], a[48:51]
v_mfma_f32_16x16x32_bf16 a[84:87], a[144:147], v[96:99], a[84:87]
ds_read_b64_tr_b16 a[184:185], v31 offset:18592
v_mfma_f32_16x16x32_bf16 a[84:87], a[148:151], v[100:103], a[84:87]
buffer_load_dwordx4 v[220:223], v2, s[52:55], s17 offen offset:3072 sc1
v_mfma_f32_16x16x32_bf16 a[84:87], a[152:155], v[104:107], a[84:87]
ds_read_b64_tr_b16 a[186:187], v31 offset:23200
v_mfma_f32_16x16x32_bf16 a[84:87], a[156:159], v[108:111], a[84:87]
v_mfma_f32_16x16x32_bf16 a[120:123], a[144:147], v[112:115], a[120:123]
ds_read_b64_tr_b16 a[188:189], v31 offset:27808
v_mfma_f32_16x16x32_bf16 a[120:123], a[148:151], v[116:119], a[120:123]
s_add_u32 m0, m0, 1024
s_nop 0
buffer_load_dwordx4 v9, s[44:47], s21 offen lds
v_mfma_f32_16x16x32_bf16 a[120:123], a[152:155], v[120:123], a[120:123]
ds_read_b64_tr_b16 a[190:191], v31 offset:32416
v_mfma_f32_16x16x32_bf16 a[120:123], a[156:159], v[124:127], a[120:123]
s_waitcnt lgkmcnt(8)
v_mfma_f32_16x16x32_bf16 a[16:19], a[160:163], v[64:67], a[16:19]
ds_read_b64_tr_b16 a[144:145], v31 offset:192
v_mfma_f32_16x16x32_bf16 a[16:19], a[164:167], v[68:71], a[16:19]
v_mfma_f32_16x16x32_bf16 a[16:19], a[168:171], v[72:75], a[16:19]
ds_read_b64_tr_b16 a[146:147], v31 offset:4800
v_mfma_f32_16x16x32_bf16 a[16:19], a[172:175], v[76:79], a[16:19]
s_add_u32 s18, s14, 0
buffer_load_dwordx4 v[224:227], v2, s[52:55], s18 offen sc1
v_mfma_f32_16x16x32_bf16 a[52:55], a[160:163], v[80:83], a[52:55]
ds_read_b64_tr_b16 a[148:149], v31 offset:9408
v_mfma_f32_16x16x32_bf16 a[52:55], a[164:167], v[84:87], a[52:55]
v_mfma_f32_16x16x32_bf16 a[52:55], a[168:171], v[88:91], a[52:55]
ds_read_b64_tr_b16 a[150:151], v31 offset:14016
v_mfma_f32_16x16x32_bf16 a[52:55], a[172:175], v[92:95], a[52:55]
v_mfma_f32_16x16x32_bf16 a[88:91], a[160:163], v[96:99], a[88:91]
ds_read_b64_tr_b16 a[152:153], v31 offset:18624
v_mfma_f32_16x16x32_bf16 a[88:91], a[164:167], v[100:103], a[88:91]
buffer_load_dwordx4 v[228:231], v2, s[52:55], s18 offen offset:1024 sc1
v_mfma_f32_16x16x32_bf16 a[88:91], a[168:171], v[104:107], a[88:91]
ds_read_b64_tr_b16 a[154:155], v31 offset:23232
v_mfma_f32_16x16x32_bf16 a[88:91], a[172:175], v[108:111], a[88:91]
v_mfma_f32_16x16x32_bf16 a[124:127], a[160:163], v[112:115], a[124:127]
ds_read_b64_tr_b16 a[156:157], v31 offset:27840
v_mfma_f32_16x16x32_bf16 a[124:127], a[164:167], v[116:119], a[124:127]
v_mfma_f32_16x16x32_bf16 a[124:127], a[168:171], v[120:123], a[124:127]
ds_read_b64_tr_b16 a[158:159], v31 offset:32448
v_mfma_f32_16x16x32_bf16 a[124:127], a[172:175], v[124:127], a[124:127]
s_waitcnt lgkmcnt(8)
s_add_u32 m0, m0, 1024
s_nop 0
buffer_load_dwordx4 v10, s[44:47], s21 offen lds
v_mfma_f32_16x16x32_bf16 a[20:23], a[176:179], v[64:67], a[20:23]
ds_read_b64_tr_b16 a[160:161], v31 offset:224
v_mfma_f32_16x16x32_bf16 a[20:23], a[180:183], v[68:71], a[20:23]
v_mfma_f32_16x16x32_bf16 a[20:23], a[184:187], v[72:75], a[20:23]
ds_read_b64_tr_b16 a[162:163], v31 offset:4832
v_mfma_f32_16x16x32_bf16 a[20:23], a[188:191], v[76:79], a[20:23]
buffer_load_dwordx4 v[232:235], v2, s[52:55], s18 offen offset:2048 sc1
v_mfma_f32_16x16x32_bf16 a[56:59], a[176:179], v[80:83], a[56:59]
ds_read_b64_tr_b16 a[164:165], v31 offset:9440
v_mfma_f32_16x16x32_bf16 a[56:59], a[180:183], v[84:87], a[56:59]
v_mfma_f32_16x16x32_bf16 a[56:59], a[184:187], v[88:91], a[56:59]
ds_read_b64_tr_b16 a[166:167], v31 offset:14048
v_mfma_f32_16x16x32_bf16 a[56:59], a[188:191], v[92:95], a[56:59]
v_mfma_f32_16x16x32_bf16 a[92:95], a[176:179], v[96:99], a[92:95]
ds_read_b64_tr_b16 a[168:169], v31 offset:18656
v_mfma_f32_16x16x32_bf16 a[92:95], a[180:183], v[100:103], a[92:95]
buffer_load_dwordx4 v[236:239], v2, s[52:55], s18 offen offset:3072 sc1
v_mfma_f32_16x16x32_bf16 a[92:95], a[184:187], v[104:107], a[92:95]
ds_read_b64_tr_b16 a[170:171], v31 offset:23264
v_mfma_f32_16x16x32_bf16 a[92:95], a[188:191], v[108:111], a[92:95]
v_mfma_f32_16x16x32_bf16 a[128:131], a[176:179], v[112:115], a[128:131]
ds_read_b64_tr_b16 a[172:173], v31 offset:27872
v_mfma_f32_16x16x32_bf16 a[128:131], a[180:183], v[116:119], a[128:131]
v_mfma_f32_16x16x32_bf16 a[128:131], a[184:187], v[120:123], a[128:131]
ds_read_b64_tr_b16 a[174:175], v31 offset:32480
v_mfma_f32_16x16x32_bf16 a[128:131], a[188:191], v[124:127], a[128:131]
s_waitcnt lgkmcnt(8)
s_add_u32 m0, m0, 1024
s_nop 0
buffer_load_dwordx4 v11, s[44:47], s21 offen lds
v_mfma_f32_16x16x32_bf16 a[24:27], a[144:147], v[64:67], a[24:27]
ds_read_b64_tr_b16 a[176:177], v31 offset:256
v_mfma_f32_16x16x32_bf16 a[24:27], a[148:151], v[68:71], a[24:27]
v_mfma_f32_16x16x32_bf16 a[24:27], a[152:155], v[72:75], a[24:27]
ds_read_b64_tr_b16 a[178:179], v31 offset:4864
v_mfma_f32_16x16x32_bf16 a[24:27], a[156:159], v[76:79], a[24:27]
v_mfma_f32_16x16x32_bf16 a[60:63], a[144:147], v[80:83], a[60:63]
ds_read_b64_tr_b16 a[180:181], v31 offset:9472
v_mfma_f32_16x16x32_bf16 a[60:63], a[148:151], v[84:87], a[60:63]
s_add_u32 s19, s15, 0
buffer_load_dwordx4 v[240:243], v2, s[52:55], s19 offen sc1
v_mfma_f32_16x16x32_bf16 a[60:63], a[152:155], v[88:91], a[60:63]
ds_read_b64_tr_b16 a[182:183], v31 offset:14080
v_mfma_f32_16x16x32_bf16 a[60:63], a[156:159], v[92:95], a[60:63]
v_mfma_f32_16x16x32_bf16 a[96:99], a[144:147], v[96:99], a[96:99]
ds_read_b64_tr_b16 a[184:185], v31 offset:18688
v_mfma_f32_16x16x32_bf16 a[96:99], a[148:151], v[100:103], a[96:99]
buffer_load_dwordx4 v[244:247], v2, s[52:55], s19 offen offset:1024 sc1
v_mfma_f32_16x16x32_bf16 a[96:99], a[152:155], v[104:107], a[96:99]
ds_read_b64_tr_b16 a[186:187], v31 offset:23296
v_mfma_f32_16x16x32_bf16 a[96:99], a[156:159], v[108:111], a[96:99]
v_mfma_f32_16x16x32_bf16 a[132:135], a[144:147], v[112:115], a[132:135]
ds_read_b64_tr_b16 a[188:189], v31 offset:27904
v_mfma_f32_16x16x32_bf16 a[132:135], a[148:151], v[116:119], a[132:135]
v_mfma_f32_16x16x32_bf16 a[132:135], a[152:155], v[120:123], a[132:135]
ds_read_b64_tr_b16 a[190:191], v31 offset:32512
v_mfma_f32_16x16x32_bf16 a[132:135], a[156:159], v[124:127], a[132:135]
s_waitcnt lgkmcnt(8)
s_add_u32 m0, m0, 1024
s_nop 0
buffer_load_dwordx4 v12, s[44:47], s21 offen lds
v_mfma_f32_16x16x32_bf16 a[28:31], a[160:163], v[64:67], a[28:31]
v_mfma_f32_16x16x32_bf16 a[28:31], a[164:167], v[68:71], a[28:31]
v_mfma_f32_16x16x32_bf16 a[28:31], a[168:171], v[72:75], a[28:31]
s_waitcnt lgkmcnt(0)
s_barrier
v_mfma_f32_16x16x32_bf16 a[28:31], a[172:175], v[76:79], a[28:31]
ds_read_b64_tr_b16 a[144:145], v28
v_mfma_f32_16x16x32_bf16 a[64:67], a[160:163], v[80:83], a[64:67]
ds_read_b64_tr_b16 a[146:147], v28 offset:4608
v_mfma_f32_16x16x32_bf16 a[64:67], a[164:167], v[84:87], a[64:67]
buffer_load_dwordx4 v[248:251], v2, s[52:55], s19 offen offset:2048 sc1
v_mfma_f32_16x16x32_bf16 a[64:67], a[168:171], v[88:91], a[64:67]
ds_read_b64_tr_b16 a[148:149], v28 offset:9216
v_mfma_f32_16x16x32_bf16 a[64:67], a[172:175], v[92:95], a[64:67]
ds_read_b64_tr_b16 a[150:151], v28 offset:13824
v_mfma_f32_16x16x32_bf16 a[100:103], a[160:163], v[96:99], a[100:103]
v_mfma_f32_16x16x32_bf16 a[100:103], a[164:167], v[100:103], a[100:103]
ds_read_b64_tr_b16 a[152:153], v28 offset:18432
v_mfma_f32_16x16x32_bf16 a[100:103], a[168:171], v[104:107], a[100:103]
buffer_load_dwordx4 v[252:255], v2, s[52:55], s19 offen offset:3072 sc1
v_mfma_f32_16x16x32_bf16 a[100:103], a[172:175], v[108:111], a[100:103]
ds_read_b64_tr_b16 a[154:155], v28 offset:23040
v_mfma_f32_16x16x32_bf16 a[136:139], a[160:163], v[112:115], a[136:139]
ds_read_b64_tr_b16 a[156:157], v28 offset:27648
v_mfma_f32_16x16x32_bf16 a[136:139], a[164:167], v[116:119], a[136:139]
v_mfma_f32_16x16x32_bf16 a[136:139], a[168:171], v[120:123], a[136:139]
ds_read_b64_tr_b16 a[158:159], v28 offset:32256
v_mfma_f32_16x16x32_bf16 a[136:139], a[172:175], v[124:127], a[136:139]
s_add_u32 m0, m0, 1024
s_nop 0
buffer_load_dwordx4 v13, s[44:47], s21 offen lds
v_mfma_f32_16x16x32_bf16 a[32:35], a[176:179], v[64:67], a[32:35]
ds_read_b64_tr_b16 a[160:161], v28 offset:32
v_mfma_f32_16x16x32_bf16 a[32:35], a[180:183], v[68:71], a[32:35]
ds_read_b64_tr_b16 a[162:163], v28 offset:4640
v_mfma_f32_16x16x32_bf16 a[32:35], a[184:187], v[72:75], a[32:35]
v_mfma_f32_16x16x32_bf16 a[32:35], a[188:191], v[76:79], a[32:35]
ds_read_b64_tr_b16 a[164:165], v28 offset:9248
v_mfma_f32_16x16x32_bf16 a[68:71], a[176:179], v[80:83], a[68:71]
ds_read_b64_tr_b16 a[166:167], v28 offset:13856
v_mfma_f32_16x16x32_bf16 a[68:71], a[180:183], v[84:87], a[68:71]
s_add_u32 m0, m0, 1024
s_nop 0
buffer_load_dwordx4 v14, s[44:47], s21 offen lds
v_mfma_f32_16x16x32_bf16 a[68:71], a[184:187], v[88:91], a[68:71]
ds_read_b64_tr_b16 a[168:169], v28 offset:18464
v_mfma_f32_16x16x32_bf16 a[68:71], a[188:191], v[92:95], a[68:71]
v_mfma_f32_16x16x32_bf16 a[104:107], a[176:179], v[96:99], a[104:107]
ds_read_b64_tr_b16 a[170:171], v28 offset:23072
v_mfma_f32_16x16x32_bf16 a[104:107], a[180:183], v[100:103], a[104:107]
ds_read_b64_tr_b16 a[172:173], v28 offset:27680
v_mfma_f32_16x16x32_bf16 a[104:107], a[184:187], v[104:107], a[104:107]
v_mfma_f32_16x16x32_bf16 a[104:107], a[188:191], v[108:111], a[104:107]
ds_read_b64_tr_b16 a[174:175], v28 offset:32288
v_mfma_f32_16x16x32_bf16 a[140:143], a[176:179], v[112:115], a[140:143]
v_mfma_f32_16x16x32_bf16 a[140:143], a[180:183], v[116:119], a[140:143]
v_mfma_f32_16x16x32_bf16 a[140:143], a[184:187], v[120:123], a[140:143]
v_mfma_f32_16x16x32_bf16 a[140:143], a[188:191], v[124:127], a[140:143]
s_waitcnt vmcnt(45) lgkmcnt(8)
v_mfma_f32_16x16x32_bf16 a[0:3], a[144:147], v[128:131], a[0:3]
ds_read_b64_tr_b16 a[176:177], v28 offset:64
v_mfma_f32_16x16x32_bf16 a[0:3], a[148:151], v[132:135], a[0:3]
s_add_u32 s16, s12, 4096
buffer_load_dwordx4 v[64:67], v2, s[52:55], s16 offen sc1
v_mfma_f32_16x16x32_bf16 a[0:3], a[152:155], v[136:139], a[0:3]
ds_read_b64_tr_b16 a[178:179], v28 offset:4672
v_mfma_f32_16x16x32_bf16 a[0:3], a[156:159], v[140:143], a[0:3]
s_waitcnt vmcnt(40)
v_mfma_f32_16x16x32_bf16 a[36:39], a[144:147], v[144:147], a[36:39]
ds_read_b64_tr_b16 a[180:181], v28 offset:9280
v_mfma_f32_16x16x32_bf16 a[36:39], a[148:151], v[148:151], a[36:39]
v_mfma_f32_16x16x32_bf16 a[36:39], a[152:155], v[152:155], a[36:39]
ds_read_b64_tr_b16 a[182:183], v28 offset:13888
v_mfma_f32_16x16x32_bf16 a[36:39], a[156:159], v[156:159], a[36:39]
s_waitcnt vmcnt(34)
buffer_load_dwordx4 v[68:71], v2, s[52:55], s16 offen offset:1024 sc1
v_mfma_f32_16x16x32_bf16 a[72:75], a[144:147], v[160:163], a[72:75]
ds_read_b64_tr_b16 a[184:185], v28 offset:18496
v_mfma_f32_16x16x32_bf16 a[72:75], a[148:151], v[164:167], a[72:75]
v_mfma_f32_16x16x32_bf16 a[72:75], a[152:155], v[168:171], a[72:75]
ds_read_b64_tr_b16 a[186:187], v28 offset:23104
v_mfma_f32_16x16x32_bf16 a[72:75], a[156:159], v[172:175], a[72:75]
s_waitcnt vmcnt(29)
v_mfma_f32_16x16x32_bf16 a[108:111], a[144:147], v[176:179], a[108:111]
ds_read_b64_tr_b16 a[188:189], v28 offset:27712
v_mfma_f32_16x16x32_bf16 a[108:111], a[148:151], v[180:183], a[108:111]
s_add_u32 m0, s24, 110592
s_add_u32 s21, s26, 294912
buffer_load_dwordx4 v6, s[44:47], s21 offen lds
v_mfma_f32_16x16x32_bf16 a[108:111], a[152:155], v[184:187], a[108:111]
ds_read_b64_tr_b16 a[190:191], v28 offset:32320
v_mfma_f32_16x16x32_bf16 a[108:111], a[156:159], v[188:191], a[108:111]
s_waitcnt lgkmcnt(8)
v_mfma_f32_16x16x32_bf16 a[4:7], a[160:163], v[128:131], a[4:7]
ds_read_b64_tr_b16 a[144:145], v28 offset:96
v_mfma_f32_16x16x32_bf16 a[4:7], a[164:167], v[132:135], a[4:7]
buffer_load_dwordx4 v[72:75], v2, s[52:55], s16 offen offset:2048 sc1
v_mfma_f32_16x16x32_bf16 a[4:7], a[168:171], v[136:139], a[4:7]
ds_read_b64_tr_b16 a[146:147], v28 offset:4704
v_mfma_f32_16x16x32_bf16 a[4:7], a[172:175], v[140:143], a[4:7]
v_mfma_f32_16x16x32_bf16 a[40:43], a[160:163], v[144:147], a[40:43]
ds_read_b64_tr_b16 a[148:149], v28 offset:9312
v_mfma_f32_16x16x32_bf16 a[40:43], a[164:167], v[148:151], a[40:43]
v_mfma_f32_16x16x32_bf16 a[40:43], a[168:171], v[152:155], a[40:43]
ds_read_b64_tr_b16 a[150:151], v28 offset:13920
v_mfma_f32_16x16x32_bf16 a[40:43], a[172:175], v[156:159], a[40:43]
buffer_load_dwordx4 v[76:79], v2, s[52:55], s16 offen offset:3072 sc1
v_mfma_f32_16x16x32_bf16 a[76:79], a[160:163], v[160:163], a[76:79]
ds_read_b64_tr_b16 a[152:153], v28 offset:18528
v_mfma_f32_16x16x32_bf16 a[76:79], a[164:167], v[164:167], a[76:79]
v_mfma_f32_16x16x32_bf16 a[76:79], a[168:171], v[168:171], a[76:79]
ds_read_b64_tr_b16 a[154:155], v28 offset:23136
v_mfma_f32_16x16x32_bf16 a[76:79], a[172:175], v[172:175], a[76:79]
v_mfma_f32_16x16x32_bf16 a[112:115], a[160:163], v[176:179], a[112:115]
ds_read_b64_tr_b16 a[156:157], v28 offset:27744
v_mfma_f32_16x16x32_bf16 a[112:115], a[164:167], v[180:183], a[112:115]
s_add_u32 m0, m0, 1024
s_nop 0
buffer_load_dwordx4 v7, s[44:47], s21 offen lds
v_mfma_f32_16x16x32_bf16 a[112:115], a[168:171], v[184:187], a[112:115]
ds_read_b64_tr_b16 a[158:159], v28 offset:32352
v_mfma_f32_16x16x32_bf16 a[112:115], a[172:175], v[188:191], a[112:115]
s_waitcnt lgkmcnt(8)
v_mfma_f32_16x16x32_bf16 a[8:11], a[176:179], v[128:131], a[8:11]
ds_read_b64_tr_b16 a[160:161], v28 offset:128
v_mfma_f32_16x16x32_bf16 a[8:11], a[180:183], v[132:135], a[8:11]
v_mfma_f32_16x16x32_bf16 a[8:11], a[184:187], v[136:139], a[8:11]
ds_read_b64_tr_b16 a[162:163], v28 offset:4736
v_mfma_f32_16x16x32_bf16 a[8:11], a[188:191], v[140:143], a[8:11]
s_add_u32 s17, s13, 4096
buffer_load_dwordx4 v[80:83], v2, s[52:55], s17 offen sc1
v_mfma_f32_16x16x32_bf16 a[44:47], a[176:179], v[144:147], a[44:47]
ds_read_b64_tr_b16 a[164:165], v28 offset:9344
v_mfma_f32_16x16x32_bf16 a[44:47], a[180:183], v[148:151], a[44:47]
v_mfma_f32_16x16x32_bf16 a[44:47], a[184:187], v[152:155], a[44:47]
ds_read_b64_tr_b16 a[166:167], v28 offset:13952
v_mfma_f32_16x16x32_bf16 a[44:47], a[188:191], v[156:159], a[44:47]
buffer_load_dwordx4 v[84:87], v2, s[52:55], s17 offen offset:1024 sc1
v_mfma_f32_16x16x32_bf16 a[80:83], a[176:179], v[160:163], a[80:83]
ds_read_b64_tr_b16 a[168:169], v28 offset:18560
v_mfma_f32_16x16x32_bf16 a[80:83], a[180:183], v[164:167], a[80:83]
v_mfma_f32_16x16x32_bf16 a[80:83], a[184:187], v[168:171], a[80:83]
ds_read_b64_tr_b16 a[170:171], v28 offset:23168
v_mfma_f32_16x16x32_bf16 a[80:83], a[188:191], v[172:175], a[80:83]
v_mfma_f32_16x16x32_bf16 a[116:119], a[176:179], v[176:179], a[116:119]
ds_read_b64_tr_b16 a[172:173], v28 offset:27776
v_mfma_f32_16x16x32_bf16 a[116:119], a[180:183], v[180:183], a[116:119]
s_add_u32 m0, m0, 1024
s_nop 0
buffer_load_dwordx4 v8, s[44:47], s21 offen lds
v_mfma_f32_16x16x32_bf16 a[116:119], a[184:187], v[184:187], a[116:119]
ds_read_b64_tr_b16 a[174:175], v28 offset:32384
v_mfma_f32_16x16x32_bf16 a[116:119], a[188:191], v[188:191], a[116:119]
s_waitcnt lgkmcnt(8)
v_mfma_f32_16x16x32_bf16 a[12:15], a[144:147], v[128:131], a[12:15]
ds_read_b64_tr_b16 a[176:177], v28 offset:160
v_mfma_f32_16x16x32_bf16 a[12:15], a[148:151], v[132:135], a[12:15]
v_mfma_f32_16x16x32_bf16 a[12:15], a[152:155], v[136:139], a[12:15]
ds_read_b64_tr_b16 a[178:179], v28 offset:4768
v_mfma_f32_16x16x32_bf16 a[12:15], a[156:159], v[140:143], a[12:15]
buffer_load_dwordx4 v[88:91], v2, s[52:55], s17 offen offset:2048 sc1
v_mfma_f32_16x16x32_bf16 a[48:51], a[144:147], v[144:147], a[48:51]
ds_read_b64_tr_b16 a[180:181], v28 offset:9376
v_mfma_f32_16x16x32_bf16 a[48:51], a[148:151], v[148:151], a[48:51]
v_mfma_f32_16x16x32_bf16 a[48:51], a[152:155], v[152:155], a[48:51]
ds_read_b64_tr_b16 a[182:183], v28 offset:13984
v_mfma_f32_16x16x32_bf16 a[48:51], a[156:159], v[156:159], a[48:51]
v_mfma_f32_16x16x32_bf16 a[84:87], a[144:147], v[160:163], a[84:87]
ds_read_b64_tr_b16 a[184:185], v28 offset:18592
v_mfma_f32_16x16x32_bf16 a[84:87], a[148:151], v[164:167], a[84:87]
buffer_load_dwordx4 v[92:95], v2, s[52:55], s17 offen offset:3072 sc1
v_mfma_f32_16x16x32_bf16 a[84:87], a[152:155], v[168:171], a[84:87]
ds_read_b64_tr_b16 a[186:187], v28 offset:23200
v_mfma_f32_16x16x32_bf16 a[84:87], a[156:159], v[172:175], a[84:87]
v_mfma_f32_16x16x32_bf16 a[120:123], a[144:147], v[176:179], a[120:123]
ds_read_b64_tr_b16 a[188:189], v28 offset:27808
v_mfma_f32_16x16x32_bf16 a[120:123], a[148:151], v[180:183], a[120:123]
s_add_u32 m0, m0, 1024
s_nop 0
buffer_load_dwordx4 v9, s[44:47], s21 offen lds
v_mfma_f32_16x16x32_bf16 a[120:123], a[152:155], v[184:187], a[120:123]
ds_read_b64_tr_b16 a[190:191], v28 offset:32416
v_mfma_f32_16x16x32_bf16 a[120:123], a[156:159], v[188:191], a[120:123]
s_waitcnt lgkmcnt(8)
v_mfma_f32_16x16x32_bf16 a[16:19], a[160:163], v[128:131], a[16:19]
ds_read_b64_tr_b16 a[144:145], v28 offset:192
v_mfma_f32_16x16x32_bf16 a[16:19], a[164:167], v[132:135], a[16:19]
v_mfma_f32_16x16x32_bf16 a[16:19], a[168:171], v[136:139], a[16:19]
ds_read_b64_tr_b16 a[146:147], v28 offset:4800
v_mfma_f32_16x16x32_bf16 a[16:19], a[172:175], v[140:143], a[16:19]
s_add_u32 s18, s14, 4096
buffer_load_dwordx4 v[96:99], v2, s[52:55], s18 offen sc1
v_mfma_f32_16x16x32_bf16 a[52:55], a[160:163], v[144:147], a[52:55]
ds_read_b64_tr_b16 a[148:149], v28 offset:9408
v_mfma_f32_16x16x32_bf16 a[52:55], a[164:167], v[148:151], a[52:55]
v_mfma_f32_16x16x32_bf16 a[52:55], a[168:171], v[152:155], a[52:55]
ds_read_b64_tr_b16 a[150:151], v28 offset:14016
v_mfma_f32_16x16x32_bf16 a[52:55], a[172:175], v[156:159], a[52:55]
v_mfma_f32_16x16x32_bf16 a[88:91], a[160:163], v[160:163], a[88:91]
ds_read_b64_tr_b16 a[152:153], v28 offset:18624
v_mfma_f32_16x16x32_bf16 a[88:91], a[164:167], v[164:167], a[88:91]
buffer_load_dwordx4 v[100:103], v2, s[52:55], s18 offen offset:1024 sc1
v_mfma_f32_16x16x32_bf16 a[88:91], a[168:171], v[168:171], a[88:91]
ds_read_b64_tr_b16 a[154:155], v28 offset:23232
v_mfma_f32_16x16x32_bf16 a[88:91], a[172:175], v[172:175], a[88:91]
v_mfma_f32_16x16x32_bf16 a[124:127], a[160:163], v[176:179], a[124:127]
ds_read_b64_tr_b16 a[156:157], v28 offset:27840
v_mfma_f32_16x16x32_bf16 a[124:127], a[164:167], v[180:183], a[124:127]
v_mfma_f32_16x16x32_bf16 a[124:127], a[168:171], v[184:187], a[124:127]
ds_read_b64_tr_b16 a[158:159], v28 offset:32448
v_mfma_f32_16x16x32_bf16 a[124:127], a[172:175], v[188:191], a[124:127]
s_waitcnt lgkmcnt(8)
s_add_u32 m0, m0, 1024
s_nop 0
buffer_load_dwordx4 v10, s[44:47], s21 offen lds
v_mfma_f32_16x16x32_bf16 a[20:23], a[176:179], v[128:131], a[20:23]
ds_read_b64_tr_b16 a[160:161], v28 offset:224
v_mfma_f32_16x16x32_bf16 a[20:23], a[180:183], v[132:135], a[20:23]
v_mfma_f32_16x16x32_bf16 a[20:23], a[184:187], v[136:139], a[20:23]
ds_read_b64_tr_b16 a[162:163], v28 offset:4832
v_mfma_f32_16x16x32_bf16 a[20:23], a[188:191], v[140:143], a[20:23]
buffer_load_dwordx4 v[104:107], v2, s[52:55], s18 offen offset:2048 sc1
v_mfma_f32_16x16x32_bf16 a[56:59], a[176:179], v[144:147], a[56:59]
ds_read_b64_tr_b16 a[164:165], v28 offset:9440
v_mfma_f32_16x16x32_bf16 a[56:59], a[180:183], v[148:151], a[56:59]
v_mfma_f32_16x16x32_bf16 a[56:59], a[184:187], v[152:155], a[56:59]
ds_read_b64_tr_b16 a[166:167], v28 offset:14048
v_mfma_f32_16x16x32_bf16 a[56:59], a[188:191], v[156:159], a[56:59]
v_mfma_f32_16x16x32_bf16 a[92:95], a[176:179], v[160:163], a[92:95]
ds_read_b64_tr_b16 a[168:169], v28 offset:18656
v_mfma_f32_16x16x32_bf16 a[92:95], a[180:183], v[164:167], a[92:95]
buffer_load_dwordx4 v[108:111], v2, s[52:55], s18 offen offset:3072 sc1
v_mfma_f32_16x16x32_bf16 a[92:95], a[184:187], v[168:171], a[92:95]
ds_read_b64_tr_b16 a[170:171], v28 offset:23264
v_mfma_f32_16x16x32_bf16 a[92:95], a[188:191], v[172:175], a[92:95]
v_mfma_f32_16x16x32_bf16 a[128:131], a[176:179], v[176:179], a[128:131]
ds_read_b64_tr_b16 a[172:173], v28 offset:27872
v_mfma_f32_16x16x32_bf16 a[128:131], a[180:183], v[180:183], a[128:131]
v_mfma_f32_16x16x32_bf16 a[128:131], a[184:187], v[184:187], a[128:131]
ds_read_b64_tr_b16 a[174:175], v28 offset:32480
v_mfma_f32_16x16x32_bf16 a[128:131], a[188:191], v[188:191], a[128:131]
s_waitcnt lgkmcnt(8)
s_add_u32 m0, m0, 1024
s_nop 0
buffer_load_dwordx4 v11, s[44:47], s21 offen lds
v_mfma_f32_16x16x32_bf16 a[24:27], a[144:147], v[128:131], a[24:27]
ds_read_b64_tr_b16 a[176:177], v28 offset:256
v_mfma_f32_16x16x32_bf16 a[24:27], a[148:151], v[132:135], a[24:27]
v_mfma_f32_16x16x32_bf16 a[24:27], a[152:155], v[136:139], a[24:27]
ds_read_b64_tr_b16 a[178:179], v28 offset:4864
v_mfma_f32_16x16x32_bf16 a[24:27], a[156:159], v[140:143], a[24:27]
v_mfma_f32_16x16x32_bf16 a[60:63], a[144:147], v[144:147], a[60:63]
ds_read_b64_tr_b16 a[180:181], v28 offset:9472
v_mfma_f32_16x16x32_bf16 a[60:63], a[148:151], v[148:151], a[60:63]
s_add_u32 s19, s15, 4096
buffer_load_dwordx4 v[112:115], v2, s[52:55], s19 offen sc1
v_mfma_f32_16x16x32_bf16 a[60:63], a[152:155], v[152:155], a[60:63]
ds_read_b64_tr_b16 a[182:183], v28 offset:14080
v_mfma_f32_16x16x32_bf16 a[60:63], a[156:159], v[156:159], a[60:63]
v_mfma_f32_16x16x32_bf16 a[96:99], a[144:147], v[160:163], a[96:99]
ds_read_b64_tr_b16 a[184:185], v28 offset:18688
v_mfma_f32_16x16x32_bf16 a[96:99], a[148:151], v[164:167], a[96:99]
buffer_load_dwordx4 v[116:119], v2, s[52:55], s19 offen offset:1024 sc1
v_mfma_f32_16x16x32_bf16 a[96:99], a[152:155], v[168:171], a[96:99]
ds_read_b64_tr_b16 a[186:187], v28 offset:23296
v_mfma_f32_16x16x32_bf16 a[96:99], a[156:159], v[172:175], a[96:99]
v_mfma_f32_16x16x32_bf16 a[132:135], a[144:147], v[176:179], a[132:135]
ds_read_b64_tr_b16 a[188:189], v28 offset:27904
v_mfma_f32_16x16x32_bf16 a[132:135], a[148:151], v[180:183], a[132:135]
v_mfma_f32_16x16x32_bf16 a[132:135], a[152:155], v[184:187], a[132:135]
ds_read_b64_tr_b16 a[190:191], v28 offset:32512
v_mfma_f32_16x16x32_bf16 a[132:135], a[156:159], v[188:191], a[132:135]
s_waitcnt lgkmcnt(8)
s_add_u32 m0, m0, 1024
s_nop 0
buffer_load_dwordx4 v12, s[44:47], s21 offen lds
v_mfma_f32_16x16x32_bf16 a[28:31], a[160:163], v[128:131], a[28:31]
v_mfma_f32_16x16x32_bf16 a[28:31], a[164:167], v[132:135], a[28:31]
v_mfma_f32_16x16x32_bf16 a[28:31], a[168:171], v[136:139], a[28:31]
s_waitcnt vmcnt(46) lgkmcnt(0)
s_barrier
v_mfma_f32_16x16x32_bf16 a[28:31], a[172:175], v[140:143], a[28:31]
ds_read_b64_tr_b16 a[144:145], v29
v_mfma_f32_16x16x32_bf16 a[64:67], a[160:163], v[144:147], a[64:67]
ds_read_b64_tr_b16 a[146:147], v29 offset:4608
v_mfma_f32_16x16x32_bf16 a[64:67], a[164:167], v[148:151], a[64:67]
buffer_load_dwordx4 v[120:123], v2, s[52:55], s19 offen offset:2048 sc1
v_mfma_f32_16x16x32_bf16 a[64:67], a[168:171], v[152:155], a[64:67]
ds_read_b64_tr_b16 a[148:149], v29 offset:9216
v_mfma_f32_16x16x32_bf16 a[64:67], a[172:175], v[156:159], a[64:67]
ds_read_b64_tr_b16 a[150:151], v29 offset:13824
v_mfma_f32_16x16x32_bf16 a[100:103], a[160:163], v[160:163], a[100:103]
v_mfma_f32_16x16x32_bf16 a[100:103], a[164:167], v[164:167], a[100:103]
ds_read_b64_tr_b16 a[152:153], v29 offset:18432
v_mfma_f32_16x16x32_bf16 a[100:103], a[168:171], v[168:171], a[100:103]
buffer_load_dwordx4 v[124:127], v2, s[52:55], s19 offen offset:3072 sc1
v_mfma_f32_16x16x32_bf16 a[100:103], a[172:175], v[172:175], a[100:103]
ds_read_b64_tr_b16 a[154:155], v29 offset:23040
v_mfma_f32_16x16x32_bf16 a[136:139], a[160:163], v[176:179], a[136:139]
ds_read_b64_tr_b16 a[156:157], v29 offset:27648
v_mfma_f32_16x16x32_bf16 a[136:139], a[164:167], v[180:183], a[136:139]
v_mfma_f32_16x16x32_bf16 a[136:139], a[168:171], v[184:187], a[136:139]
ds_read_b64_tr_b16 a[158:159], v29 offset:32256
v_mfma_f32_16x16x32_bf16 a[136:139], a[172:175], v[188:191], a[136:139]
s_add_u32 m0, m0, 1024
s_nop 0
buffer_load_dwordx4 v13, s[44:47], s21 offen lds
v_mfma_f32_16x16x32_bf16 a[32:35], a[176:179], v[128:131], a[32:35]
ds_read_b64_tr_b16 a[160:161], v29 offset:32
v_mfma_f32_16x16x32_bf16 a[32:35], a[180:183], v[132:135], a[32:35]
ds_read_b64_tr_b16 a[162:163], v29 offset:4640
v_mfma_f32_16x16x32_bf16 a[32:35], a[184:187], v[136:139], a[32:35]
v_mfma_f32_16x16x32_bf16 a[32:35], a[188:191], v[140:143], a[32:35]
ds_read_b64_tr_b16 a[164:165], v29 offset:9248
v_mfma_f32_16x16x32_bf16 a[68:71], a[176:179], v[144:147], a[68:71]
ds_read_b64_tr_b16 a[166:167], v29 offset:13856
v_mfma_f32_16x16x32_bf16 a[68:71], a[180:183], v[148:151], a[68:71]
s_add_u32 m0, m0, 1024
s_nop 0
buffer_load_dwordx4 v14, s[44:47], s21 offen lds
v_mfma_f32_16x16x32_bf16 a[68:71], a[184:187], v[152:155], a[68:71]
ds_read_b64_tr_b16 a[168:169], v29 offset:18464
v_mfma_f32_16x16x32_bf16 a[68:71], a[188:191], v[156:159], a[68:71]
v_mfma_f32_16x16x32_bf16 a[104:107], a[176:179], v[160:163], a[104:107]
ds_read_b64_tr_b16 a[170:171], v29 offset:23072
v_mfma_f32_16x16x32_bf16 a[104:107], a[180:183], v[164:167], a[104:107]
ds_read_b64_tr_b16 a[172:173], v29 offset:27680
v_mfma_f32_16x16x32_bf16 a[104:107], a[184:187], v[168:171], a[104:107]
v_mfma_f32_16x16x32_bf16 a[104:107], a[188:191], v[172:175], a[104:107]
ds_read_b64_tr_b16 a[174:175], v29 offset:32288
v_mfma_f32_16x16x32_bf16 a[140:143], a[176:179], v[176:179], a[140:143]
v_mfma_f32_16x16x32_bf16 a[140:143], a[180:183], v[180:183], a[140:143]
v_mfma_f32_16x16x32_bf16 a[140:143], a[184:187], v[184:187], a[140:143]
v_mfma_f32_16x16x32_bf16 a[140:143], a[188:191], v[188:191], a[140:143]
s_waitcnt vmcnt(45) lgkmcnt(8)
v_mfma_f32_16x16x32_bf16 a[0:3], a[144:147], v[192:195], a[0:3]
ds_read_b64_tr_b16 a[176:177], v29 offset:64
v_mfma_f32_16x16x32_bf16 a[0:3], a[148:151], v[196:199], a[0:3]
s_add_u32 s16, s12, 8192
buffer_load_dwordx4 v[128:131], v2, s[52:55], s16 offen sc1
v_mfma_f32_16x16x32_bf16 a[0:3], a[152:155], v[200:203], a[0:3]
ds_read_b64_tr_b16 a[178:179], v29 offset:4672
v_mfma_f32_16x16x32_bf16 a[0:3], a[156:159], v[204:207], a[0:3]
s_waitcnt vmcnt(40)
v_mfma_f32_16x16x32_bf16 a[36:39], a[144:147], v[208:211], a[36:39]
ds_read_b64_tr_b16 a[180:181], v29 offset:9280
v_mfma_f32_16x16x32_bf16 a[36:39], a[148:151], v[212:215], a[36:39]
v_mfma_f32_16x16x32_bf16 a[36:39], a[152:155], v[216:219], a[36:39]
ds_read_b64_tr_b16 a[182:183], v29 offset:13888
v_mfma_f32_16x16x32_bf16 a[36:39], a[156:159], v[220:223], a[36:39]
s_waitcnt vmcnt(34)
buffer_load_dwordx4 v[132:135], v2, s[52:55], s16 offen offset:1024 sc1
v_mfma_f32_16x16x32_bf16 a[72:75], a[144:147], v[224:227], a[72:75]
ds_read_b64_tr_b16 a[184:185], v29 offset:18496
v_mfma_f32_16x16x32_bf16 a[72:75], a[148:151], v[228:231], a[72:75]
v_mfma_f32_16x16x32_bf16 a[72:75], a[152:155], v[232:235], a[72:75]
ds_read_b64_tr_b16 a[186:187], v29 offset:23104
v_mfma_f32_16x16x32_bf16 a[72:75], a[156:159], v[236:239], a[72:75]
s_waitcnt vmcnt(29)
v_mfma_f32_16x16x32_bf16 a[108:111], a[144:147], v[240:243], a[108:111]
ds_read_b64_tr_b16 a[188:189], v29 offset:27712
v_mfma_f32_16x16x32_bf16 a[108:111], a[148:151], v[244:247], a[108:111]
s_add_u32 m0, s24, 0
s_add_u32 s21, s26, 442368
buffer_load_dwordx4 v6, s[44:47], s21 offen lds
v_mfma_f32_16x16x32_bf16 a[108:111], a[152:155], v[248:251], a[108:111]
ds_read_b64_tr_b16 a[190:191], v29 offset:32320
v_mfma_f32_16x16x32_bf16 a[108:111], a[156:159], v[252:255], a[108:111]
s_waitcnt lgkmcnt(8)
v_mfma_f32_16x16x32_bf16 a[4:7], a[160:163], v[192:195], a[4:7]
ds_read_b64_tr_b16 a[144:145], v29 offset:96
v_mfma_f32_16x16x32_bf16 a[4:7], a[164:167], v[196:199], a[4:7]
buffer_load_dwordx4 v[136:139], v2, s[52:55], s16 offen offset:2048 sc1
v_mfma_f32_16x16x32_bf16 a[4:7], a[168:171], v[200:203], a[4:7]
ds_read_b64_tr_b16 a[146:147], v29 offset:4704
v_mfma_f32_16x16x32_bf16 a[4:7], a[172:175], v[204:207], a[4:7]
v_mfma_f32_16x16x32_bf16 a[40:43], a[160:163], v[208:211], a[40:43]
ds_read_b64_tr_b16 a[148:149], v29 offset:9312
v_mfma_f32_16x16x32_bf16 a[40:43], a[164:167], v[212:215], a[40:43]
v_mfma_f32_16x16x32_bf16 a[40:43], a[168:171], v[216:219], a[40:43]
ds_read_b64_tr_b16 a[150:151], v29 offset:13920
v_mfma_f32_16x16x32_bf16 a[40:43], a[172:175], v[220:223], a[40:43]
buffer_load_dwordx4 v[140:143], v2, s[52:55], s16 offen offset:3072 sc1
v_mfma_f32_16x16x32_bf16 a[76:79], a[160:163], v[224:227], a[76:79]
ds_read_b64_tr_b16 a[152:153], v29 offset:18528
v_mfma_f32_16x16x32_bf16 a[76:79], a[164:167], v[228:231], a[76:79]
v_mfma_f32_16x16x32_bf16 a[76:79], a[168:171], v[232:235], a[76:79]
ds_read_b64_tr_b16 a[154:155], v29 offset:23136
v_mfma_f32_16x16x32_bf16 a[76:79], a[172:175], v[236:239], a[76:79]
v_mfma_f32_16x16x32_bf16 a[112:115], a[160:163], v[240:243], a[112:115]
ds_read_b64_tr_b16 a[156:157], v29 offset:27744
v_mfma_f32_16x16x32_bf16 a[112:115], a[164:167], v[244:247], a[112:115]
s_add_u32 m0, m0, 1024
s_nop 0
buffer_load_dwordx4 v7, s[44:47], s21 offen lds
v_mfma_f32_16x16x32_bf16 a[112:115], a[168:171], v[248:251], a[112:115]
ds_read_b64_tr_b16 a[158:159], v29 offset:32352
v_mfma_f32_16x16x32_bf16 a[112:115], a[172:175], v[252:255], a[112:115]
s_waitcnt lgkmcnt(8)
v_mfma_f32_16x16x32_bf16 a[8:11], a[176:179], v[192:195], a[8:11]
ds_read_b64_tr_b16 a[160:161], v29 offset:128
v_mfma_f32_16x16x32_bf16 a[8:11], a[180:183], v[196:199], a[8:11]
v_mfma_f32_16x16x32_bf16 a[8:11], a[184:187], v[200:203], a[8:11]
ds_read_b64_tr_b16 a[162:163], v29 offset:4736
v_mfma_f32_16x16x32_bf16 a[8:11], a[188:191], v[204:207], a[8:11]
s_add_u32 s17, s13, 8192
buffer_load_dwordx4 v[144:147], v2, s[52:55], s17 offen sc1
v_mfma_f32_16x16x32_bf16 a[44:47], a[176:179], v[208:211], a[44:47]
ds_read_b64_tr_b16 a[164:165], v29 offset:9344
v_mfma_f32_16x16x32_bf16 a[44:47], a[180:183], v[212:215], a[44:47]
v_mfma_f32_16x16x32_bf16 a[44:47], a[184:187], v[216:219], a[44:47]
ds_read_b64_tr_b16 a[166:167], v29 offset:13952
v_mfma_f32_16x16x32_bf16 a[44:47], a[188:191], v[220:223], a[44:47]
buffer_load_dwordx4 v[148:151], v2, s[52:55], s17 offen offset:1024 sc1
v_mfma_f32_16x16x32_bf16 a[80:83], a[176:179], v[224:227], a[80:83]
ds_read_b64_tr_b16 a[168:169], v29 offset:18560
v_mfma_f32_16x16x32_bf16 a[80:83], a[180:183], v[228:231], a[80:83]
v_mfma_f32_16x16x32_bf16 a[80:83], a[184:187], v[232:235], a[80:83]
ds_read_b64_tr_b16 a[170:171], v29 offset:23168
v_mfma_f32_16x16x32_bf16 a[80:83], a[188:191], v[236:239], a[80:83]
v_mfma_f32_16x16x32_bf16 a[116:119], a[176:179], v[240:243], a[116:119]
ds_read_b64_tr_b16 a[172:173], v29 offset:27776
v_mfma_f32_16x16x32_bf16 a[116:119], a[180:183], v[244:247], a[116:119]
s_add_u32 m0, m0, 1024
s_nop 0
buffer_load_dwordx4 v8, s[44:47], s21 offen lds
v_mfma_f32_16x16x32_bf16 a[116:119], a[184:187], v[248:251], a[116:119]
ds_read_b64_tr_b16 a[174:175], v29 offset:32384
v_mfma_f32_16x16x32_bf16 a[116:119], a[188:191], v[252:255], a[116:119]
s_waitcnt lgkmcnt(8)
v_mfma_f32_16x16x32_bf16 a[12:15], a[144:147], v[192:195], a[12:15]
ds_read_b64_tr_b16 a[176:177], v29 offset:160
v_mfma_f32_16x16x32_bf16 a[12:15], a[148:151], v[196:199], a[12:15]
v_mfma_f32_16x16x32_bf16 a[12:15], a[152:155], v[200:203], a[12:15]
ds_read_b64_tr_b16 a[178:179], v29 offset:4768
v_mfma_f32_16x16x32_bf16 a[12:15], a[156:159], v[204:207], a[12:15]
buffer_load_dwordx4 v[152:155], v2, s[52:55], s17 offen offset:2048 sc1
v_mfma_f32_16x16x32_bf16 a[48:51], a[144:147], v[208:211], a[48:51]
ds_read_b64_tr_b16 a[180:181], v29 offset:9376
v_mfma_f32_16x16x32_bf16 a[48:51], a[148:151], v[212:215], a[48:51]
v_mfma_f32_16x16x32_bf16 a[48:51], a[152:155], v[216:219], a[48:51]
ds_read_b64_tr_b16 a[182:183], v29 offset:13984
v_mfma_f32_16x16x32_bf16 a[48:51], a[156:159], v[220:223], a[48:51]
v_mfma_f32_16x16x32_bf16 a[84:87], a[144:147], v[224:227], a[84:87]
ds_read_b64_tr_b16 a[184:185], v29 offset:18592
v_mfma_f32_16x16x32_bf16 a[84:87], a[148:151], v[228:231], a[84:87]
buffer_load_dwordx4 v[156:159], v2, s[52:55], s17 offen offset:3072 sc1
v_mfma_f32_16x16x32_bf16 a[84:87], a[152:155], v[232:235], a[84:87]
ds_read_b64_tr_b16 a[186:187], v29 offset:23200
v_mfma_f32_16x16x32_bf16 a[84:87], a[156:159], v[236:239], a[84:87]
v_mfma_f32_16x16x32_bf16 a[120:123], a[144:147], v[240:243], a[120:123]
ds_read_b64_tr_b16 a[188:189], v29 offset:27808
v_mfma_f32_16x16x32_bf16 a[120:123], a[148:151], v[244:247], a[120:123]
s_add_u32 m0, m0, 1024
s_nop 0
buffer_load_dwordx4 v9, s[44:47], s21 offen lds
v_mfma_f32_16x16x32_bf16 a[120:123], a[152:155], v[248:251], a[120:123]
ds_read_b64_tr_b16 a[190:191], v29 offset:32416
v_mfma_f32_16x16x32_bf16 a[120:123], a[156:159], v[252:255], a[120:123]
s_waitcnt lgkmcnt(8)
v_mfma_f32_16x16x32_bf16 a[16:19], a[160:163], v[192:195], a[16:19]
ds_read_b64_tr_b16 a[144:145], v29 offset:192
v_mfma_f32_16x16x32_bf16 a[16:19], a[164:167], v[196:199], a[16:19]
v_mfma_f32_16x16x32_bf16 a[16:19], a[168:171], v[200:203], a[16:19]
ds_read_b64_tr_b16 a[146:147], v29 offset:4800
v_mfma_f32_16x16x32_bf16 a[16:19], a[172:175], v[204:207], a[16:19]
s_add_u32 s18, s14, 8192
buffer_load_dwordx4 v[160:163], v2, s[52:55], s18 offen sc1
v_mfma_f32_16x16x32_bf16 a[52:55], a[160:163], v[208:211], a[52:55]
ds_read_b64_tr_b16 a[148:149], v29 offset:9408
v_mfma_f32_16x16x32_bf16 a[52:55], a[164:167], v[212:215], a[52:55]
v_mfma_f32_16x16x32_bf16 a[52:55], a[168:171], v[216:219], a[52:55]
ds_read_b64_tr_b16 a[150:151], v29 offset:14016
v_mfma_f32_16x16x32_bf16 a[52:55], a[172:175], v[220:223], a[52:55]
v_mfma_f32_16x16x32_bf16 a[88:91], a[160:163], v[224:227], a[88:91]
ds_read_b64_tr_b16 a[152:153], v29 offset:18624
v_mfma_f32_16x16x32_bf16 a[88:91], a[164:167], v[228:231], a[88:91]
buffer_load_dwordx4 v[164:167], v2, s[52:55], s18 offen offset:1024 sc1
v_mfma_f32_16x16x32_bf16 a[88:91], a[168:171], v[232:235], a[88:91]
ds_read_b64_tr_b16 a[154:155], v29 offset:23232
v_mfma_f32_16x16x32_bf16 a[88:91], a[172:175], v[236:239], a[88:91]
v_mfma_f32_16x16x32_bf16 a[124:127], a[160:163], v[240:243], a[124:127]
ds_read_b64_tr_b16 a[156:157], v29 offset:27840
v_mfma_f32_16x16x32_bf16 a[124:127], a[164:167], v[244:247], a[124:127]
v_mfma_f32_16x16x32_bf16 a[124:127], a[168:171], v[248:251], a[124:127]
ds_read_b64_tr_b16 a[158:159], v29 offset:32448
v_mfma_f32_16x16x32_bf16 a[124:127], a[172:175], v[252:255], a[124:127]
s_waitcnt lgkmcnt(8)
s_add_u32 m0, m0, 1024
s_nop 0
buffer_load_dwordx4 v10, s[44:47], s21 offen lds
v_mfma_f32_16x16x32_bf16 a[20:23], a[176:179], v[192:195], a[20:23]
ds_read_b64_tr_b16 a[160:161], v29 offset:224
v_mfma_f32_16x16x32_bf16 a[20:23], a[180:183], v[196:199], a[20:23]
v_mfma_f32_16x16x32_bf16 a[20:23], a[184:187], v[200:203], a[20:23]
ds_read_b64_tr_b16 a[162:163], v29 offset:4832
v_mfma_f32_16x16x32_bf16 a[20:23], a[188:191], v[204:207], a[20:23]
buffer_load_dwordx4 v[168:171], v2, s[52:55], s18 offen offset:2048 sc1
v_mfma_f32_16x16x32_bf16 a[56:59], a[176:179], v[208:211], a[56:59]
ds_read_b64_tr_b16 a[164:165], v29 offset:9440
v_mfma_f32_16x16x32_bf16 a[56:59], a[180:183], v[212:215], a[56:59]
v_mfma_f32_16x16x32_bf16 a[56:59], a[184:187], v[216:219], a[56:59]
ds_read_b64_tr_b16 a[166:167], v29 offset:14048
v_mfma_f32_16x16x32_bf16 a[56:59], a[188:191], v[220:223], a[56:59]
v_mfma_f32_16x16x32_bf16 a[92:95], a[176:179], v[224:227], a[92:95]
ds_read_b64_tr_b16 a[168:169], v29 offset:18656
v_mfma_f32_16x16x32_bf16 a[92:95], a[180:183], v[228:231], a[92:95]
buffer_load_dwordx4 v[172:175], v2, s[52:55], s18 offen offset:3072 sc1
v_mfma_f32_16x16x32_bf16 a[92:95], a[184:187], v[232:235], a[92:95]
ds_read_b64_tr_b16 a[170:171], v29 offset:23264
v_mfma_f32_16x16x32_bf16 a[92:95], a[188:191], v[236:239], a[92:95]
v_mfma_f32_16x16x32_bf16 a[128:131], a[176:179], v[240:243], a[128:131]
ds_read_b64_tr_b16 a[172:173], v29 offset:27872
v_mfma_f32_16x16x32_bf16 a[128:131], a[180:183], v[244:247], a[128:131]
v_mfma_f32_16x16x32_bf16 a[128:131], a[184:187], v[248:251], a[128:131]
ds_read_b64_tr_b16 a[174:175], v29 offset:32480
v_mfma_f32_16x16x32_bf16 a[128:131], a[188:191], v[252:255], a[128:131]
s_waitcnt lgkmcnt(8)
s_add_u32 m0, m0, 1024
s_nop 0
buffer_load_dwordx4 v11, s[44:47], s21 offen lds
v_mfma_f32_16x16x32_bf16 a[24:27], a[144:147], v[192:195], a[24:27]
ds_read_b64_tr_b16 a[176:177], v29 offset:256
v_mfma_f32_16x16x32_bf16 a[24:27], a[148:151], v[196:199], a[24:27]
v_mfma_f32_16x16x32_bf16 a[24:27], a[152:155], v[200:203], a[24:27]
ds_read_b64_tr_b16 a[178:179], v29 offset:4864
v_mfma_f32_16x16x32_bf16 a[24:27], a[156:159], v[204:207], a[24:27]
v_mfma_f32_16x16x32_bf16 a[60:63], a[144:147], v[208:211], a[60:63]
ds_read_b64_tr_b16 a[180:181], v29 offset:9472
v_mfma_f32_16x16x32_bf16 a[60:63], a[148:151], v[212:215], a[60:63]
s_add_u32 s19, s15, 8192
buffer_load_dwordx4 v[176:179], v2, s[52:55], s19 offen sc1
v_mfma_f32_16x16x32_bf16 a[60:63], a[152:155], v[216:219], a[60:63]
ds_read_b64_tr_b16 a[182:183], v29 offset:14080
v_mfma_f32_16x16x32_bf16 a[60:63], a[156:159], v[220:223], a[60:63]
v_mfma_f32_16x16x32_bf16 a[96:99], a[144:147], v[224:227], a[96:99]
ds_read_b64_tr_b16 a[184:185], v29 offset:18688
v_mfma_f32_16x16x32_bf16 a[96:99], a[148:151], v[228:231], a[96:99]
buffer_load_dwordx4 v[180:183], v2, s[52:55], s19 offen offset:1024 sc1
v_mfma_f32_16x16x32_bf16 a[96:99], a[152:155], v[232:235], a[96:99]
ds_read_b64_tr_b16 a[186:187], v29 offset:23296
v_mfma_f32_16x16x32_bf16 a[96:99], a[156:159], v[236:239], a[96:99]
v_mfma_f32_16x16x32_bf16 a[132:135], a[144:147], v[240:243], a[132:135]
ds_read_b64_tr_b16 a[188:189], v29 offset:27904
v_mfma_f32_16x16x32_bf16 a[132:135], a[148:151], v[244:247], a[132:135]
v_mfma_f32_16x16x32_bf16 a[132:135], a[152:155], v[248:251], a[132:135]
ds_read_b64_tr_b16 a[190:191], v29 offset:32512
v_mfma_f32_16x16x32_bf16 a[132:135], a[156:159], v[252:255], a[132:135]
s_waitcnt lgkmcnt(8)
s_add_u32 m0, m0, 1024
s_nop 0
buffer_load_dwordx4 v12, s[44:47], s21 offen lds
v_mfma_f32_16x16x32_bf16 a[28:31], a[160:163], v[192:195], a[28:31]
v_mfma_f32_16x16x32_bf16 a[28:31], a[164:167], v[196:199], a[28:31]
v_mfma_f32_16x16x32_bf16 a[28:31], a[168:171], v[200:203], a[28:31]
s_waitcnt vmcnt(46) lgkmcnt(0)
s_barrier
v_mfma_f32_16x16x32_bf16 a[28:31], a[172:175], v[204:207], a[28:31]
ds_read_b64_tr_b16 a[144:145], v30
v_mfma_f32_16x16x32_bf16 a[64:67], a[160:163], v[208:211], a[64:67]
ds_read_b64_tr_b16 a[146:147], v30 offset:4608
v_mfma_f32_16x16x32_bf16 a[64:67], a[164:167], v[212:215], a[64:67]
buffer_load_dwordx4 v[184:187], v2, s[52:55], s19 offen offset:2048 sc1
v_mfma_f32_16x16x32_bf16 a[64:67], a[168:171], v[216:219], a[64:67]
ds_read_b64_tr_b16 a[148:149], v30 offset:9216
v_mfma_f32_16x16x32_bf16 a[64:67], a[172:175], v[220:223], a[64:67]
ds_read_b64_tr_b16 a[150:151], v30 offset:13824
v_mfma_f32_16x16x32_bf16 a[100:103], a[160:163], v[224:227], a[100:103]
v_mfma_f32_16x16x32_bf16 a[100:103], a[164:167], v[228:231], a[100:103]
ds_read_b64_tr_b16 a[152:153], v30 offset:18432
v_mfma_f32_16x16x32_bf16 a[100:103], a[168:171], v[232:235], a[100:103]
buffer_load_dwordx4 v[188:191], v2, s[52:55], s19 offen offset:3072 sc1
v_mfma_f32_16x16x32_bf16 a[100:103], a[172:175], v[236:239], a[100:103]
ds_read_b64_tr_b16 a[154:155], v30 offset:23040
v_mfma_f32_16x16x32_bf16 a[136:139], a[160:163], v[240:243], a[136:139]
ds_read_b64_tr_b16 a[156:157], v30 offset:27648
v_mfma_f32_16x16x32_bf16 a[136:139], a[164:167], v[244:247], a[136:139]
v_mfma_f32_16x16x32_bf16 a[136:139], a[168:171], v[248:251], a[136:139]
ds_read_b64_tr_b16 a[158:159], v30 offset:32256
v_mfma_f32_16x16x32_bf16 a[136:139], a[172:175], v[252:255], a[136:139]
s_add_u32 m0, m0, 1024
s_nop 0
buffer_load_dwordx4 v13, s[44:47], s21 offen lds
v_mfma_f32_16x16x32_bf16 a[32:35], a[176:179], v[192:195], a[32:35]
ds_read_b64_tr_b16 a[160:161], v30 offset:32
v_mfma_f32_16x16x32_bf16 a[32:35], a[180:183], v[196:199], a[32:35]
ds_read_b64_tr_b16 a[162:163], v30 offset:4640
v_mfma_f32_16x16x32_bf16 a[32:35], a[184:187], v[200:203], a[32:35]
v_mfma_f32_16x16x32_bf16 a[32:35], a[188:191], v[204:207], a[32:35]
ds_read_b64_tr_b16 a[164:165], v30 offset:9248
v_mfma_f32_16x16x32_bf16 a[68:71], a[176:179], v[208:211], a[68:71]
ds_read_b64_tr_b16 a[166:167], v30 offset:13856
v_mfma_f32_16x16x32_bf16 a[68:71], a[180:183], v[212:215], a[68:71]
s_add_u32 m0, m0, 1024
s_nop 0
buffer_load_dwordx4 v14, s[44:47], s21 offen lds
v_mfma_f32_16x16x32_bf16 a[68:71], a[184:187], v[216:219], a[68:71]
ds_read_b64_tr_b16 a[168:169], v30 offset:18464
v_mfma_f32_16x16x32_bf16 a[68:71], a[188:191], v[220:223], a[68:71]
v_mfma_f32_16x16x32_bf16 a[104:107], a[176:179], v[224:227], a[104:107]
ds_read_b64_tr_b16 a[170:171], v30 offset:23072
v_mfma_f32_16x16x32_bf16 a[104:107], a[180:183], v[228:231], a[104:107]
ds_read_b64_tr_b16 a[172:173], v30 offset:27680
v_mfma_f32_16x16x32_bf16 a[104:107], a[184:187], v[232:235], a[104:107]
v_mfma_f32_16x16x32_bf16 a[104:107], a[188:191], v[236:239], a[104:107]
ds_read_b64_tr_b16 a[174:175], v30 offset:32288
v_mfma_f32_16x16x32_bf16 a[140:143], a[176:179], v[240:243], a[140:143]
v_mfma_f32_16x16x32_bf16 a[140:143], a[180:183], v[244:247], a[140:143]
v_mfma_f32_16x16x32_bf16 a[140:143], a[184:187], v[248:251], a[140:143]
v_mfma_f32_16x16x32_bf16 a[140:143], a[188:191], v[252:255], a[140:143]
s_waitcnt vmcnt(45) lgkmcnt(8)
v_mfma_f32_16x16x32_bf16 a[0:3], a[144:147], v[64:67], a[0:3]
ds_read_b64_tr_b16 a[176:177], v30 offset:64
v_mfma_f32_16x16x32_bf16 a[0:3], a[148:151], v[68:71], a[0:3]
s_add_u32 s16, s12, 12288
buffer_load_dwordx4 v[192:195], v2, s[52:55], s16 offen sc1
v_mfma_f32_16x16x32_bf16 a[0:3], a[152:155], v[72:75], a[0:3]
ds_read_b64_tr_b16 a[178:179], v30 offset:4672
v_mfma_f32_16x16x32_bf16 a[0:3], a[156:159], v[76:79], a[0:3]
s_waitcnt vmcnt(40)
v_mfma_f32_16x16x32_bf16 a[36:39], a[144:147], v[80:83], a[36:39]
ds_read_b64_tr_b16 a[180:181], v30 offset:9280
v_mfma_f32_16x16x32_bf16 a[36:39], a[148:151], v[84:87], a[36:39]
v_mfma_f32_16x16x32_bf16 a[36:39], a[152:155], v[88:91], a[36:39]
ds_read_b64_tr_b16 a[182:183], v30 offset:13888
v_mfma_f32_16x16x32_bf16 a[36:39], a[156:159], v[92:95], a[36:39]
s_waitcnt vmcnt(34)
v_mfma_f32_16x16x32_bf16 a[72:75], a[144:147], v[96:99], a[72:75]
ds_read_b64_tr_b16 a[184:185], v30 offset:18496
v_mfma_f32_16x16x32_bf16 a[72:75], a[148:151], v[100:103], a[72:75]
buffer_load_dwordx4 v[196:199], v2, s[52:55], s16 offen offset:1024 sc1
v_mfma_f32_16x16x32_bf16 a[72:75], a[152:155], v[104:107], a[72:75]
ds_read_b64_tr_b16 a[186:187], v30 offset:23104
v_mfma_f32_16x16x32_bf16 a[72:75], a[156:159], v[108:111], a[72:75]
s_waitcnt vmcnt(29)
v_mfma_f32_16x16x32_bf16 a[108:111], a[144:147], v[112:115], a[108:111]
ds_read_b64_tr_b16 a[188:189], v30 offset:27712
v_mfma_f32_16x16x32_bf16 a[108:111], a[148:151], v[116:119], a[108:111]
v_mfma_f32_16x16x32_bf16 a[108:111], a[152:155], v[120:123], a[108:111]
ds_read_b64_tr_b16 a[190:191], v30 offset:32320
v_mfma_f32_16x16x32_bf16 a[108:111], a[156:159], v[124:127], a[108:111]
s_waitcnt lgkmcnt(8)
v_mfma_f32_16x16x32_bf16 a[4:7], a[160:163], v[64:67], a[4:7]
ds_read_b64_tr_b16 a[144:145], v30 offset:96
v_mfma_f32_16x16x32_bf16 a[4:7], a[164:167], v[68:71], a[4:7]
v_mfma_f32_16x16x32_bf16 a[4:7], a[168:171], v[72:75], a[4:7]
ds_read_b64_tr_b16 a[146:147], v30 offset:4704
v_mfma_f32_16x16x32_bf16 a[4:7], a[172:175], v[76:79], a[4:7]
buffer_load_dwordx4 v[200:203], v2, s[52:55], s16 offen offset:2048 sc1
v_mfma_f32_16x16x32_bf16 a[40:43], a[160:163], v[80:83], a[40:43]
ds_read_b64_tr_b16 a[148:149], v30 offset:9312
v_mfma_f32_16x16x32_bf16 a[40:43], a[164:167], v[84:87], a[40:43]
v_mfma_f32_16x16x32_bf16 a[40:43], a[168:171], v[88:91], a[40:43]
ds_read_b64_tr_b16 a[150:151], v30 offset:13920
v_mfma_f32_16x16x32_bf16 a[40:43], a[172:175], v[92:95], a[40:43]
v_mfma_f32_16x16x32_bf16 a[76:79], a[160:163], v[96:99], a[76:79]
ds_read_b64_tr_b16 a[152:153], v30 offset:18528
v_mfma_f32_16x16x32_bf16 a[76:79], a[164:167], v[100:103], a[76:79]
v_mfma_f32_16x16x32_bf16 a[76:79], a[168:171], v[104:107], a[76:79]
ds_read_b64_tr_b16 a[154:155], v30 offset:23136
v_mfma_f32_16x16x32_bf16 a[76:79], a[172:175], v[108:111], a[76:79]
buffer_load_dwordx4 v[204:207], v2, s[52:55], s16 offen offset:3072 sc1
v_mfma_f32_16x16x32_bf16 a[112:115], a[160:163], v[112:115], a[112:115]
ds_read_b64_tr_b16 a[156:157], v30 offset:27744
v_mfma_f32_16x16x32_bf16 a[112:115], a[164:167], v[116:119], a[112:115]
v_mfma_f32_16x16x32_bf16 a[112:115], a[168:171], v[120:123], a[112:115]
ds_read_b64_tr_b16 a[158:159], v30 offset:32352
v_mfma_f32_16x16x32_bf16 a[112:115], a[172:175], v[124:127], a[112:115]
s_waitcnt lgkmcnt(8)
v_mfma_f32_16x16x32_bf16 a[8:11], a[176:179], v[64:67], a[8:11]
ds_read_b64_tr_b16 a[160:161], v30 offset:128
v_mfma_f32_16x16x32_bf16 a[8:11], a[180:183], v[68:71], a[8:11]
v_mfma_f32_16x16x32_bf16 a[8:11], a[184:187], v[72:75], a[8:11]
ds_read_b64_tr_b16 a[162:163], v30 offset:4736
v_mfma_f32_16x16x32_bf16 a[8:11], a[188:191], v[76:79], a[8:11]
s_add_u32 s17, s13, 12288
buffer_load_dwordx4 v[208:211], v2, s[52:55], s17 offen sc1
v_mfma_f32_16x16x32_bf16 a[44:47], a[176:179], v[80:83], a[44:47]
ds_read_b64_tr_b16 a[164:165], v30 offset:9344
v_mfma_f32_16x16x32_bf16 a[44:47], a[180:183], v[84:87], a[44:47]
v_mfma_f32_16x16x32_bf16 a[44:47], a[184:187], v[88:91], a[44:47]
ds_read_b64_tr_b16 a[166:167], v30 offset:13952
v_mfma_f32_16x16x32_bf16 a[44:47], a[188:191], v[92:95], a[44:47]
v_mfma_f32_16x16x32_bf16 a[80:83], a[176:179], v[96:99], a[80:83]
ds_read_b64_tr_b16 a[168:169], v30 offset:18560
v_mfma_f32_16x16x32_bf16 a[80:83], a[180:183], v[100:103], a[80:83]
v_mfma_f32_16x16x32_bf16 a[80:83], a[184:187], v[104:107], a[80:83]
ds_read_b64_tr_b16 a[170:171], v30 offset:23168
v_mfma_f32_16x16x32_bf16 a[80:83], a[188:191], v[108:111], a[80:83]
v_mfma_f32_16x16x32_bf16 a[116:119], a[176:179], v[112:115], a[116:119]
ds_read_b64_tr_b16 a[172:173], v30 offset:27776
v_mfma_f32_16x16x32_bf16 a[116:119], a[180:183], v[116:119], a[116:119]
buffer_load_dwordx4 v[212:215], v2, s[52:55], s17 offen offset:1024 sc1
v_mfma_f32_16x16x32_bf16 a[116:119], a[184:187], v[120:123], a[116:119]
ds_read_b64_tr_b16 a[174:175], v30 offset:32384
v_mfma_f32_16x16x32_bf16 a[116:119], a[188:191], v[124:127], a[116:119]
s_waitcnt lgkmcnt(8)
v_mfma_f32_16x16x32_bf16 a[12:15], a[144:147], v[64:67], a[12:15]
ds_read_b64_tr_b16 a[176:177], v30 offset:160
v_mfma_f32_16x16x32_bf16 a[12:15], a[148:151], v[68:71], a[12:15]
v_mfma_f32_16x16x32_bf16 a[12:15], a[152:155], v[72:75], a[12:15]
ds_read_b64_tr_b16 a[178:179], v30 offset:4768
v_mfma_f32_16x16x32_bf16 a[12:15], a[156:159], v[76:79], a[12:15]
v_mfma_f32_16x16x32_bf16 a[48:51], a[144:147], v[80:83], a[48:51]
ds_read_b64_tr_b16 a[180:181], v30 offset:9376
v_mfma_f32_16x16x32_bf16 a[48:51], a[148:151], v[84:87], a[48:51]
buffer_load_dwordx4 v[216:219], v2, s[52:55], s17 offen offset:2048 sc1
v_mfma_f32_16x16x32_bf16 a[48:51], a[152:155], v[88:91], a[48:51]
ds_read_b64_tr_b16 a[182:183], v30 offset:13984
v_mfma_f32_16x16x32_bf16 a[48:51], a[156:159], v[92:95], a[48:51]
v_mfma_f32_16x16x32_bf16 a[84:87], a[144:147], v[96:99], a[84:87]
ds_read_b64_tr_b16 a[184:185], v30 offset:18592
v_mfma_f32_16x16x32_bf16 a[84:87], a[148:151], v[100:103], a[84:87]
v_mfma_f32_16x16x32_bf16 a[84:87], a[152:155], v[104:107], a[84:87]
ds_read_b64_tr_b16 a[186:187], v30 offset:23200
v_mfma_f32_16x16x32_bf16 a[84:87], a[156:159], v[108:111], a[84:87]
v_mfma_f32_16x16x32_bf16 a[120:123], a[144:147], v[112:115], a[120:123]
ds_read_b64_tr_b16 a[188:189], v30 offset:27808
v_mfma_f32_16x16x32_bf16 a[120:123], a[148:151], v[116:119], a[120:123]
buffer_load_dwordx4 v[220:223], v2, s[52:55], s17 offen offset:3072 sc1
v_mfma_f32_16x16x32_bf16 a[120:123], a[152:155], v[120:123], a[120:123]
ds_read_b64_tr_b16 a[190:191], v30 offset:32416
v_mfma_f32_16x16x32_bf16 a[120:123], a[156:159], v[124:127], a[120:123]
s_waitcnt lgkmcnt(8)
v_mfma_f32_16x16x32_bf16 a[16:19], a[160:163], v[64:67], a[16:19]
ds_read_b64_tr_b16 a[144:145], v30 offset:192
v_mfma_f32_16x16x32_bf16 a[16:19], a[164:167], v[68:71], a[16:19]
v_mfma_f32_16x16x32_bf16 a[16:19], a[168:171], v[72:75], a[16:19]
ds_read_b64_tr_b16 a[146:147], v30 offset:4800
v_mfma_f32_16x16x32_bf16 a[16:19], a[172:175], v[76:79], a[16:19]
v_mfma_f32_16x16x32_bf16 a[52:55], a[160:163], v[80:83], a[52:55]
ds_read_b64_tr_b16 a[148:149], v30 offset:9408
v_mfma_f32_16x16x32_bf16 a[52:55], a[164:167], v[84:87], a[52:55]
v_mfma_f32_16x16x32_bf16 a[52:55], a[168:171], v[88:91], a[52:55]
ds_read_b64_tr_b16 a[150:151], v30 offset:14016
v_mfma_f32_16x16x32_bf16 a[52:55], a[172:175], v[92:95], a[52:55]
s_add_u32 s18, s14, 12288
buffer_load_dwordx4 v[224:227], v2, s[52:55], s18 offen sc1
v_mfma_f32_16x16x32_bf16 a[88:91], a[160:163], v[96:99], a[88:91]
ds_read_b64_tr_b16 a[152:153], v30 offset:18624
v_mfma_f32_16x16x32_bf16 a[88:91], a[164:167], v[100:103], a[88:91]
v_mfma_f32_16x16x32_bf16 a[88:91], a[168:171], v[104:107], a[88:91]
ds_read_b64_tr_b16 a[154:155], v30 offset:23232
v_mfma_f32_16x16x32_bf16 a[88:91], a[172:175], v[108:111], a[88:91]
v_mfma_f32_16x16x32_bf16 a[124:127], a[160:163], v[112:115], a[124:127]
ds_read_b64_tr_b16 a[156:157], v30 offset:27840
v_mfma_f32_16x16x32_bf16 a[124:127], a[164:167], v[116:119], a[124:127]
v_mfma_f32_16x16x32_bf16 a[124:127], a[168:171], v[120:123], a[124:127]
ds_read_b64_tr_b16 a[158:159], v30 offset:32448
v_mfma_f32_16x16x32_bf16 a[124:127], a[172:175], v[124:127], a[124:127]
s_waitcnt lgkmcnt(8)
buffer_load_dwordx4 v[228:231], v2, s[52:55], s18 offen offset:1024 sc1
v_mfma_f32_16x16x32_bf16 a[20:23], a[176:179], v[64:67], a[20:23]
ds_read_b64_tr_b16 a[160:161], v30 offset:224
v_mfma_f32_16x16x32_bf16 a[20:23], a[180:183], v[68:71], a[20:23]
v_mfma_f32_16x16x32_bf16 a[20:23], a[184:187], v[72:75], a[20:23]
ds_read_b64_tr_b16 a[162:163], v30 offset:4832
v_mfma_f32_16x16x32_bf16 a[20:23], a[188:191], v[76:79], a[20:23]
v_mfma_f32_16x16x32_bf16 a[56:59], a[176:179], v[80:83], a[56:59]
ds_read_b64_tr_b16 a[164:165], v30 offset:9440
v_mfma_f32_16x16x32_bf16 a[56:59], a[180:183], v[84:87], a[56:59]
v_mfma_f32_16x16x32_bf16 a[56:59], a[184:187], v[88:91], a[56:59]
ds_read_b64_tr_b16 a[166:167], v30 offset:14048
v_mfma_f32_16x16x32_bf16 a[56:59], a[188:191], v[92:95], a[56:59]
buffer_load_dwordx4 v[232:235], v2, s[52:55], s18 offen offset:2048 sc1
v_mfma_f32_16x16x32_bf16 a[92:95], a[176:179], v[96:99], a[92:95]
ds_read_b64_tr_b16 a[168:169], v30 offset:18656
v_mfma_f32_16x16x32_bf16 a[92:95], a[180:183], v[100:103], a[92:95]
v_mfma_f32_16x16x32_bf16 a[92:95], a[184:187], v[104:107], a[92:95]
ds_read_b64_tr_b16 a[170:171], v30 offset:23264
v_mfma_f32_16x16x32_bf16 a[92:95], a[188:191], v[108:111], a[92:95]
v_mfma_f32_16x16x32_bf16 a[128:131], a[176:179], v[112:115], a[128:131]
ds_read_b64_tr_b16 a[172:173], v30 offset:27872
v_mfma_f32_16x16x32_bf16 a[128:131], a[180:183], v[116:119], a[128:131]
v_mfma_f32_16x16x32_bf16 a[128:131], a[184:187], v[120:123], a[128:131]
ds_read_b64_tr_b16 a[174:175], v30 offset:32480
v_mfma_f32_16x16x32_bf16 a[128:131], a[188:191], v[124:127], a[128:131]
s_waitcnt lgkmcnt(8)
buffer_load_dwordx4 v[236:239], v2, s[52:55], s18 offen offset:3072 sc1
v_mfma_f32_16x16x32_bf16 a[24:27], a[144:147], v[64:67], a[24:27]
ds_read_b64_tr_b16 a[176:177], v30 offset:256
v_mfma_f32_16x16x32_bf16 a[24:27], a[148:151], v[68:71], a[24:27]
v_mfma_f32_16x16x32_bf16 a[24:27], a[152:155], v[72:75], a[24:27]
ds_read_b64_tr_b16 a[178:179], v30 offset:4864
v_mfma_f32_16x16x32_bf16 a[24:27], a[156:159], v[76:79], a[24:27]
v_mfma_f32_16x16x32_bf16 a[60:63], a[144:147], v[80:83], a[60:63]
ds_read_b64_tr_b16 a[180:181], v30 offset:9472
v_mfma_f32_16x16x32_bf16 a[60:63], a[148:151], v[84:87], a[60:63]
v_mfma_f32_16x16x32_bf16 a[60:63], a[152:155], v[88:91], a[60:63]
ds_read_b64_tr_b16 a[182:183], v30 offset:14080
v_mfma_f32_16x16x32_bf16 a[60:63], a[156:159], v[92:95], a[60:63]
v_mfma_f32_16x16x32_bf16 a[96:99], a[144:147], v[96:99], a[96:99]
ds_read_b64_tr_b16 a[184:185], v30 offset:18688
v_mfma_f32_16x16x32_bf16 a[96:99], a[148:151], v[100:103], a[96:99]
s_add_u32 s19, s15, 12288
buffer_load_dwordx4 v[240:243], v2, s[52:55], s19 offen sc1
v_mfma_f32_16x16x32_bf16 a[96:99], a[152:155], v[104:107], a[96:99]
ds_read_b64_tr_b16 a[186:187], v30 offset:23296
v_mfma_f32_16x16x32_bf16 a[96:99], a[156:159], v[108:111], a[96:99]
v_mfma_f32_16x16x32_bf16 a[132:135], a[144:147], v[112:115], a[132:135]
ds_read_b64_tr_b16 a[188:189], v30 offset:27904
v_mfma_f32_16x16x32_bf16 a[132:135], a[148:151], v[116:119], a[132:135]
v_mfma_f32_16x16x32_bf16 a[132:135], a[152:155], v[120:123], a[132:135]
ds_read_b64_tr_b16 a[190:191], v30 offset:32512
v_mfma_f32_16x16x32_bf16 a[132:135], a[156:159], v[124:127], a[132:135]
s_waitcnt lgkmcnt(8)
v_mfma_f32_16x16x32_bf16 a[28:31], a[160:163], v[64:67], a[28:31]
v_mfma_f32_16x16x32_bf16 a[28:31], a[164:167], v[68:71], a[28:31]
buffer_load_dwordx4 v[244:247], v2, s[52:55], s19 offen offset:1024 sc1
v_mfma_f32_16x16x32_bf16 a[28:31], a[168:171], v[72:75], a[28:31]
s_waitcnt vmcnt(39) lgkmcnt(0)
s_barrier
v_mfma_f32_16x16x32_bf16 a[28:31], a[172:175], v[76:79], a[28:31]
ds_read_b64_tr_b16 a[144:145], v31
v_mfma_f32_16x16x32_bf16 a[64:67], a[160:163], v[80:83], a[64:67]
ds_read_b64_tr_b16 a[146:147], v31 offset:4608
v_mfma_f32_16x16x32_bf16 a[64:67], a[164:167], v[84:87], a[64:67]
v_mfma_f32_16x16x32_bf16 a[64:67], a[168:171], v[88:91], a[64:67]
ds_read_b64_tr_b16 a[148:149], v31 offset:9216
v_mfma_f32_16x16x32_bf16 a[64:67], a[172:175], v[92:95], a[64:67]
ds_read_b64_tr_b16 a[150:151], v31 offset:13824
v_mfma_f32_16x16x32_bf16 a[100:103], a[160:163], v[96:99], a[100:103]
v_mfma_f32_16x16x32_bf16 a[100:103], a[164:167], v[100:103], a[100:103]
ds_read_b64_tr_b16 a[152:153], v31 offset:18432
v_mfma_f32_16x16x32_bf16 a[100:103], a[168:171], v[104:107], a[100:103]
buffer_load_dwordx4 v[248:251], v2, s[52:55], s19 offen offset:2048 sc1
v_mfma_f32_16x16x32_bf16 a[100:103], a[172:175], v[108:111], a[100:103]
ds_read_b64_tr_b16 a[154:155], v31 offset:23040
v_mfma_f32_16x16x32_bf16 a[136:139], a[160:163], v[112:115], a[136:139]
ds_read_b64_tr_b16 a[156:157], v31 offset:27648
v_mfma_f32_16x16x32_bf16 a[136:139], a[164:167], v[116:119], a[136:139]
v_mfma_f32_16x16x32_bf16 a[136:139], a[168:171], v[120:123], a[136:139]
ds_read_b64_tr_b16 a[158:159], v31 offset:32256
v_mfma_f32_16x16x32_bf16 a[136:139], a[172:175], v[124:127], a[136:139]
v_mfma_f32_16x16x32_bf16 a[32:35], a[176:179], v[64:67], a[32:35]
ds_read_b64_tr_b16 a[160:161], v31 offset:32
v_mfma_f32_16x16x32_bf16 a[32:35], a[180:183], v[68:71], a[32:35]
ds_read_b64_tr_b16 a[162:163], v31 offset:4640
v_mfma_f32_16x16x32_bf16 a[32:35], a[184:187], v[72:75], a[32:35]
buffer_load_dwordx4 v[252:255], v2, s[52:55], s19 offen offset:3072 sc1
v_mfma_f32_16x16x32_bf16 a[32:35], a[188:191], v[76:79], a[32:35]
ds_read_b64_tr_b16 a[164:165], v31 offset:9248
v_mfma_f32_16x16x32_bf16 a[68:71], a[176:179], v[80:83], a[68:71]
ds_read_b64_tr_b16 a[166:167], v31 offset:13856
v_mfma_f32_16x16x32_bf16 a[68:71], a[180:183], v[84:87], a[68:71]
v_mfma_f32_16x16x32_bf16 a[68:71], a[184:187], v[88:91], a[68:71]
ds_read_b64_tr_b16 a[168:169], v31 offset:18464
v_mfma_f32_16x16x32_bf16 a[68:71], a[188:191], v[92:95], a[68:71]
v_mfma_f32_16x16x32_bf16 a[104:107], a[176:179], v[96:99], a[104:107]
ds_read_b64_tr_b16 a[170:171], v31 offset:23072
v_mfma_f32_16x16x32_bf16 a[104:107], a[180:183], v[100:103], a[104:107]
ds_read_b64_tr_b16 a[172:173], v31 offset:27680
v_mfma_f32_16x16x32_bf16 a[104:107], a[184:187], v[104:107], a[104:107]
v_mfma_f32_16x16x32_bf16 a[104:107], a[188:191], v[108:111], a[104:107]
ds_read_b64_tr_b16 a[174:175], v31 offset:32288
v_mfma_f32_16x16x32_bf16 a[140:143], a[176:179], v[112:115], a[140:143]
v_mfma_f32_16x16x32_bf16 a[140:143], a[180:183], v[116:119], a[140:143]
v_mfma_f32_16x16x32_bf16 a[140:143], a[184:187], v[120:123], a[140:143]
v_mfma_f32_16x16x32_bf16 a[140:143], a[188:191], v[124:127], a[140:143]
s_waitcnt vmcnt(36) lgkmcnt(8)
v_mfma_f32_16x16x32_bf16 a[0:3], a[144:147], v[128:131], a[0:3]
ds_read_b64_tr_b16 a[176:177], v31 offset:64
v_mfma_f32_16x16x32_bf16 a[0:3], a[148:151], v[132:135], a[0:3]
v_mfma_f32_16x16x32_bf16 a[0:3], a[152:155], v[136:139], a[0:3]
ds_read_b64_tr_b16 a[178:179], v31 offset:4672
v_mfma_f32_16x16x32_bf16 a[0:3], a[156:159], v[140:143], a[0:3]
s_waitcnt vmcnt(30)
v_mfma_f32_16x16x32_bf16 a[36:39], a[144:147], v[144:147], a[36:39]
ds_read_b64_tr_b16 a[180:181], v31 offset:9280
v_mfma_f32_16x16x32_bf16 a[36:39], a[148:151], v[148:151], a[36:39]
v_mfma_f32_16x16x32_bf16 a[36:39], a[152:155], v[152:155], a[36:39]
ds_read_b64_tr_b16 a[182:183], v31 offset:13888
v_mfma_f32_16x16x32_bf16 a[36:39], a[156:159], v[156:159], a[36:39]
s_waitcnt vmcnt(24)
v_mfma_f32_16x16x32_bf16 a[72:75], a[144:147], v[160:163], a[72:75]
ds_read_b64_tr_b16 a[184:185], v31 offset:18496
v_mfma_f32_16x16x32_bf16 a[72:75], a[148:151], v[164:167], a[72:75]
v_mfma_f32_16x16x32_bf16 a[72:75], a[152:155], v[168:171], a[72:75]
ds_read_b64_tr_b16 a[186:187], v31 offset:23104
v_mfma_f32_16x16x32_bf16 a[72:75], a[156:159], v[172:175], a[72:75]
s_waitcnt vmcnt(18)
v_mfma_f32_16x16x32_bf16 a[108:111], a[144:147], v[176:179], a[108:111]
ds_read_b64_tr_b16 a[188:189], v31 offset:27712
v_mfma_f32_16x16x32_bf16 a[108:111], a[148:151], v[180:183], a[108:111]
v_mfma_f32_16x16x32_bf16 a[108:111], a[152:155], v[184:187], a[108:111]
ds_read_b64_tr_b16 a[190:191], v31 offset:32320
v_mfma_f32_16x16x32_bf16 a[108:111], a[156:159], v[188:191], a[108:111]
s_waitcnt lgkmcnt(8)
v_mfma_f32_16x16x32_bf16 a[4:7], a[160:163], v[128:131], a[4:7]
ds_read_b64_tr_b16 a[144:145], v31 offset:96
v_mfma_f32_16x16x32_bf16 a[4:7], a[164:167], v[132:135], a[4:7]
v_mfma_f32_16x16x32_bf16 a[4:7], a[168:171], v[136:139], a[4:7]
ds_read_b64_tr_b16 a[146:147], v31 offset:4704
v_mfma_f32_16x16x32_bf16 a[4:7], a[172:175], v[140:143], a[4:7]
v_mfma_f32_16x16x32_bf16 a[40:43], a[160:163], v[144:147], a[40:43]
ds_read_b64_tr_b16 a[148:149], v31 offset:9312
v_mfma_f32_16x16x32_bf16 a[40:43], a[164:167], v[148:151], a[40:43]
v_mfma_f32_16x16x32_bf16 a[40:43], a[168:171], v[152:155], a[40:43]
ds_read_b64_tr_b16 a[150:151], v31 offset:13920
v_mfma_f32_16x16x32_bf16 a[40:43], a[172:175], v[156:159], a[40:43]
v_mfma_f32_16x16x32_bf16 a[76:79], a[160:163], v[160:163], a[76:79]
ds_read_b64_tr_b16 a[152:153], v31 offset:18528
v_mfma_f32_16x16x32_bf16 a[76:79], a[164:167], v[164:167], a[76:79]
v_mfma_f32_16x16x32_bf16 a[76:79], a[168:171], v[168:171], a[76:79]
ds_read_b64_tr_b16 a[154:155], v31 offset:23136
v_mfma_f32_16x16x32_bf16 a[76:79], a[172:175], v[172:175], a[76:79]
v_mfma_f32_16x16x32_bf16 a[112:115], a[160:163], v[176:179], a[112:115]
ds_read_b64_tr_b16 a[156:157], v31 offset:27744
v_mfma_f32_16x16x32_bf16 a[112:115], a[164:167], v[180:183], a[112:115]
v_mfma_f32_16x16x32_bf16 a[112:115], a[168:171], v[184:187], a[112:115]
ds_read_b64_tr_b16 a[158:159], v31 offset:32352
v_mfma_f32_16x16x32_bf16 a[112:115], a[172:175], v[188:191], a[112:115]
s_waitcnt lgkmcnt(8)
v_mfma_f32_16x16x32_bf16 a[8:11], a[176:179], v[128:131], a[8:11]
ds_read_b64_tr_b16 a[160:161], v31 offset:128
v_mfma_f32_16x16x32_bf16 a[8:11], a[180:183], v[132:135], a[8:11]
v_mfma_f32_16x16x32_bf16 a[8:11], a[184:187], v[136:139], a[8:11]
ds_read_b64_tr_b16 a[162:163], v31 offset:4736
v_mfma_f32_16x16x32_bf16 a[8:11], a[188:191], v[140:143], a[8:11]
v_mfma_f32_16x16x32_bf16 a[44:47], a[176:179], v[144:147], a[44:47]
ds_read_b64_tr_b16 a[164:165], v31 offset:9344
v_mfma_f32_16x16x32_bf16 a[44:47], a[180:183], v[148:151], a[44:47]
v_mfma_f32_16x16x32_bf16 a[44:47], a[184:187], v[152:155], a[44:47]
ds_read_b64_tr_b16 a[166:167], v31 offset:13952
v_mfma_f32_16x16x32_bf16 a[44:47], a[188:191], v[156:159], a[44:47]
v_mfma_f32_16x16x32_bf16 a[80:83], a[176:179], v[160:163], a[80:83]
ds_read_b64_tr_b16 a[168:169], v31 offset:18560
v_mfma_f32_16x16x32_bf16 a[80:83], a[180:183], v[164:167], a[80:83]
v_mfma_f32_16x16x32_bf16 a[80:83], a[184:187], v[168:171], a[80:83]
ds_read_b64_tr_b16 a[170:171], v31 offset:23168
v_mfma_f32_16x16x32_bf16 a[80:83], a[188:191], v[172:175], a[80:83]
v_mfma_f32_16x16x32_bf16 a[116:119], a[176:179], v[176:179], a[116:119]
ds_read_b64_tr_b16 a[172:173], v31 offset:27776
v_mfma_f32_16x16x32_bf16 a[116:119], a[180:183], v[180:183], a[116:119]
v_mfma_f32_16x16x32_bf16 a[116:119], a[184:187], v[184:187], a[116:119]
ds_read_b64_tr_b16 a[174:175], v31 offset:32384
v_mfma_f32_16x16x32_bf16 a[116:119], a[188:191], v[188:191], a[116:119]
s_waitcnt lgkmcnt(8)
v_mfma_f32_16x16x32_bf16 a[12:15], a[144:147], v[128:131], a[12:15]
ds_read_b64_tr_b16 a[176:177], v31 offset:160
v_mfma_f32_16x16x32_bf16 a[12:15], a[148:151], v[132:135], a[12:15]
v_mfma_f32_16x16x32_bf16 a[12:15], a[152:155], v[136:139], a[12:15]
ds_read_b64_tr_b16 a[178:179], v31 offset:4768
v_mfma_f32_16x16x32_bf16 a[12:15], a[156:159], v[140:143], a[12:15]
v_mfma_f32_16x16x32_bf16 a[48:51], a[144:147], v[144:147], a[48:51]
ds_read_b64_tr_b16 a[180:181], v31 offset:9376
v_mfma_f32_16x16x32_bf16 a[48:51], a[148:151], v[148:151], a[48:51]
v_mfma_f32_16x16x32_bf16 a[48:51], a[152:155], v[152:155], a[48:51]
ds_read_b64_tr_b16 a[182:183], v31 offset:13984
v_mfma_f32_16x16x32_bf16 a[48:51], a[156:159], v[156:159], a[48:51]
v_mfma_f32_16x16x32_bf16 a[84:87], a[144:147], v[160:163], a[84:87]
ds_read_b64_tr_b16 a[184:185], v31 offset:18592
v_mfma_f32_16x16x32_bf16 a[84:87], a[148:151], v[164:167], a[84:87]
v_mfma_f32_16x16x32_bf16 a[84:87], a[152:155], v[168:171], a[84:87]
ds_read_b64_tr_b16 a[186:187], v31 offset:23200
v_mfma_f32_16x16x32_bf16 a[84:87], a[156:159], v[172:175], a[84:87]
v_mfma_f32_16x16x32_bf16 a[120:123], a[144:147], v[176:179], a[120:123]
ds_read_b64_tr_b16 a[188:189], v31 offset:27808
v_mfma_f32_16x16x32_bf16 a[120:123], a[148:151], v[180:183], a[120:123]
v_mfma_f32_16x16x32_bf16 a[120:123], a[152:155], v[184:187], a[120:123]
ds_read_b64_tr_b16 a[190:191], v31 offset:32416
v_mfma_f32_16x16x32_bf16 a[120:123], a[156:159], v[188:191], a[120:123]
s_waitcnt lgkmcnt(8)
v_mfma_f32_16x16x32_bf16 a[16:19], a[160:163], v[128:131], a[16:19]
ds_read_b64_tr_b16 a[144:145], v31 offset:192
v_mfma_f32_16x16x32_bf16 a[16:19], a[164:167], v[132:135], a[16:19]
v_mfma_f32_16x16x32_bf16 a[16:19], a[168:171], v[136:139], a[16:19]
ds_read_b64_tr_b16 a[146:147], v31 offset:4800
v_mfma_f32_16x16x32_bf16 a[16:19], a[172:175], v[140:143], a[16:19]
v_mfma_f32_16x16x32_bf16 a[52:55], a[160:163], v[144:147], a[52:55]
ds_read_b64_tr_b16 a[148:149], v31 offset:9408
v_mfma_f32_16x16x32_bf16 a[52:55], a[164:167], v[148:151], a[52:55]
v_mfma_f32_16x16x32_bf16 a[52:55], a[168:171], v[152:155], a[52:55]
ds_read_b64_tr_b16 a[150:151], v31 offset:14016
v_mfma_f32_16x16x32_bf16 a[52:55], a[172:175], v[156:159], a[52:55]
v_mfma_f32_16x16x32_bf16 a[88:91], a[160:163], v[160:163], a[88:91]
ds_read_b64_tr_b16 a[152:153], v31 offset:18624
v_mfma_f32_16x16x32_bf16 a[88:91], a[164:167], v[164:167], a[88:91]
v_mfma_f32_16x16x32_bf16 a[88:91], a[168:171], v[168:171], a[88:91]
ds_read_b64_tr_b16 a[154:155], v31 offset:23232
v_mfma_f32_16x16x32_bf16 a[88:91], a[172:175], v[172:175], a[88:91]
v_mfma_f32_16x16x32_bf16 a[124:127], a[160:163], v[176:179], a[124:127]
ds_read_b64_tr_b16 a[156:157], v31 offset:27840
v_mfma_f32_16x16x32_bf16 a[124:127], a[164:167], v[180:183], a[124:127]
v_mfma_f32_16x16x32_bf16 a[124:127], a[168:171], v[184:187], a[124:127]
ds_read_b64_tr_b16 a[158:159], v31 offset:32448
v_mfma_f32_16x16x32_bf16 a[124:127], a[172:175], v[188:191], a[124:127]
s_waitcnt lgkmcnt(8)
v_mfma_f32_16x16x32_bf16 a[20:23], a[176:179], v[128:131], a[20:23]
ds_read_b64_tr_b16 a[160:161], v31 offset:224
v_mfma_f32_16x16x32_bf16 a[20:23], a[180:183], v[132:135], a[20:23]
v_mfma_f32_16x16x32_bf16 a[20:23], a[184:187], v[136:139], a[20:23]
ds_read_b64_tr_b16 a[162:163], v31 offset:4832
v_mfma_f32_16x16x32_bf16 a[20:23], a[188:191], v[140:143], a[20:23]
v_mfma_f32_16x16x32_bf16 a[56:59], a[176:179], v[144:147], a[56:59]
ds_read_b64_tr_b16 a[164:165], v31 offset:9440
v_mfma_f32_16x16x32_bf16 a[56:59], a[180:183], v[148:151], a[56:59]
v_mfma_f32_16x16x32_bf16 a[56:59], a[184:187], v[152:155], a[56:59]
ds_read_b64_tr_b16 a[166:167], v31 offset:14048
v_mfma_f32_16x16x32_bf16 a[56:59], a[188:191], v[156:159], a[56:59]
v_mfma_f32_16x16x32_bf16 a[92:95], a[176:179], v[160:163], a[92:95]
ds_read_b64_tr_b16 a[168:169], v31 offset:18656
v_mfma_f32_16x16x32_bf16 a[92:95], a[180:183], v[164:167], a[92:95]
v_mfma_f32_16x16x32_bf16 a[92:95], a[184:187], v[168:171], a[92:95]
ds_read_b64_tr_b16 a[170:171], v31 offset:23264
v_mfma_f32_16x16x32_bf16 a[92:95], a[188:191], v[172:175], a[92:95]
v_mfma_f32_16x16x32_bf16 a[128:131], a[176:179], v[176:179], a[128:131]
ds_read_b64_tr_b16 a[172:173], v31 offset:27872
v_mfma_f32_16x16x32_bf16 a[128:131], a[180:183], v[180:183], a[128:131]
v_mfma_f32_16x16x32_bf16 a[128:131], a[184:187], v[184:187], a[128:131]
ds_read_b64_tr_b16 a[174:175], v31 offset:32480
v_mfma_f32_16x16x32_bf16 a[128:131], a[188:191], v[188:191], a[128:131]
s_waitcnt lgkmcnt(8)
v_mfma_f32_16x16x32_bf16 a[24:27], a[144:147], v[128:131], a[24:27]
ds_read_b64_tr_b16 a[176:177], v31 offset:256
v_mfma_f32_16x16x32_bf16 a[24:27], a[148:151], v[132:135], a[24:27]
v_mfma_f32_16x16x32_bf16 a[24:27], a[152:155], v[136:139], a[24:27]
ds_read_b64_tr_b16 a[178:179], v31 offset:4864
v_mfma_f32_16x16x32_bf16 a[24:27], a[156:159], v[140:143], a[24:27]
v_mfma_f32_16x16x32_bf16 a[60:63], a[144:147], v[144:147], a[60:63]
ds_read_b64_tr_b16 a[180:181], v31 offset:9472
v_mfma_f32_16x16x32_bf16 a[60:63], a[148:151], v[148:151], a[60:63]
v_mfma_f32_16x16x32_bf16 a[60:63], a[152:155], v[152:155], a[60:63]
ds_read_b64_tr_b16 a[182:183], v31 offset:14080
v_mfma_f32_16x16x32_bf16 a[60:63], a[156:159], v[156:159], a[60:63]
v_mfma_f32_16x16x32_bf16 a[96:99], a[144:147], v[160:163], a[96:99]
ds_read_b64_tr_b16 a[184:185], v31 offset:18688
v_mfma_f32_16x16x32_bf16 a[96:99], a[148:151], v[164:167], a[96:99]
v_mfma_f32_16x16x32_bf16 a[96:99], a[152:155], v[168:171], a[96:99]
ds_read_b64_tr_b16 a[186:187], v31 offset:23296
v_mfma_f32_16x16x32_bf16 a[96:99], a[156:159], v[172:175], a[96:99]
v_mfma_f32_16x16x32_bf16 a[132:135], a[144:147], v[176:179], a[132:135]
ds_read_b64_tr_b16 a[188:189], v31 offset:27904
v_mfma_f32_16x16x32_bf16 a[132:135], a[148:151], v[180:183], a[132:135]
v_mfma_f32_16x16x32_bf16 a[132:135], a[152:155], v[184:187], a[132:135]
ds_read_b64_tr_b16 a[190:191], v31 offset:32512
v_mfma_f32_16x16x32_bf16 a[132:135], a[156:159], v[188:191], a[132:135]
s_waitcnt lgkmcnt(8)
v_mfma_f32_16x16x32_bf16 a[28:31], a[160:163], v[128:131], a[28:31]
v_mfma_f32_16x16x32_bf16 a[28:31], a[164:167], v[132:135], a[28:31]
v_mfma_f32_16x16x32_bf16 a[28:31], a[168:171], v[136:139], a[28:31]
s_waitcnt vmcnt(16) lgkmcnt(0)
s_barrier
v_mfma_f32_16x16x32_bf16 a[28:31], a[172:175], v[140:143], a[28:31]
ds_read_b64_tr_b16 a[144:145], v28
v_mfma_f32_16x16x32_bf16 a[64:67], a[160:163], v[144:147], a[64:67]
ds_read_b64_tr_b16 a[146:147], v28 offset:4608
v_mfma_f32_16x16x32_bf16 a[64:67], a[164:167], v[148:151], a[64:67]
v_mfma_f32_16x16x32_bf16 a[64:67], a[168:171], v[152:155], a[64:67]
ds_read_b64_tr_b16 a[148:149], v28 offset:9216
v_mfma_f32_16x16x32_bf16 a[64:67], a[172:175], v[156:159], a[64:67]
ds_read_b64_tr_b16 a[150:151], v28 offset:13824
v_mfma_f32_16x16x32_bf16 a[100:103], a[160:163], v[160:163], a[100:103]
v_mfma_f32_16x16x32_bf16 a[100:103], a[164:167], v[164:167], a[100:103]
ds_read_b64_tr_b16 a[152:153], v28 offset:18432
v_mfma_f32_16x16x32_bf16 a[100:103], a[168:171], v[168:171], a[100:103]
v_mfma_f32_16x16x32_bf16 a[100:103], a[172:175], v[172:175], a[100:103]
ds_read_b64_tr_b16 a[154:155], v28 offset:23040
v_mfma_f32_16x16x32_bf16 a[136:139], a[160:163], v[176:179], a[136:139]
ds_read_b64_tr_b16 a[156:157], v28 offset:27648
v_mfma_f32_16x16x32_bf16 a[136:139], a[164:167], v[180:183], a[136:139]
v_mfma_f32_16x16x32_bf16 a[136:139], a[168:171], v[184:187], a[136:139]
ds_read_b64_tr_b16 a[158:159], v28 offset:32256
v_mfma_f32_16x16x32_bf16 a[136:139], a[172:175], v[188:191], a[136:139]
v_mfma_f32_16x16x32_bf16 a[32:35], a[176:179], v[128:131], a[32:35]
ds_read_b64_tr_b16 a[160:161], v28 offset:32
v_mfma_f32_16x16x32_bf16 a[32:35], a[180:183], v[132:135], a[32:35]
ds_read_b64_tr_b16 a[162:163], v28 offset:4640
v_mfma_f32_16x16x32_bf16 a[32:35], a[184:187], v[136:139], a[32:35]
v_mfma_f32_16x16x32_bf16 a[32:35], a[188:191], v[140:143], a[32:35]
ds_read_b64_tr_b16 a[164:165], v28 offset:9248
v_mfma_f32_16x16x32_bf16 a[68:71], a[176:179], v[144:147], a[68:71]
ds_read_b64_tr_b16 a[166:167], v28 offset:13856
v_mfma_f32_16x16x32_bf16 a[68:71], a[180:183], v[148:151], a[68:71]
v_mfma_f32_16x16x32_bf16 a[68:71], a[184:187], v[152:155], a[68:71]
ds_read_b64_tr_b16 a[168:169], v28 offset:18464
v_mfma_f32_16x16x32_bf16 a[68:71], a[188:191], v[156:159], a[68:71]
v_mfma_f32_16x16x32_bf16 a[104:107], a[176:179], v[160:163], a[104:107]
ds_read_b64_tr_b16 a[170:171], v28 offset:23072
v_mfma_f32_16x16x32_bf16 a[104:107], a[180:183], v[164:167], a[104:107]
ds_read_b64_tr_b16 a[172:173], v28 offset:27680
v_mfma_f32_16x16x32_bf16 a[104:107], a[184:187], v[168:171], a[104:107]
v_mfma_f32_16x16x32_bf16 a[104:107], a[188:191], v[172:175], a[104:107]
ds_read_b64_tr_b16 a[174:175], v28 offset:32288
v_mfma_f32_16x16x32_bf16 a[140:143], a[176:179], v[176:179], a[140:143]
v_mfma_f32_16x16x32_bf16 a[140:143], a[180:183], v[180:183], a[140:143]
v_mfma_f32_16x16x32_bf16 a[140:143], a[184:187], v[184:187], a[140:143]
v_mfma_f32_16x16x32_bf16 a[140:143], a[188:191], v[188:191], a[140:143]
s_waitcnt vmcnt(12) lgkmcnt(8)
v_mfma_f32_16x16x32_bf16 a[0:3], a[144:147], v[192:195], a[0:3]
ds_read_b64_tr_b16 a[176:177], v28 offset:64
v_mfma_f32_16x16x32_bf16 a[0:3], a[148:151], v[196:199], a[0:3]
v_mfma_f32_16x16x32_bf16 a[0:3], a[152:155], v[200:203], a[0:3]
ds_read_b64_tr_b16 a[178:179], v28 offset:4672
v_mfma_f32_16x16x32_bf16 a[0:3], a[156:159], v[204:207], a[0:3]
s_waitcnt vmcnt(8)
v_mfma_f32_16x16x32_bf16 a[36:39], a[144:147], v[208:211], a[36:39]
ds_read_b64_tr_b16 a[180:181], v28 offset:9280
v_mfma_f32_16x16x32_bf16 a[36:39], a[148:151], v[212:215], a[36:39]
v_mfma_f32_16x16x32_bf16 a[36:39], a[152:155], v[216:219], a[36:39]
ds_read_b64_tr_b16 a[182:183], v28 offset:13888
v_mfma_f32_16x16x32_bf16 a[36:39], a[156:159], v[220:223], a[36:39]
s_waitcnt vmcnt(4)
v_mfma_f32_16x16x32_bf16 a[72:75], a[144:147], v[224:227], a[72:75]
ds_read_b64_tr_b16 a[184:185], v28 offset:18496
v_mfma_f32_16x16x32_bf16 a[72:75], a[148:151], v[228:231], a[72:75]
v_mfma_f32_16x16x32_bf16 a[72:75], a[152:155], v[232:235], a[72:75]
ds_read_b64_tr_b16 a[186:187], v28 offset:23104
v_mfma_f32_16x16x32_bf16 a[72:75], a[156:159], v[236:239], a[72:75]
s_waitcnt vmcnt(0)
v_mfma_f32_16x16x32_bf16 a[108:111], a[144:147], v[240:243], a[108:111]
ds_read_b64_tr_b16 a[188:189], v28 offset:27712
v_mfma_f32_16x16x32_bf16 a[108:111], a[148:151], v[244:247], a[108:111]
v_mfma_f32_16x16x32_bf16 a[108:111], a[152:155], v[248:251], a[108:111]
ds_read_b64_tr_b16 a[190:191], v28 offset:32320
v_mfma_f32_16x16x32_bf16 a[108:111], a[156:159], v[252:255], a[108:111]
s_waitcnt lgkmcnt(8)
v_mfma_f32_16x16x32_bf16 a[4:7], a[160:163], v[192:195], a[4:7]
ds_read_b64_tr_b16 a[144:145], v28 offset:96
v_mfma_f32_16x16x32_bf16 a[4:7], a[164:167], v[196:199], a[4:7]
v_mfma_f32_16x16x32_bf16 a[4:7], a[168:171], v[200:203], a[4:7]
ds_read_b64_tr_b16 a[146:147], v28 offset:4704
v_mfma_f32_16x16x32_bf16 a[4:7], a[172:175], v[204:207], a[4:7]
v_mfma_f32_16x16x32_bf16 a[40:43], a[160:163], v[208:211], a[40:43]
ds_read_b64_tr_b16 a[148:149], v28 offset:9312
v_mfma_f32_16x16x32_bf16 a[40:43], a[164:167], v[212:215], a[40:43]
v_mfma_f32_16x16x32_bf16 a[40:43], a[168:171], v[216:219], a[40:43]
ds_read_b64_tr_b16 a[150:151], v28 offset:13920
v_mfma_f32_16x16x32_bf16 a[40:43], a[172:175], v[220:223], a[40:43]
v_mfma_f32_16x16x32_bf16 a[76:79], a[160:163], v[224:227], a[76:79]
ds_read_b64_tr_b16 a[152:153], v28 offset:18528
v_accvgpr_read_b32 v48, a0
v_mfma_f32_16x16x32_bf16 a[76:79], a[164:167], v[228:231], a[76:79]
v_accvgpr_read_b32 v49, a1
v_accvgpr_read_b32 v50, a2
v_mfma_f32_16x16x32_bf16 a[76:79], a[168:171], v[232:235], a[76:79]
ds_read_b64_tr_b16 a[154:155], v28 offset:23136
v_accvgpr_read_b32 v51, a3
v_mfma_f32_16x16x32_bf16 a[76:79], a[172:175], v[236:239], a[76:79]
v_accvgpr_read_b32 v52, a36
v_accvgpr_read_b32 v53, a37
v_mfma_f32_16x16x32_bf16 a[112:115], a[160:163], v[240:243], a[112:115]
ds_read_b64_tr_b16 a[156:157], v28 offset:27744
v_accvgpr_read_b32 v54, a38
v_mfma_f32_16x16x32_bf16 a[112:115], a[164:167], v[244:247], a[112:115]
v_accvgpr_read_b32 v55, a39
v_cvt_pk_bf16_f32 v32, v48, v49
v_mfma_f32_16x16x32_bf16 a[112:115], a[168:171], v[248:251], a[112:115]
ds_read_b64_tr_b16 a[158:159], v28 offset:32352
v_cvt_pk_bf16_f32 v33, v50, v51
v_mfma_f32_16x16x32_bf16 a[112:115], a[172:175], v[252:255], a[112:115]
s_waitcnt lgkmcnt(8)
v_cvt_pk_bf16_f32 v34, v52, v53
v_cvt_pk_bf16_f32 v35, v54, v55
v_mfma_f32_16x16x32_bf16 a[8:11], a[176:179], v[192:195], a[8:11]
ds_read_b64_tr_b16 a[160:161], v28 offset:128
v_mfma_f32_16x16x32_bf16 a[8:11], a[180:183], v[196:199], a[8:11]
s_add_u32 s29, s70, 0
buffer_store_dwordx4 v[32:35], v2, s[56:59], s29 offen sc1
v_accvgpr_read_b32 v56, a72
v_mfma_f32_16x16x32_bf16 a[8:11], a[184:187], v[200:203], a[8:11]
ds_read_b64_tr_b16 a[162:163], v28 offset:4736
v_accvgpr_read_b32 v57, a73
v_mfma_f32_16x16x32_bf16 a[8:11], a[188:191], v[204:207], a[8:11]
v_accvgpr_read_b32 v58, a74
v_accvgpr_read_b32 v59, a75
v_mfma_f32_16x16x32_bf16 a[44:47], a[176:179], v[208:211], a[44:47]
ds_read_b64_tr_b16 a[164:165], v28 offset:9344
v_accvgpr_read_b32 v60, a108
v_mfma_f32_16x16x32_bf16 a[44:47], a[180:183], v[212:215], a[44:47]
v_accvgpr_read_b32 v61, a109
v_accvgpr_read_b32 v62, a110
v_mfma_f32_16x16x32_bf16 a[44:47], a[184:187], v[216:219], a[44:47]
ds_read_b64_tr_b16 a[166:167], v28 offset:13952
v_accvgpr_read_b32 v63, a111
v_cvt_pk_bf16_f32 v36, v56, v57
v_mfma_f32_16x16x32_bf16 a[44:47], a[188:191], v[220:223], a[44:47]
v_cvt_pk_bf16_f32 v37, v58, v59
v_cvt_pk_bf16_f32 v38, v60, v61
v_mfma_f32_16x16x32_bf16 a[80:83], a[176:179], v[224:227], a[80:83]
ds_read_b64_tr_b16 a[168:169], v28 offset:18560
v_cvt_pk_bf16_f32 v39, v62, v63
v_mfma_f32_16x16x32_bf16 a[80:83], a[180:183], v[228:231], a[80:83]
s_add_u32 s29, s70, 36864
buffer_store_dwordx4 v[36:39], v2, s[56:59], s29 offen sc1
v_accvgpr_read_b32 v48, a4
v_mfma_f32_16x16x32_bf16 a[80:83], a[184:187], v[232:235], a[80:83]
ds_read_b64_tr_b16 a[170:171], v28 offset:23168
v_accvgpr_read_b32 v49, a5
v_mfma_f32_16x16x32_bf16 a[80:83], a[188:191], v[236:239], a[80:83]
v_accvgpr_read_b32 v50, a6
v_accvgpr_read_b32 v51, a7
v_mfma_f32_16x16x32_bf16 a[116:119], a[176:179], v[240:243], a[116:119]
ds_read_b64_tr_b16 a[172:173], v28 offset:27776
v_accvgpr_read_b32 v52, a40
v_mfma_f32_16x16x32_bf16 a[116:119], a[180:183], v[244:247], a[116:119]
v_accvgpr_read_b32 v53, a41
v_accvgpr_read_b32 v54, a42
v_mfma_f32_16x16x32_bf16 a[116:119], a[184:187], v[248:251], a[116:119]
ds_read_b64_tr_b16 a[174:175], v28 offset:32384
v_accvgpr_read_b32 v55, a43
v_cvt_pk_bf16_f32 v40, v48, v49
v_mfma_f32_16x16x32_bf16 a[116:119], a[188:191], v[252:255], a[116:119]
s_waitcnt lgkmcnt(8)
v_cvt_pk_bf16_f32 v41, v50, v51
v_cvt_pk_bf16_f32 v42, v52, v53
v_mfma_f32_16x16x32_bf16 a[12:15], a[144:147], v[192:195], a[12:15]
ds_read_b64_tr_b16 a[176:177], v28 offset:160
v_cvt_pk_bf16_f32 v43, v54, v55
v_mfma_f32_16x16x32_bf16 a[12:15], a[148:151], v[196:199], a[12:15]
s_add_u32 s29, s70, 0
buffer_store_dwordx4 v[40:43], v2, s[56:59], s29 offen offset:1024 sc1
v_accvgpr_read_b32 v56, a76
v_mfma_f32_16x16x32_bf16 a[12:15], a[152:155], v[200:203], a[12:15]
ds_read_b64_tr_b16 a[178:179], v28 offset:4768
v_accvgpr_read_b32 v57, a77
v_mfma_f32_16x16x32_bf16 a[12:15], a[156:159], v[204:207], a[12:15]
v_accvgpr_read_b32 v58, a78
v_accvgpr_read_b32 v59, a79
v_mfma_f32_16x16x32_bf16 a[48:51], a[144:147], v[208:211], a[48:51]
ds_read_b64_tr_b16 a[180:181], v28 offset:9376
v_accvgpr_read_b32 v60, a112
v_mfma_f32_16x16x32_bf16 a[48:51], a[148:151], v[212:215], a[48:51]
v_accvgpr_read_b32 v61, a113
v_accvgpr_read_b32 v62, a114
v_mfma_f32_16x16x32_bf16 a[48:51], a[152:155], v[216:219], a[48:51]
ds_read_b64_tr_b16 a[182:183], v28 offset:13984
v_accvgpr_read_b32 v63, a115
v_cvt_pk_bf16_f32 v44, v56, v57
v_mfma_f32_16x16x32_bf16 a[48:51], a[156:159], v[220:223], a[48:51]
v_cvt_pk_bf16_f32 v45, v58, v59
v_cvt_pk_bf16_f32 v46, v60, v61
v_mfma_f32_16x16x32_bf16 a[84:87], a[144:147], v[224:227], a[84:87]
ds_read_b64_tr_b16 a[184:185], v28 offset:18592
v_cvt_pk_bf16_f32 v47, v62, v63
v_mfma_f32_16x16x32_bf16 a[84:87], a[148:151], v[228:231], a[84:87]
s_add_u32 s29, s70, 36864
buffer_store_dwordx4 v[44:47], v2, s[56:59], s29 offen offset:1024 sc1
v_accvgpr_read_b32 v48, a8
v_mfma_f32_16x16x32_bf16 a[84:87], a[152:155], v[232:235], a[84:87]
ds_read_b64_tr_b16 a[186:187], v28 offset:23200
v_accvgpr_read_b32 v49, a9
v_mfma_f32_16x16x32_bf16 a[84:87], a[156:159], v[236:239], a[84:87]
v_accvgpr_read_b32 v50, a10
v_accvgpr_read_b32 v51, a11
v_mfma_f32_16x16x32_bf16 a[120:123], a[144:147], v[240:243], a[120:123]
ds_read_b64_tr_b16 a[188:189], v28 offset:27808
v_accvgpr_read_b32 v52, a44
v_mfma_f32_16x16x32_bf16 a[120:123], a[148:151], v[244:247], a[120:123]
v_accvgpr_read_b32 v53, a45
v_accvgpr_read_b32 v54, a46
v_mfma_f32_16x16x32_bf16 a[120:123], a[152:155], v[248:251], a[120:123]
ds_read_b64_tr_b16 a[190:191], v28 offset:32416
v_accvgpr_read_b32 v55, a47
v_cvt_pk_bf16_f32 v32, v48, v49
v_mfma_f32_16x16x32_bf16 a[120:123], a[156:159], v[252:255], a[120:123]
s_waitcnt lgkmcnt(8)
v_cvt_pk_bf16_f32 v33, v50, v51
v_cvt_pk_bf16_f32 v34, v52, v53
v_mfma_f32_16x16x32_bf16 a[16:19], a[160:163], v[192:195], a[16:19]
ds_read_b64_tr_b16 a[144:145], v28 offset:192
v_cvt_pk_bf16_f32 v35, v54, v55
v_mfma_f32_16x16x32_bf16 a[16:19], a[164:167], v[196:199], a[16:19]
s_add_u32 s29, s70, 0
buffer_store_dwordx4 v[32:35], v2, s[56:59], s29 offen offset:2048 sc1
v_accvgpr_read_b32 v56, a80
v_mfma_f32_16x16x32_bf16 a[16:19], a[168:171], v[200:203], a[16:19]
ds_read_b64_tr_b16 a[146:147], v28 offset:4800
v_accvgpr_read_b32 v57, a81
v_mfma_f32_16x16x32_bf16 a[16:19], a[172:175], v[204:207], a[16:19]
v_accvgpr_read_b32 v58, a82
v_accvgpr_read_b32 v59, a83
v_mfma_f32_16x16x32_bf16 a[52:55], a[160:163], v[208:211], a[52:55]
ds_read_b64_tr_b16 a[148:149], v28 offset:9408
v_accvgpr_read_b32 v60, a116
v_mfma_f32_16x16x32_bf16 a[52:55], a[164:167], v[212:215], a[52:55]
v_accvgpr_read_b32 v61, a117
v_accvgpr_read_b32 v62, a118
v_mfma_f32_16x16x32_bf16 a[52:55], a[168:171], v[216:219], a[52:55]
ds_read_b64_tr_b16 a[150:151], v28 offset:14016
v_accvgpr_read_b32 v63, a119
v_cvt_pk_bf16_f32 v36, v56, v57
v_mfma_f32_16x16x32_bf16 a[52:55], a[172:175], v[220:223], a[52:55]
v_cvt_pk_bf16_f32 v37, v58, v59
v_cvt_pk_bf16_f32 v38, v60, v61
v_mfma_f32_16x16x32_bf16 a[88:91], a[160:163], v[224:227], a[88:91]
ds_read_b64_tr_b16 a[152:153], v28 offset:18624
v_cvt_pk_bf16_f32 v39, v62, v63
v_mfma_f32_16x16x32_bf16 a[88:91], a[164:167], v[228:231], a[88:91]
s_add_u32 s29, s70, 36864
buffer_store_dwordx4 v[36:39], v2, s[56:59], s29 offen offset:2048 sc1
v_accvgpr_read_b32 v48, a12
v_mfma_f32_16x16x32_bf16 a[88:91], a[168:171], v[232:235], a[88:91]
ds_read_b64_tr_b16 a[154:155], v28 offset:23232
v_accvgpr_read_b32 v49, a13
v_mfma_f32_16x16x32_bf16 a[88:91], a[172:175], v[236:239], a[88:91]
v_accvgpr_read_b32 v50, a14
v_accvgpr_read_b32 v51, a15
v_mfma_f32_16x16x32_bf16 a[124:127], a[160:163], v[240:243], a[124:127]
ds_read_b64_tr_b16 a[156:157], v28 offset:27840
v_accvgpr_read_b32 v52, a48
v_mfma_f32_16x16x32_bf16 a[124:127], a[164:167], v[244:247], a[124:127]
v_accvgpr_read_b32 v53, a49
v_accvgpr_read_b32 v54, a50
v_mfma_f32_16x16x32_bf16 a[124:127], a[168:171], v[248:251], a[124:127]
ds_read_b64_tr_b16 a[158:159], v28 offset:32448
v_accvgpr_read_b32 v55, a51
v_cvt_pk_bf16_f32 v40, v48, v49
v_mfma_f32_16x16x32_bf16 a[124:127], a[172:175], v[252:255], a[124:127]
s_waitcnt lgkmcnt(8)
v_cvt_pk_bf16_f32 v41, v50, v51
v_cvt_pk_bf16_f32 v42, v52, v53
v_mfma_f32_16x16x32_bf16 a[20:23], a[176:179], v[192:195], a[20:23]
ds_read_b64_tr_b16 a[160:161], v28 offset:224
v_cvt_pk_bf16_f32 v43, v54, v55
v_mfma_f32_16x16x32_bf16 a[20:23], a[180:183], v[196:199], a[20:23]
s_add_u32 s29, s70, 0
buffer_store_dwordx4 v[40:43], v2, s[56:59], s29 offen offset:3072 sc1
v_accvgpr_read_b32 v56, a84
v_mfma_f32_16x16x32_bf16 a[20:23], a[184:187], v[200:203], a[20:23]
ds_read_b64_tr_b16 a[162:163], v28 offset:4832
v_accvgpr_read_b32 v57, a85
v_mfma_f32_16x16x32_bf16 a[20:23], a[188:191], v[204:207], a[20:23]
v_accvgpr_read_b32 v58, a86
v_accvgpr_read_b32 v59, a87
v_mfma_f32_16x16x32_bf16 a[56:59], a[176:179], v[208:211], a[56:59]
ds_read_b64_tr_b16 a[164:165], v28 offset:9440
v_accvgpr_read_b32 v60, a120
v_mfma_f32_16x16x32_bf16 a[56:59], a[180:183], v[212:215], a[56:59]
v_accvgpr_read_b32 v61, a121
v_accvgpr_read_b32 v62, a122
v_mfma_f32_16x16x32_bf16 a[56:59], a[184:187], v[216:219], a[56:59]
ds_read_b64_tr_b16 a[166:167], v28 offset:14048
v_accvgpr_read_b32 v63, a123
v_cvt_pk_bf16_f32 v44, v56, v57
v_mfma_f32_16x16x32_bf16 a[56:59], a[188:191], v[220:223], a[56:59]
v_cvt_pk_bf16_f32 v45, v58, v59
v_cvt_pk_bf16_f32 v46, v60, v61
v_mfma_f32_16x16x32_bf16 a[92:95], a[176:179], v[224:227], a[92:95]
ds_read_b64_tr_b16 a[168:169], v28 offset:18656
v_cvt_pk_bf16_f32 v47, v62, v63
v_mfma_f32_16x16x32_bf16 a[92:95], a[180:183], v[228:231], a[92:95]
s_add_u32 s29, s70, 36864
buffer_store_dwordx4 v[44:47], v2, s[56:59], s29 offen offset:3072 sc1
v_accvgpr_read_b32 v48, a16
v_mfma_f32_16x16x32_bf16 a[92:95], a[184:187], v[232:235], a[92:95]
ds_read_b64_tr_b16 a[170:171], v28 offset:23264
v_accvgpr_read_b32 v49, a17
v_mfma_f32_16x16x32_bf16 a[92:95], a[188:191], v[236:239], a[92:95]
v_accvgpr_read_b32 v50, a18
v_accvgpr_read_b32 v51, a19
v_mfma_f32_16x16x32_bf16 a[128:131], a[176:179], v[240:243], a[128:131]
ds_read_b64_tr_b16 a[172:173], v28 offset:27872
v_accvgpr_read_b32 v52, a52
v_mfma_f32_16x16x32_bf16 a[128:131], a[180:183], v[244:247], a[128:131]
v_accvgpr_read_b32 v53, a53
v_accvgpr_read_b32 v54, a54
v_mfma_f32_16x16x32_bf16 a[128:131], a[184:187], v[248:251], a[128:131]
ds_read_b64_tr_b16 a[174:175], v28 offset:32480
v_accvgpr_read_b32 v55, a55
v_cvt_pk_bf16_f32 v32, v48, v49
v_mfma_f32_16x16x32_bf16 a[128:131], a[188:191], v[252:255], a[128:131]
s_waitcnt lgkmcnt(8)
v_cvt_pk_bf16_f32 v33, v50, v51
v_cvt_pk_bf16_f32 v34, v52, v53
v_mfma_f32_16x16x32_bf16 a[24:27], a[144:147], v[192:195], a[24:27]
ds_read_b64_tr_b16 a[176:177], v28 offset:256
v_cvt_pk_bf16_f32 v35, v54, v55
v_mfma_f32_16x16x32_bf16 a[24:27], a[148:151], v[196:199], a[24:27]
s_add_u32 s29, s70, 4096
buffer_store_dwordx4 v[32:35], v2, s[56:59], s29 offen sc1
v_accvgpr_read_b32 v56, a88
v_mfma_f32_16x16x32_bf16 a[24:27], a[152:155], v[200:203], a[24:27]
ds_read_b64_tr_b16 a[178:179], v28 offset:4864
v_accvgpr_read_b32 v57, a89
v_mfma_f32_16x16x32_bf16 a[24:27], a[156:159], v[204:207], a[24:27]
v_accvgpr_read_b32 v58, a90
v_accvgpr_read_b32 v59, a91
v_mfma_f32_16x16x32_bf16 a[60:63], a[144:147], v[208:211], a[60:63]
ds_read_b64_tr_b16 a[180:181], v28 offset:9472
v_accvgpr_read_b32 v60, a124
v_mfma_f32_16x16x32_bf16 a[60:63], a[148:151], v[212:215], a[60:63]
v_accvgpr_read_b32 v61, a125
v_accvgpr_read_b32 v62, a126
v_mfma_f32_16x16x32_bf16 a[60:63], a[152:155], v[216:219], a[60:63]
ds_read_b64_tr_b16 a[182:183], v28 offset:14080
v_accvgpr_read_b32 v63, a127
v_cvt_pk_bf16_f32 v36, v56, v57
v_mfma_f32_16x16x32_bf16 a[60:63], a[156:159], v[220:223], a[60:63]
v_cvt_pk_bf16_f32 v37, v58, v59
v_cvt_pk_bf16_f32 v38, v60, v61
v_mfma_f32_16x16x32_bf16 a[96:99], a[144:147], v[224:227], a[96:99]
ds_read_b64_tr_b16 a[184:185], v28 offset:18688
v_cvt_pk_bf16_f32 v39, v62, v63
v_mfma_f32_16x16x32_bf16 a[96:99], a[148:151], v[228:231], a[96:99]
s_add_u32 s29, s70, 40960
buffer_store_dwordx4 v[36:39], v2, s[56:59], s29 offen sc1
v_accvgpr_read_b32 v48, a20
v_mfma_f32_16x16x32_bf16 a[96:99], a[152:155], v[232:235], a[96:99]
ds_read_b64_tr_b16 a[186:187], v28 offset:23296
v_accvgpr_read_b32 v49, a21
v_mfma_f32_16x16x32_bf16 a[96:99], a[156:159], v[236:239], a[96:99]
v_accvgpr_read_b32 v50, a22
v_accvgpr_read_b32 v51, a23
v_mfma_f32_16x16x32_bf16 a[132:135], a[144:147], v[240:243], a[132:135]
ds_read_b64_tr_b16 a[188:189], v28 offset:27904
v_accvgpr_read_b32 v52, a56
v_mfma_f32_16x16x32_bf16 a[132:135], a[148:151], v[244:247], a[132:135]
v_accvgpr_read_b32 v53, a57
v_accvgpr_read_b32 v54, a58
v_mfma_f32_16x16x32_bf16 a[132:135], a[152:155], v[248:251], a[132:135]
ds_read_b64_tr_b16 a[190:191], v28 offset:32512
v_accvgpr_read_b32 v55, a59
v_cvt_pk_bf16_f32 v40, v48, v49
v_mfma_f32_16x16x32_bf16 a[132:135], a[156:159], v[252:255], a[132:135]
s_waitcnt lgkmcnt(8)
v_cvt_pk_bf16_f32 v41, v50, v51
v_cvt_pk_bf16_f32 v42, v52, v53
v_mfma_f32_16x16x32_bf16 a[28:31], a[160:163], v[192:195], a[28:31]
v_cvt_pk_bf16_f32 v43, v54, v55
v_mfma_f32_16x16x32_bf16 a[28:31], a[164:167], v[196:199], a[28:31]
s_add_u32 s29, s70, 4096
buffer_store_dwordx4 v[40:43], v2, s[56:59], s29 offen offset:1024 sc1
v_accvgpr_read_b32 v56, a92
v_mfma_f32_16x16x32_bf16 a[28:31], a[168:171], v[200:203], a[28:31]
v_accvgpr_read_b32 v57, a93
v_accvgpr_read_b32 v58, a94
v_mfma_f32_16x16x32_bf16 a[28:31], a[172:175], v[204:207], a[28:31]
v_accvgpr_read_b32 v59, a95
v_accvgpr_read_b32 v60, a128
v_mfma_f32_16x16x32_bf16 a[64:67], a[160:163], v[208:211], a[64:67]
v_accvgpr_read_b32 v61, a129
v_accvgpr_read_b32 v62, a130
v_mfma_f32_16x16x32_bf16 a[64:67], a[164:167], v[212:215], a[64:67]
v_accvgpr_read_b32 v63, a131
v_cvt_pk_bf16_f32 v44, v56, v57
v_mfma_f32_16x16x32_bf16 a[64:67], a[168:171], v[216:219], a[64:67]
v_cvt_pk_bf16_f32 v45, v58, v59
v_cvt_pk_bf16_f32 v46, v60, v61
v_mfma_f32_16x16x32_bf16 a[64:67], a[172:175], v[220:223], a[64:67]
v_cvt_pk_bf16_f32 v47, v62, v63
v_mfma_f32_16x16x32_bf16 a[100:103], a[160:163], v[224:227], a[100:103]
s_add_u32 s29, s70, 40960
buffer_store_dwordx4 v[44:47], v2, s[56:59], s29 offen offset:1024 sc1
v_accvgpr_read_b32 v48, a24
v_mfma_f32_16x16x32_bf16 a[100:103], a[164:167], v[228:231], a[100:103]
v_accvgpr_read_b32 v49, a25
v_accvgpr_read_b32 v50, a26
v_mfma_f32_16x16x32_bf16 a[100:103], a[168:171], v[232:235], a[100:103]
v_accvgpr_read_b32 v51, a27
v_accvgpr_read_b32 v52, a60
v_mfma_f32_16x16x32_bf16 a[100:103], a[172:175], v[236:239], a[100:103]
v_accvgpr_read_b32 v53, a61
v_accvgpr_read_b32 v54, a62
v_mfma_f32_16x16x32_bf16 a[136:139], a[160:163], v[240:243], a[136:139]
v_accvgpr_read_b32 v55, a63
v_cvt_pk_bf16_f32 v32, v48, v49
v_mfma_f32_16x16x32_bf16 a[136:139], a[164:167], v[244:247], a[136:139]
v_cvt_pk_bf16_f32 v33, v50, v51
v_cvt_pk_bf16_f32 v34, v52, v53
v_mfma_f32_16x16x32_bf16 a[136:139], a[168:171], v[248:251], a[136:139]
v_cvt_pk_bf16_f32 v35, v54, v55
v_mfma_f32_16x16x32_bf16 a[136:139], a[172:175], v[252:255], a[136:139]
s_waitcnt lgkmcnt(0)
s_add_u32 s29, s70, 4096
buffer_store_dwordx4 v[32:35], v2, s[56:59], s29 offen offset:2048 sc1
v_accvgpr_read_b32 v56, a96
v_mfma_f32_16x16x32_bf16 a[32:35], a[176:179], v[192:195], a[32:35]
v_accvgpr_read_b32 v57, a97
v_accvgpr_read_b32 v58, a98
v_mfma_f32_16x16x32_bf16 a[32:35], a[180:183], v[196:199], a[32:35]
v_accvgpr_read_b32 v59, a99
v_accvgpr_read_b32 v60, a132
v_mfma_f32_16x16x32_bf16 a[32:35], a[184:187], v[200:203], a[32:35]
v_accvgpr_read_b32 v61, a133
v_accvgpr_read_b32 v62, a134
v_mfma_f32_16x16x32_bf16 a[32:35], a[188:191], v[204:207], a[32:35]
v_accvgpr_read_b32 v63, a135
v_cvt_pk_bf16_f32 v36, v56, v57
v_mfma_f32_16x16x32_bf16 a[68:71], a[176:179], v[208:211], a[68:71]
v_cvt_pk_bf16_f32 v37, v58, v59
v_cvt_pk_bf16_f32 v38, v60, v61
v_mfma_f32_16x16x32_bf16 a[68:71], a[180:183], v[212:215], a[68:71]
v_cvt_pk_bf16_f32 v39, v62, v63
v_mfma_f32_16x16x32_bf16 a[68:71], a[184:187], v[216:219], a[68:71]
s_add_u32 s29, s70, 40960
buffer_store_dwordx4 v[36:39], v2, s[56:59], s29 offen offset:2048 sc1
v_mfma_f32_16x16x32_bf16 a[68:71], a[188:191], v[220:223], a[68:71]
v_mfma_f32_16x16x32_bf16 a[104:107], a[176:179], v[224:227], a[104:107]
v_accvgpr_read_b32 v48, a28
v_accvgpr_read_b32 v49, a29
v_mfma_f32_16x16x32_bf16 a[104:107], a[180:183], v[228:231], a[104:107]
v_accvgpr_read_b32 v50, a30
v_accvgpr_read_b32 v51, a31
v_mfma_f32_16x16x32_bf16 a[104:107], a[184:187], v[232:235], a[104:107]
v_accvgpr_read_b32 v52, a64
v_accvgpr_read_b32 v53, a65
v_mfma_f32_16x16x32_bf16 a[104:107], a[188:191], v[236:239], a[104:107]
v_accvgpr_read_b32 v54, a66
v_accvgpr_read_b32 v55, a67
v_mfma_f32_16x16x32_bf16 a[140:143], a[176:179], v[240:243], a[140:143]
v_cvt_pk_bf16_f32 v40, v48, v49
v_cvt_pk_bf16_f32 v41, v50, v51
v_mfma_f32_16x16x32_bf16 a[140:143], a[180:183], v[244:247], a[140:143]
v_cvt_pk_bf16_f32 v42, v52, v53
v_cvt_pk_bf16_f32 v43, v54, v55
v_mfma_f32_16x16x32_bf16 a[140:143], a[184:187], v[248:251], a[140:143]
s_add_u32 s29, s70, 4096
buffer_store_dwordx4 v[40:43], v2, s[56:59], s29 offen offset:3072 sc1
v_accvgpr_read_b32 v56, a100
v_mfma_f32_16x16x32_bf16 a[140:143], a[188:191], v[252:255], a[140:143]
v_accvgpr_read_b32 v57, a101
v_accvgpr_read_b32 v58, a102
v_accvgpr_read_b32 v59, a103
v_accvgpr_read_b32 v60, a136
v_accvgpr_read_b32 v61, a137
v_accvgpr_read_b32 v62, a138
v_accvgpr_read_b32 v63, a139
v_cvt_pk_bf16_f32 v44, v56, v57
v_cvt_pk_bf16_f32 v45, v58, v59
v_cvt_pk_bf16_f32 v46, v60, v61
v_cvt_pk_bf16_f32 v47, v62, v63
s_add_u32 s29, s70, 40960
buffer_store_dwordx4 v[44:47], v2, s[56:59], s29 offen offset:3072 sc1
s_nop 7
v_accvgpr_read_b32 v48, a32
v_accvgpr_read_b32 v49, a33
v_accvgpr_read_b32 v50, a34
v_accvgpr_read_b32 v51, a35
v_accvgpr_read_b32 v52, a68
v_accvgpr_read_b32 v53, a69
v_accvgpr_read_b32 v54, a70
v_accvgpr_read_b32 v55, a71
v_cvt_pk_bf16_f32 v32, v48, v49
v_cvt_pk_bf16_f32 v33, v50, v51
v_cvt_pk_bf16_f32 v34, v52, v53
v_cvt_pk_bf16_f32 v35, v54, v55
s_add_u32 s29, s70, 8192
buffer_store_dwordx4 v[32:35], v2, s[56:59], s29 offen sc1
v_accvgpr_read_b32 v56, a104
v_accvgpr_read_b32 v57, a105
v_accvgpr_read_b32 v58, a106
v_accvgpr_read_b32 v59, a107
v_accvgpr_read_b32 v60, a140
v_accvgpr_read_b32 v61, a141
v_accvgpr_read_b32 v62, a142
v_accvgpr_read_b32 v63, a143
v_cvt_pk_bf16_f32 v36, v56, v57
v_cvt_pk_bf16_f32 v37, v58, v59
v_cvt_pk_bf16_f32 v38, v60, v61
v_cvt_pk_bf16_f32 v39, v62, v63
s_add_u32 s29, s70, 45056
buffer_store_dwordx4 v[36:39], v2, s[56:59], s29 offen sc1
L_ap_done:
s_lshl_b32 s27, s37, 2
s_add_u32 s27, s27, s38
s_lshl_b32 s27, s27, 7
s_add_u32 s27, s27, 8192
v_mov_b32 v23, s27
buffer_load_dword v24, v23, s[72:75], 0 offen sc1
s_mov_b32 s92, s66
s_mov_b32 s93, s67
s_mov_b32 s94, 0x240000
s_mov_b32 s95, 0x20000
s_mov_b32 s88, s68
s_mov_b32 s89, s69
s_mov_b32 s90, 0x240000
s_mov_b32 s91, 0x20000
v_and_b32 v15, 15, v1
v_mul_u32_u24 v15, 1152, v15
v_lshrrev_b32 v16, 4, v1
v_lshl_add_u32 v17, v16, 3, v15
v_add_u32 v18, 18432, v17
s_lshl_b32 s27, s37, 3
s_add_u32 s27, s27, s36
s_mul_i32 s98, s27, 36
s_mul_i32 s29, s38, 9
s_add_u32 s98, s98, s29
s_add_u32 s98, s98, s20
s_lshl_b32 s98, s98, 10
s_mul_i32 s99, s27, 36864
s_add_u32 s29, s29, s20
s_lshl_b32 s29, s29, 5
s_add_u32 s99, s99, s29
s_cmp_eq_u32 s20, 0
s_cselect_b32 s100, 0, 0x40000000
s_lshl_b32 s78, 1, s36
s_waitcnt vmcnt(0)
v_readfirstlane_b32 s101, v24
s_nop 3
s_and_b32 s101, s101, 0xff
s_andn2_b32 s101, s101, s78
s_bitcmp1_b32 s101, 0
s_cbranch_scc0 L_ap_pa0
s_add_u32 s31, s98, 0
buffer_load_dwordx4 v[64:67], v2, s[56:59], s31 offen sc1
s_add_u32 s31, s98, 4096
buffer_load_dwordx4 v[96:99], v2, s[56:59], s31 offen sc1
s_add_u32 s31, s98, 8192
s_add_u32 s31, s31, s100
buffer_load_dwordx4 v[128:131], v2, s[56:59], s31 offen sc1
L_ap_pa0:
s_bitcmp1_b32 s101, 1
s_cbranch_scc0 L_ap_pa1
s_add_u32 s31, s98, 2359296
buffer_load_dwordx4 v[68:71], v2, s[56:59], s31 offen sc1
s_add_u32 s31, s98, 2363392
buffer_load_dwordx4 v[100:103], v2, s[56:59], s31 offen sc1
s_add_u32 s31, s98, 2367488
s_add_u32 s31, s31, s100
buffer_load_dwordx4 v[132:135], v2, s[56:59], s31 offen sc1
L_ap_pa1:
s_bitcmp1_b32 s101, 2
s_cbranch_scc0 L_ap_pa2
s_add_u32 s31, s98, 4718592
buffer_load_dwordx4 v[72:75], v2, s[56:59], s31 offen sc1
s_add_u32 s31, s98, 4722688
buffer_load_dwordx4 v[104:107], v2, s[56:59], s31 offen sc1
s_add_u32 s31, s98, 4726784
s_add_u32 s31, s31, s100
buffer_load_dwordx4 v[136:139], v2, s[56:59], s31 offen sc1
L_ap_pa2:
s_bitcmp1_b32 s101, 3
s_cbranch_scc0 L_ap_pa3
s_add_u32 s31, s98, 7077888
buffer_load_dwordx4 v[76:79], v2, s[56:59], s31 offen sc1
s_add_u32 s31, s98, 7081984
buffer_load_dwordx4 v[108:111], v2, s[56:59], s31 offen sc1
s_add_u32 s31, s98, 7086080
s_add_u32 s31, s31, s100
buffer_load_dwordx4 v[140:143], v2, s[56:59], s31 offen sc1
L_ap_pa3:
s_bitcmp1_b32 s101, 4
s_cbranch_scc0 L_ap_pa4
s_add_u32 s31, s98, 9437184
buffer_load_dwordx4 v[80:83], v2, s[56:59], s31 offen sc1
s_add_u32 s31, s98, 9441280
buffer_load_dwordx4 v[112:115], v2, s[56:59], s31 offen sc1
s_add_u32 s31, s98, 9445376
s_add_u32 s31, s31, s100
buffer_load_dwordx4 v[144:147], v2, s[56:59], s31 offen sc1
L_ap_pa4:
s_bitcmp1_b32 s101, 5
s_cbranch_scc0 L_ap_pa5
s_add_u32 s31, s98, 11796480
buffer_load_dwordx4 v[84:87], v2, s[56:59], s31 offen sc1
s_add_u32 s31, s98, 11800576
buffer_load_dwordx4 v[116:119], v2, s[56:59], s31 offen sc1
s_add_u32 s31, s98, 11804672
s_add_u32 s31, s31, s100
buffer_load_dwordx4 v[148:151], v2, s[56:59], s31 offen sc1
L_ap_pa5:
s_bitcmp1_b32 s101, 6
s_cbranch_scc0 L_ap_pa6
s_add_u32 s31, s98, 14155776
buffer_load_dwordx4 v[88:91], v2, s[56:59], s31 offen sc1
s_add_u32 s31, s98, 14159872
buffer_load_dwordx4 v[120:123], v2, s[56:59], s31 offen sc1
s_add_u32 s31, s98, 14163968
s_add_u32 s31, s31, s100
buffer_load_dwordx4 v[152:155], v2, s[56:59], s31 offen sc1
L_ap_pa6:
s_bitcmp1_b32 s101, 7
s_cbranch_scc0 L_ap_pa7
s_add_u32 s31, s98, 16515072
buffer_load_dwordx4 v[92:95], v2, s[56:59], s31 offen sc1
s_add_u32 s31, s98, 16519168
buffer_load_dwordx4 v[124:127], v2, s[56:59], s31 offen sc1
s_add_u32 s31, s98, 16523264
s_add_u32 s31, s31, s100
buffer_load_dwordx4 v[156:159], v2, s[56:59], s31 offen sc1
L_ap_pa7:
s_add_u32 s31, s99, 0
buffer_load_dwordx2 v[160:161], v17, s[92:95], s31 offen
buffer_load_dwordx2 v[162:163], v18, s[92:95], s31 offen
s_add_u32 s31, s99, 128
buffer_load_dwordx2 v[164:165], v17, s[92:95], s31 offen
buffer_load_dwordx2 v[166:167], v18, s[92:95], s31 offen
s_add_u32 s31, s99, 256
s_add_u32 s31, s31, s100
buffer_load_dwordx2 v[168:169], v17, s[92:95], s31 offen
buffer_load_dwordx2 v[170:171], v18, s[92:95], s31 offen
s_barrier
s_cmp_lg_u32 s20, 0
s_cbranch_scc1 L_ap_prog
v_mov_b32 v16, s78
s_mov_b64 exec, 1
buffer_atomic_or v16, v23, s[72:75], 0 offen sc0
s_waitcnt vmcnt(0)
v_readfirstlane_b32 s28, v16
s_nop 3
s_or_b32 s29, s28, s78
s_and_b32 s29, s29, 0xff
s_cmp_eq_u32 s29, 0xff
s_cbranch_scc0 L_ap_rpoll
s_lshr_b32 s28, s28, 8
s_or_b32 s78, s78, s28
s_branch L_ap_publish
L_ap_rpoll:
s_mov_b32 s77, 0
L_ap_rpollloop:
buffer_load_dword v24, v23, s[72:75], 0 offen sc1
s_waitcnt vmcnt(0)
v_readfirstlane_b32 s28, v24
s_mov_b64 exec, -1
s_nop 2
s_and_b32 s28, s28, 0xff
s_andn2_b32 s79, s28, s101
s_or_b32 s101, s101, s79
s_bitcmp1_b32 s79, 0
s_cbranch_scc0 L_ap_p00
s_add_u32 s31, s98, 0
buffer_load_dwordx4 v[64:67], v2, s[56:59], s31 offen sc1
s_add_u32 s31, s98, 4096
buffer_load_dwordx4 v[96:99], v2, s[56:59], s31 offen sc1
s_add_u32 s31, s98, 8192
s_add_u32 s31, s31, s100
buffer_load_dwordx4 v[128:131], v2, s[56:59], s31 offen sc1
L_ap_p00:
s_bitcmp1_b32 s79, 1
s_cbranch_scc0 L_ap_p01
s_add_u32 s31, s98, 2359296
buffer_load_dwordx4 v[68:71], v2, s[56:59], s31 offen sc1
s_add_u32 s31, s98, 2363392
buffer_load_dwordx4 v[100:103], v2, s[56:59], s31 offen sc1
s_add_u32 s31, s98, 2367488
s_add_u32 s31, s31, s100
buffer_load_dwordx4 v[132:135], v2, s[56:59], s31 offen sc1
L_ap_p01:
s_bitcmp1_b32 s79, 2
s_cbranch_scc0 L_ap_p02
s_add_u32 s31, s98, 4718592
buffer_load_dwordx4 v[72:75], v2, s[56:59], s31 offen sc1
s_add_u32 s31, s98, 4722688
buffer_load_dwordx4 v[104:107], v2, s[56:59], s31 offen sc1
s_add_u32 s31, s98, 4726784
s_add_u32 s31, s31, s100
buffer_load_dwordx4 v[136:139], v2, s[56:59], s31 offen sc1
L_ap_p02:
s_bitcmp1_b32 s79, 3
s_cbranch_scc0 L_ap_p03
s_add_u32 s31, s98, 7077888
buffer_load_dwordx4 v[76:79], v2, s[56:59], s31 offen sc1
s_add_u32 s31, s98, 7081984
buffer_load_dwordx4 v[108:111], v2, s[56:59], s31 offen sc1
s_add_u32 s31, s98, 7086080
s_add_u32 s31, s31, s100
buffer_load_dwordx4 v[140:143], v2, s[56:59], s31 offen sc1
L_ap_p03:
s_bitcmp1_b32 s79, 4
s_cbranch_scc0 L_ap_p04
s_add_u32 s31, s98, 9437184
buffer_load_dwordx4 v[80:83], v2, s[56:59], s31 offen sc1
s_add_u32 s31, s98, 9441280
buffer_load_dwordx4 v[112:115], v2, s[56:59], s31 offen sc1
s_add_u32 s31, s98, 9445376
s_add_u32 s31, s31, s100
buffer_load_dwordx4 v[144:147], v2, s[56:59], s31 offen sc1
L_ap_p04:
s_bitcmp1_b32 s79, 5
s_cbranch_scc0 L_ap_p05
s_add_u32 s31, s98, 11796480
buffer_load_dwordx4 v[84:87], v2, s[56:59], s31 offen sc1
s_add_u32 s31, s98, 11800576
buffer_load_dwordx4 v[116:119], v2, s[56:59], s31 offen sc1
s_add_u32 s31, s98, 11804672
s_add_u32 s31, s31, s100
buffer_load_dwordx4 v[148:151], v2, s[56:59], s31 offen sc1
L_ap_p05:
s_bitcmp1_b32 s79, 6
s_cbranch_scc0 L_ap_p06
s_add_u32 s31, s98, 14155776
buffer_load_dwordx4 v[88:91], v2, s[56:59], s31 offen sc1
s_add_u32 s31, s98, 14159872
buffer_load_dwordx4 v[120:123], v2, s[56:59], s31 offen sc1
s_add_u32 s31, s98, 14163968
s_add_u32 s31, s31, s100
buffer_load_dwordx4 v[152:155], v2, s[56:59], s31 offen sc1
L_ap_p06:
s_bitcmp1_b32 s79, 7
s_cbranch_scc0 L_ap_p07
s_add_u32 s31, s98, 16515072
buffer_load_dwordx4 v[92:95], v2, s[56:59], s31 offen sc1
s_add_u32 s31, s98, 16519168
buffer_load_dwordx4 v[124:127], v2, s[56:59], s31 offen sc1
s_add_u32 s31, s98, 16523264
s_add_u32 s31, s31, s100
buffer_load_dwordx4 v[156:159], v2, s[56:59], s31 offen sc1
L_ap_p07:
s_mov_b64 exec, 1
s_cmp_eq_u32 s101, 0xff
s_cbranch_scc1 L_ap_publish
s_sleep 2
s_add_u32 s77, s77, 1
s_cmp_lt_u32 s77, 20000
s_cbranch_scc1 L_ap_rpollloop
s_lshl_b32 s28, s78, 8
v_mov_b32 v16, s28
buffer_atomic_or v16, v23, s[72:75], 0 offen sc0
s_waitcnt vmcnt(0)
v_readfirstlane_b32 s28, v16
s_nop 3
s_and_b32 s29, s28, 0xff
s_cmp_eq_u32 s29, 0xff
s_cselect_b32 s78, s78, 0
L_ap_publish:
v_mov_b32 v15, 0
v_mov_b32 v16, s78
ds_write_b32 v15, v16
s_mov_b64 exec, -1
s_waitcnt lgkmcnt(0)
s_branch L_ap_wait
L_ap_prog:
s_mov_b32 s77, 0
L_ap_progloop:
buffer_load_dword v24, v23, s[72:75], 0 offen sc1
s_waitcnt vmcnt(0)
v_readfirstlane_b32 s28, v24
s_nop 3
s_and_b32 s28, s28, 0xff
s_andn2_b32 s79, s28, s101
s_or_b32 s101, s101, s79
s_bitcmp1_b32 s79, 0
s_cbranch_scc0 L_ap_p10
s_add_u32 s31, s98, 0
buffer_load_dwordx4 v[64:67], v2, s[56:59], s31 offen sc1
s_add_u32 s31, s98, 4096
buffer_load_dwordx4 v[96:99], v2, s[56:59], s31 offen sc1
s_add_u32 s31, s98, 8192
s_add_u32 s31, s31, s100
buffer_load_dwordx4 v[128:131], v2, s[56:59], s31 offen sc1
L_ap_p10:
s_bitcmp1_b32 s79, 1
s_cbranch_scc0 L_ap_p11
s_add_u32 s31, s98, 2359296
buffer_load_dwordx4 v[68:71], v2, s[56:59], s31 offen sc1
s_add_u32 s31, s98, 2363392
buffer_load_dwordx4 v[100:103], v2, s[56:59], s31 offen sc1
s_add_u32 s31, s98, 2367488
s_add_u32 s31, s31, s100
buffer_load_dwordx4 v[132:135], v2, s[56:59], s31 offen sc1
L_ap_p11:
s_bitcmp1_b32 s79, 2
s_cbranch_scc0 L_ap_p12
s_add_u32 s31, s98, 4718592
buffer_load_dwordx4 v[72:75], v2, s[56:59], s31 offen sc1
s_add_u32 s31, s98, 4722688
buffer_load_dwordx4 v[104:107], v2, s[56:59], s31 offen sc1
s_add_u32 s31, s98, 4726784
s_add_u32 s31, s31, s100
buffer_load_dwordx4 v[136:139], v2, s[56:59], s31 offen sc1
L_ap_p12:
s_bitcmp1_b32 s79, 3
s_cbranch_scc0 L_ap_p13
s_add_u32 s31, s98, 7077888
buffer_load_dwordx4 v[76:79], v2, s[56:59], s31 offen sc1
s_add_u32 s31, s98, 7081984
buffer_load_dwordx4 v[108:111], v2, s[56:59], s31 offen sc1
s_add_u32 s31, s98, 7086080
s_add_u32 s31, s31, s100
buffer_load_dwordx4 v[140:143], v2, s[56:59], s31 offen sc1
L_ap_p13:
s_bitcmp1_b32 s79, 4
s_cbranch_scc0 L_ap_p14
s_add_u32 s31, s98, 9437184
buffer_load_dwordx4 v[80:83], v2, s[56:59], s31 offen sc1
s_add_u32 s31, s98, 9441280
buffer_load_dwordx4 v[112:115], v2, s[56:59], s31 offen sc1
s_add_u32 s31, s98, 9445376
s_add_u32 s31, s31, s100
buffer_load_dwordx4 v[144:147], v2, s[56:59], s31 offen sc1
L_ap_p14:
s_bitcmp1_b32 s79, 5
s_cbranch_scc0 L_ap_p15
s_add_u32 s31, s98, 11796480
buffer_load_dwordx4 v[84:87], v2, s[56:59], s31 offen sc1
s_add_u32 s31, s98, 11800576
buffer_load_dwordx4 v[116:119], v2, s[56:59], s31 offen sc1
s_add_u32 s31, s98, 11804672
s_add_u32 s31, s31, s100
buffer_load_dwordx4 v[148:151], v2, s[56:59], s31 offen sc1
L_ap_p15:
s_bitcmp1_b32 s79, 6
s_cbranch_scc0 L_ap_p16
s_add_u32 s31, s98, 14155776
buffer_load_dwordx4 v[88:91], v2, s[56:59], s31 offen sc1
s_add_u32 s31, s98, 14159872
buffer_load_dwordx4 v[120:123], v2, s[56:59], s31 offen sc1
s_add_u32 s31, s98, 14163968
s_add_u32 s31, s31, s100
buffer_load_dwordx4 v[152:155], v2, s[56:59], s31 offen sc1
L_ap_p16:
s_bitcmp1_b32 s79, 7
s_cbranch_scc0 L_ap_p17
s_add_u32 s31, s98, 16515072
buffer_load_dwordx4 v[92:95], v2, s[56:59], s31 offen sc1
s_add_u32 s31, s98, 16519168
buffer_load_dwordx4 v[124:127], v2, s[56:59], s31 offen sc1
s_add_u32 s31, s98, 16523264
s_add_u32 s31, s31, s100
buffer_load_dwordx4 v[156:159], v2, s[56:59], s31 offen sc1
L_ap_p17:
s_cmp_eq_u32 s101, 0xff
s_cbranch_scc1 L_ap_wait
s_sleep 2
s_add_u32 s77, s77, 1
s_cmp_lt_u32 s77, 20000
s_cbranch_scc1 L_ap_progloop
L_ap_wait:
s_barrier
v_mov_b32 v15, 0
ds_read_b32 v16, v15
s_waitcnt lgkmcnt(0)
v_readfirstlane_b32 s78, v16
s_nop 3
s_cmp_eq_u32 s78, 0
s_cbranch_scc1 L_ap_exit
s_andn2_b32 s101, 0xff, s101
s_bitcmp1_b32 s101, 0
s_cbranch_scc0 L_ap_pb0
s_add_u32 s31, s98, 0
s_waitcnt vmcnt(23)
buffer_load_dwordx4 v[64:67], v2, s[56:59], s31 offen sc1
s_add_u32 s31, s98, 4096
s_waitcnt vmcnt(23)
buffer_load_dwordx4 v[96:99], v2, s[56:59], s31 offen sc1
s_add_u32 s31, s98, 8192
s_add_u32 s31, s31, s100
s_waitcnt vmcnt(23)
buffer_load_dwordx4 v[128:131], v2, s[56:59], s31 offen sc1
L_ap_pb0:
s_bitcmp1_b32 s101, 1
s_cbranch_scc0 L_ap_pb1
s_add_u32 s31, s98, 2359296
s_waitcnt vmcnt(23)
buffer_load_dwordx4 v[68:71], v2, s[56:59], s31 offen sc1
s_add_u32 s31, s98, 2363392
s_waitcnt vmcnt(23)
buffer_load_dwordx4 v[100:103], v2, s[56:59], s31 offen sc1
s_add_u32 s31, s98, 2367488
s_add_u32 s31, s31, s100
s_waitcnt vmcnt(23)
buffer_load_dwordx4 v[132:135], v2, s[56:59], s31 offen sc1
L_ap_pb1:
s_bitcmp1_b32 s101, 2
s_cbranch_scc0 L_ap_pb2
s_add_u32 s31, s98, 4718592
s_waitcnt vmcnt(23)
buffer_load_dwordx4 v[72:75], v2, s[56:59], s31 offen sc1
s_add_u32 s31, s98, 4722688
s_waitcnt vmcnt(23)
buffer_load_dwordx4 v[104:107], v2, s[56:59], s31 offen sc1
s_add_u32 s31, s98, 4726784
s_add_u32 s31, s31, s100
s_waitcnt vmcnt(23)
buffer_load_dwordx4 v[136:139], v2, s[56:59], s31 offen sc1
L_ap_pb2:
s_bitcmp1_b32 s101, 3
s_cbranch_scc0 L_ap_pb3
s_add_u32 s31, s98, 7077888
s_waitcnt vmcnt(23)
buffer_load_dwordx4 v[76:79], v2, s[56:59], s31 offen sc1
s_add_u32 s31, s98, 7081984
s_waitcnt vmcnt(23)
buffer_load_dwordx4 v[108:111], v2, s[56:59], s31 offen sc1
s_add_u32 s31, s98, 7086080
s_add_u32 s31, s31, s100
s_waitcnt vmcnt(23)
buffer_load_dwordx4 v[140:143], v2, s[56:59], s31 offen sc1
L_ap_pb3:
s_bitcmp1_b32 s101, 4
s_cbranch_scc0 L_ap_pb4
s_add_u32 s31, s98, 9437184
s_waitcnt vmcnt(23)
buffer_load_dwordx4 v[80:83], v2, s[56:59], s31 offen sc1
s_add_u32 s31, s98, 9441280
s_waitcnt vmcnt(23)
buffer_load_dwordx4 v[112:115], v2, s[56:59], s31 offen sc1
s_add_u32 s31, s98, 9445376
s_add_u32 s31, s31, s100
s_waitcnt vmcnt(23)
buffer_load_dwordx4 v[144:147], v2, s[56:59], s31 offen sc1
L_ap_pb4:
s_bitcmp1_b32 s101, 5
s_cbranch_scc0 L_ap_pb5
s_add_u32 s31, s98, 11796480
s_waitcnt vmcnt(23)
buffer_load_dwordx4 v[84:87], v2, s[56:59], s31 offen sc1
s_add_u32 s31, s98, 11800576
s_waitcnt vmcnt(23)
buffer_load_dwordx4 v[116:119], v2, s[56:59], s31 offen sc1
s_add_u32 s31, s98, 11804672
s_add_u32 s31, s31, s100
s_waitcnt vmcnt(23)
buffer_load_dwordx4 v[148:151], v2, s[56:59], s31 offen sc1
L_ap_pb5:
s_bitcmp1_b32 s101, 6
s_cbranch_scc0 L_ap_pb6
s_add_u32 s31, s98, 14155776
s_waitcnt vmcnt(23)
buffer_load_dwordx4 v[88:91], v2, s[56:59], s31 offen sc1
s_add_u32 s31, s98, 14159872
s_waitcnt vmcnt(23)
buffer_load_dwordx4 v[120:123], v2, s[56:59], s31 offen sc1
s_add_u32 s31, s98, 14163968
s_add_u32 s31, s31, s100
s_waitcnt vmcnt(23)
buffer_load_dwordx4 v[152:155], v2, s[56:59], s31 offen sc1
L_ap_pb6:
s_bitcmp1_b32 s101, 7
s_cbranch_scc0 L_ap_pb7
s_add_u32 s31, s98, 16515072
s_waitcnt vmcnt(23)
buffer_load_dwordx4 v[92:95], v2, s[56:59], s31 offen sc1
s_add_u32 s31, s98, 16519168
s_waitcnt vmcnt(23)
buffer_load_dwordx4 v[124:127], v2, s[56:59], s31 offen sc1
s_add_u32 s31, s98, 16523264
s_add_u32 s31, s31, s100
s_waitcnt vmcnt(23)
buffer_load_dwordx4 v[156:159], v2, s[56:59], s31 offen sc1
L_ap_pb7:
s_waitcnt vmcnt(0)
v_mov_b32 v48, 0x00003f80
v_mov_b32 v49, 0x3f800000
v_dot2_f32_bf16 v176, v160, v48, 0
v_dot2_f32_bf16 v177, v160, v49, 0
v_dot2_f32_bf16 v178, v161, v48, 0
v_dot2_f32_bf16 v179, v161, v49, 0
v_dot2_f32_bf16 v180, v162, v48, 0
v_dot2_f32_bf16 v181, v162, v49, 0
v_dot2_f32_bf16 v182, v163, v48, 0
v_dot2_f32_bf16 v183, v163, v49, 0
v_dot2_f32_bf16 v176, v64, v48, v176
v_dot2_f32_bf16 v177, v64, v49, v177
v_dot2_f32_bf16 v178, v65, v48, v178
v_dot2_f32_bf16 v179, v65, v49, v179
v_dot2_f32_bf16 v180, v66, v48, v180
v_dot2_f32_bf16 v181, v66, v49, v181
v_dot2_f32_bf16 v182, v67, v48, v182
v_dot2_f32_bf16 v183, v67, v49, v183
v_dot2_f32_bf16 v176, v68, v48, v176
v_dot2_f32_bf16 v177, v68, v49, v177
v_dot2_f32_bf16 v178, v69, v48, v178
v_dot2_f32_bf16 v179, v69, v49, v179
v_dot2_f32_bf16 v180, v70, v48, v180
v_dot2_f32_bf16 v181, v70, v49, v181
v_dot2_f32_bf16 v182, v71, v48, v182
v_dot2_f32_bf16 v183, v71, v49, v183
v_dot2_f32_bf16 v176, v72, v48, v176
v_dot2_f32_bf16 v177, v72, v49, v177
v_dot2_f32_bf16 v178, v73, v48, v178
v_dot2_f32_bf16 v179, v73, v49, v179
v_dot2_f32_bf16 v180, v74, v48, v180
v_dot2_f32_bf16 v181, v74, v49, v181
v_dot2_f32_bf16 v182, v75, v48, v182
v_dot2_f32_bf16 v183, v75, v49, v183
v_dot2_f32_bf16 v176, v76, v48, v176
v_dot2_f32_bf16 v177, v76, v49, v177
v_dot2_f32_bf16 v178, v77, v48, v178
v_dot2_f32_bf16 v179, v77, v49, v179
v_dot2_f32_bf16 v180, v78, v48, v180
v_dot2_f32_bf16 v181, v78, v49, v181
v_dot2_f32_bf16 v182, v79, v48, v182
v_dot2_f32_bf16 v183, v79, v49, v183
v_dot2_f32_bf16 v176, v80, v48, v176
v_dot2_f32_bf16 v177, v80, v49, v177
v_dot2_f32_bf16 v178, v81, v48, v178
v_dot2_f32_bf16 v179, v81, v49, v179
v_dot2_f32_bf16 v180, v82, v48, v180
v_dot2_f32_bf16 v181, v82, v49, v181
v_dot2_f32_bf16 v182, v83, v48, v182
v_dot2_f32_bf16 v183, v83, v49, v183
v_dot2_f32_bf16 v176, v84, v48, v176
v_dot2_f32_bf16 v177, v84, v49, v177
v_dot2_f32_bf16 v178, v85, v48, v178
v_dot2_f32_bf16 v179, v85, v49, v179
v_dot2_f32_bf16 v180, v86, v48, v180
v_dot2_f32_bf16 v181, v86, v49, v181
v_dot2_f32_bf16 v182, v87, v48, v182
v_dot2_f32_bf16 v183, v87, v49, v183
v_dot2_f32_bf16 v176, v88, v48, v176
v_dot2_f32_bf16 v177, v88, v49, v177
v_dot2_f32_bf16 v178, v89, v48, v178
v_dot2_f32_bf16 v179, v89, v49, v179
v_dot2_f32_bf16 v180, v90, v48, v180
v_dot2_f32_bf16 v181, v90, v49, v181
v_dot2_f32_bf16 v182, v91, v48, v182
v_dot2_f32_bf16 v183, v91, v49, v183
v_dot2_f32_bf16 v176, v92, v48, v176
v_dot2_f32_bf16 v177, v92, v49, v177
v_dot2_f32_bf16 v178, v93, v48, v178
v_dot2_f32_bf16 v179, v93, v49, v179
v_dot2_f32_bf16 v180, v94, v48, v180
v_dot2_f32_bf16 v181, v94, v49, v181
v_dot2_f32_bf16 v182, v95, v48, v182
v_dot2_f32_bf16 v183, v95, v49, v183
s_nop 2
v_cvt_pk_bf16_f32 v32, v176, v177
v_cvt_pk_bf16_f32 v33, v178, v179
v_cvt_pk_bf16_f32 v34, v180, v181
v_cvt_pk_bf16_f32 v35, v182, v183
s_add_u32 s31, s99, 0
buffer_store_dwordx2 v[32:33], v17, s[88:91], s31 offen
buffer_store_dwordx2 v[34:35], v18, s[88:91], s31 offen
v_dot2_f32_bf16 v184, v164, v48, 0
v_dot2_f32_bf16 v185, v164, v49, 0
v_dot2_f32_bf16 v186, v165, v48, 0
v_dot2_f32_bf16 v187, v165, v49, 0
v_dot2_f32_bf16 v188, v166, v48, 0
v_dot2_f32_bf16 v189, v166, v49, 0
v_dot2_f32_bf16 v190, v167, v48, 0
v_dot2_f32_bf16 v191, v167, v49, 0
v_dot2_f32_bf16 v184, v96, v48, v184
v_dot2_f32_bf16 v185, v96, v49, v185
v_dot2_f32_bf16 v186, v97, v48, v186
v_dot2_f32_bf16 v187, v97, v49, v187
v_dot2_f32_bf16 v188, v98, v48, v188
v_dot2_f32_bf16 v189, v98, v49, v189
v_dot2_f32_bf16 v190, v99, v48, v190
v_dot2_f32_bf16 v191, v99, v49, v191
v_dot2_f32_bf16 v184, v100, v48, v184
v_dot2_f32_bf16 v185, v100, v49, v185
v_dot2_f32_bf16 v186, v101, v48, v186
v_dot2_f32_bf16 v187, v101, v49, v187
v_dot2_f32_bf16 v188, v102, v48, v188
v_dot2_f32_bf16 v189, v102, v49, v189
v_dot2_f32_bf16 v190, v103, v48, v190
v_dot2_f32_bf16 v191, v103, v49, v191
v_dot2_f32_bf16 v184, v104, v48, v184
v_dot2_f32_bf16 v185, v104, v49, v185
v_dot2_f32_bf16 v186, v105, v48, v186
v_dot2_f32_bf16 v187, v105, v49, v187
v_dot2_f32_bf16 v188, v106, v48, v188
v_dot2_f32_bf16 v189, v106, v49, v189
v_dot2_f32_bf16 v190, v107, v48, v190
v_dot2_f32_bf16 v191, v107, v49, v191
v_dot2_f32_bf16 v184, v108, v48, v184
v_dot2_f32_bf16 v185, v108, v49, v185
v_dot2_f32_bf16 v186, v109, v48, v186
v_dot2_f32_bf16 v187, v109, v49, v187
v_dot2_f32_bf16 v188, v110, v48, v188
v_dot2_f32_bf16 v189, v110, v49, v189
v_dot2_f32_bf16 v190, v111, v48, v190
v_dot2_f32_bf16 v191, v111, v49, v191
v_dot2_f32_bf16 v184, v112, v48, v184
v_dot2_f32_bf16 v185, v112, v49, v185
v_dot2_f32_bf16 v186, v113, v48, v186
v_dot2_f32_bf16 v187, v113, v49, v187
v_dot2_f32_bf16 v188, v114, v48, v188
v_dot2_f32_bf16 v189, v114, v49, v189
v_dot2_f32_bf16 v190, v115, v48, v190
v_dot2_f32_bf16 v191, v115, v49, v191
v_dot2_f32_bf16 v184, v116, v48, v184
v_dot2_f32_bf16 v185, v116, v49, v185
v_dot2_f32_bf16 v186, v117, v48, v186
v_dot2_f32_bf16 v187, v117, v49, v187
v_dot2_f32_bf16 v188, v118, v48, v188
v_dot2_f32_bf16 v189, v118, v49, v189
v_dot2_f32_bf16 v190, v119, v48, v190
v_dot2_f32_bf16 v191, v119, v49, v191
v_dot2_f32_bf16 v184, v120, v48, v184
v_dot2_f32_bf16 v185, v120, v49, v185
v_dot2_f32_bf16 v186, v121, v48, v186
v_dot2_f32_bf16 v187, v121, v49, v187
v_dot2_f32_bf16 v188, v122, v48, v188
v_dot2_f32_bf16 v189, v122, v49, v189
v_dot2_f32_bf16 v190, v123, v48, v190
v_dot2_f32_bf16 v191, v123, v49, v191
v_dot2_f32_bf16 v184, v124, v48, v184
v_dot2_f32_bf16 v185, v124, v49, v185
v_dot2_f32_bf16 v186, v125, v48, v186
v_dot2_f32_bf16 v187, v125, v49, v187
v_dot2_f32_bf16 v188, v126, v48, v188
v_dot2_f32_bf16 v189, v126, v49, v189
v_dot2_f32_bf16 v190, v127, v48, v190
v_dot2_f32_bf16 v191, v127, v49, v191
s_nop 2
v_cvt_pk_bf16_f32 v36, v184, v185
v_cvt_pk_bf16_f32 v37, v186, v187
v_cvt_pk_bf16_f32 v38, v188, v189
v_cvt_pk_bf16_f32 v39, v190, v191
s_add_u32 s31, s99, 128
buffer_store_dwordx2 v[36:37], v17, s[88:91], s31 offen
buffer_store_dwordx2 v[38:39], v18, s[88:91], s31 offen
v_dot2_f32_bf16 v176, v168, v48, 0
v_dot2_f32_bf16 v177, v168, v49, 0
v_dot2_f32_bf16 v178, v169, v48, 0
v_dot2_f32_bf16 v179, v169, v49, 0
v_dot2_f32_bf16 v180, v170, v48, 0
v_dot2_f32_bf16 v181, v170, v49, 0
v_dot2_f32_bf16 v182, v171, v48, 0
v_dot2_f32_bf16 v183, v171, v49, 0
v_dot2_f32_bf16 v176, v128, v48, v176
v_dot2_f32_bf16 v177, v128, v49, v177
v_dot2_f32_bf16 v178, v129, v48, v178
v_dot2_f32_bf16 v179, v129, v49, v179
v_dot2_f32_bf16 v180, v130, v48, v180
v_dot2_f32_bf16 v181, v130, v49, v181
v_dot2_f32_bf16 v182, v131, v48, v182
v_dot2_f32_bf16 v183, v131, v49, v183
v_dot2_f32_bf16 v176, v132, v48, v176
v_dot2_f32_bf16 v177, v132, v49, v177
v_dot2_f32_bf16 v178, v133, v48, v178
v_dot2_f32_bf16 v179, v133, v49, v179
v_dot2_f32_bf16 v180, v134, v48, v180
v_dot2_f32_bf16 v181, v134, v49, v181
v_dot2_f32_bf16 v182, v135, v48, v182
v_dot2_f32_bf16 v183, v135, v49, v183
v_dot2_f32_bf16 v176, v136, v48, v176
v_dot2_f32_bf16 v177, v136, v49, v177
v_dot2_f32_bf16 v178, v137, v48, v178
v_dot2_f32_bf16 v179, v137, v49, v179
v_dot2_f32_bf16 v180, v138, v48, v180
v_dot2_f32_bf16 v181, v138, v49, v181
v_dot2_f32_bf16 v182, v139, v48, v182
v_dot2_f32_bf16 v183, v139, v49, v183
v_dot2_f32_bf16 v176, v140, v48, v176
v_dot2_f32_bf16 v177, v140, v49, v177
v_dot2_f32_bf16 v178, v141, v48, v178
v_dot2_f32_bf16 v179, v141, v49, v179
v_dot2_f32_bf16 v180, v142, v48, v180
v_dot2_f32_bf16 v181, v142, v49, v181
v_dot2_f32_bf16 v182, v143, v48, v182
v_dot2_f32_bf16 v183, v143, v49, v183
v_dot2_f32_bf16 v176, v144, v48, v176
v_dot2_f32_bf16 v177, v144, v49, v177
v_dot2_f32_bf16 v178, v145, v48, v178
v_dot2_f32_bf16 v179, v145, v49, v179
v_dot2_f32_bf16 v180, v146, v48, v180
v_dot2_f32_bf16 v181, v146, v49, v181
v_dot2_f32_bf16 v182, v147, v48, v182
v_dot2_f32_bf16 v183, v147, v49, v183
v_dot2_f32_bf16 v176, v148, v48, v176
v_dot2_f32_bf16 v177, v148, v49, v177
v_dot2_f32_bf16 v178, v149, v48, v178
v_dot2_f32_bf16 v179, v149, v49, v179
v_dot2_f32_bf16 v180, v150, v48, v180
v_dot2_f32_bf16 v181, v150, v49, v181
v_dot2_f32_bf16 v182, v151, v48, v182
v_dot2_f32_bf16 v183, v151, v49, v183
v_dot2_f32_bf16 v176, v152, v48, v176
v_dot2_f32_bf16 v177, v152, v49, v177
v_dot2_f32_bf16 v178, v153, v48, v178
v_dot2_f32_bf16 v179, v153, v49, v179
v_dot2_f32_bf16 v180, v154, v48, v180
v_dot2_f32_bf16 v181, v154, v49, v181
v_dot2_f32_bf16 v182, v155, v48, v182
v_dot2_f32_bf16 v183, v155, v49, v183
v_dot2_f32_bf16 v176, v156, v48, v176
v_dot2_f32_bf16 v177, v156, v49, v177
v_dot2_f32_bf16 v178, v157, v48, v178
v_dot2_f32_bf16 v179, v157, v49, v179
v_dot2_f32_bf16 v180, v158, v48, v180
v_dot2_f32_bf16 v181, v158, v49, v181
v_dot2_f32_bf16 v182, v159, v48, v182
v_dot2_f32_bf16 v183, v159, v49, v183
s_nop 2
v_cvt_pk_bf16_f32 v40, v176, v177
v_cvt_pk_bf16_f32 v41, v178, v179
v_cvt_pk_bf16_f32 v42, v180, v181
v_cvt_pk_bf16_f32 v43, v182, v183
s_add_u32 s31, s99, 256
s_add_u32 s31, s31, s100
buffer_store_dwordx2 v[40:41], v17, s[88:91], s31 offen
buffer_store_dwordx2 v[42:43], v18, s[88:91], s31 offen
s_lshl_b32 s27, 1, s36
s_andn2_b32 s78, s78, s27
s_cmp_eq_u32 s78, 0
s_cbranch_scc1 L_ap_exit
s_mov_b32 s79, 0
L_ap_share:
s_lshr_b32 s27, s78, s79
s_bitcmp1_b32 s27, 0
s_cbranch_scc0 L_ap_nextshare
s_lshl_b32 s27, s37, 3
s_add_u32 s27, s27, s79
s_mul_i32 s98, s27, 36
s_mul_i32 s29, s38, 9
s_add_u32 s98, s98, s29
s_add_u32 s98, s98, s20
s_lshl_b32 s98, s98, 10
s_mul_i32 s99, s27, 36864
s_add_u32 s29, s29, s20
s_lshl_b32 s29, s29, 5
s_add_u32 s99, s99, s29
s_cmp_eq_u32 s20, 0
s_cselect_b32 s100, 0, 0x40000000
s_add_u32 s31, s98, 0
buffer_load_dwordx4 v[64:67], v2, s[56:59], s31 offen sc1
s_add_u32 s31, s98, 4096
buffer_load_dwordx4 v[96:99], v2, s[56:59], s31 offen sc1
s_add_u32 s31, s98, 8192
s_add_u32 s31, s31, s100
buffer_load_dwordx4 v[128:131], v2, s[56:59], s31 offen sc1
s_add_u32 s31, s98, 2359296
buffer_load_dwordx4 v[68:71], v2, s[56:59], s31 offen sc1
s_add_u32 s31, s98, 2363392
buffer_load_dwordx4 v[100:103], v2, s[56:59], s31 offen sc1
s_add_u32 s31, s98, 2367488
s_add_u32 s31, s31, s100
buffer_load_dwordx4 v[132:135], v2, s[56:59], s31 offen sc1
s_add_u32 s31, s98, 4718592
buffer_load_dwordx4 v[72:75], v2, s[56:59], s31 offen sc1
s_add_u32 s31, s98, 4722688
buffer_load_dwordx4 v[104:107], v2, s[56:59], s31 offen sc1
s_add_u32 s31, s98, 4726784
s_add_u32 s31, s31, s100
buffer_load_dwordx4 v[136:139], v2, s[56:59], s31 offen sc1
s_add_u32 s31, s98, 7077888
buffer_load_dwordx4 v[76:79], v2, s[56:59], s31 offen sc1
s_add_u32 s31, s98, 7081984
buffer_load_dwordx4 v[108:111], v2, s[56:59], s31 offen sc1
s_add_u32 s31, s98, 7086080
s_add_u32 s31, s31, s100
buffer_load_dwordx4 v[140:143], v2, s[56:59], s31 offen sc1
s_add_u32 s31, s98, 9437184
buffer_load_dwordx4 v[80:83], v2, s[56:59], s31 offen sc1
s_add_u32 s31, s98, 9441280
buffer_load_dwordx4 v[112:115], v2, s[56:59], s31 offen sc1
s_add_u32 s31, s98, 9445376
s_add_u32 s31, s31, s100
buffer_load_dwordx4 v[144:147], v2, s[56:59], s31 offen sc1
s_add_u32 s31, s98, 11796480
buffer_load_dwordx4 v[84:87], v2, s[56:59], s31 offen sc1
s_add_u32 s31, s98, 11800576
buffer_load_dwordx4 v[116:119], v2, s[56:59], s31 offen sc1
s_add_u32 s31, s98, 11804672
s_add_u32 s31, s31, s100
buffer_load_dwordx4 v[148:151], v2, s[56:59], s31 offen sc1
s_add_u32 s31, s98, 14155776
buffer_load_dwordx4 v[88:91], v2, s[56:59], s31 offen sc1
s_add_u32 s31, s98, 14159872
buffer_load_dwordx4 v[120:123], v2, s[56:59], s31 offen sc1
s_add_u32 s31, s98, 14163968
s_add_u32 s31, s31, s100
buffer_load_dwordx4 v[152:155], v2, s[56:59], s31 offen sc1
s_add_u32 s31, s98, 16515072
buffer_load_dwordx4 v[92:95], v2, s[56:59], s31 offen sc1
s_add_u32 s31, s98, 16519168
buffer_load_dwordx4 v[124:127], v2, s[56:59], s31 offen sc1
s_add_u32 s31, s98, 16523264
s_add_u32 s31, s31, s100
buffer_load_dwordx4 v[156:159], v2, s[56:59], s31 offen sc1
s_add_u32 s31, s99, 0
buffer_load_dwordx2 v[160:161], v17, s[92:95], s31 offen
buffer_load_dwordx2 v[162:163], v18, s[92:95], s31 offen
s_add_u32 s31, s99, 128
buffer_load_dwordx2 v[164:165], v17, s[92:95], s31 offen
buffer_load_dwordx2 v[166:167], v18, s[92:95], s31 offen
s_add_u32 s31, s99, 256
s_add_u32 s31, s31, s100
buffer_load_dwordx2 v[168:169], v17, s[92:95], s31 offen
buffer_load_dwordx2 v[170:171], v18, s[92:95], s31 offen
s_waitcnt vmcnt(0)
v_mov_b32 v48, 0x00003f80
v_mov_b32 v49, 0x3f800000
v_dot2_f32_bf16 v176, v160, v48, 0
v_dot2_f32_bf16 v177, v160, v49, 0
v_dot2_f32_bf16 v178, v161, v48, 0
v_dot2_f32_bf16 v179, v161, v49, 0
v_dot2_f32_bf16 v180, v162, v48, 0
v_dot2_f32_bf16 v181, v162, v49, 0
v_dot2_f32_bf16 v182, v163, v48, 0
v_dot2_f32_bf16 v183, v163, v49, 0
v_dot2_f32_bf16 v176, v64, v48, v176
v_dot2_f32_bf16 v177, v64, v49, v177
v_dot2_f32_bf16 v178, v65, v48, v178
v_dot2_f32_bf16 v179, v65, v49, v179
v_dot2_f32_bf16 v180, v66, v48, v180
v_dot2_f32_bf16 v181, v66, v49, v181
v_dot2_f32_bf16 v182, v67, v48, v182
v_dot2_f32_bf16 v183, v67, v49, v183
v_dot2_f32_bf16 v176, v68, v48, v176
v_dot2_f32_bf16 v177, v68, v49, v177
v_dot2_f32_bf16 v178, v69, v48, v178
v_dot2_f32_bf16 v179, v69, v49, v179
v_dot2_f32_bf16 v180, v70, v48, v180
v_dot2_f32_bf16 v181, v70, v49, v181
v_dot2_f32_bf16 v182, v71, v48, v182
v_dot2_f32_bf16 v183, v71, v49, v183
v_dot2_f32_bf16 v176, v72, v48, v176
v_dot2_f32_bf16 v177, v72, v49, v177
v_dot2_f32_bf16 v178, v73, v48, v178
v_dot2_f32_bf16 v179, v73, v49, v179
v_dot2_f32_bf16 v180, v74, v48, v180
v_dot2_f32_bf16 v181, v74, v49, v181
v_dot2_f32_bf16 v182, v75, v48, v182
v_dot2_f32_bf16 v183, v75, v49, v183
v_dot2_f32_bf16 v176, v76, v48, v176
v_dot2_f32_bf16 v177, v76, v49, v177
v_dot2_f32_bf16 v178, v77, v48, v178
v_dot2_f32_bf16 v179, v77, v49, v179
v_dot2_f32_bf16 v180, v78, v48, v180
v_dot2_f32_bf16 v181, v78, v49, v181
v_dot2_f32_bf16 v182, v79, v48, v182
v_dot2_f32_bf16 v183, v79, v49, v183
v_dot2_f32_bf16 v176, v80, v48, v176
v_dot2_f32_bf16 v177, v80, v49, v177
v_dot2_f32_bf16 v178, v81, v48, v178
v_dot2_f32_bf16 v179, v81, v49, v179
v_dot2_f32_bf16 v180, v82, v48, v180
v_dot2_f32_bf16 v181, v82, v49, v181
v_dot2_f32_bf16 v182, v83, v48, v182
v_dot2_f32_bf16 v183, v83, v49, v183
v_dot2_f32_bf16 v176, v84, v48, v176
v_dot2_f32_bf16 v177, v84, v49, v177
v_dot2_f32_bf16 v178, v85, v48, v178
v_dot2_f32_bf16 v179, v85, v49, v179
v_dot2_f32_bf16 v180, v86, v48, v180
v_dot2_f32_bf16 v181, v86, v49, v181
v_dot2_f32_bf16 v182, v87, v48, v182
v_dot2_f32_bf16 v183, v87, v49, v183
v_dot2_f32_bf16 v176, v88, v48, v176
v_dot2_f32_bf16 v177, v88, v49, v177
v_dot2_f32_bf16 v178, v89, v48, v178
v_dot2_f32_bf16 v179, v89, v49, v179
v_dot2_f32_bf16 v180, v90, v48, v180
v_dot2_f32_bf16 v181, v90, v49, v181
v_dot2_f32_bf16 v182, v91, v48, v182
v_dot2_f32_bf16 v183, v91, v49, v183
v_dot2_f32_bf16 v176, v92, v48, v176
v_dot2_f32_bf16 v177, v92, v49, v177
v_dot2_f32_bf16 v178, v93, v48, v178
v_dot2_f32_bf16 v179, v93, v49, v179
v_dot2_f32_bf16 v180, v94, v48, v180
v_dot2_f32_bf16 v181, v94, v49, v181
v_dot2_f32_bf16 v182, v95, v48, v182
v_dot2_f32_bf16 v183, v95, v49, v183
s_nop 2
v_cvt_pk_bf16_f32 v32, v176, v177
v_cvt_pk_bf16_f32 v33, v178, v179
v_cvt_pk_bf16_f32 v34, v180, v181
v_cvt_pk_bf16_f32 v35, v182, v183
s_add_u32 s31, s99, 0
buffer_store_dwordx2 v[32:33], v17, s[88:91], s31 offen
buffer_store_dwordx2 v[34:35], v18, s[88:91], s31 offen
v_dot2_f32_bf16 v184, v164, v48, 0
v_dot2_f32_bf16 v185, v164, v49, 0
v_dot2_f32_bf16 v186, v165, v48, 0
v_dot2_f32_bf16 v187, v165, v49, 0
v_dot2_f32_bf16 v188, v166, v48, 0
v_dot2_f32_bf16 v189, v166, v49, 0
v_dot2_f32_bf16 v190, v167, v48, 0
v_dot2_f32_bf16 v191, v167, v49, 0
v_dot2_f32_bf16 v184, v96, v48, v184
v_dot2_f32_bf16 v185, v96, v49, v185
v_dot2_f32_bf16 v186, v97, v48, v186
v_dot2_f32_bf16 v187, v97, v49, v187
v_dot2_f32_bf16 v188, v98, v48, v188
v_dot2_f32_bf16 v189, v98, v49, v189
v_dot2_f32_bf16 v190, v99, v48, v190
v_dot2_f32_bf16 v191, v99, v49, v191
v_dot2_f32_bf16 v184, v100, v48, v184
v_dot2_f32_bf16 v185, v100, v49, v185
v_dot2_f32_bf16 v186, v101, v48, v186
v_dot2_f32_bf16 v187, v101, v49, v187
v_dot2_f32_bf16 v188, v102, v48, v188
v_dot2_f32_bf16 v189, v102, v49, v189
v_dot2_f32_bf16 v190, v103, v48, v190
v_dot2_f32_bf16 v191, v103, v49, v191
v_dot2_f32_bf16 v184, v104, v48, v184
v_dot2_f32_bf16 v185, v104, v49, v185
v_dot2_f32_bf16 v186, v105, v48, v186
v_dot2_f32_bf16 v187, v105, v49, v187
v_dot2_f32_bf16 v188, v106, v48, v188
v_dot2_f32_bf16 v189, v106, v49, v189
v_dot2_f32_bf16 v190, v107, v48, v190
v_dot2_f32_bf16 v191, v107, v49, v191
v_dot2_f32_bf16 v184, v108, v48, v184
v_dot2_f32_bf16 v185, v108, v49, v185
v_dot2_f32_bf16 v186, v109, v48, v186
v_dot2_f32_bf16 v187, v109, v49, v187
v_dot2_f32_bf16 v188, v110, v48, v188
v_dot2_f32_bf16 v189, v110, v49, v189
v_dot2_f32_bf16 v190, v111, v48, v190
v_dot2_f32_bf16 v191, v111, v49, v191
v_dot2_f32_bf16 v184, v112, v48, v184
v_dot2_f32_bf16 v185, v112, v49, v185
v_dot2_f32_bf16 v186, v113, v48, v186
v_dot2_f32_bf16 v187, v113, v49, v187
v_dot2_f32_bf16 v188, v114, v48, v188
v_dot2_f32_bf16 v189, v114, v49, v189
v_dot2_f32_bf16 v190, v115, v48, v190
v_dot2_f32_bf16 v191, v115, v49, v191
v_dot2_f32_bf16 v184, v116, v48, v184
v_dot2_f32_bf16 v185, v116, v49, v185
v_dot2_f32_bf16 v186, v117, v48, v186
v_dot2_f32_bf16 v187, v117, v49, v187
v_dot2_f32_bf16 v188, v118, v48, v188
v_dot2_f32_bf16 v189, v118, v49, v189
v_dot2_f32_bf16 v190, v119, v48, v190
v_dot2_f32_bf16 v191, v119, v49, v191
v_dot2_f32_bf16 v184, v120, v48, v184
v_dot2_f32_bf16 v185, v120, v49, v185
v_dot2_f32_bf16 v186, v121, v48, v186
v_dot2_f32_bf16 v187, v121, v49, v187
v_dot2_f32_bf16 v188, v122, v48, v188
v_dot2_f32_bf16 v189, v122, v49, v189
v_dot2_f32_bf16 v190, v123, v48, v190
v_dot2_f32_bf16 v191, v123, v49, v191
v_dot2_f32_bf16 v184, v124, v48, v184
v_dot2_f32_bf16 v185, v124, v49, v185
v_dot2_f32_bf16 v186, v125, v48, v186
v_dot2_f32_bf16 v187, v125, v49, v187
v_dot2_f32_bf16 v188, v126, v48, v188
v_dot2_f32_bf16 v189, v126, v49, v189
v_dot2_f32_bf16 v190, v127, v48, v190
v_dot2_f32_bf16 v191, v127, v49, v191
s_nop 2
v_cvt_pk_bf16_f32 v36, v184, v185
v_cvt_pk_bf16_f32 v37, v186, v187
v_cvt_pk_bf16_f32 v38, v188, v189
v_cvt_pk_bf16_f32 v39, v190, v191
s_add_u32 s31, s99, 128
buffer_store_dwordx2 v[36:37], v17, s[88:91], s31 offen
buffer_store_dwordx2 v[38:39], v18, s[88:91], s31 offen
v_dot2_f32_bf16 v176, v168, v48, 0
v_dot2_f32_bf16 v177, v168, v49, 0
v_dot2_f32_bf16 v178, v169, v48, 0
v_dot2_f32_bf16 v179, v169, v49, 0
v_dot2_f32_bf16 v180, v170, v48, 0
v_dot2_f32_bf16 v181, v170, v49, 0
v_dot2_f32_bf16 v182, v171, v48, 0
v_dot2_f32_bf16 v183, v171, v49, 0
v_dot2_f32_bf16 v176, v128, v48, v176
v_dot2_f32_bf16 v177, v128, v49, v177
v_dot2_f32_bf16 v178, v129, v48, v178
v_dot2_f32_bf16 v179, v129, v49, v179
v_dot2_f32_bf16 v180, v130, v48, v180
v_dot2_f32_bf16 v181, v130, v49, v181
v_dot2_f32_bf16 v182, v131, v48, v182
v_dot2_f32_bf16 v183, v131, v49, v183
v_dot2_f32_bf16 v176, v132, v48, v176
v_dot2_f32_bf16 v177, v132, v49, v177
v_dot2_f32_bf16 v178, v133, v48, v178
v_dot2_f32_bf16 v179, v133, v49, v179
v_dot2_f32_bf16 v180, v134, v48, v180
v_dot2_f32_bf16 v181, v134, v49, v181
v_dot2_f32_bf16 v182, v135, v48, v182
v_dot2_f32_bf16 v183, v135, v49, v183
v_dot2_f32_bf16 v176, v136, v48, v176
v_dot2_f32_bf16 v177, v136, v49, v177
v_dot2_f32_bf16 v178, v137, v48, v178
v_dot2_f32_bf16 v179, v137, v49, v179
v_dot2_f32_bf16 v180, v138, v48, v180
v_dot2_f32_bf16 v181, v138, v49, v181
v_dot2_f32_bf16 v182, v139, v48, v182
v_dot2_f32_bf16 v183, v139, v49, v183
v_dot2_f32_bf16 v176, v140, v48, v176
v_dot2_f32_bf16 v177, v140, v49, v177
v_dot2_f32_bf16 v178, v141, v48, v178
v_dot2_f32_bf16 v179, v141, v49, v179
v_dot2_f32_bf16 v180, v142, v48, v180
v_dot2_f32_bf16 v181, v142, v49, v181
v_dot2_f32_bf16 v182, v143, v48, v182
v_dot2_f32_bf16 v183, v143, v49, v183
v_dot2_f32_bf16 v176, v144, v48, v176
v_dot2_f32_bf16 v177, v144, v49, v177
v_dot2_f32_bf16 v178, v145, v48, v178
v_dot2_f32_bf16 v179, v145, v49, v179
v_dot2_f32_bf16 v180, v146, v48, v180
v_dot2_f32_bf16 v181, v146, v49, v181
v_dot2_f32_bf16 v182, v147, v48, v182
v_dot2_f32_bf16 v183, v147, v49, v183
v_dot2_f32_bf16 v176, v148, v48, v176
v_dot2_f32_bf16 v177, v148, v49, v177
v_dot2_f32_bf16 v178, v149, v48, v178
v_dot2_f32_bf16 v179, v149, v49, v179
v_dot2_f32_bf16 v180, v150, v48, v180
v_dot2_f32_bf16 v181, v150, v49, v181
v_dot2_f32_bf16 v182, v151, v48, v182
v_dot2_f32_bf16 v183, v151, v49, v183
v_dot2_f32_bf16 v176, v152, v48, v176
v_dot2_f32_bf16 v177, v152, v49, v177
v_dot2_f32_bf16 v178, v153, v48, v178
v_dot2_f32_bf16 v179, v153, v49, v179
v_dot2_f32_bf16 v180, v154, v48, v180
v_dot2_f32_bf16 v181, v154, v49, v181
v_dot2_f32_bf16 v182, v155, v48, v182
v_dot2_f32_bf16 v183, v155, v49, v183
v_dot2_f32_bf16 v176, v156, v48, v176
v_dot2_f32_bf16 v177, v156, v49, v177
v_dot2_f32_bf16 v178, v157, v48, v178
v_dot2_f32_bf16 v179, v157, v49, v179
v_dot2_f32_bf16 v180, v158, v48, v180
v_dot2_f32_bf16 v181, v158, v49, v181
v_dot2_f32_bf16 v182, v159, v48, v182
v_dot2_f32_bf16 v183, v159, v49, v183
s_nop 2
v_cvt_pk_bf16_f32 v40, v176, v177
v_cvt_pk_bf16_f32 v41, v178, v179
v_cvt_pk_bf16_f32 v42, v180, v181
v_cvt_pk_bf16_f32 v43, v182, v183
s_add_u32 s31, s99, 256
s_add_u32 s31, s31, s100
buffer_store_dwordx2 v[40:41], v17, s[88:91], s31 offen
buffer_store_dwordx2 v[42:43], v18, s[88:91], s31 offen
L_ap_nextshare:
s_add_u32 s79, s79, 1
s_cmp_lt_u32 s79, 8
s_cbranch_scc1 L_ap_share
L_ap_exit:
s_endpgm
L_ap_end:
s_endpgm
L_ap_spin4:
s_mov_b32 s77, 0
L_ap_spinl4:
buffer_load_dword v24, v23, s[72:75], 0 offen sc1
s_waitcnt vmcnt(0)
v_readfirstlane_b32 s76, v24
s_nop 3
s_cmp_ge_u32 s76, 8
s_cbranch_scc1 L_ap_ret4
s_sleep 2
s_add_u32 s77, s77, 1
s_cmp_lt_u32 s77, 20000
s_cbranch_scc1 L_ap_spinl4
s_branch L_ap_ret4
L_ap_spin5:
s_mov_b32 s77, 0
L_ap_spinl5:
buffer_load_dword v24, v23, s[72:75], 0 offen sc1
s_waitcnt vmcnt(0)
v_readfirstlane_b32 s76, v24
s_nop 3
s_cmp_ge_u32 s76, 8
s_cbranch_scc1 L_ap_ret5
s_sleep 2
s_add_u32 s77, s77, 1
s_cmp_lt_u32 s77, 20000
s_cbranch_scc1 L_ap_spinl5
s_branch L_ap_ret5
L_att_Fm0:
v_mfma_f32_16x16x32_bf16 v[64:67], a[208:211], a[144:147], v[192:195]
ds_read_b128 a[240:243], v3 offset:16384
v_add_f32 v208, v224, v200
v_mfma_f32_16x16x32_bf16 v[64:67], a[212:215], a[148:151], v[64:67]
v_add_f32 v209, v225, v200
v_add_f32 v210, v226, v200
v_mfma_f32_16x16x32_bf16 v[64:67], a[216:219], a[152:155], v[64:67]
s_mov_b32 m0, s25
s_mov_b32 s26, s24
buffer_load_dwordx4 v2, s[40:43], s26 offen lds
v_mfma_f32_16x16x32_bf16 v[64:67], a[220:223], a[156:159], v[64:67]
ds_read_b128 a[244:247], v3 offset:17408
v_add_f32 v211, v227, v200
v_mfma_f32_16x16x32_bf16 v[68:71], a[208:211], a[160:163], v[196:199]
v_add_f32 v212, v228, v200
v_mfma_f32_16x16x32_bf16 v[68:71], a[212:215], a[164:167], v[68:71]
v_add_f32 v213, v229, v200
v_mfma_f32_16x16x32_bf16 v[68:71], a[216:219], a[168:171], v[68:71]
buffer_load_dwordx4 v2, s[40:43], s26 offen offset:1024 lds
v_add_f32 v214, v230, v200
v_mfma_f32_16x16x32_bf16 v[68:71], a[220:223], a[172:175], v[68:71]
ds_read_b128 a[248:251], v3 offset:18432
v_add_f32 v215, v231, v200
v_mfma_f32_16x16x32_bf16 v[72:75], a[208:211], a[176:179], v[208:211]
v_add_f32 v216, v232, v200
v_mfma_f32_16x16x32_bf16 v[72:75], a[212:215], a[180:183], v[72:75]
v_add_f32 v217, v233, v200
v_mfma_f32_16x16x32_bf16 v[72:75], a[216:219], a[184:187], v[72:75]
v_add_f32 v218, v234, v200
v_mfma_f32_16x16x32_bf16 v[72:75], a[220:223], a[188:191], v[72:75]
ds_read_b128 a[252:255], v3 offset:19456
v_add_f32 v219, v235, v200
v_mfma_f32_16x16x32_bf16 v[76:79], a[208:211], a[192:195], v[204:207]
buffer_load_dwordx4 v2, s[40:43], s26 offen offset:2048 lds
v_add_f32 v220, v236, v200
v_mfma_f32_16x16x32_bf16 v[76:79], a[212:215], a[196:199], v[76:79]
v_exp_f32 v64, v64
v_mfma_f32_16x16x32_bf16 v[76:79], a[216:219], a[200:203], v[76:79]
v_exp_f32 v65, v65
v_mfma_f32_16x16x32_bf16 v[76:79], a[220:223], a[204:207], v[76:79]
s_waitcnt lgkmcnt(4)
v_exp_f32 v66, v66
v_exp_f32 v67, v67
v_mfma_f32_16x16x32_bf16 v[80:83], a[224:227], a[144:147], v[192:195]
ds_read_b128 v[240:243], v3 offset:20480
v_cvt_pk_bf16_f32 v128, v64, v65
v_cvt_pk_bf16_f32 v129, v66, v67
v_mfma_f32_16x16x32_bf16 v[80:83], a[228:231], a[148:151], v[80:83]
buffer_load_dwordx4 v2, s[40:43], s26 offen offset:3072 lds
v_add_f32 v221, v237, v200
v_mfma_f32_16x16x32_bf16 v[80:83], a[232:235], a[152:155], v[80:83]
v_exp_f32 v68, v68
v_mfma_f32_16x16x32_bf16 v[80:83], a[236:239], a[156:159], v[80:83]
ds_read_b128 v[244:247], v3 offset:21504
v_exp_f32 v69, v69
v_mfma_f32_16x16x32_bf16 v[84:87], a[224:227], a[160:163], v[196:199]
v_exp_f32 v70, v70
v_exp_f32 v71, v71
v_mfma_f32_16x16x32_bf16 v[84:87], a[228:231], a[164:167], v[84:87]
v_cvt_pk_bf16_f32 v136, v68, v69
v_cvt_pk_bf16_f32 v137, v70, v71
v_mfma_f32_16x16x32_bf16 v[84:87], a[232:235], a[168:171], v[84:87]
s_add_u32 m0, m0, 4096
s_add_u32 s26, s26, 4096
buffer_load_dwordx4 v2, s[40:43], s26 offen lds
v_mfma_f32_16x16x32_bf16 v[84:87], a[236:239], a[172:175], v[84:87]
ds_read_b128 v[248:251], v3 offset:22528
v_exp_f32 v72, v72
v_mfma_f32_16x16x32_bf16 v[88:91], a[224:227], a[176:179], v[212:215]
v_exp_f32 v73, v73
v_exp_f32 v74, v74
v_mfma_f32_16x16x32_bf16 v[88:91], a[228:231], a[180:183], v[88:91]
buffer_load_dwordx4 v2, s[40:43], s26 offen offset:1024 lds
v_exp_f32 v75, v75
v_mfma_f32_16x16x32_bf16 v[88:91], a[232:235], a[184:187], v[88:91]
v_cvt_pk_bf16_f32 v144, v72, v73
v_cvt_pk_bf16_f32 v145, v74, v75
v_mfma_f32_16x16x32_bf16 v[88:91], a[236:239], a[188:191], v[88:91]
ds_read_b128 v[252:255], v3 offset:23552
v_exp_f32 v76, v76
v_mfma_f32_16x16x32_bf16 v[92:95], a[224:227], a[192:195], v[204:207]
v_exp_f32 v77, v77
v_exp_f32 v78, v78
v_mfma_f32_16x16x32_bf16 v[92:95], a[228:231], a[196:199], v[92:95]
v_exp_f32 v79, v79
v_cvt_pk_bf16_f32 v152, v76, v77
v_mfma_f32_16x16x32_bf16 v[92:95], a[232:235], a[200:203], v[92:95]
buffer_load_dwordx4 v2, s[40:43], s26 offen offset:2048 lds
v_cvt_pk_bf16_f32 v153, v78, v79
v_mfma_f32_16x16x32_bf16 v[92:95], a[236:239], a[204:207], v[92:95]
s_waitcnt lgkmcnt(4)
v_exp_f32 v80, v80
v_exp_f32 v81, v81
v_mfma_f32_16x16x32_bf16 v[96:99], a[240:243], a[144:147], v[192:195]
v_exp_f32 v82, v82
v_exp_f32 v83, v83
v_mfma_f32_16x16x32_bf16 v[96:99], a[244:247], a[148:151], v[96:99]
v_cvt_pk_bf16_f32 v130, v80, v81
v_cvt_pk_bf16_f32 v131, v82, v83
v_mfma_f32_16x16x32_bf16 v[96:99], a[248:251], a[152:155], v[96:99]
v_exp_f32 v84, v84
v_mfma_f32_16x16x32_bf16 v[96:99], a[252:255], a[156:159], v[96:99]
buffer_load_dwordx4 v2, s[40:43], s26 offen offset:3072 lds
s_add_u32 s24, s24, 32768
s_add_u32 s25, s25, 32768
s_and_b32 s25, s25, 0x1ffff
v_exp_f32 v85, v85
v_mfma_f32_16x16x32_bf16 v[100:103], a[240:243], a[160:163], v[196:199]
v_exp_f32 v86, v86
v_exp_f32 v87, v87
v_mfma_f32_16x16x32_bf16 v[100:103], a[244:247], a[164:167], v[100:103]
v_cvt_pk_bf16_f32 v138, v84, v85
v_cvt_pk_bf16_f32 v139, v86, v87
v_mfma_f32_16x16x32_bf16 v[100:103], a[248:251], a[168:171], v[100:103]
v_exp_f32 v88, v88
v_mfma_f32_16x16x32_bf16 v[100:103], a[252:255], a[172:175], v[100:103]
v_exp_f32 v89, v89
v_exp_f32 v90, v90
v_mfma_f32_16x16x32_bf16 v[104:107], a[240:243], a[176:179], v[216:219]
v_exp_f32 v91, v91
v_cvt_pk_bf16_f32 v146, v88, v89
v_mfma_f32_16x16x32_bf16 v[104:107], a[244:247], a[180:183], v[104:107]
v_cvt_pk_bf16_f32 v147, v90, v91
v_mfma_f32_16x16x32_bf16 v[104:107], a[248:251], a[184:187], v[104:107]
v_exp_f32 v92, v92
v_mfma_f32_16x16x32_bf16 v[104:107], a[252:255], a[188:191], v[104:107]
v_exp_f32 v93, v93
v_exp_f32 v94, v94
v_mfma_f32_16x16x32_bf16 v[108:111], a[240:243], a[192:195], v[204:207]
v_exp_f32 v95, v95
v_cvt_pk_bf16_f32 v154, v92, v93
v_mfma_f32_16x16x32_bf16 v[108:111], a[244:247], a[196:199], v[108:111]
v_cvt_pk_bf16_f32 v155, v94, v95
v_add_f32 v222, v238, v200
v_mfma_f32_16x16x32_bf16 v[108:111], a[248:251], a[200:203], v[108:111]
v_exp_f32 v96, v96
v_mfma_f32_16x16x32_bf16 v[108:111], a[252:255], a[204:207], v[108:111]
s_waitcnt lgkmcnt(0)
v_exp_f32 v97, v97
v_exp_f32 v98, v98
v_mfma_f32_16x16x32_bf16 v[112:115], v[240:243], a[144:147], v[192:195]
s_waitcnt vmcnt(9)
s_barrier
v_exp_f32 v99, v99
v_cvt_pk_bf16_f32 v132, v96, v97
v_mfma_f32_16x16x32_bf16 v[112:115], v[244:247], a[148:151], v[112:115]
ds_read_b128 a[208:211], v3 offset:32768
v_cvt_pk_bf16_f32 v133, v98, v99
v_mfma_f32_16x16x32_bf16 v[112:115], v[248:251], a[152:155], v[112:115]
ds_read_b128 a[212:215], v3 offset:33792
v_add_f32 v223, v239, v200
v_mfma_f32_16x16x32_bf16 v[112:115], v[252:255], a[156:159], v[112:115]
v_exp_f32 v100, v100
v_exp_f32 v101, v101
v_mfma_f32_16x16x32_bf16 v[116:119], v[240:243], a[160:163], v[196:199]
ds_read_b128 a[216:219], v3 offset:34816
v_exp_f32 v102, v102
v_mfma_f32_16x16x32_bf16 v[116:119], v[244:247], a[164:167], v[116:119]
ds_read_b128 a[220:223], v3 offset:35840
v_exp_f32 v103, v103
v_mfma_f32_16x16x32_bf16 v[116:119], v[248:251], a[168:171], v[116:119]
v_cvt_pk_bf16_f32 v140, v100, v101
v_cvt_pk_bf16_f32 v141, v102, v103
v_mfma_f32_16x16x32_bf16 v[116:119], v[252:255], a[172:175], v[116:119]
ds_read_b128 a[224:227], v3 offset:36864
v_exp_f32 v104, v104
v_mfma_f32_16x16x32_bf16 v[120:123], v[240:243], a[176:179], v[220:223]
v_exp_f32 v105, v105
v_exp_f32 v106, v106
v_mfma_f32_16x16x32_bf16 v[120:123], v[244:247], a[180:183], v[120:123]
ds_read_b128 a[228:231], v3 offset:37888
v_exp_f32 v107, v107
v_mfma_f32_16x16x32_bf16 v[120:123], v[248:251], a[184:187], v[120:123]
ds_read_b128 a[232:235], v3 offset:38912
v_cvt_pk_bf16_f32 v148, v104, v105
v_cvt_pk_bf16_f32 v149, v106, v107
v_mfma_f32_16x16x32_bf16 v[120:123], v[252:255], a[188:191], v[120:123]
v_exp_f32 v108, v108
v_exp_f32 v109, v109
v_mfma_f32_16x16x32_bf16 v[124:127], v[240:243], a[192:195], v[204:207]
ds_read_b128 a[236:239], v3 offset:39936
v_exp_f32 v110, v110
v_mfma_f32_16x16x32_bf16 v[124:127], v[244:247], a[196:199], v[124:127]
v_exp_f32 v111, v111
v_cvt_pk_bf16_f32 v156, v108, v109
v_mfma_f32_16x16x32_bf16 v[124:127], v[248:251], a[200:203], v[124:127]
v_cvt_pk_bf16_f32 v157, v110, v111
v_mfma_f32_16x16x32_bf16 v[124:127], v[252:255], a[204:207], v[124:127]
v_exp_f32 v112, v112
v_exp_f32 v113, v113
v_exp_f32 v114, v114
v_exp_f32 v115, v115
v_cvt_pk_bf16_f32 v134, v112, v113
v_cvt_pk_bf16_f32 v135, v114, v115
v_exp_f32 v116, v116
v_exp_f32 v117, v117
v_exp_f32 v118, v118
v_exp_f32 v119, v119
v_cvt_pk_bf16_f32 v142, v116, v117
v_cvt_pk_bf16_f32 v143, v118, v119
s_branch L_att_DDm1
L_att_SDm0:
v_add_f32 v208, v224, v192
v_add_f32 v209, v225, v192
v_add_f32 v210, v226, v192
v_add_f32 v211, v227, v192
s_nop 1
s_waitcnt lgkmcnt(4)
v_mfma_f32_16x16x32_bf16 v[64:67], a[208:211], a[144:147], v[208:211]
ds_read_b128 a[240:243], v3 offset:16384
v_add_f32 v212, v228, v192
v_mfma_f32_16x16x32_bf16 v[64:67], a[212:215], a[148:151], v[64:67]
ds_read_b128 a[244:247], v3 offset:17408
v_add_f32 v213, v229, v192
v_mfma_f32_16x16x32_bf16 v[64:67], a[216:219], a[152:155], v[64:67]
s_mov_b32 m0, s25
s_mov_b32 s26, s24
buffer_load_dwordx4 v2, s[40:43], s26 offen lds
v_mfma_f32_16x16x32_bf16 v[64:67], a[220:223], a[156:159], v[64:67]
ds_read_b128 a[248:251], v3 offset:18432
v_add_f32 v214, v230, v192
v_mfma_f32_16x16x32_bf16 v[68:71], a[208:211], a[160:163], v[196:199]
v_add_f32 v215, v231, v192
v_exp_f32 v116, v116
v_mfma_f32_16x16x32_bf16 v[68:71], a[212:215], a[164:167], v[68:71]
ds_read_b128 a[252:255], v3 offset:19456
v_add_f32 v216, v232, v192
v_mfma_f32_16x16x32_bf16 v[68:71], a[216:219], a[168:171], v[68:71]
v_exp_f32 v117, v117
v_mfma_f32_16x16x32_bf16 v[68:71], a[220:223], a[172:175], v[68:71]
s_waitcnt lgkmcnt(4)
v_exp_f32 v118, v118
v_mfma_f32_16x16x32_bf16 v[80:83], a[224:227], a[144:147], v[212:215]
ds_read_b128 v[240:243], v3 offset:20480
v_add_f32 v217, v233, v192
v_mfma_f32_16x16x32_bf16 v[80:83], a[228:231], a[148:151], v[80:83]
ds_read_b128 v[244:247], v3 offset:21504
v_add_f32 v218, v234, v192
v_mfma_f32_16x16x32_bf16 v[80:83], a[232:235], a[152:155], v[80:83]
buffer_load_dwordx4 v2, s[40:43], s26 offen offset:1024 lds
v_exp_f32 v119, v119
v_mfma_f32_16x16x32_bf16 v[80:83], a[236:239], a[156:159], v[80:83]
ds_read_b128 v[248:251], v3 offset:22528
v_add_f32 v219, v235, v192
v_mfma_f32_16x16x32_bf16 v[84:87], a[224:227], a[160:163], v[196:199]
v_cvt_pk_bf16_f32 v174, v116, v117
v_cvt_pk_bf16_f32 v175, v118, v119
v_mfma_f32_16x16x32_bf16 v[84:87], a[228:231], a[164:167], v[84:87]
ds_read_b128 v[252:255], v3 offset:23552
v_add_f32 v220, v236, v192
v_mfma_f32_16x16x32_bf16 v[84:87], a[232:235], a[168:171], v[84:87]
v_exp_f32 v124, v124
v_mfma_f32_16x16x32_bf16 v[84:87], a[236:239], a[172:175], v[84:87]
s_waitcnt lgkmcnt(4)
buffer_load_dwordx4 v2, s[40:43], s26 offen offset:2048 lds
v_add_f32 v221, v237, v192
v_mfma_f32_16x16x32_bf16 v[96:99], a[240:243], a[144:147], v[216:219]
ds_read_b128 v[32:35], v4 offset:40960
v_exp_f32 v125, v125
v_mfma_f32_16x16x32_bf16 v[96:99], a[244:247], a[148:151], v[96:99]
v_exp_f32 v126, v126
v_mfma_f32_16x16x32_bf16 v[96:99], a[248:251], a[152:155], v[96:99]
ds_read_b128 v[36:39], v4 offset:57344
v_add_f32 v222, v238, v192
v_mfma_f32_16x16x32_bf16 v[96:99], a[252:255], a[156:159], v[96:99]
v_add_f32 v223, v239, v192
v_mfma_f32_16x16x32_bf16 v[100:103], a[240:243], a[160:163], v[196:199]
ds_read_b128 v[40:43], v4 offset:41984
v_exp_f32 v127, v127
v_mfma_f32_16x16x32_bf16 v[100:103], a[244:247], a[164:167], v[100:103]
v_cvt_pk_bf16_f32 v190, v124, v125
v_cvt_pk_bf16_f32 v191, v126, v127
v_mfma_f32_16x16x32_bf16 v[100:103], a[248:251], a[168:171], v[100:103]
buffer_load_dwordx4 v2, s[40:43], s26 offen offset:3072 lds
v_mfma_f32_16x16x32_bf16 v[100:103], a[252:255], a[172:175], v[100:103]
s_waitcnt lgkmcnt(3)
ds_read_b128 v[44:47], v4 offset:58368
v_mfma_f32_16x16x32_bf16 v[112:115], v[240:243], a[144:147], v[220:223]
v_exp_f32 v64, v64
v_mfma_f32_16x16x32_bf16 v[112:115], v[244:247], a[148:151], v[112:115]
ds_read_b128 v[48:51], v4 offset:43008
v_mfma_f32_16x16x32_bf16 v[112:115], v[248:251], a[152:155], v[112:115]
v_exp_f32 v65, v65
v_mfma_f32_16x16x32_bf16 v[112:115], v[252:255], a[156:159], v[112:115]
ds_read_b128 v[52:55], v4 offset:59392
v_mfma_f32_16x16x32_bf16 v[116:119], v[240:243], a[160:163], v[196:199]
v_exp_f32 v66, v66
v_mfma_f32_16x16x32_bf16 v[116:119], v[244:247], a[164:167], v[116:119]
s_add_u32 m0, m0, 4096
s_add_u32 s26, s26, 4096
buffer_load_dwordx4 v2, s[40:43], s26 offen lds
v_mfma_f32_16x16x32_bf16 v[116:119], v[248:251], a[168:171], v[116:119]
v_exp_f32 v67, v67
v_mfma_f32_16x16x32_bf16 v[116:119], v[252:255], a[172:175], v[116:119]
s_waitcnt lgkmcnt(4)
v_cvt_pk_bf16_f32 v128, v64, v65
v_cvt_pk_bf16_f32 v129, v66, v67
v_mfma_f32_16x16x32_bf16 a[0:3], v[32:35], v[160:163], a[0:3]
ds_read_b128 v[56:59], v4 offset:44032
v_mfma_f32_16x16x32_bf16 a[0:3], v[36:39], v[164:167], a[0:3]
v_exp_f32 v68, v68
v_mfma_f32_16x16x32_bf16 a[32:35], v[32:35], v[168:171], a[32:35]
v_exp_f32 v69, v69
v_mfma_f32_16x16x32_bf16 a[32:35], v[36:39], v[172:175], a[32:35]
ds_read_b128 v[60:63], v4 offset:60416
v_mfma_f32_16x16x32_bf16 a[96:99], v[32:35], v[184:187], a[96:99]
buffer_load_dwordx4 v2, s[40:43], s26 offen offset:1024 lds
v_mfma_f32_16x16x32_bf16 a[96:99], v[36:39], v[188:191], a[96:99]
s_waitcnt lgkmcnt(4)
v_exp_f32 v70, v70
v_mfma_f32_16x16x32_bf16 a[4:7], v[40:43], v[160:163], a[4:7]
ds_read_b128 v[32:35], v4 offset:45056
v_mfma_f32_16x16x32_bf16 a[4:7], v[44:47], v[164:167], a[4:7]
v_exp_f32 v71, v71
v_mfma_f32_16x16x32_bf16 a[36:39], v[40:43], v[168:171], a[36:39]
v_cvt_pk_bf16_f32 v136, v68, v69
v_cvt_pk_bf16_f32 v137, v70, v71
v_mfma_f32_16x16x32_bf16 a[36:39], v[44:47], v[172:175], a[36:39]
ds_read_b128 v[36:39], v4 offset:61440
v_mfma_f32_16x16x32_bf16 a[100:103], v[40:43], v[184:187], a[100:103]
buffer_load_dwordx4 v2, s[40:43], s26 offen offset:2048 lds
v_mfma_f32_16x16x32_bf16 a[100:103], v[44:47], v[188:191], a[100:103]
s_waitcnt lgkmcnt(4)
v_exp_f32 v80, v80
v_mfma_f32_16x16x32_bf16 a[8:11], v[48:51], v[160:163], a[8:11]
ds_read_b128 v[40:43], v4 offset:46080
v_mfma_f32_16x16x32_bf16 a[8:11], v[52:55], v[164:167], a[8:11]
v_exp_f32 v81, v81
v_mfma_f32_16x16x32_bf16 a[40:43], v[48:51], v[168:171], a[40:43]
v_exp_f32 v82, v82
v_mfma_f32_16x16x32_bf16 a[40:43], v[52:55], v[172:175], a[40:43]
ds_read_b128 v[44:47], v4 offset:62464
v_mfma_f32_16x16x32_bf16 a[104:107], v[48:51], v[184:187], a[104:107]
v_exp_f32 v83, v83
v_mfma_f32_16x16x32_bf16 a[104:107], v[52:55], v[188:191], a[104:107]
s_waitcnt lgkmcnt(4)
buffer_load_dwordx4 v2, s[40:43], s26 offen offset:3072 lds
s_add_u32 s24, s24, 32768
s_add_u32 s25, s25, 32768
s_and_b32 s25, s25, 0x1ffff
v_cvt_pk_bf16_f32 v130, v80, v81
v_mfma_f32_16x16x32_bf16 a[12:15], v[56:59], v[160:163], a[12:15]
ds_read_b128 v[48:51], v4 offset:47104
v_cvt_pk_bf16_f32 v131, v82, v83
v_mfma_f32_16x16x32_bf16 a[12:15], v[60:63], v[164:167], a[12:15]
v_exp_f32 v84, v84
v_mfma_f32_16x16x32_bf16 a[44:47], v[56:59], v[168:171], a[44:47]
v_exp_f32 v85, v85
v_mfma_f32_16x16x32_bf16 a[44:47], v[60:63], v[172:175], a[44:47]
ds_read_b128 v[52:55], v4 offset:63488
v_mfma_f32_16x16x32_bf16 a[108:111], v[56:59], v[184:187], a[108:111]
v_exp_f32 v86, v86
v_mfma_f32_16x16x32_bf16 a[108:111], v[60:63], v[188:191], a[108:111]
s_waitcnt lgkmcnt(4)
v_exp_f32 v87, v87
v_mfma_f32_16x16x32_bf16 a[16:19], v[32:35], v[160:163], a[16:19]
ds_read_b128 v[56:59], v4 offset:48128
v_cvt_pk_bf16_f32 v138, v84, v85
v_mfma_f32_16x16x32_bf16 a[16:19], v[36:39], v[164:167], a[16:19]
v_cvt_pk_bf16_f32 v139, v86, v87
v_mfma_f32_16x16x32_bf16 a[48:51], v[32:35], v[168:171], a[48:51]
v_mfma_f32_16x16x32_bf16 a[48:51], v[36:39], v[172:175], a[48:51]
ds_read_b128 v[60:63], v4 offset:64512
v_mfma_f32_16x16x32_bf16 a[112:115], v[32:35], v[184:187], a[112:115]
v_exp_f32 v96, v96
v_mfma_f32_16x16x32_bf16 a[112:115], v[36:39], v[188:191], a[112:115]
s_waitcnt lgkmcnt(4)
v_exp_f32 v97, v97
v_mfma_f32_16x16x32_bf16 a[20:23], v[40:43], v[160:163], a[20:23]
v_mfma_f32_16x16x32_bf16 a[20:23], v[44:47], v[164:167], a[20:23]
v_exp_f32 v98, v98
v_mfma_f32_16x16x32_bf16 a[52:55], v[40:43], v[168:171], a[52:55]
v_mfma_f32_16x16x32_bf16 a[52:55], v[44:47], v[172:175], a[52:55]
v_exp_f32 v99, v99
v_mfma_f32_16x16x32_bf16 a[116:119], v[40:43], v[184:187], a[116:119]
v_mfma_f32_16x16x32_bf16 a[116:119], v[44:47], v[188:191], a[116:119]
s_waitcnt lgkmcnt(2)
v_cvt_pk_bf16_f32 v132, v96, v97
v_mfma_f32_16x16x32_bf16 a[24:27], v[48:51], v[160:163], a[24:27]
s_waitcnt vmcnt(8) lgkmcnt(0)
s_barrier
v_cvt_pk_bf16_f32 v133, v98, v99
v_mfma_f32_16x16x32_bf16 a[24:27], v[52:55], v[164:167], a[24:27]
ds_read_b128 a[208:211], v3 offset:32768
v_mfma_f32_16x16x32_bf16 a[56:59], v[48:51], v[168:171], a[56:59]
ds_read_b128 a[212:215], v3 offset:33792
v_mfma_f32_16x16x32_bf16 a[56:59], v[52:55], v[172:175], a[56:59]
v_exp_f32 v100, v100
v_mfma_f32_16x16x32_bf16 a[120:123], v[48:51], v[184:187], a[120:123]
ds_read_b128 a[216:219], v3 offset:34816
v_mfma_f32_16x16x32_bf16 a[120:123], v[52:55], v[188:191], a[120:123]
v_exp_f32 v101, v101
v_mfma_f32_16x16x32_bf16 a[28:31], v[56:59], v[160:163], a[28:31]
ds_read_b128 a[220:223], v3 offset:35840
v_mfma_f32_16x16x32_bf16 a[28:31], v[60:63], v[164:167], a[28:31]
v_exp_f32 v102, v102
v_mfma_f32_16x16x32_bf16 a[60:63], v[56:59], v[168:171], a[60:63]
ds_read_b128 a[224:227], v3 offset:36864
v_mfma_f32_16x16x32_bf16 a[60:63], v[60:63], v[172:175], a[60:63]
v_exp_f32 v103, v103
v_mfma_f32_16x16x32_bf16 a[124:127], v[56:59], v[184:187], a[124:127]
ds_read_b128 a[228:231], v3 offset:37888
v_cvt_pk_bf16_f32 v140, v100, v101
v_mfma_f32_16x16x32_bf16 a[124:127], v[60:63], v[188:191], a[124:127]
v_cvt_pk_bf16_f32 v141, v102, v103
v_mfma_f32_16x16x32_bf16 a[128:131], v[28:31], v[160:163], a[128:131]
ds_read_b128 a[232:235], v3 offset:38912
v_mfma_f32_16x16x32_bf16 a[128:131], v[28:31], v[164:167], a[128:131]
v_mfma_f32_16x16x32_bf16 a[132:135], v[28:31], v[168:171], a[132:135]
ds_read_b128 a[236:239], v3 offset:39936
v_mfma_f32_16x16x32_bf16 a[132:135], v[28:31], v[172:175], a[132:135]
v_mfma_f32_16x16x32_bf16 a[140:143], v[28:31], v[184:187], a[140:143]
v_mfma_f32_16x16x32_bf16 a[140:143], v[28:31], v[188:191], a[140:143]
v_mov_b32 v12, 0x57800000
s_nop 7
v_accvgpr_read_b32 v11, a136
s_nop 0
v_cmp_nlt_f32 vcc, v11, v12
v_rcp_f32 v11, v11
s_nop 2
s_cmp_lg_u64 vcc, 0
s_cselect_b32 s27, 4, 0
s_or_b32 s32, s32, s27
v_accvgpr_read_b32 v13, a64
v_accvgpr_read_b32 v14, a65
v_accvgpr_read_b32 v15, a66
v_accvgpr_read_b32 v16, a67
v_accvgpr_read_b32 v17, a68
v_accvgpr_read_b32 v18, a69
v_accvgpr_read_b32 v19, a70
v_accvgpr_read_b32 v20, a71
v_mul_f32 v13, v13, v11
v_mul_f32 v14, v14, v11
v_mul_f32 v15, v15, v11
v_mul_f32 v16, v16, v11
v_mul_f32 v17, v17, v11
v_mul_f32 v18, v18, v11
v_mul_f32 v19, v19, v11
v_mul_f32 v20, v20, v11
v_cvt_pk_bf16_f32 v208, v13, v14
v_cvt_pk_bf16_f32 v209, v15, v16
v_cvt_pk_bf16_f32 v210, v17, v18
v_cvt_pk_bf16_f32 v211, v19, v20
buffer_store_dwordx4 v[208:211], v2, s[48:51], s58 offen sc1
v_accvgpr_read_b32 v216, a72
v_accvgpr_read_b32 v217, a73
v_accvgpr_read_b32 v218, a74
v_accvgpr_read_b32 v219, a75
v_accvgpr_read_b32 v220, a76
v_accvgpr_read_b32 v221, a77
v_accvgpr_read_b32 v222, a78
v_accvgpr_read_b32 v223, a79
v_mul_f32 v216, v216, v11
v_mul_f32 v217, v217, v11
v_mul_f32 v218, v218, v11
v_mul_f32 v219, v219, v11
v_mul_f32 v220, v220, v11
v_mul_f32 v221, v221, v11
v_mul_f32 v222, v222, v11
v_mul_f32 v223, v223, v11
v_cvt_pk_bf16_f32 v212, v216, v217
v_cvt_pk_bf16_f32 v213, v218, v219
v_cvt_pk_bf16_f32 v214, v220, v221
v_cvt_pk_bf16_f32 v215, v222, v223
buffer_store_dwordx4 v[212:215], v2, s[48:51], s58 offen offset:1024 sc1
v_accvgpr_read_b32 v13, a80
v_accvgpr_read_b32 v14, a81
v_accvgpr_read_b32 v15, a82
v_accvgpr_read_b32 v16, a83
v_accvgpr_read_b32 v17, a84
v_accvgpr_read_b32 v18, a85
v_accvgpr_read_b32 v19, a86
v_accvgpr_read_b32 v20, a87
v_mul_f32 v13, v13, v11
v_mul_f32 v14, v14, v11
v_mul_f32 v15, v15, v11
v_mul_f32 v16, v16, v11
v_mul_f32 v17, v17, v11
v_mul_f32 v18, v18, v11
v_mul_f32 v19, v19, v11
v_mul_f32 v20, v20, v11
v_cvt_pk_bf16_f32 v208, v13, v14
v_cvt_pk_bf16_f32 v209, v15, v16
v_cvt_pk_bf16_f32 v210, v17, v18
v_cvt_pk_bf16_f32 v211, v19, v20
buffer_store_dwordx4 v[208:211], v2, s[48:51], s58 offen offset:2048 sc1
v_accvgpr_read_b32 v216, a88
v_accvgpr_read_b32 v217, a89
v_accvgpr_read_b32 v218, a90
v_accvgpr_read_b32 v219, a91
v_accvgpr_read_b32 v220, a92
v_accvgpr_read_b32 v221, a93
v_accvgpr_read_b32 v222, a94
v_accvgpr_read_b32 v223, a95
v_mul_f32 v216, v216, v11
v_mul_f32 v217, v217, v11
v_mul_f32 v218, v218, v11
v_mul_f32 v219, v219, v11
v_mul_f32 v220, v220, v11
v_mul_f32 v221, v221, v11
v_mul_f32 v222, v222, v11
v_mul_f32 v223, v223, v11
v_cvt_pk_bf16_f32 v212, v216, v217
v_cvt_pk_bf16_f32 v213, v218, v219
v_cvt_pk_bf16_f32 v214, v220, v221
v_cvt_pk_bf16_f32 v215, v222, v223
buffer_store_dwordx4 v[212:215], v2, s[48:51], s58 offen offset:3072 sc1
v_accvgpr_read_b32 v11, a140
s_nop 0
v_cmp_nlt_f32 vcc, v11, v12
v_rcp_f32 v11, v11
s_nop 2
s_cmp_lg_u64 vcc, 0
s_cselect_b32 s27, 8, 0
s_or_b32 s32, s32, s27
v_accvgpr_read_b32 v13, a96
v_accvgpr_read_b32 v14, a97
v_accvgpr_read_b32 v15, a98
v_accvgpr_read_b32 v16, a99
v_accvgpr_read_b32 v17, a100
v_accvgpr_read_b32 v18, a101
v_accvgpr_read_b32 v19, a102
v_accvgpr_read_b32 v20, a103
v_mul_f32 v13, v13, v11
v_mul_f32 v14, v14, v11
v_mul_f32 v15, v15, v11
v_mul_f32 v16, v16, v11
v_mul_f32 v17, v17, v11
v_mul_f32 v18, v18, v11
v_mul_f32 v19, v19, v11
v_mul_f32 v20, v20, v11
v_cvt_pk_bf16_f32 v208, v13, v14
v_cvt_pk_bf16_f32 v209, v15, v16
v_cvt_pk_bf16_f32 v210, v17, v18
v_cvt_pk_bf16_f32 v211, v19, v20
buffer_store_dwordx4 v[208:211], v2, s[48:51], s59 offen sc1
v_accvgpr_read_b32 v216, a104
v_accvgpr_read_b32 v217, a105
v_accvgpr_read_b32 v218, a106
v_accvgpr_read_b32 v219, a107
v_accvgpr_read_b32 v220, a108
v_accvgpr_read_b32 v221, a109
v_accvgpr_read_b32 v222, a110
v_accvgpr_read_b32 v223, a111
v_mul_f32 v216, v216, v11
v_mul_f32 v217, v217, v11
v_mul_f32 v218, v218, v11
v_mul_f32 v219, v219, v11
v_mul_f32 v220, v220, v11
v_mul_f32 v221, v221, v11
v_mul_f32 v222, v222, v11
v_mul_f32 v223, v223, v11
v_cvt_pk_bf16_f32 v212, v216, v217
v_cvt_pk_bf16_f32 v213, v218, v219
v_cvt_pk_bf16_f32 v214, v220, v221
v_cvt_pk_bf16_f32 v215, v222, v223
buffer_store_dwordx4 v[212:215], v2, s[48:51], s59 offen offset:1024 sc1
v_accvgpr_read_b32 v13, a112
v_accvgpr_read_b32 v14, a113
v_accvgpr_read_b32 v15, a114
v_accvgpr_read_b32 v16, a115
v_accvgpr_read_b32 v17, a116
v_accvgpr_read_b32 v18, a117
v_accvgpr_read_b32 v19, a118
v_accvgpr_read_b32 v20, a119
v_mul_f32 v13, v13, v11
v_mul_f32 v14, v14, v11
v_mul_f32 v15, v15, v11
v_mul_f32 v16, v16, v11
v_mul_f32 v17, v17, v11
v_mul_f32 v18, v18, v11
v_mul_f32 v19, v19, v11
v_mul_f32 v20, v20, v11
v_cvt_pk_bf16_f32 v208, v13, v14
v_cvt_pk_bf16_f32 v209, v15, v16
v_cvt_pk_bf16_f32 v210, v17, v18
v_cvt_pk_bf16_f32 v211, v19, v20
buffer_store_dwordx4 v[208:211], v2, s[48:51], s59 offen offset:2048 sc1
v_accvgpr_read_b32 v216, a120
v_accvgpr_read_b32 v217, a121
v_accvgpr_read_b32 v218, a122
v_accvgpr_read_b32 v219, a123
v_accvgpr_read_b32 v220, a124
v_accvgpr_read_b32 v221, a125
v_accvgpr_read_b32 v222, a126
v_accvgpr_read_b32 v223, a127
v_mul_f32 v216, v216, v11
v_mul_f32 v217, v217, v11
v_mul_f32 v218, v218, v11
v_mul_f32 v219, v219, v11
v_mul_f32 v220, v220, v11
v_mul_f32 v221, v221, v11
v_mul_f32 v222, v222, v11
v_mul_f32 v223, v223, v11
v_cvt_pk_bf16_f32 v212, v216, v217
v_cvt_pk_bf16_f32 v213, v218, v219
v_cvt_pk_bf16_f32 v214, v220, v221
v_cvt_pk_bf16_f32 v215, v222, v223
buffer_store_dwordx4 v[212:215], v2, s[48:51], s59 offen offset:3072 sc1
s_branch L_att_SSm1
L_att_slow:
s_cmp_lg_u32 s39, 0
s_cbranch_scc1 L_att_slowq0
v_accvgpr_read_b32 v180, a144
v_accvgpr_read_b32 v181, a145
v_accvgpr_read_b32 v182, a146
v_accvgpr_read_b32 v183, a147
v_accvgpr_read_b32 v184, a148
v_accvgpr_read_b32 v185, a149
v_accvgpr_read_b32 v186, a150
v_accvgpr_read_b32 v187, a151
v_accvgpr_read_b32 v188, a152
v_accvgpr_read_b32 v189, a153
v_accvgpr_read_b32 v190, a154
v_accvgpr_read_b32 v191, a155
v_accvgpr_read_b32 v192, a156
v_accvgpr_read_b32 v193, a157
v_accvgpr_read_b32 v194, a158
v_accvgpr_read_b32 v195, a159
s_add_u32 s28, s33, 0
s_mov_b32 s29, s56
L_att_slowq0:
s_cmp_lg_u32 s39, 1
s_cbranch_scc1 L_att_slowq1
v_accvgpr_read_b32 v180, a160
v_accvgpr_read_b32 v181, a161
v_accvgpr_read_b32 v182, a162
v_accvgpr_read_b32 v183, a163
v_accvgpr_read_b32 v184, a164
v_accvgpr_read_b32 v185, a165
v_accvgpr_read_b32 v186, a166
v_accvgpr_read_b32 v187, a167
v_accvgpr_read_b32 v188, a168
v_accvgpr_read_b32 v189, a169
v_accvgpr_read_b32 v190, a170
v_accvgpr_read_b32 v191, a171
v_accvgpr_read_b32 v192, a172
v_accvgpr_read_b32 v193, a173
v_accvgpr_read_b32 v194, a174
v_accvgpr_read_b32 v195, a175
s_add_u32 s28, s33, 4
s_mov_b32 s29, s57
L_att_slowq1:
s_cmp_lg_u32 s39, 2
s_cbranch_scc1 L_att_slowq2
v_accvgpr_read_b32 v180, a176
v_accvgpr_read_b32 v181, a177
v_accvgpr_read_b32 v182, a178
v_accvgpr_read_b32 v183, a179
v_accvgpr_read_b32 v184, a180
v_accvgpr_read_b32 v185, a181
v_accvgpr_read_b32 v186, a182
v_accvgpr_read_b32 v187, a183
v_accvgpr_read_b32 v188, a184
v_accvgpr_read_b32 v189, a185
v_accvgpr_read_b32 v190, a186
v_accvgpr_read_b32 v191, a187
v_accvgpr_read_b32 v192, a188
v_accvgpr_read_b32 v193, a189
v_accvgpr_read_b32 v194, a190
v_accvgpr_read_b32 v195, a191
s_add_u32 s28, s34, 0
s_mov_b32 s29, s58
L_att_slowq2:
s_cmp_lg_u32 s39, 3
s_cbranch_scc1 L_att_slowq3
v_accvgpr_read_b32 v180, a192
v_accvgpr_read_b32 v181, a193
v_accvgpr_read_b32 v182, a194
v_accvgpr_read_b32 v183, a195
v_accvgpr_read_b32 v184, a196
v_accvgpr_read_b32 v185, a197
v_accvgpr_read_b32 v186, a198
v_accvgpr_read_b32 v187, a199
v_accvgpr_read_b32 v188, a200
v_accvgpr_read_b32 v189, a201
v_accvgpr_read_b32 v190, a202
v_accvgpr_read_b32 v191, a203
v_accvgpr_read_b32 v192, a204
v_accvgpr_read_b32 v193, a205
v_accvgpr_read_b32 v194, a206
v_accvgpr_read_b32 v195, a207
s_add_u32 s28, s34, 4
s_mov_b32 s29, s59
L_att_slowq3:
s_lshr_b32 s38, s28, 1
s_add_u32 s38, s38, 1
s_lshl_b32 s28, s28, 4
v_and_b32 v170, 15, v0
v_add_u32 v170, s28, v170
v_lshrrev_b32 v171, 4, v2
v_lshrrev_b32 v171, 4, v171
v_lshlrev_b32 v171, 2, v171
v_sub_u32 v170, v170, v171
v_mov_b32 v168, 0xff800000
v_mov_b32 v169, 0
v_mov_b32 v172, 0xff800000
v_mov_b32 v136, 0
v_mov_b32 v137, 0
v_mov_b32 v138, 0
v_mov_b32 v139, 0
v_mov_b32 v140, 0
v_mov_b32 v141, 0
v_mov_b32 v142, 0
v_mov_b32 v143, 0
v_mov_b32 v144, 0
v_mov_b32 v145, 0
v_mov_b32 v146, 0
v_mov_b32 v147, 0
v_mov_b32 v148, 0
v_mov_b32 v149, 0
v_mov_b32 v150, 0
v_mov_b32 v151, 0
v_mov_b32 v152, 0
v_mov_b32 v153, 0
v_mov_b32 v154, 0
v_mov_b32 v155, 0
v_mov_b32 v156, 0
v_mov_b32 v157, 0
v_mov_b32 v158, 0
v_mov_b32 v159, 0
v_mov_b32 v160, 0
v_mov_b32 v161, 0
v_mov_b32 v162, 0
v_mov_b32 v163, 0
v_mov_b32 v164, 0
v_mov_b32 v165, 0
v_mov_b32 v166, 0
v_mov_b32 v167, 0
s_mov_b32 s37, 0
L_att_slowloop:
s_lshl_b32 s28, s37, 14
buffer_load_dwordx4 v[64:67], v2, s[40:43], s28 offen
buffer_load_dwordx4 v[68:71], v2, s[40:43], s28 offen offset:1024
buffer_load_dwordx4 v[72:75], v2, s[40:43], s28 offen offset:2048
buffer_load_dwordx4 v[76:79], v2, s[40:43], s28 offen offset:3072
s_add_u32 s28, s28, 4096
buffer_load_dwordx4 v[80:83], v2, s[40:43], s28 offen
buffer_load_dwordx4 v[84:87], v2, s[40:43], s28 offen offset:1024
buffer_load_dwordx4 v[88:91], v2, s[40:43], s28 offen offset:2048
buffer_load_dwordx4 v[92:95], v2, s[40:43], s28 offen offset:3072
s_add_u32 s28, s28, 4096
buffer_load_dwordx4 v[96:99], v2, s[40:43], s28 offen
buffer_load_dwordx4 v[100:103], v2, s[40:43], s28 offen offset:1024
buffer_load_dwordx4 v[104:107], v2, s[40:43], s28 offen offset:2048
buffer_load_dwordx4 v[108:111], v2, s[40:43], s28 offen offset:3072
s_add_u32 s28, s28, 4096
buffer_load_dwordx4 v[112:115], v2, s[40:43], s28 offen
buffer_load_dwordx4 v[116:119], v2, s[40:43], s28 offen offset:1024
buffer_load_dwordx4 v[120:123], v2, s[40:43], s28 offen offset:2048
buffer_load_dwordx4 v[124:127], v2, s[40:43], s28 offen offset:3072
s_waitcnt vmcnt(15)
v_mfma_f32_16x16x32_bf16 v[128:131], v[64:67], v[180:183], 0
s_waitcnt vmcnt(14)
v_mfma_f32_16x16x32_bf16 v[128:131], v[68:71], v[184:187], v[128:131]
s_waitcnt vmcnt(13)
v_mfma_f32_16x16x32_bf16 v[128:131], v[72:75], v[188:191], v[128:131]
s_waitcnt vmcnt(12)
v_mfma_f32_16x16x32_bf16 v[128:131], v[76:79], v[192:195], v[128:131]
s_waitcnt vmcnt(11)
v_mfma_f32_16x16x32_bf16 v[132:135], v[80:83], v[180:183], 0
s_waitcnt vmcnt(10)
v_mfma_f32_16x16x32_bf16 v[132:135], v[84:87], v[184:187], v[132:135]
s_waitcnt vmcnt(9)
v_mfma_f32_16x16x32_bf16 v[132:135], v[88:91], v[188:191], v[132:135]
s_waitcnt vmcnt(8)
v_mfma_f32_16x16x32_bf16 v[132:135], v[92:95], v[192:195], v[132:135]
s_waitcnt vmcnt(7)
s_lshl_b32 s30, s37, 5
s_nop 7
s_add_u32 s31, s30, 0
v_cmp_le_i32 vcc, s31, v170
s_nop 1
v_cndmask_b32 v128, v172, v128, vcc
s_add_u32 s31, s30, 1
v_cmp_le_i32 vcc, s31, v170
s_nop 1
v_cndmask_b32 v129, v172, v129, vcc
s_add_u32 s31, s30, 2
v_cmp_le_i32 vcc, s31, v170
s_nop 1
v_cndmask_b32 v130, v172, v130, vcc
s_add_u32 s31, s30, 3
v_cmp_le_i32 vcc, s31, v170
s_nop 1
v_cndmask_b32 v131, v172, v131, vcc
s_add_u32 s31, s30, 16
v_cmp_le_i32 vcc, s31, v170
s_nop 1
v_cndmask_b32 v132, v172, v132, vcc
s_add_u32 s31, s30, 17
v_cmp_le_i32 vcc, s31, v170
s_nop 1
v_cndmask_b32 v133, v172, v133, vcc
s_add_u32 s31, s30, 18
v_cmp_le_i32 vcc, s31, v170
s_nop 1
v_cndmask_b32 v134, v172, v134, vcc
s_add_u32 s31, s30, 19
v_cmp_le_i32 vcc, s31, v170
s_nop 1
v_cndmask_b32 v135, v172, v135, vcc
v_max3_f32 v173, v128, v129, v130
v_max3_f32 v173, v173, v131, v132
v_max3_f32 v173, v173, v133, v134
v_max3_f32 v173, v173, v135, v168
v_mov_b32 v174, v173
s_nop 1
v_permlane16_swap_b32 v173, v174
s_nop 1
v_max_f32 v173, v173, v174
v_mov_b32 v174, v173
s_nop 1
v_permlane32_swap_b32 v173, v174
s_nop 1
v_max_f32 v173, v173, v174
v_sub_f32 v174, v168, v173
v_exp_f32 v174, v174
v_mov_b32 v168, v173
v_sub_f32 v128, v128, v168
v_exp_f32 v128, v128
v_sub_f32 v129, v129, v168
v_exp_f32 v129, v129
v_sub_f32 v130, v130, v168
v_exp_f32 v130, v130
v_sub_f32 v131, v131, v168
v_exp_f32 v131, v131
v_sub_f32 v132, v132, v168
v_exp_f32 v132, v132
v_sub_f32 v133, v133, v168
v_exp_f32 v133, v133
v_sub_f32 v134, v134, v168
v_exp_f32 v134, v134
v_sub_f32 v135, v135, v168
v_exp_f32 v135, v135
s_nop 0
v_cvt_pk_bf16_f32 v176, v128, v129
v_cvt_pk_bf16_f32 v177, v130, v131
v_cvt_pk_bf16_f32 v178, v132, v133
v_cvt_pk_bf16_f32 v179, v134, v135
v_mul_f32 v169, v169, v174
v_lshlrev_b32 v175, 16, v176
v_add_f32 v169, v169, v175
v_and_b32 v175, 0xffff0000, v176
v_add_f32 v169, v169, v175
v_lshlrev_b32 v175, 16, v177
v_add_f32 v169, v169, v175
v_and_b32 v175, 0xffff0000, v177
v_add_f32 v169, v169, v175
v_lshlrev_b32 v175, 16, v178
v_add_f32 v169, v169, v175
v_and_b32 v175, 0xffff0000, v178
v_add_f32 v169, v169, v175
v_lshlrev_b32 v175, 16, v179
v_add_f32 v169, v169, v175
v_and_b32 v175, 0xffff0000, v179
v_add_f32 v169, v169, v175
v_mul_f32 v136, v136, v174
v_mul_f32 v137, v137, v174
v_mul_f32 v138, v138, v174
v_mul_f32 v139, v139, v174
v_mul_f32 v140, v140, v174
v_mul_f32 v141, v141, v174
v_mul_f32 v142, v142, v174
v_mul_f32 v143, v143, v174
v_mul_f32 v144, v144, v174
v_mul_f32 v145, v145, v174
v_mul_f32 v146, v146, v174
v_mul_f32 v147, v147, v174
v_mul_f32 v148, v148, v174
v_mul_f32 v149, v149, v174
v_mul_f32 v150, v150, v174
v_mul_f32 v151, v151, v174
v_mul_f32 v152, v152, v174
v_mul_f32 v153, v153, v174
v_mul_f32 v154, v154, v174
v_mul_f32 v155, v155, v174
v_mul_f32 v156, v156, v174
v_mul_f32 v157, v157, v174
v_mul_f32 v158, v158, v174
v_mul_f32 v159, v159, v174
v_mul_f32 v160, v160, v174
v_mul_f32 v161, v161, v174
v_mul_f32 v162, v162, v174
v_mul_f32 v163, v163, v174
v_mul_f32 v164, v164, v174
v_mul_f32 v165, v165, v174
v_mul_f32 v166, v166, v174
v_mul_f32 v167, v167, v174
s_nop 1
v_mfma_f32_16x16x32_bf16 v[136:139], v[96:99], v[176:179], v[136:139]
s_waitcnt vmcnt(6)
v_mfma_f32_16x16x32_bf16 v[140:143], v[100:103], v[176:179], v[140:143]
s_waitcnt vmcnt(5)
v_mfma_f32_16x16x32_bf16 v[144:147], v[104:107], v[176:179], v[144:147]
s_waitcnt vmcnt(4)
v_mfma_f32_16x16x32_bf16 v[148:151], v[108:111], v[176:179], v[148:151]
s_waitcnt vmcnt(3)
v_mfma_f32_16x16x32_bf16 v[152:155], v[112:115], v[176:179], v[152:155]
s_waitcnt vmcnt(2)
v_mfma_f32_16x16x32_bf16 v[156:159], v[116:119], v[176:179], v[156:159]
s_waitcnt vmcnt(1)
v_mfma_f32_16x16x32_bf16 v[160:163], v[120:123], v[176:179], v[160:163]
s_waitcnt vmcnt(0)
v_mfma_f32_16x16x32_bf16 v[164:167], v[124:127], v[176:179], v[164:167]
s_nop 7
s_add_u32 s37, s37, 1
s_cmp_lt_u32 s37, s38
s_cbranch_scc1 L_att_slowloop
v_mov_b32 v174, v169
s_nop 1
v_permlane16_swap_b32 v169, v174
s_nop 1
v_add_f32 v169, v169, v174
v_mov_b32 v174, v169
s_nop 1
v_permlane32_swap_b32 v169, v174
s_nop 1
v_add_f32 v169, v169, v174
v_rcp_f32 v169, v169
s_nop 0
v_mul_f32 v136, v136, v169
v_mul_f32 v137, v137, v169
v_mul_f32 v138, v138, v169
v_mul_f32 v139, v139, v169
v_mul_f32 v140, v140, v169
v_mul_f32 v141, v141, v169
v_mul_f32 v142, v142, v169
v_mul_f32 v143, v143, v169
v_mul_f32 v144, v144, v169
v_mul_f32 v145, v145, v169
v_mul_f32 v146, v146, v169
v_mul_f32 v147, v147, v169
v_mul_f32 v148, v148, v169
v_mul_f32 v149, v149, v169
v_mul_f32 v150, v150, v169
v_mul_f32 v151, v151, v169
v_mul_f32 v152, v152, v169
v_mul_f32 v153, v153, v169
v_mul_f32 v154, v154, v169
v_mul_f32 v155, v155, v169
v_mul_f32 v156, v156, v169
v_mul_f32 v157, v157, v169
v_mul_f32 v158, v158, v169
v_mul_f32 v159, v159, v169
v_mul_f32 v160, v160, v169
v_mul_f32 v161, v161, v169
v_mul_f32 v162, v162, v169
v_mul_f32 v163, v163, v169
v_mul_f32 v164, v164, v169
v_mul_f32 v165, v165, v169
v_mul_f32 v166, v166, v169
v_mul_f32 v167, v167, v169
v_cvt_pk_bf16_f32 v128, v136, v137
v_cvt_pk_bf16_f32 v129, v138, v139
v_cvt_pk_bf16_f32 v130, v140, v141
v_cvt_pk_bf16_f32 v131, v142, v143
buffer_store_dwordx4 v[128:131], v2, s[48:51], s29 offen sc1
s_nop 1
v_cvt_pk_bf16_f32 v128, v144, v145
v_cvt_pk_bf16_f32 v129, v146, v147
v_cvt_pk_bf16_f32 v130, v148, v149
v_cvt_pk_bf16_f32 v131, v150, v151
buffer_store_dwordx4 v[128:131], v2, s[48:51], s29 offen offset:1024 sc1
s_nop 1
v_cvt_pk_bf16_f32 v128, v152, v153
v_cvt_pk_bf16_f32 v129, v154, v155
v_cvt_pk_bf16_f32 v130, v156, v157
v_cvt_pk_bf16_f32 v131, v158, v159
buffer_store_dwordx4 v[128:131], v2, s[48:51], s29 offen offset:2048 sc1
s_nop 1
v_cvt_pk_bf16_f32 v128, v160, v161
v_cvt_pk_bf16_f32 v129, v162, v163
v_cvt_pk_bf16_f32 v130, v164, v165
v_cvt_pk_bf16_f32 v131, v166, v167
buffer_store_dwordx4 v[128:131], v2, s[48:51], s29 offen offset:3072 sc1
s_nop 1
s_branch L_att_slowret
.section .rodata,"a"
.p2align 6
.amdhsa_kernel ap_kernel
  .amdhsa_next_free_vgpr 512
  .amdhsa_next_free_sgpr 102
  .amdhsa_accum_offset 256
  .amdhsa_group_segment_fixed_size 0
  .amdhsa_kernarg_size 104
  .amdhsa_user_sgpr_count 2
  .amdhsa_user_sgpr_kernarg_segment_ptr 1
  .amdhsa_system_sgpr_workgroup_id_x 1
  .amdhsa_float_denorm_mode_32 3
.end_amdhsa_kernel
```
